```python
import torch

def _softmax(x, axis=-1):
    return torch.softmax(x, dim=axis)
def _gelu(x):
    return torch.nn.functional.gelu(x, approximate="tanh")
def _silu(x):
    return torch.nn.functional.silu(x)
def _sigmoid(x):
    return torch.sigmoid(x)
def _layernorm(x, axis=-1, eps=1e-5):
    m = x.mean(dim=axis, keepdim=True)
    v = x.var(dim=axis, keepdim=True, unbiased=False)
    return (x - m) / torch.sqrt(v + eps)
def _scatter_add(tgt, idx, src, axis=0):
    return tgt.clone().index_add_(axis, idx, src)
def _segment_sum(src, seg, n):
    out = torch.zeros((n,) + src.shape[1:], dtype=src.dtype)
    return out.index_add_(0, seg, src)
def _pad(x, pw):
    flat = tuple(v for pair in reversed(pw) for v in pair)
    return torch.nn.functional.pad(x, flat)

kernel_name = 'parallel_sum__softmax_full_mha__swiglu_ffn__prompt'

def setup_inputs():

    _w = (lambda a: (lambda t: t.to(torch.bfloat16) if t.is_floating_point() else t)(torch.as_tensor(a)))
    def _A_setup():
        B, S, D = 1, 2048, 1024
        return {
            "x": _w((lambda *s: torch.randn(*s, dtype=torch.bfloat16) * 0.05)(B, S, D)),
            "wqkv": _w((lambda *s: torch.randn(*s, dtype=torch.bfloat16) * 0.05)(D, 3 * D)),
            "wo": _w((lambda *s: torch.randn(*s, dtype=torch.bfloat16) * 0.05)(D, D)),
        }
    _A_in = _A_setup()

    def _B_setup():
        B, S, D, F = 1, 2048, 1024, 3584
        return {
            "x": _w((lambda *s: torch.randn(*s, dtype=torch.bfloat16) * 0.05)(B, S, D)),
            "w_gate": _w((lambda *s: torch.randn(*s, dtype=torch.bfloat16) * 0.05)(D, F)),
            "w_up": _w((lambda *s: torch.randn(*s, dtype=torch.bfloat16) * 0.05)(D, F)),
            "w_down": _w((lambda *s: torch.randn(*s, dtype=torch.bfloat16) * 0.05)(F, D)),
        }
    _B_in = _B_setup()

    return {
        "A_x": _A_in["x"],
        "A_wqkv": _A_in["wqkv"],
        "A_wo": _A_in["wo"],
        "B_x": _B_in["x"],
        "B_w_gate": _B_in["w_gate"],
        "B_w_up": _B_in["w_up"],
        "B_w_down": _B_in["w_down"],
    }

def reference(A_x, A_wqkv, A_wo, B_x, B_w_gate, B_w_up, B_w_down):
    def _A_ref(x, wqkv, wo):
        B, S, D = x.shape
        H = 32; Dh = D // H
        qkv = (lambda x, *d: x.permute(*d))((x @ wqkv).reshape(B, S, 3, H, Dh), 2, 0, 3, 1, 4)
        q, k, v = qkv[0], qkv[1], qkv[2]
        scale = Dh ** -0.5
        scores = torch.einsum("bhqd,bhkd->bhqk", q, k) * scale
        p = _softmax(scores, axis=-1)
        o = torch.einsum("bhqk,bhkd->bhqd", p, v)
        return (lambda x, *d: x.permute(*d))(o, 0, 2, 1, 3).reshape(B, S, D) @ wo

    def _B_ref(x, w_gate, w_up, w_down):
        g = _silu(x @ w_gate)
        u = x @ w_up
        return (g * u) @ w_down

    x = A_x
    xn = _layernorm(x, axis=-1)
    return x + _A_ref(xn, A_wqkv, A_wo) + _B_ref(xn, B_w_gate, B_w_up, B_w_down)
```

```asm
; @launch grid=(256,1,1) block=(256,1,1) lds=163840
.amdgcn_target "amdgcn-amd-amdhsa--gfx950"
.text
.globl parallel_sum__softmax_full_mha__swiglu_ffn__prompt_kernel
.p2align 8
.type parallel_sum__softmax_full_mha__swiglu_ffn__prompt_kernel,@function
parallel_sum__softmax_full_mha__swiglu_ffn__prompt_kernel:
s_cmp_lt_u32 s2,256
s_cbranch_scc1 L_go
s_endpgm
L_go:
s_load_dwordx4 s[8:11],s[0:1],0
s_load_dwordx4 s[36:39],s[0:1],32
s_load_dwordx4 s[52:55],s[0:1],64
s_load_dwordx2 s[64:65],s[0:1],48
s_load_dwordx2 s[68:69],s[0:1],16
s_getpc_b64 s[60:61]
v_and_b32 v140,15,v0
v_lshlrev_b32 v140,7,v140
global_load_dword v139,v140,s[60:61] offset:128
v_lshrrev_b32 v1,6,v0
v_and_b32 v2,63,v0
v_readfirstlane_b32 s31,v1
s_and_b32 s32,s2,7
s_lshr_b32 s33,s2,3
s_and_b32 s34,s33,7
s_lshr_b32 s33,s33,3
s_lshl_b32 s33,s33,3
s_add_u32 s35,s32,s33
s_getpc_b64 s[60:61]
.Lct0:
s_cmp_ge_u32 s35,24
s_mov_b32 s62,L_mainA-.Lct0
s_cselect_b32 s62,L_mainB-.Lct0,s62
s_add_u32 s60,s60,s62
s_addc_u32 s61,s61,0
s_and_b32 s62,s34,3
s_lshl_b32 s62,s62,2
s_add_u32 s62,s62,s31
s_lshl_b32 s62,s62,7
v_min_u32 v140,3,v2
v_lshl_add_u32 v140,v140,11,s62
global_load_dword v139,v140,s[60:61]
s_lshl_b32 s29,s31,12
s_lshl_b32 s30,s31,10
s_lshl_b32 s33,s31,13
s_and_b32 s40,s31,1
s_lshr_b32 s41,s31,1
v_lshrrev_b32 v5,4,v2
v_lshrrev_b32 v3,5,v2
v_bfe_u32 v4,v2,3,2
v_lshl_add_u32 v3,v3,3,v4
v_bfe_u32 v4,v2,1,2
v_xor_b32 v4,v4,v5
v_and_b32 v5,1,v2
v_lshl_add_u32 v4,v4,1,v5
v_lshlrev_b32 v4,4,v4
s_cmp_ge_u32 s35,24
s_cselect_b32 s42,1,0
s_mov_b32 s28,7168
s_mov_b32 s18,0x700000
s_mov_b32 s15,0x00020000
s_mov_b32 s19,0x00020000
s_cbranch_scc1 L_descB
s_lshl_b32 s43,s35,8
s_add_u32 s26,s43,128
s_cmp_eq_u32 s31,3
s_cselect_b32 s46,2,1
s_cmp_eq_u32 s31,2
s_cselect_b32 s25,s26,s43
s_branch L_descC
L_descB:
s_sub_u32 s43,s35,24
s_lshl_b32 s26,s43,7
s_add_u32 s26,s26,6144
s_lshl_b32 s43,s43,8
s_lshl_b32 s25,s31,7
s_add_u32 s25,s25,s43
s_add_u32 s25,s25,3968
s_cmp_eq_u32 s31,3
s_cselect_b32 s46,1,0
s_cselect_b32 s25,s26,s25
L_descC:
s_and_b32 s48,s35,7
s_lshl_b32 s48,s48,1
s_bfe_u32 s49,s35,0x10003
s_add_u32 s48,s48,s49
s_and_b32 s49,s35,16
s_add_u32 s48,s48,s49
s_lshl_b32 s48,s48,7
s_cmp_eq_u32 s31,0
s_cselect_b32 s46,0,s46
s_cselect_b32 s25,s48,s25
s_cmp_eq_u32 s46,0
s_cselect_b32 s27,6144,s28
s_cselect_b32 s14,0x600000,s18
v_mad_u32_u24 v132,v3,s27,v4
v_mad_u32_u24 v136,v3,s28,v4
s_mul_i32 s48,s27,4
s_sub_u32 s48,s48,1024
v_add_u32 v133,s48,v132
s_mul_i32 s48,s27,16
s_sub_u32 s48,s48,2048
v_add_u32 v134,s48,v132
s_mul_i32 s48,s27,20
s_sub_u32 s48,s48,3072
v_add_u32 v135,s48,v132
s_lshl_b32 s48,s41,4
s_lshl_b32 s49,s40,2
s_add_u32 s48,s48,s49
s_mul_i32 s48,s48,s28
s_add_u32 s26,s26,s48
s_lshl_b32 s27,s27,5
s_lshl_b32 s28,s28,5
s_waitcnt lgkmcnt(0)
s_cmp_eq_u32 s46,1
s_cselect_b64 s[12:13],s[36:37],s[38:39]
s_cmp_eq_u32 s46,0
s_cselect_b64 s[12:13],s[10:11],s[12:13]
s_mov_b32 s16,s38
s_and_b32 s17,s39,0xffff
s_and_b32 s13,s13,0xffff
s_mov_b64 s[6:7],s[54:55]
s_and_b32 s9,s9,0xffff
s_mov_b32 s10,0x400000
s_mov_b32 s11,0x00020000
s_add_u32 m0,s29,65536
s_nop 0
buffer_load_dwordx4 v132,s[12:15],s25 offen lds
buffer_load_dwordx4 v133,s[12:15],s25 offen offset:1024 lds
buffer_load_dwordx4 v134,s[12:15],s25 offen offset:2048 lds
buffer_load_dwordx4 v135,s[12:15],s25 offen offset:3072 lds
s_add_u32 s25,s25,s27
s_add_u32 m0,s30,81920
s_nop 0
buffer_load_dwordx4 v136,s[16:19],s26 offen lds
s_add_u32 s26,s26,s28
v_lshrrev_b32 v3,3,v2
v_and_b32 v4,7,v2
v_lshrrev_b32 v5,4,v2
v_xor_b32 v4,v4,v5
v_lshlrev_b32 v3,11,v3
v_lshl_add_u32 v128,v4,4,v3
v_xor_b32 v4,4,v4
v_lshl_add_u32 v6,v4,4,v3
v_add_u32 v129,15360,v6
v_add_u32 v130,30720,v128
v_add_u32 v131,46080,v6
s_lshl_b32 s24,s34,19
s_lshl_b32 s43,s31,17
s_add_u32 s24,s24,s43
s_add_u32 s32,s24,0x10000
s_lshl_b32 s63,s34,19
s_lshl_b32 s44,s35,14
s_add_u32 s63,s63,s44
s_add_u32 s63,s63,s29
v_lshlrev_b32 v9,4,v2
s_add_u32 m0,s33,0
s_nop 0
buffer_load_dwordx4 v128,s[8:11],s24 offen lds
buffer_load_dwordx4 v129,s[8:11],s24 offen offset:1024 lds
buffer_load_dwordx4 v130,s[8:11],s24 offen offset:2048 lds
buffer_load_dwordx4 v131,s[8:11],s24 offen offset:3072 lds
s_add_u32 m0,s33,4096
s_nop 0
buffer_load_dwordx4 v128,s[8:11],s32 offen lds
buffer_load_dwordx4 v129,s[8:11],s32 offen offset:1024 lds
buffer_load_dwordx4 v130,s[8:11],s32 offen offset:2048 lds
buffer_load_dwordx4 v131,s[8:11],s32 offen offset:3072 lds
s_add_u32 s24,s24,128
s_add_u32 s32,s32,128
s_add_u32 m0,s29,86016
s_nop 0
buffer_load_dwordx4 v132,s[12:15],s25 offen lds
buffer_load_dwordx4 v133,s[12:15],s25 offen offset:1024 lds
buffer_load_dwordx4 v134,s[12:15],s25 offen offset:2048 lds
buffer_load_dwordx4 v135,s[12:15],s25 offen offset:3072 lds
s_add_u32 s25,s25,s27
s_add_u32 m0,s30,102400
s_nop 0
buffer_load_dwordx4 v136,s[16:19],s26 offen lds
s_add_u32 s26,s26,s28
s_mov_b32 s20,s6
s_and_b32 s21,s7,0xffff
s_mov_b32 s22,0x4000000
s_mov_b32 s23,0x00020000
s_and_b32 s53,s53,0xffff
s_mov_b32 s54,256
s_mov_b32 s55,0x00020000
s_lshl_b32 s43,s35,7
s_lshl_b32 s44,s34,2
s_add_u32 s43,s43,s44
s_add_u32 s43,s43,0x2700000
s_lshl_b32 s45,s34,7
s_lshl_b32 s46,s35,2
s_add_u32 s45,s45,s46
s_add_u32 s56,s45,0x2701800
s_add_u32 s45,s45,0x2701000
s_lshl_b32 s46,s35,5
s_add_u32 s46,s46,s44
s_add_u32 s58,s46,0x2701c00
s_and_b32 s46,s2,7
s_lshl_b32 s46,s46,2
s_lshr_b32 s47,s2,6
s_add_u32 s47,s47,s46
s_lshl_b32 s47,s47,2
s_lshl_b32 s46,s34,7
s_add_u32 s46,s46,s47
s_add_u32 s46,s46,0x2701400
s_xor_b32 s47,s2,5
s_lshl_b32 s47,s47,7
s_add_u32 s47,s47,0x2702000
v_mov_b32 v10,s58
v_mov_b32 v11,0
s_add_u32 s3,s47,64
s_lshl_b32 s44,s2,7
s_add_u32 s44,s44,0x2702044
v_writelane_b32 v10,s43,0
v_writelane_b32 v10,s45,1
v_writelane_b32 v10,s46,2
v_writelane_b32 v10,s47,3
v_writelane_b32 v10,s56,4
v_writelane_b32 v10,s3,5
v_writelane_b32 v10,s44,6
v_and_b32 v3,15,v2
v_lshrrev_b32 v4,4,v2
v_lshrrev_b32 v5,1,v3
v_xor_b32 v4,v4,v5
v_lshlrev_b32 v3,7,v3
s_lshl_b32 s48,s40,14
v_add_u32 v3,s48,v3
v_lshl_add_u32 v112,v4,4,v3
v_xor_b32 v113,64,v112
v_add_u32 v114,32768,v112
v_add_u32 v115,32768,v113
v_lshrrev_b32 v3,5,v2
v_bfe_u32 v4,v2,4,1
v_bfe_u32 v5,v2,2,2
v_lshlrev_b32 v3,4,v3
v_lshl_add_u32 v3,v4,2,v3
v_add_u32 v3,v3,v5
v_bfe_u32 v6,v3,1,2
v_lshlrev_b32 v3,7,v3
v_and_b32 v5,3,v2
v_lshl_add_u32 v3,v5,3,v3
v_add_u32 v3,65536,v3
s_lshl_b32 s48,s41,12
s_lshl_b32 s49,s41,1
v_xor_b32 v7,0,v6
v_lshl_add_u32 v7,v7,5,v3
v_add_u32 v120,s48,v7
v_add_u32 v124,61440,v120
v_xor_b32 v7,1,v6
v_lshl_add_u32 v7,v7,5,v3
v_add_u32 v121,s48,v7
v_add_u32 v125,61440,v121
v_xor_b32 v7,2,v6
v_lshl_add_u32 v7,v7,5,v3
v_add_u32 v122,s48,v7
v_add_u32 v126,61440,v122
v_xor_b32 v7,3,v6
v_lshl_add_u32 v7,v7,5,v3
v_add_u32 v123,s48,v7
v_add_u32 v127,61440,v123
v_xor_b32 v7,0,v6
v_xor_b32 v7,s49,v7
v_lshl_add_u32 v116,v7,5,v3
v_add_u32 v118,61440,v116
v_xor_b32 v7,1,v6
v_xor_b32 v7,s49,v7
v_lshl_add_u32 v117,v7,5,v3
v_add_u32 v119,61440,v117
v_and_b32 v3,15,v2
v_lshrrev_b32 v4,5,v2
v_lshrrev_b32 v3,1,v3
v_cmp_eq_u32 vcc,v3,v4
v_mov_b32 v5,0x3f803f80
v_and_b32 v3,1,v2
v_cndmask_b32 v164,0,v5,vcc
v_cmp_eq_u32 vcc,1,v3
v_mov_b32 v5,0xeeee
v_mov_b32 v4,0x4444
v_mov_b32 v165,v164
v_mov_b32 v166,v164
v_mov_b32 v167,v164
v_cndmask_b32 v143,v4,v5,vcc
v_mov_b32 v144,0
v_mov_b32 v145,0
v_mov_b32 v146,0
v_mov_b32 v147,0
v_mov_b32 v148,0
v_mov_b32 v149,0
v_mov_b32 v150,0
v_mov_b32 v151,0
v_mov_b32 v152,0
v_mov_b32 v153,0
v_mov_b32 v154,0
v_mov_b32 v155,0
v_mov_b32 v156,0
v_mov_b32 v157,0
v_mov_b32 v158,0
v_mov_b32 v159,0
v_mov_b32 v160,0
v_mov_b32 v161,0
v_mov_b32 v162,0
v_mov_b32 v163,0
s_and_b32 s65,s65,0xffff
s_mov_b32 s66,0x700000
s_mov_b32 s67,0x00020000
s_and_b32 s69,s69,0xffff
s_mov_b32 s70,0x200000
s_mov_b32 s71,0x00020000
s_lshl_b32 s72,s2,2
s_add_u32 s72,s72,s31
s_lshl_b32 s73,s72,11
s_mul_i32 s72,s72,1792
v_lshlrev_b32 v137,7,v2
v_mov_b32 v140,0x80000000
v_cmp_gt_u32 vcc,16,v2
v_cmp_gt_u32 s[74:75],14,v2
s_nop 1
v_cndmask_b32 v138,v140,v137,vcc
v_cndmask_b32 v137,v140,v137,s[74:75]
s_max_u32 s57,s34,1
s_add_u32 s57,s57,1
s_cmp_le_u32 s34,4
s_cselect_b32 s57,s57,-1
s_cmp_eq_u32 s31,0
s_cselect_b32 s51,2,-1
s_cselect_b32 s57,s57,-1
s_cmp_eq_u32 s40,1
s_cselect_b64 vcc,-1,0
s_waitcnt vmcnt(5)
s_barrier
ds_read_b64_tr_b16 v[16:17],v116
ds_read_b64_tr_b16 v[18:19],v116 offset:1024
ds_read_b64_tr_b16 v[20:21],v117
ds_read_b64_tr_b16 v[22:23],v117 offset:1024
ds_read_b64_tr_b16 v[24:25],v120 offset:4096
ds_read_b64_tr_b16 v[26:27],v120 offset:5120
ds_read_b64_tr_b16 v[28:29],v121 offset:4096
ds_read_b64_tr_b16 v[30:31],v121 offset:5120
ds_read_b64_tr_b16 v[32:33],v122 offset:4096
ds_read_b64_tr_b16 v[34:35],v122 offset:5120
ds_read_b64_tr_b16 v[36:37],v123 offset:4096
ds_read_b64_tr_b16 v[38:39],v123 offset:5120
ds_read_b128 v[96:99],v112
ds_read_b128 v[100:103],v112 offset:2048
s_add_u32 m0,s29,106496
s_nop 0
buffer_load_dwordx4 v132,s[12:15],s25 offen lds
buffer_load_dwordx4 v133,s[12:15],s25 offen offset:1024 lds
buffer_load_dwordx4 v134,s[12:15],s25 offen offset:2048 lds
buffer_load_dwordx4 v135,s[12:15],s25 offen offset:3072 lds
s_add_u32 s25,s25,s27
s_add_u32 m0,s30,122880
s_nop 0
buffer_load_dwordx4 v136,s[16:19],s26 offen lds
s_add_u32 s26,s26,s28
s_waitcnt lgkmcnt(0)
s_cmp_eq_u32 s42,1
s_cbranch_scc1 L_mainB
L_mainA:
ds_read_b64_tr_b16 v[40:41],v120 offset:12288
ds_read_b64_tr_b16 v[42:43],v120 offset:13312
ds_read_b64_tr_b16 v[44:45],v121 offset:12288
ds_read_b64_tr_b16 v[46:47],v121 offset:13312
ds_read_b64_tr_b16 v[48:49],v122 offset:12288
ds_read_b64_tr_b16 v[50:51],v122 offset:13312
ds_read_b64_tr_b16 v[52:53],v123 offset:12288
ds_read_b64_tr_b16 v[54:55],v123 offset:13312
s_mov_b32 s50,0
s_waitcnt vmcnt(5) lgkmcnt(0)
s_barrier
v_mfma_f32_16x16x32_bf16 a[0:3],v[16:19],v[96:99],0
s_add_u32 m0,s29,126976
v_mfma_f32_16x16x32_bf16 a[4:7],v[20:23],v[96:99],0
ds_read_b128 v[104:107],v112 offset:4096
buffer_load_dwordx4 v132,s[12:15],s25 offen lds
v_mfma_f32_16x16x32_bf16 a[8:11],v[24:27],v[96:99],0
s_cmp_lg_u32 s31,0
s_cbranch_scc1 L_nzA
s_mov_b64 exec,255
buffer_store_dword v11,v10,s[20:23],0 offen sc1
s_mov_b64 exec,-1
L_nzA:
v_mfma_f32_16x16x32_bf16 a[12:15],v[28:31],v[96:99],0
ds_read_b64_tr_b16 v[56:57],v116 offset:20480
v_mfma_f32_16x16x32_bf16 a[16:19],v[32:35],v[96:99],0
v_mfma_f32_16x16x32_bf16 a[20:23],v[36:39],v[96:99],0
ds_read_b64_tr_b16 v[58:59],v116 offset:21504
buffer_load_dwordx4 v133,s[12:15],s25 offen offset:1024 lds
v_mfma_f32_16x16x32_bf16 a[24:27],v[40:43],v[96:99],0
v_mfma_f32_16x16x32_bf16 a[28:31],v[44:47],v[96:99],0
ds_read_b64_tr_b16 v[60:61],v117 offset:20480
v_mfma_f32_16x16x32_bf16 a[32:35],v[48:51],v[96:99],0
v_mfma_f32_16x16x32_bf16 a[36:39],v[52:55],v[96:99],0
ds_read_b64_tr_b16 v[62:63],v117 offset:21504
buffer_load_dwordx4 v134,s[12:15],s25 offen offset:2048 lds
v_mfma_f32_16x16x32_bf16 a[40:43],v[16:19],v[100:103],0
v_mfma_f32_16x16x32_bf16 a[44:47],v[20:23],v[100:103],0
ds_read_b128 v[108:111],v112 offset:6144
v_mfma_f32_16x16x32_bf16 a[48:51],v[24:27],v[100:103],0
v_mfma_f32_16x16x32_bf16 a[52:55],v[28:31],v[100:103],0
ds_read_b64_tr_b16 v[64:65],v120 offset:24576
buffer_load_dwordx4 v135,s[12:15],s25 offen offset:3072 lds
v_mfma_f32_16x16x32_bf16 a[56:59],v[32:35],v[100:103],0
v_mfma_f32_16x16x32_bf16 a[60:63],v[36:39],v[100:103],0
ds_read_b64_tr_b16 v[66:67],v120 offset:25600
v_mfma_f32_16x16x32_bf16 a[64:67],v[40:43],v[100:103],0
v_mfma_f32_16x16x32_bf16 a[68:71],v[44:47],v[100:103],0
ds_read_b64_tr_b16 v[68:69],v121 offset:24576
s_add_u32 s25,s25,s27
v_mfma_f32_16x16x32_bf16 a[72:75],v[48:51],v[100:103],0
s_add_u32 m0,s30,143360
v_mfma_f32_16x16x32_bf16 a[76:79],v[52:55],v[100:103],0
ds_read_b64_tr_b16 v[70:71],v121 offset:25600
buffer_load_dwordx4 v136,s[16:19],s26 offen lds
s_waitcnt lgkmcnt(9)
v_mfma_f32_16x16x32_bf16 a[80:83],v[16:19],v[104:107],0
v_mfma_f32_16x16x32_bf16 a[84:87],v[20:23],v[104:107],0
ds_read_b128 v[96:99],v112 offset:8192
v_mfma_f32_16x16x32_bf16 a[88:91],v[24:27],v[104:107],0
v_mfma_f32_16x16x32_bf16 a[92:95],v[28:31],v[104:107],0
ds_read_b64_tr_b16 v[72:73],v122 offset:24576
s_add_u32 s26,s26,s28
v_mfma_f32_16x16x32_bf16 a[96:99],v[32:35],v[104:107],0
s_add_u32 m0,s33,32768
v_mfma_f32_16x16x32_bf16 a[100:103],v[36:39],v[104:107],0
ds_read_b64_tr_b16 v[74:75],v122 offset:25600
buffer_load_dwordx4 v128,s[8:11],s24 offen lds
v_mfma_f32_16x16x32_bf16 a[104:107],v[40:43],v[104:107],0
v_mfma_f32_16x16x32_bf16 a[108:111],v[44:47],v[104:107],0
ds_read_b64_tr_b16 v[76:77],v123 offset:24576
v_mfma_f32_16x16x32_bf16 a[112:115],v[48:51],v[104:107],0
v_mfma_f32_16x16x32_bf16 a[116:119],v[52:55],v[104:107],0
ds_read_b64_tr_b16 v[78:79],v123 offset:25600
buffer_load_dwordx4 v129,s[8:11],s24 offen offset:1024 lds
s_waitcnt lgkmcnt(9)
v_mfma_f32_16x16x32_bf16 a[120:123],v[16:19],v[108:111],0
v_mfma_f32_16x16x32_bf16 a[124:127],v[20:23],v[108:111],0
ds_read_b128 v[100:103],v112 offset:10240
v_mfma_f32_16x16x32_bf16 a[128:131],v[24:27],v[108:111],0
v_min_u32 v168,7,v2
v_lshlrev_b32 v168,7,v168
v_mfma_f32_16x16x32_bf16 a[132:135],v[28:31],v[108:111],0
ds_read_b64_tr_b16 v[80:81],v120 offset:32768
buffer_load_dwordx4 v130,s[8:11],s24 offen offset:2048 lds
v_mfma_f32_16x16x32_bf16 a[136:139],v[32:35],v[108:111],0
v_mfma_f32_16x16x32_bf16 a[140:143],v[36:39],v[108:111],0
ds_read_b64_tr_b16 v[82:83],v120 offset:33792
v_mfma_f32_16x16x32_bf16 a[144:147],v[40:43],v[108:111],0
buffer_load_dword v139,v168,s[8:11],s63 offen
v_mfma_f32_16x16x32_bf16 a[148:151],v[44:47],v[108:111],0
ds_read_b64_tr_b16 v[84:85],v121 offset:32768
buffer_load_dwordx4 v131,s[8:11],s24 offen offset:3072 lds
v_mfma_f32_16x16x32_bf16 a[152:155],v[48:51],v[108:111],0
v_mfma_f32_16x16x32_bf16 a[156:159],v[52:55],v[108:111],0
ds_read_b64_tr_b16 v[86:87],v121 offset:33792
s_waitcnt lgkmcnt(9)
v_mfma_f32_16x16x32_bf16 a[160:163],v[16:19],v[96:99],0
v_mfma_f32_16x16x32_bf16 a[164:167],v[20:23],v[96:99],0
ds_read_b128 v[104:107],v112 offset:12288
s_add_u32 m0,s33,36864
v_mfma_f32_16x16x32_bf16 a[168:171],v[24:27],v[96:99],0
buffer_load_dwordx4 v128,s[8:11],s32 offen lds
v_mfma_f32_16x16x32_bf16 a[172:175],v[28:31],v[96:99],0
ds_read_b64_tr_b16 v[88:89],v122 offset:32768
v_mfma_f32_16x16x32_bf16 a[176:179],v[32:35],v[96:99],0
v_mfma_f32_16x16x32_bf16 a[180:183],v[36:39],v[96:99],0
ds_read_b64_tr_b16 v[90:91],v122 offset:33792
v_mfma_f32_16x16x32_bf16 a[184:187],v[40:43],v[96:99],0
buffer_load_dwordx4 v129,s[8:11],s32 offen offset:1024 lds
v_mfma_f32_16x16x32_bf16 a[188:191],v[44:47],v[96:99],0
ds_read_b64_tr_b16 v[92:93],v123 offset:32768
v_mfma_f32_16x16x32_bf16 a[192:195],v[48:51],v[96:99],0
v_mfma_f32_16x16x32_bf16 a[196:199],v[52:55],v[96:99],0
ds_read_b64_tr_b16 v[94:95],v123 offset:33792
s_waitcnt lgkmcnt(9)
v_mfma_f32_16x16x32_bf16 a[200:203],v[16:19],v[100:103],0
buffer_load_dwordx4 v130,s[8:11],s32 offen offset:2048 lds
v_mfma_f32_16x16x32_bf16 a[204:207],v[20:23],v[100:103],0
ds_read_b128 v[108:111],v112 offset:14336
v_mfma_f32_16x16x32_bf16 a[208:211],v[24:27],v[100:103],0
s_cmp_lg_u32 s34,0
s_cbranch_scc1 .Lce1
s_cbranch_vccnz .Lcs1
v_smfmac_f32_16x16x64_bf16 v[144:147],v[164:167],v[16:23],v143
v_smfmac_f32_16x16x64_bf16 v[148:151],v[164:167],v[24:31],v143
v_smfmac_f32_16x16x64_bf16 v[152:155],v[164:167],v[32:39],v143
s_branch .Lce1
.Lcs1:
v_smfmac_f32_16x16x64_bf16 v[156:159],v[164:167],v[40:47],v143
v_smfmac_f32_16x16x64_bf16 v[160:163],v[164:167],v[48:55],v143
.Lce1:
v_mfma_f32_16x16x32_bf16 a[212:215],v[28:31],v[100:103],0
v_mfma_f32_16x16x32_bf16 a[216:219],v[32:35],v[100:103],0
buffer_load_dwordx4 v131,s[8:11],s32 offen offset:3072 lds
v_mfma_f32_16x16x32_bf16 a[220:223],v[36:39],v[100:103],0
v_mfma_f32_16x16x32_bf16 a[224:227],v[40:43],v[100:103],0
v_mfma_f32_16x16x32_bf16 a[228:231],v[44:47],v[100:103],0
v_mfma_f32_16x16x32_bf16 a[232:235],v[48:51],v[100:103],0
s_add_u32 s24,s24,128
s_waitcnt vmcnt(14) lgkmcnt(0)
s_barrier
v_mfma_f32_16x16x32_bf16 a[236:239],v[52:55],v[100:103],0
s_add_u32 s32,s32,128
v_mfma_f32_16x16x32_bf16 a[240:243],v[16:19],v[104:107],0
s_add_u32 m0,s29,65536
v_mfma_f32_16x16x32_bf16 a[244:247],v[20:23],v[104:107],0
ds_read_b128 v[96:99],v113
buffer_load_dwordx4 v132,s[12:15],s25 offen lds
v_mfma_f32_16x16x32_bf16 a[248:251],v[24:27],v[104:107],0
v_mfma_f32_16x16x32_bf16 a[252:255],v[28:31],v[104:107],0
v_mfma_f32_16x16x32_bf16 v[192:195],v[32:35],v[104:107],0
v_mfma_f32_16x16x32_bf16 v[196:199],v[36:39],v[104:107],0
buffer_load_dwordx4 v133,s[12:15],s25 offen offset:1024 lds
v_mfma_f32_16x16x32_bf16 v[200:203],v[40:43],v[104:107],0
v_mfma_f32_16x16x32_bf16 v[204:207],v[44:47],v[104:107],0
v_mfma_f32_16x16x32_bf16 v[208:211],v[48:51],v[104:107],0
v_mfma_f32_16x16x32_bf16 v[212:215],v[52:55],v[104:107],0
buffer_load_dwordx4 v134,s[12:15],s25 offen offset:2048 lds
v_mfma_f32_16x16x32_bf16 v[216:219],v[16:19],v[108:111],0
v_mfma_f32_16x16x32_bf16 v[220:223],v[20:23],v[108:111],0
ds_read_b128 v[100:103],v113 offset:2048
v_mfma_f32_16x16x32_bf16 v[224:227],v[24:27],v[108:111],0
v_mfma_f32_16x16x32_bf16 v[228:231],v[28:31],v[108:111],0
buffer_load_dwordx4 v135,s[12:15],s25 offen offset:3072 lds
v_mfma_f32_16x16x32_bf16 v[232:235],v[32:35],v[108:111],0
v_mfma_f32_16x16x32_bf16 v[236:239],v[36:39],v[108:111],0
v_mfma_f32_16x16x32_bf16 v[240:243],v[40:43],v[108:111],0
v_mfma_f32_16x16x32_bf16 v[244:247],v[44:47],v[108:111],0
s_add_u32 s25,s25,s27
v_mfma_f32_16x16x32_bf16 v[248:251],v[48:51],v[108:111],0
s_add_u32 m0,s30,81920
v_mfma_f32_16x16x32_bf16 v[252:255],v[52:55],v[108:111],0
buffer_load_dwordx4 v136,s[16:19],s26 offen lds
s_add_u32 s26,s26,s28
s_waitcnt lgkmcnt(1)
v_mfma_f32_16x16x32_bf16 a[0:3],v[56:59],v[96:99],a[0:3]
s_getpc_b64 s[60:61]
.Lct1:
s_add_u32 s60,s60,L_trip1A-.Lct1
s_addc_u32 s61,s61,0
s_lshr_b32 s62,s2,3
v_mfma_f32_16x16x32_bf16 a[4:7],v[60:63],v[96:99],a[4:7]
ds_read_b128 v[104:107],v113 offset:4096
s_lshl_b32 s62,s62,2
v_mfma_f32_16x16x32_bf16 a[8:11],v[64:67],v[96:99],a[8:11]
s_add_u32 s62,s62,s31
s_and_b32 s62,s62,15
v_mfma_f32_16x16x32_bf16 a[12:15],v[68:71],v[96:99],a[12:15]
ds_read_b64_tr_b16 v[16:17],v116 offset:40960
s_lshl_b32 s62,s62,7
v_mfma_f32_16x16x32_bf16 a[16:19],v[72:75],v[96:99],a[16:19]
s_add_u32 m0,s29,86016
v_lshlrev_b32 v140,11,v2
v_mfma_f32_16x16x32_bf16 a[20:23],v[76:79],v[96:99],a[20:23]
ds_read_b64_tr_b16 v[18:19],v116 offset:41984
v_add_u32 v140,s62,v140
v_mfma_f32_16x16x32_bf16 a[24:27],v[80:83],v[96:99],a[24:27]
v_min_u32 v140,L_epiA-L_trip1A-4,v140
global_load_dword v139,v140,s[60:61]
v_mfma_f32_16x16x32_bf16 a[28:31],v[84:87],v[96:99],a[28:31]
ds_read_b64_tr_b16 v[20:21],v117 offset:40960
s_lshl_b32 s43,s35,3
v_mfma_f32_16x16x32_bf16 a[32:35],v[88:91],v[96:99],a[32:35]
buffer_load_dwordx4 v132,s[12:15],s25 offen lds
v_mfma_f32_16x16x32_bf16 a[36:39],v[92:95],v[96:99],a[36:39]
ds_read_b64_tr_b16 v[22:23],v117 offset:41984
s_waitcnt lgkmcnt(5)
v_mfma_f32_16x16x32_bf16 a[40:43],v[56:59],v[100:103],a[40:43]
s_add_u32 s43,s43,s34
s_lshl_b32 s43,s43,2
v_mfma_f32_16x16x32_bf16 a[44:47],v[60:63],v[100:103],a[44:47]
ds_read_b128 v[108:111],v113 offset:6144
s_lshl_b32 s49,s40,1
v_mfma_f32_16x16x32_bf16 a[48:51],v[64:67],v[100:103],a[48:51]
s_add_u32 s43,s43,s49
s_add_u32 s43,s43,s41
v_mfma_f32_16x16x32_bf16 a[52:55],v[68:71],v[100:103],a[52:55]
ds_read_b64_tr_b16 v[24:25],v120 offset:45056
s_lshl_b32 s43,s43,9
v_mfma_f32_16x16x32_bf16 a[56:59],v[72:75],v[100:103],a[56:59]
s_add_u32 s43,s43,0x2720000
v_mfma_f32_16x16x32_bf16 a[60:63],v[76:79],v[100:103],a[60:63]
ds_read_b64_tr_b16 v[26:27],v120 offset:46080
v_mfma_f32_16x16x32_bf16 a[64:67],v[80:83],v[100:103],a[64:67]
v_mfma_f32_16x16x32_bf16 a[68:71],v[84:87],v[100:103],a[68:71]
ds_read_b64_tr_b16 v[28:29],v121 offset:45056
v_mfma_f32_16x16x32_bf16 a[72:75],v[88:91],v[100:103],a[72:75]
buffer_load_dwordx4 v133,s[12:15],s25 offen offset:1024 lds
v_mfma_f32_16x16x32_bf16 a[76:79],v[92:95],v[100:103],a[76:79]
ds_read_b64_tr_b16 v[30:31],v121 offset:46080
s_waitcnt lgkmcnt(9)
v_mfma_f32_16x16x32_bf16 a[80:83],v[56:59],v[104:107],a[80:83]
v_mfma_f32_16x16x32_bf16 a[84:87],v[60:63],v[104:107],a[84:87]
ds_read_b128 v[96:99],v113 offset:8192
v_mfma_f32_16x16x32_bf16 a[88:91],v[64:67],v[104:107],a[88:91]
v_mfma_f32_16x16x32_bf16 a[92:95],v[68:71],v[104:107],a[92:95]
ds_read_b64_tr_b16 v[32:33],v122 offset:45056
v_mfma_f32_16x16x32_bf16 a[96:99],v[72:75],v[104:107],a[96:99]
v_mfma_f32_16x16x32_bf16 a[100:103],v[76:79],v[104:107],a[100:103]
ds_read_b64_tr_b16 v[34:35],v122 offset:46080
v_mfma_f32_16x16x32_bf16 a[104:107],v[80:83],v[104:107],a[104:107]
v_mfma_f32_16x16x32_bf16 a[108:111],v[84:87],v[104:107],a[108:111]
ds_read_b64_tr_b16 v[36:37],v123 offset:45056
v_mfma_f32_16x16x32_bf16 a[112:115],v[88:91],v[104:107],a[112:115]
buffer_load_dwordx4 v134,s[12:15],s25 offen offset:2048 lds
v_mfma_f32_16x16x32_bf16 a[116:119],v[92:95],v[104:107],a[116:119]
ds_read_b64_tr_b16 v[38:39],v123 offset:46080
s_waitcnt lgkmcnt(9)
v_mfma_f32_16x16x32_bf16 a[120:123],v[56:59],v[108:111],a[120:123]
v_mfma_f32_16x16x32_bf16 a[124:127],v[60:63],v[108:111],a[124:127]
ds_read_b128 v[100:103],v113 offset:10240
v_mfma_f32_16x16x32_bf16 a[128:131],v[64:67],v[108:111],a[128:131]
v_min_u32 v168,7,v2
v_lshlrev_b32 v168,7,v168
v_mfma_f32_16x16x32_bf16 a[132:135],v[68:71],v[108:111],a[132:135]
ds_read_b64_tr_b16 v[40:41],v120 offset:53248
v_mfma_f32_16x16x32_bf16 a[136:139],v[72:75],v[108:111],a[136:139]
v_mfma_f32_16x16x32_bf16 a[140:143],v[76:79],v[108:111],a[140:143]
ds_read_b64_tr_b16 v[42:43],v120 offset:54272
v_mfma_f32_16x16x32_bf16 a[144:147],v[80:83],v[108:111],a[144:147]
buffer_load_dword v139,v168,s[8:11],s63 offen offset:1024
v_mfma_f32_16x16x32_bf16 a[148:151],v[84:87],v[108:111],a[148:151]
ds_read_b64_tr_b16 v[44:45],v121 offset:53248
v_mfma_f32_16x16x32_bf16 a[152:155],v[88:91],v[108:111],a[152:155]
buffer_load_dwordx4 v135,s[12:15],s25 offen offset:3072 lds
v_mfma_f32_16x16x32_bf16 a[156:159],v[92:95],v[108:111],a[156:159]
ds_read_b64_tr_b16 v[46:47],v121 offset:54272
s_waitcnt lgkmcnt(9)
v_mfma_f32_16x16x32_bf16 a[160:163],v[56:59],v[96:99],a[160:163]
s_add_u32 s25,s25,s27
v_mfma_f32_16x16x32_bf16 a[164:167],v[60:63],v[96:99],a[164:167]
ds_read_b128 v[104:107],v113 offset:12288
v_mfma_f32_16x16x32_bf16 a[168:171],v[64:67],v[96:99],a[168:171]
v_mfma_f32_16x16x32_bf16 a[172:175],v[68:71],v[96:99],a[172:175]
ds_read_b64_tr_b16 v[48:49],v122 offset:53248
v_mfma_f32_16x16x32_bf16 a[176:179],v[72:75],v[96:99],a[176:179]
s_add_u32 m0,s30,102400
v_mfma_f32_16x16x32_bf16 a[180:183],v[76:79],v[96:99],a[180:183]
ds_read_b64_tr_b16 v[50:51],v122 offset:54272
v_mfma_f32_16x16x32_bf16 a[184:187],v[80:83],v[96:99],a[184:187]
v_mfma_f32_16x16x32_bf16 a[188:191],v[84:87],v[96:99],a[188:191]
ds_read_b64_tr_b16 v[52:53],v123 offset:53248
v_mfma_f32_16x16x32_bf16 a[192:195],v[88:91],v[96:99],a[192:195]
buffer_load_dwordx4 v136,s[16:19],s26 offen lds
v_mfma_f32_16x16x32_bf16 a[196:199],v[92:95],v[96:99],a[196:199]
ds_read_b64_tr_b16 v[54:55],v123 offset:54272
s_waitcnt lgkmcnt(9)
v_mfma_f32_16x16x32_bf16 a[200:203],v[56:59],v[100:103],a[200:203]
s_add_u32 s26,s26,s28
v_mfma_f32_16x16x32_bf16 a[204:207],v[60:63],v[100:103],a[204:207]
ds_read_b128 v[108:111],v113 offset:14336
v_mfma_f32_16x16x32_bf16 a[208:211],v[64:67],v[100:103],a[208:211]
s_cmp_lg_u32 s34,0
s_cbranch_scc1 .Lce2
s_cbranch_vccnz .Lcs2
v_smfmac_f32_16x16x64_bf16 v[144:147],v[164:167],v[56:63],v143
v_smfmac_f32_16x16x64_bf16 v[148:151],v[164:167],v[64:71],v143
v_smfmac_f32_16x16x64_bf16 v[152:155],v[164:167],v[72:79],v143
s_branch .Lce2
.Lcs2:
v_smfmac_f32_16x16x64_bf16 v[156:159],v[164:167],v[80:87],v143
v_smfmac_f32_16x16x64_bf16 v[160:163],v[164:167],v[88:95],v143
.Lce2:
v_mfma_f32_16x16x32_bf16 a[212:215],v[68:71],v[100:103],a[212:215]
v_mfma_f32_16x16x32_bf16 a[216:219],v[72:75],v[100:103],a[216:219]
v_mfma_f32_16x16x32_bf16 a[220:223],v[76:79],v[100:103],a[220:223]
v_mfma_f32_16x16x32_bf16 a[224:227],v[80:83],v[100:103],a[224:227]
v_mfma_f32_16x16x32_bf16 a[228:231],v[84:87],v[100:103],a[228:231]
v_mfma_f32_16x16x32_bf16 a[232:235],v[88:91],v[100:103],a[232:235]
s_waitcnt vmcnt(12) lgkmcnt(0)
s_barrier
v_mfma_f32_16x16x32_bf16 a[236:239],v[92:95],v[100:103],a[236:239]
s_add_u32 m0,s33,0
v_mfma_f32_16x16x32_bf16 a[240:243],v[56:59],v[104:107],a[240:243]
buffer_load_dwordx4 v128,s[8:11],s24 offen lds
v_mfma_f32_16x16x32_bf16 a[244:247],v[60:63],v[104:107],a[244:247]
ds_read_b128 v[96:99],v114
v_mfma_f32_16x16x32_bf16 a[248:251],v[64:67],v[104:107],a[248:251]
v_mfma_f32_16x16x32_bf16 a[252:255],v[68:71],v[104:107],a[252:255]
v_mfma_f32_16x16x32_bf16 v[192:195],v[72:75],v[104:107],v[192:195]
v_mfma_f32_16x16x32_bf16 v[196:199],v[76:79],v[104:107],v[196:199]
v_mfma_f32_16x16x32_bf16 v[200:203],v[80:83],v[104:107],v[200:203]
v_mfma_f32_16x16x32_bf16 v[204:207],v[84:87],v[104:107],v[204:207]
v_mfma_f32_16x16x32_bf16 v[208:211],v[88:91],v[104:107],v[208:211]
buffer_load_dwordx4 v129,s[8:11],s24 offen offset:1024 lds
v_mfma_f32_16x16x32_bf16 v[212:215],v[92:95],v[104:107],v[212:215]
v_mfma_f32_16x16x32_bf16 v[216:219],v[56:59],v[108:111],v[216:219]
v_mfma_f32_16x16x32_bf16 v[220:223],v[60:63],v[108:111],v[220:223]
ds_read_b128 v[100:103],v114 offset:2048
v_mfma_f32_16x16x32_bf16 v[224:227],v[64:67],v[108:111],v[224:227]
v_mfma_f32_16x16x32_bf16 v[228:231],v[68:71],v[108:111],v[228:231]
v_mfma_f32_16x16x32_bf16 v[232:235],v[72:75],v[108:111],v[232:235]
v_mfma_f32_16x16x32_bf16 v[236:239],v[76:79],v[108:111],v[236:239]
v_mfma_f32_16x16x32_bf16 v[240:243],v[80:83],v[108:111],v[240:243]
buffer_load_dwordx4 v130,s[8:11],s24 offen offset:2048 lds
v_mfma_f32_16x16x32_bf16 v[244:247],v[84:87],v[108:111],v[244:247]
v_mfma_f32_16x16x32_bf16 v[248:251],v[88:91],v[108:111],v[248:251]
v_mfma_f32_16x16x32_bf16 v[252:255],v[92:95],v[108:111],v[252:255]
s_waitcnt lgkmcnt(1)
v_mfma_f32_16x16x32_bf16 a[0:3],v[16:19],v[96:99],a[0:3]
v_mfma_f32_16x16x32_bf16 a[4:7],v[20:23],v[96:99],a[4:7]
ds_read_b128 v[104:107],v114 offset:4096
v_mfma_f32_16x16x32_bf16 a[8:11],v[24:27],v[96:99],a[8:11]
v_mfma_f32_16x16x32_bf16 a[12:15],v[28:31],v[96:99],a[12:15]
ds_read_b64_tr_b16 v[56:57],v118
v_mfma_f32_16x16x32_bf16 a[16:19],v[32:35],v[96:99],a[16:19]
buffer_load_dwordx4 v131,s[8:11],s24 offen offset:3072 lds
v_mfma_f32_16x16x32_bf16 a[20:23],v[36:39],v[96:99],a[20:23]
ds_read_b64_tr_b16 v[58:59],v118 offset:1024
v_mfma_f32_16x16x32_bf16 a[24:27],v[40:43],v[96:99],a[24:27]
v_mfma_f32_16x16x32_bf16 a[28:31],v[44:47],v[96:99],a[28:31]
ds_read_b64_tr_b16 v[60:61],v119
v_mfma_f32_16x16x32_bf16 a[32:35],v[48:51],v[96:99],a[32:35]
s_add_u32 m0,s33,4096
v_mfma_f32_16x16x32_bf16 a[36:39],v[52:55],v[96:99],a[36:39]
ds_read_b64_tr_b16 v[62:63],v119 offset:1024
s_waitcnt lgkmcnt(5)
v_mfma_f32_16x16x32_bf16 a[40:43],v[16:19],v[100:103],a[40:43]
v_mfma_f32_16x16x32_bf16 a[44:47],v[20:23],v[100:103],a[44:47]
ds_read_b128 v[108:111],v114 offset:6144
v_mfma_f32_16x16x32_bf16 a[48:51],v[24:27],v[100:103],a[48:51]
v_mfma_f32_16x16x32_bf16 a[52:55],v[28:31],v[100:103],a[52:55]
ds_read_b64_tr_b16 v[64:65],v124 offset:4096
v_mfma_f32_16x16x32_bf16 a[56:59],v[32:35],v[100:103],a[56:59]
buffer_load_dwordx4 v128,s[8:11],s32 offen lds
v_mfma_f32_16x16x32_bf16 a[60:63],v[36:39],v[100:103],a[60:63]
ds_read_b64_tr_b16 v[66:67],v124 offset:5120
v_mfma_f32_16x16x32_bf16 a[64:67],v[40:43],v[100:103],a[64:67]
v_mfma_f32_16x16x32_bf16 a[68:71],v[44:47],v[100:103],a[68:71]
ds_read_b64_tr_b16 v[68:69],v125 offset:4096
v_mfma_f32_16x16x32_bf16 a[72:75],v[48:51],v[100:103],a[72:75]
v_mfma_f32_16x16x32_bf16 a[76:79],v[52:55],v[100:103],a[76:79]
ds_read_b64_tr_b16 v[70:71],v125 offset:5120
s_waitcnt lgkmcnt(9)
v_mfma_f32_16x16x32_bf16 a[80:83],v[16:19],v[104:107],a[80:83]
buffer_load_dwordx4 v129,s[8:11],s32 offen offset:1024 lds
v_mfma_f32_16x16x32_bf16 a[84:87],v[20:23],v[104:107],a[84:87]
ds_read_b128 v[96:99],v114 offset:8192
v_mfma_f32_16x16x32_bf16 a[88:91],v[24:27],v[104:107],a[88:91]
v_mfma_f32_16x16x32_bf16 a[92:95],v[28:31],v[104:107],a[92:95]
ds_read_b64_tr_b16 v[72:73],v126 offset:4096
v_mfma_f32_16x16x32_bf16 a[96:99],v[32:35],v[104:107],a[96:99]
v_mfma_f32_16x16x32_bf16 a[100:103],v[36:39],v[104:107],a[100:103]
ds_read_b64_tr_b16 v[74:75],v126 offset:5120
v_mfma_f32_16x16x32_bf16 a[104:107],v[40:43],v[104:107],a[104:107]
v_mfma_f32_16x16x32_bf16 a[108:111],v[44:47],v[104:107],a[108:111]
ds_read_b64_tr_b16 v[76:77],v127 offset:4096
v_mfma_f32_16x16x32_bf16 a[112:115],v[48:51],v[104:107],a[112:115]
buffer_load_dwordx4 v130,s[8:11],s32 offen offset:2048 lds
v_mfma_f32_16x16x32_bf16 a[116:119],v[52:55],v[104:107],a[116:119]
ds_read_b64_tr_b16 v[78:79],v127 offset:5120
s_waitcnt lgkmcnt(9)
v_mfma_f32_16x16x32_bf16 a[120:123],v[16:19],v[108:111],a[120:123]
v_mfma_f32_16x16x32_bf16 a[124:127],v[20:23],v[108:111],a[124:127]
ds_read_b128 v[100:103],v114 offset:10240
v_mfma_f32_16x16x32_bf16 a[128:131],v[24:27],v[108:111],a[128:131]
v_min_u32 v168,7,v2
v_lshlrev_b32 v168,7,v168
v_mfma_f32_16x16x32_bf16 a[132:135],v[28:31],v[108:111],a[132:135]
ds_read_b64_tr_b16 v[80:81],v124 offset:12288
v_mfma_f32_16x16x32_bf16 a[136:139],v[32:35],v[108:111],a[136:139]
buffer_load_dwordx4 v131,s[8:11],s32 offen offset:3072 lds
v_mfma_f32_16x16x32_bf16 a[140:143],v[36:39],v[108:111],a[140:143]
ds_read_b64_tr_b16 v[82:83],v124 offset:13312
v_mfma_f32_16x16x32_bf16 a[144:147],v[40:43],v[108:111],a[144:147]
buffer_load_dword v139,v168,s[8:11],s63 offen offset:2048
v_mfma_f32_16x16x32_bf16 a[148:151],v[44:47],v[108:111],a[148:151]
ds_read_b64_tr_b16 v[84:85],v125 offset:12288
v_mfma_f32_16x16x32_bf16 a[152:155],v[48:51],v[108:111],a[152:155]
s_add_u32 s24,s24,128
v_mfma_f32_16x16x32_bf16 a[156:159],v[52:55],v[108:111],a[156:159]
ds_read_b64_tr_b16 v[86:87],v125 offset:13312
s_waitcnt lgkmcnt(9)
v_mfma_f32_16x16x32_bf16 a[160:163],v[16:19],v[96:99],a[160:163]
s_add_u32 s32,s32,128
v_mfma_f32_16x16x32_bf16 a[164:167],v[20:23],v[96:99],a[164:167]
ds_read_b128 v[104:107],v114 offset:12288
v_mfma_f32_16x16x32_bf16 a[168:171],v[24:27],v[96:99],a[168:171]
s_add_u32 m0,s29,106496
v_mfma_f32_16x16x32_bf16 a[172:175],v[28:31],v[96:99],a[172:175]
ds_read_b64_tr_b16 v[88:89],v126 offset:12288
v_mfma_f32_16x16x32_bf16 a[176:179],v[32:35],v[96:99],a[176:179]
buffer_load_dwordx4 v132,s[12:15],s25 offen lds
v_mfma_f32_16x16x32_bf16 a[180:183],v[36:39],v[96:99],a[180:183]
ds_read_b64_tr_b16 v[90:91],v126 offset:13312
v_mfma_f32_16x16x32_bf16 a[184:187],v[40:43],v[96:99],a[184:187]
v_mfma_f32_16x16x32_bf16 a[188:191],v[44:47],v[96:99],a[188:191]
ds_read_b64_tr_b16 v[92:93],v127 offset:12288
v_mfma_f32_16x16x32_bf16 a[192:195],v[48:51],v[96:99],a[192:195]
v_mfma_f32_16x16x32_bf16 a[196:199],v[52:55],v[96:99],a[196:199]
ds_read_b64_tr_b16 v[94:95],v127 offset:13312
s_waitcnt lgkmcnt(9)
v_mfma_f32_16x16x32_bf16 a[200:203],v[16:19],v[100:103],a[200:203]
buffer_load_dwordx4 v133,s[12:15],s25 offen offset:1024 lds
v_mfma_f32_16x16x32_bf16 a[204:207],v[20:23],v[100:103],a[204:207]
ds_read_b128 v[108:111],v114 offset:14336
v_mfma_f32_16x16x32_bf16 a[208:211],v[24:27],v[100:103],a[208:211]
s_cmp_lg_u32 s34,0
s_cbranch_scc1 .Lce3
s_cbranch_vccnz .Lcs3
v_smfmac_f32_16x16x64_bf16 v[144:147],v[164:167],v[16:23],v143
v_smfmac_f32_16x16x64_bf16 v[148:151],v[164:167],v[24:31],v143
v_smfmac_f32_16x16x64_bf16 v[152:155],v[164:167],v[32:39],v143
s_branch .Lce3
.Lcs3:
v_smfmac_f32_16x16x64_bf16 v[156:159],v[164:167],v[40:47],v143
v_smfmac_f32_16x16x64_bf16 v[160:163],v[164:167],v[48:55],v143
.Lce3:
v_mfma_f32_16x16x32_bf16 a[212:215],v[28:31],v[100:103],a[212:215]
v_mfma_f32_16x16x32_bf16 a[216:219],v[32:35],v[100:103],a[216:219]
v_mfma_f32_16x16x32_bf16 a[220:223],v[36:39],v[100:103],a[220:223]
v_mfma_f32_16x16x32_bf16 a[224:227],v[40:43],v[100:103],a[224:227]
buffer_load_dwordx4 v134,s[12:15],s25 offen offset:2048 lds
v_mfma_f32_16x16x32_bf16 a[228:231],v[44:47],v[100:103],a[228:231]
v_mfma_f32_16x16x32_bf16 a[232:235],v[48:51],v[100:103],a[232:235]
s_waitcnt vmcnt(19) lgkmcnt(0)
s_barrier
v_mfma_f32_16x16x32_bf16 a[236:239],v[52:55],v[100:103],a[236:239]
v_mfma_f32_16x16x32_bf16 a[240:243],v[16:19],v[104:107],a[240:243]
v_mfma_f32_16x16x32_bf16 a[244:247],v[20:23],v[104:107],a[244:247]
ds_read_b128 v[96:99],v115
v_mfma_f32_16x16x32_bf16 a[248:251],v[24:27],v[104:107],a[248:251]
v_mfma_f32_16x16x32_bf16 a[252:255],v[28:31],v[104:107],a[252:255]
v_mfma_f32_16x16x32_bf16 v[192:195],v[32:35],v[104:107],v[192:195]
buffer_load_dwordx4 v135,s[12:15],s25 offen offset:3072 lds
v_mfma_f32_16x16x32_bf16 v[196:199],v[36:39],v[104:107],v[196:199]
v_mfma_f32_16x16x32_bf16 v[200:203],v[40:43],v[104:107],v[200:203]
s_add_u32 s25,s25,s27
v_mfma_f32_16x16x32_bf16 v[204:207],v[44:47],v[104:107],v[204:207]
v_mfma_f32_16x16x32_bf16 v[208:211],v[48:51],v[104:107],v[208:211]
s_add_u32 m0,s30,122880
v_mfma_f32_16x16x32_bf16 v[212:215],v[52:55],v[104:107],v[212:215]
v_mfma_f32_16x16x32_bf16 v[216:219],v[16:19],v[108:111],v[216:219]
v_mfma_f32_16x16x32_bf16 v[220:223],v[20:23],v[108:111],v[220:223]
ds_read_b128 v[100:103],v115 offset:2048
v_mfma_f32_16x16x32_bf16 v[224:227],v[24:27],v[108:111],v[224:227]
v_mfma_f32_16x16x32_bf16 v[228:231],v[28:31],v[108:111],v[228:231]
v_mfma_f32_16x16x32_bf16 v[232:235],v[32:35],v[108:111],v[232:235]
buffer_load_dwordx4 v136,s[16:19],s26 offen lds
v_mfma_f32_16x16x32_bf16 v[236:239],v[36:39],v[108:111],v[236:239]
v_mfma_f32_16x16x32_bf16 v[240:243],v[40:43],v[108:111],v[240:243]
v_mfma_f32_16x16x32_bf16 v[244:247],v[44:47],v[108:111],v[244:247]
v_mfma_f32_16x16x32_bf16 v[248:251],v[48:51],v[108:111],v[248:251]
s_add_u32 s26,s26,s28
v_mfma_f32_16x16x32_bf16 v[252:255],v[52:55],v[108:111],v[252:255]
s_waitcnt lgkmcnt(1)
v_mfma_f32_16x16x32_bf16 a[0:3],v[56:59],v[96:99],a[0:3]
v_mfma_f32_16x16x32_bf16 a[4:7],v[60:63],v[96:99],a[4:7]
ds_read_b128 v[104:107],v115 offset:4096
v_mfma_f32_16x16x32_bf16 a[8:11],v[64:67],v[96:99],a[8:11]
v_mfma_f32_16x16x32_bf16 a[12:15],v[68:71],v[96:99],a[12:15]
ds_read_b64_tr_b16 v[16:17],v116
v_mfma_f32_16x16x32_bf16 a[16:19],v[72:75],v[96:99],a[16:19]
s_add_u32 m0,s29,126976
v_mfma_f32_16x16x32_bf16 a[20:23],v[76:79],v[96:99],a[20:23]
ds_read_b64_tr_b16 v[18:19],v116 offset:1024
v_mfma_f32_16x16x32_bf16 a[24:27],v[80:83],v[96:99],a[24:27]
v_mfma_f32_16x16x32_bf16 a[28:31],v[84:87],v[96:99],a[28:31]
ds_read_b64_tr_b16 v[20:21],v117
v_mfma_f32_16x16x32_bf16 a[32:35],v[88:91],v[96:99],a[32:35]
buffer_load_dwordx4 v132,s[12:15],s25 offen lds
v_mfma_f32_16x16x32_bf16 a[36:39],v[92:95],v[96:99],a[36:39]
ds_read_b64_tr_b16 v[22:23],v117 offset:1024
s_waitcnt lgkmcnt(5)
v_mfma_f32_16x16x32_bf16 a[40:43],v[56:59],v[100:103],a[40:43]
v_mfma_f32_16x16x32_bf16 a[44:47],v[60:63],v[100:103],a[44:47]
ds_read_b128 v[108:111],v115 offset:6144
v_mfma_f32_16x16x32_bf16 a[48:51],v[64:67],v[100:103],a[48:51]
v_mfma_f32_16x16x32_bf16 a[52:55],v[68:71],v[100:103],a[52:55]
ds_read_b64_tr_b16 v[24:25],v120 offset:4096
v_mfma_f32_16x16x32_bf16 a[56:59],v[72:75],v[100:103],a[56:59]
v_mfma_f32_16x16x32_bf16 a[60:63],v[76:79],v[100:103],a[60:63]
ds_read_b64_tr_b16 v[26:27],v120 offset:5120
v_mfma_f32_16x16x32_bf16 a[64:67],v[80:83],v[100:103],a[64:67]
v_mfma_f32_16x16x32_bf16 a[68:71],v[84:87],v[100:103],a[68:71]
ds_read_b64_tr_b16 v[28:29],v121 offset:4096
v_mfma_f32_16x16x32_bf16 a[72:75],v[88:91],v[100:103],a[72:75]
buffer_load_dwordx4 v133,s[12:15],s25 offen offset:1024 lds
v_mfma_f32_16x16x32_bf16 a[76:79],v[92:95],v[100:103],a[76:79]
ds_read_b64_tr_b16 v[30:31],v121 offset:5120
s_waitcnt lgkmcnt(9)
v_mfma_f32_16x16x32_bf16 a[80:83],v[56:59],v[104:107],a[80:83]
v_mfma_f32_16x16x32_bf16 a[84:87],v[60:63],v[104:107],a[84:87]
ds_read_b128 v[96:99],v115 offset:8192
v_mfma_f32_16x16x32_bf16 a[88:91],v[64:67],v[104:107],a[88:91]
v_mfma_f32_16x16x32_bf16 a[92:95],v[68:71],v[104:107],a[92:95]
ds_read_b64_tr_b16 v[32:33],v122 offset:4096
v_mfma_f32_16x16x32_bf16 a[96:99],v[72:75],v[104:107],a[96:99]
v_mfma_f32_16x16x32_bf16 a[100:103],v[76:79],v[104:107],a[100:103]
ds_read_b64_tr_b16 v[34:35],v122 offset:5120
v_mfma_f32_16x16x32_bf16 a[104:107],v[80:83],v[104:107],a[104:107]
v_mfma_f32_16x16x32_bf16 a[108:111],v[84:87],v[104:107],a[108:111]
ds_read_b64_tr_b16 v[36:37],v123 offset:4096
v_mfma_f32_16x16x32_bf16 a[112:115],v[88:91],v[104:107],a[112:115]
buffer_load_dwordx4 v134,s[12:15],s25 offen offset:2048 lds
v_mfma_f32_16x16x32_bf16 a[116:119],v[92:95],v[104:107],a[116:119]
ds_read_b64_tr_b16 v[38:39],v123 offset:5120
s_waitcnt lgkmcnt(9)
v_mfma_f32_16x16x32_bf16 a[120:123],v[56:59],v[108:111],a[120:123]
v_mfma_f32_16x16x32_bf16 a[124:127],v[60:63],v[108:111],a[124:127]
ds_read_b128 v[100:103],v115 offset:10240
v_mfma_f32_16x16x32_bf16 a[128:131],v[64:67],v[108:111],a[128:131]
v_min_u32 v168,7,v2
v_lshlrev_b32 v168,7,v168
v_mfma_f32_16x16x32_bf16 a[132:135],v[68:71],v[108:111],a[132:135]
ds_read_b64_tr_b16 v[40:41],v120 offset:12288
v_mfma_f32_16x16x32_bf16 a[136:139],v[72:75],v[108:111],a[136:139]
v_mfma_f32_16x16x32_bf16 a[140:143],v[76:79],v[108:111],a[140:143]
ds_read_b64_tr_b16 v[42:43],v120 offset:13312
v_mfma_f32_16x16x32_bf16 a[144:147],v[80:83],v[108:111],a[144:147]
buffer_load_dword v139,v168,s[8:11],s63 offen offset:3072
v_mfma_f32_16x16x32_bf16 a[148:151],v[84:87],v[108:111],a[148:151]
ds_read_b64_tr_b16 v[44:45],v121 offset:12288
v_mfma_f32_16x16x32_bf16 a[152:155],v[88:91],v[108:111],a[152:155]
buffer_load_dwordx4 v135,s[12:15],s25 offen offset:3072 lds
v_mfma_f32_16x16x32_bf16 a[156:159],v[92:95],v[108:111],a[156:159]
ds_read_b64_tr_b16 v[46:47],v121 offset:13312
s_waitcnt lgkmcnt(9)
v_mfma_f32_16x16x32_bf16 a[160:163],v[56:59],v[96:99],a[160:163]
s_add_u32 s25,s25,s27
v_mfma_f32_16x16x32_bf16 a[164:167],v[60:63],v[96:99],a[164:167]
ds_read_b128 v[104:107],v115 offset:12288
v_mfma_f32_16x16x32_bf16 a[168:171],v[64:67],v[96:99],a[168:171]
v_mfma_f32_16x16x32_bf16 a[172:175],v[68:71],v[96:99],a[172:175]
ds_read_b64_tr_b16 v[48:49],v122 offset:12288
v_mfma_f32_16x16x32_bf16 a[176:179],v[72:75],v[96:99],a[176:179]
s_add_u32 m0,s30,143360
v_mfma_f32_16x16x32_bf16 a[180:183],v[76:79],v[96:99],a[180:183]
ds_read_b64_tr_b16 v[50:51],v122 offset:13312
v_mfma_f32_16x16x32_bf16 a[184:187],v[80:83],v[96:99],a[184:187]
v_mfma_f32_16x16x32_bf16 a[188:191],v[84:87],v[96:99],a[188:191]
ds_read_b64_tr_b16 v[52:53],v123 offset:12288
v_mfma_f32_16x16x32_bf16 a[192:195],v[88:91],v[96:99],a[192:195]
buffer_load_dwordx4 v136,s[16:19],s26 offen lds
v_mfma_f32_16x16x32_bf16 a[196:199],v[92:95],v[96:99],a[196:199]
ds_read_b64_tr_b16 v[54:55],v123 offset:13312
s_waitcnt lgkmcnt(9)
v_mfma_f32_16x16x32_bf16 a[200:203],v[56:59],v[100:103],a[200:203]
s_add_u32 s26,s26,s28
v_mfma_f32_16x16x32_bf16 a[204:207],v[60:63],v[100:103],a[204:207]
ds_read_b128 v[108:111],v115 offset:14336
v_mfma_f32_16x16x32_bf16 a[208:211],v[64:67],v[100:103],a[208:211]
s_cmp_lg_u32 s34,0
s_cbranch_scc1 .Lce4
s_cbranch_vccnz .Lcs4
v_smfmac_f32_16x16x64_bf16 v[144:147],v[164:167],v[56:63],v143
v_smfmac_f32_16x16x64_bf16 v[148:151],v[164:167],v[64:71],v143
v_smfmac_f32_16x16x64_bf16 v[152:155],v[164:167],v[72:79],v143
s_branch .Lce4
.Lcs4:
v_smfmac_f32_16x16x64_bf16 v[156:159],v[164:167],v[80:87],v143
v_smfmac_f32_16x16x64_bf16 v[160:163],v[164:167],v[88:95],v143
.Lce4:
v_mfma_f32_16x16x32_bf16 a[212:215],v[68:71],v[100:103],a[212:215]
v_mfma_f32_16x16x32_bf16 a[216:219],v[72:75],v[100:103],a[216:219]
v_mfma_f32_16x16x32_bf16 a[220:223],v[76:79],v[100:103],a[220:223]
v_mfma_f32_16x16x32_bf16 a[224:227],v[80:83],v[100:103],a[224:227]
v_mfma_f32_16x16x32_bf16 a[228:231],v[84:87],v[100:103],a[228:231]
v_mfma_f32_16x16x32_bf16 a[232:235],v[88:91],v[100:103],a[232:235]
s_waitcnt vmcnt(12) lgkmcnt(0)
s_barrier
v_mfma_f32_16x16x32_bf16 a[236:239],v[92:95],v[100:103],a[236:239]
s_add_u32 m0,s33,32768
v_mfma_f32_16x16x32_bf16 a[240:243],v[56:59],v[104:107],a[240:243]
buffer_load_dwordx4 v128,s[8:11],s24 offen lds
v_mfma_f32_16x16x32_bf16 a[244:247],v[60:63],v[104:107],a[244:247]
ds_read_b128 v[96:99],v112
v_mfma_f32_16x16x32_bf16 a[248:251],v[64:67],v[104:107],a[248:251]
v_mfma_f32_16x16x32_bf16 a[252:255],v[68:71],v[104:107],a[252:255]
v_mfma_f32_16x16x32_bf16 v[192:195],v[72:75],v[104:107],v[192:195]
v_mfma_f32_16x16x32_bf16 v[196:199],v[76:79],v[104:107],v[196:199]
v_mfma_f32_16x16x32_bf16 v[200:203],v[80:83],v[104:107],v[200:203]
v_mfma_f32_16x16x32_bf16 v[204:207],v[84:87],v[104:107],v[204:207]
v_mfma_f32_16x16x32_bf16 v[208:211],v[88:91],v[104:107],v[208:211]
buffer_load_dwordx4 v129,s[8:11],s24 offen offset:1024 lds
v_mfma_f32_16x16x32_bf16 v[212:215],v[92:95],v[104:107],v[212:215]
v_mfma_f32_16x16x32_bf16 v[216:219],v[56:59],v[108:111],v[216:219]
v_mfma_f32_16x16x32_bf16 v[220:223],v[60:63],v[108:111],v[220:223]
ds_read_b128 v[100:103],v112 offset:2048
v_mfma_f32_16x16x32_bf16 v[224:227],v[64:67],v[108:111],v[224:227]
v_mfma_f32_16x16x32_bf16 v[228:231],v[68:71],v[108:111],v[228:231]
v_mfma_f32_16x16x32_bf16 v[232:235],v[72:75],v[108:111],v[232:235]
v_mfma_f32_16x16x32_bf16 v[236:239],v[76:79],v[108:111],v[236:239]
v_mfma_f32_16x16x32_bf16 v[240:243],v[80:83],v[108:111],v[240:243]
buffer_load_dwordx4 v130,s[8:11],s24 offen offset:2048 lds
v_mfma_f32_16x16x32_bf16 v[244:247],v[84:87],v[108:111],v[244:247]
v_mfma_f32_16x16x32_bf16 v[248:251],v[88:91],v[108:111],v[248:251]
v_mfma_f32_16x16x32_bf16 v[252:255],v[92:95],v[108:111],v[252:255]
L_trip1A:
s_mov_b32 s50,1
s_waitcnt lgkmcnt(1)
v_mfma_f32_16x16x32_bf16 a[0:3],v[16:19],v[96:99],a[0:3]
v_mfma_f32_16x16x32_bf16 a[4:7],v[20:23],v[96:99],a[4:7]
ds_read_b128 v[104:107],v112 offset:4096
v_mfma_f32_16x16x32_bf16 a[8:11],v[24:27],v[96:99],a[8:11]
v_mfma_f32_16x16x32_bf16 a[12:15],v[28:31],v[96:99],a[12:15]
ds_read_b64_tr_b16 v[56:57],v116 offset:20480
v_mfma_f32_16x16x32_bf16 a[16:19],v[32:35],v[96:99],a[16:19]
buffer_load_dwordx4 v131,s[8:11],s24 offen offset:3072 lds
v_mfma_f32_16x16x32_bf16 a[20:23],v[36:39],v[96:99],a[20:23]
ds_read_b64_tr_b16 v[58:59],v116 offset:21504
v_mfma_f32_16x16x32_bf16 a[24:27],v[40:43],v[96:99],a[24:27]
v_mfma_f32_16x16x32_bf16 a[28:31],v[44:47],v[96:99],a[28:31]
ds_read_b64_tr_b16 v[60:61],v117 offset:20480
v_mfma_f32_16x16x32_bf16 a[32:35],v[48:51],v[96:99],a[32:35]
s_add_u32 m0,s33,36864
v_mfma_f32_16x16x32_bf16 a[36:39],v[52:55],v[96:99],a[36:39]
ds_read_b64_tr_b16 v[62:63],v117 offset:21504
s_waitcnt lgkmcnt(5)
v_mfma_f32_16x16x32_bf16 a[40:43],v[16:19],v[100:103],a[40:43]
v_mfma_f32_16x16x32_bf16 a[44:47],v[20:23],v[100:103],a[44:47]
ds_read_b128 v[108:111],v112 offset:6144
v_mfma_f32_16x16x32_bf16 a[48:51],v[24:27],v[100:103],a[48:51]
buffer_load_dwordx4 v[168:171],v9,s[8:11],s63 offen
v_mfma_f32_16x16x32_bf16 a[52:55],v[28:31],v[100:103],a[52:55]
ds_read_b64_tr_b16 v[64:65],v120 offset:24576
v_mfma_f32_16x16x32_bf16 a[56:59],v[32:35],v[100:103],a[56:59]
buffer_load_dwordx4 v128,s[8:11],s32 offen lds
v_mfma_f32_16x16x32_bf16 a[60:63],v[36:39],v[100:103],a[60:63]
ds_read_b64_tr_b16 v[66:67],v120 offset:25600
v_mfma_f32_16x16x32_bf16 a[64:67],v[40:43],v[100:103],a[64:67]
v_mfma_f32_16x16x32_bf16 a[68:71],v[44:47],v[100:103],a[68:71]
ds_read_b64_tr_b16 v[68:69],v121 offset:24576
v_mfma_f32_16x16x32_bf16 a[72:75],v[48:51],v[100:103],a[72:75]
v_mfma_f32_16x16x32_bf16 a[76:79],v[52:55],v[100:103],a[76:79]
ds_read_b64_tr_b16 v[70:71],v121 offset:25600
s_waitcnt lgkmcnt(9)
v_mfma_f32_16x16x32_bf16 a[80:83],v[16:19],v[104:107],a[80:83]
buffer_load_dwordx4 v129,s[8:11],s32 offen offset:1024 lds
v_mfma_f32_16x16x32_bf16 a[84:87],v[20:23],v[104:107],a[84:87]
ds_read_b128 v[96:99],v112 offset:8192
v_mfma_f32_16x16x32_bf16 a[88:91],v[24:27],v[104:107],a[88:91]
buffer_load_dwordx4 v[172:175],v9,s[8:11],s63 offen offset:1024
v_mfma_f32_16x16x32_bf16 a[92:95],v[28:31],v[104:107],a[92:95]
ds_read_b64_tr_b16 v[72:73],v122 offset:24576
v_mfma_f32_16x16x32_bf16 a[96:99],v[32:35],v[104:107],a[96:99]
v_mfma_f32_16x16x32_bf16 a[100:103],v[36:39],v[104:107],a[100:103]
ds_read_b64_tr_b16 v[74:75],v122 offset:25600
v_mfma_f32_16x16x32_bf16 a[104:107],v[40:43],v[104:107],a[104:107]
v_mfma_f32_16x16x32_bf16 a[108:111],v[44:47],v[104:107],a[108:111]
ds_read_b64_tr_b16 v[76:77],v123 offset:24576
v_mfma_f32_16x16x32_bf16 a[112:115],v[48:51],v[104:107],a[112:115]
buffer_load_dwordx4 v130,s[8:11],s32 offen offset:2048 lds
v_mfma_f32_16x16x32_bf16 a[116:119],v[52:55],v[104:107],a[116:119]
ds_read_b64_tr_b16 v[78:79],v123 offset:25600
s_waitcnt lgkmcnt(9)
v_mfma_f32_16x16x32_bf16 a[120:123],v[16:19],v[108:111],a[120:123]
v_mfma_f32_16x16x32_bf16 a[124:127],v[20:23],v[108:111],a[124:127]
ds_read_b128 v[100:103],v112 offset:10240
v_mfma_f32_16x16x32_bf16 a[128:131],v[24:27],v[108:111],a[128:131]
buffer_load_dwordx4 v[176:179],v9,s[8:11],s63 offen offset:2048
v_mfma_f32_16x16x32_bf16 a[132:135],v[28:31],v[108:111],a[132:135]
ds_read_b64_tr_b16 v[80:81],v120 offset:32768
v_mfma_f32_16x16x32_bf16 a[136:139],v[32:35],v[108:111],a[136:139]
buffer_load_dwordx4 v131,s[8:11],s32 offen offset:3072 lds
v_mfma_f32_16x16x32_bf16 a[140:143],v[36:39],v[108:111],a[140:143]
ds_read_b64_tr_b16 v[82:83],v120 offset:33792
v_mfma_f32_16x16x32_bf16 a[144:147],v[40:43],v[108:111],a[144:147]
v_mfma_f32_16x16x32_bf16 a[148:151],v[44:47],v[108:111],a[148:151]
ds_read_b64_tr_b16 v[84:85],v121 offset:32768
v_mfma_f32_16x16x32_bf16 a[152:155],v[48:51],v[108:111],a[152:155]
s_add_u32 s24,s24,128
v_mfma_f32_16x16x32_bf16 a[156:159],v[52:55],v[108:111],a[156:159]
ds_read_b64_tr_b16 v[86:87],v121 offset:33792
s_waitcnt lgkmcnt(9)
v_mfma_f32_16x16x32_bf16 a[160:163],v[16:19],v[96:99],a[160:163]
s_add_u32 s32,s32,128
v_mfma_f32_16x16x32_bf16 a[164:167],v[20:23],v[96:99],a[164:167]
ds_read_b128 v[104:107],v112 offset:12288
v_mfma_f32_16x16x32_bf16 a[168:171],v[24:27],v[96:99],a[168:171]
s_add_u32 m0,s29,65536
v_mfma_f32_16x16x32_bf16 a[172:175],v[28:31],v[96:99],a[172:175]
ds_read_b64_tr_b16 v[88:89],v122 offset:32768
v_mfma_f32_16x16x32_bf16 a[176:179],v[32:35],v[96:99],a[176:179]
buffer_load_dwordx4 v132,s[12:15],s25 offen lds
v_mfma_f32_16x16x32_bf16 a[180:183],v[36:39],v[96:99],a[180:183]
ds_read_b64_tr_b16 v[90:91],v122 offset:33792
v_mfma_f32_16x16x32_bf16 a[184:187],v[40:43],v[96:99],a[184:187]
buffer_load_dwordx4 v[180:183],v9,s[8:11],s63 offen offset:3072
v_mfma_f32_16x16x32_bf16 a[188:191],v[44:47],v[96:99],a[188:191]
ds_read_b64_tr_b16 v[92:93],v123 offset:32768
v_mfma_f32_16x16x32_bf16 a[192:195],v[48:51],v[96:99],a[192:195]
v_mfma_f32_16x16x32_bf16 a[196:199],v[52:55],v[96:99],a[196:199]
ds_read_b64_tr_b16 v[94:95],v123 offset:33792
s_waitcnt lgkmcnt(9)
v_mfma_f32_16x16x32_bf16 a[200:203],v[16:19],v[100:103],a[200:203]
buffer_load_dwordx4 v133,s[12:15],s25 offen offset:1024 lds
v_mfma_f32_16x16x32_bf16 a[204:207],v[20:23],v[100:103],a[204:207]
ds_read_b128 v[108:111],v112 offset:14336
v_mfma_f32_16x16x32_bf16 a[208:211],v[24:27],v[100:103],a[208:211]
s_cmp_lg_u32 s34,1
s_cbranch_scc1 .Lce5
s_cbranch_vccnz .Lcs5
v_smfmac_f32_16x16x64_bf16 v[144:147],v[164:167],v[16:23],v143
v_smfmac_f32_16x16x64_bf16 v[148:151],v[164:167],v[24:31],v143
v_smfmac_f32_16x16x64_bf16 v[152:155],v[164:167],v[32:39],v143
s_branch .Lce5
.Lcs5:
v_smfmac_f32_16x16x64_bf16 v[156:159],v[164:167],v[40:47],v143
v_smfmac_f32_16x16x64_bf16 v[160:163],v[164:167],v[48:55],v143
.Lce5:
v_mfma_f32_16x16x32_bf16 a[212:215],v[28:31],v[100:103],a[212:215]
v_mfma_f32_16x16x32_bf16 a[216:219],v[32:35],v[100:103],a[216:219]
v_mfma_f32_16x16x32_bf16 a[220:223],v[36:39],v[100:103],a[220:223]
v_mfma_f32_16x16x32_bf16 a[224:227],v[40:43],v[100:103],a[224:227]
buffer_load_dwordx4 v134,s[12:15],s25 offen offset:2048 lds
v_mfma_f32_16x16x32_bf16 a[228:231],v[44:47],v[100:103],a[228:231]
v_mfma_f32_16x16x32_bf16 a[232:235],v[48:51],v[100:103],a[232:235]
s_waitcnt vmcnt(21) lgkmcnt(0)
s_barrier
v_mfma_f32_16x16x32_bf16 a[236:239],v[52:55],v[100:103],a[236:239]
v_mfma_f32_16x16x32_bf16 a[240:243],v[16:19],v[104:107],a[240:243]
v_mfma_f32_16x16x32_bf16 a[244:247],v[20:23],v[104:107],a[244:247]
ds_read_b128 v[96:99],v113
v_mfma_f32_16x16x32_bf16 a[248:251],v[24:27],v[104:107],a[248:251]
v_mfma_f32_16x16x32_bf16 a[252:255],v[28:31],v[104:107],a[252:255]
v_mfma_f32_16x16x32_bf16 v[192:195],v[32:35],v[104:107],v[192:195]
buffer_load_dwordx4 v135,s[12:15],s25 offen offset:3072 lds
v_mfma_f32_16x16x32_bf16 v[196:199],v[36:39],v[104:107],v[196:199]
v_mfma_f32_16x16x32_bf16 v[200:203],v[40:43],v[104:107],v[200:203]
s_add_u32 s25,s25,s27
v_mfma_f32_16x16x32_bf16 v[204:207],v[44:47],v[104:107],v[204:207]
v_mfma_f32_16x16x32_bf16 v[208:211],v[48:51],v[104:107],v[208:211]
s_add_u32 m0,s30,81920
v_mfma_f32_16x16x32_bf16 v[212:215],v[52:55],v[104:107],v[212:215]
v_mfma_f32_16x16x32_bf16 v[216:219],v[16:19],v[108:111],v[216:219]
v_mfma_f32_16x16x32_bf16 v[220:223],v[20:23],v[108:111],v[220:223]
ds_read_b128 v[100:103],v113 offset:2048
v_mfma_f32_16x16x32_bf16 v[224:227],v[24:27],v[108:111],v[224:227]
v_mfma_f32_16x16x32_bf16 v[228:231],v[28:31],v[108:111],v[228:231]
v_mfma_f32_16x16x32_bf16 v[232:235],v[32:35],v[108:111],v[232:235]
buffer_load_dwordx4 v136,s[16:19],s26 offen lds
v_mfma_f32_16x16x32_bf16 v[236:239],v[36:39],v[108:111],v[236:239]
v_mfma_f32_16x16x32_bf16 v[240:243],v[40:43],v[108:111],v[240:243]
v_mfma_f32_16x16x32_bf16 v[244:247],v[44:47],v[108:111],v[244:247]
v_mfma_f32_16x16x32_bf16 v[248:251],v[48:51],v[108:111],v[248:251]
s_add_u32 s26,s26,s28
v_mfma_f32_16x16x32_bf16 v[252:255],v[52:55],v[108:111],v[252:255]
s_waitcnt lgkmcnt(1)
v_mfma_f32_16x16x32_bf16 a[0:3],v[56:59],v[96:99],a[0:3]
s_waitcnt vmcnt(4)
s_mov_b32 s44,0xffff0000
v_mfma_f32_16x16x32_bf16 a[4:7],v[60:63],v[96:99],a[4:7]
ds_read_b128 v[104:107],v113 offset:4096
v_lshlrev_b32 v184,16,v168
v_mfma_f32_16x16x32_bf16 a[8:11],v[64:67],v[96:99],a[8:11]
v_and_b32 v185,s44,v168
v_mov_b32 v3,v184
v_mfma_f32_16x16x32_bf16 a[12:15],v[68:71],v[96:99],a[12:15]
ds_read_b64_tr_b16 v[16:17],v116 offset:40960
v_mov_b32 v4,v185
v_mfma_f32_16x16x32_bf16 a[16:19],v[72:75],v[96:99],a[16:19]
s_add_u32 m0,s29,86016
v_lshlrev_b32 v186,16,v176
v_mfma_f32_16x16x32_bf16 a[20:23],v[76:79],v[96:99],a[20:23]
ds_read_b64_tr_b16 v[18:19],v116 offset:41984
v_and_b32 v187,s44,v176
v_mfma_f32_16x16x32_bf16 a[24:27],v[80:83],v[96:99],a[24:27]
v_mov_b32 v5,v186
v_mov_b32 v6,v187
v_mfma_f32_16x16x32_bf16 a[28:31],v[84:87],v[96:99],a[28:31]
ds_read_b64_tr_b16 v[20:21],v117 offset:40960
v_lshlrev_b32 v184,16,v169
v_mfma_f32_16x16x32_bf16 a[32:35],v[88:91],v[96:99],a[32:35]
buffer_load_dwordx4 v132,s[12:15],s25 offen lds
v_mfma_f32_16x16x32_bf16 a[36:39],v[92:95],v[96:99],a[36:39]
ds_read_b64_tr_b16 v[22:23],v117 offset:41984
s_waitcnt lgkmcnt(5)
v_mfma_f32_16x16x32_bf16 a[40:43],v[56:59],v[100:103],a[40:43]
v_and_b32 v185,s44,v169
v_add_f32 v3,v3,v184
v_mfma_f32_16x16x32_bf16 a[44:47],v[60:63],v[100:103],a[44:47]
ds_read_b128 v[108:111],v113 offset:6144
v_add_f32 v4,v4,v185
v_mfma_f32_16x16x32_bf16 a[48:51],v[64:67],v[100:103],a[48:51]
v_lshlrev_b32 v186,16,v177
v_and_b32 v187,s44,v177
v_mfma_f32_16x16x32_bf16 a[52:55],v[68:71],v[100:103],a[52:55]
ds_read_b64_tr_b16 v[24:25],v120 offset:45056
v_add_f32 v5,v5,v186
v_mfma_f32_16x16x32_bf16 a[56:59],v[72:75],v[100:103],a[56:59]
v_add_f32 v6,v6,v187
v_lshlrev_b32 v184,16,v170
v_mfma_f32_16x16x32_bf16 a[60:63],v[76:79],v[100:103],a[60:63]
ds_read_b64_tr_b16 v[26:27],v120 offset:46080
v_and_b32 v185,s44,v170
v_mfma_f32_16x16x32_bf16 a[64:67],v[80:83],v[100:103],a[64:67]
v_add_f32 v3,v3,v184
v_add_f32 v4,v4,v185
v_mfma_f32_16x16x32_bf16 a[68:71],v[84:87],v[100:103],a[68:71]
ds_read_b64_tr_b16 v[28:29],v121 offset:45056
v_lshlrev_b32 v186,16,v178
v_mfma_f32_16x16x32_bf16 a[72:75],v[88:91],v[100:103],a[72:75]
buffer_load_dwordx4 v133,s[12:15],s25 offen offset:1024 lds
v_mfma_f32_16x16x32_bf16 a[76:79],v[92:95],v[100:103],a[76:79]
ds_read_b64_tr_b16 v[30:31],v121 offset:46080
s_waitcnt lgkmcnt(9)
v_mfma_f32_16x16x32_bf16 a[80:83],v[56:59],v[104:107],a[80:83]
v_and_b32 v187,s44,v178
v_add_f32 v5,v5,v186
v_mfma_f32_16x16x32_bf16 a[84:87],v[60:63],v[104:107],a[84:87]
ds_read_b128 v[96:99],v113 offset:8192
v_add_f32 v6,v6,v187
v_mfma_f32_16x16x32_bf16 a[88:91],v[64:67],v[104:107],a[88:91]
v_lshlrev_b32 v184,16,v171
v_and_b32 v185,s44,v171
v_mfma_f32_16x16x32_bf16 a[92:95],v[68:71],v[104:107],a[92:95]
ds_read_b64_tr_b16 v[32:33],v122 offset:45056
v_add_f32 v3,v3,v184
v_mfma_f32_16x16x32_bf16 a[96:99],v[72:75],v[104:107],a[96:99]
v_add_f32 v4,v4,v185
v_lshlrev_b32 v186,16,v179
v_mfma_f32_16x16x32_bf16 a[100:103],v[76:79],v[104:107],a[100:103]
ds_read_b64_tr_b16 v[34:35],v122 offset:46080
v_and_b32 v187,s44,v179
v_mfma_f32_16x16x32_bf16 a[104:107],v[80:83],v[104:107],a[104:107]
v_add_f32 v5,v5,v186
v_add_f32 v6,v6,v187
v_mfma_f32_16x16x32_bf16 a[108:111],v[84:87],v[104:107],a[108:111]
ds_read_b64_tr_b16 v[36:37],v123 offset:45056
v_lshlrev_b32 v184,16,v172
v_mfma_f32_16x16x32_bf16 a[112:115],v[88:91],v[104:107],a[112:115]
buffer_load_dwordx4 v134,s[12:15],s25 offen offset:2048 lds
v_mfma_f32_16x16x32_bf16 a[116:119],v[92:95],v[104:107],a[116:119]
ds_read_b64_tr_b16 v[38:39],v123 offset:46080
s_waitcnt lgkmcnt(9)
v_mfma_f32_16x16x32_bf16 a[120:123],v[56:59],v[108:111],a[120:123]
v_and_b32 v185,s44,v172
v_add_f32 v3,v3,v184
v_mfma_f32_16x16x32_bf16 a[124:127],v[60:63],v[108:111],a[124:127]
ds_read_b128 v[100:103],v113 offset:10240
v_add_f32 v4,v4,v185
v_mfma_f32_16x16x32_bf16 a[128:131],v[64:67],v[108:111],a[128:131]
v_lshlrev_b32 v186,16,v180
v_and_b32 v187,s44,v180
v_mfma_f32_16x16x32_bf16 a[132:135],v[68:71],v[108:111],a[132:135]
ds_read_b64_tr_b16 v[40:41],v120 offset:53248
v_add_f32 v5,v5,v186
v_mfma_f32_16x16x32_bf16 a[136:139],v[72:75],v[108:111],a[136:139]
v_add_f32 v6,v6,v187
v_lshlrev_b32 v184,16,v173
v_mfma_f32_16x16x32_bf16 a[140:143],v[76:79],v[108:111],a[140:143]
ds_read_b64_tr_b16 v[42:43],v120 offset:54272
v_and_b32 v185,s44,v173
v_mfma_f32_16x16x32_bf16 a[144:147],v[80:83],v[108:111],a[144:147]
v_add_f32 v3,v3,v184
v_add_f32 v4,v4,v185
v_mfma_f32_16x16x32_bf16 a[148:151],v[84:87],v[108:111],a[148:151]
ds_read_b64_tr_b16 v[44:45],v121 offset:53248
v_lshlrev_b32 v186,16,v181
v_mfma_f32_16x16x32_bf16 a[152:155],v[88:91],v[108:111],a[152:155]
buffer_load_dwordx4 v135,s[12:15],s25 offen offset:3072 lds
v_mfma_f32_16x16x32_bf16 a[156:159],v[92:95],v[108:111],a[156:159]
ds_read_b64_tr_b16 v[46:47],v121 offset:54272
s_waitcnt lgkmcnt(9)
v_mfma_f32_16x16x32_bf16 a[160:163],v[56:59],v[96:99],a[160:163]
s_add_u32 s25,s25,s27
v_and_b32 v187,s44,v181
v_mfma_f32_16x16x32_bf16 a[164:167],v[60:63],v[96:99],a[164:167]
ds_read_b128 v[104:107],v113 offset:12288
v_add_f32 v5,v5,v186
v_mfma_f32_16x16x32_bf16 a[168:171],v[64:67],v[96:99],a[168:171]
v_add_f32 v6,v6,v187
v_lshlrev_b32 v184,16,v174
v_mfma_f32_16x16x32_bf16 a[172:175],v[68:71],v[96:99],a[172:175]
ds_read_b64_tr_b16 v[48:49],v122 offset:53248
v_and_b32 v185,s44,v174
v_mfma_f32_16x16x32_bf16 a[176:179],v[72:75],v[96:99],a[176:179]
s_add_u32 m0,s30,102400
v_add_f32 v3,v3,v184
v_mfma_f32_16x16x32_bf16 a[180:183],v[76:79],v[96:99],a[180:183]
ds_read_b64_tr_b16 v[50:51],v122 offset:54272
v_add_f32 v4,v4,v185
v_mfma_f32_16x16x32_bf16 a[184:187],v[80:83],v[96:99],a[184:187]
v_lshlrev_b32 v186,16,v182
v_and_b32 v187,s44,v182
v_mfma_f32_16x16x32_bf16 a[188:191],v[84:87],v[96:99],a[188:191]
ds_read_b64_tr_b16 v[52:53],v123 offset:53248
v_add_f32 v5,v5,v186
v_mfma_f32_16x16x32_bf16 a[192:195],v[88:91],v[96:99],a[192:195]
buffer_load_dwordx4 v136,s[16:19],s26 offen lds
v_mfma_f32_16x16x32_bf16 a[196:199],v[92:95],v[96:99],a[196:199]
ds_read_b64_tr_b16 v[54:55],v123 offset:54272
s_waitcnt lgkmcnt(9)
v_mfma_f32_16x16x32_bf16 a[200:203],v[56:59],v[100:103],a[200:203]
s_add_u32 s26,s26,s28
v_add_f32 v6,v6,v187
v_mfma_f32_16x16x32_bf16 a[204:207],v[60:63],v[100:103],a[204:207]
ds_read_b128 v[108:111],v113 offset:14336
v_lshlrev_b32 v184,16,v175
v_mfma_f32_16x16x32_bf16 a[208:211],v[64:67],v[100:103],a[208:211]
s_cmp_lg_u32 s34,1
s_cbranch_scc1 .Lce6
s_cbranch_vccnz .Lcs6
v_smfmac_f32_16x16x64_bf16 v[144:147],v[164:167],v[56:63],v143
v_smfmac_f32_16x16x64_bf16 v[148:151],v[164:167],v[64:71],v143
v_smfmac_f32_16x16x64_bf16 v[152:155],v[164:167],v[72:79],v143
s_branch .Lce6
.Lcs6:
v_smfmac_f32_16x16x64_bf16 v[156:159],v[164:167],v[80:87],v143
v_smfmac_f32_16x16x64_bf16 v[160:163],v[164:167],v[88:95],v143
.Lce6:
v_mfma_f32_16x16x32_bf16 a[212:215],v[68:71],v[100:103],a[212:215]
v_and_b32 v185,s44,v175
v_add_f32 v3,v3,v184
v_mfma_f32_16x16x32_bf16 a[216:219],v[72:75],v[100:103],a[216:219]
v_add_f32 v4,v4,v185
v_lshlrev_b32 v186,16,v183
v_mfma_f32_16x16x32_bf16 a[220:223],v[76:79],v[100:103],a[220:223]
v_and_b32 v187,s44,v183
v_add_f32 v5,v5,v186
v_mfma_f32_16x16x32_bf16 a[224:227],v[80:83],v[100:103],a[224:227]
v_add_f32 v6,v6,v187
v_add_f32 v3,v3,v4
v_mfma_f32_16x16x32_bf16 a[228:231],v[84:87],v[100:103],a[228:231]
v_add_f32 v5,v5,v6
v_mov_b32 v14,0x3a800000
v_mfma_f32_16x16x32_bf16 a[232:235],v[88:91],v[100:103],a[232:235]
s_waitcnt lgkmcnt(0)
s_barrier
v_mfma_f32_16x16x32_bf16 a[236:239],v[92:95],v[100:103],a[236:239]
s_add_u32 m0,s33,0
v_mfma_f32_16x16x32_bf16 a[240:243],v[56:59],v[104:107],a[240:243]
buffer_load_dwordx4 v128,s[8:11],s24 offen lds
v_mfma_f32_16x16x32_bf16 a[244:247],v[60:63],v[104:107],a[244:247]
ds_read_b128 v[96:99],v114
s_nop 0
v_mfma_f32_16x16x32_bf16 a[248:251],v[64:67],v[104:107],a[248:251]
v_add_f32_dpp v3,v3,v3 row_shr:1 row_mask:0xf bank_mask:0xf bound_ctrl:1
v_add_f32_dpp v5,v5,v5 row_shr:1 row_mask:0xf bank_mask:0xf bound_ctrl:1
v_mfma_f32_16x16x32_bf16 a[252:255],v[68:71],v[104:107],a[252:255]
s_nop 0
v_add_f32_dpp v3,v3,v3 row_shr:2 row_mask:0xf bank_mask:0xf bound_ctrl:1
v_mfma_f32_16x16x32_bf16 v[192:195],v[72:75],v[104:107],v[192:195]
v_add_f32_dpp v5,v5,v5 row_shr:2 row_mask:0xf bank_mask:0xf bound_ctrl:1
s_nop 0
v_mfma_f32_16x16x32_bf16 v[196:199],v[76:79],v[104:107],v[196:199]
v_add_f32_dpp v3,v3,v3 row_shr:4 row_mask:0xf bank_mask:0xf bound_ctrl:1
v_add_f32_dpp v5,v5,v5 row_shr:4 row_mask:0xf bank_mask:0xf bound_ctrl:1
v_mfma_f32_16x16x32_bf16 v[200:203],v[80:83],v[104:107],v[200:203]
s_nop 0
v_add_f32_dpp v3,v3,v3 row_shr:8 row_mask:0xf bank_mask:0xf bound_ctrl:1
v_mfma_f32_16x16x32_bf16 v[204:207],v[84:87],v[104:107],v[204:207]
v_add_f32_dpp v5,v5,v5 row_shr:8 row_mask:0xf bank_mask:0xf bound_ctrl:1
s_nop 0
v_mfma_f32_16x16x32_bf16 v[208:211],v[88:91],v[104:107],v[208:211]
buffer_load_dwordx4 v129,s[8:11],s24 offen offset:1024 lds
v_mfma_f32_16x16x32_bf16 v[212:215],v[92:95],v[104:107],v[212:215]
v_add_f32_dpp v3,v3,v3 row_bcast:15 row_mask:0xa bank_mask:0xf
v_mfma_f32_16x16x32_bf16 v[216:219],v[56:59],v[108:111],v[216:219]
v_add_f32_dpp v5,v5,v5 row_bcast:15 row_mask:0xa bank_mask:0xf
s_nop 0
v_mfma_f32_16x16x32_bf16 v[220:223],v[60:63],v[108:111],v[220:223]
ds_read_b128 v[100:103],v114 offset:2048
v_add_f32_dpp v3,v3,v3 row_bcast:31 row_mask:0xc bank_mask:0xf
v_mfma_f32_16x16x32_bf16 v[224:227],v[64:67],v[108:111],v[224:227]
v_add_f32_dpp v5,v5,v5 row_bcast:31 row_mask:0xc bank_mask:0xf
s_nop 0
v_mfma_f32_16x16x32_bf16 v[228:231],v[68:71],v[108:111],v[228:231]
v_readlane_b32 s46,v3,63
v_readlane_b32 s47,v5,63
v_mfma_f32_16x16x32_bf16 v[232:235],v[72:75],v[108:111],v[232:235]
s_nop 0
v_mul_f32 v7,s46,v14
v_mfma_f32_16x16x32_bf16 v[236:239],v[76:79],v[108:111],v[236:239]
v_mul_f32 v8,s47,v14
v_lshlrev_b32 v184,16,v168
v_mfma_f32_16x16x32_bf16 v[240:243],v[80:83],v[108:111],v[240:243]
buffer_load_dwordx4 v130,s[8:11],s24 offen offset:2048 lds
v_mfma_f32_16x16x32_bf16 v[244:247],v[84:87],v[108:111],v[244:247]
v_and_b32 v185,s44,v168
v_sub_f32 v184,v184,v7
v_mfma_f32_16x16x32_bf16 v[248:251],v[88:91],v[108:111],v[248:251]
v_sub_f32 v185,v185,v7
v_mul_f32 v3,v184,v184
v_mfma_f32_16x16x32_bf16 v[252:255],v[92:95],v[108:111],v[252:255]
v_mul_f32 v4,v185,v185
s_waitcnt lgkmcnt(1)
v_mfma_f32_16x16x32_bf16 a[0:3],v[16:19],v[96:99],a[0:3]
v_lshlrev_b32 v186,16,v176
v_and_b32 v187,s44,v176
v_mfma_f32_16x16x32_bf16 a[4:7],v[20:23],v[96:99],a[4:7]
ds_read_b128 v[104:107],v114 offset:4096
v_sub_f32 v186,v186,v8
v_mfma_f32_16x16x32_bf16 a[8:11],v[24:27],v[96:99],a[8:11]
v_sub_f32 v187,v187,v8
v_mul_f32 v5,v186,v186
v_mfma_f32_16x16x32_bf16 a[12:15],v[28:31],v[96:99],a[12:15]
ds_read_b64_tr_b16 v[56:57],v118
v_mul_f32 v6,v187,v187
v_mfma_f32_16x16x32_bf16 a[16:19],v[32:35],v[96:99],a[16:19]
buffer_load_dwordx4 v131,s[8:11],s24 offen offset:3072 lds
v_mfma_f32_16x16x32_bf16 a[20:23],v[36:39],v[96:99],a[20:23]
ds_read_b64_tr_b16 v[58:59],v118 offset:1024
v_lshlrev_b32 v184,16,v169
v_mfma_f32_16x16x32_bf16 a[24:27],v[40:43],v[96:99],a[24:27]
v_and_b32 v185,s44,v169
v_sub_f32 v184,v184,v7
v_mfma_f32_16x16x32_bf16 a[28:31],v[44:47],v[96:99],a[28:31]
ds_read_b64_tr_b16 v[60:61],v119
v_sub_f32 v185,v185,v7
v_mfma_f32_16x16x32_bf16 a[32:35],v[48:51],v[96:99],a[32:35]
s_add_u32 m0,s33,4096
v_fmac_f32 v3,v184,v184
v_mfma_f32_16x16x32_bf16 a[36:39],v[52:55],v[96:99],a[36:39]
ds_read_b64_tr_b16 v[62:63],v119 offset:1024
s_waitcnt lgkmcnt(5)
v_mfma_f32_16x16x32_bf16 a[40:43],v[16:19],v[100:103],a[40:43]
v_fmac_f32 v4,v185,v185
v_lshlrev_b32 v186,16,v177
v_mfma_f32_16x16x32_bf16 a[44:47],v[20:23],v[100:103],a[44:47]
ds_read_b128 v[108:111],v114 offset:6144
v_and_b32 v187,s44,v177
v_mfma_f32_16x16x32_bf16 a[48:51],v[24:27],v[100:103],a[48:51]
v_sub_f32 v186,v186,v8
v_sub_f32 v187,v187,v8
v_mfma_f32_16x16x32_bf16 a[52:55],v[28:31],v[100:103],a[52:55]
ds_read_b64_tr_b16 v[64:65],v124 offset:4096
v_fmac_f32 v5,v186,v186
v_mfma_f32_16x16x32_bf16 a[56:59],v[32:35],v[100:103],a[56:59]
buffer_load_dwordx4 v128,s[8:11],s32 offen lds
v_mfma_f32_16x16x32_bf16 a[60:63],v[36:39],v[100:103],a[60:63]
ds_read_b64_tr_b16 v[66:67],v124 offset:5120
v_fmac_f32 v6,v187,v187
v_mfma_f32_16x16x32_bf16 a[64:67],v[40:43],v[100:103],a[64:67]
v_lshlrev_b32 v184,16,v170
v_and_b32 v185,s44,v170
v_mfma_f32_16x16x32_bf16 a[68:71],v[44:47],v[100:103],a[68:71]
ds_read_b64_tr_b16 v[68:69],v125 offset:4096
v_sub_f32 v184,v184,v7
v_mfma_f32_16x16x32_bf16 a[72:75],v[48:51],v[100:103],a[72:75]
v_sub_f32 v185,v185,v7
v_fmac_f32 v3,v184,v184
v_mfma_f32_16x16x32_bf16 a[76:79],v[52:55],v[100:103],a[76:79]
ds_read_b64_tr_b16 v[70:71],v125 offset:5120
s_waitcnt lgkmcnt(9)
v_mfma_f32_16x16x32_bf16 a[80:83],v[16:19],v[104:107],a[80:83]
buffer_load_dwordx4 v129,s[8:11],s32 offen offset:1024 lds
v_mfma_f32_16x16x32_bf16 a[84:87],v[20:23],v[104:107],a[84:87]
ds_read_b128 v[96:99],v114 offset:8192
v_fmac_f32 v4,v185,v185
v_mfma_f32_16x16x32_bf16 a[88:91],v[24:27],v[104:107],a[88:91]
v_lshlrev_b32 v186,16,v178
v_and_b32 v187,s44,v178
v_mfma_f32_16x16x32_bf16 a[92:95],v[28:31],v[104:107],a[92:95]
ds_read_b64_tr_b16 v[72:73],v126 offset:4096
v_sub_f32 v186,v186,v8
v_mfma_f32_16x16x32_bf16 a[96:99],v[32:35],v[104:107],a[96:99]
v_sub_f32 v187,v187,v8
v_fmac_f32 v5,v186,v186
v_mfma_f32_16x16x32_bf16 a[100:103],v[36:39],v[104:107],a[100:103]
ds_read_b64_tr_b16 v[74:75],v126 offset:5120
v_fmac_f32 v6,v187,v187
v_mfma_f32_16x16x32_bf16 a[104:107],v[40:43],v[104:107],a[104:107]
v_lshlrev_b32 v184,16,v171
v_and_b32 v185,s44,v171
v_mfma_f32_16x16x32_bf16 a[108:111],v[44:47],v[104:107],a[108:111]
ds_read_b64_tr_b16 v[76:77],v127 offset:4096
v_sub_f32 v184,v184,v7
v_mfma_f32_16x16x32_bf16 a[112:115],v[48:51],v[104:107],a[112:115]
buffer_load_dwordx4 v130,s[8:11],s32 offen offset:2048 lds
v_mfma_f32_16x16x32_bf16 a[116:119],v[52:55],v[104:107],a[116:119]
ds_read_b64_tr_b16 v[78:79],v127 offset:5120
s_waitcnt lgkmcnt(9)
v_mfma_f32_16x16x32_bf16 a[120:123],v[16:19],v[108:111],a[120:123]
v_sub_f32 v185,v185,v7
v_fmac_f32 v3,v184,v184
v_mfma_f32_16x16x32_bf16 a[124:127],v[20:23],v[108:111],a[124:127]
ds_read_b128 v[100:103],v114 offset:10240
v_fmac_f32 v4,v185,v185
v_mfma_f32_16x16x32_bf16 a[128:131],v[24:27],v[108:111],a[128:131]
v_lshlrev_b32 v186,16,v179
v_and_b32 v187,s44,v179
v_mfma_f32_16x16x32_bf16 a[132:135],v[28:31],v[108:111],a[132:135]
ds_read_b64_tr_b16 v[80:81],v124 offset:12288
v_sub_f32 v186,v186,v8
v_mfma_f32_16x16x32_bf16 a[136:139],v[32:35],v[108:111],a[136:139]
buffer_load_dwordx4 v131,s[8:11],s32 offen offset:3072 lds
v_mfma_f32_16x16x32_bf16 a[140:143],v[36:39],v[108:111],a[140:143]
ds_read_b64_tr_b16 v[82:83],v124 offset:13312
v_sub_f32 v187,v187,v8
v_mfma_f32_16x16x32_bf16 a[144:147],v[40:43],v[108:111],a[144:147]
v_fmac_f32 v5,v186,v186
v_fmac_f32 v6,v187,v187
v_mfma_f32_16x16x32_bf16 a[148:151],v[44:47],v[108:111],a[148:151]
ds_read_b64_tr_b16 v[84:85],v125 offset:12288
v_lshlrev_b32 v184,16,v172
v_mfma_f32_16x16x32_bf16 a[152:155],v[48:51],v[108:111],a[152:155]
s_add_u32 s24,s24,128
v_and_b32 v185,s44,v172
v_mfma_f32_16x16x32_bf16 a[156:159],v[52:55],v[108:111],a[156:159]
ds_read_b64_tr_b16 v[86:87],v125 offset:13312
s_waitcnt lgkmcnt(9)
v_mfma_f32_16x16x32_bf16 a[160:163],v[16:19],v[96:99],a[160:163]
s_add_u32 s32,s32,128
v_sub_f32 v184,v184,v7
v_mfma_f32_16x16x32_bf16 a[164:167],v[20:23],v[96:99],a[164:167]
ds_read_b128 v[104:107],v114 offset:12288
v_sub_f32 v185,v185,v7
v_mfma_f32_16x16x32_bf16 a[168:171],v[24:27],v[96:99],a[168:171]
s_add_u32 m0,s29,106496
v_fmac_f32 v3,v184,v184
v_mfma_f32_16x16x32_bf16 a[172:175],v[28:31],v[96:99],a[172:175]
ds_read_b64_tr_b16 v[88:89],v126 offset:12288
v_fmac_f32 v4,v185,v185
v_mfma_f32_16x16x32_bf16 a[176:179],v[32:35],v[96:99],a[176:179]
buffer_load_dwordx4 v132,s[12:15],s25 offen lds
v_mfma_f32_16x16x32_bf16 a[180:183],v[36:39],v[96:99],a[180:183]
ds_read_b64_tr_b16 v[90:91],v126 offset:13312
v_lshlrev_b32 v186,16,v180
v_mfma_f32_16x16x32_bf16 a[184:187],v[40:43],v[96:99],a[184:187]
v_and_b32 v187,s44,v180
v_sub_f32 v186,v186,v8
v_mfma_f32_16x16x32_bf16 a[188:191],v[44:47],v[96:99],a[188:191]
ds_read_b64_tr_b16 v[92:93],v127 offset:12288
v_sub_f32 v187,v187,v8
v_mfma_f32_16x16x32_bf16 a[192:195],v[48:51],v[96:99],a[192:195]
v_fmac_f32 v5,v186,v186
v_fmac_f32 v6,v187,v187
v_mfma_f32_16x16x32_bf16 a[196:199],v[52:55],v[96:99],a[196:199]
ds_read_b64_tr_b16 v[94:95],v127 offset:13312
s_waitcnt lgkmcnt(9)
v_mfma_f32_16x16x32_bf16 a[200:203],v[16:19],v[100:103],a[200:203]
buffer_load_dwordx4 v133,s[12:15],s25 offen offset:1024 lds
v_mfma_f32_16x16x32_bf16 a[204:207],v[20:23],v[100:103],a[204:207]
ds_read_b128 v[108:111],v114 offset:14336
v_lshlrev_b32 v184,16,v173
v_mfma_f32_16x16x32_bf16 a[208:211],v[24:27],v[100:103],a[208:211]
s_cmp_lg_u32 s34,1
s_cbranch_scc1 .Lce7
s_cbranch_vccnz .Lcs7
v_smfmac_f32_16x16x64_bf16 v[144:147],v[164:167],v[16:23],v143
v_smfmac_f32_16x16x64_bf16 v[148:151],v[164:167],v[24:31],v143
v_smfmac_f32_16x16x64_bf16 v[152:155],v[164:167],v[32:39],v143
s_branch .Lce7
.Lcs7:
v_smfmac_f32_16x16x64_bf16 v[156:159],v[164:167],v[40:47],v143
v_smfmac_f32_16x16x64_bf16 v[160:163],v[164:167],v[48:55],v143
.Lce7:
v_mfma_f32_16x16x32_bf16 a[212:215],v[28:31],v[100:103],a[212:215]
v_and_b32 v185,s44,v173
v_sub_f32 v184,v184,v7
v_mfma_f32_16x16x32_bf16 a[216:219],v[32:35],v[100:103],a[216:219]
v_sub_f32 v185,v185,v7
v_fmac_f32 v3,v184,v184
v_mfma_f32_16x16x32_bf16 a[220:223],v[36:39],v[100:103],a[220:223]
v_fmac_f32 v4,v185,v185
v_lshlrev_b32 v186,16,v181
v_mfma_f32_16x16x32_bf16 a[224:227],v[40:43],v[100:103],a[224:227]
buffer_load_dwordx4 v134,s[12:15],s25 offen offset:2048 lds
v_mfma_f32_16x16x32_bf16 a[228:231],v[44:47],v[100:103],a[228:231]
v_and_b32 v187,s44,v181
v_sub_f32 v186,v186,v8
v_mfma_f32_16x16x32_bf16 a[232:235],v[48:51],v[100:103],a[232:235]
s_waitcnt vmcnt(16) lgkmcnt(0)
s_barrier
s_cmp_lg_u32 s50,s51
s_cbranch_scc1 L_evAu
v_mov_b32 v10,1
v_mov_b32 v11,0
s_and_b32 s48,s2,7
s_lshl_b32 s48,s48,2
s_mov_b64 exec,1
buffer_store_dword v10,v11,s[20:23],s56 offen sc1
buffer_atomic_add v10,v11,s[52:55],s48 offen sc1
s_mov_b64 exec,-1
L_evAu:
s_cmp_lg_u32 s50,s57
s_cbranch_scc1 L_ezAu
v_mov_b32 v10,1
v_mov_b32 v11,0
s_mov_b64 exec,1
buffer_store_dword v10,v11,s[20:23],s58 offen sc1
s_mov_b64 exec,-1
L_ezAu:
v_mfma_f32_16x16x32_bf16 a[236:239],v[52:55],v[100:103],a[236:239]
v_sub_f32 v187,v187,v8
v_mfma_f32_16x16x32_bf16 a[240:243],v[16:19],v[104:107],a[240:243]
v_fmac_f32 v5,v186,v186
v_fmac_f32 v6,v187,v187
v_mfma_f32_16x16x32_bf16 a[244:247],v[20:23],v[104:107],a[244:247]
ds_read_b128 v[96:99],v115
v_lshlrev_b32 v184,16,v174
v_mfma_f32_16x16x32_bf16 a[248:251],v[24:27],v[104:107],a[248:251]
v_and_b32 v185,s44,v174
v_sub_f32 v184,v184,v7
v_mfma_f32_16x16x32_bf16 a[252:255],v[28:31],v[104:107],a[252:255]
v_sub_f32 v185,v185,v7
v_fmac_f32 v3,v184,v184
v_mfma_f32_16x16x32_bf16 v[192:195],v[32:35],v[104:107],v[192:195]
buffer_load_dwordx4 v135,s[12:15],s25 offen offset:3072 lds
v_mfma_f32_16x16x32_bf16 v[196:199],v[36:39],v[104:107],v[196:199]
v_fmac_f32 v4,v185,v185
v_lshlrev_b32 v186,16,v182
v_mfma_f32_16x16x32_bf16 v[200:203],v[40:43],v[104:107],v[200:203]
s_add_u32 s25,s25,s27
v_and_b32 v187,s44,v182
v_mfma_f32_16x16x32_bf16 v[204:207],v[44:47],v[104:107],v[204:207]
v_sub_f32 v186,v186,v8
v_sub_f32 v187,v187,v8
v_mfma_f32_16x16x32_bf16 v[208:211],v[48:51],v[104:107],v[208:211]
s_add_u32 m0,s30,122880
v_fmac_f32 v5,v186,v186
v_mfma_f32_16x16x32_bf16 v[212:215],v[52:55],v[104:107],v[212:215]
v_fmac_f32 v6,v187,v187
v_mfma_f32_16x16x32_bf16 v[216:219],v[16:19],v[108:111],v[216:219]
v_lshlrev_b32 v184,16,v175
v_and_b32 v185,s44,v175
v_mfma_f32_16x16x32_bf16 v[220:223],v[20:23],v[108:111],v[220:223]
ds_read_b128 v[100:103],v115 offset:2048
v_sub_f32 v184,v184,v7
v_mfma_f32_16x16x32_bf16 v[224:227],v[24:27],v[108:111],v[224:227]
v_sub_f32 v185,v185,v7
v_fmac_f32 v3,v184,v184
v_mfma_f32_16x16x32_bf16 v[228:231],v[28:31],v[108:111],v[228:231]
v_fmac_f32 v4,v185,v185
v_lshlrev_b32 v186,16,v183
v_mfma_f32_16x16x32_bf16 v[232:235],v[32:35],v[108:111],v[232:235]
buffer_load_dwordx4 v136,s[16:19],s26 offen lds
v_mfma_f32_16x16x32_bf16 v[236:239],v[36:39],v[108:111],v[236:239]
v_and_b32 v187,s44,v183
v_sub_f32 v186,v186,v8
v_mfma_f32_16x16x32_bf16 v[240:243],v[40:43],v[108:111],v[240:243]
v_sub_f32 v187,v187,v8
v_fmac_f32 v5,v186,v186
v_mfma_f32_16x16x32_bf16 v[244:247],v[44:47],v[108:111],v[244:247]
v_fmac_f32 v6,v187,v187
v_add_f32 v3,v3,v4
v_mfma_f32_16x16x32_bf16 v[248:251],v[48:51],v[108:111],v[248:251]
s_add_u32 s26,s26,s28
v_add_f32 v5,v5,v6
v_mfma_f32_16x16x32_bf16 v[252:255],v[52:55],v[108:111],v[252:255]
s_mov_b32 s45,0x3727c5ac
s_waitcnt lgkmcnt(1)
v_mfma_f32_16x16x32_bf16 a[0:3],v[56:59],v[96:99],a[0:3]
s_nop 0
v_add_f32_dpp v3,v3,v3 row_shr:1 row_mask:0xf bank_mask:0xf bound_ctrl:1
v_mfma_f32_16x16x32_bf16 a[4:7],v[60:63],v[96:99],a[4:7]
ds_read_b128 v[104:107],v115 offset:4096
v_add_f32_dpp v5,v5,v5 row_shr:1 row_mask:0xf bank_mask:0xf bound_ctrl:1
v_mfma_f32_16x16x32_bf16 a[8:11],v[64:67],v[96:99],a[8:11]
s_nop 0
v_add_f32_dpp v3,v3,v3 row_shr:2 row_mask:0xf bank_mask:0xf bound_ctrl:1
v_mfma_f32_16x16x32_bf16 a[12:15],v[68:71],v[96:99],a[12:15]
ds_read_b64_tr_b16 v[16:17],v116
v_add_f32_dpp v5,v5,v5 row_shr:2 row_mask:0xf bank_mask:0xf bound_ctrl:1
v_mfma_f32_16x16x32_bf16 a[16:19],v[72:75],v[96:99],a[16:19]
s_add_u32 m0,s29,126976
s_nop 0
v_mfma_f32_16x16x32_bf16 a[20:23],v[76:79],v[96:99],a[20:23]
ds_read_b64_tr_b16 v[18:19],v116 offset:1024
v_add_f32_dpp v3,v3,v3 row_shr:4 row_mask:0xf bank_mask:0xf bound_ctrl:1
v_mfma_f32_16x16x32_bf16 a[24:27],v[80:83],v[96:99],a[24:27]
v_add_f32_dpp v5,v5,v5 row_shr:4 row_mask:0xf bank_mask:0xf bound_ctrl:1
s_nop 0
v_mfma_f32_16x16x32_bf16 a[28:31],v[84:87],v[96:99],a[28:31]
ds_read_b64_tr_b16 v[20:21],v117
v_add_f32_dpp v3,v3,v3 row_shr:8 row_mask:0xf bank_mask:0xf bound_ctrl:1
v_mfma_f32_16x16x32_bf16 a[32:35],v[88:91],v[96:99],a[32:35]
buffer_load_dwordx4 v132,s[12:15],s25 offen lds
v_mfma_f32_16x16x32_bf16 a[36:39],v[92:95],v[96:99],a[36:39]
ds_read_b64_tr_b16 v[22:23],v117 offset:1024
s_waitcnt lgkmcnt(5)
v_mfma_f32_16x16x32_bf16 a[40:43],v[56:59],v[100:103],a[40:43]
v_add_f32_dpp v5,v5,v5 row_shr:8 row_mask:0xf bank_mask:0xf bound_ctrl:1
s_nop 0
v_mfma_f32_16x16x32_bf16 a[44:47],v[60:63],v[100:103],a[44:47]
ds_read_b128 v[108:111],v115 offset:6144
v_add_f32_dpp v3,v3,v3 row_bcast:15 row_mask:0xa bank_mask:0xf
v_mfma_f32_16x16x32_bf16 a[48:51],v[64:67],v[100:103],a[48:51]
v_add_f32_dpp v5,v5,v5 row_bcast:15 row_mask:0xa bank_mask:0xf
s_nop 0
v_mfma_f32_16x16x32_bf16 a[52:55],v[68:71],v[100:103],a[52:55]
ds_read_b64_tr_b16 v[24:25],v120 offset:4096
v_add_f32_dpp v3,v3,v3 row_bcast:31 row_mask:0xc bank_mask:0xf
v_mfma_f32_16x16x32_bf16 a[56:59],v[72:75],v[100:103],a[56:59]
v_add_f32_dpp v5,v5,v5 row_bcast:31 row_mask:0xc bank_mask:0xf
s_nop 0
v_mfma_f32_16x16x32_bf16 a[60:63],v[76:79],v[100:103],a[60:63]
ds_read_b64_tr_b16 v[26:27],v120 offset:5120
v_readlane_b32 s46,v3,63
v_mfma_f32_16x16x32_bf16 a[64:67],v[80:83],v[100:103],a[64:67]
v_readlane_b32 s47,v5,63
s_nop 0
v_mfma_f32_16x16x32_bf16 a[68:71],v[84:87],v[100:103],a[68:71]
ds_read_b64_tr_b16 v[28:29],v121 offset:4096
v_mul_f32 v12,s46,v14
v_mfma_f32_16x16x32_bf16 a[72:75],v[88:91],v[100:103],a[72:75]
buffer_load_dwordx4 v133,s[12:15],s25 offen offset:1024 lds
v_mfma_f32_16x16x32_bf16 a[76:79],v[92:95],v[100:103],a[76:79]
ds_read_b64_tr_b16 v[30:31],v121 offset:5120
s_waitcnt lgkmcnt(9)
v_mfma_f32_16x16x32_bf16 a[80:83],v[56:59],v[104:107],a[80:83]
v_mul_f32 v13,s47,v14
v_cvt_pk_bf16_f32 v12,v12,v7
v_mfma_f32_16x16x32_bf16 a[84:87],v[60:63],v[104:107],a[84:87]
ds_read_b128 v[96:99],v115 offset:8192
v_cvt_pk_bf16_f32 v13,v13,v8
v_mfma_f32_16x16x32_bf16 a[88:91],v[64:67],v[104:107],a[88:91]
v_and_b32 v186,s44,v12
v_and_b32 v187,s44,v13
v_mfma_f32_16x16x32_bf16 a[92:95],v[68:71],v[104:107],a[92:95]
ds_read_b64_tr_b16 v[32:33],v122 offset:4096
v_lshlrev_b32 v12,16,v12
v_mfma_f32_16x16x32_bf16 a[96:99],v[72:75],v[104:107],a[96:99]
v_lshlrev_b32 v13,16,v13
v_add_f32 v12,s45,v12
v_mfma_f32_16x16x32_bf16 a[100:103],v[76:79],v[104:107],a[100:103]
ds_read_b64_tr_b16 v[34:35],v122 offset:5120
v_add_f32 v13,s45,v13
v_mfma_f32_16x16x32_bf16 a[104:107],v[80:83],v[104:107],a[104:107]
v_cvt_pk_bf16_f32 v12,v12,v12
v_cvt_pk_bf16_f32 v13,v13,v13
v_mfma_f32_16x16x32_bf16 a[108:111],v[84:87],v[104:107],a[108:111]
ds_read_b64_tr_b16 v[36:37],v123 offset:4096
v_lshlrev_b32 v12,16,v12
v_mfma_f32_16x16x32_bf16 a[112:115],v[88:91],v[104:107],a[112:115]
buffer_load_dwordx4 v134,s[12:15],s25 offen offset:2048 lds
v_mfma_f32_16x16x32_bf16 a[116:119],v[92:95],v[104:107],a[116:119]
ds_read_b64_tr_b16 v[38:39],v123 offset:5120
s_waitcnt lgkmcnt(9)
v_mfma_f32_16x16x32_bf16 a[120:123],v[56:59],v[108:111],a[120:123]
v_lshlrev_b32 v13,16,v13
v_sqrt_f32 v12,v12
v_mfma_f32_16x16x32_bf16 a[124:127],v[60:63],v[108:111],a[124:127]
ds_read_b128 v[100:103],v115 offset:10240
v_sqrt_f32 v13,v13
v_mfma_f32_16x16x32_bf16 a[128:131],v[64:67],v[108:111],a[128:131]
s_nop 0
v_cvt_pk_bf16_f32 v12,v12,v12
v_mfma_f32_16x16x32_bf16 a[132:135],v[68:71],v[108:111],a[132:135]
ds_read_b64_tr_b16 v[40:41],v120 offset:12288
v_cvt_pk_bf16_f32 v13,v13,v13
v_mfma_f32_16x16x32_bf16 a[136:139],v[72:75],v[108:111],a[136:139]
v_lshlrev_b32 v12,16,v12
v_lshlrev_b32 v13,16,v13
v_mfma_f32_16x16x32_bf16 a[140:143],v[76:79],v[108:111],a[140:143]
ds_read_b64_tr_b16 v[42:43],v120 offset:13312
v_rcp_f32 v184,v12
v_mfma_f32_16x16x32_bf16 a[144:147],v[80:83],v[108:111],a[144:147]
v_rcp_f32 v185,v13
v_mul_f32 v190,v12,v12
v_mfma_f32_16x16x32_bf16 a[148:151],v[84:87],v[108:111],a[148:151]
ds_read_b64_tr_b16 v[44:45],v121 offset:12288
v_mul_f32 v191,v13,v13
v_mfma_f32_16x16x32_bf16 a[152:155],v[88:91],v[108:111],a[152:155]
buffer_load_dwordx4 v135,s[12:15],s25 offen offset:3072 lds
v_mfma_f32_16x16x32_bf16 a[156:159],v[92:95],v[108:111],a[156:159]
ds_read_b64_tr_b16 v[46:47],v121 offset:13312
s_waitcnt lgkmcnt(9)
v_mfma_f32_16x16x32_bf16 a[160:163],v[56:59],v[96:99],a[160:163]
s_add_u32 s25,s25,s27
v_xor_b32 v186,0x80000000,v186
v_mfma_f32_16x16x32_bf16 a[164:167],v[60:63],v[96:99],a[164:167]
ds_read_b128 v[104:107],v115 offset:12288
v_xor_b32 v187,0x80000000,v187
v_mfma_f32_16x16x32_bf16 a[168:171],v[64:67],v[96:99],a[168:171]
v_mul_f32 v188,0xbfb8aa3b,v184
v_mul_f32 v189,0xbfb8aa3b,v185
v_mfma_f32_16x16x32_bf16 a[172:175],v[68:71],v[96:99],a[172:175]
ds_read_b64_tr_b16 v[48:49],v122 offset:12288
v_cmp_eq_u32 s[48:49],1,v2
v_mfma_f32_16x16x32_bf16 a[176:179],v[72:75],v[96:99],a[176:179]
s_add_u32 m0,s30,143360
s_nop 1
v_mfma_f32_16x16x32_bf16 a[180:183],v[76:79],v[96:99],a[180:183]
ds_read_b64_tr_b16 v[50:51],v122 offset:13312
v_cndmask_b32 v184,v184,v186,s[48:49]
v_mfma_f32_16x16x32_bf16 a[184:187],v[80:83],v[96:99],a[184:187]
v_cndmask_b32 v185,v185,v187,s[48:49]
v_cmp_eq_u32 s[48:49],2,v2
v_mfma_f32_16x16x32_bf16 a[188:191],v[84:87],v[96:99],a[188:191]
ds_read_b64_tr_b16 v[52:53],v123 offset:12288
s_nop 1
v_mfma_f32_16x16x32_bf16 a[192:195],v[88:91],v[96:99],a[192:195]
buffer_load_dwordx4 v136,s[16:19],s26 offen lds
v_mfma_f32_16x16x32_bf16 a[196:199],v[92:95],v[96:99],a[196:199]
ds_read_b64_tr_b16 v[54:55],v123 offset:13312
s_waitcnt lgkmcnt(9)
v_mfma_f32_16x16x32_bf16 a[200:203],v[56:59],v[100:103],a[200:203]
s_add_u32 s26,s26,s28
v_cndmask_b32 v184,v184,v188,s[48:49]
v_mfma_f32_16x16x32_bf16 a[204:207],v[60:63],v[100:103],a[204:207]
ds_read_b128 v[108:111],v115 offset:14336
v_cndmask_b32 v185,v185,v189,s[48:49]
v_mfma_f32_16x16x32_bf16 a[208:211],v[64:67],v[100:103],a[208:211]
s_cmp_lg_u32 s34,1
s_cbranch_scc1 .Lce8
s_cbranch_vccnz .Lcs8
v_smfmac_f32_16x16x64_bf16 v[144:147],v[164:167],v[56:63],v143
v_smfmac_f32_16x16x64_bf16 v[148:151],v[164:167],v[64:71],v143
v_smfmac_f32_16x16x64_bf16 v[152:155],v[164:167],v[72:79],v143
s_branch .Lce8
.Lcs8:
v_smfmac_f32_16x16x64_bf16 v[156:159],v[164:167],v[80:87],v143
v_smfmac_f32_16x16x64_bf16 v[160:163],v[164:167],v[88:95],v143
.Lce8:
v_mfma_f32_16x16x32_bf16 a[212:215],v[68:71],v[100:103],a[212:215]
v_cmp_eq_u32 s[48:49],3,v2
s_nop 1
v_mfma_f32_16x16x32_bf16 a[216:219],v[72:75],v[100:103],a[216:219]
v_cndmask_b32 v184,v184,v190,s[48:49]
v_cndmask_b32 v185,v185,v191,s[48:49]
v_mfma_f32_16x16x32_bf16 a[220:223],v[76:79],v[100:103],a[220:223]
v_lshlrev_b32 v12,13,v2
v_cmp_gt_u32 s[48:49],4,v2
v_mfma_f32_16x16x32_bf16 a[224:227],v[80:83],v[100:103],a[224:227]
v_mov_b32 v13,0x80000000
s_lshl_b32 s46,s34,10
v_mfma_f32_16x16x32_bf16 a[228:231],v[84:87],v[100:103],a[228:231]
s_lshl_b32 s47,s35,5
s_add_u32 s46,s46,s47
v_mfma_f32_16x16x32_bf16 a[232:235],v[88:91],v[100:103],a[232:235]
s_waitcnt vmcnt(10) lgkmcnt(0)
s_barrier
v_mfma_f32_16x16x32_bf16 a[236:239],v[92:95],v[100:103],a[236:239]
s_add_u32 m0,s33,32768
v_mfma_f32_16x16x32_bf16 a[240:243],v[56:59],v[104:107],a[240:243]
buffer_load_dwordx4 v128,s[8:11],s24 offen lds
v_mfma_f32_16x16x32_bf16 a[244:247],v[60:63],v[104:107],a[244:247]
ds_read_b128 v[96:99],v112
s_lshl_b32 s47,s31,3
v_mfma_f32_16x16x32_bf16 a[248:251],v[64:67],v[104:107],a[248:251]
s_add_u32 s46,s46,s47
s_add_u32 s46,s46,0x2710000
v_mfma_f32_16x16x32_bf16 a[252:255],v[68:71],v[104:107],a[252:255]
v_cndmask_b32 v12,v13,v12,s[48:49]
buffer_store_dwordx2 v[184:185],v12,s[20:23],s46 offen sc1
v_mfma_f32_16x16x32_bf16 v[192:195],v[72:75],v[104:107],v[192:195]
v_mfma_f32_16x16x32_bf16 v[196:199],v[76:79],v[104:107],v[196:199]
v_mfma_f32_16x16x32_bf16 v[200:203],v[80:83],v[104:107],v[200:203]
v_mfma_f32_16x16x32_bf16 v[204:207],v[84:87],v[104:107],v[204:207]
v_mfma_f32_16x16x32_bf16 v[208:211],v[88:91],v[104:107],v[208:211]
buffer_load_dwordx4 v129,s[8:11],s24 offen offset:1024 lds
v_mfma_f32_16x16x32_bf16 v[212:215],v[92:95],v[104:107],v[212:215]
v_mfma_f32_16x16x32_bf16 v[216:219],v[56:59],v[108:111],v[216:219]
v_mfma_f32_16x16x32_bf16 v[220:223],v[60:63],v[108:111],v[220:223]
ds_read_b128 v[100:103],v112 offset:2048
v_mfma_f32_16x16x32_bf16 v[224:227],v[64:67],v[108:111],v[224:227]
v_mfma_f32_16x16x32_bf16 v[228:231],v[68:71],v[108:111],v[228:231]
v_mfma_f32_16x16x32_bf16 v[232:235],v[72:75],v[108:111],v[232:235]
v_mfma_f32_16x16x32_bf16 v[236:239],v[76:79],v[108:111],v[236:239]
v_mfma_f32_16x16x32_bf16 v[240:243],v[80:83],v[108:111],v[240:243]
buffer_load_dwordx4 v130,s[8:11],s24 offen offset:2048 lds
v_mfma_f32_16x16x32_bf16 v[244:247],v[84:87],v[108:111],v[244:247]
v_mfma_f32_16x16x32_bf16 v[248:251],v[88:91],v[108:111],v[248:251]
v_mfma_f32_16x16x32_bf16 v[252:255],v[92:95],v[108:111],v[252:255]
s_min_u32 s59,s34,5
s_cmp_lt_u32 s34,2
s_cselect_b32 s59,5,s59
s_cbranch_scc1 L_pubA
s_mov_b32 s50,2
s_cmp_eq_u32 s34,2
s_cbranch_scc1 L_bxA
.p2align 6
L_loopA:
s_waitcnt lgkmcnt(1)
v_mfma_f32_16x16x32_bf16 a[0:3],v[16:19],v[96:99],a[0:3]
v_mfma_f32_16x16x32_bf16 a[4:7],v[20:23],v[96:99],a[4:7]
ds_read_b128 v[104:107],v112 offset:4096
v_mfma_f32_16x16x32_bf16 a[8:11],v[24:27],v[96:99],a[8:11]
v_mfma_f32_16x16x32_bf16 a[12:15],v[28:31],v[96:99],a[12:15]
ds_read_b64_tr_b16 v[56:57],v116 offset:20480
v_mfma_f32_16x16x32_bf16 a[16:19],v[32:35],v[96:99],a[16:19]
buffer_load_dwordx4 v131,s[8:11],s24 offen offset:3072 lds
v_mfma_f32_16x16x32_bf16 a[20:23],v[36:39],v[96:99],a[20:23]
ds_read_b64_tr_b16 v[58:59],v116 offset:21504
v_mfma_f32_16x16x32_bf16 a[24:27],v[40:43],v[96:99],a[24:27]
v_mfma_f32_16x16x32_bf16 a[28:31],v[44:47],v[96:99],a[28:31]
ds_read_b64_tr_b16 v[60:61],v117 offset:20480
v_mfma_f32_16x16x32_bf16 a[32:35],v[48:51],v[96:99],a[32:35]
s_add_u32 m0,s33,36864
v_mfma_f32_16x16x32_bf16 a[36:39],v[52:55],v[96:99],a[36:39]
ds_read_b64_tr_b16 v[62:63],v117 offset:21504
s_waitcnt lgkmcnt(5)
v_mfma_f32_16x16x32_bf16 a[40:43],v[16:19],v[100:103],a[40:43]
v_mfma_f32_16x16x32_bf16 a[44:47],v[20:23],v[100:103],a[44:47]
ds_read_b128 v[108:111],v112 offset:6144
v_mfma_f32_16x16x32_bf16 a[48:51],v[24:27],v[100:103],a[48:51]
v_mfma_f32_16x16x32_bf16 a[52:55],v[28:31],v[100:103],a[52:55]
ds_read_b64_tr_b16 v[64:65],v120 offset:24576
v_mfma_f32_16x16x32_bf16 a[56:59],v[32:35],v[100:103],a[56:59]
buffer_load_dwordx4 v128,s[8:11],s32 offen lds
v_mfma_f32_16x16x32_bf16 a[60:63],v[36:39],v[100:103],a[60:63]
ds_read_b64_tr_b16 v[66:67],v120 offset:25600
v_mfma_f32_16x16x32_bf16 a[64:67],v[40:43],v[100:103],a[64:67]
v_mfma_f32_16x16x32_bf16 a[68:71],v[44:47],v[100:103],a[68:71]
ds_read_b64_tr_b16 v[68:69],v121 offset:24576
v_mfma_f32_16x16x32_bf16 a[72:75],v[48:51],v[100:103],a[72:75]
v_mfma_f32_16x16x32_bf16 a[76:79],v[52:55],v[100:103],a[76:79]
ds_read_b64_tr_b16 v[70:71],v121 offset:25600
s_waitcnt lgkmcnt(9)
v_mfma_f32_16x16x32_bf16 a[80:83],v[16:19],v[104:107],a[80:83]
buffer_load_dwordx4 v129,s[8:11],s32 offen offset:1024 lds
v_mfma_f32_16x16x32_bf16 a[84:87],v[20:23],v[104:107],a[84:87]
ds_read_b128 v[96:99],v112 offset:8192
v_mfma_f32_16x16x32_bf16 a[88:91],v[24:27],v[104:107],a[88:91]
v_mfma_f32_16x16x32_bf16 a[92:95],v[28:31],v[104:107],a[92:95]
ds_read_b64_tr_b16 v[72:73],v122 offset:24576
v_mfma_f32_16x16x32_bf16 a[96:99],v[32:35],v[104:107],a[96:99]
v_mfma_f32_16x16x32_bf16 a[100:103],v[36:39],v[104:107],a[100:103]
ds_read_b64_tr_b16 v[74:75],v122 offset:25600
v_mfma_f32_16x16x32_bf16 a[104:107],v[40:43],v[104:107],a[104:107]
v_mfma_f32_16x16x32_bf16 a[108:111],v[44:47],v[104:107],a[108:111]
ds_read_b64_tr_b16 v[76:77],v123 offset:24576
v_mfma_f32_16x16x32_bf16 a[112:115],v[48:51],v[104:107],a[112:115]
buffer_load_dwordx4 v130,s[8:11],s32 offen offset:2048 lds
v_mfma_f32_16x16x32_bf16 a[116:119],v[52:55],v[104:107],a[116:119]
ds_read_b64_tr_b16 v[78:79],v123 offset:25600
s_waitcnt lgkmcnt(9)
v_mfma_f32_16x16x32_bf16 a[120:123],v[16:19],v[108:111],a[120:123]
v_mfma_f32_16x16x32_bf16 a[124:127],v[20:23],v[108:111],a[124:127]
ds_read_b128 v[100:103],v112 offset:10240
v_mfma_f32_16x16x32_bf16 a[128:131],v[24:27],v[108:111],a[128:131]
v_mfma_f32_16x16x32_bf16 a[132:135],v[28:31],v[108:111],a[132:135]
ds_read_b64_tr_b16 v[80:81],v120 offset:32768
v_mfma_f32_16x16x32_bf16 a[136:139],v[32:35],v[108:111],a[136:139]
buffer_load_dwordx4 v131,s[8:11],s32 offen offset:3072 lds
v_mfma_f32_16x16x32_bf16 a[140:143],v[36:39],v[108:111],a[140:143]
ds_read_b64_tr_b16 v[82:83],v120 offset:33792
v_mfma_f32_16x16x32_bf16 a[144:147],v[40:43],v[108:111],a[144:147]
v_mfma_f32_16x16x32_bf16 a[148:151],v[44:47],v[108:111],a[148:151]
ds_read_b64_tr_b16 v[84:85],v121 offset:32768
v_mfma_f32_16x16x32_bf16 a[152:155],v[48:51],v[108:111],a[152:155]
s_add_u32 s24,s24,128
v_mfma_f32_16x16x32_bf16 a[156:159],v[52:55],v[108:111],a[156:159]
ds_read_b64_tr_b16 v[86:87],v121 offset:33792
s_waitcnt lgkmcnt(9)
v_mfma_f32_16x16x32_bf16 a[160:163],v[16:19],v[96:99],a[160:163]
s_add_u32 s32,s32,128
v_mfma_f32_16x16x32_bf16 a[164:167],v[20:23],v[96:99],a[164:167]
ds_read_b128 v[104:107],v112 offset:12288
v_mfma_f32_16x16x32_bf16 a[168:171],v[24:27],v[96:99],a[168:171]
s_add_u32 m0,s29,65536
v_mfma_f32_16x16x32_bf16 a[172:175],v[28:31],v[96:99],a[172:175]
ds_read_b64_tr_b16 v[88:89],v122 offset:32768
v_mfma_f32_16x16x32_bf16 a[176:179],v[32:35],v[96:99],a[176:179]
buffer_load_dwordx4 v132,s[12:15],s25 offen lds
v_mfma_f32_16x16x32_bf16 a[180:183],v[36:39],v[96:99],a[180:183]
ds_read_b64_tr_b16 v[90:91],v122 offset:33792
v_mfma_f32_16x16x32_bf16 a[184:187],v[40:43],v[96:99],a[184:187]
v_mfma_f32_16x16x32_bf16 a[188:191],v[44:47],v[96:99],a[188:191]
ds_read_b64_tr_b16 v[92:93],v123 offset:32768
v_mfma_f32_16x16x32_bf16 a[192:195],v[48:51],v[96:99],a[192:195]
v_mfma_f32_16x16x32_bf16 a[196:199],v[52:55],v[96:99],a[196:199]
ds_read_b64_tr_b16 v[94:95],v123 offset:33792
s_waitcnt lgkmcnt(9)
v_mfma_f32_16x16x32_bf16 a[200:203],v[16:19],v[100:103],a[200:203]
buffer_load_dwordx4 v133,s[12:15],s25 offen offset:1024 lds
v_mfma_f32_16x16x32_bf16 a[204:207],v[20:23],v[100:103],a[204:207]
ds_read_b128 v[108:111],v112 offset:14336
v_mfma_f32_16x16x32_bf16 a[208:211],v[24:27],v[100:103],a[208:211]
v_mfma_f32_16x16x32_bf16 a[212:215],v[28:31],v[100:103],a[212:215]
v_mfma_f32_16x16x32_bf16 a[216:219],v[32:35],v[100:103],a[216:219]
v_mfma_f32_16x16x32_bf16 a[220:223],v[36:39],v[100:103],a[220:223]
v_mfma_f32_16x16x32_bf16 a[224:227],v[40:43],v[100:103],a[224:227]
buffer_load_dwordx4 v134,s[12:15],s25 offen offset:2048 lds
v_mfma_f32_16x16x32_bf16 a[228:231],v[44:47],v[100:103],a[228:231]
v_mfma_f32_16x16x32_bf16 a[232:235],v[48:51],v[100:103],a[232:235]
s_waitcnt vmcnt(16) lgkmcnt(0)
s_barrier
v_mfma_f32_16x16x32_bf16 a[236:239],v[52:55],v[100:103],a[236:239]
v_mfma_f32_16x16x32_bf16 a[240:243],v[16:19],v[104:107],a[240:243]
v_mfma_f32_16x16x32_bf16 a[244:247],v[20:23],v[104:107],a[244:247]
ds_read_b128 v[96:99],v113
v_mfma_f32_16x16x32_bf16 a[248:251],v[24:27],v[104:107],a[248:251]
v_mfma_f32_16x16x32_bf16 a[252:255],v[28:31],v[104:107],a[252:255]
v_mfma_f32_16x16x32_bf16 v[192:195],v[32:35],v[104:107],v[192:195]
buffer_load_dwordx4 v135,s[12:15],s25 offen offset:3072 lds
v_mfma_f32_16x16x32_bf16 v[196:199],v[36:39],v[104:107],v[196:199]
v_mfma_f32_16x16x32_bf16 v[200:203],v[40:43],v[104:107],v[200:203]
s_add_u32 s25,s25,s27
v_mfma_f32_16x16x32_bf16 v[204:207],v[44:47],v[104:107],v[204:207]
v_mfma_f32_16x16x32_bf16 v[208:211],v[48:51],v[104:107],v[208:211]
s_add_u32 m0,s30,81920
v_mfma_f32_16x16x32_bf16 v[212:215],v[52:55],v[104:107],v[212:215]
v_mfma_f32_16x16x32_bf16 v[216:219],v[16:19],v[108:111],v[216:219]
v_mfma_f32_16x16x32_bf16 v[220:223],v[20:23],v[108:111],v[220:223]
ds_read_b128 v[100:103],v113 offset:2048
v_mfma_f32_16x16x32_bf16 v[224:227],v[24:27],v[108:111],v[224:227]
v_mfma_f32_16x16x32_bf16 v[228:231],v[28:31],v[108:111],v[228:231]
v_mfma_f32_16x16x32_bf16 v[232:235],v[32:35],v[108:111],v[232:235]
buffer_load_dwordx4 v136,s[16:19],s26 offen lds
v_mfma_f32_16x16x32_bf16 v[236:239],v[36:39],v[108:111],v[236:239]
v_mfma_f32_16x16x32_bf16 v[240:243],v[40:43],v[108:111],v[240:243]
v_mfma_f32_16x16x32_bf16 v[244:247],v[44:47],v[108:111],v[244:247]
v_mfma_f32_16x16x32_bf16 v[248:251],v[48:51],v[108:111],v[248:251]
s_add_u32 s26,s26,s28
v_mfma_f32_16x16x32_bf16 v[252:255],v[52:55],v[108:111],v[252:255]
s_waitcnt lgkmcnt(1)
v_mfma_f32_16x16x32_bf16 a[0:3],v[56:59],v[96:99],a[0:3]
v_mfma_f32_16x16x32_bf16 a[4:7],v[60:63],v[96:99],a[4:7]
ds_read_b128 v[104:107],v113 offset:4096
v_mfma_f32_16x16x32_bf16 a[8:11],v[64:67],v[96:99],a[8:11]
v_mfma_f32_16x16x32_bf16 a[12:15],v[68:71],v[96:99],a[12:15]
ds_read_b64_tr_b16 v[16:17],v116 offset:40960
v_mfma_f32_16x16x32_bf16 a[16:19],v[72:75],v[96:99],a[16:19]
s_add_u32 m0,s29,86016
v_mfma_f32_16x16x32_bf16 a[20:23],v[76:79],v[96:99],a[20:23]
ds_read_b64_tr_b16 v[18:19],v116 offset:41984
v_mfma_f32_16x16x32_bf16 a[24:27],v[80:83],v[96:99],a[24:27]
v_mfma_f32_16x16x32_bf16 a[28:31],v[84:87],v[96:99],a[28:31]
ds_read_b64_tr_b16 v[20:21],v117 offset:40960
v_mfma_f32_16x16x32_bf16 a[32:35],v[88:91],v[96:99],a[32:35]
buffer_load_dwordx4 v132,s[12:15],s25 offen lds
v_mfma_f32_16x16x32_bf16 a[36:39],v[92:95],v[96:99],a[36:39]
ds_read_b64_tr_b16 v[22:23],v117 offset:41984
s_waitcnt lgkmcnt(5)
v_mfma_f32_16x16x32_bf16 a[40:43],v[56:59],v[100:103],a[40:43]
v_mfma_f32_16x16x32_bf16 a[44:47],v[60:63],v[100:103],a[44:47]
ds_read_b128 v[108:111],v113 offset:6144
v_mfma_f32_16x16x32_bf16 a[48:51],v[64:67],v[100:103],a[48:51]
v_mfma_f32_16x16x32_bf16 a[52:55],v[68:71],v[100:103],a[52:55]
ds_read_b64_tr_b16 v[24:25],v120 offset:45056
v_mfma_f32_16x16x32_bf16 a[56:59],v[72:75],v[100:103],a[56:59]
v_mfma_f32_16x16x32_bf16 a[60:63],v[76:79],v[100:103],a[60:63]
ds_read_b64_tr_b16 v[26:27],v120 offset:46080
v_mfma_f32_16x16x32_bf16 a[64:67],v[80:83],v[100:103],a[64:67]
v_mfma_f32_16x16x32_bf16 a[68:71],v[84:87],v[100:103],a[68:71]
ds_read_b64_tr_b16 v[28:29],v121 offset:45056
v_mfma_f32_16x16x32_bf16 a[72:75],v[88:91],v[100:103],a[72:75]
buffer_load_dwordx4 v133,s[12:15],s25 offen offset:1024 lds
v_mfma_f32_16x16x32_bf16 a[76:79],v[92:95],v[100:103],a[76:79]
ds_read_b64_tr_b16 v[30:31],v121 offset:46080
s_waitcnt lgkmcnt(9)
v_mfma_f32_16x16x32_bf16 a[80:83],v[56:59],v[104:107],a[80:83]
v_mfma_f32_16x16x32_bf16 a[84:87],v[60:63],v[104:107],a[84:87]
ds_read_b128 v[96:99],v113 offset:8192
v_mfma_f32_16x16x32_bf16 a[88:91],v[64:67],v[104:107],a[88:91]
v_mfma_f32_16x16x32_bf16 a[92:95],v[68:71],v[104:107],a[92:95]
ds_read_b64_tr_b16 v[32:33],v122 offset:45056
v_mfma_f32_16x16x32_bf16 a[96:99],v[72:75],v[104:107],a[96:99]
v_mfma_f32_16x16x32_bf16 a[100:103],v[76:79],v[104:107],a[100:103]
ds_read_b64_tr_b16 v[34:35],v122 offset:46080
v_mfma_f32_16x16x32_bf16 a[104:107],v[80:83],v[104:107],a[104:107]
v_mfma_f32_16x16x32_bf16 a[108:111],v[84:87],v[104:107],a[108:111]
ds_read_b64_tr_b16 v[36:37],v123 offset:45056
v_mfma_f32_16x16x32_bf16 a[112:115],v[88:91],v[104:107],a[112:115]
buffer_load_dwordx4 v134,s[12:15],s25 offen offset:2048 lds
v_mfma_f32_16x16x32_bf16 a[116:119],v[92:95],v[104:107],a[116:119]
ds_read_b64_tr_b16 v[38:39],v123 offset:46080
s_waitcnt lgkmcnt(9)
v_mfma_f32_16x16x32_bf16 a[120:123],v[56:59],v[108:111],a[120:123]
v_mfma_f32_16x16x32_bf16 a[124:127],v[60:63],v[108:111],a[124:127]
ds_read_b128 v[100:103],v113 offset:10240
v_mfma_f32_16x16x32_bf16 a[128:131],v[64:67],v[108:111],a[128:131]
v_mfma_f32_16x16x32_bf16 a[132:135],v[68:71],v[108:111],a[132:135]
ds_read_b64_tr_b16 v[40:41],v120 offset:53248
v_mfma_f32_16x16x32_bf16 a[136:139],v[72:75],v[108:111],a[136:139]
v_mfma_f32_16x16x32_bf16 a[140:143],v[76:79],v[108:111],a[140:143]
ds_read_b64_tr_b16 v[42:43],v120 offset:54272
v_mfma_f32_16x16x32_bf16 a[144:147],v[80:83],v[108:111],a[144:147]
v_mfma_f32_16x16x32_bf16 a[148:151],v[84:87],v[108:111],a[148:151]
ds_read_b64_tr_b16 v[44:45],v121 offset:53248
v_mfma_f32_16x16x32_bf16 a[152:155],v[88:91],v[108:111],a[152:155]
buffer_load_dwordx4 v135,s[12:15],s25 offen offset:3072 lds
v_mfma_f32_16x16x32_bf16 a[156:159],v[92:95],v[108:111],a[156:159]
ds_read_b64_tr_b16 v[46:47],v121 offset:54272
s_waitcnt lgkmcnt(9)
v_mfma_f32_16x16x32_bf16 a[160:163],v[56:59],v[96:99],a[160:163]
s_add_u32 s25,s25,s27
v_mfma_f32_16x16x32_bf16 a[164:167],v[60:63],v[96:99],a[164:167]
ds_read_b128 v[104:107],v113 offset:12288
v_mfma_f32_16x16x32_bf16 a[168:171],v[64:67],v[96:99],a[168:171]
v_mfma_f32_16x16x32_bf16 a[172:175],v[68:71],v[96:99],a[172:175]
ds_read_b64_tr_b16 v[48:49],v122 offset:53248
v_mfma_f32_16x16x32_bf16 a[176:179],v[72:75],v[96:99],a[176:179]
s_add_u32 m0,s30,102400
v_mfma_f32_16x16x32_bf16 a[180:183],v[76:79],v[96:99],a[180:183]
ds_read_b64_tr_b16 v[50:51],v122 offset:54272
v_mfma_f32_16x16x32_bf16 a[184:187],v[80:83],v[96:99],a[184:187]
v_mfma_f32_16x16x32_bf16 a[188:191],v[84:87],v[96:99],a[188:191]
ds_read_b64_tr_b16 v[52:53],v123 offset:53248
v_mfma_f32_16x16x32_bf16 a[192:195],v[88:91],v[96:99],a[192:195]
buffer_load_dwordx4 v136,s[16:19],s26 offen lds
v_mfma_f32_16x16x32_bf16 a[196:199],v[92:95],v[96:99],a[196:199]
ds_read_b64_tr_b16 v[54:55],v123 offset:54272
s_waitcnt lgkmcnt(9)
v_mfma_f32_16x16x32_bf16 a[200:203],v[56:59],v[100:103],a[200:203]
s_add_u32 s26,s26,s28
v_mfma_f32_16x16x32_bf16 a[204:207],v[60:63],v[100:103],a[204:207]
ds_read_b128 v[108:111],v113 offset:14336
v_mfma_f32_16x16x32_bf16 a[208:211],v[64:67],v[100:103],a[208:211]
v_mfma_f32_16x16x32_bf16 a[212:215],v[68:71],v[100:103],a[212:215]
v_mfma_f32_16x16x32_bf16 a[216:219],v[72:75],v[100:103],a[216:219]
v_mfma_f32_16x16x32_bf16 a[220:223],v[76:79],v[100:103],a[220:223]
v_mfma_f32_16x16x32_bf16 a[224:227],v[80:83],v[100:103],a[224:227]
v_mfma_f32_16x16x32_bf16 a[228:231],v[84:87],v[100:103],a[228:231]
v_mfma_f32_16x16x32_bf16 a[232:235],v[88:91],v[100:103],a[232:235]
s_waitcnt vmcnt(10) lgkmcnt(0)
s_barrier
v_mfma_f32_16x16x32_bf16 a[236:239],v[92:95],v[100:103],a[236:239]
s_add_u32 m0,s33,0
v_mfma_f32_16x16x32_bf16 a[240:243],v[56:59],v[104:107],a[240:243]
buffer_load_dwordx4 v128,s[8:11],s24 offen lds
v_mfma_f32_16x16x32_bf16 a[244:247],v[60:63],v[104:107],a[244:247]
ds_read_b128 v[96:99],v114
v_mfma_f32_16x16x32_bf16 a[248:251],v[64:67],v[104:107],a[248:251]
buffer_load_dword v139,v137,s[64:67],s72 offen
v_mfma_f32_16x16x32_bf16 a[252:255],v[68:71],v[104:107],a[252:255]
v_mfma_f32_16x16x32_bf16 v[192:195],v[72:75],v[104:107],v[192:195]
v_mfma_f32_16x16x32_bf16 v[196:199],v[76:79],v[104:107],v[196:199]
v_mfma_f32_16x16x32_bf16 v[200:203],v[80:83],v[104:107],v[200:203]
v_mfma_f32_16x16x32_bf16 v[204:207],v[84:87],v[104:107],v[204:207]
v_mfma_f32_16x16x32_bf16 v[208:211],v[88:91],v[104:107],v[208:211]
buffer_load_dwordx4 v129,s[8:11],s24 offen offset:1024 lds
v_mfma_f32_16x16x32_bf16 v[212:215],v[92:95],v[104:107],v[212:215]
v_mfma_f32_16x16x32_bf16 v[216:219],v[56:59],v[108:111],v[216:219]
v_mfma_f32_16x16x32_bf16 v[220:223],v[60:63],v[108:111],v[220:223]
ds_read_b128 v[100:103],v114 offset:2048
v_mfma_f32_16x16x32_bf16 v[224:227],v[64:67],v[108:111],v[224:227]
s_add_u32 s72,s72,1835008
v_mfma_f32_16x16x32_bf16 v[228:231],v[68:71],v[108:111],v[228:231]
v_mfma_f32_16x16x32_bf16 v[232:235],v[72:75],v[108:111],v[232:235]
v_mfma_f32_16x16x32_bf16 v[236:239],v[76:79],v[108:111],v[236:239]
v_mfma_f32_16x16x32_bf16 v[240:243],v[80:83],v[108:111],v[240:243]
buffer_load_dwordx4 v130,s[8:11],s24 offen offset:2048 lds
v_mfma_f32_16x16x32_bf16 v[244:247],v[84:87],v[108:111],v[244:247]
v_mfma_f32_16x16x32_bf16 v[248:251],v[88:91],v[108:111],v[248:251]
v_mfma_f32_16x16x32_bf16 v[252:255],v[92:95],v[108:111],v[252:255]
s_waitcnt lgkmcnt(1)
v_mfma_f32_16x16x32_bf16 a[0:3],v[16:19],v[96:99],a[0:3]
v_mfma_f32_16x16x32_bf16 a[4:7],v[20:23],v[96:99],a[4:7]
ds_read_b128 v[104:107],v114 offset:4096
v_mfma_f32_16x16x32_bf16 a[8:11],v[24:27],v[96:99],a[8:11]
v_mfma_f32_16x16x32_bf16 a[12:15],v[28:31],v[96:99],a[12:15]
ds_read_b64_tr_b16 v[56:57],v118
v_mfma_f32_16x16x32_bf16 a[16:19],v[32:35],v[96:99],a[16:19]
buffer_load_dwordx4 v131,s[8:11],s24 offen offset:3072 lds
v_mfma_f32_16x16x32_bf16 a[20:23],v[36:39],v[96:99],a[20:23]
ds_read_b64_tr_b16 v[58:59],v118 offset:1024
v_mfma_f32_16x16x32_bf16 a[24:27],v[40:43],v[96:99],a[24:27]
v_mfma_f32_16x16x32_bf16 a[28:31],v[44:47],v[96:99],a[28:31]
ds_read_b64_tr_b16 v[60:61],v119
v_mfma_f32_16x16x32_bf16 a[32:35],v[48:51],v[96:99],a[32:35]
s_add_u32 m0,s33,4096
v_mfma_f32_16x16x32_bf16 a[36:39],v[52:55],v[96:99],a[36:39]
ds_read_b64_tr_b16 v[62:63],v119 offset:1024
s_waitcnt lgkmcnt(5)
v_mfma_f32_16x16x32_bf16 a[40:43],v[16:19],v[100:103],a[40:43]
v_mfma_f32_16x16x32_bf16 a[44:47],v[20:23],v[100:103],a[44:47]
ds_read_b128 v[108:111],v114 offset:6144
v_mfma_f32_16x16x32_bf16 a[48:51],v[24:27],v[100:103],a[48:51]
v_mfma_f32_16x16x32_bf16 a[52:55],v[28:31],v[100:103],a[52:55]
ds_read_b64_tr_b16 v[64:65],v124 offset:4096
v_mfma_f32_16x16x32_bf16 a[56:59],v[32:35],v[100:103],a[56:59]
buffer_load_dwordx4 v128,s[8:11],s32 offen lds
v_mfma_f32_16x16x32_bf16 a[60:63],v[36:39],v[100:103],a[60:63]
ds_read_b64_tr_b16 v[66:67],v124 offset:5120
v_mfma_f32_16x16x32_bf16 a[64:67],v[40:43],v[100:103],a[64:67]
v_mfma_f32_16x16x32_bf16 a[68:71],v[44:47],v[100:103],a[68:71]
ds_read_b64_tr_b16 v[68:69],v125 offset:4096
v_mfma_f32_16x16x32_bf16 a[72:75],v[48:51],v[100:103],a[72:75]
v_mfma_f32_16x16x32_bf16 a[76:79],v[52:55],v[100:103],a[76:79]
ds_read_b64_tr_b16 v[70:71],v125 offset:5120
s_waitcnt lgkmcnt(9)
v_mfma_f32_16x16x32_bf16 a[80:83],v[16:19],v[104:107],a[80:83]
buffer_load_dwordx4 v129,s[8:11],s32 offen offset:1024 lds
v_mfma_f32_16x16x32_bf16 a[84:87],v[20:23],v[104:107],a[84:87]
ds_read_b128 v[96:99],v114 offset:8192
v_mfma_f32_16x16x32_bf16 a[88:91],v[24:27],v[104:107],a[88:91]
v_mfma_f32_16x16x32_bf16 a[92:95],v[28:31],v[104:107],a[92:95]
ds_read_b64_tr_b16 v[72:73],v126 offset:4096
v_mfma_f32_16x16x32_bf16 a[96:99],v[32:35],v[104:107],a[96:99]
v_mfma_f32_16x16x32_bf16 a[100:103],v[36:39],v[104:107],a[100:103]
ds_read_b64_tr_b16 v[74:75],v126 offset:5120
v_mfma_f32_16x16x32_bf16 a[104:107],v[40:43],v[104:107],a[104:107]
v_mfma_f32_16x16x32_bf16 a[108:111],v[44:47],v[104:107],a[108:111]
ds_read_b64_tr_b16 v[76:77],v127 offset:4096
v_mfma_f32_16x16x32_bf16 a[112:115],v[48:51],v[104:107],a[112:115]
buffer_load_dwordx4 v130,s[8:11],s32 offen offset:2048 lds
v_mfma_f32_16x16x32_bf16 a[116:119],v[52:55],v[104:107],a[116:119]
ds_read_b64_tr_b16 v[78:79],v127 offset:5120
s_waitcnt lgkmcnt(9)
v_mfma_f32_16x16x32_bf16 a[120:123],v[16:19],v[108:111],a[120:123]
v_mfma_f32_16x16x32_bf16 a[124:127],v[20:23],v[108:111],a[124:127]
ds_read_b128 v[100:103],v114 offset:10240
v_mfma_f32_16x16x32_bf16 a[128:131],v[24:27],v[108:111],a[128:131]
v_mfma_f32_16x16x32_bf16 a[132:135],v[28:31],v[108:111],a[132:135]
ds_read_b64_tr_b16 v[80:81],v124 offset:12288
v_mfma_f32_16x16x32_bf16 a[136:139],v[32:35],v[108:111],a[136:139]
buffer_load_dwordx4 v131,s[8:11],s32 offen offset:3072 lds
v_mfma_f32_16x16x32_bf16 a[140:143],v[36:39],v[108:111],a[140:143]
ds_read_b64_tr_b16 v[82:83],v124 offset:13312
v_mfma_f32_16x16x32_bf16 a[144:147],v[40:43],v[108:111],a[144:147]
v_mfma_f32_16x16x32_bf16 a[148:151],v[44:47],v[108:111],a[148:151]
ds_read_b64_tr_b16 v[84:85],v125 offset:12288
v_mfma_f32_16x16x32_bf16 a[152:155],v[48:51],v[108:111],a[152:155]
s_add_u32 s24,s24,128
v_mfma_f32_16x16x32_bf16 a[156:159],v[52:55],v[108:111],a[156:159]
ds_read_b64_tr_b16 v[86:87],v125 offset:13312
s_waitcnt lgkmcnt(9)
v_mfma_f32_16x16x32_bf16 a[160:163],v[16:19],v[96:99],a[160:163]
s_add_u32 s32,s32,128
v_mfma_f32_16x16x32_bf16 a[164:167],v[20:23],v[96:99],a[164:167]
ds_read_b128 v[104:107],v114 offset:12288
v_mfma_f32_16x16x32_bf16 a[168:171],v[24:27],v[96:99],a[168:171]
s_add_u32 m0,s29,106496
v_mfma_f32_16x16x32_bf16 a[172:175],v[28:31],v[96:99],a[172:175]
ds_read_b64_tr_b16 v[88:89],v126 offset:12288
v_mfma_f32_16x16x32_bf16 a[176:179],v[32:35],v[96:99],a[176:179]
buffer_load_dwordx4 v132,s[12:15],s25 offen lds
v_mfma_f32_16x16x32_bf16 a[180:183],v[36:39],v[96:99],a[180:183]
ds_read_b64_tr_b16 v[90:91],v126 offset:13312
v_mfma_f32_16x16x32_bf16 a[184:187],v[40:43],v[96:99],a[184:187]
v_mfma_f32_16x16x32_bf16 a[188:191],v[44:47],v[96:99],a[188:191]
ds_read_b64_tr_b16 v[92:93],v127 offset:12288
v_mfma_f32_16x16x32_bf16 a[192:195],v[48:51],v[96:99],a[192:195]
v_mfma_f32_16x16x32_bf16 a[196:199],v[52:55],v[96:99],a[196:199]
ds_read_b64_tr_b16 v[94:95],v127 offset:13312
s_waitcnt lgkmcnt(9)
v_mfma_f32_16x16x32_bf16 a[200:203],v[16:19],v[100:103],a[200:203]
buffer_load_dwordx4 v133,s[12:15],s25 offen offset:1024 lds
v_mfma_f32_16x16x32_bf16 a[204:207],v[20:23],v[100:103],a[204:207]
ds_read_b128 v[108:111],v114 offset:14336
v_mfma_f32_16x16x32_bf16 a[208:211],v[24:27],v[100:103],a[208:211]
v_mfma_f32_16x16x32_bf16 a[212:215],v[28:31],v[100:103],a[212:215]
v_mfma_f32_16x16x32_bf16 a[216:219],v[32:35],v[100:103],a[216:219]
v_mfma_f32_16x16x32_bf16 a[220:223],v[36:39],v[100:103],a[220:223]
v_mfma_f32_16x16x32_bf16 a[224:227],v[40:43],v[100:103],a[224:227]
buffer_load_dwordx4 v134,s[12:15],s25 offen offset:2048 lds
v_mfma_f32_16x16x32_bf16 a[228:231],v[44:47],v[100:103],a[228:231]
v_mfma_f32_16x16x32_bf16 a[232:235],v[48:51],v[100:103],a[232:235]
s_waitcnt vmcnt(16) lgkmcnt(0)
s_barrier
s_cmp_lg_u32 s50,s51
s_cbranch_scc1 L_evA0
v_mov_b32 v10,1
v_mov_b32 v11,0
s_and_b32 s48,s2,7
s_lshl_b32 s48,s48,2
s_mov_b64 exec,1
buffer_store_dword v10,v11,s[20:23],s56 offen sc1
buffer_atomic_add v10,v11,s[52:55],s48 offen sc1
s_mov_b64 exec,-1
L_evA0:
s_cmp_lg_u32 s50,s57
s_cbranch_scc1 L_ezA0
v_mov_b32 v10,1
v_mov_b32 v11,0
s_mov_b64 exec,1
buffer_store_dword v10,v11,s[20:23],s58 offen sc1
s_mov_b64 exec,-1
L_ezA0:
v_mfma_f32_16x16x32_bf16 a[236:239],v[52:55],v[100:103],a[236:239]
v_mfma_f32_16x16x32_bf16 a[240:243],v[16:19],v[104:107],a[240:243]
v_mfma_f32_16x16x32_bf16 a[244:247],v[20:23],v[104:107],a[244:247]
ds_read_b128 v[96:99],v115
v_mfma_f32_16x16x32_bf16 a[248:251],v[24:27],v[104:107],a[248:251]
v_mfma_f32_16x16x32_bf16 a[252:255],v[28:31],v[104:107],a[252:255]
v_mfma_f32_16x16x32_bf16 v[192:195],v[32:35],v[104:107],v[192:195]
buffer_load_dwordx4 v135,s[12:15],s25 offen offset:3072 lds
v_mfma_f32_16x16x32_bf16 v[196:199],v[36:39],v[104:107],v[196:199]
v_mfma_f32_16x16x32_bf16 v[200:203],v[40:43],v[104:107],v[200:203]
s_add_u32 s25,s25,s27
v_mfma_f32_16x16x32_bf16 v[204:207],v[44:47],v[104:107],v[204:207]
v_mfma_f32_16x16x32_bf16 v[208:211],v[48:51],v[104:107],v[208:211]
s_add_u32 m0,s30,122880
v_mfma_f32_16x16x32_bf16 v[212:215],v[52:55],v[104:107],v[212:215]
v_mfma_f32_16x16x32_bf16 v[216:219],v[16:19],v[108:111],v[216:219]
v_mfma_f32_16x16x32_bf16 v[220:223],v[20:23],v[108:111],v[220:223]
ds_read_b128 v[100:103],v115 offset:2048
v_mfma_f32_16x16x32_bf16 v[224:227],v[24:27],v[108:111],v[224:227]
v_mfma_f32_16x16x32_bf16 v[228:231],v[28:31],v[108:111],v[228:231]
v_mfma_f32_16x16x32_bf16 v[232:235],v[32:35],v[108:111],v[232:235]
buffer_load_dwordx4 v136,s[16:19],s26 offen lds
v_mfma_f32_16x16x32_bf16 v[236:239],v[36:39],v[108:111],v[236:239]
v_mfma_f32_16x16x32_bf16 v[240:243],v[40:43],v[108:111],v[240:243]
v_mfma_f32_16x16x32_bf16 v[244:247],v[44:47],v[108:111],v[244:247]
v_mfma_f32_16x16x32_bf16 v[248:251],v[48:51],v[108:111],v[248:251]
s_add_u32 s26,s26,s28
v_mfma_f32_16x16x32_bf16 v[252:255],v[52:55],v[108:111],v[252:255]
s_waitcnt lgkmcnt(1)
v_mfma_f32_16x16x32_bf16 a[0:3],v[56:59],v[96:99],a[0:3]
v_mfma_f32_16x16x32_bf16 a[4:7],v[60:63],v[96:99],a[4:7]
ds_read_b128 v[104:107],v115 offset:4096
v_mfma_f32_16x16x32_bf16 a[8:11],v[64:67],v[96:99],a[8:11]
v_mfma_f32_16x16x32_bf16 a[12:15],v[68:71],v[96:99],a[12:15]
ds_read_b64_tr_b16 v[16:17],v116
v_mfma_f32_16x16x32_bf16 a[16:19],v[72:75],v[96:99],a[16:19]
s_add_u32 m0,s29,126976
v_mfma_f32_16x16x32_bf16 a[20:23],v[76:79],v[96:99],a[20:23]
ds_read_b64_tr_b16 v[18:19],v116 offset:1024
v_mfma_f32_16x16x32_bf16 a[24:27],v[80:83],v[96:99],a[24:27]
v_mfma_f32_16x16x32_bf16 a[28:31],v[84:87],v[96:99],a[28:31]
ds_read_b64_tr_b16 v[20:21],v117
v_mfma_f32_16x16x32_bf16 a[32:35],v[88:91],v[96:99],a[32:35]
buffer_load_dwordx4 v132,s[12:15],s25 offen lds
v_mfma_f32_16x16x32_bf16 a[36:39],v[92:95],v[96:99],a[36:39]
ds_read_b64_tr_b16 v[22:23],v117 offset:1024
s_waitcnt lgkmcnt(5)
v_mfma_f32_16x16x32_bf16 a[40:43],v[56:59],v[100:103],a[40:43]
v_mfma_f32_16x16x32_bf16 a[44:47],v[60:63],v[100:103],a[44:47]
ds_read_b128 v[108:111],v115 offset:6144
v_mfma_f32_16x16x32_bf16 a[48:51],v[64:67],v[100:103],a[48:51]
v_mfma_f32_16x16x32_bf16 a[52:55],v[68:71],v[100:103],a[52:55]
ds_read_b64_tr_b16 v[24:25],v120 offset:4096
v_mfma_f32_16x16x32_bf16 a[56:59],v[72:75],v[100:103],a[56:59]
v_mfma_f32_16x16x32_bf16 a[60:63],v[76:79],v[100:103],a[60:63]
ds_read_b64_tr_b16 v[26:27],v120 offset:5120
v_mfma_f32_16x16x32_bf16 a[64:67],v[80:83],v[100:103],a[64:67]
v_mfma_f32_16x16x32_bf16 a[68:71],v[84:87],v[100:103],a[68:71]
ds_read_b64_tr_b16 v[28:29],v121 offset:4096
v_mfma_f32_16x16x32_bf16 a[72:75],v[88:91],v[100:103],a[72:75]
buffer_load_dwordx4 v133,s[12:15],s25 offen offset:1024 lds
v_mfma_f32_16x16x32_bf16 a[76:79],v[92:95],v[100:103],a[76:79]
ds_read_b64_tr_b16 v[30:31],v121 offset:5120
s_waitcnt lgkmcnt(9)
v_mfma_f32_16x16x32_bf16 a[80:83],v[56:59],v[104:107],a[80:83]
v_mfma_f32_16x16x32_bf16 a[84:87],v[60:63],v[104:107],a[84:87]
ds_read_b128 v[96:99],v115 offset:8192
v_mfma_f32_16x16x32_bf16 a[88:91],v[64:67],v[104:107],a[88:91]
v_mfma_f32_16x16x32_bf16 a[92:95],v[68:71],v[104:107],a[92:95]
ds_read_b64_tr_b16 v[32:33],v122 offset:4096
v_mfma_f32_16x16x32_bf16 a[96:99],v[72:75],v[104:107],a[96:99]
v_mfma_f32_16x16x32_bf16 a[100:103],v[76:79],v[104:107],a[100:103]
ds_read_b64_tr_b16 v[34:35],v122 offset:5120
v_mfma_f32_16x16x32_bf16 a[104:107],v[80:83],v[104:107],a[104:107]
v_mfma_f32_16x16x32_bf16 a[108:111],v[84:87],v[104:107],a[108:111]
ds_read_b64_tr_b16 v[36:37],v123 offset:4096
v_mfma_f32_16x16x32_bf16 a[112:115],v[88:91],v[104:107],a[112:115]
buffer_load_dwordx4 v134,s[12:15],s25 offen offset:2048 lds
v_mfma_f32_16x16x32_bf16 a[116:119],v[92:95],v[104:107],a[116:119]
ds_read_b64_tr_b16 v[38:39],v123 offset:5120
s_waitcnt lgkmcnt(9)
v_mfma_f32_16x16x32_bf16 a[120:123],v[56:59],v[108:111],a[120:123]
v_mfma_f32_16x16x32_bf16 a[124:127],v[60:63],v[108:111],a[124:127]
ds_read_b128 v[100:103],v115 offset:10240
v_mfma_f32_16x16x32_bf16 a[128:131],v[64:67],v[108:111],a[128:131]
v_mfma_f32_16x16x32_bf16 a[132:135],v[68:71],v[108:111],a[132:135]
ds_read_b64_tr_b16 v[40:41],v120 offset:12288
v_mfma_f32_16x16x32_bf16 a[136:139],v[72:75],v[108:111],a[136:139]
v_mfma_f32_16x16x32_bf16 a[140:143],v[76:79],v[108:111],a[140:143]
ds_read_b64_tr_b16 v[42:43],v120 offset:13312
v_mfma_f32_16x16x32_bf16 a[144:147],v[80:83],v[108:111],a[144:147]
v_mfma_f32_16x16x32_bf16 a[148:151],v[84:87],v[108:111],a[148:151]
ds_read_b64_tr_b16 v[44:45],v121 offset:12288
v_mfma_f32_16x16x32_bf16 a[152:155],v[88:91],v[108:111],a[152:155]
buffer_load_dwordx4 v135,s[12:15],s25 offen offset:3072 lds
v_mfma_f32_16x16x32_bf16 a[156:159],v[92:95],v[108:111],a[156:159]
ds_read_b64_tr_b16 v[46:47],v121 offset:13312
s_waitcnt lgkmcnt(9)
v_mfma_f32_16x16x32_bf16 a[160:163],v[56:59],v[96:99],a[160:163]
s_add_u32 s25,s25,s27
v_mfma_f32_16x16x32_bf16 a[164:167],v[60:63],v[96:99],a[164:167]
ds_read_b128 v[104:107],v115 offset:12288
v_mfma_f32_16x16x32_bf16 a[168:171],v[64:67],v[96:99],a[168:171]
v_mfma_f32_16x16x32_bf16 a[172:175],v[68:71],v[96:99],a[172:175]
ds_read_b64_tr_b16 v[48:49],v122 offset:12288
v_mfma_f32_16x16x32_bf16 a[176:179],v[72:75],v[96:99],a[176:179]
s_add_u32 m0,s30,143360
v_mfma_f32_16x16x32_bf16 a[180:183],v[76:79],v[96:99],a[180:183]
ds_read_b64_tr_b16 v[50:51],v122 offset:13312
v_mfma_f32_16x16x32_bf16 a[184:187],v[80:83],v[96:99],a[184:187]
v_mfma_f32_16x16x32_bf16 a[188:191],v[84:87],v[96:99],a[188:191]
ds_read_b64_tr_b16 v[52:53],v123 offset:12288
v_mfma_f32_16x16x32_bf16 a[192:195],v[88:91],v[96:99],a[192:195]
buffer_load_dwordx4 v136,s[16:19],s26 offen lds
v_mfma_f32_16x16x32_bf16 a[196:199],v[92:95],v[96:99],a[196:199]
ds_read_b64_tr_b16 v[54:55],v123 offset:13312
s_waitcnt lgkmcnt(9)
v_mfma_f32_16x16x32_bf16 a[200:203],v[56:59],v[100:103],a[200:203]
s_add_u32 s26,s26,s28
v_mfma_f32_16x16x32_bf16 a[204:207],v[60:63],v[100:103],a[204:207]
ds_read_b128 v[108:111],v115 offset:14336
v_mfma_f32_16x16x32_bf16 a[208:211],v[64:67],v[100:103],a[208:211]
v_mfma_f32_16x16x32_bf16 a[212:215],v[68:71],v[100:103],a[212:215]
v_mfma_f32_16x16x32_bf16 a[216:219],v[72:75],v[100:103],a[216:219]
v_mfma_f32_16x16x32_bf16 a[220:223],v[76:79],v[100:103],a[220:223]
v_mfma_f32_16x16x32_bf16 a[224:227],v[80:83],v[100:103],a[224:227]
v_mfma_f32_16x16x32_bf16 a[228:231],v[84:87],v[100:103],a[228:231]
v_mfma_f32_16x16x32_bf16 a[232:235],v[88:91],v[100:103],a[232:235]
s_waitcnt vmcnt(10) lgkmcnt(0)
s_barrier
v_mfma_f32_16x16x32_bf16 a[236:239],v[92:95],v[100:103],a[236:239]
s_add_u32 m0,s33,32768
v_mfma_f32_16x16x32_bf16 a[240:243],v[56:59],v[104:107],a[240:243]
buffer_load_dwordx4 v128,s[8:11],s24 offen lds
v_mfma_f32_16x16x32_bf16 a[244:247],v[60:63],v[104:107],a[244:247]
ds_read_b128 v[96:99],v112
v_mfma_f32_16x16x32_bf16 a[248:251],v[64:67],v[104:107],a[248:251]
v_mfma_f32_16x16x32_bf16 a[252:255],v[68:71],v[104:107],a[252:255]
v_mfma_f32_16x16x32_bf16 v[192:195],v[72:75],v[104:107],v[192:195]
v_mfma_f32_16x16x32_bf16 v[196:199],v[76:79],v[104:107],v[196:199]
v_mfma_f32_16x16x32_bf16 v[200:203],v[80:83],v[104:107],v[200:203]
v_mfma_f32_16x16x32_bf16 v[204:207],v[84:87],v[104:107],v[204:207]
v_mfma_f32_16x16x32_bf16 v[208:211],v[88:91],v[104:107],v[208:211]
buffer_load_dwordx4 v129,s[8:11],s24 offen offset:1024 lds
v_mfma_f32_16x16x32_bf16 v[212:215],v[92:95],v[104:107],v[212:215]
v_mfma_f32_16x16x32_bf16 v[216:219],v[56:59],v[108:111],v[216:219]
v_mfma_f32_16x16x32_bf16 v[220:223],v[60:63],v[108:111],v[220:223]
ds_read_b128 v[100:103],v112 offset:2048
v_mfma_f32_16x16x32_bf16 v[224:227],v[64:67],v[108:111],v[224:227]
v_mfma_f32_16x16x32_bf16 v[228:231],v[68:71],v[108:111],v[228:231]
v_mfma_f32_16x16x32_bf16 v[232:235],v[72:75],v[108:111],v[232:235]
v_mfma_f32_16x16x32_bf16 v[236:239],v[76:79],v[108:111],v[236:239]
v_mfma_f32_16x16x32_bf16 v[240:243],v[80:83],v[108:111],v[240:243]
buffer_load_dwordx4 v130,s[8:11],s24 offen offset:2048 lds
s_add_u32 s50,s50,1
v_mfma_f32_16x16x32_bf16 v[244:247],v[84:87],v[108:111],v[244:247]
s_cmp_lg_u32 s50,s59
v_mfma_f32_16x16x32_bf16 v[248:251],v[88:91],v[108:111],v[248:251]
v_mfma_f32_16x16x32_bf16 v[252:255],v[92:95],v[108:111],v[252:255]
s_cbranch_scc1 L_loopA
L_bxA:
s_waitcnt lgkmcnt(1)
v_mfma_f32_16x16x32_bf16 a[0:3],v[16:19],v[96:99],a[0:3]
v_mfma_f32_16x16x32_bf16 a[4:7],v[20:23],v[96:99],a[4:7]
ds_read_b128 v[104:107],v112 offset:4096
v_mfma_f32_16x16x32_bf16 a[8:11],v[24:27],v[96:99],a[8:11]
v_mfma_f32_16x16x32_bf16 a[12:15],v[28:31],v[96:99],a[12:15]
ds_read_b64_tr_b16 v[56:57],v116 offset:20480
v_mfma_f32_16x16x32_bf16 a[16:19],v[32:35],v[96:99],a[16:19]
buffer_load_dwordx4 v131,s[8:11],s24 offen offset:3072 lds
v_mfma_f32_16x16x32_bf16 a[20:23],v[36:39],v[96:99],a[20:23]
ds_read_b64_tr_b16 v[58:59],v116 offset:21504
v_mfma_f32_16x16x32_bf16 a[24:27],v[40:43],v[96:99],a[24:27]
v_mfma_f32_16x16x32_bf16 a[28:31],v[44:47],v[96:99],a[28:31]
ds_read_b64_tr_b16 v[60:61],v117 offset:20480
v_mfma_f32_16x16x32_bf16 a[32:35],v[48:51],v[96:99],a[32:35]
s_add_u32 m0,s33,36864
v_mfma_f32_16x16x32_bf16 a[36:39],v[52:55],v[96:99],a[36:39]
ds_read_b64_tr_b16 v[62:63],v117 offset:21504
s_waitcnt lgkmcnt(5)
v_mfma_f32_16x16x32_bf16 a[40:43],v[16:19],v[100:103],a[40:43]
v_mfma_f32_16x16x32_bf16 a[44:47],v[20:23],v[100:103],a[44:47]
ds_read_b128 v[108:111],v112 offset:6144
v_mfma_f32_16x16x32_bf16 a[48:51],v[24:27],v[100:103],a[48:51]
v_mfma_f32_16x16x32_bf16 a[52:55],v[28:31],v[100:103],a[52:55]
ds_read_b64_tr_b16 v[64:65],v120 offset:24576
v_mfma_f32_16x16x32_bf16 a[56:59],v[32:35],v[100:103],a[56:59]
buffer_load_dwordx4 v128,s[8:11],s32 offen lds
v_mfma_f32_16x16x32_bf16 a[60:63],v[36:39],v[100:103],a[60:63]
ds_read_b64_tr_b16 v[66:67],v120 offset:25600
v_mfma_f32_16x16x32_bf16 a[64:67],v[40:43],v[100:103],a[64:67]
v_mfma_f32_16x16x32_bf16 a[68:71],v[44:47],v[100:103],a[68:71]
ds_read_b64_tr_b16 v[68:69],v121 offset:24576
v_mfma_f32_16x16x32_bf16 a[72:75],v[48:51],v[100:103],a[72:75]
v_mfma_f32_16x16x32_bf16 a[76:79],v[52:55],v[100:103],a[76:79]
ds_read_b64_tr_b16 v[70:71],v121 offset:25600
s_waitcnt lgkmcnt(9)
v_mfma_f32_16x16x32_bf16 a[80:83],v[16:19],v[104:107],a[80:83]
buffer_load_dwordx4 v129,s[8:11],s32 offen offset:1024 lds
v_mfma_f32_16x16x32_bf16 a[84:87],v[20:23],v[104:107],a[84:87]
ds_read_b128 v[96:99],v112 offset:8192
v_mfma_f32_16x16x32_bf16 a[88:91],v[24:27],v[104:107],a[88:91]
v_mfma_f32_16x16x32_bf16 a[92:95],v[28:31],v[104:107],a[92:95]
ds_read_b64_tr_b16 v[72:73],v122 offset:24576
v_mfma_f32_16x16x32_bf16 a[96:99],v[32:35],v[104:107],a[96:99]
v_mfma_f32_16x16x32_bf16 a[100:103],v[36:39],v[104:107],a[100:103]
ds_read_b64_tr_b16 v[74:75],v122 offset:25600
v_mfma_f32_16x16x32_bf16 a[104:107],v[40:43],v[104:107],a[104:107]
v_mfma_f32_16x16x32_bf16 a[108:111],v[44:47],v[104:107],a[108:111]
ds_read_b64_tr_b16 v[76:77],v123 offset:24576
v_mfma_f32_16x16x32_bf16 a[112:115],v[48:51],v[104:107],a[112:115]
buffer_load_dwordx4 v130,s[8:11],s32 offen offset:2048 lds
v_mfma_f32_16x16x32_bf16 a[116:119],v[52:55],v[104:107],a[116:119]
ds_read_b64_tr_b16 v[78:79],v123 offset:25600
s_waitcnt lgkmcnt(9)
v_mfma_f32_16x16x32_bf16 a[120:123],v[16:19],v[108:111],a[120:123]
v_mfma_f32_16x16x32_bf16 a[124:127],v[20:23],v[108:111],a[124:127]
ds_read_b128 v[100:103],v112 offset:10240
v_mfma_f32_16x16x32_bf16 a[128:131],v[24:27],v[108:111],a[128:131]
v_mfma_f32_16x16x32_bf16 a[132:135],v[28:31],v[108:111],a[132:135]
ds_read_b64_tr_b16 v[80:81],v120 offset:32768
v_mfma_f32_16x16x32_bf16 a[136:139],v[32:35],v[108:111],a[136:139]
buffer_load_dwordx4 v131,s[8:11],s32 offen offset:3072 lds
v_mfma_f32_16x16x32_bf16 a[140:143],v[36:39],v[108:111],a[140:143]
ds_read_b64_tr_b16 v[82:83],v120 offset:33792
v_mfma_f32_16x16x32_bf16 a[144:147],v[40:43],v[108:111],a[144:147]
v_mfma_f32_16x16x32_bf16 a[148:151],v[44:47],v[108:111],a[148:151]
ds_read_b64_tr_b16 v[84:85],v121 offset:32768
v_mfma_f32_16x16x32_bf16 a[152:155],v[48:51],v[108:111],a[152:155]
s_add_u32 s24,s24,128
v_mfma_f32_16x16x32_bf16 a[156:159],v[52:55],v[108:111],a[156:159]
ds_read_b64_tr_b16 v[86:87],v121 offset:33792
s_waitcnt lgkmcnt(9)
v_mfma_f32_16x16x32_bf16 a[160:163],v[16:19],v[96:99],a[160:163]
s_add_u32 s32,s32,128
v_mfma_f32_16x16x32_bf16 a[164:167],v[20:23],v[96:99],a[164:167]
ds_read_b128 v[104:107],v112 offset:12288
v_mfma_f32_16x16x32_bf16 a[168:171],v[24:27],v[96:99],a[168:171]
s_add_u32 m0,s29,65536
v_mfma_f32_16x16x32_bf16 a[172:175],v[28:31],v[96:99],a[172:175]
ds_read_b64_tr_b16 v[88:89],v122 offset:32768
v_mfma_f32_16x16x32_bf16 a[176:179],v[32:35],v[96:99],a[176:179]
buffer_load_dwordx4 v132,s[12:15],s25 offen lds
v_mfma_f32_16x16x32_bf16 a[180:183],v[36:39],v[96:99],a[180:183]
ds_read_b64_tr_b16 v[90:91],v122 offset:33792
v_mfma_f32_16x16x32_bf16 a[184:187],v[40:43],v[96:99],a[184:187]
v_mfma_f32_16x16x32_bf16 a[188:191],v[44:47],v[96:99],a[188:191]
ds_read_b64_tr_b16 v[92:93],v123 offset:32768
v_mfma_f32_16x16x32_bf16 a[192:195],v[48:51],v[96:99],a[192:195]
v_mfma_f32_16x16x32_bf16 a[196:199],v[52:55],v[96:99],a[196:199]
ds_read_b64_tr_b16 v[94:95],v123 offset:33792
s_waitcnt lgkmcnt(9)
v_mfma_f32_16x16x32_bf16 a[200:203],v[16:19],v[100:103],a[200:203]
buffer_load_dwordx4 v133,s[12:15],s25 offen offset:1024 lds
v_mfma_f32_16x16x32_bf16 a[204:207],v[20:23],v[100:103],a[204:207]
ds_read_b128 v[108:111],v112 offset:14336
v_mfma_f32_16x16x32_bf16 a[208:211],v[24:27],v[100:103],a[208:211]
s_cbranch_vccnz .Lcs9
v_smfmac_f32_16x16x64_bf16 v[144:147],v[164:167],v[16:23],v143
v_smfmac_f32_16x16x64_bf16 v[148:151],v[164:167],v[24:31],v143
v_smfmac_f32_16x16x64_bf16 v[152:155],v[164:167],v[32:39],v143
s_branch .Lce9
.Lcs9:
v_smfmac_f32_16x16x64_bf16 v[156:159],v[164:167],v[40:47],v143
v_smfmac_f32_16x16x64_bf16 v[160:163],v[164:167],v[48:55],v143
.Lce9:
v_mfma_f32_16x16x32_bf16 a[212:215],v[28:31],v[100:103],a[212:215]
v_mfma_f32_16x16x32_bf16 a[216:219],v[32:35],v[100:103],a[216:219]
v_mfma_f32_16x16x32_bf16 a[220:223],v[36:39],v[100:103],a[220:223]
v_mfma_f32_16x16x32_bf16 a[224:227],v[40:43],v[100:103],a[224:227]
buffer_load_dwordx4 v134,s[12:15],s25 offen offset:2048 lds
v_mfma_f32_16x16x32_bf16 a[228:231],v[44:47],v[100:103],a[228:231]
v_mfma_f32_16x16x32_bf16 a[232:235],v[48:51],v[100:103],a[232:235]
s_waitcnt vmcnt(16) lgkmcnt(0)
s_barrier
v_mfma_f32_16x16x32_bf16 a[236:239],v[52:55],v[100:103],a[236:239]
v_mfma_f32_16x16x32_bf16 a[240:243],v[16:19],v[104:107],a[240:243]
v_mfma_f32_16x16x32_bf16 a[244:247],v[20:23],v[104:107],a[244:247]
ds_read_b128 v[96:99],v113
v_mfma_f32_16x16x32_bf16 a[248:251],v[24:27],v[104:107],a[248:251]
v_mfma_f32_16x16x32_bf16 a[252:255],v[28:31],v[104:107],a[252:255]
v_mfma_f32_16x16x32_bf16 v[192:195],v[32:35],v[104:107],v[192:195]
buffer_load_dwordx4 v135,s[12:15],s25 offen offset:3072 lds
v_mfma_f32_16x16x32_bf16 v[196:199],v[36:39],v[104:107],v[196:199]
v_mfma_f32_16x16x32_bf16 v[200:203],v[40:43],v[104:107],v[200:203]
s_add_u32 s25,s25,s27
v_mfma_f32_16x16x32_bf16 v[204:207],v[44:47],v[104:107],v[204:207]
v_mfma_f32_16x16x32_bf16 v[208:211],v[48:51],v[104:107],v[208:211]
s_add_u32 m0,s30,81920
v_mfma_f32_16x16x32_bf16 v[212:215],v[52:55],v[104:107],v[212:215]
v_mfma_f32_16x16x32_bf16 v[216:219],v[16:19],v[108:111],v[216:219]
v_mfma_f32_16x16x32_bf16 v[220:223],v[20:23],v[108:111],v[220:223]
ds_read_b128 v[100:103],v113 offset:2048
v_mfma_f32_16x16x32_bf16 v[224:227],v[24:27],v[108:111],v[224:227]
v_mfma_f32_16x16x32_bf16 v[228:231],v[28:31],v[108:111],v[228:231]
v_mfma_f32_16x16x32_bf16 v[232:235],v[32:35],v[108:111],v[232:235]
buffer_load_dwordx4 v136,s[16:19],s26 offen lds
v_mfma_f32_16x16x32_bf16 v[236:239],v[36:39],v[108:111],v[236:239]
v_mfma_f32_16x16x32_bf16 v[240:243],v[40:43],v[108:111],v[240:243]
v_mfma_f32_16x16x32_bf16 v[244:247],v[44:47],v[108:111],v[244:247]
v_mfma_f32_16x16x32_bf16 v[248:251],v[48:51],v[108:111],v[248:251]
s_add_u32 s26,s26,s28
v_mfma_f32_16x16x32_bf16 v[252:255],v[52:55],v[108:111],v[252:255]
s_waitcnt lgkmcnt(1)
v_mfma_f32_16x16x32_bf16 a[0:3],v[56:59],v[96:99],a[0:3]
v_mfma_f32_16x16x32_bf16 a[4:7],v[60:63],v[96:99],a[4:7]
ds_read_b128 v[104:107],v113 offset:4096
v_mfma_f32_16x16x32_bf16 a[8:11],v[64:67],v[96:99],a[8:11]
v_mfma_f32_16x16x32_bf16 a[12:15],v[68:71],v[96:99],a[12:15]
ds_read_b64_tr_b16 v[16:17],v116 offset:40960
v_mfma_f32_16x16x32_bf16 a[16:19],v[72:75],v[96:99],a[16:19]
s_add_u32 m0,s29,86016
v_mfma_f32_16x16x32_bf16 a[20:23],v[76:79],v[96:99],a[20:23]
ds_read_b64_tr_b16 v[18:19],v116 offset:41984
v_mfma_f32_16x16x32_bf16 a[24:27],v[80:83],v[96:99],a[24:27]
v_mfma_f32_16x16x32_bf16 a[28:31],v[84:87],v[96:99],a[28:31]
ds_read_b64_tr_b16 v[20:21],v117 offset:40960
v_mfma_f32_16x16x32_bf16 a[32:35],v[88:91],v[96:99],a[32:35]
buffer_load_dwordx4 v132,s[12:15],s25 offen lds
v_mfma_f32_16x16x32_bf16 a[36:39],v[92:95],v[96:99],a[36:39]
ds_read_b64_tr_b16 v[22:23],v117 offset:41984
s_waitcnt lgkmcnt(5)
v_mfma_f32_16x16x32_bf16 a[40:43],v[56:59],v[100:103],a[40:43]
v_mfma_f32_16x16x32_bf16 a[44:47],v[60:63],v[100:103],a[44:47]
ds_read_b128 v[108:111],v113 offset:6144
v_mfma_f32_16x16x32_bf16 a[48:51],v[64:67],v[100:103],a[48:51]
v_mfma_f32_16x16x32_bf16 a[52:55],v[68:71],v[100:103],a[52:55]
ds_read_b64_tr_b16 v[24:25],v120 offset:45056
v_mfma_f32_16x16x32_bf16 a[56:59],v[72:75],v[100:103],a[56:59]
v_mfma_f32_16x16x32_bf16 a[60:63],v[76:79],v[100:103],a[60:63]
ds_read_b64_tr_b16 v[26:27],v120 offset:46080
v_mfma_f32_16x16x32_bf16 a[64:67],v[80:83],v[100:103],a[64:67]
v_mfma_f32_16x16x32_bf16 a[68:71],v[84:87],v[100:103],a[68:71]
ds_read_b64_tr_b16 v[28:29],v121 offset:45056
v_mfma_f32_16x16x32_bf16 a[72:75],v[88:91],v[100:103],a[72:75]
buffer_load_dwordx4 v133,s[12:15],s25 offen offset:1024 lds
v_mfma_f32_16x16x32_bf16 a[76:79],v[92:95],v[100:103],a[76:79]
ds_read_b64_tr_b16 v[30:31],v121 offset:46080
s_waitcnt lgkmcnt(9)
v_mfma_f32_16x16x32_bf16 a[80:83],v[56:59],v[104:107],a[80:83]
v_mfma_f32_16x16x32_bf16 a[84:87],v[60:63],v[104:107],a[84:87]
ds_read_b128 v[96:99],v113 offset:8192
v_mfma_f32_16x16x32_bf16 a[88:91],v[64:67],v[104:107],a[88:91]
v_mfma_f32_16x16x32_bf16 a[92:95],v[68:71],v[104:107],a[92:95]
ds_read_b64_tr_b16 v[32:33],v122 offset:45056
v_mfma_f32_16x16x32_bf16 a[96:99],v[72:75],v[104:107],a[96:99]
v_mfma_f32_16x16x32_bf16 a[100:103],v[76:79],v[104:107],a[100:103]
ds_read_b64_tr_b16 v[34:35],v122 offset:46080
v_mfma_f32_16x16x32_bf16 a[104:107],v[80:83],v[104:107],a[104:107]
v_mfma_f32_16x16x32_bf16 a[108:111],v[84:87],v[104:107],a[108:111]
ds_read_b64_tr_b16 v[36:37],v123 offset:45056
v_mfma_f32_16x16x32_bf16 a[112:115],v[88:91],v[104:107],a[112:115]
buffer_load_dwordx4 v134,s[12:15],s25 offen offset:2048 lds
v_mfma_f32_16x16x32_bf16 a[116:119],v[92:95],v[104:107],a[116:119]
ds_read_b64_tr_b16 v[38:39],v123 offset:46080
s_waitcnt lgkmcnt(9)
v_mfma_f32_16x16x32_bf16 a[120:123],v[56:59],v[108:111],a[120:123]
v_mfma_f32_16x16x32_bf16 a[124:127],v[60:63],v[108:111],a[124:127]
ds_read_b128 v[100:103],v113 offset:10240
v_mfma_f32_16x16x32_bf16 a[128:131],v[64:67],v[108:111],a[128:131]
v_mfma_f32_16x16x32_bf16 a[132:135],v[68:71],v[108:111],a[132:135]
ds_read_b64_tr_b16 v[40:41],v120 offset:53248
v_mfma_f32_16x16x32_bf16 a[136:139],v[72:75],v[108:111],a[136:139]
v_mfma_f32_16x16x32_bf16 a[140:143],v[76:79],v[108:111],a[140:143]
ds_read_b64_tr_b16 v[42:43],v120 offset:54272
v_mfma_f32_16x16x32_bf16 a[144:147],v[80:83],v[108:111],a[144:147]
v_mfma_f32_16x16x32_bf16 a[148:151],v[84:87],v[108:111],a[148:151]
ds_read_b64_tr_b16 v[44:45],v121 offset:53248
v_mfma_f32_16x16x32_bf16 a[152:155],v[88:91],v[108:111],a[152:155]
buffer_load_dwordx4 v135,s[12:15],s25 offen offset:3072 lds
v_mfma_f32_16x16x32_bf16 a[156:159],v[92:95],v[108:111],a[156:159]
ds_read_b64_tr_b16 v[46:47],v121 offset:54272
s_waitcnt lgkmcnt(9)
v_mfma_f32_16x16x32_bf16 a[160:163],v[56:59],v[96:99],a[160:163]
s_add_u32 s25,s25,s27
v_mfma_f32_16x16x32_bf16 a[164:167],v[60:63],v[96:99],a[164:167]
ds_read_b128 v[104:107],v113 offset:12288
v_mfma_f32_16x16x32_bf16 a[168:171],v[64:67],v[96:99],a[168:171]
v_mfma_f32_16x16x32_bf16 a[172:175],v[68:71],v[96:99],a[172:175]
ds_read_b64_tr_b16 v[48:49],v122 offset:53248
v_mfma_f32_16x16x32_bf16 a[176:179],v[72:75],v[96:99],a[176:179]
s_add_u32 m0,s30,102400
v_mfma_f32_16x16x32_bf16 a[180:183],v[76:79],v[96:99],a[180:183]
ds_read_b64_tr_b16 v[50:51],v122 offset:54272
v_mfma_f32_16x16x32_bf16 a[184:187],v[80:83],v[96:99],a[184:187]
v_mfma_f32_16x16x32_bf16 a[188:191],v[84:87],v[96:99],a[188:191]
ds_read_b64_tr_b16 v[52:53],v123 offset:53248
v_mfma_f32_16x16x32_bf16 a[192:195],v[88:91],v[96:99],a[192:195]
buffer_load_dwordx4 v136,s[16:19],s26 offen lds
v_mfma_f32_16x16x32_bf16 a[196:199],v[92:95],v[96:99],a[196:199]
ds_read_b64_tr_b16 v[54:55],v123 offset:54272
s_waitcnt lgkmcnt(9)
v_mfma_f32_16x16x32_bf16 a[200:203],v[56:59],v[100:103],a[200:203]
s_add_u32 s26,s26,s28
v_mfma_f32_16x16x32_bf16 a[204:207],v[60:63],v[100:103],a[204:207]
ds_read_b128 v[108:111],v113 offset:14336
v_mfma_f32_16x16x32_bf16 a[208:211],v[64:67],v[100:103],a[208:211]
s_cbranch_vccnz .Lcs10
v_smfmac_f32_16x16x64_bf16 v[144:147],v[164:167],v[56:63],v143
v_smfmac_f32_16x16x64_bf16 v[148:151],v[164:167],v[64:71],v143
v_smfmac_f32_16x16x64_bf16 v[152:155],v[164:167],v[72:79],v143
s_branch .Lce10
.Lcs10:
v_smfmac_f32_16x16x64_bf16 v[156:159],v[164:167],v[80:87],v143
v_smfmac_f32_16x16x64_bf16 v[160:163],v[164:167],v[88:95],v143
.Lce10:
v_mfma_f32_16x16x32_bf16 a[212:215],v[68:71],v[100:103],a[212:215]
v_mfma_f32_16x16x32_bf16 a[216:219],v[72:75],v[100:103],a[216:219]
v_mfma_f32_16x16x32_bf16 a[220:223],v[76:79],v[100:103],a[220:223]
v_mfma_f32_16x16x32_bf16 a[224:227],v[80:83],v[100:103],a[224:227]
v_mfma_f32_16x16x32_bf16 a[228:231],v[84:87],v[100:103],a[228:231]
v_mfma_f32_16x16x32_bf16 a[232:235],v[88:91],v[100:103],a[232:235]
s_waitcnt vmcnt(10) lgkmcnt(0)
s_barrier
v_mfma_f32_16x16x32_bf16 a[236:239],v[92:95],v[100:103],a[236:239]
s_add_u32 m0,s33,0
v_mfma_f32_16x16x32_bf16 a[240:243],v[56:59],v[104:107],a[240:243]
buffer_load_dwordx4 v128,s[8:11],s24 offen lds
v_mfma_f32_16x16x32_bf16 a[244:247],v[60:63],v[104:107],a[244:247]
ds_read_b128 v[96:99],v114
v_mfma_f32_16x16x32_bf16 a[248:251],v[64:67],v[104:107],a[248:251]
buffer_load_dword v139,v137,s[64:67],s72 offen
v_mfma_f32_16x16x32_bf16 a[252:255],v[68:71],v[104:107],a[252:255]
v_mfma_f32_16x16x32_bf16 v[192:195],v[72:75],v[104:107],v[192:195]
v_mfma_f32_16x16x32_bf16 v[196:199],v[76:79],v[104:107],v[196:199]
v_mfma_f32_16x16x32_bf16 v[200:203],v[80:83],v[104:107],v[200:203]
v_mfma_f32_16x16x32_bf16 v[204:207],v[84:87],v[104:107],v[204:207]
v_mfma_f32_16x16x32_bf16 v[208:211],v[88:91],v[104:107],v[208:211]
buffer_load_dwordx4 v129,s[8:11],s24 offen offset:1024 lds
v_mfma_f32_16x16x32_bf16 v[212:215],v[92:95],v[104:107],v[212:215]
v_mfma_f32_16x16x32_bf16 v[216:219],v[56:59],v[108:111],v[216:219]
v_mfma_f32_16x16x32_bf16 v[220:223],v[60:63],v[108:111],v[220:223]
ds_read_b128 v[100:103],v114 offset:2048
v_mfma_f32_16x16x32_bf16 v[224:227],v[64:67],v[108:111],v[224:227]
s_add_u32 s72,s72,1835008
v_mfma_f32_16x16x32_bf16 v[228:231],v[68:71],v[108:111],v[228:231]
v_mfma_f32_16x16x32_bf16 v[232:235],v[72:75],v[108:111],v[232:235]
v_mfma_f32_16x16x32_bf16 v[236:239],v[76:79],v[108:111],v[236:239]
v_mfma_f32_16x16x32_bf16 v[240:243],v[80:83],v[108:111],v[240:243]
buffer_load_dwordx4 v130,s[8:11],s24 offen offset:2048 lds
v_mfma_f32_16x16x32_bf16 v[244:247],v[84:87],v[108:111],v[244:247]
v_mfma_f32_16x16x32_bf16 v[248:251],v[88:91],v[108:111],v[248:251]
v_mfma_f32_16x16x32_bf16 v[252:255],v[92:95],v[108:111],v[252:255]
s_waitcnt lgkmcnt(1)
v_mfma_f32_16x16x32_bf16 a[0:3],v[16:19],v[96:99],a[0:3]
v_mfma_f32_16x16x32_bf16 a[4:7],v[20:23],v[96:99],a[4:7]
ds_read_b128 v[104:107],v114 offset:4096
v_mfma_f32_16x16x32_bf16 a[8:11],v[24:27],v[96:99],a[8:11]
v_mfma_f32_16x16x32_bf16 a[12:15],v[28:31],v[96:99],a[12:15]
ds_read_b64_tr_b16 v[56:57],v118
v_mfma_f32_16x16x32_bf16 a[16:19],v[32:35],v[96:99],a[16:19]
buffer_load_dwordx4 v131,s[8:11],s24 offen offset:3072 lds
v_mfma_f32_16x16x32_bf16 a[20:23],v[36:39],v[96:99],a[20:23]
ds_read_b64_tr_b16 v[58:59],v118 offset:1024
v_mfma_f32_16x16x32_bf16 a[24:27],v[40:43],v[96:99],a[24:27]
v_mfma_f32_16x16x32_bf16 a[28:31],v[44:47],v[96:99],a[28:31]
ds_read_b64_tr_b16 v[60:61],v119
v_mfma_f32_16x16x32_bf16 a[32:35],v[48:51],v[96:99],a[32:35]
s_add_u32 m0,s33,4096
v_mfma_f32_16x16x32_bf16 a[36:39],v[52:55],v[96:99],a[36:39]
ds_read_b64_tr_b16 v[62:63],v119 offset:1024
s_waitcnt lgkmcnt(5)
v_mfma_f32_16x16x32_bf16 a[40:43],v[16:19],v[100:103],a[40:43]
v_mfma_f32_16x16x32_bf16 a[44:47],v[20:23],v[100:103],a[44:47]
ds_read_b128 v[108:111],v114 offset:6144
v_mfma_f32_16x16x32_bf16 a[48:51],v[24:27],v[100:103],a[48:51]
v_mfma_f32_16x16x32_bf16 a[52:55],v[28:31],v[100:103],a[52:55]
ds_read_b64_tr_b16 v[64:65],v124 offset:4096
v_mfma_f32_16x16x32_bf16 a[56:59],v[32:35],v[100:103],a[56:59]
buffer_load_dwordx4 v128,s[8:11],s32 offen lds
v_mfma_f32_16x16x32_bf16 a[60:63],v[36:39],v[100:103],a[60:63]
ds_read_b64_tr_b16 v[66:67],v124 offset:5120
v_mfma_f32_16x16x32_bf16 a[64:67],v[40:43],v[100:103],a[64:67]
v_mfma_f32_16x16x32_bf16 a[68:71],v[44:47],v[100:103],a[68:71]
ds_read_b64_tr_b16 v[68:69],v125 offset:4096
v_mfma_f32_16x16x32_bf16 a[72:75],v[48:51],v[100:103],a[72:75]
v_mfma_f32_16x16x32_bf16 a[76:79],v[52:55],v[100:103],a[76:79]
ds_read_b64_tr_b16 v[70:71],v125 offset:5120
s_waitcnt lgkmcnt(9)
v_mfma_f32_16x16x32_bf16 a[80:83],v[16:19],v[104:107],a[80:83]
buffer_load_dwordx4 v129,s[8:11],s32 offen offset:1024 lds
v_mfma_f32_16x16x32_bf16 a[84:87],v[20:23],v[104:107],a[84:87]
ds_read_b128 v[96:99],v114 offset:8192
v_mfma_f32_16x16x32_bf16 a[88:91],v[24:27],v[104:107],a[88:91]
v_mfma_f32_16x16x32_bf16 a[92:95],v[28:31],v[104:107],a[92:95]
ds_read_b64_tr_b16 v[72:73],v126 offset:4096
v_mfma_f32_16x16x32_bf16 a[96:99],v[32:35],v[104:107],a[96:99]
v_mfma_f32_16x16x32_bf16 a[100:103],v[36:39],v[104:107],a[100:103]
ds_read_b64_tr_b16 v[74:75],v126 offset:5120
v_mfma_f32_16x16x32_bf16 a[104:107],v[40:43],v[104:107],a[104:107]
v_mfma_f32_16x16x32_bf16 a[108:111],v[44:47],v[104:107],a[108:111]
ds_read_b64_tr_b16 v[76:77],v127 offset:4096
v_mfma_f32_16x16x32_bf16 a[112:115],v[48:51],v[104:107],a[112:115]
buffer_load_dwordx4 v130,s[8:11],s32 offen offset:2048 lds
v_mfma_f32_16x16x32_bf16 a[116:119],v[52:55],v[104:107],a[116:119]
ds_read_b64_tr_b16 v[78:79],v127 offset:5120
s_waitcnt lgkmcnt(9)
v_mfma_f32_16x16x32_bf16 a[120:123],v[16:19],v[108:111],a[120:123]
v_mfma_f32_16x16x32_bf16 a[124:127],v[20:23],v[108:111],a[124:127]
ds_read_b128 v[100:103],v114 offset:10240
v_mfma_f32_16x16x32_bf16 a[128:131],v[24:27],v[108:111],a[128:131]
v_mfma_f32_16x16x32_bf16 a[132:135],v[28:31],v[108:111],a[132:135]
ds_read_b64_tr_b16 v[80:81],v124 offset:12288
v_mfma_f32_16x16x32_bf16 a[136:139],v[32:35],v[108:111],a[136:139]
buffer_load_dwordx4 v131,s[8:11],s32 offen offset:3072 lds
v_mfma_f32_16x16x32_bf16 a[140:143],v[36:39],v[108:111],a[140:143]
ds_read_b64_tr_b16 v[82:83],v124 offset:13312
v_mfma_f32_16x16x32_bf16 a[144:147],v[40:43],v[108:111],a[144:147]
v_mfma_f32_16x16x32_bf16 a[148:151],v[44:47],v[108:111],a[148:151]
ds_read_b64_tr_b16 v[84:85],v125 offset:12288
v_mfma_f32_16x16x32_bf16 a[152:155],v[48:51],v[108:111],a[152:155]
s_add_u32 s24,s24,128
v_mfma_f32_16x16x32_bf16 a[156:159],v[52:55],v[108:111],a[156:159]
ds_read_b64_tr_b16 v[86:87],v125 offset:13312
s_waitcnt lgkmcnt(9)
v_mfma_f32_16x16x32_bf16 a[160:163],v[16:19],v[96:99],a[160:163]
s_add_u32 s32,s32,128
v_mfma_f32_16x16x32_bf16 a[164:167],v[20:23],v[96:99],a[164:167]
ds_read_b128 v[104:107],v114 offset:12288
v_mfma_f32_16x16x32_bf16 a[168:171],v[24:27],v[96:99],a[168:171]
s_add_u32 m0,s29,106496
v_mfma_f32_16x16x32_bf16 a[172:175],v[28:31],v[96:99],a[172:175]
ds_read_b64_tr_b16 v[88:89],v126 offset:12288
v_mfma_f32_16x16x32_bf16 a[176:179],v[32:35],v[96:99],a[176:179]
buffer_load_dwordx4 v132,s[12:15],s25 offen lds
v_mfma_f32_16x16x32_bf16 a[180:183],v[36:39],v[96:99],a[180:183]
ds_read_b64_tr_b16 v[90:91],v126 offset:13312
v_mfma_f32_16x16x32_bf16 a[184:187],v[40:43],v[96:99],a[184:187]
v_mfma_f32_16x16x32_bf16 a[188:191],v[44:47],v[96:99],a[188:191]
ds_read_b64_tr_b16 v[92:93],v127 offset:12288
v_mfma_f32_16x16x32_bf16 a[192:195],v[48:51],v[96:99],a[192:195]
v_mfma_f32_16x16x32_bf16 a[196:199],v[52:55],v[96:99],a[196:199]
ds_read_b64_tr_b16 v[94:95],v127 offset:13312
s_waitcnt lgkmcnt(9)
v_mfma_f32_16x16x32_bf16 a[200:203],v[16:19],v[100:103],a[200:203]
buffer_load_dwordx4 v133,s[12:15],s25 offen offset:1024 lds
v_mfma_f32_16x16x32_bf16 a[204:207],v[20:23],v[100:103],a[204:207]
ds_read_b128 v[108:111],v114 offset:14336
v_mfma_f32_16x16x32_bf16 a[208:211],v[24:27],v[100:103],a[208:211]
s_cbranch_vccnz .Lcs11
v_smfmac_f32_16x16x64_bf16 v[144:147],v[164:167],v[16:23],v143
v_smfmac_f32_16x16x64_bf16 v[148:151],v[164:167],v[24:31],v143
v_smfmac_f32_16x16x64_bf16 v[152:155],v[164:167],v[32:39],v143
s_branch .Lce11
.Lcs11:
v_smfmac_f32_16x16x64_bf16 v[156:159],v[164:167],v[40:47],v143
v_smfmac_f32_16x16x64_bf16 v[160:163],v[164:167],v[48:55],v143
.Lce11:
v_mfma_f32_16x16x32_bf16 a[212:215],v[28:31],v[100:103],a[212:215]
v_mfma_f32_16x16x32_bf16 a[216:219],v[32:35],v[100:103],a[216:219]
v_mfma_f32_16x16x32_bf16 a[220:223],v[36:39],v[100:103],a[220:223]
v_mfma_f32_16x16x32_bf16 a[224:227],v[40:43],v[100:103],a[224:227]
buffer_load_dwordx4 v134,s[12:15],s25 offen offset:2048 lds
v_mfma_f32_16x16x32_bf16 a[228:231],v[44:47],v[100:103],a[228:231]
v_mfma_f32_16x16x32_bf16 a[232:235],v[48:51],v[100:103],a[232:235]
s_waitcnt vmcnt(16) lgkmcnt(0)
s_barrier
s_cmp_lg_u32 s50,s51
s_cbranch_scc1 L_evA1
v_mov_b32 v10,1
v_mov_b32 v11,0
s_and_b32 s48,s2,7
s_lshl_b32 s48,s48,2
s_mov_b64 exec,1
buffer_store_dword v10,v11,s[20:23],s56 offen sc1
buffer_atomic_add v10,v11,s[52:55],s48 offen sc1
s_mov_b64 exec,-1
L_evA1:
s_cmp_lg_u32 s50,s57
s_cbranch_scc1 L_ezA1
v_mov_b32 v10,1
v_mov_b32 v11,0
s_mov_b64 exec,1
buffer_store_dword v10,v11,s[20:23],s58 offen sc1
s_mov_b64 exec,-1
L_ezA1:
v_mfma_f32_16x16x32_bf16 a[236:239],v[52:55],v[100:103],a[236:239]
v_mfma_f32_16x16x32_bf16 a[240:243],v[16:19],v[104:107],a[240:243]
v_mfma_f32_16x16x32_bf16 a[244:247],v[20:23],v[104:107],a[244:247]
ds_read_b128 v[96:99],v115
v_mfma_f32_16x16x32_bf16 a[248:251],v[24:27],v[104:107],a[248:251]
v_mfma_f32_16x16x32_bf16 a[252:255],v[28:31],v[104:107],a[252:255]
v_mfma_f32_16x16x32_bf16 v[192:195],v[32:35],v[104:107],v[192:195]
buffer_load_dwordx4 v135,s[12:15],s25 offen offset:3072 lds
v_mfma_f32_16x16x32_bf16 v[196:199],v[36:39],v[104:107],v[196:199]
v_mfma_f32_16x16x32_bf16 v[200:203],v[40:43],v[104:107],v[200:203]
s_add_u32 s25,s25,s27
v_mfma_f32_16x16x32_bf16 v[204:207],v[44:47],v[104:107],v[204:207]
v_mfma_f32_16x16x32_bf16 v[208:211],v[48:51],v[104:107],v[208:211]
s_add_u32 m0,s30,122880
v_mfma_f32_16x16x32_bf16 v[212:215],v[52:55],v[104:107],v[212:215]
v_mfma_f32_16x16x32_bf16 v[216:219],v[16:19],v[108:111],v[216:219]
v_mfma_f32_16x16x32_bf16 v[220:223],v[20:23],v[108:111],v[220:223]
ds_read_b128 v[100:103],v115 offset:2048
v_mfma_f32_16x16x32_bf16 v[224:227],v[24:27],v[108:111],v[224:227]
v_mfma_f32_16x16x32_bf16 v[228:231],v[28:31],v[108:111],v[228:231]
v_mfma_f32_16x16x32_bf16 v[232:235],v[32:35],v[108:111],v[232:235]
buffer_load_dwordx4 v136,s[16:19],s26 offen lds
v_mfma_f32_16x16x32_bf16 v[236:239],v[36:39],v[108:111],v[236:239]
v_mfma_f32_16x16x32_bf16 v[240:243],v[40:43],v[108:111],v[240:243]
v_mfma_f32_16x16x32_bf16 v[244:247],v[44:47],v[108:111],v[244:247]
v_mfma_f32_16x16x32_bf16 v[248:251],v[48:51],v[108:111],v[248:251]
s_add_u32 s26,s26,s28
v_mfma_f32_16x16x32_bf16 v[252:255],v[52:55],v[108:111],v[252:255]
s_waitcnt lgkmcnt(1)
v_mfma_f32_16x16x32_bf16 a[0:3],v[56:59],v[96:99],a[0:3]
v_mfma_f32_16x16x32_bf16 a[4:7],v[60:63],v[96:99],a[4:7]
ds_read_b128 v[104:107],v115 offset:4096
v_mfma_f32_16x16x32_bf16 a[8:11],v[64:67],v[96:99],a[8:11]
v_mfma_f32_16x16x32_bf16 a[12:15],v[68:71],v[96:99],a[12:15]
ds_read_b64_tr_b16 v[16:17],v116
v_mfma_f32_16x16x32_bf16 a[16:19],v[72:75],v[96:99],a[16:19]
s_add_u32 m0,s29,126976
v_mfma_f32_16x16x32_bf16 a[20:23],v[76:79],v[96:99],a[20:23]
ds_read_b64_tr_b16 v[18:19],v116 offset:1024
v_mfma_f32_16x16x32_bf16 a[24:27],v[80:83],v[96:99],a[24:27]
v_mfma_f32_16x16x32_bf16 a[28:31],v[84:87],v[96:99],a[28:31]
ds_read_b64_tr_b16 v[20:21],v117
v_mfma_f32_16x16x32_bf16 a[32:35],v[88:91],v[96:99],a[32:35]
buffer_load_dwordx4 v132,s[12:15],s25 offen lds
v_mfma_f32_16x16x32_bf16 a[36:39],v[92:95],v[96:99],a[36:39]
ds_read_b64_tr_b16 v[22:23],v117 offset:1024
s_waitcnt lgkmcnt(5)
v_mfma_f32_16x16x32_bf16 a[40:43],v[56:59],v[100:103],a[40:43]
v_mfma_f32_16x16x32_bf16 a[44:47],v[60:63],v[100:103],a[44:47]
ds_read_b128 v[108:111],v115 offset:6144
v_mfma_f32_16x16x32_bf16 a[48:51],v[64:67],v[100:103],a[48:51]
v_mfma_f32_16x16x32_bf16 a[52:55],v[68:71],v[100:103],a[52:55]
ds_read_b64_tr_b16 v[24:25],v120 offset:4096
v_mfma_f32_16x16x32_bf16 a[56:59],v[72:75],v[100:103],a[56:59]
v_mfma_f32_16x16x32_bf16 a[60:63],v[76:79],v[100:103],a[60:63]
ds_read_b64_tr_b16 v[26:27],v120 offset:5120
v_mfma_f32_16x16x32_bf16 a[64:67],v[80:83],v[100:103],a[64:67]
v_mfma_f32_16x16x32_bf16 a[68:71],v[84:87],v[100:103],a[68:71]
ds_read_b64_tr_b16 v[28:29],v121 offset:4096
v_mfma_f32_16x16x32_bf16 a[72:75],v[88:91],v[100:103],a[72:75]
buffer_load_dwordx4 v133,s[12:15],s25 offen offset:1024 lds
v_mfma_f32_16x16x32_bf16 a[76:79],v[92:95],v[100:103],a[76:79]
ds_read_b64_tr_b16 v[30:31],v121 offset:5120
s_waitcnt lgkmcnt(9)
v_mfma_f32_16x16x32_bf16 a[80:83],v[56:59],v[104:107],a[80:83]
v_mfma_f32_16x16x32_bf16 a[84:87],v[60:63],v[104:107],a[84:87]
ds_read_b128 v[96:99],v115 offset:8192
v_mfma_f32_16x16x32_bf16 a[88:91],v[64:67],v[104:107],a[88:91]
v_mfma_f32_16x16x32_bf16 a[92:95],v[68:71],v[104:107],a[92:95]
ds_read_b64_tr_b16 v[32:33],v122 offset:4096
v_mfma_f32_16x16x32_bf16 a[96:99],v[72:75],v[104:107],a[96:99]
v_mfma_f32_16x16x32_bf16 a[100:103],v[76:79],v[104:107],a[100:103]
ds_read_b64_tr_b16 v[34:35],v122 offset:5120
v_mfma_f32_16x16x32_bf16 a[104:107],v[80:83],v[104:107],a[104:107]
v_mfma_f32_16x16x32_bf16 a[108:111],v[84:87],v[104:107],a[108:111]
ds_read_b64_tr_b16 v[36:37],v123 offset:4096
v_mfma_f32_16x16x32_bf16 a[112:115],v[88:91],v[104:107],a[112:115]
buffer_load_dwordx4 v134,s[12:15],s25 offen offset:2048 lds
v_mfma_f32_16x16x32_bf16 a[116:119],v[92:95],v[104:107],a[116:119]
ds_read_b64_tr_b16 v[38:39],v123 offset:5120
s_waitcnt lgkmcnt(9)
v_mfma_f32_16x16x32_bf16 a[120:123],v[56:59],v[108:111],a[120:123]
v_mfma_f32_16x16x32_bf16 a[124:127],v[60:63],v[108:111],a[124:127]
ds_read_b128 v[100:103],v115 offset:10240
v_mfma_f32_16x16x32_bf16 a[128:131],v[64:67],v[108:111],a[128:131]
v_mfma_f32_16x16x32_bf16 a[132:135],v[68:71],v[108:111],a[132:135]
ds_read_b64_tr_b16 v[40:41],v120 offset:12288
v_mfma_f32_16x16x32_bf16 a[136:139],v[72:75],v[108:111],a[136:139]
v_mfma_f32_16x16x32_bf16 a[140:143],v[76:79],v[108:111],a[140:143]
ds_read_b64_tr_b16 v[42:43],v120 offset:13312
v_mfma_f32_16x16x32_bf16 a[144:147],v[80:83],v[108:111],a[144:147]
v_mfma_f32_16x16x32_bf16 a[148:151],v[84:87],v[108:111],a[148:151]
ds_read_b64_tr_b16 v[44:45],v121 offset:12288
v_mfma_f32_16x16x32_bf16 a[152:155],v[88:91],v[108:111],a[152:155]
buffer_load_dwordx4 v135,s[12:15],s25 offen offset:3072 lds
v_mfma_f32_16x16x32_bf16 a[156:159],v[92:95],v[108:111],a[156:159]
ds_read_b64_tr_b16 v[46:47],v121 offset:13312
s_waitcnt lgkmcnt(9)
v_mfma_f32_16x16x32_bf16 a[160:163],v[56:59],v[96:99],a[160:163]
s_add_u32 s25,s25,s27
v_mfma_f32_16x16x32_bf16 a[164:167],v[60:63],v[96:99],a[164:167]
ds_read_b128 v[104:107],v115 offset:12288
v_mfma_f32_16x16x32_bf16 a[168:171],v[64:67],v[96:99],a[168:171]
v_mfma_f32_16x16x32_bf16 a[172:175],v[68:71],v[96:99],a[172:175]
ds_read_b64_tr_b16 v[48:49],v122 offset:12288
v_mfma_f32_16x16x32_bf16 a[176:179],v[72:75],v[96:99],a[176:179]
s_add_u32 m0,s30,143360
v_mfma_f32_16x16x32_bf16 a[180:183],v[76:79],v[96:99],a[180:183]
ds_read_b64_tr_b16 v[50:51],v122 offset:13312
v_mfma_f32_16x16x32_bf16 a[184:187],v[80:83],v[96:99],a[184:187]
v_mfma_f32_16x16x32_bf16 a[188:191],v[84:87],v[96:99],a[188:191]
ds_read_b64_tr_b16 v[52:53],v123 offset:12288
v_mfma_f32_16x16x32_bf16 a[192:195],v[88:91],v[96:99],a[192:195]
buffer_load_dwordx4 v136,s[16:19],s26 offen lds
v_mfma_f32_16x16x32_bf16 a[196:199],v[92:95],v[96:99],a[196:199]
ds_read_b64_tr_b16 v[54:55],v123 offset:13312
s_waitcnt lgkmcnt(9)
v_mfma_f32_16x16x32_bf16 a[200:203],v[56:59],v[100:103],a[200:203]
s_add_u32 s26,s26,s28
v_mfma_f32_16x16x32_bf16 a[204:207],v[60:63],v[100:103],a[204:207]
ds_read_b128 v[108:111],v115 offset:14336
v_mfma_f32_16x16x32_bf16 a[208:211],v[64:67],v[100:103],a[208:211]
s_cbranch_vccnz .Lcs12
v_smfmac_f32_16x16x64_bf16 v[144:147],v[164:167],v[56:63],v143
v_smfmac_f32_16x16x64_bf16 v[148:151],v[164:167],v[64:71],v143
v_smfmac_f32_16x16x64_bf16 v[152:155],v[164:167],v[72:79],v143
s_branch .Lce12
.Lcs12:
v_smfmac_f32_16x16x64_bf16 v[156:159],v[164:167],v[80:87],v143
v_smfmac_f32_16x16x64_bf16 v[160:163],v[164:167],v[88:95],v143
.Lce12:
v_mfma_f32_16x16x32_bf16 a[212:215],v[68:71],v[100:103],a[212:215]
v_mfma_f32_16x16x32_bf16 a[216:219],v[72:75],v[100:103],a[216:219]
v_mfma_f32_16x16x32_bf16 a[220:223],v[76:79],v[100:103],a[220:223]
v_mfma_f32_16x16x32_bf16 a[224:227],v[80:83],v[100:103],a[224:227]
v_mfma_f32_16x16x32_bf16 a[228:231],v[84:87],v[100:103],a[228:231]
v_mfma_f32_16x16x32_bf16 a[232:235],v[88:91],v[100:103],a[232:235]
s_waitcnt vmcnt(10) lgkmcnt(0)
s_barrier
v_mfma_f32_16x16x32_bf16 a[236:239],v[92:95],v[100:103],a[236:239]
s_add_u32 m0,s33,32768
v_mfma_f32_16x16x32_bf16 a[240:243],v[56:59],v[104:107],a[240:243]
buffer_load_dwordx4 v128,s[8:11],s24 offen lds
v_mfma_f32_16x16x32_bf16 a[244:247],v[60:63],v[104:107],a[244:247]
ds_read_b128 v[96:99],v112
v_mfma_f32_16x16x32_bf16 a[248:251],v[64:67],v[104:107],a[248:251]
v_mfma_f32_16x16x32_bf16 a[252:255],v[68:71],v[104:107],a[252:255]
v_mfma_f32_16x16x32_bf16 v[192:195],v[72:75],v[104:107],v[192:195]
v_mfma_f32_16x16x32_bf16 v[196:199],v[76:79],v[104:107],v[196:199]
v_mfma_f32_16x16x32_bf16 v[200:203],v[80:83],v[104:107],v[200:203]
v_mfma_f32_16x16x32_bf16 v[204:207],v[84:87],v[104:107],v[204:207]
v_mfma_f32_16x16x32_bf16 v[208:211],v[88:91],v[104:107],v[208:211]
buffer_load_dwordx4 v129,s[8:11],s24 offen offset:1024 lds
v_mfma_f32_16x16x32_bf16 v[212:215],v[92:95],v[104:107],v[212:215]
v_mfma_f32_16x16x32_bf16 v[216:219],v[56:59],v[108:111],v[216:219]
v_mfma_f32_16x16x32_bf16 v[220:223],v[60:63],v[108:111],v[220:223]
ds_read_b128 v[100:103],v112 offset:2048
v_mfma_f32_16x16x32_bf16 v[224:227],v[64:67],v[108:111],v[224:227]
v_mfma_f32_16x16x32_bf16 v[228:231],v[68:71],v[108:111],v[228:231]
v_mfma_f32_16x16x32_bf16 v[232:235],v[72:75],v[108:111],v[232:235]
v_mfma_f32_16x16x32_bf16 v[236:239],v[76:79],v[108:111],v[236:239]
v_mfma_f32_16x16x32_bf16 v[240:243],v[80:83],v[108:111],v[240:243]
buffer_load_dwordx4 v130,s[8:11],s24 offen offset:2048 lds
v_mfma_f32_16x16x32_bf16 v[244:247],v[84:87],v[108:111],v[244:247]
v_mfma_f32_16x16x32_bf16 v[248:251],v[88:91],v[108:111],v[248:251]
v_mfma_f32_16x16x32_bf16 v[252:255],v[92:95],v[108:111],v[252:255]
s_cmp_eq_u32 s50,5
s_cbranch_scc1 L_lendA
L_pubA:
v_add_f32 v184,v144,v145
v_add_f32 v185,v146,v147
v_add_f32 v186,v148,v149
v_add_f32 v187,v150,v151
v_add_f32 v188,v152,v153
v_add_f32 v189,v154,v155
v_add_f32 v3,v156,v157
v_add_f32 v4,v158,v159
v_add_f32 v5,v160,v161
v_add_f32 v6,v162,v163
v_add_f32 v184,v184,v3
v_add_f32 v185,v185,v4
v_add_f32 v186,v186,v5
v_add_f32 v187,v187,v6
v_lshlrev_b32 v3,5,v2
s_mov_b64 exec,0xffff
buffer_store_dwordx4 v[184:187],v3,s[20:23],s43 offen sc1
buffer_store_dwordx2 v[188:189],v3,s[20:23],s43 offen offset:16 sc1
s_mov_b64 exec,-1
s_add_u32 s50,s50,1
s_mov_b32 s59,5
s_cmp_eq_u32 s50,5
s_cbranch_scc1 L_bxA
s_branch L_loopA
L_lendA:
s_waitcnt lgkmcnt(1)
v_mfma_f32_16x16x32_bf16 a[0:3],v[16:19],v[96:99],a[0:3]
v_min_u32 v169,7,v2
v_lshlrev_b32 v169,2,v169
v_mfma_f32_16x16x32_bf16 a[4:7],v[20:23],v[96:99],a[4:7]
ds_read_b128 v[104:107],v112 offset:4096
buffer_load_dword v168,v169,s[52:55],0 offen sc1
v_mfma_f32_16x16x32_bf16 a[8:11],v[24:27],v[96:99],a[8:11]
s_lshl_b32 s48,s34,7
s_add_u32 s48,s48,0x2701800
v_mfma_f32_16x16x32_bf16 a[12:15],v[28:31],v[96:99],a[12:15]
ds_read_b64_tr_b16 v[56:57],v116 offset:20480
v_lshl_add_u32 v171,v2,2,s48
v_mfma_f32_16x16x32_bf16 a[16:19],v[32:35],v[96:99],a[16:19]
buffer_load_dwordx4 v131,s[8:11],s24 offen offset:3072 lds
v_mfma_f32_16x16x32_bf16 a[20:23],v[36:39],v[96:99],a[20:23]
ds_read_b64_tr_b16 v[58:59],v116 offset:21504
s_lshl_b32 s48,s35,5
v_mfma_f32_16x16x32_bf16 a[24:27],v[40:43],v[96:99],a[24:27]
s_add_u32 s48,s48,0x2701b80
v_min_u32 v170,36,v2
v_mfma_f32_16x16x32_bf16 a[28:31],v[44:47],v[96:99],a[28:31]
ds_read_b64_tr_b16 v[60:61],v117 offset:20480
v_lshl_add_u32 v170,v170,2,s48
v_mfma_f32_16x16x32_bf16 a[32:35],v[48:51],v[96:99],a[32:35]
s_add_u32 m0,s33,36864
v_cmp_gt_u32 s[48:49],32,v2
v_mfma_f32_16x16x32_bf16 a[36:39],v[52:55],v[96:99],a[36:39]
ds_read_b64_tr_b16 v[62:63],v117 offset:21504
s_waitcnt lgkmcnt(5)
v_mfma_f32_16x16x32_bf16 a[40:43],v[16:19],v[100:103],a[40:43]
s_nop 1
v_cndmask_b32 v171,v170,v171,s[48:49]
v_mfma_f32_16x16x32_bf16 a[44:47],v[20:23],v[100:103],a[44:47]
ds_read_b128 v[108:111],v112 offset:6144
v_mfma_f32_16x16x32_bf16 a[48:51],v[24:27],v[100:103],a[48:51]
v_mfma_f32_16x16x32_bf16 a[52:55],v[28:31],v[100:103],a[52:55]
ds_read_b64_tr_b16 v[64:65],v120 offset:24576
v_mfma_f32_16x16x32_bf16 a[56:59],v[32:35],v[100:103],a[56:59]
buffer_load_dwordx4 v128,s[8:11],s32 offen lds
v_mfma_f32_16x16x32_bf16 a[60:63],v[36:39],v[100:103],a[60:63]
ds_read_b64_tr_b16 v[66:67],v120 offset:25600
v_mfma_f32_16x16x32_bf16 a[64:67],v[40:43],v[100:103],a[64:67]
v_mfma_f32_16x16x32_bf16 a[68:71],v[44:47],v[100:103],a[68:71]
ds_read_b64_tr_b16 v[68:69],v121 offset:24576
v_mfma_f32_16x16x32_bf16 a[72:75],v[48:51],v[100:103],a[72:75]
v_mfma_f32_16x16x32_bf16 a[76:79],v[52:55],v[100:103],a[76:79]
ds_read_b64_tr_b16 v[70:71],v121 offset:25600
s_waitcnt lgkmcnt(9)
v_mfma_f32_16x16x32_bf16 a[80:83],v[16:19],v[104:107],a[80:83]
buffer_load_dwordx4 v129,s[8:11],s32 offen offset:1024 lds
v_mfma_f32_16x16x32_bf16 a[84:87],v[20:23],v[104:107],a[84:87]
ds_read_b128 v[96:99],v112 offset:8192
v_mfma_f32_16x16x32_bf16 a[88:91],v[24:27],v[104:107],a[88:91]
buffer_load_dword v139,v138,s[68:71],s73 offen
v_mfma_f32_16x16x32_bf16 a[92:95],v[28:31],v[104:107],a[92:95]
ds_read_b64_tr_b16 v[72:73],v122 offset:24576
v_mfma_f32_16x16x32_bf16 a[96:99],v[32:35],v[104:107],a[96:99]
v_mfma_f32_16x16x32_bf16 a[100:103],v[36:39],v[104:107],a[100:103]
ds_read_b64_tr_b16 v[74:75],v122 offset:25600
v_mfma_f32_16x16x32_bf16 a[104:107],v[40:43],v[104:107],a[104:107]
v_mfma_f32_16x16x32_bf16 a[108:111],v[44:47],v[104:107],a[108:111]
ds_read_b64_tr_b16 v[76:77],v123 offset:24576
v_mfma_f32_16x16x32_bf16 a[112:115],v[48:51],v[104:107],a[112:115]
buffer_load_dwordx4 v130,s[8:11],s32 offen offset:2048 lds
v_mfma_f32_16x16x32_bf16 a[116:119],v[52:55],v[104:107],a[116:119]
ds_read_b64_tr_b16 v[78:79],v123 offset:25600
s_waitcnt lgkmcnt(9)
v_mfma_f32_16x16x32_bf16 a[120:123],v[16:19],v[108:111],a[120:123]
v_mfma_f32_16x16x32_bf16 a[124:127],v[20:23],v[108:111],a[124:127]
ds_read_b128 v[100:103],v112 offset:10240
v_mfma_f32_16x16x32_bf16 a[128:131],v[24:27],v[108:111],a[128:131]
v_mfma_f32_16x16x32_bf16 a[132:135],v[28:31],v[108:111],a[132:135]
ds_read_b64_tr_b16 v[80:81],v120 offset:32768
v_mfma_f32_16x16x32_bf16 a[136:139],v[32:35],v[108:111],a[136:139]
buffer_load_dwordx4 v131,s[8:11],s32 offen offset:3072 lds
v_mfma_f32_16x16x32_bf16 a[140:143],v[36:39],v[108:111],a[140:143]
ds_read_b64_tr_b16 v[82:83],v120 offset:33792
v_mfma_f32_16x16x32_bf16 a[144:147],v[40:43],v[108:111],a[144:147]
v_mfma_f32_16x16x32_bf16 a[148:151],v[44:47],v[108:111],a[148:151]
ds_read_b64_tr_b16 v[84:85],v121 offset:32768
v_mfma_f32_16x16x32_bf16 a[152:155],v[48:51],v[108:111],a[152:155]
s_add_u32 s24,s24,128
v_mfma_f32_16x16x32_bf16 a[156:159],v[52:55],v[108:111],a[156:159]
ds_read_b64_tr_b16 v[86:87],v121 offset:33792
s_waitcnt lgkmcnt(9)
v_mfma_f32_16x16x32_bf16 a[160:163],v[16:19],v[96:99],a[160:163]
s_add_u32 s32,s32,128
v_mfma_f32_16x16x32_bf16 a[164:167],v[20:23],v[96:99],a[164:167]
ds_read_b128 v[104:107],v112 offset:12288
v_mfma_f32_16x16x32_bf16 a[168:171],v[24:27],v[96:99],a[168:171]
s_add_u32 m0,s29,65536
v_mfma_f32_16x16x32_bf16 a[172:175],v[28:31],v[96:99],a[172:175]
ds_read_b64_tr_b16 v[88:89],v122 offset:32768
v_mfma_f32_16x16x32_bf16 a[176:179],v[32:35],v[96:99],a[176:179]
buffer_load_dwordx4 v132,s[12:15],s25 offen lds
v_mfma_f32_16x16x32_bf16 a[180:183],v[36:39],v[96:99],a[180:183]
ds_read_b64_tr_b16 v[90:91],v122 offset:33792
v_mfma_f32_16x16x32_bf16 a[184:187],v[40:43],v[96:99],a[184:187]
v_mfma_f32_16x16x32_bf16 a[188:191],v[44:47],v[96:99],a[188:191]
ds_read_b64_tr_b16 v[92:93],v123 offset:32768
v_mfma_f32_16x16x32_bf16 a[192:195],v[48:51],v[96:99],a[192:195]
v_mfma_f32_16x16x32_bf16 a[196:199],v[52:55],v[96:99],a[196:199]
ds_read_b64_tr_b16 v[94:95],v123 offset:33792
s_waitcnt lgkmcnt(9)
v_mfma_f32_16x16x32_bf16 a[200:203],v[16:19],v[100:103],a[200:203]
buffer_load_dwordx4 v133,s[12:15],s25 offen offset:1024 lds
v_mfma_f32_16x16x32_bf16 a[204:207],v[20:23],v[100:103],a[204:207]
ds_read_b128 v[108:111],v112 offset:14336
v_mfma_f32_16x16x32_bf16 a[208:211],v[24:27],v[100:103],a[208:211]
s_cbranch_vccnz .Lcs13
v_smfmac_f32_16x16x64_bf16 v[144:147],v[164:167],v[16:23],v143
v_smfmac_f32_16x16x64_bf16 v[148:151],v[164:167],v[24:31],v143
v_smfmac_f32_16x16x64_bf16 v[152:155],v[164:167],v[32:39],v143
s_branch .Lce13
.Lcs13:
v_smfmac_f32_16x16x64_bf16 v[156:159],v[164:167],v[40:47],v143
v_smfmac_f32_16x16x64_bf16 v[160:163],v[164:167],v[48:55],v143
.Lce13:
v_mfma_f32_16x16x32_bf16 a[212:215],v[28:31],v[100:103],a[212:215]
v_mfma_f32_16x16x32_bf16 a[216:219],v[32:35],v[100:103],a[216:219]
v_mfma_f32_16x16x32_bf16 a[220:223],v[36:39],v[100:103],a[220:223]
v_mfma_f32_16x16x32_bf16 a[224:227],v[40:43],v[100:103],a[224:227]
buffer_load_dwordx4 v134,s[12:15],s25 offen offset:2048 lds
v_mfma_f32_16x16x32_bf16 a[228:231],v[44:47],v[100:103],a[228:231]
v_mfma_f32_16x16x32_bf16 a[232:235],v[48:51],v[100:103],a[232:235]
s_waitcnt vmcnt(18) lgkmcnt(0)
s_barrier
v_mfma_f32_16x16x32_bf16 a[236:239],v[52:55],v[100:103],a[236:239]
v_mfma_f32_16x16x32_bf16 a[240:243],v[16:19],v[104:107],a[240:243]
v_mfma_f32_16x16x32_bf16 a[244:247],v[20:23],v[104:107],a[244:247]
ds_read_b128 v[96:99],v113
v_mfma_f32_16x16x32_bf16 a[248:251],v[24:27],v[104:107],a[248:251]
v_mfma_f32_16x16x32_bf16 a[252:255],v[28:31],v[104:107],a[252:255]
v_mfma_f32_16x16x32_bf16 v[192:195],v[32:35],v[104:107],v[192:195]
buffer_load_dwordx4 v135,s[12:15],s25 offen offset:3072 lds
v_mfma_f32_16x16x32_bf16 v[196:199],v[36:39],v[104:107],v[196:199]
v_mfma_f32_16x16x32_bf16 v[200:203],v[40:43],v[104:107],v[200:203]
s_add_u32 s25,s25,s27
v_mfma_f32_16x16x32_bf16 v[204:207],v[44:47],v[104:107],v[204:207]
v_mfma_f32_16x16x32_bf16 v[208:211],v[48:51],v[104:107],v[208:211]
s_add_u32 m0,s30,81920
v_mfma_f32_16x16x32_bf16 v[212:215],v[52:55],v[104:107],v[212:215]
v_mfma_f32_16x16x32_bf16 v[216:219],v[16:19],v[108:111],v[216:219]
v_mfma_f32_16x16x32_bf16 v[220:223],v[20:23],v[108:111],v[220:223]
ds_read_b128 v[100:103],v113 offset:2048
v_mfma_f32_16x16x32_bf16 v[224:227],v[24:27],v[108:111],v[224:227]
v_mfma_f32_16x16x32_bf16 v[228:231],v[28:31],v[108:111],v[228:231]
v_mfma_f32_16x16x32_bf16 v[232:235],v[32:35],v[108:111],v[232:235]
buffer_load_dwordx4 v136,s[16:19],s26 offen lds
v_mfma_f32_16x16x32_bf16 v[236:239],v[36:39],v[108:111],v[236:239]
v_mfma_f32_16x16x32_bf16 v[240:243],v[40:43],v[108:111],v[240:243]
v_mfma_f32_16x16x32_bf16 v[244:247],v[44:47],v[108:111],v[244:247]
v_mfma_f32_16x16x32_bf16 v[248:251],v[48:51],v[108:111],v[248:251]
s_add_u32 s26,s26,s28
v_mfma_f32_16x16x32_bf16 v[252:255],v[52:55],v[108:111],v[252:255]
s_waitcnt lgkmcnt(1)
v_mfma_f32_16x16x32_bf16 a[0:3],v[56:59],v[96:99],a[0:3]
v_mfma_f32_16x16x32_bf16 a[4:7],v[60:63],v[96:99],a[4:7]
ds_read_b128 v[104:107],v113 offset:4096
v_mfma_f32_16x16x32_bf16 a[8:11],v[64:67],v[96:99],a[8:11]
v_mfma_f32_16x16x32_bf16 a[12:15],v[68:71],v[96:99],a[12:15]
ds_read_b64_tr_b16 v[16:17],v116 offset:40960
v_mfma_f32_16x16x32_bf16 a[16:19],v[72:75],v[96:99],a[16:19]
s_add_u32 m0,s29,86016
v_mfma_f32_16x16x32_bf16 a[20:23],v[76:79],v[96:99],a[20:23]
ds_read_b64_tr_b16 v[18:19],v116 offset:41984
v_mfma_f32_16x16x32_bf16 a[24:27],v[80:83],v[96:99],a[24:27]
v_mfma_f32_16x16x32_bf16 a[28:31],v[84:87],v[96:99],a[28:31]
ds_read_b64_tr_b16 v[20:21],v117 offset:40960
v_mfma_f32_16x16x32_bf16 a[32:35],v[88:91],v[96:99],a[32:35]
buffer_load_dwordx4 v132,s[12:15],s25 offen lds
v_mfma_f32_16x16x32_bf16 a[36:39],v[92:95],v[96:99],a[36:39]
ds_read_b64_tr_b16 v[22:23],v117 offset:41984
s_waitcnt lgkmcnt(5)
v_mfma_f32_16x16x32_bf16 a[40:43],v[56:59],v[100:103],a[40:43]
v_mfma_f32_16x16x32_bf16 a[44:47],v[60:63],v[100:103],a[44:47]
ds_read_b128 v[108:111],v113 offset:6144
v_mfma_f32_16x16x32_bf16 a[48:51],v[64:67],v[100:103],a[48:51]
v_mfma_f32_16x16x32_bf16 a[52:55],v[68:71],v[100:103],a[52:55]
ds_read_b64_tr_b16 v[24:25],v120 offset:45056
v_mfma_f32_16x16x32_bf16 a[56:59],v[72:75],v[100:103],a[56:59]
v_mfma_f32_16x16x32_bf16 a[60:63],v[76:79],v[100:103],a[60:63]
ds_read_b64_tr_b16 v[26:27],v120 offset:46080
v_mfma_f32_16x16x32_bf16 a[64:67],v[80:83],v[100:103],a[64:67]
v_mfma_f32_16x16x32_bf16 a[68:71],v[84:87],v[100:103],a[68:71]
ds_read_b64_tr_b16 v[28:29],v121 offset:45056
v_mfma_f32_16x16x32_bf16 a[72:75],v[88:91],v[100:103],a[72:75]
buffer_load_dwordx4 v133,s[12:15],s25 offen offset:1024 lds
v_mfma_f32_16x16x32_bf16 a[76:79],v[92:95],v[100:103],a[76:79]
ds_read_b64_tr_b16 v[30:31],v121 offset:46080
s_waitcnt lgkmcnt(9)
v_mfma_f32_16x16x32_bf16 a[80:83],v[56:59],v[104:107],a[80:83]
v_mfma_f32_16x16x32_bf16 a[84:87],v[60:63],v[104:107],a[84:87]
ds_read_b128 v[96:99],v113 offset:8192
v_mfma_f32_16x16x32_bf16 a[88:91],v[64:67],v[104:107],a[88:91]
v_mfma_f32_16x16x32_bf16 a[92:95],v[68:71],v[104:107],a[92:95]
ds_read_b64_tr_b16 v[32:33],v122 offset:45056
v_mfma_f32_16x16x32_bf16 a[96:99],v[72:75],v[104:107],a[96:99]
v_mfma_f32_16x16x32_bf16 a[100:103],v[76:79],v[104:107],a[100:103]
ds_read_b64_tr_b16 v[34:35],v122 offset:46080
v_mfma_f32_16x16x32_bf16 a[104:107],v[80:83],v[104:107],a[104:107]
v_mfma_f32_16x16x32_bf16 a[108:111],v[84:87],v[104:107],a[108:111]
ds_read_b64_tr_b16 v[36:37],v123 offset:45056
v_mfma_f32_16x16x32_bf16 a[112:115],v[88:91],v[104:107],a[112:115]
buffer_load_dwordx4 v134,s[12:15],s25 offen offset:2048 lds
v_mfma_f32_16x16x32_bf16 a[116:119],v[92:95],v[104:107],a[116:119]
ds_read_b64_tr_b16 v[38:39],v123 offset:46080
s_waitcnt lgkmcnt(9)
v_mfma_f32_16x16x32_bf16 a[120:123],v[56:59],v[108:111],a[120:123]
s_waitcnt vmcnt(14)
s_mov_b32 s75,0x40000
L_zA_chk:
v_cmp_le_u32 s[48:49],32,v168
s_sub_u32 s75,s75,1
s_cbranch_scc1 L_zA_ok
s_nop 1
s_cmp_eq_u64 s[48:49],-1
s_cbranch_scc1 L_zA_ok
s_sleep 4
buffer_load_dword v168,v169,s[52:55],0 offen sc1
s_waitcnt vmcnt(0)
s_branch L_zA_chk
L_zA_ok:
buffer_load_dword v168,v171,s[20:23],0 offen sc1
v_mfma_f32_16x16x32_bf16 a[124:127],v[60:63],v[108:111],a[124:127]
ds_read_b128 v[100:103],v113 offset:10240
s_lshl_b32 s44,s31,13
v_mfma_f32_16x16x32_bf16 a[128:131],v[64:67],v[108:111],a[128:131]
s_lshl_b32 s45,s34,10
s_add_u32 s44,s44,s45
v_mfma_f32_16x16x32_bf16 a[132:135],v[68:71],v[108:111],a[132:135]
ds_read_b64_tr_b16 v[40:41],v120 offset:53248
s_add_u32 s44,s44,0x2710000
v_mfma_f32_16x16x32_bf16 a[136:139],v[72:75],v[108:111],a[136:139]
s_lshl_b32 s45,s34,11
s_sub_u32 s45,s43,s45
v_mfma_f32_16x16x32_bf16 a[140:143],v[76:79],v[108:111],a[140:143]
ds_read_b64_tr_b16 v[42:43],v120 offset:54272
v_and_b32 v172,15,v2
v_mfma_f32_16x16x32_bf16 a[144:147],v[80:83],v[108:111],a[144:147]
v_lshrrev_b32 v173,4,v2
v_lshlrev_b32 v174,5,v172
v_mfma_f32_16x16x32_bf16 a[148:151],v[84:87],v[108:111],a[148:151]
ds_read_b64_tr_b16 v[44:45],v121 offset:53248
v_lshl_add_u32 v174,v173,3,v174
v_mfma_f32_16x16x32_bf16 a[152:155],v[88:91],v[108:111],a[152:155]
buffer_load_dwordx4 v135,s[12:15],s25 offen offset:3072 lds
v_mfma_f32_16x16x32_bf16 a[156:159],v[92:95],v[108:111],a[156:159]
ds_read_b64_tr_b16 v[46:47],v121 offset:54272
s_waitcnt lgkmcnt(9)
v_mfma_f32_16x16x32_bf16 a[160:163],v[56:59],v[96:99],a[160:163]
s_add_u32 s25,s25,s27
s_mul_i32 s46,s31,768
v_mfma_f32_16x16x32_bf16 a[164:167],v[60:63],v[96:99],a[164:167]
ds_read_b128 v[104:107],v113 offset:12288
s_add_u32 s46,s46,150528
v_mfma_f32_16x16x32_bf16 a[168:171],v[64:67],v[96:99],a[168:171]
v_lshl_add_u32 v172,v172,2,s46
v_lshl_add_u32 v173,v173,7,v172
v_mfma_f32_16x16x32_bf16 a[172:175],v[68:71],v[96:99],a[172:175]
ds_read_b64_tr_b16 v[48:49],v122 offset:53248
v_mfma_f32_16x16x32_bf16 a[176:179],v[72:75],v[96:99],a[176:179]
s_add_u32 m0,s30,102400
v_mfma_f32_16x16x32_bf16 a[180:183],v[76:79],v[96:99],a[180:183]
ds_read_b64_tr_b16 v[50:51],v122 offset:54272
v_mfma_f32_16x16x32_bf16 a[184:187],v[80:83],v[96:99],a[184:187]
v_mfma_f32_16x16x32_bf16 a[188:191],v[84:87],v[96:99],a[188:191]
ds_read_b64_tr_b16 v[52:53],v123 offset:53248
v_mfma_f32_16x16x32_bf16 a[192:195],v[88:91],v[96:99],a[192:195]
buffer_load_dwordx4 v136,s[16:19],s26 offen lds
v_mfma_f32_16x16x32_bf16 a[196:199],v[92:95],v[96:99],a[196:199]
ds_read_b64_tr_b16 v[54:55],v123 offset:54272
s_waitcnt lgkmcnt(9)
v_mfma_f32_16x16x32_bf16 a[200:203],v[56:59],v[100:103],a[200:203]
s_add_u32 s26,s26,s28
v_mfma_f32_16x16x32_bf16 a[204:207],v[60:63],v[100:103],a[204:207]
ds_read_b128 v[108:111],v113 offset:14336
v_mfma_f32_16x16x32_bf16 a[208:211],v[64:67],v[100:103],a[208:211]
s_cbranch_vccnz .Lcs14
v_smfmac_f32_16x16x64_bf16 v[144:147],v[164:167],v[56:63],v143
v_smfmac_f32_16x16x64_bf16 v[148:151],v[164:167],v[64:71],v143
v_smfmac_f32_16x16x64_bf16 v[152:155],v[164:167],v[72:79],v143
s_branch .Lce14
.Lcs14:
v_smfmac_f32_16x16x64_bf16 v[156:159],v[164:167],v[80:87],v143
v_smfmac_f32_16x16x64_bf16 v[160:163],v[164:167],v[88:95],v143
.Lce14:
v_mfma_f32_16x16x32_bf16 a[212:215],v[68:71],v[100:103],a[212:215]
v_mfma_f32_16x16x32_bf16 a[216:219],v[72:75],v[100:103],a[216:219]
v_mfma_f32_16x16x32_bf16 a[220:223],v[76:79],v[100:103],a[220:223]
v_mfma_f32_16x16x32_bf16 a[224:227],v[80:83],v[100:103],a[224:227]
v_mfma_f32_16x16x32_bf16 a[228:231],v[84:87],v[100:103],a[228:231]
v_mfma_f32_16x16x32_bf16 a[232:235],v[88:91],v[100:103],a[232:235]
s_waitcnt vmcnt(11) lgkmcnt(0)
s_barrier
v_mfma_f32_16x16x32_bf16 a[236:239],v[92:95],v[100:103],a[236:239]
s_add_u32 m0,s33,0
v_mfma_f32_16x16x32_bf16 a[240:243],v[56:59],v[104:107],a[240:243]
buffer_load_dwordx4 v128,s[8:11],s24 offen lds
v_mfma_f32_16x16x32_bf16 a[244:247],v[60:63],v[104:107],a[244:247]
ds_read_b128 v[96:99],v114
v_mfma_f32_16x16x32_bf16 a[248:251],v[64:67],v[104:107],a[248:251]
v_mfma_f32_16x16x32_bf16 a[252:255],v[68:71],v[104:107],a[252:255]
v_mfma_f32_16x16x32_bf16 v[192:195],v[72:75],v[104:107],v[192:195]
v_mfma_f32_16x16x32_bf16 v[196:199],v[76:79],v[104:107],v[196:199]
v_mfma_f32_16x16x32_bf16 v[200:203],v[80:83],v[104:107],v[200:203]
v_mfma_f32_16x16x32_bf16 v[204:207],v[84:87],v[104:107],v[204:207]
v_mfma_f32_16x16x32_bf16 v[208:211],v[88:91],v[104:107],v[208:211]
buffer_load_dwordx4 v129,s[8:11],s24 offen offset:1024 lds
v_mfma_f32_16x16x32_bf16 v[212:215],v[92:95],v[104:107],v[212:215]
v_mfma_f32_16x16x32_bf16 v[216:219],v[56:59],v[108:111],v[216:219]
v_mfma_f32_16x16x32_bf16 v[220:223],v[60:63],v[108:111],v[220:223]
ds_read_b128 v[100:103],v114 offset:2048
v_mfma_f32_16x16x32_bf16 v[224:227],v[64:67],v[108:111],v[224:227]
v_mfma_f32_16x16x32_bf16 v[228:231],v[68:71],v[108:111],v[228:231]
v_mfma_f32_16x16x32_bf16 v[232:235],v[72:75],v[108:111],v[232:235]
v_mfma_f32_16x16x32_bf16 v[236:239],v[76:79],v[108:111],v[236:239]
v_mfma_f32_16x16x32_bf16 v[240:243],v[80:83],v[108:111],v[240:243]
buffer_load_dwordx4 v130,s[8:11],s24 offen offset:2048 lds
v_mfma_f32_16x16x32_bf16 v[244:247],v[84:87],v[108:111],v[244:247]
v_mfma_f32_16x16x32_bf16 v[248:251],v[88:91],v[108:111],v[248:251]
v_mfma_f32_16x16x32_bf16 v[252:255],v[92:95],v[108:111],v[252:255]
s_waitcnt lgkmcnt(1)
v_mfma_f32_16x16x32_bf16 a[0:3],v[16:19],v[96:99],a[0:3]
v_mfma_f32_16x16x32_bf16 a[4:7],v[20:23],v[96:99],a[4:7]
ds_read_b128 v[104:107],v114 offset:4096
v_mfma_f32_16x16x32_bf16 a[8:11],v[24:27],v[96:99],a[8:11]
s_getpc_b64 s[60:61]
.Lct2:
s_add_u32 s60,s60,L_epiA-.Lct2
s_addc_u32 s61,s61,0
v_mfma_f32_16x16x32_bf16 a[12:15],v[28:31],v[96:99],a[12:15]
ds_read_b64_tr_b16 v[56:57],v118
v_mfma_f32_16x16x32_bf16 a[16:19],v[32:35],v[96:99],a[16:19]
buffer_load_dwordx4 v131,s[8:11],s24 offen offset:3072 lds
v_mfma_f32_16x16x32_bf16 a[20:23],v[36:39],v[96:99],a[20:23]
ds_read_b64_tr_b16 v[58:59],v118 offset:1024
v_mfma_f32_16x16x32_bf16 a[24:27],v[40:43],v[96:99],a[24:27]
s_lshr_b32 s62,s2,3
v_mfma_f32_16x16x32_bf16 a[28:31],v[44:47],v[96:99],a[28:31]
ds_read_b64_tr_b16 v[60:61],v119
v_mfma_f32_16x16x32_bf16 a[32:35],v[48:51],v[96:99],a[32:35]
s_add_u32 m0,s33,4096
v_mfma_f32_16x16x32_bf16 a[36:39],v[52:55],v[96:99],a[36:39]
ds_read_b64_tr_b16 v[62:63],v119 offset:1024
s_waitcnt lgkmcnt(5)
v_mfma_f32_16x16x32_bf16 a[40:43],v[16:19],v[100:103],a[40:43]
v_mfma_f32_16x16x32_bf16 a[44:47],v[20:23],v[100:103],a[44:47]
ds_read_b128 v[108:111],v114 offset:6144
v_mfma_f32_16x16x32_bf16 a[48:51],v[24:27],v[100:103],a[48:51]
s_lshl_b32 s62,s62,2
v_mfma_f32_16x16x32_bf16 a[52:55],v[28:31],v[100:103],a[52:55]
ds_read_b64_tr_b16 v[64:65],v124 offset:4096
v_mfma_f32_16x16x32_bf16 a[56:59],v[32:35],v[100:103],a[56:59]
buffer_load_dwordx4 v128,s[8:11],s32 offen lds
v_mfma_f32_16x16x32_bf16 a[60:63],v[36:39],v[100:103],a[60:63]
ds_read_b64_tr_b16 v[66:67],v124 offset:5120
v_mfma_f32_16x16x32_bf16 a[64:67],v[40:43],v[100:103],a[64:67]
s_add_u32 s62,s62,s31
v_mfma_f32_16x16x32_bf16 a[68:71],v[44:47],v[100:103],a[68:71]
ds_read_b64_tr_b16 v[68:69],v125 offset:4096
v_mfma_f32_16x16x32_bf16 a[72:75],v[48:51],v[100:103],a[72:75]
v_mfma_f32_16x16x32_bf16 a[76:79],v[52:55],v[100:103],a[76:79]
ds_read_b64_tr_b16 v[70:71],v125 offset:5120
s_waitcnt lgkmcnt(9)
v_mfma_f32_16x16x32_bf16 a[80:83],v[16:19],v[104:107],a[80:83]
buffer_load_dwordx4 v129,s[8:11],s32 offen offset:1024 lds
v_mfma_f32_16x16x32_bf16 a[84:87],v[20:23],v[104:107],a[84:87]
ds_read_b128 v[96:99],v114 offset:8192
v_mfma_f32_16x16x32_bf16 a[88:91],v[24:27],v[104:107],a[88:91]
s_and_b32 s62,s62,15
v_mfma_f32_16x16x32_bf16 a[92:95],v[28:31],v[104:107],a[92:95]
ds_read_b64_tr_b16 v[72:73],v126 offset:4096
v_mfma_f32_16x16x32_bf16 a[96:99],v[32:35],v[104:107],a[96:99]
v_mfma_f32_16x16x32_bf16 a[100:103],v[36:39],v[104:107],a[100:103]
ds_read_b64_tr_b16 v[74:75],v126 offset:5120
v_mfma_f32_16x16x32_bf16 a[104:107],v[40:43],v[104:107],a[104:107]
s_lshl_b32 s62,s62,7
v_mfma_f32_16x16x32_bf16 a[108:111],v[44:47],v[104:107],a[108:111]
ds_read_b64_tr_b16 v[76:77],v127 offset:4096
v_mfma_f32_16x16x32_bf16 a[112:115],v[48:51],v[104:107],a[112:115]
buffer_load_dwordx4 v130,s[8:11],s32 offen offset:2048 lds
v_mfma_f32_16x16x32_bf16 a[116:119],v[52:55],v[104:107],a[116:119]
ds_read_b64_tr_b16 v[78:79],v127 offset:5120
s_waitcnt lgkmcnt(9)
v_mfma_f32_16x16x32_bf16 a[120:123],v[16:19],v[108:111],a[120:123]
v_mfma_f32_16x16x32_bf16 a[124:127],v[20:23],v[108:111],a[124:127]
ds_read_b128 v[100:103],v114 offset:10240
v_mfma_f32_16x16x32_bf16 a[128:131],v[24:27],v[108:111],a[128:131]
v_lshlrev_b32 v140,11,v2
v_mfma_f32_16x16x32_bf16 a[132:135],v[28:31],v[108:111],a[132:135]
ds_read_b64_tr_b16 v[80:81],v124 offset:12288
v_mfma_f32_16x16x32_bf16 a[136:139],v[32:35],v[108:111],a[136:139]
buffer_load_dwordx4 v131,s[8:11],s32 offen offset:3072 lds
v_mfma_f32_16x16x32_bf16 a[140:143],v[36:39],v[108:111],a[140:143]
ds_read_b64_tr_b16 v[82:83],v124 offset:13312
v_mfma_f32_16x16x32_bf16 a[144:147],v[40:43],v[108:111],a[144:147]
v_add_u32 v140,s62,v140
v_mfma_f32_16x16x32_bf16 a[148:151],v[44:47],v[108:111],a[148:151]
ds_read_b64_tr_b16 v[84:85],v125 offset:12288
v_mfma_f32_16x16x32_bf16 a[152:155],v[48:51],v[108:111],a[152:155]
s_add_u32 s24,s24,128
v_mfma_f32_16x16x32_bf16 a[156:159],v[52:55],v[108:111],a[156:159]
ds_read_b64_tr_b16 v[86:87],v125 offset:13312
s_waitcnt lgkmcnt(9)
v_mfma_f32_16x16x32_bf16 a[160:163],v[16:19],v[96:99],a[160:163]
s_add_u32 s32,s32,128
v_mfma_f32_16x16x32_bf16 a[164:167],v[20:23],v[96:99],a[164:167]
ds_read_b128 v[104:107],v114 offset:12288
v_mfma_f32_16x16x32_bf16 a[168:171],v[24:27],v[96:99],a[168:171]
s_add_u32 m0,s29,106496
v_mfma_f32_16x16x32_bf16 a[172:175],v[28:31],v[96:99],a[172:175]
ds_read_b64_tr_b16 v[88:89],v126 offset:12288
v_mfma_f32_16x16x32_bf16 a[176:179],v[32:35],v[96:99],a[176:179]
buffer_load_dwordx4 v132,s[12:15],s25 offen lds
v_mfma_f32_16x16x32_bf16 a[180:183],v[36:39],v[96:99],a[180:183]
ds_read_b64_tr_b16 v[90:91],v126 offset:13312
v_mfma_f32_16x16x32_bf16 a[184:187],v[40:43],v[96:99],a[184:187]
v_min_u32 v140,L_atfin-L_epiA-4,v140
v_mfma_f32_16x16x32_bf16 a[188:191],v[44:47],v[96:99],a[188:191]
ds_read_b64_tr_b16 v[92:93],v127 offset:12288
v_mfma_f32_16x16x32_bf16 a[192:195],v[48:51],v[96:99],a[192:195]
v_mfma_f32_16x16x32_bf16 a[196:199],v[52:55],v[96:99],a[196:199]
ds_read_b64_tr_b16 v[94:95],v127 offset:13312
s_waitcnt lgkmcnt(9)
v_mfma_f32_16x16x32_bf16 a[200:203],v[16:19],v[100:103],a[200:203]
buffer_load_dwordx4 v133,s[12:15],s25 offen offset:1024 lds
v_mfma_f32_16x16x32_bf16 a[204:207],v[20:23],v[100:103],a[204:207]
ds_read_b128 v[108:111],v114 offset:14336
v_mfma_f32_16x16x32_bf16 a[208:211],v[24:27],v[100:103],a[208:211]
s_cbranch_vccnz .Lcs15
v_smfmac_f32_16x16x64_bf16 v[144:147],v[164:167],v[16:23],v143
v_smfmac_f32_16x16x64_bf16 v[148:151],v[164:167],v[24:31],v143
v_smfmac_f32_16x16x64_bf16 v[152:155],v[164:167],v[32:39],v143
s_branch .Lce15
.Lcs15:
v_smfmac_f32_16x16x64_bf16 v[156:159],v[164:167],v[40:47],v143
v_smfmac_f32_16x16x64_bf16 v[160:163],v[164:167],v[48:55],v143
.Lce15:
v_mfma_f32_16x16x32_bf16 a[212:215],v[28:31],v[100:103],a[212:215]
v_mfma_f32_16x16x32_bf16 a[216:219],v[32:35],v[100:103],a[216:219]
v_mfma_f32_16x16x32_bf16 a[220:223],v[36:39],v[100:103],a[220:223]
v_mfma_f32_16x16x32_bf16 a[224:227],v[40:43],v[100:103],a[224:227]
buffer_load_dwordx4 v134,s[12:15],s25 offen offset:2048 lds
v_mfma_f32_16x16x32_bf16 a[228:231],v[44:47],v[100:103],a[228:231]
v_mfma_f32_16x16x32_bf16 a[232:235],v[48:51],v[100:103],a[232:235]
s_waitcnt vmcnt(17) lgkmcnt(0)
s_barrier
v_mfma_f32_16x16x32_bf16 a[236:239],v[52:55],v[100:103],a[236:239]
v_mfma_f32_16x16x32_bf16 a[240:243],v[16:19],v[104:107],a[240:243]
v_mfma_f32_16x16x32_bf16 a[244:247],v[20:23],v[104:107],a[244:247]
ds_read_b128 v[96:99],v115
v_mfma_f32_16x16x32_bf16 a[248:251],v[24:27],v[104:107],a[248:251]
global_load_dword v139,v140,s[60:61]
v_mfma_f32_16x16x32_bf16 a[252:255],v[28:31],v[104:107],a[252:255]
v_mfma_f32_16x16x32_bf16 v[192:195],v[32:35],v[104:107],v[192:195]
buffer_load_dwordx4 v135,s[12:15],s25 offen offset:3072 lds
v_mfma_f32_16x16x32_bf16 v[196:199],v[36:39],v[104:107],v[196:199]
v_mfma_f32_16x16x32_bf16 v[200:203],v[40:43],v[104:107],v[200:203]
s_add_u32 s25,s25,s27
v_mfma_f32_16x16x32_bf16 v[204:207],v[44:47],v[104:107],v[204:207]
v_mfma_f32_16x16x32_bf16 v[208:211],v[48:51],v[104:107],v[208:211]
s_add_u32 m0,s30,122880
v_mfma_f32_16x16x32_bf16 v[212:215],v[52:55],v[104:107],v[212:215]
v_mfma_f32_16x16x32_bf16 v[216:219],v[16:19],v[108:111],v[216:219]
v_mfma_f32_16x16x32_bf16 v[220:223],v[20:23],v[108:111],v[220:223]
ds_read_b128 v[100:103],v115 offset:2048
v_mfma_f32_16x16x32_bf16 v[224:227],v[24:27],v[108:111],v[224:227]
v_mfma_f32_16x16x32_bf16 v[228:231],v[28:31],v[108:111],v[228:231]
v_mfma_f32_16x16x32_bf16 v[232:235],v[32:35],v[108:111],v[232:235]
buffer_load_dwordx4 v136,s[16:19],s26 offen lds
v_mfma_f32_16x16x32_bf16 v[236:239],v[36:39],v[108:111],v[236:239]
v_mfma_f32_16x16x32_bf16 v[240:243],v[40:43],v[108:111],v[240:243]
v_mfma_f32_16x16x32_bf16 v[244:247],v[44:47],v[108:111],v[244:247]
v_mfma_f32_16x16x32_bf16 v[248:251],v[48:51],v[108:111],v[248:251]
s_add_u32 s26,s26,s28
v_mfma_f32_16x16x32_bf16 v[252:255],v[52:55],v[108:111],v[252:255]
s_waitcnt lgkmcnt(1)
v_mfma_f32_16x16x32_bf16 a[0:3],v[56:59],v[96:99],a[0:3]
v_mfma_f32_16x16x32_bf16 a[4:7],v[60:63],v[96:99],a[4:7]
ds_read_b128 v[104:107],v115 offset:4096
v_mfma_f32_16x16x32_bf16 a[8:11],v[64:67],v[96:99],a[8:11]
s_waitcnt vmcnt(16)
s_mov_b32 s75,0x40000
L_fA_chk:
v_cmp_eq_u32 s[48:49],1,v168
s_sub_u32 s75,s75,1
s_cbranch_scc1 L_fA_ok
s_nop 1
s_cmp_eq_u64 s[48:49],-1
s_cbranch_scc1 L_fA_ok
s_sleep 4
buffer_load_dword v168,v171,s[20:23],0 offen sc1
s_waitcnt vmcnt(0)
s_branch L_fA_chk
L_fA_ok:
s_add_u32 m0,s30,155648
s_nop 0
buffer_load_dwordx4 v9,s[20:23],s44 offen sc1 lds
v_mfma_f32_16x16x32_bf16 a[12:15],v[68:71],v[96:99],a[12:15]
ds_read_b64_tr_b16 v[16:17],v116
v_mfma_f32_16x16x32_bf16 a[16:19],v[72:75],v[96:99],a[16:19]
s_add_u32 m0,s29,126976
v_mfma_f32_16x16x32_bf16 a[20:23],v[76:79],v[96:99],a[20:23]
ds_read_b64_tr_b16 v[18:19],v116 offset:1024
v_mfma_f32_16x16x32_bf16 a[24:27],v[80:83],v[96:99],a[24:27]
v_mfma_f32_16x16x32_bf16 a[28:31],v[84:87],v[96:99],a[28:31]
ds_read_b64_tr_b16 v[20:21],v117
v_mfma_f32_16x16x32_bf16 a[32:35],v[88:91],v[96:99],a[32:35]
buffer_load_dwordx4 v132,s[12:15],s25 offen lds
v_mfma_f32_16x16x32_bf16 a[36:39],v[92:95],v[96:99],a[36:39]
ds_read_b64_tr_b16 v[22:23],v117 offset:1024
s_waitcnt lgkmcnt(5)
v_mfma_f32_16x16x32_bf16 a[40:43],v[56:59],v[100:103],a[40:43]
s_cmp_eq_u32 s34,0
s_cselect_b32 s46,0x80000000,s45
buffer_load_dwordx2 v[176:177],v174,s[20:23],s46 offen sc1
v_mfma_f32_16x16x32_bf16 a[44:47],v[60:63],v[100:103],a[44:47]
ds_read_b128 v[108:111],v115 offset:6144
s_add_u32 s45,s45,2048
v_mfma_f32_16x16x32_bf16 a[48:51],v[64:67],v[100:103],a[48:51]
s_cmp_eq_u32 s34,1
s_cselect_b32 s46,0x80000000,s45
buffer_load_dwordx2 v[178:179],v174,s[20:23],s46 offen sc1
v_mfma_f32_16x16x32_bf16 a[52:55],v[68:71],v[100:103],a[52:55]
ds_read_b64_tr_b16 v[24:25],v120 offset:4096
s_add_u32 s45,s45,2048
v_mfma_f32_16x16x32_bf16 a[56:59],v[72:75],v[100:103],a[56:59]
s_cmp_eq_u32 s34,2
s_cselect_b32 s46,0x80000000,s45
buffer_load_dwordx2 v[180:181],v174,s[20:23],s46 offen sc1
v_mfma_f32_16x16x32_bf16 a[60:63],v[76:79],v[100:103],a[60:63]
ds_read_b64_tr_b16 v[26:27],v120 offset:5120
s_add_u32 s45,s45,2048
v_mfma_f32_16x16x32_bf16 a[64:67],v[80:83],v[100:103],a[64:67]
s_cmp_eq_u32 s34,3
s_cselect_b32 s46,0x80000000,s45
buffer_load_dwordx2 v[182:183],v174,s[20:23],s46 offen sc1
v_mfma_f32_16x16x32_bf16 a[68:71],v[84:87],v[100:103],a[68:71]
ds_read_b64_tr_b16 v[28:29],v121 offset:4096
s_add_u32 s45,s45,2048
v_mfma_f32_16x16x32_bf16 a[72:75],v[88:91],v[100:103],a[72:75]
buffer_load_dwordx4 v133,s[12:15],s25 offen offset:1024 lds
v_mfma_f32_16x16x32_bf16 a[76:79],v[92:95],v[100:103],a[76:79]
ds_read_b64_tr_b16 v[30:31],v121 offset:5120
s_waitcnt lgkmcnt(9)
v_mfma_f32_16x16x32_bf16 a[80:83],v[56:59],v[104:107],a[80:83]
s_cmp_eq_u32 s34,4
s_cselect_b32 s46,0x80000000,s45
buffer_load_dwordx2 v[184:185],v174,s[20:23],s46 offen sc1
v_mfma_f32_16x16x32_bf16 a[84:87],v[60:63],v[104:107],a[84:87]
ds_read_b128 v[96:99],v115 offset:8192
s_add_u32 s45,s45,2048
v_mfma_f32_16x16x32_bf16 a[88:91],v[64:67],v[104:107],a[88:91]
v_mfma_f32_16x16x32_bf16 a[92:95],v[68:71],v[104:107],a[92:95]
ds_read_b64_tr_b16 v[32:33],v122 offset:4096
v_mfma_f32_16x16x32_bf16 a[96:99],v[72:75],v[104:107],a[96:99]
v_mfma_f32_16x16x32_bf16 a[100:103],v[76:79],v[104:107],a[100:103]
ds_read_b64_tr_b16 v[34:35],v122 offset:5120
v_mfma_f32_16x16x32_bf16 a[104:107],v[80:83],v[104:107],a[104:107]
v_mfma_f32_16x16x32_bf16 a[108:111],v[84:87],v[104:107],a[108:111]
ds_read_b64_tr_b16 v[36:37],v123 offset:4096
v_mfma_f32_16x16x32_bf16 a[112:115],v[88:91],v[104:107],a[112:115]
buffer_load_dwordx4 v134,s[12:15],s25 offen offset:2048 lds
v_mfma_f32_16x16x32_bf16 a[116:119],v[92:95],v[104:107],a[116:119]
ds_read_b64_tr_b16 v[38:39],v123 offset:5120
s_waitcnt lgkmcnt(9)
v_mfma_f32_16x16x32_bf16 a[120:123],v[56:59],v[108:111],a[120:123]
v_mfma_f32_16x16x32_bf16 a[124:127],v[60:63],v[108:111],a[124:127]
ds_read_b128 v[100:103],v115 offset:10240
v_mfma_f32_16x16x32_bf16 a[128:131],v[64:67],v[108:111],a[128:131]
v_mfma_f32_16x16x32_bf16 a[132:135],v[68:71],v[108:111],a[132:135]
ds_read_b64_tr_b16 v[40:41],v120 offset:12288
v_mfma_f32_16x16x32_bf16 a[136:139],v[72:75],v[108:111],a[136:139]
v_mfma_f32_16x16x32_bf16 a[140:143],v[76:79],v[108:111],a[140:143]
ds_read_b64_tr_b16 v[42:43],v120 offset:13312
v_mfma_f32_16x16x32_bf16 a[144:147],v[80:83],v[108:111],a[144:147]
v_mfma_f32_16x16x32_bf16 a[148:151],v[84:87],v[108:111],a[148:151]
ds_read_b64_tr_b16 v[44:45],v121 offset:12288
v_mfma_f32_16x16x32_bf16 a[152:155],v[88:91],v[108:111],a[152:155]
buffer_load_dwordx4 v135,s[12:15],s25 offen offset:3072 lds
v_mfma_f32_16x16x32_bf16 a[156:159],v[92:95],v[108:111],a[156:159]
ds_read_b64_tr_b16 v[46:47],v121 offset:13312
s_waitcnt lgkmcnt(9)
v_mfma_f32_16x16x32_bf16 a[160:163],v[56:59],v[96:99],a[160:163]
s_add_u32 s25,s25,s27
v_mfma_f32_16x16x32_bf16 a[164:167],v[60:63],v[96:99],a[164:167]
ds_read_b128 v[104:107],v115 offset:12288
v_mfma_f32_16x16x32_bf16 a[168:171],v[64:67],v[96:99],a[168:171]
v_mfma_f32_16x16x32_bf16 a[172:175],v[68:71],v[96:99],a[172:175]
ds_read_b64_tr_b16 v[48:49],v122 offset:12288
v_mfma_f32_16x16x32_bf16 a[176:179],v[72:75],v[96:99],a[176:179]
s_add_u32 m0,s30,143360
v_mfma_f32_16x16x32_bf16 a[180:183],v[76:79],v[96:99],a[180:183]
ds_read_b64_tr_b16 v[50:51],v122 offset:13312
v_mfma_f32_16x16x32_bf16 a[184:187],v[80:83],v[96:99],a[184:187]
v_mfma_f32_16x16x32_bf16 a[188:191],v[84:87],v[96:99],a[188:191]
ds_read_b64_tr_b16 v[52:53],v123 offset:12288
v_mfma_f32_16x16x32_bf16 a[192:195],v[88:91],v[96:99],a[192:195]
buffer_load_dwordx4 v136,s[16:19],s26 offen lds
v_mfma_f32_16x16x32_bf16 a[196:199],v[92:95],v[96:99],a[196:199]
ds_read_b64_tr_b16 v[54:55],v123 offset:13312
s_waitcnt lgkmcnt(9)
v_mfma_f32_16x16x32_bf16 a[200:203],v[56:59],v[100:103],a[200:203]
s_add_u32 s26,s26,s28
v_mfma_f32_16x16x32_bf16 a[204:207],v[60:63],v[100:103],a[204:207]
ds_read_b128 v[108:111],v115 offset:14336
v_mfma_f32_16x16x32_bf16 a[208:211],v[64:67],v[100:103],a[208:211]
s_cbranch_vccnz .Lcs16
v_smfmac_f32_16x16x64_bf16 v[144:147],v[164:167],v[56:63],v143
v_smfmac_f32_16x16x64_bf16 v[148:151],v[164:167],v[64:71],v143
v_smfmac_f32_16x16x64_bf16 v[152:155],v[164:167],v[72:79],v143
s_branch .Lce16
.Lcs16:
v_smfmac_f32_16x16x64_bf16 v[156:159],v[164:167],v[80:87],v143
v_smfmac_f32_16x16x64_bf16 v[160:163],v[164:167],v[88:95],v143
.Lce16:
v_mfma_f32_16x16x32_bf16 a[212:215],v[68:71],v[100:103],a[212:215]
v_mfma_f32_16x16x32_bf16 a[216:219],v[72:75],v[100:103],a[216:219]
v_mfma_f32_16x16x32_bf16 a[220:223],v[76:79],v[100:103],a[220:223]
v_mfma_f32_16x16x32_bf16 a[224:227],v[80:83],v[100:103],a[224:227]
v_mfma_f32_16x16x32_bf16 a[228:231],v[84:87],v[100:103],a[228:231]
v_mfma_f32_16x16x32_bf16 a[232:235],v[88:91],v[100:103],a[232:235]
s_waitcnt vmcnt(17) lgkmcnt(0)
s_barrier
v_mfma_f32_16x16x32_bf16 a[236:239],v[92:95],v[100:103],a[236:239]
s_add_u32 m0,s33,32768
v_mfma_f32_16x16x32_bf16 a[240:243],v[56:59],v[104:107],a[240:243]
buffer_load_dwordx4 v128,s[8:11],s24 offen lds
v_mfma_f32_16x16x32_bf16 a[244:247],v[60:63],v[104:107],a[244:247]
ds_read_b128 v[96:99],v112
v_mfma_f32_16x16x32_bf16 a[248:251],v[64:67],v[104:107],a[248:251]
v_mfma_f32_16x16x32_bf16 a[252:255],v[68:71],v[104:107],a[252:255]
v_mfma_f32_16x16x32_bf16 v[192:195],v[72:75],v[104:107],v[192:195]
v_mfma_f32_16x16x32_bf16 v[196:199],v[76:79],v[104:107],v[196:199]
v_mfma_f32_16x16x32_bf16 v[200:203],v[80:83],v[104:107],v[200:203]
v_mfma_f32_16x16x32_bf16 v[204:207],v[84:87],v[104:107],v[204:207]
v_mfma_f32_16x16x32_bf16 v[208:211],v[88:91],v[104:107],v[208:211]
buffer_load_dwordx4 v129,s[8:11],s24 offen offset:1024 lds
v_mfma_f32_16x16x32_bf16 v[212:215],v[92:95],v[104:107],v[212:215]
v_mfma_f32_16x16x32_bf16 v[216:219],v[56:59],v[108:111],v[216:219]
v_mfma_f32_16x16x32_bf16 v[220:223],v[60:63],v[108:111],v[220:223]
ds_read_b128 v[100:103],v112 offset:2048
v_mfma_f32_16x16x32_bf16 v[224:227],v[64:67],v[108:111],v[224:227]
v_mfma_f32_16x16x32_bf16 v[228:231],v[68:71],v[108:111],v[228:231]
v_mfma_f32_16x16x32_bf16 v[232:235],v[72:75],v[108:111],v[232:235]
v_mfma_f32_16x16x32_bf16 v[236:239],v[76:79],v[108:111],v[236:239]
v_mfma_f32_16x16x32_bf16 v[240:243],v[80:83],v[108:111],v[240:243]
buffer_load_dwordx4 v130,s[8:11],s24 offen offset:2048 lds
v_mfma_f32_16x16x32_bf16 v[244:247],v[84:87],v[108:111],v[244:247]
v_mfma_f32_16x16x32_bf16 v[248:251],v[88:91],v[108:111],v[248:251]
v_mfma_f32_16x16x32_bf16 v[252:255],v[92:95],v[108:111],v[252:255]
s_waitcnt lgkmcnt(1)
v_mfma_f32_16x16x32_bf16 a[0:3],v[16:19],v[96:99],a[0:3]
buffer_load_dwordx4 v131,s[8:11],s24 offen offset:3072 lds
v_mfma_f32_16x16x32_bf16 a[4:7],v[20:23],v[96:99],a[4:7]
ds_read_b128 v[104:107],v112 offset:4096
v_mfma_f32_16x16x32_bf16 a[8:11],v[24:27],v[96:99],a[8:11]
s_add_u32 m0,s33,36864
v_mfma_f32_16x16x32_bf16 a[12:15],v[28:31],v[96:99],a[12:15]
ds_read_b64_tr_b16 v[56:57],v116 offset:20480
v_mfma_f32_16x16x32_bf16 a[16:19],v[32:35],v[96:99],a[16:19]
v_mfma_f32_16x16x32_bf16 a[20:23],v[36:39],v[96:99],a[20:23]
ds_read_b64_tr_b16 v[58:59],v116 offset:21504
v_mfma_f32_16x16x32_bf16 a[24:27],v[40:43],v[96:99],a[24:27]
buffer_load_dwordx4 v128,s[8:11],s32 offen lds
v_mfma_f32_16x16x32_bf16 a[28:31],v[44:47],v[96:99],a[28:31]
ds_read_b64_tr_b16 v[60:61],v117 offset:20480
v_mfma_f32_16x16x32_bf16 a[32:35],v[48:51],v[96:99],a[32:35]
v_mfma_f32_16x16x32_bf16 a[36:39],v[52:55],v[96:99],a[36:39]
ds_read_b64_tr_b16 v[62:63],v117 offset:21504
s_waitcnt lgkmcnt(5)
v_mfma_f32_16x16x32_bf16 a[40:43],v[16:19],v[100:103],a[40:43]
buffer_load_dwordx4 v129,s[8:11],s32 offen offset:1024 lds
v_mfma_f32_16x16x32_bf16 a[44:47],v[20:23],v[100:103],a[44:47]
ds_read_b128 v[108:111],v112 offset:6144
v_mfma_f32_16x16x32_bf16 a[48:51],v[24:27],v[100:103],a[48:51]
s_waitcnt vmcnt(9)
v_add_f32 v176,v176,v178
v_mfma_f32_16x16x32_bf16 a[52:55],v[28:31],v[100:103],a[52:55]
ds_read_b64_tr_b16 v[64:65],v120 offset:24576
v_add_f32 v177,v177,v179
v_mfma_f32_16x16x32_bf16 a[56:59],v[32:35],v[100:103],a[56:59]
buffer_load_dwordx4 v130,s[8:11],s32 offen offset:2048 lds
v_mfma_f32_16x16x32_bf16 a[60:63],v[36:39],v[100:103],a[60:63]
ds_read_b64_tr_b16 v[66:67],v120 offset:25600
v_add_f32 v176,v176,v180
v_mfma_f32_16x16x32_bf16 a[64:67],v[40:43],v[100:103],a[64:67]
v_add_f32 v177,v177,v181
v_add_f32 v176,v176,v182
v_mfma_f32_16x16x32_bf16 a[68:71],v[44:47],v[100:103],a[68:71]
ds_read_b64_tr_b16 v[68:69],v121 offset:24576
v_add_f32 v177,v177,v183
v_mfma_f32_16x16x32_bf16 a[72:75],v[48:51],v[100:103],a[72:75]
buffer_load_dwordx4 v131,s[8:11],s32 offen offset:3072 lds
v_mfma_f32_16x16x32_bf16 a[76:79],v[52:55],v[100:103],a[76:79]
ds_read_b64_tr_b16 v[70:71],v121 offset:25600
s_waitcnt lgkmcnt(9)
v_mfma_f32_16x16x32_bf16 a[80:83],v[16:19],v[104:107],a[80:83]
s_add_u32 s24,s24,128
v_add_f32 v176,v176,v184
v_mfma_f32_16x16x32_bf16 a[84:87],v[20:23],v[104:107],a[84:87]
ds_read_b128 v[96:99],v112 offset:8192
v_add_f32 v177,v177,v185
v_mfma_f32_16x16x32_bf16 a[88:91],v[24:27],v[104:107],a[88:91]
ds_write_b32 v173,v176
ds_write_b32 v173,v177 offset:64
v_mfma_f32_16x16x32_bf16 a[92:95],v[28:31],v[104:107],a[92:95]
ds_read_b64_tr_b16 v[72:73],v122 offset:24576
ds_read2_b32 v[178:179],v172 offset0:0 offset1:16
v_mfma_f32_16x16x32_bf16 a[96:99],v[32:35],v[104:107],a[96:99]
s_add_u32 s32,s32,128
ds_read2_b32 v[180:181],v172 offset0:32 offset1:48
v_mfma_f32_16x16x32_bf16 a[100:103],v[36:39],v[104:107],a[100:103]
s_waitcnt lgkmcnt(11)
ds_read_b64_tr_b16 v[74:75],v122 offset:25600
ds_read2_b32 v[182:183],v172 offset0:64 offset1:80
v_mfma_f32_16x16x32_bf16 a[104:107],v[40:43],v[104:107],a[104:107]
v_mfma_f32_16x16x32_bf16 a[108:111],v[44:47],v[104:107],a[108:111]
ds_read_b64_tr_b16 v[76:77],v123 offset:24576
v_mfma_f32_16x16x32_bf16 a[112:115],v[48:51],v[104:107],a[112:115]
v_mfma_f32_16x16x32_bf16 a[116:119],v[52:55],v[104:107],a[116:119]
ds_read_b64_tr_b16 v[78:79],v123 offset:25600
s_waitcnt lgkmcnt(14)
v_mfma_f32_16x16x32_bf16 a[120:123],v[16:19],v[108:111],a[120:123]
v_mfma_f32_16x16x32_bf16 a[124:127],v[20:23],v[108:111],a[124:127]
ds_read_b128 v[100:103],v112 offset:10240
v_mfma_f32_16x16x32_bf16 a[128:131],v[24:27],v[108:111],a[128:131]
s_waitcnt lgkmcnt(3)
v_add_f32 v144,v144,v178
v_mfma_f32_16x16x32_bf16 a[132:135],v[28:31],v[108:111],a[132:135]
ds_read_b64_tr_b16 v[80:81],v120 offset:32768
v_add_f32 v146,v146,v179
v_mfma_f32_16x16x32_bf16 a[136:139],v[32:35],v[108:111],a[136:139]
v_add_f32 v148,v148,v180
v_add_f32 v150,v150,v181
v_mfma_f32_16x16x32_bf16 a[140:143],v[36:39],v[108:111],a[140:143]
ds_read_b64_tr_b16 v[82:83],v120 offset:33792
v_add_f32 v152,v152,v182
v_mfma_f32_16x16x32_bf16 a[144:147],v[40:43],v[108:111],a[144:147]
v_add_f32 v154,v154,v183
v_add_f32 v156,v156,v178
v_mfma_f32_16x16x32_bf16 a[148:151],v[44:47],v[108:111],a[148:151]
ds_read_b64_tr_b16 v[84:85],v121 offset:32768
v_add_f32 v158,v158,v179
v_mfma_f32_16x16x32_bf16 a[152:155],v[48:51],v[108:111],a[152:155]
v_add_f32 v160,v160,v180
v_add_f32 v162,v162,v181
v_mfma_f32_16x16x32_bf16 a[156:159],v[52:55],v[108:111],a[156:159]
ds_read_b64_tr_b16 v[86:87],v121 offset:33792
v_mfma_f32_16x16x32_bf16 a[160:163],v[16:19],v[96:99],a[160:163]
v_mfma_f32_16x16x32_bf16 a[164:167],v[20:23],v[96:99],a[164:167]
ds_read_b128 v[104:107],v112 offset:12288
v_mfma_f32_16x16x32_bf16 a[168:171],v[24:27],v[96:99],a[168:171]
v_mfma_f32_16x16x32_bf16 a[172:175],v[28:31],v[96:99],a[172:175]
ds_read_b64_tr_b16 v[88:89],v122 offset:32768
v_mfma_f32_16x16x32_bf16 a[176:179],v[32:35],v[96:99],a[176:179]
v_mfma_f32_16x16x32_bf16 a[180:183],v[36:39],v[96:99],a[180:183]
ds_read_b64_tr_b16 v[90:91],v122 offset:33792
v_mfma_f32_16x16x32_bf16 a[184:187],v[40:43],v[96:99],a[184:187]
v_mfma_f32_16x16x32_bf16 a[188:191],v[44:47],v[96:99],a[188:191]
ds_read_b64_tr_b16 v[92:93],v123 offset:32768
v_mfma_f32_16x16x32_bf16 a[192:195],v[48:51],v[96:99],a[192:195]
v_mfma_f32_16x16x32_bf16 a[196:199],v[52:55],v[96:99],a[196:199]
ds_read_b64_tr_b16 v[94:95],v123 offset:33792
s_waitcnt lgkmcnt(9)
v_mfma_f32_16x16x32_bf16 a[200:203],v[16:19],v[100:103],a[200:203]
v_mfma_f32_16x16x32_bf16 a[204:207],v[20:23],v[100:103],a[204:207]
ds_read_b128 v[108:111],v112 offset:14336
v_mfma_f32_16x16x32_bf16 a[208:211],v[24:27],v[100:103],a[208:211]
s_cbranch_vccnz .Lcs17
v_smfmac_f32_16x16x64_bf16 v[144:147],v[164:167],v[16:23],v143
v_smfmac_f32_16x16x64_bf16 v[148:151],v[164:167],v[24:31],v143
v_smfmac_f32_16x16x64_bf16 v[152:155],v[164:167],v[32:39],v143
s_branch .Lce17
.Lcs17:
v_smfmac_f32_16x16x64_bf16 v[156:159],v[164:167],v[40:47],v143
v_smfmac_f32_16x16x64_bf16 v[160:163],v[164:167],v[48:55],v143
.Lce17:
v_mfma_f32_16x16x32_bf16 a[212:215],v[28:31],v[100:103],a[212:215]
v_mfma_f32_16x16x32_bf16 a[216:219],v[32:35],v[100:103],a[216:219]
v_mfma_f32_16x16x32_bf16 a[220:223],v[36:39],v[100:103],a[220:223]
v_mfma_f32_16x16x32_bf16 a[224:227],v[40:43],v[100:103],a[224:227]
v_mfma_f32_16x16x32_bf16 a[228:231],v[44:47],v[100:103],a[228:231]
v_mfma_f32_16x16x32_bf16 a[232:235],v[48:51],v[100:103],a[232:235]
v_mfma_f32_16x16x32_bf16 a[236:239],v[52:55],v[100:103],a[236:239]
s_waitcnt lgkmcnt(5)
v_mfma_f32_16x16x32_bf16 a[240:243],v[16:19],v[104:107],a[240:243]
v_mfma_f32_16x16x32_bf16 a[244:247],v[20:23],v[104:107],a[244:247]
ds_read_b128 v[96:99],v113
v_mfma_f32_16x16x32_bf16 a[248:251],v[24:27],v[104:107],a[248:251]
v_mfma_f32_16x16x32_bf16 a[252:255],v[28:31],v[104:107],a[252:255]
v_mfma_f32_16x16x32_bf16 v[192:195],v[32:35],v[104:107],v[192:195]
v_mfma_f32_16x16x32_bf16 v[196:199],v[36:39],v[104:107],v[196:199]
v_mfma_f32_16x16x32_bf16 v[200:203],v[40:43],v[104:107],v[200:203]
v_mfma_f32_16x16x32_bf16 v[204:207],v[44:47],v[104:107],v[204:207]
v_mfma_f32_16x16x32_bf16 v[208:211],v[48:51],v[104:107],v[208:211]
v_mfma_f32_16x16x32_bf16 v[212:215],v[52:55],v[104:107],v[212:215]
s_waitcnt lgkmcnt(1)
v_mfma_f32_16x16x32_bf16 v[216:219],v[16:19],v[108:111],v[216:219]
v_mfma_f32_16x16x32_bf16 v[220:223],v[20:23],v[108:111],v[220:223]
ds_read_b128 v[100:103],v113 offset:2048
v_mfma_f32_16x16x32_bf16 v[224:227],v[24:27],v[108:111],v[224:227]
v_mfma_f32_16x16x32_bf16 v[228:231],v[28:31],v[108:111],v[228:231]
v_mfma_f32_16x16x32_bf16 v[232:235],v[32:35],v[108:111],v[232:235]
v_mfma_f32_16x16x32_bf16 v[236:239],v[36:39],v[108:111],v[236:239]
v_mfma_f32_16x16x32_bf16 v[240:243],v[40:43],v[108:111],v[240:243]
v_mfma_f32_16x16x32_bf16 v[244:247],v[44:47],v[108:111],v[244:247]
v_mfma_f32_16x16x32_bf16 v[248:251],v[48:51],v[108:111],v[248:251]
v_mfma_f32_16x16x32_bf16 v[252:255],v[52:55],v[108:111],v[252:255]
s_waitcnt vmcnt(0) lgkmcnt(0)
s_barrier
L_epiA:
v_mfma_f32_16x16x32_bf16 a[0:3],v[56:59],v[96:99],a[0:3]
ds_read_b128 v[104:107],v113 offset:4096
ds_read_b128 v[108:111],v113 offset:6144
v_mfma_f32_16x16x32_bf16 a[4:7],v[60:63],v[96:99],a[4:7]
ds_read_b64_tr_b16 v[16:17],v116 offset:40960
ds_read_b64_tr_b16 v[18:19],v116 offset:41984
v_mfma_f32_16x16x32_bf16 a[40:43],v[56:59],v[100:103],a[40:43]
ds_read_b128 v[96:99],v113 offset:8192
ds_read_b64_tr_b16 v[20:21],v117 offset:40960
v_mfma_f32_16x16x32_bf16 a[44:47],v[60:63],v[100:103],a[44:47]
ds_read_b64_tr_b16 v[22:23],v117 offset:41984
ds_read_b64_tr_b16 v[24:25],v120 offset:45056
s_waitcnt lgkmcnt(7)
v_mfma_f32_16x16x32_bf16 a[80:83],v[56:59],v[104:107],a[80:83]
ds_read_b128 v[100:103],v113 offset:10240
ds_read_b64_tr_b16 v[26:27],v120 offset:46080
v_mfma_f32_16x16x32_bf16 a[84:87],v[60:63],v[104:107],a[84:87]
ds_read_b64_tr_b16 v[28:29],v121 offset:45056
ds_read_b64_tr_b16 v[30:31],v121 offset:46080
s_waitcnt lgkmcnt(10)
v_mfma_f32_16x16x32_bf16 a[120:123],v[56:59],v[108:111],a[120:123]
ds_read_b128 v[104:107],v113 offset:12288
ds_read_b64_tr_b16 v[32:33],v122 offset:45056
v_mfma_f32_16x16x32_bf16 a[124:127],v[60:63],v[108:111],a[124:127]
ds_read_b64_tr_b16 v[34:35],v122 offset:46080
ds_read_b64_tr_b16 v[36:37],v123 offset:45056
s_waitcnt lgkmcnt(11)
v_mfma_f32_16x16x32_bf16 a[160:163],v[56:59],v[96:99],a[160:163]
ds_read_b128 v[108:111],v113 offset:14336
ds_read_b64_tr_b16 v[38:39],v123 offset:46080
v_mfma_f32_16x16x32_bf16 a[164:167],v[60:63],v[96:99],a[164:167]
ds_read_b64_tr_b16 v[40:41],v120 offset:53248
ds_read_b64_tr_b16 v[42:43],v120 offset:54272
s_waitcnt lgkmcnt(11)
v_mfma_f32_16x16x32_bf16 a[200:203],v[56:59],v[100:103],a[200:203]
ds_read_b128 v[96:99],v114
ds_read_b64_tr_b16 v[44:45],v121 offset:53248
v_mfma_f32_16x16x32_bf16 a[204:207],v[60:63],v[100:103],a[204:207]
ds_read_b64_tr_b16 v[46:47],v121 offset:54272
ds_read_b64_tr_b16 v[48:49],v122 offset:53248
s_waitcnt lgkmcnt(11)
v_mfma_f32_16x16x32_bf16 a[240:243],v[56:59],v[104:107],a[240:243]
ds_read_b128 v[100:103],v114 offset:2048
ds_read_b64_tr_b16 v[50:51],v122 offset:54272
v_mfma_f32_16x16x32_bf16 a[244:247],v[60:63],v[104:107],a[244:247]
ds_read_b64_tr_b16 v[52:53],v123 offset:53248
ds_read_b64_tr_b16 v[54:55],v123 offset:54272
s_waitcnt lgkmcnt(11)
v_mfma_f32_16x16x32_bf16 v[216:219],v[56:59],v[108:111],v[216:219]
ds_read_b128 v[104:107],v114 offset:4096
v_mfma_f32_16x16x32_bf16 v[220:223],v[60:63],v[108:111],v[220:223]
s_cbranch_vccnz .Lce18
v_smfmac_f32_16x16x64_bf16 v[144:147],v[164:167],v[56:63],v143
.Lce18:
s_waitcnt lgkmcnt(8)
v_mfma_f32_16x16x32_bf16 a[0:3],v[16:19],v[96:99],a[0:3]
ds_read_b128 v[108:111],v114 offset:6144
ds_read_b64_tr_b16 v[56:57],v118
v_mfma_f32_16x16x32_bf16 a[4:7],v[20:23],v[96:99],a[4:7]
ds_read_b64_tr_b16 v[58:59],v118 offset:1024
ds_read_b64_tr_b16 v[60:61],v119
s_waitcnt lgkmcnt(8)
v_mfma_f32_16x16x32_bf16 a[40:43],v[16:19],v[100:103],a[40:43]
ds_read_b128 v[96:99],v114 offset:8192
ds_read_b64_tr_b16 v[62:63],v119 offset:1024
v_mfma_f32_16x16x32_bf16 a[44:47],v[20:23],v[100:103],a[44:47]
s_waitcnt lgkmcnt(6)
v_mfma_f32_16x16x32_bf16 a[80:83],v[16:19],v[104:107],a[80:83]
ds_read_b128 v[100:103],v114 offset:10240
v_mfma_f32_16x16x32_bf16 a[84:87],v[20:23],v[104:107],a[84:87]
s_waitcnt lgkmcnt(6)
v_mfma_f32_16x16x32_bf16 a[120:123],v[16:19],v[108:111],a[120:123]
ds_read_b128 v[104:107],v114 offset:12288
v_mfma_f32_16x16x32_bf16 a[124:127],v[20:23],v[108:111],a[124:127]
s_waitcnt lgkmcnt(3)
v_mfma_f32_16x16x32_bf16 a[160:163],v[16:19],v[96:99],a[160:163]
ds_read_b128 v[108:111],v114 offset:14336
v_mfma_f32_16x16x32_bf16 a[164:167],v[20:23],v[96:99],a[164:167]
s_waitcnt lgkmcnt(2)
v_mfma_f32_16x16x32_bf16 a[200:203],v[16:19],v[100:103],a[200:203]
ds_read_b128 v[96:99],v115
v_mfma_f32_16x16x32_bf16 a[204:207],v[20:23],v[100:103],a[204:207]
s_waitcnt lgkmcnt(2)
v_mfma_f32_16x16x32_bf16 a[240:243],v[16:19],v[104:107],a[240:243]
ds_read_b128 v[100:103],v115 offset:2048
v_mfma_f32_16x16x32_bf16 a[244:247],v[20:23],v[104:107],a[244:247]
s_waitcnt lgkmcnt(2)
v_mfma_f32_16x16x32_bf16 v[216:219],v[16:19],v[108:111],v[216:219]
ds_read_b128 v[104:107],v115 offset:4096
v_mfma_f32_16x16x32_bf16 v[220:223],v[20:23],v[108:111],v[220:223]
s_cbranch_vccnz .Lce19
v_smfmac_f32_16x16x64_bf16 v[144:147],v[164:167],v[16:23],v143
.Lce19:
s_waitcnt lgkmcnt(2)
v_mfma_f32_16x16x32_bf16 a[0:3],v[56:59],v[96:99],a[0:3]
ds_read_b128 v[108:111],v115 offset:6144
v_mfma_f32_16x16x32_bf16 a[4:7],v[60:63],v[96:99],a[4:7]
s_waitcnt lgkmcnt(2)
v_mfma_f32_16x16x32_bf16 a[40:43],v[56:59],v[100:103],a[40:43]
ds_read_b128 v[96:99],v115 offset:8192
v_mfma_f32_16x16x32_bf16 a[44:47],v[60:63],v[100:103],a[44:47]
s_waitcnt lgkmcnt(2)
v_mfma_f32_16x16x32_bf16 a[80:83],v[56:59],v[104:107],a[80:83]
ds_read_b128 v[100:103],v115 offset:10240
v_mfma_f32_16x16x32_bf16 a[84:87],v[60:63],v[104:107],a[84:87]
s_waitcnt lgkmcnt(2)
v_mfma_f32_16x16x32_bf16 a[120:123],v[56:59],v[108:111],a[120:123]
ds_read_b128 v[104:107],v115 offset:12288
v_mfma_f32_16x16x32_bf16 a[124:127],v[60:63],v[108:111],a[124:127]
s_waitcnt lgkmcnt(2)
v_mfma_f32_16x16x32_bf16 a[160:163],v[56:59],v[96:99],a[160:163]
ds_read_b128 v[108:111],v115 offset:14336
v_mfma_f32_16x16x32_bf16 a[164:167],v[60:63],v[96:99],a[164:167]
s_waitcnt lgkmcnt(2)
v_mfma_f32_16x16x32_bf16 a[200:203],v[56:59],v[100:103],a[200:203]
ds_read_b128 v[96:99],v113
v_mfma_f32_16x16x32_bf16 a[204:207],v[60:63],v[100:103],a[204:207]
s_waitcnt lgkmcnt(2)
v_mfma_f32_16x16x32_bf16 a[240:243],v[56:59],v[104:107],a[240:243]
ds_read_b128 v[100:103],v113 offset:2048
v_mfma_f32_16x16x32_bf16 a[244:247],v[60:63],v[104:107],a[244:247]
s_waitcnt lgkmcnt(2)
v_mfma_f32_16x16x32_bf16 v[216:219],v[56:59],v[108:111],v[216:219]
ds_read_b128 v[104:107],v113 offset:4096
v_mfma_f32_16x16x32_bf16 v[220:223],v[60:63],v[108:111],v[220:223]
s_cbranch_vccnz .Lce20
v_smfmac_f32_16x16x64_bf16 v[144:147],v[164:167],v[56:63],v143
.Lce20:
s_waitcnt lgkmcnt(2)
v_mfma_f32_16x16x32_bf16 a[8:11],v[64:67],v[96:99],a[8:11]
v_lshrrev_b32 v3,5,v2
v_bfe_u32 v4,v2,4,1
v_mfma_f32_16x16x32_bf16 a[12:15],v[68:71],v[96:99],a[12:15]
v_lshlrev_b32 v3,10,v3
v_lshl_add_u32 v3,v4,9,v3
v_mfma_f32_16x16x32_bf16 a[16:19],v[72:75],v[96:99],a[16:19]
v_and_b32 v5,15,v2
v_lshl_add_u32 v8,v5,4,v3
v_mfma_f32_16x16x32_bf16 a[20:23],v[76:79],v[96:99],a[20:23]
v_bfe_u32 v6,v2,2,2
v_and_b32 v7,3,v2
v_mfma_f32_16x16x32_bf16 a[24:27],v[80:83],v[96:99],a[24:27]
v_lshl_add_u32 v6,v6,3,v7
v_lshl_add_u32 v12,v6,4,v3
v_mfma_f32_16x16x32_bf16 a[28:31],v[84:87],v[96:99],a[28:31]
s_mul_i32 s48,s41,1280
s_add_u32 s48,s48,147456
v_mfma_f32_16x16x32_bf16 a[32:35],v[88:91],v[96:99],a[32:35]
v_lshl_add_u32 v7,v5,2,s48
s_mul_i32 s49,s40,640
v_mfma_f32_16x16x32_bf16 a[36:39],v[92:95],v[96:99],a[36:39]
v_add_u32 v11,s49,v7
v_cmp_gt_u32 s[46:47],16,v2
s_waitcnt lgkmcnt(1)
v_mfma_f32_16x16x32_bf16 a[48:51],v[64:67],v[100:103],a[48:51]
ds_read_b128 v[108:111],v113 offset:6144
v_mov_b32 v10,153600
v_mfma_f32_16x16x32_bf16 a[52:55],v[68:71],v[100:103],a[52:55]
v_lshrrev_b32 v6,4,v2
v_lshl_add_u32 v13,v6,4,s48
v_mfma_f32_16x16x32_bf16 a[56:59],v[72:75],v[100:103],a[56:59]
s_lshl_b32 s48,s40,9
s_add_u32 s48,s48,155648
v_mfma_f32_16x16x32_bf16 a[60:63],v[76:79],v[100:103],a[60:63]
v_lshl_add_u32 v14,v5,2,s48
v_lshl_add_u32 v15,v6,4,s48
v_mfma_f32_16x16x32_bf16 a[64:67],v[80:83],v[100:103],a[64:67]
v_cndmask_b32 v11,v10,v11,s[46:47]
v_add_f32 v168,v144,v145
v_mfma_f32_16x16x32_bf16 a[68:71],v[84:87],v[100:103],a[68:71]
v_add_f32 v169,v146,v147
ds_write_b32 v11,v168
v_mfma_f32_16x16x32_bf16 a[72:75],v[88:91],v[100:103],a[72:75]
ds_write_b32 v11,v169 offset:64
s_lshl_b32 s51,s34,14
v_mfma_f32_16x16x32_bf16 a[76:79],v[92:95],v[100:103],a[76:79]
s_lshl_b32 s56,s40,13
s_add_u32 s51,s51,s56
s_waitcnt lgkmcnt(3)
v_mfma_f32_16x16x32_bf16 a[88:91],v[64:67],v[104:107],a[88:91]
ds_read_b128 v[96:99],v113 offset:8192
s_and_b32 s56,s35,7
v_mfma_f32_16x16x32_bf16 a[92:95],v[68:71],v[104:107],a[92:95]
s_lshl_b32 s56,s56,1
s_bfe_u32 s59,s35,0x10003
v_mfma_f32_16x16x32_bf16 a[96:99],v[72:75],v[104:107],a[96:99]
s_add_u32 s56,s56,s59
s_lshl_b32 s56,s56,1
v_mfma_f32_16x16x32_bf16 a[100:103],v[76:79],v[104:107],a[100:103]
s_add_u32 s59,s56,s41
s_cmp_lt_u32 s35,16
s_cselect_b32 s46,17,18
s_mov_b32 s44,126912
s_cselect_b32 s44,-6400,s44
s_mov_b32 s45,0x800000
s_cselect_b32 s45,0x401000,s45
s_cselect_b32 s56,256,64
s_mov_b32 s57,0xfc0
s_cselect_b32 s57,0x700,s57
s_cselect_b32 s58,0x3e8293ee,1.0
s_cselect_b64 s[48:49],-1,0
v_mfma_f32_16x16x32_bf16 a[104:107],v[80:83],v[104:107],a[104:107]
s_lshl_b32 s59,s59,s46
s_add_u32 s45,s45,s59
v_mfma_f32_16x16x32_bf16 a[108:111],v[84:87],v[104:107],a[108:111]
s_add_u32 s45,s45,s51
v_cndmask_b32 v8,v12,v8,s[48:49]
v_mfma_f32_16x16x32_bf16 a[112:115],v[88:91],v[104:107],a[112:115]
s_waitcnt lgkmcnt(0)
s_barrier
ds_read_b128 v[16:19],v13
v_mfma_f32_16x16x32_bf16 a[116:119],v[92:95],v[104:107],a[116:119]
ds_read_b128 v[20:23],v13 offset:64
v_add_u32 v6,1024,v14
v_mfma_f32_16x16x32_bf16 a[128:131],v[64:67],v[108:111],a[128:131]
ds_read_b128 v[100:103],v113 offset:10240
ds_read2_b32 v[56:57],v14 offset0:0 offset1:16
v_mfma_f32_16x16x32_bf16 a[132:135],v[68:71],v[108:111],a[132:135]
ds_read2_b32 v[58:59],v14 offset0:32 offset1:48
ds_read2_b32 v[60:61],v14 offset0:64 offset1:80
v_mfma_f32_16x16x32_bf16 a[136:139],v[72:75],v[108:111],a[136:139]
ds_read2_b32 v[62:63],v14 offset0:96 offset1:112
ds_read2_b32 v[168:169],v6 offset0:0 offset1:16
v_mfma_f32_16x16x32_bf16 a[140:143],v[76:79],v[108:111],a[140:143]
ds_read2_b32 v[170:171],v6 offset0:32 offset1:48
ds_read2_b32 v[172:173],v6 offset0:64 offset1:80
v_mfma_f32_16x16x32_bf16 a[144:147],v[80:83],v[108:111],a[144:147]
ds_read2_b32 v[174:175],v6 offset0:96 offset1:112
s_waitcnt lgkmcnt(4)
v_mfma_f32_16x16x32_bf16 a[148:151],v[84:87],v[108:111],a[148:151]
v_mul_f32 v56,s58,v56
v_mul_f32 v57,s58,v57
v_mfma_f32_16x16x32_bf16 a[152:155],v[88:91],v[108:111],a[152:155]
v_mul_f32 v58,s58,v58
v_mul_f32 v59,s58,v59
v_mfma_f32_16x16x32_bf16 a[156:159],v[92:95],v[108:111],a[156:159]
v_mul_f32 v60,s58,v60
v_mul_f32 v61,s58,v61
v_mfma_f32_16x16x32_bf16 a[168:171],v[64:67],v[96:99],a[168:171]
ds_read_b128 v[104:107],v113 offset:12288
v_mul_f32 v62,s58,v62
v_mfma_f32_16x16x32_bf16 a[172:175],v[68:71],v[96:99],a[172:175]
v_mul_f32 v63,s58,v63
s_waitcnt lgkmcnt(1)
v_mfma_f32_16x16x32_bf16 a[176:179],v[72:75],v[96:99],a[176:179]
v_accvgpr_read_b32 v176,a160
v_accvgpr_read_b32 v177,a161
v_mfma_f32_16x16x32_bf16 a[180:183],v[76:79],v[96:99],a[180:183]
v_accvgpr_read_b32 v178,a162
v_accvgpr_read_b32 v179,a163
v_mfma_f32_16x16x32_bf16 a[184:187],v[80:83],v[96:99],a[184:187]
v_fma_f32 v176,v16,v172,v176
v_fma_f32 v177,v17,v172,v177
v_mfma_f32_16x16x32_bf16 a[188:191],v[84:87],v[96:99],a[188:191]
v_fma_f32 v178,v18,v172,v178
v_fma_f32 v179,v19,v172,v179
v_mfma_f32_16x16x32_bf16 a[192:195],v[88:91],v[96:99],a[192:195]
v_mul_f32 v176,v176,v60
v_mul_f32 v177,v177,v60
v_mfma_f32_16x16x32_bf16 a[196:199],v[92:95],v[96:99],a[196:199]
v_mul_f32 v178,v178,v60
v_mul_f32 v179,v179,v60
v_mfma_f32_16x16x32_bf16 a[208:211],v[64:67],v[100:103],a[208:211]
ds_read_b128 v[108:111],v113 offset:14336
v_accvgpr_read_b32 v180,a164
v_mfma_f32_16x16x32_bf16 a[212:215],v[68:71],v[100:103],a[212:215]
v_accvgpr_read_b32 v181,a165
v_accvgpr_read_b32 v182,a166
v_mfma_f32_16x16x32_bf16 a[216:219],v[72:75],v[100:103],a[216:219]
v_accvgpr_read_b32 v183,a167
v_fma_f32 v180,v20,v172,v180
v_mfma_f32_16x16x32_bf16 a[220:223],v[76:79],v[100:103],a[220:223]
v_fma_f32 v181,v21,v172,v181
v_fma_f32 v182,v22,v172,v182
v_mfma_f32_16x16x32_bf16 a[224:227],v[80:83],v[100:103],a[224:227]
v_fma_f32 v183,v23,v172,v183
v_mul_f32 v180,v180,v60
v_mfma_f32_16x16x32_bf16 a[228:231],v[84:87],v[100:103],a[228:231]
v_mul_f32 v181,v181,v60
v_mul_f32 v182,v182,v60
v_mfma_f32_16x16x32_bf16 a[232:235],v[88:91],v[100:103],a[232:235]
v_mul_f32 v183,v183,v60
v_cvt_pk_bf16_f32 v184,v176,v177
v_mfma_f32_16x16x32_bf16 a[236:239],v[92:95],v[100:103],a[236:239]
v_cvt_pk_bf16_f32 v185,v178,v179
v_cvt_pk_bf16_f32 v186,v180,v181
s_waitcnt lgkmcnt(1)
v_mfma_f32_16x16x32_bf16 a[248:251],v[64:67],v[104:107],a[248:251]
ds_read_b128 v[96:99],v114
v_cvt_pk_bf16_f32 v187,v182,v183
v_mfma_f32_16x16x32_bf16 a[252:255],v[68:71],v[104:107],a[252:255]
buffer_store_dwordx4 v[184:187],v8,s[20:23],s45 offen sc1
s_add_u32 s45,s45,s56
v_mfma_f32_16x16x32_bf16 v[192:195],v[72:75],v[104:107],v[192:195]
v_accvgpr_read_b32 v176,a200
v_accvgpr_read_b32 v177,a201
v_mfma_f32_16x16x32_bf16 v[196:199],v[76:79],v[104:107],v[196:199]
v_accvgpr_read_b32 v178,a202
v_accvgpr_read_b32 v179,a203
v_mfma_f32_16x16x32_bf16 v[200:203],v[80:83],v[104:107],v[200:203]
v_fma_f32 v176,v16,v173,v176
v_fma_f32 v177,v17,v173,v177
v_mfma_f32_16x16x32_bf16 v[204:207],v[84:87],v[104:107],v[204:207]
v_fma_f32 v178,v18,v173,v178
v_fma_f32 v179,v19,v173,v179
v_mfma_f32_16x16x32_bf16 v[208:211],v[88:91],v[104:107],v[208:211]
v_mul_f32 v176,v176,v61
v_mul_f32 v177,v177,v61
v_mfma_f32_16x16x32_bf16 v[212:215],v[92:95],v[104:107],v[212:215]
v_mul_f32 v178,v178,v61
v_mul_f32 v179,v179,v61
s_waitcnt lgkmcnt(1)
v_mfma_f32_16x16x32_bf16 v[224:227],v[64:67],v[108:111],v[224:227]
ds_read_b128 v[100:103],v114 offset:2048
v_accvgpr_read_b32 v180,a204
v_mfma_f32_16x16x32_bf16 v[228:231],v[68:71],v[108:111],v[228:231]
v_accvgpr_read_b32 v181,a205
v_accvgpr_read_b32 v182,a206
v_mfma_f32_16x16x32_bf16 v[232:235],v[72:75],v[108:111],v[232:235]
v_accvgpr_read_b32 v183,a207
v_fma_f32 v180,v20,v173,v180
v_mfma_f32_16x16x32_bf16 v[236:239],v[76:79],v[108:111],v[236:239]
v_fma_f32 v181,v21,v173,v181
v_fma_f32 v182,v22,v173,v182
v_mfma_f32_16x16x32_bf16 v[240:243],v[80:83],v[108:111],v[240:243]
v_fma_f32 v183,v23,v173,v183
v_mul_f32 v180,v180,v61
v_mfma_f32_16x16x32_bf16 v[244:247],v[84:87],v[108:111],v[244:247]
v_mul_f32 v181,v181,v61
v_mul_f32 v182,v182,v61
v_mfma_f32_16x16x32_bf16 v[248:251],v[88:91],v[108:111],v[248:251]
v_mul_f32 v183,v183,v61
v_cvt_pk_bf16_f32 v188,v176,v177
v_mfma_f32_16x16x32_bf16 v[252:255],v[92:95],v[108:111],v[252:255]
v_cvt_pk_bf16_f32 v189,v178,v179
v_cvt_pk_bf16_f32 v190,v180,v181
s_cbranch_vccnz .Lcs21
v_smfmac_f32_16x16x64_bf16 v[148:151],v[164:167],v[64:71],v143
v_smfmac_f32_16x16x64_bf16 v[152:155],v[164:167],v[72:79],v143
s_branch .Lce21
.Lcs21:
v_smfmac_f32_16x16x64_bf16 v[156:159],v[164:167],v[80:87],v143
v_smfmac_f32_16x16x64_bf16 v[160:163],v[164:167],v[88:95],v143
.Lce21:
s_waitcnt lgkmcnt(1)
v_mfma_f32_16x16x32_bf16 a[8:11],v[24:27],v[96:99],a[8:11]
ds_read_b128 v[104:107],v114 offset:4096
ds_read_b64_tr_b16 v[64:65],v124 offset:4096
v_mfma_f32_16x16x32_bf16 a[12:15],v[28:31],v[96:99],a[12:15]
ds_read_b64_tr_b16 v[66:67],v124 offset:5120
ds_read_b64_tr_b16 v[68:69],v125 offset:4096
v_mfma_f32_16x16x32_bf16 a[16:19],v[32:35],v[96:99],a[16:19]
ds_read_b64_tr_b16 v[70:71],v125 offset:5120
ds_read_b64_tr_b16 v[72:73],v126 offset:4096
v_mfma_f32_16x16x32_bf16 a[20:23],v[36:39],v[96:99],a[20:23]
ds_read_b64_tr_b16 v[74:75],v126 offset:5120
ds_read_b64_tr_b16 v[76:77],v127 offset:4096
v_mfma_f32_16x16x32_bf16 a[24:27],v[40:43],v[96:99],a[24:27]
ds_read_b64_tr_b16 v[78:79],v127 offset:5120
ds_read_b64_tr_b16 v[80:81],v124 offset:12288
v_mfma_f32_16x16x32_bf16 a[28:31],v[44:47],v[96:99],a[28:31]
ds_read_b64_tr_b16 v[82:83],v124 offset:13312
ds_read_b64_tr_b16 v[84:85],v125 offset:12288
v_mfma_f32_16x16x32_bf16 a[32:35],v[48:51],v[96:99],a[32:35]
ds_read_b64_tr_b16 v[86:87],v125 offset:13312
ds_read_b64_tr_b16 v[88:89],v126 offset:12288
v_mfma_f32_16x16x32_bf16 a[36:39],v[52:55],v[96:99],a[36:39]
s_waitcnt lgkmcnt(11)
ds_read_b64_tr_b16 v[90:91],v126 offset:13312
ds_read_b64_tr_b16 v[92:93],v127 offset:12288
v_mfma_f32_16x16x32_bf16 a[48:51],v[24:27],v[100:103],a[48:51]
ds_read_b128 v[108:111],v114 offset:6144
ds_read_b64_tr_b16 v[94:95],v127 offset:13312
v_mfma_f32_16x16x32_bf16 a[52:55],v[28:31],v[100:103],a[52:55]
v_cvt_pk_bf16_f32 v191,v182,v183
buffer_store_dwordx4 v[188:191],v8,s[20:23],s45 offen sc1
v_mfma_f32_16x16x32_bf16 a[56:59],v[32:35],v[100:103],a[56:59]
s_add_u32 s45,s45,s57
v_accvgpr_read_b32 v176,a240
v_mfma_f32_16x16x32_bf16 a[60:63],v[36:39],v[100:103],a[60:63]
v_accvgpr_read_b32 v177,a241
v_accvgpr_read_b32 v178,a242
v_mfma_f32_16x16x32_bf16 a[64:67],v[40:43],v[100:103],a[64:67]
v_accvgpr_read_b32 v179,a243
v_fma_f32 v176,v16,v174,v176
v_mfma_f32_16x16x32_bf16 a[68:71],v[44:47],v[100:103],a[68:71]
v_fma_f32 v177,v17,v174,v177
v_fma_f32 v178,v18,v174,v178
v_mfma_f32_16x16x32_bf16 a[72:75],v[48:51],v[100:103],a[72:75]
v_fma_f32 v179,v19,v174,v179
v_mul_f32 v176,v176,v62
v_mfma_f32_16x16x32_bf16 a[76:79],v[52:55],v[100:103],a[76:79]
v_mul_f32 v177,v177,v62
v_mul_f32 v178,v178,v62
v_mfma_f32_16x16x32_bf16 a[88:91],v[24:27],v[104:107],a[88:91]
s_waitcnt lgkmcnt(11)
ds_read_b128 v[96:99],v114 offset:8192
v_mul_f32 v179,v179,v62
v_mfma_f32_16x16x32_bf16 a[92:95],v[28:31],v[104:107],a[92:95]
v_accvgpr_read_b32 v180,a244
v_accvgpr_read_b32 v181,a245
v_mfma_f32_16x16x32_bf16 a[96:99],v[32:35],v[104:107],a[96:99]
v_accvgpr_read_b32 v182,a246
v_accvgpr_read_b32 v183,a247
v_mfma_f32_16x16x32_bf16 a[100:103],v[36:39],v[104:107],a[100:103]
v_fma_f32 v180,v20,v174,v180
v_fma_f32 v181,v21,v174,v181
v_mfma_f32_16x16x32_bf16 a[104:107],v[40:43],v[104:107],a[104:107]
v_fma_f32 v182,v22,v174,v182
v_fma_f32 v183,v23,v174,v183
v_mfma_f32_16x16x32_bf16 a[108:111],v[44:47],v[104:107],a[108:111]
v_mul_f32 v180,v180,v62
v_mul_f32 v181,v181,v62
v_mfma_f32_16x16x32_bf16 a[112:115],v[48:51],v[104:107],a[112:115]
v_mul_f32 v182,v182,v62
v_mul_f32 v183,v183,v62
v_mfma_f32_16x16x32_bf16 a[116:119],v[52:55],v[104:107],a[116:119]
v_cvt_pk_bf16_f32 v184,v176,v177
v_cvt_pk_bf16_f32 v185,v178,v179
s_waitcnt lgkmcnt(2)
v_mfma_f32_16x16x32_bf16 a[128:131],v[24:27],v[108:111],a[128:131]
ds_read_b128 v[100:103],v114 offset:10240
v_cvt_pk_bf16_f32 v186,v180,v181
v_mfma_f32_16x16x32_bf16 a[132:135],v[28:31],v[108:111],a[132:135]
v_cvt_pk_bf16_f32 v187,v182,v183
buffer_store_dwordx4 v[184:187],v8,s[20:23],s45 offen sc1
v_mfma_f32_16x16x32_bf16 a[136:139],v[32:35],v[108:111],a[136:139]
s_add_u32 s45,s45,s56
v_fma_f32 v176,v16,v175,v216
v_mfma_f32_16x16x32_bf16 a[140:143],v[36:39],v[108:111],a[140:143]
v_fma_f32 v177,v17,v175,v217
v_fma_f32 v178,v18,v175,v218
v_mfma_f32_16x16x32_bf16 a[144:147],v[40:43],v[108:111],a[144:147]
v_fma_f32 v179,v19,v175,v219
v_mul_f32 v176,v176,v63
v_mfma_f32_16x16x32_bf16 a[148:151],v[44:47],v[108:111],a[148:151]
v_mul_f32 v177,v177,v63
v_mul_f32 v178,v178,v63
v_mfma_f32_16x16x32_bf16 a[152:155],v[48:51],v[108:111],a[152:155]
v_mul_f32 v179,v179,v63
v_fma_f32 v180,v20,v175,v220
v_mfma_f32_16x16x32_bf16 a[156:159],v[52:55],v[108:111],a[156:159]
v_fma_f32 v181,v21,v175,v221
v_fma_f32 v182,v22,v175,v222
s_waitcnt lgkmcnt(1)
v_mfma_f32_16x16x32_bf16 a[168:171],v[24:27],v[96:99],a[168:171]
ds_read_b128 v[104:107],v114 offset:12288
v_fma_f32 v183,v23,v175,v223
v_mfma_f32_16x16x32_bf16 a[172:175],v[28:31],v[96:99],a[172:175]
v_mul_f32 v180,v180,v63
v_mul_f32 v181,v181,v63
v_mfma_f32_16x16x32_bf16 a[176:179],v[32:35],v[96:99],a[176:179]
v_mul_f32 v182,v182,v63
v_mul_f32 v183,v183,v63
v_mfma_f32_16x16x32_bf16 a[180:183],v[36:39],v[96:99],a[180:183]
v_cvt_pk_bf16_f32 v188,v176,v177
v_cvt_pk_bf16_f32 v189,v178,v179
v_mfma_f32_16x16x32_bf16 a[184:187],v[40:43],v[96:99],a[184:187]
v_cvt_pk_bf16_f32 v190,v180,v181
v_cvt_pk_bf16_f32 v191,v182,v183
v_mfma_f32_16x16x32_bf16 a[188:191],v[44:47],v[96:99],a[188:191]
buffer_store_dwordx4 v[188:191],v8,s[20:23],s45 offen sc1
s_add_u32 s45,s45,s44
v_mfma_f32_16x16x32_bf16 a[192:195],v[48:51],v[96:99],a[192:195]
v_accvgpr_read_b32 v176,a0
v_accvgpr_read_b32 v177,a1
v_mfma_f32_16x16x32_bf16 a[196:199],v[52:55],v[96:99],a[196:199]
v_accvgpr_read_b32 v178,a2
v_accvgpr_read_b32 v179,a3
s_waitcnt lgkmcnt(1)
v_mfma_f32_16x16x32_bf16 a[208:211],v[24:27],v[100:103],a[208:211]
ds_read_b128 v[108:111],v114 offset:14336
v_fma_f32 v176,v16,v168,v176
v_mfma_f32_16x16x32_bf16 a[212:215],v[28:31],v[100:103],a[212:215]
v_fma_f32 v177,v17,v168,v177
v_fma_f32 v178,v18,v168,v178
v_mfma_f32_16x16x32_bf16 a[216:219],v[32:35],v[100:103],a[216:219]
v_fma_f32 v179,v19,v168,v179
v_mul_f32 v176,v176,v56
v_mfma_f32_16x16x32_bf16 a[220:223],v[36:39],v[100:103],a[220:223]
v_mul_f32 v177,v177,v56
v_mul_f32 v178,v178,v56
v_mfma_f32_16x16x32_bf16 a[224:227],v[40:43],v[100:103],a[224:227]
v_mul_f32 v179,v179,v56
v_accvgpr_read_b32 v180,a4
v_mfma_f32_16x16x32_bf16 a[228:231],v[44:47],v[100:103],a[228:231]
v_accvgpr_read_b32 v181,a5
v_accvgpr_read_b32 v182,a6
v_mfma_f32_16x16x32_bf16 a[232:235],v[48:51],v[100:103],a[232:235]
v_accvgpr_read_b32 v183,a7
v_fma_f32 v180,v20,v168,v180
v_mfma_f32_16x16x32_bf16 a[236:239],v[52:55],v[100:103],a[236:239]
v_fma_f32 v181,v21,v168,v181
v_fma_f32 v182,v22,v168,v182
s_waitcnt lgkmcnt(1)
v_mfma_f32_16x16x32_bf16 a[248:251],v[24:27],v[104:107],a[248:251]
ds_read_b128 v[96:99],v115
v_fma_f32 v183,v23,v168,v183
v_mfma_f32_16x16x32_bf16 a[252:255],v[28:31],v[104:107],a[252:255]
v_mul_f32 v180,v180,v56
v_mul_f32 v181,v181,v56
v_mfma_f32_16x16x32_bf16 v[192:195],v[32:35],v[104:107],v[192:195]
v_mul_f32 v182,v182,v56
v_mul_f32 v183,v183,v56
v_mfma_f32_16x16x32_bf16 v[196:199],v[36:39],v[104:107],v[196:199]
v_cvt_pk_bf16_f32 v184,v176,v177
v_cvt_pk_bf16_f32 v185,v178,v179
v_mfma_f32_16x16x32_bf16 v[200:203],v[40:43],v[104:107],v[200:203]
v_cvt_pk_bf16_f32 v186,v180,v181
v_cvt_pk_bf16_f32 v187,v182,v183
v_mfma_f32_16x16x32_bf16 v[204:207],v[44:47],v[104:107],v[204:207]
buffer_store_dwordx4 v[184:187],v8,s[20:23],s45 offen sc1
s_add_u32 s45,s45,s56
v_mfma_f32_16x16x32_bf16 v[208:211],v[48:51],v[104:107],v[208:211]
v_accvgpr_read_b32 v176,a40
v_accvgpr_read_b32 v177,a41
v_mfma_f32_16x16x32_bf16 v[212:215],v[52:55],v[104:107],v[212:215]
v_accvgpr_read_b32 v178,a42
v_accvgpr_read_b32 v179,a43
s_waitcnt lgkmcnt(1)
v_mfma_f32_16x16x32_bf16 v[224:227],v[24:27],v[108:111],v[224:227]
ds_read_b128 v[100:103],v115 offset:2048
v_fma_f32 v176,v16,v169,v176
v_mfma_f32_16x16x32_bf16 v[228:231],v[28:31],v[108:111],v[228:231]
v_fma_f32 v177,v17,v169,v177
v_fma_f32 v178,v18,v169,v178
v_mfma_f32_16x16x32_bf16 v[232:235],v[32:35],v[108:111],v[232:235]
v_fma_f32 v179,v19,v169,v179
v_mul_f32 v176,v176,v57
v_mfma_f32_16x16x32_bf16 v[236:239],v[36:39],v[108:111],v[236:239]
v_mul_f32 v177,v177,v57
v_mul_f32 v178,v178,v57
v_mfma_f32_16x16x32_bf16 v[240:243],v[40:43],v[108:111],v[240:243]
v_mul_f32 v179,v179,v57
v_accvgpr_read_b32 v180,a44
v_mfma_f32_16x16x32_bf16 v[244:247],v[44:47],v[108:111],v[244:247]
v_accvgpr_read_b32 v181,a45
v_accvgpr_read_b32 v182,a46
v_mfma_f32_16x16x32_bf16 v[248:251],v[48:51],v[108:111],v[248:251]
v_accvgpr_read_b32 v183,a47
v_fma_f32 v180,v20,v169,v180
v_mfma_f32_16x16x32_bf16 v[252:255],v[52:55],v[108:111],v[252:255]
v_fma_f32 v181,v21,v169,v181
v_fma_f32 v182,v22,v169,v182
s_cbranch_vccnz .Lcs22
v_smfmac_f32_16x16x64_bf16 v[148:151],v[164:167],v[24:31],v143
v_smfmac_f32_16x16x64_bf16 v[152:155],v[164:167],v[32:39],v143
s_branch .Lce22
.Lcs22:
v_smfmac_f32_16x16x64_bf16 v[156:159],v[164:167],v[40:47],v143
v_smfmac_f32_16x16x64_bf16 v[160:163],v[164:167],v[48:55],v143
.Lce22:
s_waitcnt lgkmcnt(1)
v_mfma_f32_16x16x32_bf16 a[8:11],v[64:67],v[96:99],a[8:11]
ds_read_b128 v[104:107],v115 offset:4096
v_fma_f32 v183,v23,v169,v183
v_mfma_f32_16x16x32_bf16 a[12:15],v[68:71],v[96:99],a[12:15]
v_mul_f32 v180,v180,v57
v_mul_f32 v181,v181,v57
v_mfma_f32_16x16x32_bf16 a[16:19],v[72:75],v[96:99],a[16:19]
v_mul_f32 v182,v182,v57
v_mul_f32 v183,v183,v57
v_mfma_f32_16x16x32_bf16 a[20:23],v[76:79],v[96:99],a[20:23]
v_cvt_pk_bf16_f32 v188,v176,v177
v_cvt_pk_bf16_f32 v189,v178,v179
v_mfma_f32_16x16x32_bf16 a[24:27],v[80:83],v[96:99],a[24:27]
v_cvt_pk_bf16_f32 v190,v180,v181
v_cvt_pk_bf16_f32 v191,v182,v183
v_mfma_f32_16x16x32_bf16 a[28:31],v[84:87],v[96:99],a[28:31]
buffer_store_dwordx4 v[188:191],v8,s[20:23],s45 offen sc1
s_add_u32 s45,s45,s57
v_mfma_f32_16x16x32_bf16 a[32:35],v[88:91],v[96:99],a[32:35]
v_accvgpr_read_b32 v176,a80
v_accvgpr_read_b32 v177,a81
v_mfma_f32_16x16x32_bf16 a[36:39],v[92:95],v[96:99],a[36:39]
v_accvgpr_read_b32 v178,a82
v_accvgpr_read_b32 v179,a83
s_cbranch_vccnz .Lcs23
v_smfmac_f32_16x16x64_bf16 v[148:151],v[164:167],v[64:71],v143
v_smfmac_f32_16x16x64_bf16 v[152:155],v[164:167],v[72:79],v143
s_branch .Lce23
.Lcs23:
v_smfmac_f32_16x16x64_bf16 v[156:159],v[164:167],v[80:87],v143
v_smfmac_f32_16x16x64_bf16 v[160:163],v[164:167],v[88:95],v143
.Lce23:
s_waitcnt lgkmcnt(1)
v_mfma_f32_16x16x32_bf16 a[48:51],v[64:67],v[100:103],a[48:51]
ds_read_b128 v[108:111],v115 offset:6144
v_fma_f32 v176,v16,v170,v176
v_mfma_f32_16x16x32_bf16 a[52:55],v[68:71],v[100:103],a[52:55]
v_fma_f32 v177,v17,v170,v177
v_fma_f32 v178,v18,v170,v178
v_mfma_f32_16x16x32_bf16 a[56:59],v[72:75],v[100:103],a[56:59]
v_fma_f32 v179,v19,v170,v179
v_mul_f32 v176,v176,v58
v_mfma_f32_16x16x32_bf16 a[60:63],v[76:79],v[100:103],a[60:63]
v_mul_f32 v177,v177,v58
v_mul_f32 v178,v178,v58
v_mfma_f32_16x16x32_bf16 a[64:67],v[80:83],v[100:103],a[64:67]
v_mul_f32 v179,v179,v58
v_accvgpr_read_b32 v180,a84
v_mfma_f32_16x16x32_bf16 a[68:71],v[84:87],v[100:103],a[68:71]
v_accvgpr_read_b32 v181,a85
v_accvgpr_read_b32 v182,a86
v_mfma_f32_16x16x32_bf16 a[72:75],v[88:91],v[100:103],a[72:75]
v_accvgpr_read_b32 v183,a87
v_fma_f32 v180,v20,v170,v180
v_mfma_f32_16x16x32_bf16 a[76:79],v[92:95],v[100:103],a[76:79]
v_fma_f32 v181,v21,v170,v181
v_fma_f32 v182,v22,v170,v182
s_waitcnt lgkmcnt(1)
v_mfma_f32_16x16x32_bf16 a[88:91],v[64:67],v[104:107],a[88:91]
ds_read_b128 v[96:99],v115 offset:8192
v_fma_f32 v183,v23,v170,v183
v_mfma_f32_16x16x32_bf16 a[92:95],v[68:71],v[104:107],a[92:95]
v_mul_f32 v180,v180,v58
v_mul_f32 v181,v181,v58
v_mfma_f32_16x16x32_bf16 a[96:99],v[72:75],v[104:107],a[96:99]
v_mul_f32 v182,v182,v58
v_mul_f32 v183,v183,v58
v_mfma_f32_16x16x32_bf16 a[100:103],v[76:79],v[104:107],a[100:103]
v_cvt_pk_bf16_f32 v184,v176,v177
v_cvt_pk_bf16_f32 v185,v178,v179
v_mfma_f32_16x16x32_bf16 a[104:107],v[80:83],v[104:107],a[104:107]
v_cvt_pk_bf16_f32 v186,v180,v181
v_cvt_pk_bf16_f32 v187,v182,v183
v_mfma_f32_16x16x32_bf16 a[108:111],v[84:87],v[104:107],a[108:111]
buffer_store_dwordx4 v[184:187],v8,s[20:23],s45 offen sc1
s_add_u32 s45,s45,s56
v_mfma_f32_16x16x32_bf16 a[112:115],v[88:91],v[104:107],a[112:115]
v_accvgpr_read_b32 v176,a120
v_accvgpr_read_b32 v177,a121
v_mfma_f32_16x16x32_bf16 a[116:119],v[92:95],v[104:107],a[116:119]
v_accvgpr_read_b32 v178,a122
v_accvgpr_read_b32 v179,a123
s_waitcnt lgkmcnt(1)
v_mfma_f32_16x16x32_bf16 a[128:131],v[64:67],v[108:111],a[128:131]
ds_read_b128 v[100:103],v115 offset:10240
v_fma_f32 v176,v16,v171,v176
v_mfma_f32_16x16x32_bf16 a[132:135],v[68:71],v[108:111],a[132:135]
v_fma_f32 v177,v17,v171,v177
v_fma_f32 v178,v18,v171,v178
v_mfma_f32_16x16x32_bf16 a[136:139],v[72:75],v[108:111],a[136:139]
v_fma_f32 v179,v19,v171,v179
v_mul_f32 v176,v176,v59
v_mfma_f32_16x16x32_bf16 a[140:143],v[76:79],v[108:111],a[140:143]
v_mul_f32 v177,v177,v59
v_mul_f32 v178,v178,v59
v_mfma_f32_16x16x32_bf16 a[144:147],v[80:83],v[108:111],a[144:147]
v_mul_f32 v179,v179,v59
v_accvgpr_read_b32 v180,a124
v_mfma_f32_16x16x32_bf16 a[148:151],v[84:87],v[108:111],a[148:151]
v_accvgpr_read_b32 v181,a125
v_accvgpr_read_b32 v182,a126
v_mfma_f32_16x16x32_bf16 a[152:155],v[88:91],v[108:111],a[152:155]
v_accvgpr_read_b32 v183,a127
v_fma_f32 v180,v20,v171,v180
v_mfma_f32_16x16x32_bf16 a[156:159],v[92:95],v[108:111],a[156:159]
v_fma_f32 v181,v21,v171,v181
v_fma_f32 v182,v22,v171,v182
s_waitcnt lgkmcnt(1)
v_mfma_f32_16x16x32_bf16 a[168:171],v[64:67],v[96:99],a[168:171]
ds_read_b128 v[104:107],v115 offset:12288
v_fma_f32 v183,v23,v171,v183
v_mfma_f32_16x16x32_bf16 a[172:175],v[68:71],v[96:99],a[172:175]
v_mul_f32 v180,v180,v59
v_mul_f32 v181,v181,v59
v_mfma_f32_16x16x32_bf16 a[176:179],v[72:75],v[96:99],a[176:179]
v_mul_f32 v182,v182,v59
v_mul_f32 v183,v183,v59
v_mfma_f32_16x16x32_bf16 a[180:183],v[76:79],v[96:99],a[180:183]
v_cvt_pk_bf16_f32 v188,v176,v177
v_cvt_pk_bf16_f32 v189,v178,v179
v_mfma_f32_16x16x32_bf16 a[184:187],v[80:83],v[96:99],a[184:187]
v_cvt_pk_bf16_f32 v190,v180,v181
v_cvt_pk_bf16_f32 v191,v182,v183
v_mfma_f32_16x16x32_bf16 a[188:191],v[84:87],v[96:99],a[188:191]
buffer_store_dwordx4 v[188:191],v8,s[20:23],s45 offen sc1
s_add_u32 s45,s45,s57
v_mfma_f32_16x16x32_bf16 a[192:195],v[88:91],v[96:99],a[192:195]
v_add_f32 v176,v148,v149
v_add_f32 v177,v150,v151
v_mfma_f32_16x16x32_bf16 a[196:199],v[92:95],v[96:99],a[196:199]
v_add_f32 v178,v152,v153
v_add_f32 v179,v154,v155
s_waitcnt lgkmcnt(1)
v_mfma_f32_16x16x32_bf16 a[208:211],v[64:67],v[100:103],a[208:211]
ds_read_b128 v[108:111],v115 offset:14336
v_add_f32 v180,v156,v157
v_mfma_f32_16x16x32_bf16 a[212:215],v[68:71],v[100:103],a[212:215]
v_add_f32 v181,v158,v159
v_add_f32 v182,v160,v161
v_mfma_f32_16x16x32_bf16 a[216:219],v[72:75],v[100:103],a[216:219]
v_add_f32 v183,v162,v163
ds_write_b32 v11,v176 offset:128
v_mfma_f32_16x16x32_bf16 a[220:223],v[76:79],v[100:103],a[220:223]
ds_write_b32 v11,v177 offset:192
ds_write_b32 v11,v178 offset:256
v_mfma_f32_16x16x32_bf16 a[224:227],v[80:83],v[100:103],a[224:227]
ds_write_b32 v11,v179 offset:320
ds_write_b32 v11,v180 offset:384
v_mfma_f32_16x16x32_bf16 a[228:231],v[84:87],v[100:103],a[228:231]
ds_write_b32 v11,v181 offset:448
ds_write_b32 v11,v182 offset:512
v_mfma_f32_16x16x32_bf16 a[232:235],v[88:91],v[100:103],a[232:235]
ds_write_b32 v11,v183 offset:576
v_lshrrev_b32 v3,5,v2
v_mfma_f32_16x16x32_bf16 a[236:239],v[92:95],v[100:103],a[236:239]
v_lshlrev_b32 v3,12,v3
v_lshl_add_u32 v3,v4,9,v3
s_waitcnt lgkmcnt(9)
v_mfma_f32_16x16x32_bf16 a[248:251],v[64:67],v[104:107],a[248:251]
v_lshl_add_u32 v150,v5,4,v3
v_add_u32 v6,1024,v14
v_mfma_f32_16x16x32_bf16 a[252:255],v[68:71],v[104:107],a[252:255]
v_add_u32 v152,2048,v14
v_add_u32 v153,3072,v14
v_mfma_f32_16x16x32_bf16 v[192:195],v[72:75],v[104:107],v[192:195]
ds_read2_b32 v[16:17],v6 offset0:0 offset1:16
ds_read2_b32 v[18:19],v6 offset0:32 offset1:48
v_mfma_f32_16x16x32_bf16 v[196:199],v[76:79],v[104:107],v[196:199]
ds_read2_b32 v[20:21],v6 offset0:64 offset1:80
ds_read2_b32 v[22:23],v6 offset0:96 offset1:112
v_mfma_f32_16x16x32_bf16 v[200:203],v[80:83],v[104:107],v[200:203]
ds_read2_b32 v[56:57],v152 offset0:0 offset1:16
ds_read2_b32 v[58:59],v152 offset0:32 offset1:48
v_mfma_f32_16x16x32_bf16 v[204:207],v[84:87],v[104:107],v[204:207]
s_waitcnt lgkmcnt(11)
ds_read2_b32 v[60:61],v152 offset0:64 offset1:80
ds_read2_b32 v[62:63],v152 offset0:96 offset1:112
v_mfma_f32_16x16x32_bf16 v[208:211],v[88:91],v[104:107],v[208:211]
ds_read2_b32 v[168:169],v153 offset0:0 offset1:16
ds_read2_b32 v[170:171],v153 offset0:32 offset1:48
v_mfma_f32_16x16x32_bf16 v[212:215],v[92:95],v[104:107],v[212:215]
s_waitcnt lgkmcnt(11)
ds_read2_b32 v[172:173],v153 offset0:64 offset1:80
ds_read2_b32 v[174:175],v153 offset0:96 offset1:112
v_mfma_f32_16x16x32_bf16 v[224:227],v[64:67],v[108:111],v[224:227]
s_lshl_b32 s52,s34,1
s_add_u32 s52,s52,s40
v_mfma_f32_16x16x32_bf16 v[228:231],v[68:71],v[108:111],v[228:231]
s_mul_i32 s52,s52,1179648
s_lshl_b32 s53,s35,2
v_mfma_f32_16x16x32_bf16 v[232:235],v[72:75],v[108:111],v[232:235]
s_lshl_b32 s54,s41,1
s_add_u32 s53,s53,s54
v_mfma_f32_16x16x32_bf16 v[236:239],v[76:79],v[108:111],v[236:239]
s_lshl_b32 s53,s53,13
s_add_u32 s52,s52,s53
v_mfma_f32_16x16x32_bf16 v[240:243],v[80:83],v[108:111],v[240:243]
s_add_u32 s52,s52,0x1000000
s_add_u32 s53,s52,8192
v_mfma_f32_16x16x32_bf16 v[244:247],v[84:87],v[108:111],v[244:247]
s_waitcnt lgkmcnt(0)
s_barrier
ds_read_b128 v[24:27],v13 offset:128
v_mfma_f32_16x16x32_bf16 v[248:251],v[88:91],v[108:111],v[248:251]
ds_read_b128 v[28:31],v13 offset:192
ds_read_b128 v[32:35],v13 offset:256
v_mfma_f32_16x16x32_bf16 v[252:255],v[92:95],v[108:111],v[252:255]
ds_read_b128 v[36:39],v13 offset:320
ds_read_b128 v[40:43],v13 offset:1024
s_nop 7
ds_read_b128 v[44:47],v13 offset:1088
ds_read_b128 v[48:51],v13 offset:1152
ds_read_b128 v[52:55],v13 offset:1216
s_waitcnt lgkmcnt(6)
v_pk_fma_f32 v[64:65],v[24:25],v[22:23],v[224:225] op_sel:[0,1,0] op_sel_hi:[1,1,1]
v_pk_fma_f32 v[66:67],v[26:27],v[22:23],v[226:227] op_sel:[0,1,0] op_sel_hi:[1,1,1]
v_pk_fma_f32 v[68:69],v[28:29],v[22:23],v[228:229] op_sel:[0,1,0] op_sel_hi:[1,1,1]
v_pk_fma_f32 v[70:71],v[30:31],v[22:23],v[230:231] op_sel:[0,1,0] op_sel_hi:[1,1,1]
v_pk_mul_f32 v[80:81],v[64:65],v[62:63] op_sel:[0,1] op_sel_hi:[1,1]
v_pk_mul_f32 v[82:83],v[66:67],v[62:63] op_sel:[0,1] op_sel_hi:[1,1]
v_pk_mul_f32 v[84:85],v[68:69],v[62:63] op_sel:[0,1] op_sel_hi:[1,1]
v_pk_mul_f32 v[86:87],v[70:71],v[62:63] op_sel:[0,1] op_sel_hi:[1,1]
v_exp_f32 v80,v80
v_exp_f32 v81,v81
v_exp_f32 v82,v82
v_exp_f32 v83,v83
v_exp_f32 v84,v84
v_exp_f32 v85,v85
v_exp_f32 v86,v86
v_exp_f32 v87,v87
s_waitcnt lgkmcnt(2)
v_pk_fma_f32 v[72:73],v[40:41],v[22:23],v[240:241] op_sel:[0,1,0] op_sel_hi:[1,1,1]
v_pk_fma_f32 v[74:75],v[42:43],v[22:23],v[242:243] op_sel:[0,1,0] op_sel_hi:[1,1,1]
v_pk_fma_f32 v[76:77],v[44:45],v[22:23],v[244:245] op_sel:[0,1,0] op_sel_hi:[1,1,1]
v_pk_fma_f32 v[78:79],v[46:47],v[22:23],v[246:247] op_sel:[0,1,0] op_sel_hi:[1,1,1]
v_pk_fma_f32 v[80:81],v[80:81],v[174:175],v[174:175] op_sel:[0,1,1] op_sel_hi:[1,1,1]
v_pk_fma_f32 v[82:83],v[82:83],v[174:175],v[174:175] op_sel:[0,1,1] op_sel_hi:[1,1,1]
v_pk_fma_f32 v[84:85],v[84:85],v[174:175],v[174:175] op_sel:[0,1,1] op_sel_hi:[1,1,1]
v_pk_fma_f32 v[86:87],v[86:87],v[174:175],v[174:175] op_sel:[0,1,1] op_sel_hi:[1,1,1]
v_rcp_f32 v80,v80
v_rcp_f32 v81,v81
v_rcp_f32 v82,v82
v_rcp_f32 v83,v83
v_rcp_f32 v84,v84
v_rcp_f32 v85,v85
v_rcp_f32 v86,v86
v_rcp_f32 v87,v87
v_pk_mul_f32 v[64:65],v[64:65],v[72:73]
v_pk_mul_f32 v[66:67],v[66:67],v[74:75]
v_pk_mul_f32 v[68:69],v[68:69],v[76:77]
v_pk_mul_f32 v[70:71],v[70:71],v[78:79]
v_pk_mul_f32 v[64:65],v[64:65],v[80:81]
v_pk_mul_f32 v[66:67],v[66:67],v[82:83]
v_pk_mul_f32 v[68:69],v[68:69],v[84:85]
v_pk_mul_f32 v[70:71],v[70:71],v[86:87]
v_cvt_pk_bf16_f32 v176,v64,v65
v_cvt_pk_bf16_f32 v177,v66,v67
v_cvt_pk_bf16_f32 v178,v68,v69
v_cvt_pk_bf16_f32 v179,v70,v71
s_waitcnt vmcnt(0) lgkmcnt(0)
s_barrier
s_lshl_b32 s62,s35,7
s_lshl_b32 s63,s34,2
s_add_u32 s62,s62,s63
s_add_u32 s62,s62,0x2700000
s_cmp_lg_u32 s31,0
s_cbranch_scc1 L_fqA
v_mov_b32 v10,1
v_mov_b32 v11,0
s_mov_b64 exec,1
buffer_store_dword v10,v11,s[20:23],s62 offen sc1
s_mov_b64 exec,-1
L_fqA:
v_pk_fma_f32 v[96:97],v[32:33],v[22:23],v[232:233] op_sel:[0,1,0] op_sel_hi:[1,1,1]
v_pk_fma_f32 v[98:99],v[34:35],v[22:23],v[234:235] op_sel:[0,1,0] op_sel_hi:[1,1,1]
v_pk_fma_f32 v[100:101],v[36:37],v[22:23],v[236:237] op_sel:[0,1,0] op_sel_hi:[1,1,1]
v_pk_fma_f32 v[102:103],v[38:39],v[22:23],v[238:239] op_sel:[0,1,0] op_sel_hi:[1,1,1]
v_pk_mul_f32 v[112:113],v[96:97],v[62:63] op_sel:[0,1] op_sel_hi:[1,1]
v_pk_mul_f32 v[114:115],v[98:99],v[62:63] op_sel:[0,1] op_sel_hi:[1,1]
v_pk_mul_f32 v[116:117],v[100:101],v[62:63] op_sel:[0,1] op_sel_hi:[1,1]
v_pk_mul_f32 v[118:119],v[102:103],v[62:63] op_sel:[0,1] op_sel_hi:[1,1]
v_exp_f32 v112,v112
v_exp_f32 v113,v113
v_exp_f32 v114,v114
v_exp_f32 v115,v115
v_exp_f32 v116,v116
v_exp_f32 v117,v117
v_exp_f32 v118,v118
v_exp_f32 v119,v119
v_pk_fma_f32 v[104:105],v[48:49],v[22:23],v[248:249] op_sel:[0,1,0] op_sel_hi:[1,1,1]
v_pk_fma_f32 v[106:107],v[50:51],v[22:23],v[250:251] op_sel:[0,1,0] op_sel_hi:[1,1,1]
v_pk_fma_f32 v[108:109],v[52:53],v[22:23],v[252:253] op_sel:[0,1,0] op_sel_hi:[1,1,1]
v_pk_fma_f32 v[110:111],v[54:55],v[22:23],v[254:255] op_sel:[0,1,0] op_sel_hi:[1,1,1]
v_pk_fma_f32 v[112:113],v[112:113],v[174:175],v[174:175] op_sel:[0,1,1] op_sel_hi:[1,1,1]
v_pk_fma_f32 v[114:115],v[114:115],v[174:175],v[174:175] op_sel:[0,1,1] op_sel_hi:[1,1,1]
v_pk_fma_f32 v[116:117],v[116:117],v[174:175],v[174:175] op_sel:[0,1,1] op_sel_hi:[1,1,1]
v_pk_fma_f32 v[118:119],v[118:119],v[174:175],v[174:175] op_sel:[0,1,1] op_sel_hi:[1,1,1]
v_rcp_f32 v112,v112
v_rcp_f32 v113,v113
v_rcp_f32 v114,v114
v_rcp_f32 v115,v115
v_rcp_f32 v116,v116
v_rcp_f32 v117,v117
v_rcp_f32 v118,v118
v_rcp_f32 v119,v119
v_pk_mul_f32 v[96:97],v[96:97],v[104:105]
v_pk_mul_f32 v[98:99],v[98:99],v[106:107]
v_pk_mul_f32 v[100:101],v[100:101],v[108:109]
v_pk_mul_f32 v[102:103],v[102:103],v[110:111]
v_pk_mul_f32 v[96:97],v[96:97],v[112:113]
v_pk_mul_f32 v[98:99],v[98:99],v[114:115]
v_pk_mul_f32 v[100:101],v[100:101],v[116:117]
v_pk_mul_f32 v[102:103],v[102:103],v[118:119]
v_cvt_pk_bf16_f32 v180,v96,v97
v_cvt_pk_bf16_f32 v181,v98,v99
v_cvt_pk_bf16_f32 v182,v100,v101
v_cvt_pk_bf16_f32 v183,v102,v103
buffer_store_dwordx4 v[176:179],v150,s[20:23],s52 offen offset:3328 sc1
v_accvgpr_read_b32 v64,a248
v_accvgpr_read_b32 v65,a249
v_accvgpr_read_b32 v66,a250
v_accvgpr_read_b32 v67,a251
v_accvgpr_read_b32 v68,a252
v_accvgpr_read_b32 v69,a253
v_accvgpr_read_b32 v70,a254
v_accvgpr_read_b32 v71,a255
v_pk_fma_f32 v[64:65],v[24:25],v[22:23],v[64:65] op_sel:[0,0,0] op_sel_hi:[1,0,1]
v_pk_fma_f32 v[66:67],v[26:27],v[22:23],v[66:67] op_sel:[0,0,0] op_sel_hi:[1,0,1]
v_pk_fma_f32 v[68:69],v[28:29],v[22:23],v[68:69] op_sel:[0,0,0] op_sel_hi:[1,0,1]
v_pk_fma_f32 v[70:71],v[30:31],v[22:23],v[70:71] op_sel:[0,0,0] op_sel_hi:[1,0,1]
v_pk_mul_f32 v[80:81],v[64:65],v[62:63] op_sel:[0,0] op_sel_hi:[1,0]
v_pk_mul_f32 v[82:83],v[66:67],v[62:63] op_sel:[0,0] op_sel_hi:[1,0]
v_pk_mul_f32 v[84:85],v[68:69],v[62:63] op_sel:[0,0] op_sel_hi:[1,0]
v_pk_mul_f32 v[86:87],v[70:71],v[62:63] op_sel:[0,0] op_sel_hi:[1,0]
v_exp_f32 v80,v80
v_exp_f32 v81,v81
v_exp_f32 v82,v82
v_exp_f32 v83,v83
v_exp_f32 v84,v84
v_exp_f32 v85,v85
v_exp_f32 v86,v86
v_exp_f32 v87,v87
v_pk_fma_f32 v[72:73],v[40:41],v[22:23],v[200:201] op_sel:[0,0,0] op_sel_hi:[1,0,1]
v_pk_fma_f32 v[74:75],v[42:43],v[22:23],v[202:203] op_sel:[0,0,0] op_sel_hi:[1,0,1]
v_pk_fma_f32 v[76:77],v[44:45],v[22:23],v[204:205] op_sel:[0,0,0] op_sel_hi:[1,0,1]
v_pk_fma_f32 v[78:79],v[46:47],v[22:23],v[206:207] op_sel:[0,0,0] op_sel_hi:[1,0,1]
v_pk_fma_f32 v[80:81],v[80:81],v[174:175],v[174:175] op_sel:[0,0,0] op_sel_hi:[1,0,0]
v_pk_fma_f32 v[82:83],v[82:83],v[174:175],v[174:175] op_sel:[0,0,0] op_sel_hi:[1,0,0]
v_pk_fma_f32 v[84:85],v[84:85],v[174:175],v[174:175] op_sel:[0,0,0] op_sel_hi:[1,0,0]
v_pk_fma_f32 v[86:87],v[86:87],v[174:175],v[174:175] op_sel:[0,0,0] op_sel_hi:[1,0,0]
v_rcp_f32 v80,v80
v_rcp_f32 v81,v81
v_rcp_f32 v82,v82
v_rcp_f32 v83,v83
v_rcp_f32 v84,v84
v_rcp_f32 v85,v85
v_rcp_f32 v86,v86
v_rcp_f32 v87,v87
v_pk_mul_f32 v[64:65],v[64:65],v[72:73]
v_pk_mul_f32 v[66:67],v[66:67],v[74:75]
v_pk_mul_f32 v[68:69],v[68:69],v[76:77]
v_pk_mul_f32 v[70:71],v[70:71],v[78:79]
v_pk_mul_f32 v[64:65],v[64:65],v[80:81]
v_pk_mul_f32 v[66:67],v[66:67],v[82:83]
v_pk_mul_f32 v[68:69],v[68:69],v[84:85]
v_pk_mul_f32 v[70:71],v[70:71],v[86:87]
v_cvt_pk_bf16_f32 v184,v64,v65
v_cvt_pk_bf16_f32 v185,v66,v67
v_cvt_pk_bf16_f32 v186,v68,v69
v_cvt_pk_bf16_f32 v187,v70,v71
buffer_store_dwordx4 v[180:183],v150,s[20:23],s53 offen offset:3328 sc1
v_pk_fma_f32 v[96:97],v[32:33],v[22:23],v[192:193] op_sel:[0,0,0] op_sel_hi:[1,0,1]
v_pk_fma_f32 v[98:99],v[34:35],v[22:23],v[194:195] op_sel:[0,0,0] op_sel_hi:[1,0,1]
v_pk_fma_f32 v[100:101],v[36:37],v[22:23],v[196:197] op_sel:[0,0,0] op_sel_hi:[1,0,1]
v_pk_fma_f32 v[102:103],v[38:39],v[22:23],v[198:199] op_sel:[0,0,0] op_sel_hi:[1,0,1]
v_pk_mul_f32 v[112:113],v[96:97],v[62:63] op_sel:[0,0] op_sel_hi:[1,0]
v_pk_mul_f32 v[114:115],v[98:99],v[62:63] op_sel:[0,0] op_sel_hi:[1,0]
v_pk_mul_f32 v[116:117],v[100:101],v[62:63] op_sel:[0,0] op_sel_hi:[1,0]
v_pk_mul_f32 v[118:119],v[102:103],v[62:63] op_sel:[0,0] op_sel_hi:[1,0]
v_exp_f32 v112,v112
v_exp_f32 v113,v113
v_exp_f32 v114,v114
v_exp_f32 v115,v115
v_exp_f32 v116,v116
v_exp_f32 v117,v117
v_exp_f32 v118,v118
v_exp_f32 v119,v119
v_pk_fma_f32 v[104:105],v[48:49],v[22:23],v[208:209] op_sel:[0,0,0] op_sel_hi:[1,0,1]
v_pk_fma_f32 v[106:107],v[50:51],v[22:23],v[210:211] op_sel:[0,0,0] op_sel_hi:[1,0,1]
v_pk_fma_f32 v[108:109],v[52:53],v[22:23],v[212:213] op_sel:[0,0,0] op_sel_hi:[1,0,1]
v_pk_fma_f32 v[110:111],v[54:55],v[22:23],v[214:215] op_sel:[0,0,0] op_sel_hi:[1,0,1]
v_pk_fma_f32 v[112:113],v[112:113],v[174:175],v[174:175] op_sel:[0,0,0] op_sel_hi:[1,0,0]
v_pk_fma_f32 v[114:115],v[114:115],v[174:175],v[174:175] op_sel:[0,0,0] op_sel_hi:[1,0,0]
v_pk_fma_f32 v[116:117],v[116:117],v[174:175],v[174:175] op_sel:[0,0,0] op_sel_hi:[1,0,0]
v_pk_fma_f32 v[118:119],v[118:119],v[174:175],v[174:175] op_sel:[0,0,0] op_sel_hi:[1,0,0]
v_rcp_f32 v112,v112
v_rcp_f32 v113,v113
v_rcp_f32 v114,v114
v_rcp_f32 v115,v115
v_rcp_f32 v116,v116
v_rcp_f32 v117,v117
v_rcp_f32 v118,v118
v_rcp_f32 v119,v119
v_pk_mul_f32 v[96:97],v[96:97],v[104:105]
v_pk_mul_f32 v[98:99],v[98:99],v[106:107]
v_pk_mul_f32 v[100:101],v[100:101],v[108:109]
v_pk_mul_f32 v[102:103],v[102:103],v[110:111]
v_pk_mul_f32 v[96:97],v[96:97],v[112:113]
v_pk_mul_f32 v[98:99],v[98:99],v[114:115]
v_pk_mul_f32 v[100:101],v[100:101],v[116:117]
v_pk_mul_f32 v[102:103],v[102:103],v[118:119]
v_cvt_pk_bf16_f32 v188,v96,v97
v_cvt_pk_bf16_f32 v189,v98,v99
v_cvt_pk_bf16_f32 v190,v100,v101
v_cvt_pk_bf16_f32 v191,v102,v103
buffer_store_dwordx4 v[184:187],v150,s[20:23],s52 offen offset:3072 sc1
v_accvgpr_read_b32 v64,a8
v_accvgpr_read_b32 v65,a9
v_accvgpr_read_b32 v66,a10
v_accvgpr_read_b32 v67,a11
v_accvgpr_read_b32 v68,a12
v_accvgpr_read_b32 v69,a13
v_accvgpr_read_b32 v70,a14
v_accvgpr_read_b32 v71,a15
v_pk_fma_f32 v[64:65],v[24:25],v[16:17],v[64:65] op_sel:[0,0,0] op_sel_hi:[1,0,1]
v_pk_fma_f32 v[66:67],v[26:27],v[16:17],v[66:67] op_sel:[0,0,0] op_sel_hi:[1,0,1]
v_pk_fma_f32 v[68:69],v[28:29],v[16:17],v[68:69] op_sel:[0,0,0] op_sel_hi:[1,0,1]
v_pk_fma_f32 v[70:71],v[30:31],v[16:17],v[70:71] op_sel:[0,0,0] op_sel_hi:[1,0,1]
v_pk_mul_f32 v[80:81],v[64:65],v[56:57] op_sel:[0,0] op_sel_hi:[1,0]
v_pk_mul_f32 v[82:83],v[66:67],v[56:57] op_sel:[0,0] op_sel_hi:[1,0]
v_pk_mul_f32 v[84:85],v[68:69],v[56:57] op_sel:[0,0] op_sel_hi:[1,0]
v_pk_mul_f32 v[86:87],v[70:71],v[56:57] op_sel:[0,0] op_sel_hi:[1,0]
v_exp_f32 v80,v80
v_exp_f32 v81,v81
v_exp_f32 v82,v82
v_exp_f32 v83,v83
v_exp_f32 v84,v84
v_exp_f32 v85,v85
v_exp_f32 v86,v86
v_exp_f32 v87,v87
v_accvgpr_read_b32 v72,a24
v_accvgpr_read_b32 v73,a25
v_accvgpr_read_b32 v74,a26
v_accvgpr_read_b32 v75,a27
v_accvgpr_read_b32 v76,a28
v_accvgpr_read_b32 v77,a29
v_accvgpr_read_b32 v78,a30
v_accvgpr_read_b32 v79,a31
v_pk_fma_f32 v[72:73],v[40:41],v[16:17],v[72:73] op_sel:[0,0,0] op_sel_hi:[1,0,1]
v_pk_fma_f32 v[74:75],v[42:43],v[16:17],v[74:75] op_sel:[0,0,0] op_sel_hi:[1,0,1]
v_pk_fma_f32 v[76:77],v[44:45],v[16:17],v[76:77] op_sel:[0,0,0] op_sel_hi:[1,0,1]
v_pk_fma_f32 v[78:79],v[46:47],v[16:17],v[78:79] op_sel:[0,0,0] op_sel_hi:[1,0,1]
v_pk_fma_f32 v[80:81],v[80:81],v[168:169],v[168:169] op_sel:[0,0,0] op_sel_hi:[1,0,0]
v_pk_fma_f32 v[82:83],v[82:83],v[168:169],v[168:169] op_sel:[0,0,0] op_sel_hi:[1,0,0]
v_pk_fma_f32 v[84:85],v[84:85],v[168:169],v[168:169] op_sel:[0,0,0] op_sel_hi:[1,0,0]
v_pk_fma_f32 v[86:87],v[86:87],v[168:169],v[168:169] op_sel:[0,0,0] op_sel_hi:[1,0,0]
v_rcp_f32 v80,v80
v_rcp_f32 v81,v81
v_rcp_f32 v82,v82
v_rcp_f32 v83,v83
v_rcp_f32 v84,v84
v_rcp_f32 v85,v85
v_rcp_f32 v86,v86
v_rcp_f32 v87,v87
v_pk_mul_f32 v[64:65],v[64:65],v[72:73]
v_pk_mul_f32 v[66:67],v[66:67],v[74:75]
v_pk_mul_f32 v[68:69],v[68:69],v[76:77]
v_pk_mul_f32 v[70:71],v[70:71],v[78:79]
v_pk_mul_f32 v[64:65],v[64:65],v[80:81]
v_pk_mul_f32 v[66:67],v[66:67],v[82:83]
v_pk_mul_f32 v[68:69],v[68:69],v[84:85]
v_pk_mul_f32 v[70:71],v[70:71],v[86:87]
v_cvt_pk_bf16_f32 v192,v64,v65
v_cvt_pk_bf16_f32 v193,v66,v67
v_cvt_pk_bf16_f32 v194,v68,v69
v_cvt_pk_bf16_f32 v195,v70,v71
buffer_store_dwordx4 v[188:191],v150,s[20:23],s53 offen offset:3072 sc1
v_accvgpr_read_b32 v96,a16
v_accvgpr_read_b32 v97,a17
v_accvgpr_read_b32 v98,a18
v_accvgpr_read_b32 v99,a19
v_accvgpr_read_b32 v100,a20
v_accvgpr_read_b32 v101,a21
v_accvgpr_read_b32 v102,a22
v_accvgpr_read_b32 v103,a23
v_pk_fma_f32 v[96:97],v[32:33],v[16:17],v[96:97] op_sel:[0,0,0] op_sel_hi:[1,0,1]
v_pk_fma_f32 v[98:99],v[34:35],v[16:17],v[98:99] op_sel:[0,0,0] op_sel_hi:[1,0,1]
v_pk_fma_f32 v[100:101],v[36:37],v[16:17],v[100:101] op_sel:[0,0,0] op_sel_hi:[1,0,1]
v_pk_fma_f32 v[102:103],v[38:39],v[16:17],v[102:103] op_sel:[0,0,0] op_sel_hi:[1,0,1]
v_pk_mul_f32 v[112:113],v[96:97],v[56:57] op_sel:[0,0] op_sel_hi:[1,0]
v_pk_mul_f32 v[114:115],v[98:99],v[56:57] op_sel:[0,0] op_sel_hi:[1,0]
v_pk_mul_f32 v[116:117],v[100:101],v[56:57] op_sel:[0,0] op_sel_hi:[1,0]
v_pk_mul_f32 v[118:119],v[102:103],v[56:57] op_sel:[0,0] op_sel_hi:[1,0]
v_exp_f32 v112,v112
v_exp_f32 v113,v113
v_exp_f32 v114,v114
v_exp_f32 v115,v115
v_exp_f32 v116,v116
v_exp_f32 v117,v117
v_exp_f32 v118,v118
v_exp_f32 v119,v119
v_accvgpr_read_b32 v104,a32
v_accvgpr_read_b32 v105,a33
v_accvgpr_read_b32 v106,a34
v_accvgpr_read_b32 v107,a35
v_accvgpr_read_b32 v108,a36
v_accvgpr_read_b32 v109,a37
v_accvgpr_read_b32 v110,a38
v_accvgpr_read_b32 v111,a39
v_pk_fma_f32 v[104:105],v[48:49],v[16:17],v[104:105] op_sel:[0,0,0] op_sel_hi:[1,0,1]
v_pk_fma_f32 v[106:107],v[50:51],v[16:17],v[106:107] op_sel:[0,0,0] op_sel_hi:[1,0,1]
v_pk_fma_f32 v[108:109],v[52:53],v[16:17],v[108:109] op_sel:[0,0,0] op_sel_hi:[1,0,1]
v_pk_fma_f32 v[110:111],v[54:55],v[16:17],v[110:111] op_sel:[0,0,0] op_sel_hi:[1,0,1]
v_pk_fma_f32 v[112:113],v[112:113],v[168:169],v[168:169] op_sel:[0,0,0] op_sel_hi:[1,0,0]
v_pk_fma_f32 v[114:115],v[114:115],v[168:169],v[168:169] op_sel:[0,0,0] op_sel_hi:[1,0,0]
v_pk_fma_f32 v[116:117],v[116:117],v[168:169],v[168:169] op_sel:[0,0,0] op_sel_hi:[1,0,0]
v_pk_fma_f32 v[118:119],v[118:119],v[168:169],v[168:169] op_sel:[0,0,0] op_sel_hi:[1,0,0]
v_rcp_f32 v112,v112
v_rcp_f32 v113,v113
v_rcp_f32 v114,v114
v_rcp_f32 v115,v115
v_rcp_f32 v116,v116
v_rcp_f32 v117,v117
v_rcp_f32 v118,v118
v_rcp_f32 v119,v119
v_pk_mul_f32 v[96:97],v[96:97],v[104:105]
v_pk_mul_f32 v[98:99],v[98:99],v[106:107]
v_pk_mul_f32 v[100:101],v[100:101],v[108:109]
v_pk_mul_f32 v[102:103],v[102:103],v[110:111]
v_pk_mul_f32 v[96:97],v[96:97],v[112:113]
v_pk_mul_f32 v[98:99],v[98:99],v[114:115]
v_pk_mul_f32 v[100:101],v[100:101],v[116:117]
v_pk_mul_f32 v[102:103],v[102:103],v[118:119]
v_cvt_pk_bf16_f32 v196,v96,v97
v_cvt_pk_bf16_f32 v197,v98,v99
v_cvt_pk_bf16_f32 v198,v100,v101
v_cvt_pk_bf16_f32 v199,v102,v103
buffer_store_dwordx4 v[192:195],v150,s[20:23],s52 offen sc1
v_accvgpr_read_b32 v64,a48
v_accvgpr_read_b32 v65,a49
v_accvgpr_read_b32 v66,a50
v_accvgpr_read_b32 v67,a51
v_accvgpr_read_b32 v68,a52
v_accvgpr_read_b32 v69,a53
v_accvgpr_read_b32 v70,a54
v_accvgpr_read_b32 v71,a55
v_pk_fma_f32 v[64:65],v[24:25],v[16:17],v[64:65] op_sel:[0,1,0] op_sel_hi:[1,1,1]
v_pk_fma_f32 v[66:67],v[26:27],v[16:17],v[66:67] op_sel:[0,1,0] op_sel_hi:[1,1,1]
v_pk_fma_f32 v[68:69],v[28:29],v[16:17],v[68:69] op_sel:[0,1,0] op_sel_hi:[1,1,1]
v_pk_fma_f32 v[70:71],v[30:31],v[16:17],v[70:71] op_sel:[0,1,0] op_sel_hi:[1,1,1]
v_pk_mul_f32 v[80:81],v[64:65],v[56:57] op_sel:[0,1] op_sel_hi:[1,1]
v_pk_mul_f32 v[82:83],v[66:67],v[56:57] op_sel:[0,1] op_sel_hi:[1,1]
v_pk_mul_f32 v[84:85],v[68:69],v[56:57] op_sel:[0,1] op_sel_hi:[1,1]
v_pk_mul_f32 v[86:87],v[70:71],v[56:57] op_sel:[0,1] op_sel_hi:[1,1]
v_exp_f32 v80,v80
v_exp_f32 v81,v81
v_exp_f32 v82,v82
v_exp_f32 v83,v83
v_exp_f32 v84,v84
v_exp_f32 v85,v85
v_exp_f32 v86,v86
v_exp_f32 v87,v87
v_accvgpr_read_b32 v72,a64
v_accvgpr_read_b32 v73,a65
v_accvgpr_read_b32 v74,a66
v_accvgpr_read_b32 v75,a67
v_accvgpr_read_b32 v76,a68
v_accvgpr_read_b32 v77,a69
v_accvgpr_read_b32 v78,a70
v_accvgpr_read_b32 v79,a71
v_pk_fma_f32 v[72:73],v[40:41],v[16:17],v[72:73] op_sel:[0,1,0] op_sel_hi:[1,1,1]
v_pk_fma_f32 v[74:75],v[42:43],v[16:17],v[74:75] op_sel:[0,1,0] op_sel_hi:[1,1,1]
v_pk_fma_f32 v[76:77],v[44:45],v[16:17],v[76:77] op_sel:[0,1,0] op_sel_hi:[1,1,1]
v_pk_fma_f32 v[78:79],v[46:47],v[16:17],v[78:79] op_sel:[0,1,0] op_sel_hi:[1,1,1]
v_pk_fma_f32 v[80:81],v[80:81],v[168:169],v[168:169] op_sel:[0,1,1] op_sel_hi:[1,1,1]
v_pk_fma_f32 v[82:83],v[82:83],v[168:169],v[168:169] op_sel:[0,1,1] op_sel_hi:[1,1,1]
v_pk_fma_f32 v[84:85],v[84:85],v[168:169],v[168:169] op_sel:[0,1,1] op_sel_hi:[1,1,1]
v_pk_fma_f32 v[86:87],v[86:87],v[168:169],v[168:169] op_sel:[0,1,1] op_sel_hi:[1,1,1]
v_rcp_f32 v80,v80
v_rcp_f32 v81,v81
v_rcp_f32 v82,v82
v_rcp_f32 v83,v83
v_rcp_f32 v84,v84
v_rcp_f32 v85,v85
v_rcp_f32 v86,v86
v_rcp_f32 v87,v87
v_pk_mul_f32 v[64:65],v[64:65],v[72:73]
v_pk_mul_f32 v[66:67],v[66:67],v[74:75]
v_pk_mul_f32 v[68:69],v[68:69],v[76:77]
v_pk_mul_f32 v[70:71],v[70:71],v[78:79]
v_pk_mul_f32 v[64:65],v[64:65],v[80:81]
v_pk_mul_f32 v[66:67],v[66:67],v[82:83]
v_pk_mul_f32 v[68:69],v[68:69],v[84:85]
v_pk_mul_f32 v[70:71],v[70:71],v[86:87]
v_cvt_pk_bf16_f32 v200,v64,v65
v_cvt_pk_bf16_f32 v201,v66,v67
v_cvt_pk_bf16_f32 v202,v68,v69
v_cvt_pk_bf16_f32 v203,v70,v71
buffer_store_dwordx4 v[196:199],v150,s[20:23],s53 offen sc1
v_accvgpr_read_b32 v96,a56
v_accvgpr_read_b32 v97,a57
v_accvgpr_read_b32 v98,a58
v_accvgpr_read_b32 v99,a59
v_accvgpr_read_b32 v100,a60
v_accvgpr_read_b32 v101,a61
v_accvgpr_read_b32 v102,a62
v_accvgpr_read_b32 v103,a63
v_pk_fma_f32 v[96:97],v[32:33],v[16:17],v[96:97] op_sel:[0,1,0] op_sel_hi:[1,1,1]
v_pk_fma_f32 v[98:99],v[34:35],v[16:17],v[98:99] op_sel:[0,1,0] op_sel_hi:[1,1,1]
v_pk_fma_f32 v[100:101],v[36:37],v[16:17],v[100:101] op_sel:[0,1,0] op_sel_hi:[1,1,1]
v_pk_fma_f32 v[102:103],v[38:39],v[16:17],v[102:103] op_sel:[0,1,0] op_sel_hi:[1,1,1]
v_pk_mul_f32 v[112:113],v[96:97],v[56:57] op_sel:[0,1] op_sel_hi:[1,1]
v_pk_mul_f32 v[114:115],v[98:99],v[56:57] op_sel:[0,1] op_sel_hi:[1,1]
v_pk_mul_f32 v[116:117],v[100:101],v[56:57] op_sel:[0,1] op_sel_hi:[1,1]
v_pk_mul_f32 v[118:119],v[102:103],v[56:57] op_sel:[0,1] op_sel_hi:[1,1]
v_exp_f32 v112,v112
v_exp_f32 v113,v113
v_exp_f32 v114,v114
v_exp_f32 v115,v115
v_exp_f32 v116,v116
v_exp_f32 v117,v117
v_exp_f32 v118,v118
v_exp_f32 v119,v119
v_accvgpr_read_b32 v104,a72
v_accvgpr_read_b32 v105,a73
v_accvgpr_read_b32 v106,a74
v_accvgpr_read_b32 v107,a75
v_accvgpr_read_b32 v108,a76
v_accvgpr_read_b32 v109,a77
v_accvgpr_read_b32 v110,a78
v_accvgpr_read_b32 v111,a79
v_pk_fma_f32 v[104:105],v[48:49],v[16:17],v[104:105] op_sel:[0,1,0] op_sel_hi:[1,1,1]
v_pk_fma_f32 v[106:107],v[50:51],v[16:17],v[106:107] op_sel:[0,1,0] op_sel_hi:[1,1,1]
v_pk_fma_f32 v[108:109],v[52:53],v[16:17],v[108:109] op_sel:[0,1,0] op_sel_hi:[1,1,1]
v_pk_fma_f32 v[110:111],v[54:55],v[16:17],v[110:111] op_sel:[0,1,0] op_sel_hi:[1,1,1]
v_pk_fma_f32 v[112:113],v[112:113],v[168:169],v[168:169] op_sel:[0,1,1] op_sel_hi:[1,1,1]
v_pk_fma_f32 v[114:115],v[114:115],v[168:169],v[168:169] op_sel:[0,1,1] op_sel_hi:[1,1,1]
v_pk_fma_f32 v[116:117],v[116:117],v[168:169],v[168:169] op_sel:[0,1,1] op_sel_hi:[1,1,1]
v_pk_fma_f32 v[118:119],v[118:119],v[168:169],v[168:169] op_sel:[0,1,1] op_sel_hi:[1,1,1]
v_rcp_f32 v112,v112
v_rcp_f32 v113,v113
v_rcp_f32 v114,v114
v_rcp_f32 v115,v115
v_rcp_f32 v116,v116
v_rcp_f32 v117,v117
v_rcp_f32 v118,v118
v_rcp_f32 v119,v119
v_pk_mul_f32 v[96:97],v[96:97],v[104:105]
v_pk_mul_f32 v[98:99],v[98:99],v[106:107]
v_pk_mul_f32 v[100:101],v[100:101],v[108:109]
v_pk_mul_f32 v[102:103],v[102:103],v[110:111]
v_pk_mul_f32 v[96:97],v[96:97],v[112:113]
v_pk_mul_f32 v[98:99],v[98:99],v[114:115]
v_pk_mul_f32 v[100:101],v[100:101],v[116:117]
v_pk_mul_f32 v[102:103],v[102:103],v[118:119]
v_cvt_pk_bf16_f32 v204,v96,v97
v_cvt_pk_bf16_f32 v205,v98,v99
v_cvt_pk_bf16_f32 v206,v100,v101
v_cvt_pk_bf16_f32 v207,v102,v103
buffer_store_dwordx4 v[200:203],v150,s[20:23],s52 offen offset:256 sc1
v_accvgpr_read_b32 v64,a88
v_accvgpr_read_b32 v65,a89
v_accvgpr_read_b32 v66,a90
v_accvgpr_read_b32 v67,a91
v_accvgpr_read_b32 v68,a92
v_accvgpr_read_b32 v69,a93
v_accvgpr_read_b32 v70,a94
v_accvgpr_read_b32 v71,a95
v_pk_fma_f32 v[64:65],v[24:25],v[18:19],v[64:65] op_sel:[0,0,0] op_sel_hi:[1,0,1]
v_pk_fma_f32 v[66:67],v[26:27],v[18:19],v[66:67] op_sel:[0,0,0] op_sel_hi:[1,0,1]
v_pk_fma_f32 v[68:69],v[28:29],v[18:19],v[68:69] op_sel:[0,0,0] op_sel_hi:[1,0,1]
v_pk_fma_f32 v[70:71],v[30:31],v[18:19],v[70:71] op_sel:[0,0,0] op_sel_hi:[1,0,1]
v_pk_mul_f32 v[80:81],v[64:65],v[58:59] op_sel:[0,0] op_sel_hi:[1,0]
v_pk_mul_f32 v[82:83],v[66:67],v[58:59] op_sel:[0,0] op_sel_hi:[1,0]
v_pk_mul_f32 v[84:85],v[68:69],v[58:59] op_sel:[0,0] op_sel_hi:[1,0]
v_pk_mul_f32 v[86:87],v[70:71],v[58:59] op_sel:[0,0] op_sel_hi:[1,0]
v_exp_f32 v80,v80
v_exp_f32 v81,v81
v_exp_f32 v82,v82
v_exp_f32 v83,v83
v_exp_f32 v84,v84
v_exp_f32 v85,v85
v_exp_f32 v86,v86
v_exp_f32 v87,v87
v_accvgpr_read_b32 v72,a104
v_accvgpr_read_b32 v73,a105
v_accvgpr_read_b32 v74,a106
v_accvgpr_read_b32 v75,a107
v_accvgpr_read_b32 v76,a108
v_accvgpr_read_b32 v77,a109
v_accvgpr_read_b32 v78,a110
v_accvgpr_read_b32 v79,a111
v_pk_fma_f32 v[72:73],v[40:41],v[18:19],v[72:73] op_sel:[0,0,0] op_sel_hi:[1,0,1]
v_pk_fma_f32 v[74:75],v[42:43],v[18:19],v[74:75] op_sel:[0,0,0] op_sel_hi:[1,0,1]
v_pk_fma_f32 v[76:77],v[44:45],v[18:19],v[76:77] op_sel:[0,0,0] op_sel_hi:[1,0,1]
v_pk_fma_f32 v[78:79],v[46:47],v[18:19],v[78:79] op_sel:[0,0,0] op_sel_hi:[1,0,1]
v_pk_fma_f32 v[80:81],v[80:81],v[170:171],v[170:171] op_sel:[0,0,0] op_sel_hi:[1,0,0]
v_pk_fma_f32 v[82:83],v[82:83],v[170:171],v[170:171] op_sel:[0,0,0] op_sel_hi:[1,0,0]
v_pk_fma_f32 v[84:85],v[84:85],v[170:171],v[170:171] op_sel:[0,0,0] op_sel_hi:[1,0,0]
v_pk_fma_f32 v[86:87],v[86:87],v[170:171],v[170:171] op_sel:[0,0,0] op_sel_hi:[1,0,0]
v_rcp_f32 v80,v80
v_rcp_f32 v81,v81
v_rcp_f32 v82,v82
v_rcp_f32 v83,v83
v_rcp_f32 v84,v84
v_rcp_f32 v85,v85
v_rcp_f32 v86,v86
v_rcp_f32 v87,v87
v_pk_mul_f32 v[64:65],v[64:65],v[72:73]
v_pk_mul_f32 v[66:67],v[66:67],v[74:75]
v_pk_mul_f32 v[68:69],v[68:69],v[76:77]
v_pk_mul_f32 v[70:71],v[70:71],v[78:79]
v_pk_mul_f32 v[64:65],v[64:65],v[80:81]
v_pk_mul_f32 v[66:67],v[66:67],v[82:83]
v_pk_mul_f32 v[68:69],v[68:69],v[84:85]
v_pk_mul_f32 v[70:71],v[70:71],v[86:87]
v_cvt_pk_bf16_f32 v208,v64,v65
v_cvt_pk_bf16_f32 v209,v66,v67
v_cvt_pk_bf16_f32 v210,v68,v69
v_cvt_pk_bf16_f32 v211,v70,v71
buffer_store_dwordx4 v[204:207],v150,s[20:23],s53 offen offset:256 sc1
v_accvgpr_read_b32 v96,a96
v_accvgpr_read_b32 v97,a97
v_accvgpr_read_b32 v98,a98
v_accvgpr_read_b32 v99,a99
v_accvgpr_read_b32 v100,a100
v_accvgpr_read_b32 v101,a101
v_accvgpr_read_b32 v102,a102
v_accvgpr_read_b32 v103,a103
v_pk_fma_f32 v[96:97],v[32:33],v[18:19],v[96:97] op_sel:[0,0,0] op_sel_hi:[1,0,1]
v_pk_fma_f32 v[98:99],v[34:35],v[18:19],v[98:99] op_sel:[0,0,0] op_sel_hi:[1,0,1]
v_pk_fma_f32 v[100:101],v[36:37],v[18:19],v[100:101] op_sel:[0,0,0] op_sel_hi:[1,0,1]
v_pk_fma_f32 v[102:103],v[38:39],v[18:19],v[102:103] op_sel:[0,0,0] op_sel_hi:[1,0,1]
v_pk_mul_f32 v[112:113],v[96:97],v[58:59] op_sel:[0,0] op_sel_hi:[1,0]
v_pk_mul_f32 v[114:115],v[98:99],v[58:59] op_sel:[0,0] op_sel_hi:[1,0]
v_pk_mul_f32 v[116:117],v[100:101],v[58:59] op_sel:[0,0] op_sel_hi:[1,0]
v_pk_mul_f32 v[118:119],v[102:103],v[58:59] op_sel:[0,0] op_sel_hi:[1,0]
v_exp_f32 v112,v112
v_exp_f32 v113,v113
v_exp_f32 v114,v114
v_exp_f32 v115,v115
v_exp_f32 v116,v116
v_exp_f32 v117,v117
v_exp_f32 v118,v118
v_exp_f32 v119,v119
v_accvgpr_read_b32 v104,a112
v_accvgpr_read_b32 v105,a113
v_accvgpr_read_b32 v106,a114
v_accvgpr_read_b32 v107,a115
v_accvgpr_read_b32 v108,a116
v_accvgpr_read_b32 v109,a117
v_accvgpr_read_b32 v110,a118
v_accvgpr_read_b32 v111,a119
v_pk_fma_f32 v[104:105],v[48:49],v[18:19],v[104:105] op_sel:[0,0,0] op_sel_hi:[1,0,1]
v_pk_fma_f32 v[106:107],v[50:51],v[18:19],v[106:107] op_sel:[0,0,0] op_sel_hi:[1,0,1]
v_pk_fma_f32 v[108:109],v[52:53],v[18:19],v[108:109] op_sel:[0,0,0] op_sel_hi:[1,0,1]
v_pk_fma_f32 v[110:111],v[54:55],v[18:19],v[110:111] op_sel:[0,0,0] op_sel_hi:[1,0,1]
v_pk_fma_f32 v[112:113],v[112:113],v[170:171],v[170:171] op_sel:[0,0,0] op_sel_hi:[1,0,0]
v_pk_fma_f32 v[114:115],v[114:115],v[170:171],v[170:171] op_sel:[0,0,0] op_sel_hi:[1,0,0]
v_pk_fma_f32 v[116:117],v[116:117],v[170:171],v[170:171] op_sel:[0,0,0] op_sel_hi:[1,0,0]
v_pk_fma_f32 v[118:119],v[118:119],v[170:171],v[170:171] op_sel:[0,0,0] op_sel_hi:[1,0,0]
v_rcp_f32 v112,v112
v_rcp_f32 v113,v113
v_rcp_f32 v114,v114
v_rcp_f32 v115,v115
v_rcp_f32 v116,v116
v_rcp_f32 v117,v117
v_rcp_f32 v118,v118
v_rcp_f32 v119,v119
v_pk_mul_f32 v[96:97],v[96:97],v[104:105]
v_pk_mul_f32 v[98:99],v[98:99],v[106:107]
v_pk_mul_f32 v[100:101],v[100:101],v[108:109]
v_pk_mul_f32 v[102:103],v[102:103],v[110:111]
v_pk_mul_f32 v[96:97],v[96:97],v[112:113]
v_pk_mul_f32 v[98:99],v[98:99],v[114:115]
v_pk_mul_f32 v[100:101],v[100:101],v[116:117]
v_pk_mul_f32 v[102:103],v[102:103],v[118:119]
v_cvt_pk_bf16_f32 v212,v96,v97
v_cvt_pk_bf16_f32 v213,v98,v99
v_cvt_pk_bf16_f32 v214,v100,v101
v_cvt_pk_bf16_f32 v215,v102,v103
buffer_store_dwordx4 v[208:211],v150,s[20:23],s52 offen offset:1024 sc1
v_accvgpr_read_b32 v64,a128
v_accvgpr_read_b32 v65,a129
v_accvgpr_read_b32 v66,a130
v_accvgpr_read_b32 v67,a131
v_accvgpr_read_b32 v68,a132
v_accvgpr_read_b32 v69,a133
v_accvgpr_read_b32 v70,a134
v_accvgpr_read_b32 v71,a135
v_pk_fma_f32 v[64:65],v[24:25],v[18:19],v[64:65] op_sel:[0,1,0] op_sel_hi:[1,1,1]
v_pk_fma_f32 v[66:67],v[26:27],v[18:19],v[66:67] op_sel:[0,1,0] op_sel_hi:[1,1,1]
v_pk_fma_f32 v[68:69],v[28:29],v[18:19],v[68:69] op_sel:[0,1,0] op_sel_hi:[1,1,1]
v_pk_fma_f32 v[70:71],v[30:31],v[18:19],v[70:71] op_sel:[0,1,0] op_sel_hi:[1,1,1]
v_pk_mul_f32 v[80:81],v[64:65],v[58:59] op_sel:[0,1] op_sel_hi:[1,1]
v_pk_mul_f32 v[82:83],v[66:67],v[58:59] op_sel:[0,1] op_sel_hi:[1,1]
v_pk_mul_f32 v[84:85],v[68:69],v[58:59] op_sel:[0,1] op_sel_hi:[1,1]
v_pk_mul_f32 v[86:87],v[70:71],v[58:59] op_sel:[0,1] op_sel_hi:[1,1]
v_exp_f32 v80,v80
v_exp_f32 v81,v81
v_exp_f32 v82,v82
v_exp_f32 v83,v83
v_exp_f32 v84,v84
v_exp_f32 v85,v85
v_exp_f32 v86,v86
v_exp_f32 v87,v87
v_accvgpr_read_b32 v72,a144
v_accvgpr_read_b32 v73,a145
v_accvgpr_read_b32 v74,a146
v_accvgpr_read_b32 v75,a147
v_accvgpr_read_b32 v76,a148
v_accvgpr_read_b32 v77,a149
v_accvgpr_read_b32 v78,a150
v_accvgpr_read_b32 v79,a151
v_pk_fma_f32 v[72:73],v[40:41],v[18:19],v[72:73] op_sel:[0,1,0] op_sel_hi:[1,1,1]
v_pk_fma_f32 v[74:75],v[42:43],v[18:19],v[74:75] op_sel:[0,1,0] op_sel_hi:[1,1,1]
v_pk_fma_f32 v[76:77],v[44:45],v[18:19],v[76:77] op_sel:[0,1,0] op_sel_hi:[1,1,1]
v_pk_fma_f32 v[78:79],v[46:47],v[18:19],v[78:79] op_sel:[0,1,0] op_sel_hi:[1,1,1]
v_pk_fma_f32 v[80:81],v[80:81],v[170:171],v[170:171] op_sel:[0,1,1] op_sel_hi:[1,1,1]
v_pk_fma_f32 v[82:83],v[82:83],v[170:171],v[170:171] op_sel:[0,1,1] op_sel_hi:[1,1,1]
v_pk_fma_f32 v[84:85],v[84:85],v[170:171],v[170:171] op_sel:[0,1,1] op_sel_hi:[1,1,1]
v_pk_fma_f32 v[86:87],v[86:87],v[170:171],v[170:171] op_sel:[0,1,1] op_sel_hi:[1,1,1]
v_rcp_f32 v80,v80
v_rcp_f32 v81,v81
v_rcp_f32 v82,v82
v_rcp_f32 v83,v83
v_rcp_f32 v84,v84
v_rcp_f32 v85,v85
v_rcp_f32 v86,v86
v_rcp_f32 v87,v87
v_pk_mul_f32 v[64:65],v[64:65],v[72:73]
v_pk_mul_f32 v[66:67],v[66:67],v[74:75]
v_pk_mul_f32 v[68:69],v[68:69],v[76:77]
v_pk_mul_f32 v[70:71],v[70:71],v[78:79]
v_pk_mul_f32 v[64:65],v[64:65],v[80:81]
v_pk_mul_f32 v[66:67],v[66:67],v[82:83]
v_pk_mul_f32 v[68:69],v[68:69],v[84:85]
v_pk_mul_f32 v[70:71],v[70:71],v[86:87]
v_cvt_pk_bf16_f32 v216,v64,v65
v_cvt_pk_bf16_f32 v217,v66,v67
v_cvt_pk_bf16_f32 v218,v68,v69
v_cvt_pk_bf16_f32 v219,v70,v71
buffer_store_dwordx4 v[212:215],v150,s[20:23],s53 offen offset:1024 sc1
v_accvgpr_read_b32 v96,a136
v_accvgpr_read_b32 v97,a137
v_accvgpr_read_b32 v98,a138
v_accvgpr_read_b32 v99,a139
v_accvgpr_read_b32 v100,a140
v_accvgpr_read_b32 v101,a141
v_accvgpr_read_b32 v102,a142
v_accvgpr_read_b32 v103,a143
v_pk_fma_f32 v[96:97],v[32:33],v[18:19],v[96:97] op_sel:[0,1,0] op_sel_hi:[1,1,1]
v_pk_fma_f32 v[98:99],v[34:35],v[18:19],v[98:99] op_sel:[0,1,0] op_sel_hi:[1,1,1]
v_pk_fma_f32 v[100:101],v[36:37],v[18:19],v[100:101] op_sel:[0,1,0] op_sel_hi:[1,1,1]
v_pk_fma_f32 v[102:103],v[38:39],v[18:19],v[102:103] op_sel:[0,1,0] op_sel_hi:[1,1,1]
v_pk_mul_f32 v[112:113],v[96:97],v[58:59] op_sel:[0,1] op_sel_hi:[1,1]
v_pk_mul_f32 v[114:115],v[98:99],v[58:59] op_sel:[0,1] op_sel_hi:[1,1]
v_pk_mul_f32 v[116:117],v[100:101],v[58:59] op_sel:[0,1] op_sel_hi:[1,1]
v_pk_mul_f32 v[118:119],v[102:103],v[58:59] op_sel:[0,1] op_sel_hi:[1,1]
v_exp_f32 v112,v112
v_exp_f32 v113,v113
v_exp_f32 v114,v114
v_exp_f32 v115,v115
v_exp_f32 v116,v116
v_exp_f32 v117,v117
v_exp_f32 v118,v118
v_exp_f32 v119,v119
v_accvgpr_read_b32 v104,a152
v_accvgpr_read_b32 v105,a153
v_accvgpr_read_b32 v106,a154
v_accvgpr_read_b32 v107,a155
v_accvgpr_read_b32 v108,a156
v_accvgpr_read_b32 v109,a157
v_accvgpr_read_b32 v110,a158
v_accvgpr_read_b32 v111,a159
v_pk_fma_f32 v[104:105],v[48:49],v[18:19],v[104:105] op_sel:[0,1,0] op_sel_hi:[1,1,1]
v_pk_fma_f32 v[106:107],v[50:51],v[18:19],v[106:107] op_sel:[0,1,0] op_sel_hi:[1,1,1]
v_pk_fma_f32 v[108:109],v[52:53],v[18:19],v[108:109] op_sel:[0,1,0] op_sel_hi:[1,1,1]
v_pk_fma_f32 v[110:111],v[54:55],v[18:19],v[110:111] op_sel:[0,1,0] op_sel_hi:[1,1,1]
v_pk_fma_f32 v[112:113],v[112:113],v[170:171],v[170:171] op_sel:[0,1,1] op_sel_hi:[1,1,1]
v_pk_fma_f32 v[114:115],v[114:115],v[170:171],v[170:171] op_sel:[0,1,1] op_sel_hi:[1,1,1]
v_pk_fma_f32 v[116:117],v[116:117],v[170:171],v[170:171] op_sel:[0,1,1] op_sel_hi:[1,1,1]
v_pk_fma_f32 v[118:119],v[118:119],v[170:171],v[170:171] op_sel:[0,1,1] op_sel_hi:[1,1,1]
v_rcp_f32 v112,v112
v_rcp_f32 v113,v113
v_rcp_f32 v114,v114
v_rcp_f32 v115,v115
v_rcp_f32 v116,v116
v_rcp_f32 v117,v117
v_rcp_f32 v118,v118
v_rcp_f32 v119,v119
v_pk_mul_f32 v[96:97],v[96:97],v[104:105]
v_pk_mul_f32 v[98:99],v[98:99],v[106:107]
v_pk_mul_f32 v[100:101],v[100:101],v[108:109]
v_pk_mul_f32 v[102:103],v[102:103],v[110:111]
v_pk_mul_f32 v[96:97],v[96:97],v[112:113]
v_pk_mul_f32 v[98:99],v[98:99],v[114:115]
v_pk_mul_f32 v[100:101],v[100:101],v[116:117]
v_pk_mul_f32 v[102:103],v[102:103],v[118:119]
v_cvt_pk_bf16_f32 v220,v96,v97
v_cvt_pk_bf16_f32 v221,v98,v99
v_cvt_pk_bf16_f32 v222,v100,v101
v_cvt_pk_bf16_f32 v223,v102,v103
buffer_store_dwordx4 v[216:219],v150,s[20:23],s52 offen offset:1280 sc1
v_accvgpr_read_b32 v64,a168
v_accvgpr_read_b32 v65,a169
v_accvgpr_read_b32 v66,a170
v_accvgpr_read_b32 v67,a171
v_accvgpr_read_b32 v68,a172
v_accvgpr_read_b32 v69,a173
v_accvgpr_read_b32 v70,a174
v_accvgpr_read_b32 v71,a175
v_pk_fma_f32 v[64:65],v[24:25],v[20:21],v[64:65] op_sel:[0,0,0] op_sel_hi:[1,0,1]
v_pk_fma_f32 v[66:67],v[26:27],v[20:21],v[66:67] op_sel:[0,0,0] op_sel_hi:[1,0,1]
v_pk_fma_f32 v[68:69],v[28:29],v[20:21],v[68:69] op_sel:[0,0,0] op_sel_hi:[1,0,1]
v_pk_fma_f32 v[70:71],v[30:31],v[20:21],v[70:71] op_sel:[0,0,0] op_sel_hi:[1,0,1]
v_pk_mul_f32 v[80:81],v[64:65],v[60:61] op_sel:[0,0] op_sel_hi:[1,0]
v_pk_mul_f32 v[82:83],v[66:67],v[60:61] op_sel:[0,0] op_sel_hi:[1,0]
v_pk_mul_f32 v[84:85],v[68:69],v[60:61] op_sel:[0,0] op_sel_hi:[1,0]
v_pk_mul_f32 v[86:87],v[70:71],v[60:61] op_sel:[0,0] op_sel_hi:[1,0]
v_exp_f32 v80,v80
v_exp_f32 v81,v81
v_exp_f32 v82,v82
v_exp_f32 v83,v83
v_exp_f32 v84,v84
v_exp_f32 v85,v85
v_exp_f32 v86,v86
v_exp_f32 v87,v87
v_accvgpr_read_b32 v72,a184
v_accvgpr_read_b32 v73,a185
v_accvgpr_read_b32 v74,a186
v_accvgpr_read_b32 v75,a187
v_accvgpr_read_b32 v76,a188
v_accvgpr_read_b32 v77,a189
v_accvgpr_read_b32 v78,a190
v_accvgpr_read_b32 v79,a191
v_pk_fma_f32 v[72:73],v[40:41],v[20:21],v[72:73] op_sel:[0,0,0] op_sel_hi:[1,0,1]
v_pk_fma_f32 v[74:75],v[42:43],v[20:21],v[74:75] op_sel:[0,0,0] op_sel_hi:[1,0,1]
v_pk_fma_f32 v[76:77],v[44:45],v[20:21],v[76:77] op_sel:[0,0,0] op_sel_hi:[1,0,1]
v_pk_fma_f32 v[78:79],v[46:47],v[20:21],v[78:79] op_sel:[0,0,0] op_sel_hi:[1,0,1]
v_pk_fma_f32 v[80:81],v[80:81],v[172:173],v[172:173] op_sel:[0,0,0] op_sel_hi:[1,0,0]
v_pk_fma_f32 v[82:83],v[82:83],v[172:173],v[172:173] op_sel:[0,0,0] op_sel_hi:[1,0,0]
v_pk_fma_f32 v[84:85],v[84:85],v[172:173],v[172:173] op_sel:[0,0,0] op_sel_hi:[1,0,0]
v_pk_fma_f32 v[86:87],v[86:87],v[172:173],v[172:173] op_sel:[0,0,0] op_sel_hi:[1,0,0]
v_rcp_f32 v80,v80
v_rcp_f32 v81,v81
v_rcp_f32 v82,v82
v_rcp_f32 v83,v83
v_rcp_f32 v84,v84
v_rcp_f32 v85,v85
v_rcp_f32 v86,v86
v_rcp_f32 v87,v87
v_pk_mul_f32 v[64:65],v[64:65],v[72:73]
v_pk_mul_f32 v[66:67],v[66:67],v[74:75]
v_pk_mul_f32 v[68:69],v[68:69],v[76:77]
v_pk_mul_f32 v[70:71],v[70:71],v[78:79]
v_pk_mul_f32 v[64:65],v[64:65],v[80:81]
v_pk_mul_f32 v[66:67],v[66:67],v[82:83]
v_pk_mul_f32 v[68:69],v[68:69],v[84:85]
v_pk_mul_f32 v[70:71],v[70:71],v[86:87]
v_cvt_pk_bf16_f32 v224,v64,v65
v_cvt_pk_bf16_f32 v225,v66,v67
v_cvt_pk_bf16_f32 v226,v68,v69
v_cvt_pk_bf16_f32 v227,v70,v71
buffer_store_dwordx4 v[220:223],v150,s[20:23],s53 offen offset:1280 sc1
s_and_b32 s62,s2,7
s_lshr_b32 s71,s2,6
s_lshl_b32 s70,s62,2
s_add_u32 s70,s70,s71
s_lshr_b32 s63,s71,1
s_lshl_b32 s63,s63,3
s_add_u32 s63,s63,s62
s_lshl_b32 s63,s63,7
s_bfe_u32 s71,s2,0x30003
s_lshl_b32 s72,s71,2
s_add_u32 s72,s72,s63
s_add_u32 s63,s63,2048
s_lshl_b32 s62,s62,7
s_add_u32 s62,s62,3072
v_and_b32 v13,7,v2
v_lshlrev_b32 v13,2,v13
v_add_u32 v14,s63,v13
v_add_u32 v13,s62,v13
v_mov_b32 v15,s72
v_cmp_gt_u32 vcc,16,v2
v_cmp_gt_u32 s[74:75],8,v2
s_nop 1
v_cndmask_b32 v13,v15,v13,vcc
v_cndmask_b32 v13,v13,v14,s[74:75]
v_add_u32 v13,0x2700000,v13
v_lshlrev_b32 v9,4,v2
buffer_load_dword v14,v13,s[20:23],0 offen sc1
v_accvgpr_read_b32 v96,a176
v_accvgpr_read_b32 v97,a177
v_accvgpr_read_b32 v98,a178
v_accvgpr_read_b32 v99,a179
v_accvgpr_read_b32 v100,a180
v_accvgpr_read_b32 v101,a181
v_accvgpr_read_b32 v102,a182
v_accvgpr_read_b32 v103,a183
v_pk_fma_f32 v[96:97],v[32:33],v[20:21],v[96:97] op_sel:[0,0,0] op_sel_hi:[1,0,1]
v_pk_fma_f32 v[98:99],v[34:35],v[20:21],v[98:99] op_sel:[0,0,0] op_sel_hi:[1,0,1]
v_pk_fma_f32 v[100:101],v[36:37],v[20:21],v[100:101] op_sel:[0,0,0] op_sel_hi:[1,0,1]
v_pk_fma_f32 v[102:103],v[38:39],v[20:21],v[102:103] op_sel:[0,0,0] op_sel_hi:[1,0,1]
v_pk_mul_f32 v[112:113],v[96:97],v[60:61] op_sel:[0,0] op_sel_hi:[1,0]
v_pk_mul_f32 v[114:115],v[98:99],v[60:61] op_sel:[0,0] op_sel_hi:[1,0]
v_pk_mul_f32 v[116:117],v[100:101],v[60:61] op_sel:[0,0] op_sel_hi:[1,0]
v_pk_mul_f32 v[118:119],v[102:103],v[60:61] op_sel:[0,0] op_sel_hi:[1,0]
v_exp_f32 v112,v112
v_exp_f32 v113,v113
v_exp_f32 v114,v114
v_exp_f32 v115,v115
v_exp_f32 v116,v116
v_exp_f32 v117,v117
v_exp_f32 v118,v118
v_exp_f32 v119,v119
v_accvgpr_read_b32 v104,a192
v_accvgpr_read_b32 v105,a193
v_accvgpr_read_b32 v106,a194
v_accvgpr_read_b32 v107,a195
v_accvgpr_read_b32 v108,a196
v_accvgpr_read_b32 v109,a197
v_accvgpr_read_b32 v110,a198
v_accvgpr_read_b32 v111,a199
v_pk_fma_f32 v[104:105],v[48:49],v[20:21],v[104:105] op_sel:[0,0,0] op_sel_hi:[1,0,1]
v_pk_fma_f32 v[106:107],v[50:51],v[20:21],v[106:107] op_sel:[0,0,0] op_sel_hi:[1,0,1]
v_pk_fma_f32 v[108:109],v[52:53],v[20:21],v[108:109] op_sel:[0,0,0] op_sel_hi:[1,0,1]
v_pk_fma_f32 v[110:111],v[54:55],v[20:21],v[110:111] op_sel:[0,0,0] op_sel_hi:[1,0,1]
v_pk_fma_f32 v[112:113],v[112:113],v[172:173],v[172:173] op_sel:[0,0,0] op_sel_hi:[1,0,0]
v_pk_fma_f32 v[114:115],v[114:115],v[172:173],v[172:173] op_sel:[0,0,0] op_sel_hi:[1,0,0]
v_pk_fma_f32 v[116:117],v[116:117],v[172:173],v[172:173] op_sel:[0,0,0] op_sel_hi:[1,0,0]
v_pk_fma_f32 v[118:119],v[118:119],v[172:173],v[172:173] op_sel:[0,0,0] op_sel_hi:[1,0,0]
v_rcp_f32 v112,v112
v_rcp_f32 v113,v113
v_rcp_f32 v114,v114
v_rcp_f32 v115,v115
v_rcp_f32 v116,v116
v_rcp_f32 v117,v117
v_rcp_f32 v118,v118
v_rcp_f32 v119,v119
v_pk_mul_f32 v[96:97],v[96:97],v[104:105]
v_pk_mul_f32 v[98:99],v[98:99],v[106:107]
v_pk_mul_f32 v[100:101],v[100:101],v[108:109]
v_pk_mul_f32 v[102:103],v[102:103],v[110:111]
v_pk_mul_f32 v[96:97],v[96:97],v[112:113]
v_pk_mul_f32 v[98:99],v[98:99],v[114:115]
v_pk_mul_f32 v[100:101],v[100:101],v[116:117]
v_pk_mul_f32 v[102:103],v[102:103],v[118:119]
v_cvt_pk_bf16_f32 v228,v96,v97
v_cvt_pk_bf16_f32 v229,v98,v99
v_cvt_pk_bf16_f32 v230,v100,v101
v_cvt_pk_bf16_f32 v231,v102,v103
buffer_store_dwordx4 v[224:227],v150,s[20:23],s52 offen offset:2048 sc1
v_accvgpr_read_b32 v64,a208
v_accvgpr_read_b32 v65,a209
v_accvgpr_read_b32 v66,a210
v_accvgpr_read_b32 v67,a211
v_accvgpr_read_b32 v68,a212
v_accvgpr_read_b32 v69,a213
v_accvgpr_read_b32 v70,a214
v_accvgpr_read_b32 v71,a215
v_pk_fma_f32 v[64:65],v[24:25],v[20:21],v[64:65] op_sel:[0,1,0] op_sel_hi:[1,1,1]
v_pk_fma_f32 v[66:67],v[26:27],v[20:21],v[66:67] op_sel:[0,1,0] op_sel_hi:[1,1,1]
v_pk_fma_f32 v[68:69],v[28:29],v[20:21],v[68:69] op_sel:[0,1,0] op_sel_hi:[1,1,1]
v_pk_fma_f32 v[70:71],v[30:31],v[20:21],v[70:71] op_sel:[0,1,0] op_sel_hi:[1,1,1]
v_pk_mul_f32 v[80:81],v[64:65],v[60:61] op_sel:[0,1] op_sel_hi:[1,1]
v_pk_mul_f32 v[82:83],v[66:67],v[60:61] op_sel:[0,1] op_sel_hi:[1,1]
v_pk_mul_f32 v[84:85],v[68:69],v[60:61] op_sel:[0,1] op_sel_hi:[1,1]
v_pk_mul_f32 v[86:87],v[70:71],v[60:61] op_sel:[0,1] op_sel_hi:[1,1]
v_exp_f32 v80,v80
v_exp_f32 v81,v81
v_exp_f32 v82,v82
v_exp_f32 v83,v83
v_exp_f32 v84,v84
v_exp_f32 v85,v85
v_exp_f32 v86,v86
v_exp_f32 v87,v87
v_accvgpr_read_b32 v72,a224
v_accvgpr_read_b32 v73,a225
v_accvgpr_read_b32 v74,a226
v_accvgpr_read_b32 v75,a227
v_accvgpr_read_b32 v76,a228
v_accvgpr_read_b32 v77,a229
v_accvgpr_read_b32 v78,a230
v_accvgpr_read_b32 v79,a231
v_pk_fma_f32 v[72:73],v[40:41],v[20:21],v[72:73] op_sel:[0,1,0] op_sel_hi:[1,1,1]
v_pk_fma_f32 v[74:75],v[42:43],v[20:21],v[74:75] op_sel:[0,1,0] op_sel_hi:[1,1,1]
v_pk_fma_f32 v[76:77],v[44:45],v[20:21],v[76:77] op_sel:[0,1,0] op_sel_hi:[1,1,1]
v_pk_fma_f32 v[78:79],v[46:47],v[20:21],v[78:79] op_sel:[0,1,0] op_sel_hi:[1,1,1]
v_pk_fma_f32 v[80:81],v[80:81],v[172:173],v[172:173] op_sel:[0,1,1] op_sel_hi:[1,1,1]
v_pk_fma_f32 v[82:83],v[82:83],v[172:173],v[172:173] op_sel:[0,1,1] op_sel_hi:[1,1,1]
v_pk_fma_f32 v[84:85],v[84:85],v[172:173],v[172:173] op_sel:[0,1,1] op_sel_hi:[1,1,1]
v_pk_fma_f32 v[86:87],v[86:87],v[172:173],v[172:173] op_sel:[0,1,1] op_sel_hi:[1,1,1]
v_rcp_f32 v80,v80
v_rcp_f32 v81,v81
v_rcp_f32 v82,v82
v_rcp_f32 v83,v83
v_rcp_f32 v84,v84
v_rcp_f32 v85,v85
v_rcp_f32 v86,v86
v_rcp_f32 v87,v87
v_pk_mul_f32 v[64:65],v[64:65],v[72:73]
v_pk_mul_f32 v[66:67],v[66:67],v[74:75]
v_pk_mul_f32 v[68:69],v[68:69],v[76:77]
v_pk_mul_f32 v[70:71],v[70:71],v[78:79]
v_pk_mul_f32 v[64:65],v[64:65],v[80:81]
v_pk_mul_f32 v[66:67],v[66:67],v[82:83]
v_pk_mul_f32 v[68:69],v[68:69],v[84:85]
v_pk_mul_f32 v[70:71],v[70:71],v[86:87]
v_cvt_pk_bf16_f32 v232,v64,v65
v_cvt_pk_bf16_f32 v233,v66,v67
v_cvt_pk_bf16_f32 v234,v68,v69
v_cvt_pk_bf16_f32 v235,v70,v71
buffer_store_dwordx4 v[228:231],v150,s[20:23],s53 offen offset:2048 sc1
s_waitcnt vmcnt(2)
s_mov_b32 s75,0x40000
kvpollA_chk:
v_cmp_eq_u32 vcc,1,v14
s_sub_u32 s75,s75,1
s_cbranch_scc1 kvpollA_ok
s_nop 1
s_cmp_eq_u64 vcc,-1
s_cbranch_scc1 kvpollA_ok
s_sleep 4
buffer_load_dword v14,v13,s[20:23],0 offen sc1
s_waitcnt vmcnt(0)
s_branch kvpollA_chk
kvpollA_ok:
s_add_u32 s64,s6,0x800000
s_addc_u32 s65,s7,0
s_and_b32 s65,s65,0xffff
s_mov_b32 s66,0x800000
s_mov_b32 s67,0x00020000
s_lshl_b32 s69,s31,11
s_lshl_b32 s68,s70,18
s_add_u32 s68,s68,s69
s_add_u32 m0,s69,131072
s_nop 0
buffer_load_dwordx4 v9,s[64:67],s68 offen sc1 lds
buffer_load_dwordx4 v9,s[64:67],s68 offen offset:1024 sc1 lds
s_add_u32 s68,s68,8192
s_lshl_b32 s62,s70,17
s_lshl_b32 s63,s71,14
s_add_u32 s62,s62,s63
s_lshl_b32 s63,s31,12
s_add_u32 s62,s62,s63
s_add_u32 s62,s62,0x400000
buffer_load_dwordx4 a[64:67],v9,s[20:23],s62 offen sc1
buffer_load_dwordx4 a[68:71],v9,s[20:23],s62 offen offset:1024 sc1
buffer_load_dwordx4 a[72:75],v9,s[20:23],s62 offen offset:2048 sc1
buffer_load_dwordx4 a[76:79],v9,s[20:23],s62 offen offset:3072 sc1
s_add_u32 m0,s69,139264
s_nop 0
buffer_load_dwordx4 v9,s[64:67],s68 offen sc1 lds
buffer_load_dwordx4 v9,s[64:67],s68 offen offset:1024 sc1 lds
s_add_u32 s68,s68,8192
s_add_u32 m0,s69,147456
s_nop 0
buffer_load_dwordx4 v9,s[64:67],s68 offen sc1 lds
buffer_load_dwordx4 v9,s[64:67],s68 offen offset:1024 sc1 lds
s_add_u32 s68,s68,8192
s_add_u32 m0,s69,155648
s_nop 0
buffer_load_dwordx4 v9,s[64:67],s68 offen sc1 lds
buffer_load_dwordx4 v9,s[64:67],s68 offen offset:1024 sc1 lds
s_add_u32 s68,s68,8192
s_lshl_b32 s62,s71,2
s_add_u32 s62,s62,s31
s_lshl_b32 s62,s62,12
s_lshl_b32 s63,s70,18
s_add_u32 s62,s62,s63
v_and_b32 v12,31,v2
v_lshlrev_b32 v12,7,v12
buffer_load_dword v15,v12,s[64:67],s62 offen sc1
v_accvgpr_read_b32 v96,a216
v_accvgpr_read_b32 v97,a217
v_accvgpr_read_b32 v98,a218
v_accvgpr_read_b32 v99,a219
v_accvgpr_read_b32 v100,a220
v_accvgpr_read_b32 v101,a221
v_accvgpr_read_b32 v102,a222
v_accvgpr_read_b32 v103,a223
v_pk_fma_f32 v[96:97],v[32:33],v[20:21],v[96:97] op_sel:[0,1,0] op_sel_hi:[1,1,1]
v_pk_fma_f32 v[98:99],v[34:35],v[20:21],v[98:99] op_sel:[0,1,0] op_sel_hi:[1,1,1]
v_pk_fma_f32 v[100:101],v[36:37],v[20:21],v[100:101] op_sel:[0,1,0] op_sel_hi:[1,1,1]
v_pk_fma_f32 v[102:103],v[38:39],v[20:21],v[102:103] op_sel:[0,1,0] op_sel_hi:[1,1,1]
v_pk_mul_f32 v[112:113],v[96:97],v[60:61] op_sel:[0,1] op_sel_hi:[1,1]
v_pk_mul_f32 v[114:115],v[98:99],v[60:61] op_sel:[0,1] op_sel_hi:[1,1]
v_pk_mul_f32 v[116:117],v[100:101],v[60:61] op_sel:[0,1] op_sel_hi:[1,1]
v_pk_mul_f32 v[118:119],v[102:103],v[60:61] op_sel:[0,1] op_sel_hi:[1,1]
v_exp_f32 v112,v112
v_exp_f32 v113,v113
v_exp_f32 v114,v114
v_exp_f32 v115,v115
v_exp_f32 v116,v116
v_exp_f32 v117,v117
v_exp_f32 v118,v118
v_exp_f32 v119,v119
v_accvgpr_read_b32 v104,a232
v_accvgpr_read_b32 v105,a233
v_accvgpr_read_b32 v106,a234
v_accvgpr_read_b32 v107,a235
v_accvgpr_read_b32 v108,a236
v_accvgpr_read_b32 v109,a237
v_accvgpr_read_b32 v110,a238
v_accvgpr_read_b32 v111,a239
v_pk_fma_f32 v[104:105],v[48:49],v[20:21],v[104:105] op_sel:[0,1,0] op_sel_hi:[1,1,1]
v_pk_fma_f32 v[106:107],v[50:51],v[20:21],v[106:107] op_sel:[0,1,0] op_sel_hi:[1,1,1]
v_pk_fma_f32 v[108:109],v[52:53],v[20:21],v[108:109] op_sel:[0,1,0] op_sel_hi:[1,1,1]
v_pk_fma_f32 v[110:111],v[54:55],v[20:21],v[110:111] op_sel:[0,1,0] op_sel_hi:[1,1,1]
v_pk_fma_f32 v[112:113],v[112:113],v[172:173],v[172:173] op_sel:[0,1,1] op_sel_hi:[1,1,1]
v_pk_fma_f32 v[114:115],v[114:115],v[172:173],v[172:173] op_sel:[0,1,1] op_sel_hi:[1,1,1]
v_pk_fma_f32 v[116:117],v[116:117],v[172:173],v[172:173] op_sel:[0,1,1] op_sel_hi:[1,1,1]
v_pk_fma_f32 v[118:119],v[118:119],v[172:173],v[172:173] op_sel:[0,1,1] op_sel_hi:[1,1,1]
v_rcp_f32 v112,v112
v_rcp_f32 v113,v113
v_rcp_f32 v114,v114
v_rcp_f32 v115,v115
v_rcp_f32 v116,v116
v_rcp_f32 v117,v117
v_rcp_f32 v118,v118
v_rcp_f32 v119,v119
v_pk_mul_f32 v[96:97],v[96:97],v[104:105]
v_pk_mul_f32 v[98:99],v[98:99],v[106:107]
v_pk_mul_f32 v[100:101],v[100:101],v[108:109]
v_pk_mul_f32 v[102:103],v[102:103],v[110:111]
v_pk_mul_f32 v[96:97],v[96:97],v[112:113]
v_pk_mul_f32 v[98:99],v[98:99],v[114:115]
v_pk_mul_f32 v[100:101],v[100:101],v[116:117]
v_pk_mul_f32 v[102:103],v[102:103],v[118:119]
v_cvt_pk_bf16_f32 v236,v96,v97
v_cvt_pk_bf16_f32 v237,v98,v99
v_cvt_pk_bf16_f32 v238,v100,v101
v_cvt_pk_bf16_f32 v239,v102,v103
buffer_store_dwordx4 v[232:235],v150,s[20:23],s52 offen offset:2304 sc1
s_nop 0
buffer_store_dwordx4 v[236:239],v150,s[20:23],s53 offen offset:2304 sc1
s_load_dwordx2 s[4:5],s[0:1],16
s_load_dwordx2 s[36:37],s[0:1],48
s_load_dwordx2 s[38:39],s[0:1],0
v_mov_b32 v76,0xdddd
v_and_b32 v3,3,v2
v_bfe_u32 v4,v2,2,1
v_cmp_eq_u32 vcc,0,v3
v_mov_b32 v5,0x3f803f80
s_nop 0
v_cndmask_b32 v5,0,v5,vcc
v_cmp_eq_u32 vcc,0,v4
s_nop 1
v_cndmask_b32 v72,0,v5,vcc
v_cndmask_b32 v73,0,v5,vcc
v_sub_u32 v74,v5,v72
v_sub_u32 v75,v5,v72
v_mov_b32 v32,0
v_mov_b32 v33,0
v_mov_b32 v34,0
v_mov_b32 v35,0
v_mov_b32 v36,0
v_mov_b32 v37,0
v_mov_b32 v38,0
v_mov_b32 v39,0
v_mov_b32 v40,0
v_mov_b32 v41,0
v_mov_b32 v42,0
v_mov_b32 v43,0
v_mov_b32 v44,0
v_mov_b32 v45,0
v_mov_b32 v46,0
v_mov_b32 v47,0
v_mov_b32 v48,0
v_mov_b32 v49,0
v_mov_b32 v50,0
v_mov_b32 v51,0
v_mov_b32 v52,0
v_mov_b32 v53,0
v_mov_b32 v54,0
v_mov_b32 v55,0
v_mov_b32 v56,0
v_mov_b32 v57,0
v_mov_b32 v58,0
v_mov_b32 v59,0
v_mov_b32 v60,0
v_mov_b32 v61,0
v_mov_b32 v62,0
v_mov_b32 v63,0
v_mov_b32 v64,0
v_mov_b32 v65,0
v_mov_b32 v66,0
v_mov_b32 v67,0
v_mov_b32 v68,0
v_mov_b32 v69,0
v_mov_b32 v70,0
v_mov_b32 v71,0
v_add_u32 v77,131072,v9
v_mov_b32 v78,v150
s_waitcnt lgkmcnt(0)
s_and_b32 s40,s2,1
s_mul_i32 s46,s40,5
s_xor_b32 s46,s46,s2
s_bfe_u32 s41,s46,0x10001
s_lshl_b32 s41,s41,3
s_bfe_u32 s42,s46,0x30003
s_add_u32 s41,s41,s42
s_bfe_u32 s42,s46,0x10002
s_lshl_b32 s42,s42,2
s_lshr_b32 s43,s46,6
s_add_u32 s42,s42,s43
s_and_b32 s44,s31,1
s_lshr_b32 s45,s31,1
s_lshl_b32 s29,s31,12
s_add_u32 s8,s6,0x1000000
s_addc_u32 s9,s7,0
s_and_b32 s9,s9,0xffff
s_mov_b32 s10,0x1200000
s_mov_b32 s11,0x00020000
s_mov_b32 s12,s36
s_and_b32 s13,s37,0xffff
s_mov_b32 s14,0x700000
s_mov_b32 s15,0x00020000
s_mov_b32 s16,s4
s_and_b32 s17,s5,0xffff
s_mov_b32 s18,0x200000
s_mov_b32 s19,0x00020000
s_mul_i32 s24,s41,1179648
s_lshl_b32 s46,s40,11
s_lshl_b32 s47,s45,13
s_add_u32 s46,s46,s47
s_add_u32 s25,s24,s46
s_add_u32 s25,s25,917504
s_add_u32 s24,s24,s29
s_mul_i32 s46,s40,901120
s_add_u32 s24,s24,s46
s_mul_i32 s32,s40,-32768
s_add_u32 s32,s32,16384
s_lshl_b32 s74,s32,3
s_mul_i32 s26,s40,7208960
s_lshl_b32 s46,s31,15
s_add_u32 s26,s26,s46
s_lshl_b32 s47,s42,8
s_add_u32 s26,s26,s47
s_lshl_b32 s46,s45,16
s_add_u32 s27,s46,s47
s_add_u32 s28,s27,0x8000
s_lshl_b32 s30,s45,13
s_lshl_b32 s33,s45,12
s_xor_b32 s43,s44,s40
s_add_u32 s4,s29,0x10000
s_add_u32 s5,s30,0x10000
s_add_u32 s36,s33,0x10000
v_lshrrev_b32 v3,4,v2
v_bfe_u32 v4,v2,1,3
v_and_b32 v5,1,v2
v_lshlrev_b32 v5,4,v5
v_lshl_add_u32 v5,v3,11,v5
v_xor_b32 v6,v4,v3
v_lshl_add_u32 v7,v6,5,v5
v_xor_b32 v6,4,v6
v_lshl_add_u32 v8,v6,5,v5
v_add_u32 v244,0,v7
v_add_u32 v245,7168,v8
v_add_u32 v246,14336,v7
v_add_u32 v247,21504,v8
v_add_u32 v28,2048,v9
v_lshrrev_b32 v3,5,v2
v_bfe_u32 v4,v2,4,1
v_and_b32 v5,15,v2
v_lshlrev_b32 v5,4,v5
v_lshl_add_u32 v5,v4,9,v5
v_lshl_add_u32 v4,v3,12,v5
s_lshl_b32 s46,s44,11
v_add_u32 v16,s46,v4
v_add_u32 v17,65536,v16
v_lshl_add_u32 v4,v3,11,v5
s_lshl_b32 s46,s43,10
v_add_u32 v26,s46,v4
v_add_u32 v27,65536,v26
v_lshrrev_b32 v3,2,v2
v_and_b32 v4,7,v3
v_and_b32 v5,3,v2
v_lshlrev_b32 v5,3,v5
v_lshl_add_u32 v6,v3,8,v5
s_lshl_b32 s46,s45,2
v_xor_b32 v4,s46,v4
v_xor_b32 v7,0,v4
v_lshl_add_u32 v18,v7,5,v6
v_add_u32 v19,65536,v18
v_xor_b32 v7,1,v4
v_lshl_add_u32 v20,v7,5,v6
v_add_u32 v21,65536,v20
v_xor_b32 v7,2,v4
v_lshl_add_u32 v22,v7,5,v6
v_add_u32 v23,65536,v22
v_xor_b32 v7,3,v4
v_lshl_add_u32 v24,v7,5,v6
v_add_u32 v25,65536,v24
s_lshr_b32 s46,s41,1
s_lshl_b32 s46,s46,7
s_add_u32 s46,s46,0x2701000
v_lshl_add_u32 v250,v2,2,s46
s_and_b32 s46,s2,7
s_lshl_b32 s46,s46,2
s_add_u32 s46,s46,0x2701060
v_and_b32 v3,7,v2
v_lshl_add_u32 v3,v3,7,s46
v_cmp_gt_u32 vcc,32,v2
s_nop 1
v_cndmask_b32 v250,v3,v250,vcc
s_waitcnt vmcnt(13)
s_barrier
ds_read_b128 v[80:83],v77
ds_read_b128 v[84:87],v77 offset:1024
ds_read_b128 v[96:99],v77 offset:2048
ds_read_b128 v[100:103],v77 offset:3072
s_waitcnt vmcnt(9)
s_branch L_attn
L_mainB:
ds_read_b64_tr_b16 v[40:41],v116 offset:12288
ds_read_b64_tr_b16 v[42:43],v116 offset:13312
ds_read_b64_tr_b16 v[44:45],v117 offset:12288
ds_read_b64_tr_b16 v[46:47],v117 offset:13312
ds_read_b64_tr_b16 v[48:49],v116 offset:16384
ds_read_b64_tr_b16 v[50:51],v116 offset:17408
ds_read_b64_tr_b16 v[52:53],v117 offset:16384
ds_read_b64_tr_b16 v[54:55],v117 offset:17408
s_mov_b32 s50,0
s_waitcnt vmcnt(5) lgkmcnt(0)
s_barrier
v_mfma_f32_16x16x32_bf16 a[0:3],v[16:19],v[96:99],0
s_add_u32 m0,s29,126976
v_mfma_f32_16x16x32_bf16 a[4:7],v[20:23],v[96:99],0
ds_read_b128 v[104:107],v112 offset:4096
buffer_load_dwordx4 v132,s[12:15],s25 offen lds
v_mfma_f32_16x16x32_bf16 a[8:11],v[96:99],v[24:27],0
s_cmp_lg_u32 s31,0
s_cbranch_scc1 L_nzB
s_mov_b64 exec,255
buffer_store_dword v11,v10,s[20:23],0 offen sc1
s_mov_b64 exec,-1
L_nzB:
v_mfma_f32_16x16x32_bf16 a[12:15],v[96:99],v[28:31],0
ds_read_b64_tr_b16 v[56:57],v116 offset:20480
v_mfma_f32_16x16x32_bf16 a[16:19],v[96:99],v[32:35],0
v_mfma_f32_16x16x32_bf16 a[20:23],v[96:99],v[36:39],0
ds_read_b64_tr_b16 v[58:59],v116 offset:21504
buffer_load_dwordx4 v133,s[12:15],s25 offen offset:1024 lds
v_mfma_f32_16x16x32_bf16 a[24:27],v[40:43],v[96:99],0
v_mfma_f32_16x16x32_bf16 a[28:31],v[44:47],v[96:99],0
ds_read_b64_tr_b16 v[60:61],v117 offset:20480
v_mfma_f32_16x16x32_bf16 a[32:35],v[48:51],v[96:99],0
v_mfma_f32_16x16x32_bf16 a[36:39],v[52:55],v[96:99],0
ds_read_b64_tr_b16 v[62:63],v117 offset:21504
buffer_load_dwordx4 v134,s[12:15],s25 offen offset:2048 lds
v_mfma_f32_16x16x32_bf16 a[40:43],v[16:19],v[100:103],0
v_mfma_f32_16x16x32_bf16 a[44:47],v[20:23],v[100:103],0
ds_read_b128 v[108:111],v112 offset:6144
v_mfma_f32_16x16x32_bf16 a[48:51],v[100:103],v[24:27],0
v_mfma_f32_16x16x32_bf16 a[52:55],v[100:103],v[28:31],0
ds_read_b64_tr_b16 v[64:65],v120 offset:24576
buffer_load_dwordx4 v135,s[12:15],s25 offen offset:3072 lds
v_mfma_f32_16x16x32_bf16 a[56:59],v[100:103],v[32:35],0
v_mfma_f32_16x16x32_bf16 a[60:63],v[100:103],v[36:39],0
ds_read_b64_tr_b16 v[66:67],v120 offset:25600
v_mfma_f32_16x16x32_bf16 a[64:67],v[40:43],v[100:103],0
v_mfma_f32_16x16x32_bf16 a[68:71],v[44:47],v[100:103],0
ds_read_b64_tr_b16 v[68:69],v121 offset:24576
s_add_u32 s25,s25,s27
v_mfma_f32_16x16x32_bf16 a[72:75],v[48:51],v[100:103],0
s_add_u32 m0,s30,143360
v_mfma_f32_16x16x32_bf16 a[76:79],v[52:55],v[100:103],0
ds_read_b64_tr_b16 v[70:71],v121 offset:25600
buffer_load_dwordx4 v136,s[16:19],s26 offen lds
s_waitcnt lgkmcnt(9)
v_mfma_f32_16x16x32_bf16 a[80:83],v[16:19],v[104:107],0
v_mfma_f32_16x16x32_bf16 a[84:87],v[20:23],v[104:107],0
ds_read_b128 v[96:99],v112 offset:8192
v_mfma_f32_16x16x32_bf16 a[88:91],v[104:107],v[24:27],0
v_mfma_f32_16x16x32_bf16 a[92:95],v[104:107],v[28:31],0
ds_read_b64_tr_b16 v[72:73],v122 offset:24576
s_add_u32 s26,s26,s28
v_mfma_f32_16x16x32_bf16 a[96:99],v[104:107],v[32:35],0
s_add_u32 m0,s33,32768
v_mfma_f32_16x16x32_bf16 a[100:103],v[104:107],v[36:39],0
ds_read_b64_tr_b16 v[74:75],v122 offset:25600
buffer_load_dwordx4 v128,s[8:11],s24 offen lds
v_mfma_f32_16x16x32_bf16 a[104:107],v[40:43],v[104:107],0
v_mfma_f32_16x16x32_bf16 a[108:111],v[44:47],v[104:107],0
ds_read_b64_tr_b16 v[76:77],v123 offset:24576
v_mfma_f32_16x16x32_bf16 a[112:115],v[48:51],v[104:107],0
v_mfma_f32_16x16x32_bf16 a[116:119],v[52:55],v[104:107],0
ds_read_b64_tr_b16 v[78:79],v123 offset:25600
buffer_load_dwordx4 v129,s[8:11],s24 offen offset:1024 lds
s_waitcnt lgkmcnt(9)
v_mfma_f32_16x16x32_bf16 a[120:123],v[16:19],v[108:111],0
v_mfma_f32_16x16x32_bf16 a[124:127],v[20:23],v[108:111],0
ds_read_b128 v[100:103],v112 offset:10240
v_mfma_f32_16x16x32_bf16 a[128:131],v[108:111],v[24:27],0
v_min_u32 v168,7,v2
v_lshlrev_b32 v168,7,v168
v_mfma_f32_16x16x32_bf16 a[132:135],v[108:111],v[28:31],0
ds_read_b64_tr_b16 v[80:81],v116 offset:32768
buffer_load_dwordx4 v130,s[8:11],s24 offen offset:2048 lds
v_mfma_f32_16x16x32_bf16 a[136:139],v[108:111],v[32:35],0
v_mfma_f32_16x16x32_bf16 a[140:143],v[108:111],v[36:39],0
ds_read_b64_tr_b16 v[82:83],v116 offset:33792
v_mfma_f32_16x16x32_bf16 a[144:147],v[40:43],v[108:111],0
buffer_load_dword v139,v168,s[8:11],s63 offen
v_mfma_f32_16x16x32_bf16 a[148:151],v[44:47],v[108:111],0
ds_read_b64_tr_b16 v[84:85],v117 offset:32768
buffer_load_dwordx4 v131,s[8:11],s24 offen offset:3072 lds
v_mfma_f32_16x16x32_bf16 a[152:155],v[48:51],v[108:111],0
v_mfma_f32_16x16x32_bf16 a[156:159],v[52:55],v[108:111],0
ds_read_b64_tr_b16 v[86:87],v117 offset:33792
s_waitcnt lgkmcnt(9)
v_mfma_f32_16x16x32_bf16 a[160:163],v[16:19],v[96:99],0
v_mfma_f32_16x16x32_bf16 a[164:167],v[20:23],v[96:99],0
ds_read_b128 v[104:107],v112 offset:12288
s_add_u32 m0,s33,36864
v_mfma_f32_16x16x32_bf16 a[168:171],v[96:99],v[24:27],0
buffer_load_dwordx4 v128,s[8:11],s32 offen lds
v_mfma_f32_16x16x32_bf16 a[172:175],v[96:99],v[28:31],0
ds_read_b64_tr_b16 v[88:89],v116 offset:36864
v_mfma_f32_16x16x32_bf16 a[176:179],v[96:99],v[32:35],0
v_mfma_f32_16x16x32_bf16 a[180:183],v[96:99],v[36:39],0
ds_read_b64_tr_b16 v[90:91],v116 offset:37888
v_mfma_f32_16x16x32_bf16 a[184:187],v[40:43],v[96:99],0
buffer_load_dwordx4 v129,s[8:11],s32 offen offset:1024 lds
v_mfma_f32_16x16x32_bf16 a[188:191],v[44:47],v[96:99],0
ds_read_b64_tr_b16 v[92:93],v117 offset:36864
v_mfma_f32_16x16x32_bf16 a[192:195],v[48:51],v[96:99],0
v_mfma_f32_16x16x32_bf16 a[196:199],v[52:55],v[96:99],0
ds_read_b64_tr_b16 v[94:95],v117 offset:37888
s_waitcnt lgkmcnt(9)
v_mfma_f32_16x16x32_bf16 a[200:203],v[16:19],v[100:103],0
buffer_load_dwordx4 v130,s[8:11],s32 offen offset:2048 lds
v_mfma_f32_16x16x32_bf16 a[204:207],v[20:23],v[100:103],0
ds_read_b128 v[108:111],v112 offset:14336
v_mfma_f32_16x16x32_bf16 a[208:211],v[100:103],v[24:27],0
s_cmp_lg_u32 s34,0
s_cbranch_scc1 .Lce24
s_cbranch_vccnz .Lcs24
v_smfmac_f32_16x16x64_bf16 v[144:147],v[164:167],v[16:23],v143
v_smfmac_f32_16x16x64_bf16 v[148:151],v[164:167],v[24:31],v143
v_smfmac_f32_16x16x64_bf16 v[152:155],v[164:167],v[32:39],v143
s_branch .Lce24
.Lcs24:
v_smfmac_f32_16x16x64_bf16 v[156:159],v[164:167],v[40:47],v143
v_smfmac_f32_16x16x64_bf16 v[160:163],v[164:167],v[48:55],v143
.Lce24:
v_mfma_f32_16x16x32_bf16 a[212:215],v[100:103],v[28:31],0
v_mfma_f32_16x16x32_bf16 a[216:219],v[100:103],v[32:35],0
buffer_load_dwordx4 v131,s[8:11],s32 offen offset:3072 lds
v_mfma_f32_16x16x32_bf16 a[220:223],v[100:103],v[36:39],0
v_mfma_f32_16x16x32_bf16 a[224:227],v[40:43],v[100:103],0
v_mfma_f32_16x16x32_bf16 a[228:231],v[44:47],v[100:103],0
v_mfma_f32_16x16x32_bf16 a[232:235],v[48:51],v[100:103],0
s_add_u32 s24,s24,128
s_waitcnt vmcnt(14) lgkmcnt(0)
s_barrier
v_mfma_f32_16x16x32_bf16 a[236:239],v[52:55],v[100:103],0
s_add_u32 s32,s32,128
v_mfma_f32_16x16x32_bf16 a[240:243],v[16:19],v[104:107],0
s_add_u32 m0,s29,65536
v_mfma_f32_16x16x32_bf16 a[244:247],v[20:23],v[104:107],0
ds_read_b128 v[96:99],v113
buffer_load_dwordx4 v132,s[12:15],s25 offen lds
v_mfma_f32_16x16x32_bf16 a[248:251],v[104:107],v[24:27],0
v_mfma_f32_16x16x32_bf16 a[252:255],v[104:107],v[28:31],0
v_mfma_f32_16x16x32_bf16 v[192:195],v[104:107],v[32:35],0
v_mfma_f32_16x16x32_bf16 v[196:199],v[104:107],v[36:39],0
buffer_load_dwordx4 v133,s[12:15],s25 offen offset:1024 lds
v_mfma_f32_16x16x32_bf16 v[200:203],v[40:43],v[104:107],0
v_mfma_f32_16x16x32_bf16 v[204:207],v[44:47],v[104:107],0
v_mfma_f32_16x16x32_bf16 v[208:211],v[48:51],v[104:107],0
v_mfma_f32_16x16x32_bf16 v[212:215],v[52:55],v[104:107],0
buffer_load_dwordx4 v134,s[12:15],s25 offen offset:2048 lds
v_mfma_f32_16x16x32_bf16 v[216:219],v[16:19],v[108:111],0
v_mfma_f32_16x16x32_bf16 v[220:223],v[20:23],v[108:111],0
ds_read_b128 v[100:103],v113 offset:2048
v_mfma_f32_16x16x32_bf16 v[224:227],v[108:111],v[24:27],0
v_mfma_f32_16x16x32_bf16 v[228:231],v[108:111],v[28:31],0
buffer_load_dwordx4 v135,s[12:15],s25 offen offset:3072 lds
v_mfma_f32_16x16x32_bf16 v[232:235],v[108:111],v[32:35],0
v_mfma_f32_16x16x32_bf16 v[236:239],v[108:111],v[36:39],0
v_mfma_f32_16x16x32_bf16 v[240:243],v[40:43],v[108:111],0
v_mfma_f32_16x16x32_bf16 v[244:247],v[44:47],v[108:111],0
s_add_u32 s25,s25,s27
v_mfma_f32_16x16x32_bf16 v[248:251],v[48:51],v[108:111],0
s_add_u32 m0,s30,81920
v_mfma_f32_16x16x32_bf16 v[252:255],v[52:55],v[108:111],0
buffer_load_dwordx4 v136,s[16:19],s26 offen lds
s_add_u32 s26,s26,s28
s_waitcnt lgkmcnt(1)
v_mfma_f32_16x16x32_bf16 a[0:3],v[56:59],v[96:99],a[0:3]
s_getpc_b64 s[60:61]
.Lct3:
s_add_u32 s60,s60,L_trip1B-.Lct3
s_addc_u32 s61,s61,0
s_lshr_b32 s62,s2,3
v_mfma_f32_16x16x32_bf16 a[4:7],v[60:63],v[96:99],a[4:7]
ds_read_b128 v[104:107],v113 offset:4096
s_lshl_b32 s62,s62,2
v_mfma_f32_16x16x32_bf16 a[8:11],v[96:99],v[64:67],a[8:11]
s_add_u32 s62,s62,s31
s_and_b32 s62,s62,15
v_mfma_f32_16x16x32_bf16 a[12:15],v[96:99],v[68:71],a[12:15]
ds_read_b64_tr_b16 v[16:17],v116 offset:40960
s_lshl_b32 s62,s62,7
v_mfma_f32_16x16x32_bf16 a[16:19],v[96:99],v[72:75],a[16:19]
s_add_u32 m0,s29,86016
v_lshlrev_b32 v140,11,v2
v_mfma_f32_16x16x32_bf16 a[20:23],v[96:99],v[76:79],a[20:23]
ds_read_b64_tr_b16 v[18:19],v116 offset:41984
v_add_u32 v140,s62,v140
v_mfma_f32_16x16x32_bf16 a[24:27],v[80:83],v[96:99],a[24:27]
v_min_u32 v140,L_epiB-L_trip1B-4,v140
global_load_dword v139,v140,s[60:61]
v_mfma_f32_16x16x32_bf16 a[28:31],v[84:87],v[96:99],a[28:31]
ds_read_b64_tr_b16 v[20:21],v117 offset:40960
s_lshl_b32 s43,s35,3
v_mfma_f32_16x16x32_bf16 a[32:35],v[88:91],v[96:99],a[32:35]
buffer_load_dwordx4 v132,s[12:15],s25 offen lds
v_mfma_f32_16x16x32_bf16 a[36:39],v[92:95],v[96:99],a[36:39]
ds_read_b64_tr_b16 v[22:23],v117 offset:41984
s_waitcnt lgkmcnt(5)
v_mfma_f32_16x16x32_bf16 a[40:43],v[56:59],v[100:103],a[40:43]
s_add_u32 s43,s43,s34
s_lshl_b32 s43,s43,2
v_mfma_f32_16x16x32_bf16 a[44:47],v[60:63],v[100:103],a[44:47]
ds_read_b128 v[108:111],v113 offset:6144
s_lshl_b32 s49,s40,1
v_mfma_f32_16x16x32_bf16 a[48:51],v[100:103],v[64:67],a[48:51]
s_add_u32 s43,s43,s49
s_add_u32 s43,s43,s41
v_mfma_f32_16x16x32_bf16 a[52:55],v[100:103],v[68:71],a[52:55]
ds_read_b64_tr_b16 v[24:25],v120 offset:45056
s_lshl_b32 s43,s43,9
v_mfma_f32_16x16x32_bf16 a[56:59],v[100:103],v[72:75],a[56:59]
s_add_u32 s43,s43,0x2720000
v_mfma_f32_16x16x32_bf16 a[60:63],v[100:103],v[76:79],a[60:63]
ds_read_b64_tr_b16 v[26:27],v120 offset:46080
v_mfma_f32_16x16x32_bf16 a[64:67],v[80:83],v[100:103],a[64:67]
v_mfma_f32_16x16x32_bf16 a[68:71],v[84:87],v[100:103],a[68:71]
ds_read_b64_tr_b16 v[28:29],v121 offset:45056
v_mfma_f32_16x16x32_bf16 a[72:75],v[88:91],v[100:103],a[72:75]
buffer_load_dwordx4 v133,s[12:15],s25 offen offset:1024 lds
v_mfma_f32_16x16x32_bf16 a[76:79],v[92:95],v[100:103],a[76:79]
ds_read_b64_tr_b16 v[30:31],v121 offset:46080
s_waitcnt lgkmcnt(9)
v_mfma_f32_16x16x32_bf16 a[80:83],v[56:59],v[104:107],a[80:83]
v_mfma_f32_16x16x32_bf16 a[84:87],v[60:63],v[104:107],a[84:87]
ds_read_b128 v[96:99],v113 offset:8192
v_mfma_f32_16x16x32_bf16 a[88:91],v[104:107],v[64:67],a[88:91]
v_mfma_f32_16x16x32_bf16 a[92:95],v[104:107],v[68:71],a[92:95]
ds_read_b64_tr_b16 v[32:33],v122 offset:45056
v_mfma_f32_16x16x32_bf16 a[96:99],v[104:107],v[72:75],a[96:99]
v_mfma_f32_16x16x32_bf16 a[100:103],v[104:107],v[76:79],a[100:103]
ds_read_b64_tr_b16 v[34:35],v122 offset:46080
v_mfma_f32_16x16x32_bf16 a[104:107],v[80:83],v[104:107],a[104:107]
v_mfma_f32_16x16x32_bf16 a[108:111],v[84:87],v[104:107],a[108:111]
ds_read_b64_tr_b16 v[36:37],v123 offset:45056
v_mfma_f32_16x16x32_bf16 a[112:115],v[88:91],v[104:107],a[112:115]
buffer_load_dwordx4 v134,s[12:15],s25 offen offset:2048 lds
v_mfma_f32_16x16x32_bf16 a[116:119],v[92:95],v[104:107],a[116:119]
ds_read_b64_tr_b16 v[38:39],v123 offset:46080
s_waitcnt lgkmcnt(9)
v_mfma_f32_16x16x32_bf16 a[120:123],v[56:59],v[108:111],a[120:123]
v_mfma_f32_16x16x32_bf16 a[124:127],v[60:63],v[108:111],a[124:127]
ds_read_b128 v[100:103],v113 offset:10240
v_mfma_f32_16x16x32_bf16 a[128:131],v[108:111],v[64:67],a[128:131]
v_min_u32 v168,7,v2
v_lshlrev_b32 v168,7,v168
v_mfma_f32_16x16x32_bf16 a[132:135],v[108:111],v[68:71],a[132:135]
ds_read_b64_tr_b16 v[40:41],v116 offset:53248
v_mfma_f32_16x16x32_bf16 a[136:139],v[108:111],v[72:75],a[136:139]
v_mfma_f32_16x16x32_bf16 a[140:143],v[108:111],v[76:79],a[140:143]
ds_read_b64_tr_b16 v[42:43],v116 offset:54272
v_mfma_f32_16x16x32_bf16 a[144:147],v[80:83],v[108:111],a[144:147]
buffer_load_dword v139,v168,s[8:11],s63 offen offset:1024
v_mfma_f32_16x16x32_bf16 a[148:151],v[84:87],v[108:111],a[148:151]
ds_read_b64_tr_b16 v[44:45],v117 offset:53248
v_mfma_f32_16x16x32_bf16 a[152:155],v[88:91],v[108:111],a[152:155]
buffer_load_dwordx4 v135,s[12:15],s25 offen offset:3072 lds
v_mfma_f32_16x16x32_bf16 a[156:159],v[92:95],v[108:111],a[156:159]
ds_read_b64_tr_b16 v[46:47],v117 offset:54272
s_waitcnt lgkmcnt(9)
v_mfma_f32_16x16x32_bf16 a[160:163],v[56:59],v[96:99],a[160:163]
s_add_u32 s25,s25,s27
v_mfma_f32_16x16x32_bf16 a[164:167],v[60:63],v[96:99],a[164:167]
ds_read_b128 v[104:107],v113 offset:12288
v_mfma_f32_16x16x32_bf16 a[168:171],v[96:99],v[64:67],a[168:171]
v_mfma_f32_16x16x32_bf16 a[172:175],v[96:99],v[68:71],a[172:175]
ds_read_b64_tr_b16 v[48:49],v116 offset:57344
v_mfma_f32_16x16x32_bf16 a[176:179],v[96:99],v[72:75],a[176:179]
s_add_u32 m0,s30,102400
v_mfma_f32_16x16x32_bf16 a[180:183],v[96:99],v[76:79],a[180:183]
ds_read_b64_tr_b16 v[50:51],v116 offset:58368
v_mfma_f32_16x16x32_bf16 a[184:187],v[80:83],v[96:99],a[184:187]
v_mfma_f32_16x16x32_bf16 a[188:191],v[84:87],v[96:99],a[188:191]
ds_read_b64_tr_b16 v[52:53],v117 offset:57344
v_mfma_f32_16x16x32_bf16 a[192:195],v[88:91],v[96:99],a[192:195]
buffer_load_dwordx4 v136,s[16:19],s26 offen lds
v_mfma_f32_16x16x32_bf16 a[196:199],v[92:95],v[96:99],a[196:199]
ds_read_b64_tr_b16 v[54:55],v117 offset:58368
s_waitcnt lgkmcnt(9)
v_mfma_f32_16x16x32_bf16 a[200:203],v[56:59],v[100:103],a[200:203]
s_add_u32 s26,s26,s28
v_mfma_f32_16x16x32_bf16 a[204:207],v[60:63],v[100:103],a[204:207]
ds_read_b128 v[108:111],v113 offset:14336
v_mfma_f32_16x16x32_bf16 a[208:211],v[100:103],v[64:67],a[208:211]
s_cmp_lg_u32 s34,0
s_cbranch_scc1 .Lce25
s_cbranch_vccnz .Lcs25
v_smfmac_f32_16x16x64_bf16 v[144:147],v[164:167],v[56:63],v143
v_smfmac_f32_16x16x64_bf16 v[148:151],v[164:167],v[64:71],v143
v_smfmac_f32_16x16x64_bf16 v[152:155],v[164:167],v[72:79],v143
s_branch .Lce25
.Lcs25:
v_smfmac_f32_16x16x64_bf16 v[156:159],v[164:167],v[80:87],v143
v_smfmac_f32_16x16x64_bf16 v[160:163],v[164:167],v[88:95],v143
.Lce25:
v_mfma_f32_16x16x32_bf16 a[212:215],v[100:103],v[68:71],a[212:215]
v_mfma_f32_16x16x32_bf16 a[216:219],v[100:103],v[72:75],a[216:219]
v_mfma_f32_16x16x32_bf16 a[220:223],v[100:103],v[76:79],a[220:223]
v_mfma_f32_16x16x32_bf16 a[224:227],v[80:83],v[100:103],a[224:227]
v_mfma_f32_16x16x32_bf16 a[228:231],v[84:87],v[100:103],a[228:231]
v_mfma_f32_16x16x32_bf16 a[232:235],v[88:91],v[100:103],a[232:235]
s_waitcnt vmcnt(12) lgkmcnt(0)
s_barrier
v_mfma_f32_16x16x32_bf16 a[236:239],v[92:95],v[100:103],a[236:239]
s_add_u32 m0,s33,0
v_mfma_f32_16x16x32_bf16 a[240:243],v[56:59],v[104:107],a[240:243]
buffer_load_dwordx4 v128,s[8:11],s24 offen lds
v_mfma_f32_16x16x32_bf16 a[244:247],v[60:63],v[104:107],a[244:247]
ds_read_b128 v[96:99],v114
v_mfma_f32_16x16x32_bf16 a[248:251],v[104:107],v[64:67],a[248:251]
v_mfma_f32_16x16x32_bf16 a[252:255],v[104:107],v[68:71],a[252:255]
v_mfma_f32_16x16x32_bf16 v[192:195],v[104:107],v[72:75],v[192:195]
v_mfma_f32_16x16x32_bf16 v[196:199],v[104:107],v[76:79],v[196:199]
v_mfma_f32_16x16x32_bf16 v[200:203],v[80:83],v[104:107],v[200:203]
v_mfma_f32_16x16x32_bf16 v[204:207],v[84:87],v[104:107],v[204:207]
v_mfma_f32_16x16x32_bf16 v[208:211],v[88:91],v[104:107],v[208:211]
buffer_load_dwordx4 v129,s[8:11],s24 offen offset:1024 lds
v_mfma_f32_16x16x32_bf16 v[212:215],v[92:95],v[104:107],v[212:215]
v_mfma_f32_16x16x32_bf16 v[216:219],v[56:59],v[108:111],v[216:219]
v_mfma_f32_16x16x32_bf16 v[220:223],v[60:63],v[108:111],v[220:223]
ds_read_b128 v[100:103],v114 offset:2048
v_mfma_f32_16x16x32_bf16 v[224:227],v[108:111],v[64:67],v[224:227]
v_mfma_f32_16x16x32_bf16 v[228:231],v[108:111],v[68:71],v[228:231]
v_mfma_f32_16x16x32_bf16 v[232:235],v[108:111],v[72:75],v[232:235]
v_mfma_f32_16x16x32_bf16 v[236:239],v[108:111],v[76:79],v[236:239]
v_mfma_f32_16x16x32_bf16 v[240:243],v[80:83],v[108:111],v[240:243]
buffer_load_dwordx4 v130,s[8:11],s24 offen offset:2048 lds
v_mfma_f32_16x16x32_bf16 v[244:247],v[84:87],v[108:111],v[244:247]
v_mfma_f32_16x16x32_bf16 v[248:251],v[88:91],v[108:111],v[248:251]
v_mfma_f32_16x16x32_bf16 v[252:255],v[92:95],v[108:111],v[252:255]
s_waitcnt lgkmcnt(1)
v_mfma_f32_16x16x32_bf16 a[0:3],v[16:19],v[96:99],a[0:3]
v_mfma_f32_16x16x32_bf16 a[4:7],v[20:23],v[96:99],a[4:7]
ds_read_b128 v[104:107],v114 offset:4096
v_mfma_f32_16x16x32_bf16 a[8:11],v[96:99],v[24:27],a[8:11]
v_mfma_f32_16x16x32_bf16 a[12:15],v[96:99],v[28:31],a[12:15]
ds_read_b64_tr_b16 v[56:57],v118
v_mfma_f32_16x16x32_bf16 a[16:19],v[96:99],v[32:35],a[16:19]
buffer_load_dwordx4 v131,s[8:11],s24 offen offset:3072 lds
v_mfma_f32_16x16x32_bf16 a[20:23],v[96:99],v[36:39],a[20:23]
ds_read_b64_tr_b16 v[58:59],v118 offset:1024
v_mfma_f32_16x16x32_bf16 a[24:27],v[40:43],v[96:99],a[24:27]
v_mfma_f32_16x16x32_bf16 a[28:31],v[44:47],v[96:99],a[28:31]
ds_read_b64_tr_b16 v[60:61],v119
v_mfma_f32_16x16x32_bf16 a[32:35],v[48:51],v[96:99],a[32:35]
s_add_u32 m0,s33,4096
v_mfma_f32_16x16x32_bf16 a[36:39],v[52:55],v[96:99],a[36:39]
ds_read_b64_tr_b16 v[62:63],v119 offset:1024
s_waitcnt lgkmcnt(5)
v_mfma_f32_16x16x32_bf16 a[40:43],v[16:19],v[100:103],a[40:43]
v_mfma_f32_16x16x32_bf16 a[44:47],v[20:23],v[100:103],a[44:47]
ds_read_b128 v[108:111],v114 offset:6144
v_mfma_f32_16x16x32_bf16 a[48:51],v[100:103],v[24:27],a[48:51]
v_mfma_f32_16x16x32_bf16 a[52:55],v[100:103],v[28:31],a[52:55]
ds_read_b64_tr_b16 v[64:65],v124 offset:4096
v_mfma_f32_16x16x32_bf16 a[56:59],v[100:103],v[32:35],a[56:59]
buffer_load_dwordx4 v128,s[8:11],s32 offen lds
v_mfma_f32_16x16x32_bf16 a[60:63],v[100:103],v[36:39],a[60:63]
ds_read_b64_tr_b16 v[66:67],v124 offset:5120
v_mfma_f32_16x16x32_bf16 a[64:67],v[40:43],v[100:103],a[64:67]
v_mfma_f32_16x16x32_bf16 a[68:71],v[44:47],v[100:103],a[68:71]
ds_read_b64_tr_b16 v[68:69],v125 offset:4096
v_mfma_f32_16x16x32_bf16 a[72:75],v[48:51],v[100:103],a[72:75]
v_mfma_f32_16x16x32_bf16 a[76:79],v[52:55],v[100:103],a[76:79]
ds_read_b64_tr_b16 v[70:71],v125 offset:5120
s_waitcnt lgkmcnt(9)
v_mfma_f32_16x16x32_bf16 a[80:83],v[16:19],v[104:107],a[80:83]
buffer_load_dwordx4 v129,s[8:11],s32 offen offset:1024 lds
v_mfma_f32_16x16x32_bf16 a[84:87],v[20:23],v[104:107],a[84:87]
ds_read_b128 v[96:99],v114 offset:8192
v_mfma_f32_16x16x32_bf16 a[88:91],v[104:107],v[24:27],a[88:91]
v_mfma_f32_16x16x32_bf16 a[92:95],v[104:107],v[28:31],a[92:95]
ds_read_b64_tr_b16 v[72:73],v126 offset:4096
v_mfma_f32_16x16x32_bf16 a[96:99],v[104:107],v[32:35],a[96:99]
v_mfma_f32_16x16x32_bf16 a[100:103],v[104:107],v[36:39],a[100:103]
ds_read_b64_tr_b16 v[74:75],v126 offset:5120
v_mfma_f32_16x16x32_bf16 a[104:107],v[40:43],v[104:107],a[104:107]
v_mfma_f32_16x16x32_bf16 a[108:111],v[44:47],v[104:107],a[108:111]
ds_read_b64_tr_b16 v[76:77],v127 offset:4096
v_mfma_f32_16x16x32_bf16 a[112:115],v[48:51],v[104:107],a[112:115]
buffer_load_dwordx4 v130,s[8:11],s32 offen offset:2048 lds
v_mfma_f32_16x16x32_bf16 a[116:119],v[52:55],v[104:107],a[116:119]
ds_read_b64_tr_b16 v[78:79],v127 offset:5120
s_waitcnt lgkmcnt(9)
v_mfma_f32_16x16x32_bf16 a[120:123],v[16:19],v[108:111],a[120:123]
v_mfma_f32_16x16x32_bf16 a[124:127],v[20:23],v[108:111],a[124:127]
ds_read_b128 v[100:103],v114 offset:10240
v_mfma_f32_16x16x32_bf16 a[128:131],v[108:111],v[24:27],a[128:131]
v_min_u32 v168,7,v2
v_lshlrev_b32 v168,7,v168
v_mfma_f32_16x16x32_bf16 a[132:135],v[108:111],v[28:31],a[132:135]
ds_read_b64_tr_b16 v[80:81],v118 offset:12288
v_mfma_f32_16x16x32_bf16 a[136:139],v[108:111],v[32:35],a[136:139]
buffer_load_dwordx4 v131,s[8:11],s32 offen offset:3072 lds
v_mfma_f32_16x16x32_bf16 a[140:143],v[108:111],v[36:39],a[140:143]
ds_read_b64_tr_b16 v[82:83],v118 offset:13312
v_mfma_f32_16x16x32_bf16 a[144:147],v[40:43],v[108:111],a[144:147]
buffer_load_dword v139,v168,s[8:11],s63 offen offset:2048
v_mfma_f32_16x16x32_bf16 a[148:151],v[44:47],v[108:111],a[148:151]
ds_read_b64_tr_b16 v[84:85],v119 offset:12288
v_mfma_f32_16x16x32_bf16 a[152:155],v[48:51],v[108:111],a[152:155]
s_add_u32 s24,s24,128
v_mfma_f32_16x16x32_bf16 a[156:159],v[52:55],v[108:111],a[156:159]
ds_read_b64_tr_b16 v[86:87],v119 offset:13312
s_waitcnt lgkmcnt(9)
v_mfma_f32_16x16x32_bf16 a[160:163],v[16:19],v[96:99],a[160:163]
s_add_u32 s32,s32,128
v_mfma_f32_16x16x32_bf16 a[164:167],v[20:23],v[96:99],a[164:167]
ds_read_b128 v[104:107],v114 offset:12288
v_mfma_f32_16x16x32_bf16 a[168:171],v[96:99],v[24:27],a[168:171]
s_add_u32 m0,s29,106496
v_mfma_f32_16x16x32_bf16 a[172:175],v[96:99],v[28:31],a[172:175]
ds_read_b64_tr_b16 v[88:89],v118 offset:16384
v_mfma_f32_16x16x32_bf16 a[176:179],v[96:99],v[32:35],a[176:179]
buffer_load_dwordx4 v132,s[12:15],s25 offen lds
v_mfma_f32_16x16x32_bf16 a[180:183],v[96:99],v[36:39],a[180:183]
ds_read_b64_tr_b16 v[90:91],v118 offset:17408
v_mfma_f32_16x16x32_bf16 a[184:187],v[40:43],v[96:99],a[184:187]
v_mfma_f32_16x16x32_bf16 a[188:191],v[44:47],v[96:99],a[188:191]
ds_read_b64_tr_b16 v[92:93],v119 offset:16384
v_mfma_f32_16x16x32_bf16 a[192:195],v[48:51],v[96:99],a[192:195]
v_mfma_f32_16x16x32_bf16 a[196:199],v[52:55],v[96:99],a[196:199]
ds_read_b64_tr_b16 v[94:95],v119 offset:17408
s_waitcnt lgkmcnt(9)
v_mfma_f32_16x16x32_bf16 a[200:203],v[16:19],v[100:103],a[200:203]
buffer_load_dwordx4 v133,s[12:15],s25 offen offset:1024 lds
v_mfma_f32_16x16x32_bf16 a[204:207],v[20:23],v[100:103],a[204:207]
ds_read_b128 v[108:111],v114 offset:14336
v_mfma_f32_16x16x32_bf16 a[208:211],v[100:103],v[24:27],a[208:211]
s_cmp_lg_u32 s34,0
s_cbranch_scc1 .Lce26
s_cbranch_vccnz .Lcs26
v_smfmac_f32_16x16x64_bf16 v[144:147],v[164:167],v[16:23],v143
v_smfmac_f32_16x16x64_bf16 v[148:151],v[164:167],v[24:31],v143
v_smfmac_f32_16x16x64_bf16 v[152:155],v[164:167],v[32:39],v143
s_branch .Lce26
.Lcs26:
v_smfmac_f32_16x16x64_bf16 v[156:159],v[164:167],v[40:47],v143
v_smfmac_f32_16x16x64_bf16 v[160:163],v[164:167],v[48:55],v143
.Lce26:
v_mfma_f32_16x16x32_bf16 a[212:215],v[100:103],v[28:31],a[212:215]
v_mfma_f32_16x16x32_bf16 a[216:219],v[100:103],v[32:35],a[216:219]
v_mfma_f32_16x16x32_bf16 a[220:223],v[100:103],v[36:39],a[220:223]
v_mfma_f32_16x16x32_bf16 a[224:227],v[40:43],v[100:103],a[224:227]
buffer_load_dwordx4 v134,s[12:15],s25 offen offset:2048 lds
v_mfma_f32_16x16x32_bf16 a[228:231],v[44:47],v[100:103],a[228:231]
v_mfma_f32_16x16x32_bf16 a[232:235],v[48:51],v[100:103],a[232:235]
s_waitcnt vmcnt(19) lgkmcnt(0)
s_barrier
v_mfma_f32_16x16x32_bf16 a[236:239],v[52:55],v[100:103],a[236:239]
v_mfma_f32_16x16x32_bf16 a[240:243],v[16:19],v[104:107],a[240:243]
v_mfma_f32_16x16x32_bf16 a[244:247],v[20:23],v[104:107],a[244:247]
ds_read_b128 v[96:99],v115
v_mfma_f32_16x16x32_bf16 a[248:251],v[104:107],v[24:27],a[248:251]
v_mfma_f32_16x16x32_bf16 a[252:255],v[104:107],v[28:31],a[252:255]
v_mfma_f32_16x16x32_bf16 v[192:195],v[104:107],v[32:35],v[192:195]
buffer_load_dwordx4 v135,s[12:15],s25 offen offset:3072 lds
v_mfma_f32_16x16x32_bf16 v[196:199],v[104:107],v[36:39],v[196:199]
v_mfma_f32_16x16x32_bf16 v[200:203],v[40:43],v[104:107],v[200:203]
s_add_u32 s25,s25,s27
v_mfma_f32_16x16x32_bf16 v[204:207],v[44:47],v[104:107],v[204:207]
v_mfma_f32_16x16x32_bf16 v[208:211],v[48:51],v[104:107],v[208:211]
s_add_u32 m0,s30,122880
v_mfma_f32_16x16x32_bf16 v[212:215],v[52:55],v[104:107],v[212:215]
v_mfma_f32_16x16x32_bf16 v[216:219],v[16:19],v[108:111],v[216:219]
v_mfma_f32_16x16x32_bf16 v[220:223],v[20:23],v[108:111],v[220:223]
ds_read_b128 v[100:103],v115 offset:2048
v_mfma_f32_16x16x32_bf16 v[224:227],v[108:111],v[24:27],v[224:227]
v_mfma_f32_16x16x32_bf16 v[228:231],v[108:111],v[28:31],v[228:231]
v_mfma_f32_16x16x32_bf16 v[232:235],v[108:111],v[32:35],v[232:235]
buffer_load_dwordx4 v136,s[16:19],s26 offen lds
v_mfma_f32_16x16x32_bf16 v[236:239],v[108:111],v[36:39],v[236:239]
v_mfma_f32_16x16x32_bf16 v[240:243],v[40:43],v[108:111],v[240:243]
v_mfma_f32_16x16x32_bf16 v[244:247],v[44:47],v[108:111],v[244:247]
v_mfma_f32_16x16x32_bf16 v[248:251],v[48:51],v[108:111],v[248:251]
s_add_u32 s26,s26,s28
v_mfma_f32_16x16x32_bf16 v[252:255],v[52:55],v[108:111],v[252:255]
s_waitcnt lgkmcnt(1)
v_mfma_f32_16x16x32_bf16 a[0:3],v[56:59],v[96:99],a[0:3]
v_mfma_f32_16x16x32_bf16 a[4:7],v[60:63],v[96:99],a[4:7]
ds_read_b128 v[104:107],v115 offset:4096
v_mfma_f32_16x16x32_bf16 a[8:11],v[96:99],v[64:67],a[8:11]
v_mfma_f32_16x16x32_bf16 a[12:15],v[96:99],v[68:71],a[12:15]
ds_read_b64_tr_b16 v[16:17],v116
v_mfma_f32_16x16x32_bf16 a[16:19],v[96:99],v[72:75],a[16:19]
s_add_u32 m0,s29,126976
v_mfma_f32_16x16x32_bf16 a[20:23],v[96:99],v[76:79],a[20:23]
ds_read_b64_tr_b16 v[18:19],v116 offset:1024
v_mfma_f32_16x16x32_bf16 a[24:27],v[80:83],v[96:99],a[24:27]
v_mfma_f32_16x16x32_bf16 a[28:31],v[84:87],v[96:99],a[28:31]
ds_read_b64_tr_b16 v[20:21],v117
v_mfma_f32_16x16x32_bf16 a[32:35],v[88:91],v[96:99],a[32:35]
buffer_load_dwordx4 v132,s[12:15],s25 offen lds
v_mfma_f32_16x16x32_bf16 a[36:39],v[92:95],v[96:99],a[36:39]
ds_read_b64_tr_b16 v[22:23],v117 offset:1024
s_waitcnt lgkmcnt(5)
v_mfma_f32_16x16x32_bf16 a[40:43],v[56:59],v[100:103],a[40:43]
v_mfma_f32_16x16x32_bf16 a[44:47],v[60:63],v[100:103],a[44:47]
ds_read_b128 v[108:111],v115 offset:6144
v_mfma_f32_16x16x32_bf16 a[48:51],v[100:103],v[64:67],a[48:51]
v_mfma_f32_16x16x32_bf16 a[52:55],v[100:103],v[68:71],a[52:55]
ds_read_b64_tr_b16 v[24:25],v120 offset:4096
v_mfma_f32_16x16x32_bf16 a[56:59],v[100:103],v[72:75],a[56:59]
v_mfma_f32_16x16x32_bf16 a[60:63],v[100:103],v[76:79],a[60:63]
ds_read_b64_tr_b16 v[26:27],v120 offset:5120
v_mfma_f32_16x16x32_bf16 a[64:67],v[80:83],v[100:103],a[64:67]
v_mfma_f32_16x16x32_bf16 a[68:71],v[84:87],v[100:103],a[68:71]
ds_read_b64_tr_b16 v[28:29],v121 offset:4096
v_mfma_f32_16x16x32_bf16 a[72:75],v[88:91],v[100:103],a[72:75]
buffer_load_dwordx4 v133,s[12:15],s25 offen offset:1024 lds
v_mfma_f32_16x16x32_bf16 a[76:79],v[92:95],v[100:103],a[76:79]
ds_read_b64_tr_b16 v[30:31],v121 offset:5120
s_waitcnt lgkmcnt(9)
v_mfma_f32_16x16x32_bf16 a[80:83],v[56:59],v[104:107],a[80:83]
v_mfma_f32_16x16x32_bf16 a[84:87],v[60:63],v[104:107],a[84:87]
ds_read_b128 v[96:99],v115 offset:8192
v_mfma_f32_16x16x32_bf16 a[88:91],v[104:107],v[64:67],a[88:91]
v_mfma_f32_16x16x32_bf16 a[92:95],v[104:107],v[68:71],a[92:95]
ds_read_b64_tr_b16 v[32:33],v122 offset:4096
v_mfma_f32_16x16x32_bf16 a[96:99],v[104:107],v[72:75],a[96:99]
v_mfma_f32_16x16x32_bf16 a[100:103],v[104:107],v[76:79],a[100:103]
ds_read_b64_tr_b16 v[34:35],v122 offset:5120
v_mfma_f32_16x16x32_bf16 a[104:107],v[80:83],v[104:107],a[104:107]
v_mfma_f32_16x16x32_bf16 a[108:111],v[84:87],v[104:107],a[108:111]
ds_read_b64_tr_b16 v[36:37],v123 offset:4096
v_mfma_f32_16x16x32_bf16 a[112:115],v[88:91],v[104:107],a[112:115]
buffer_load_dwordx4 v134,s[12:15],s25 offen offset:2048 lds
v_mfma_f32_16x16x32_bf16 a[116:119],v[92:95],v[104:107],a[116:119]
ds_read_b64_tr_b16 v[38:39],v123 offset:5120
s_waitcnt lgkmcnt(9)
v_mfma_f32_16x16x32_bf16 a[120:123],v[56:59],v[108:111],a[120:123]
v_mfma_f32_16x16x32_bf16 a[124:127],v[60:63],v[108:111],a[124:127]
ds_read_b128 v[100:103],v115 offset:10240
v_mfma_f32_16x16x32_bf16 a[128:131],v[108:111],v[64:67],a[128:131]
v_min_u32 v168,7,v2
v_lshlrev_b32 v168,7,v168
v_mfma_f32_16x16x32_bf16 a[132:135],v[108:111],v[68:71],a[132:135]
ds_read_b64_tr_b16 v[40:41],v116 offset:12288
v_mfma_f32_16x16x32_bf16 a[136:139],v[108:111],v[72:75],a[136:139]
v_mfma_f32_16x16x32_bf16 a[140:143],v[108:111],v[76:79],a[140:143]
ds_read_b64_tr_b16 v[42:43],v116 offset:13312
v_mfma_f32_16x16x32_bf16 a[144:147],v[80:83],v[108:111],a[144:147]
buffer_load_dword v139,v168,s[8:11],s63 offen offset:3072
v_mfma_f32_16x16x32_bf16 a[148:151],v[84:87],v[108:111],a[148:151]
ds_read_b64_tr_b16 v[44:45],v117 offset:12288
v_mfma_f32_16x16x32_bf16 a[152:155],v[88:91],v[108:111],a[152:155]
buffer_load_dwordx4 v135,s[12:15],s25 offen offset:3072 lds
v_mfma_f32_16x16x32_bf16 a[156:159],v[92:95],v[108:111],a[156:159]
ds_read_b64_tr_b16 v[46:47],v117 offset:13312
s_waitcnt lgkmcnt(9)
v_mfma_f32_16x16x32_bf16 a[160:163],v[56:59],v[96:99],a[160:163]
s_add_u32 s25,s25,s27
v_mfma_f32_16x16x32_bf16 a[164:167],v[60:63],v[96:99],a[164:167]
ds_read_b128 v[104:107],v115 offset:12288
v_mfma_f32_16x16x32_bf16 a[168:171],v[96:99],v[64:67],a[168:171]
v_mfma_f32_16x16x32_bf16 a[172:175],v[96:99],v[68:71],a[172:175]
ds_read_b64_tr_b16 v[48:49],v116 offset:16384
v_mfma_f32_16x16x32_bf16 a[176:179],v[96:99],v[72:75],a[176:179]
s_add_u32 m0,s30,143360
v_mfma_f32_16x16x32_bf16 a[180:183],v[96:99],v[76:79],a[180:183]
ds_read_b64_tr_b16 v[50:51],v116 offset:17408
v_mfma_f32_16x16x32_bf16 a[184:187],v[80:83],v[96:99],a[184:187]
v_mfma_f32_16x16x32_bf16 a[188:191],v[84:87],v[96:99],a[188:191]
ds_read_b64_tr_b16 v[52:53],v117 offset:16384
v_mfma_f32_16x16x32_bf16 a[192:195],v[88:91],v[96:99],a[192:195]
buffer_load_dwordx4 v136,s[16:19],s26 offen lds
v_mfma_f32_16x16x32_bf16 a[196:199],v[92:95],v[96:99],a[196:199]
ds_read_b64_tr_b16 v[54:55],v117 offset:17408
s_waitcnt lgkmcnt(9)
v_mfma_f32_16x16x32_bf16 a[200:203],v[56:59],v[100:103],a[200:203]
s_add_u32 s26,s26,s28
v_mfma_f32_16x16x32_bf16 a[204:207],v[60:63],v[100:103],a[204:207]
ds_read_b128 v[108:111],v115 offset:14336
v_mfma_f32_16x16x32_bf16 a[208:211],v[100:103],v[64:67],a[208:211]
s_cmp_lg_u32 s34,0
s_cbranch_scc1 .Lce27
s_cbranch_vccnz .Lcs27
v_smfmac_f32_16x16x64_bf16 v[144:147],v[164:167],v[56:63],v143
v_smfmac_f32_16x16x64_bf16 v[148:151],v[164:167],v[64:71],v143
v_smfmac_f32_16x16x64_bf16 v[152:155],v[164:167],v[72:79],v143
s_branch .Lce27
.Lcs27:
v_smfmac_f32_16x16x64_bf16 v[156:159],v[164:167],v[80:87],v143
v_smfmac_f32_16x16x64_bf16 v[160:163],v[164:167],v[88:95],v143
.Lce27:
v_mfma_f32_16x16x32_bf16 a[212:215],v[100:103],v[68:71],a[212:215]
v_mfma_f32_16x16x32_bf16 a[216:219],v[100:103],v[72:75],a[216:219]
v_mfma_f32_16x16x32_bf16 a[220:223],v[100:103],v[76:79],a[220:223]
v_mfma_f32_16x16x32_bf16 a[224:227],v[80:83],v[100:103],a[224:227]
v_mfma_f32_16x16x32_bf16 a[228:231],v[84:87],v[100:103],a[228:231]
v_mfma_f32_16x16x32_bf16 a[232:235],v[88:91],v[100:103],a[232:235]
s_waitcnt vmcnt(12) lgkmcnt(0)
s_barrier
v_mfma_f32_16x16x32_bf16 a[236:239],v[92:95],v[100:103],a[236:239]
s_add_u32 m0,s33,32768
v_mfma_f32_16x16x32_bf16 a[240:243],v[56:59],v[104:107],a[240:243]
buffer_load_dwordx4 v128,s[8:11],s24 offen lds
v_mfma_f32_16x16x32_bf16 a[244:247],v[60:63],v[104:107],a[244:247]
ds_read_b128 v[96:99],v112
v_mfma_f32_16x16x32_bf16 a[248:251],v[104:107],v[64:67],a[248:251]
v_mfma_f32_16x16x32_bf16 a[252:255],v[104:107],v[68:71],a[252:255]
v_mfma_f32_16x16x32_bf16 v[192:195],v[104:107],v[72:75],v[192:195]
v_mfma_f32_16x16x32_bf16 v[196:199],v[104:107],v[76:79],v[196:199]
v_mfma_f32_16x16x32_bf16 v[200:203],v[80:83],v[104:107],v[200:203]
v_mfma_f32_16x16x32_bf16 v[204:207],v[84:87],v[104:107],v[204:207]
v_mfma_f32_16x16x32_bf16 v[208:211],v[88:91],v[104:107],v[208:211]
buffer_load_dwordx4 v129,s[8:11],s24 offen offset:1024 lds
v_mfma_f32_16x16x32_bf16 v[212:215],v[92:95],v[104:107],v[212:215]
v_mfma_f32_16x16x32_bf16 v[216:219],v[56:59],v[108:111],v[216:219]
v_mfma_f32_16x16x32_bf16 v[220:223],v[60:63],v[108:111],v[220:223]
ds_read_b128 v[100:103],v112 offset:2048
v_mfma_f32_16x16x32_bf16 v[224:227],v[108:111],v[64:67],v[224:227]
v_mfma_f32_16x16x32_bf16 v[228:231],v[108:111],v[68:71],v[228:231]
v_mfma_f32_16x16x32_bf16 v[232:235],v[108:111],v[72:75],v[232:235]
v_mfma_f32_16x16x32_bf16 v[236:239],v[108:111],v[76:79],v[236:239]
v_mfma_f32_16x16x32_bf16 v[240:243],v[80:83],v[108:111],v[240:243]
buffer_load_dwordx4 v130,s[8:11],s24 offen offset:2048 lds
v_mfma_f32_16x16x32_bf16 v[244:247],v[84:87],v[108:111],v[244:247]
v_mfma_f32_16x16x32_bf16 v[248:251],v[88:91],v[108:111],v[248:251]
v_mfma_f32_16x16x32_bf16 v[252:255],v[92:95],v[108:111],v[252:255]
L_trip1B:
s_mov_b32 s50,1
s_waitcnt lgkmcnt(1)
v_mfma_f32_16x16x32_bf16 a[0:3],v[16:19],v[96:99],a[0:3]
v_mfma_f32_16x16x32_bf16 a[4:7],v[20:23],v[96:99],a[4:7]
ds_read_b128 v[104:107],v112 offset:4096
v_mfma_f32_16x16x32_bf16 a[8:11],v[96:99],v[24:27],a[8:11]
v_mfma_f32_16x16x32_bf16 a[12:15],v[96:99],v[28:31],a[12:15]
ds_read_b64_tr_b16 v[56:57],v116 offset:20480
v_mfma_f32_16x16x32_bf16 a[16:19],v[96:99],v[32:35],a[16:19]
buffer_load_dwordx4 v131,s[8:11],s24 offen offset:3072 lds
v_mfma_f32_16x16x32_bf16 a[20:23],v[96:99],v[36:39],a[20:23]
ds_read_b64_tr_b16 v[58:59],v116 offset:21504
v_mfma_f32_16x16x32_bf16 a[24:27],v[40:43],v[96:99],a[24:27]
v_mfma_f32_16x16x32_bf16 a[28:31],v[44:47],v[96:99],a[28:31]
ds_read_b64_tr_b16 v[60:61],v117 offset:20480
v_mfma_f32_16x16x32_bf16 a[32:35],v[48:51],v[96:99],a[32:35]
s_add_u32 m0,s33,36864
v_mfma_f32_16x16x32_bf16 a[36:39],v[52:55],v[96:99],a[36:39]
ds_read_b64_tr_b16 v[62:63],v117 offset:21504
s_waitcnt lgkmcnt(5)
v_mfma_f32_16x16x32_bf16 a[40:43],v[16:19],v[100:103],a[40:43]
v_mfma_f32_16x16x32_bf16 a[44:47],v[20:23],v[100:103],a[44:47]
ds_read_b128 v[108:111],v112 offset:6144
v_mfma_f32_16x16x32_bf16 a[48:51],v[100:103],v[24:27],a[48:51]
buffer_load_dwordx4 v[168:171],v9,s[8:11],s63 offen
v_mfma_f32_16x16x32_bf16 a[52:55],v[100:103],v[28:31],a[52:55]
ds_read_b64_tr_b16 v[64:65],v120 offset:24576
v_mfma_f32_16x16x32_bf16 a[56:59],v[100:103],v[32:35],a[56:59]
buffer_load_dwordx4 v128,s[8:11],s32 offen lds
v_mfma_f32_16x16x32_bf16 a[60:63],v[100:103],v[36:39],a[60:63]
ds_read_b64_tr_b16 v[66:67],v120 offset:25600
v_mfma_f32_16x16x32_bf16 a[64:67],v[40:43],v[100:103],a[64:67]
v_mfma_f32_16x16x32_bf16 a[68:71],v[44:47],v[100:103],a[68:71]
ds_read_b64_tr_b16 v[68:69],v121 offset:24576
v_mfma_f32_16x16x32_bf16 a[72:75],v[48:51],v[100:103],a[72:75]
v_mfma_f32_16x16x32_bf16 a[76:79],v[52:55],v[100:103],a[76:79]
ds_read_b64_tr_b16 v[70:71],v121 offset:25600
s_waitcnt lgkmcnt(9)
v_mfma_f32_16x16x32_bf16 a[80:83],v[16:19],v[104:107],a[80:83]
buffer_load_dwordx4 v129,s[8:11],s32 offen offset:1024 lds
v_mfma_f32_16x16x32_bf16 a[84:87],v[20:23],v[104:107],a[84:87]
ds_read_b128 v[96:99],v112 offset:8192
v_mfma_f32_16x16x32_bf16 a[88:91],v[104:107],v[24:27],a[88:91]
buffer_load_dwordx4 v[172:175],v9,s[8:11],s63 offen offset:1024
v_mfma_f32_16x16x32_bf16 a[92:95],v[104:107],v[28:31],a[92:95]
ds_read_b64_tr_b16 v[72:73],v122 offset:24576
v_mfma_f32_16x16x32_bf16 a[96:99],v[104:107],v[32:35],a[96:99]
v_mfma_f32_16x16x32_bf16 a[100:103],v[104:107],v[36:39],a[100:103]
ds_read_b64_tr_b16 v[74:75],v122 offset:25600
v_mfma_f32_16x16x32_bf16 a[104:107],v[40:43],v[104:107],a[104:107]
v_mfma_f32_16x16x32_bf16 a[108:111],v[44:47],v[104:107],a[108:111]
ds_read_b64_tr_b16 v[76:77],v123 offset:24576
v_mfma_f32_16x16x32_bf16 a[112:115],v[48:51],v[104:107],a[112:115]
buffer_load_dwordx4 v130,s[8:11],s32 offen offset:2048 lds
v_mfma_f32_16x16x32_bf16 a[116:119],v[52:55],v[104:107],a[116:119]
ds_read_b64_tr_b16 v[78:79],v123 offset:25600
s_waitcnt lgkmcnt(9)
v_mfma_f32_16x16x32_bf16 a[120:123],v[16:19],v[108:111],a[120:123]
v_mfma_f32_16x16x32_bf16 a[124:127],v[20:23],v[108:111],a[124:127]
ds_read_b128 v[100:103],v112 offset:10240
v_mfma_f32_16x16x32_bf16 a[128:131],v[108:111],v[24:27],a[128:131]
buffer_load_dwordx4 v[176:179],v9,s[8:11],s63 offen offset:2048
v_mfma_f32_16x16x32_bf16 a[132:135],v[108:111],v[28:31],a[132:135]
ds_read_b64_tr_b16 v[80:81],v116 offset:32768
v_mfma_f32_16x16x32_bf16 a[136:139],v[108:111],v[32:35],a[136:139]
buffer_load_dwordx4 v131,s[8:11],s32 offen offset:3072 lds
v_mfma_f32_16x16x32_bf16 a[140:143],v[108:111],v[36:39],a[140:143]
ds_read_b64_tr_b16 v[82:83],v116 offset:33792
v_mfma_f32_16x16x32_bf16 a[144:147],v[40:43],v[108:111],a[144:147]
v_mfma_f32_16x16x32_bf16 a[148:151],v[44:47],v[108:111],a[148:151]
ds_read_b64_tr_b16 v[84:85],v117 offset:32768
v_mfma_f32_16x16x32_bf16 a[152:155],v[48:51],v[108:111],a[152:155]
s_add_u32 s24,s24,128
v_mfma_f32_16x16x32_bf16 a[156:159],v[52:55],v[108:111],a[156:159]
ds_read_b64_tr_b16 v[86:87],v117 offset:33792
s_waitcnt lgkmcnt(9)
v_mfma_f32_16x16x32_bf16 a[160:163],v[16:19],v[96:99],a[160:163]
s_add_u32 s32,s32,128
v_mfma_f32_16x16x32_bf16 a[164:167],v[20:23],v[96:99],a[164:167]
ds_read_b128 v[104:107],v112 offset:12288
v_mfma_f32_16x16x32_bf16 a[168:171],v[96:99],v[24:27],a[168:171]
s_add_u32 m0,s29,65536
v_mfma_f32_16x16x32_bf16 a[172:175],v[96:99],v[28:31],a[172:175]
ds_read_b64_tr_b16 v[88:89],v116 offset:36864
v_mfma_f32_16x16x32_bf16 a[176:179],v[96:99],v[32:35],a[176:179]
buffer_load_dwordx4 v132,s[12:15],s25 offen lds
v_mfma_f32_16x16x32_bf16 a[180:183],v[96:99],v[36:39],a[180:183]
ds_read_b64_tr_b16 v[90:91],v116 offset:37888
v_mfma_f32_16x16x32_bf16 a[184:187],v[40:43],v[96:99],a[184:187]
buffer_load_dwordx4 v[180:183],v9,s[8:11],s63 offen offset:3072
v_mfma_f32_16x16x32_bf16 a[188:191],v[44:47],v[96:99],a[188:191]
ds_read_b64_tr_b16 v[92:93],v117 offset:36864
v_mfma_f32_16x16x32_bf16 a[192:195],v[48:51],v[96:99],a[192:195]
v_mfma_f32_16x16x32_bf16 a[196:199],v[52:55],v[96:99],a[196:199]
ds_read_b64_tr_b16 v[94:95],v117 offset:37888
s_waitcnt lgkmcnt(9)
v_mfma_f32_16x16x32_bf16 a[200:203],v[16:19],v[100:103],a[200:203]
buffer_load_dwordx4 v133,s[12:15],s25 offen offset:1024 lds
v_mfma_f32_16x16x32_bf16 a[204:207],v[20:23],v[100:103],a[204:207]
ds_read_b128 v[108:111],v112 offset:14336
v_mfma_f32_16x16x32_bf16 a[208:211],v[100:103],v[24:27],a[208:211]
s_cmp_lg_u32 s34,1
s_cbranch_scc1 .Lce28
s_cbranch_vccnz .Lcs28
v_smfmac_f32_16x16x64_bf16 v[144:147],v[164:167],v[16:23],v143
v_smfmac_f32_16x16x64_bf16 v[148:151],v[164:167],v[24:31],v143
v_smfmac_f32_16x16x64_bf16 v[152:155],v[164:167],v[32:39],v143
s_branch .Lce28
.Lcs28:
v_smfmac_f32_16x16x64_bf16 v[156:159],v[164:167],v[40:47],v143
v_smfmac_f32_16x16x64_bf16 v[160:163],v[164:167],v[48:55],v143
.Lce28:
v_mfma_f32_16x16x32_bf16 a[212:215],v[100:103],v[28:31],a[212:215]
v_mfma_f32_16x16x32_bf16 a[216:219],v[100:103],v[32:35],a[216:219]
v_mfma_f32_16x16x32_bf16 a[220:223],v[100:103],v[36:39],a[220:223]
v_mfma_f32_16x16x32_bf16 a[224:227],v[40:43],v[100:103],a[224:227]
buffer_load_dwordx4 v134,s[12:15],s25 offen offset:2048 lds
v_mfma_f32_16x16x32_bf16 a[228:231],v[44:47],v[100:103],a[228:231]
v_mfma_f32_16x16x32_bf16 a[232:235],v[48:51],v[100:103],a[232:235]
s_waitcnt vmcnt(21) lgkmcnt(0)
s_barrier
v_mfma_f32_16x16x32_bf16 a[236:239],v[52:55],v[100:103],a[236:239]
v_mfma_f32_16x16x32_bf16 a[240:243],v[16:19],v[104:107],a[240:243]
v_mfma_f32_16x16x32_bf16 a[244:247],v[20:23],v[104:107],a[244:247]
ds_read_b128 v[96:99],v113
v_mfma_f32_16x16x32_bf16 a[248:251],v[104:107],v[24:27],a[248:251]
v_mfma_f32_16x16x32_bf16 a[252:255],v[104:107],v[28:31],a[252:255]
v_mfma_f32_16x16x32_bf16 v[192:195],v[104:107],v[32:35],v[192:195]
buffer_load_dwordx4 v135,s[12:15],s25 offen offset:3072 lds
v_mfma_f32_16x16x32_bf16 v[196:199],v[104:107],v[36:39],v[196:199]
v_mfma_f32_16x16x32_bf16 v[200:203],v[40:43],v[104:107],v[200:203]
s_add_u32 s25,s25,s27
v_mfma_f32_16x16x32_bf16 v[204:207],v[44:47],v[104:107],v[204:207]
v_mfma_f32_16x16x32_bf16 v[208:211],v[48:51],v[104:107],v[208:211]
s_add_u32 m0,s30,81920
v_mfma_f32_16x16x32_bf16 v[212:215],v[52:55],v[104:107],v[212:215]
v_mfma_f32_16x16x32_bf16 v[216:219],v[16:19],v[108:111],v[216:219]
v_mfma_f32_16x16x32_bf16 v[220:223],v[20:23],v[108:111],v[220:223]
ds_read_b128 v[100:103],v113 offset:2048
v_mfma_f32_16x16x32_bf16 v[224:227],v[108:111],v[24:27],v[224:227]
v_mfma_f32_16x16x32_bf16 v[228:231],v[108:111],v[28:31],v[228:231]
v_mfma_f32_16x16x32_bf16 v[232:235],v[108:111],v[32:35],v[232:235]
buffer_load_dwordx4 v136,s[16:19],s26 offen lds
v_mfma_f32_16x16x32_bf16 v[236:239],v[108:111],v[36:39],v[236:239]
v_mfma_f32_16x16x32_bf16 v[240:243],v[40:43],v[108:111],v[240:243]
v_mfma_f32_16x16x32_bf16 v[244:247],v[44:47],v[108:111],v[244:247]
v_mfma_f32_16x16x32_bf16 v[248:251],v[48:51],v[108:111],v[248:251]
s_add_u32 s26,s26,s28
v_mfma_f32_16x16x32_bf16 v[252:255],v[52:55],v[108:111],v[252:255]
s_waitcnt lgkmcnt(1)
v_mfma_f32_16x16x32_bf16 a[0:3],v[56:59],v[96:99],a[0:3]
s_waitcnt vmcnt(4)
s_mov_b32 s44,0xffff0000
v_mfma_f32_16x16x32_bf16 a[4:7],v[60:63],v[96:99],a[4:7]
ds_read_b128 v[104:107],v113 offset:4096
v_lshlrev_b32 v184,16,v168
v_mfma_f32_16x16x32_bf16 a[8:11],v[96:99],v[64:67],a[8:11]
v_and_b32 v185,s44,v168
v_mov_b32 v3,v184
v_mfma_f32_16x16x32_bf16 a[12:15],v[96:99],v[68:71],a[12:15]
ds_read_b64_tr_b16 v[16:17],v116 offset:40960
v_mov_b32 v4,v185
v_mfma_f32_16x16x32_bf16 a[16:19],v[96:99],v[72:75],a[16:19]
s_add_u32 m0,s29,86016
v_lshlrev_b32 v186,16,v176
v_mfma_f32_16x16x32_bf16 a[20:23],v[96:99],v[76:79],a[20:23]
ds_read_b64_tr_b16 v[18:19],v116 offset:41984
v_and_b32 v187,s44,v176
v_mfma_f32_16x16x32_bf16 a[24:27],v[80:83],v[96:99],a[24:27]
v_mov_b32 v5,v186
v_mov_b32 v6,v187
v_mfma_f32_16x16x32_bf16 a[28:31],v[84:87],v[96:99],a[28:31]
ds_read_b64_tr_b16 v[20:21],v117 offset:40960
v_lshlrev_b32 v184,16,v169
v_mfma_f32_16x16x32_bf16 a[32:35],v[88:91],v[96:99],a[32:35]
buffer_load_dwordx4 v132,s[12:15],s25 offen lds
v_mfma_f32_16x16x32_bf16 a[36:39],v[92:95],v[96:99],a[36:39]
ds_read_b64_tr_b16 v[22:23],v117 offset:41984
s_waitcnt lgkmcnt(5)
v_mfma_f32_16x16x32_bf16 a[40:43],v[56:59],v[100:103],a[40:43]
v_and_b32 v185,s44,v169
v_add_f32 v3,v3,v184
v_mfma_f32_16x16x32_bf16 a[44:47],v[60:63],v[100:103],a[44:47]
ds_read_b128 v[108:111],v113 offset:6144
v_add_f32 v4,v4,v185
v_mfma_f32_16x16x32_bf16 a[48:51],v[100:103],v[64:67],a[48:51]
v_lshlrev_b32 v186,16,v177
v_and_b32 v187,s44,v177
v_mfma_f32_16x16x32_bf16 a[52:55],v[100:103],v[68:71],a[52:55]
ds_read_b64_tr_b16 v[24:25],v120 offset:45056
v_add_f32 v5,v5,v186
v_mfma_f32_16x16x32_bf16 a[56:59],v[100:103],v[72:75],a[56:59]
v_add_f32 v6,v6,v187
v_lshlrev_b32 v184,16,v170
v_mfma_f32_16x16x32_bf16 a[60:63],v[100:103],v[76:79],a[60:63]
ds_read_b64_tr_b16 v[26:27],v120 offset:46080
v_and_b32 v185,s44,v170
v_mfma_f32_16x16x32_bf16 a[64:67],v[80:83],v[100:103],a[64:67]
v_add_f32 v3,v3,v184
v_add_f32 v4,v4,v185
v_mfma_f32_16x16x32_bf16 a[68:71],v[84:87],v[100:103],a[68:71]
ds_read_b64_tr_b16 v[28:29],v121 offset:45056
v_lshlrev_b32 v186,16,v178
v_mfma_f32_16x16x32_bf16 a[72:75],v[88:91],v[100:103],a[72:75]
buffer_load_dwordx4 v133,s[12:15],s25 offen offset:1024 lds
v_mfma_f32_16x16x32_bf16 a[76:79],v[92:95],v[100:103],a[76:79]
ds_read_b64_tr_b16 v[30:31],v121 offset:46080
s_waitcnt lgkmcnt(9)
v_mfma_f32_16x16x32_bf16 a[80:83],v[56:59],v[104:107],a[80:83]
v_and_b32 v187,s44,v178
v_add_f32 v5,v5,v186
v_mfma_f32_16x16x32_bf16 a[84:87],v[60:63],v[104:107],a[84:87]
ds_read_b128 v[96:99],v113 offset:8192
v_add_f32 v6,v6,v187
v_mfma_f32_16x16x32_bf16 a[88:91],v[104:107],v[64:67],a[88:91]
v_lshlrev_b32 v184,16,v171
v_and_b32 v185,s44,v171
v_mfma_f32_16x16x32_bf16 a[92:95],v[104:107],v[68:71],a[92:95]
ds_read_b64_tr_b16 v[32:33],v122 offset:45056
v_add_f32 v3,v3,v184
v_mfma_f32_16x16x32_bf16 a[96:99],v[104:107],v[72:75],a[96:99]
v_add_f32 v4,v4,v185
v_lshlrev_b32 v186,16,v179
v_mfma_f32_16x16x32_bf16 a[100:103],v[104:107],v[76:79],a[100:103]
ds_read_b64_tr_b16 v[34:35],v122 offset:46080
v_and_b32 v187,s44,v179
v_mfma_f32_16x16x32_bf16 a[104:107],v[80:83],v[104:107],a[104:107]
v_add_f32 v5,v5,v186
v_add_f32 v6,v6,v187
v_mfma_f32_16x16x32_bf16 a[108:111],v[84:87],v[104:107],a[108:111]
ds_read_b64_tr_b16 v[36:37],v123 offset:45056
v_lshlrev_b32 v184,16,v172
v_mfma_f32_16x16x32_bf16 a[112:115],v[88:91],v[104:107],a[112:115]
buffer_load_dwordx4 v134,s[12:15],s25 offen offset:2048 lds
v_mfma_f32_16x16x32_bf16 a[116:119],v[92:95],v[104:107],a[116:119]
ds_read_b64_tr_b16 v[38:39],v123 offset:46080
s_waitcnt lgkmcnt(9)
v_mfma_f32_16x16x32_bf16 a[120:123],v[56:59],v[108:111],a[120:123]
v_and_b32 v185,s44,v172
v_add_f32 v3,v3,v184
v_mfma_f32_16x16x32_bf16 a[124:127],v[60:63],v[108:111],a[124:127]
ds_read_b128 v[100:103],v113 offset:10240
v_add_f32 v4,v4,v185
v_mfma_f32_16x16x32_bf16 a[128:131],v[108:111],v[64:67],a[128:131]
v_lshlrev_b32 v186,16,v180
v_and_b32 v187,s44,v180
v_mfma_f32_16x16x32_bf16 a[132:135],v[108:111],v[68:71],a[132:135]
ds_read_b64_tr_b16 v[40:41],v116 offset:53248
v_add_f32 v5,v5,v186
v_mfma_f32_16x16x32_bf16 a[136:139],v[108:111],v[72:75],a[136:139]
v_add_f32 v6,v6,v187
v_lshlrev_b32 v184,16,v173
v_mfma_f32_16x16x32_bf16 a[140:143],v[108:111],v[76:79],a[140:143]
ds_read_b64_tr_b16 v[42:43],v116 offset:54272
v_and_b32 v185,s44,v173
v_mfma_f32_16x16x32_bf16 a[144:147],v[80:83],v[108:111],a[144:147]
v_add_f32 v3,v3,v184
v_add_f32 v4,v4,v185
v_mfma_f32_16x16x32_bf16 a[148:151],v[84:87],v[108:111],a[148:151]
ds_read_b64_tr_b16 v[44:45],v117 offset:53248
v_lshlrev_b32 v186,16,v181
v_mfma_f32_16x16x32_bf16 a[152:155],v[88:91],v[108:111],a[152:155]
buffer_load_dwordx4 v135,s[12:15],s25 offen offset:3072 lds
v_mfma_f32_16x16x32_bf16 a[156:159],v[92:95],v[108:111],a[156:159]
ds_read_b64_tr_b16 v[46:47],v117 offset:54272
s_waitcnt lgkmcnt(9)
v_mfma_f32_16x16x32_bf16 a[160:163],v[56:59],v[96:99],a[160:163]
s_add_u32 s25,s25,s27
v_and_b32 v187,s44,v181
v_mfma_f32_16x16x32_bf16 a[164:167],v[60:63],v[96:99],a[164:167]
ds_read_b128 v[104:107],v113 offset:12288
v_add_f32 v5,v5,v186
v_mfma_f32_16x16x32_bf16 a[168:171],v[96:99],v[64:67],a[168:171]
v_add_f32 v6,v6,v187
v_lshlrev_b32 v184,16,v174
v_mfma_f32_16x16x32_bf16 a[172:175],v[96:99],v[68:71],a[172:175]
ds_read_b64_tr_b16 v[48:49],v116 offset:57344
v_and_b32 v185,s44,v174
v_mfma_f32_16x16x32_bf16 a[176:179],v[96:99],v[72:75],a[176:179]
s_add_u32 m0,s30,102400
v_add_f32 v3,v3,v184
v_mfma_f32_16x16x32_bf16 a[180:183],v[96:99],v[76:79],a[180:183]
ds_read_b64_tr_b16 v[50:51],v116 offset:58368
v_add_f32 v4,v4,v185
v_mfma_f32_16x16x32_bf16 a[184:187],v[80:83],v[96:99],a[184:187]
v_lshlrev_b32 v186,16,v182
v_and_b32 v187,s44,v182
v_mfma_f32_16x16x32_bf16 a[188:191],v[84:87],v[96:99],a[188:191]
ds_read_b64_tr_b16 v[52:53],v117 offset:57344
v_add_f32 v5,v5,v186
v_mfma_f32_16x16x32_bf16 a[192:195],v[88:91],v[96:99],a[192:195]
buffer_load_dwordx4 v136,s[16:19],s26 offen lds
v_mfma_f32_16x16x32_bf16 a[196:199],v[92:95],v[96:99],a[196:199]
ds_read_b64_tr_b16 v[54:55],v117 offset:58368
s_waitcnt lgkmcnt(9)
v_mfma_f32_16x16x32_bf16 a[200:203],v[56:59],v[100:103],a[200:203]
s_add_u32 s26,s26,s28
v_add_f32 v6,v6,v187
v_mfma_f32_16x16x32_bf16 a[204:207],v[60:63],v[100:103],a[204:207]
ds_read_b128 v[108:111],v113 offset:14336
v_lshlrev_b32 v184,16,v175
v_mfma_f32_16x16x32_bf16 a[208:211],v[100:103],v[64:67],a[208:211]
s_cmp_lg_u32 s34,1
s_cbranch_scc1 .Lce29
s_cbranch_vccnz .Lcs29
v_smfmac_f32_16x16x64_bf16 v[144:147],v[164:167],v[56:63],v143
v_smfmac_f32_16x16x64_bf16 v[148:151],v[164:167],v[64:71],v143
v_smfmac_f32_16x16x64_bf16 v[152:155],v[164:167],v[72:79],v143
s_branch .Lce29
.Lcs29:
v_smfmac_f32_16x16x64_bf16 v[156:159],v[164:167],v[80:87],v143
v_smfmac_f32_16x16x64_bf16 v[160:163],v[164:167],v[88:95],v143
.Lce29:
v_mfma_f32_16x16x32_bf16 a[212:215],v[100:103],v[68:71],a[212:215]
v_and_b32 v185,s44,v175
v_add_f32 v3,v3,v184
v_mfma_f32_16x16x32_bf16 a[216:219],v[100:103],v[72:75],a[216:219]
v_add_f32 v4,v4,v185
v_lshlrev_b32 v186,16,v183
v_mfma_f32_16x16x32_bf16 a[220:223],v[100:103],v[76:79],a[220:223]
v_and_b32 v187,s44,v183
v_add_f32 v5,v5,v186
v_mfma_f32_16x16x32_bf16 a[224:227],v[80:83],v[100:103],a[224:227]
v_add_f32 v6,v6,v187
v_add_f32 v3,v3,v4
v_mfma_f32_16x16x32_bf16 a[228:231],v[84:87],v[100:103],a[228:231]
v_add_f32 v5,v5,v6
v_mov_b32 v14,0x3a800000
v_mfma_f32_16x16x32_bf16 a[232:235],v[88:91],v[100:103],a[232:235]
s_waitcnt lgkmcnt(0)
s_barrier
v_mfma_f32_16x16x32_bf16 a[236:239],v[92:95],v[100:103],a[236:239]
s_add_u32 m0,s33,0
v_mfma_f32_16x16x32_bf16 a[240:243],v[56:59],v[104:107],a[240:243]
buffer_load_dwordx4 v128,s[8:11],s24 offen lds
v_mfma_f32_16x16x32_bf16 a[244:247],v[60:63],v[104:107],a[244:247]
ds_read_b128 v[96:99],v114
s_nop 0
v_mfma_f32_16x16x32_bf16 a[248:251],v[104:107],v[64:67],a[248:251]
v_add_f32_dpp v3,v3,v3 row_shr:1 row_mask:0xf bank_mask:0xf bound_ctrl:1
v_add_f32_dpp v5,v5,v5 row_shr:1 row_mask:0xf bank_mask:0xf bound_ctrl:1
v_mfma_f32_16x16x32_bf16 a[252:255],v[104:107],v[68:71],a[252:255]
s_nop 0
v_add_f32_dpp v3,v3,v3 row_shr:2 row_mask:0xf bank_mask:0xf bound_ctrl:1
v_mfma_f32_16x16x32_bf16 v[192:195],v[104:107],v[72:75],v[192:195]
v_add_f32_dpp v5,v5,v5 row_shr:2 row_mask:0xf bank_mask:0xf bound_ctrl:1
s_nop 0
v_mfma_f32_16x16x32_bf16 v[196:199],v[104:107],v[76:79],v[196:199]
v_add_f32_dpp v3,v3,v3 row_shr:4 row_mask:0xf bank_mask:0xf bound_ctrl:1
v_add_f32_dpp v5,v5,v5 row_shr:4 row_mask:0xf bank_mask:0xf bound_ctrl:1
v_mfma_f32_16x16x32_bf16 v[200:203],v[80:83],v[104:107],v[200:203]
s_nop 0
v_add_f32_dpp v3,v3,v3 row_shr:8 row_mask:0xf bank_mask:0xf bound_ctrl:1
v_mfma_f32_16x16x32_bf16 v[204:207],v[84:87],v[104:107],v[204:207]
v_add_f32_dpp v5,v5,v5 row_shr:8 row_mask:0xf bank_mask:0xf bound_ctrl:1
s_nop 0
v_mfma_f32_16x16x32_bf16 v[208:211],v[88:91],v[104:107],v[208:211]
buffer_load_dwordx4 v129,s[8:11],s24 offen offset:1024 lds
v_mfma_f32_16x16x32_bf16 v[212:215],v[92:95],v[104:107],v[212:215]
v_add_f32_dpp v3,v3,v3 row_bcast:15 row_mask:0xa bank_mask:0xf
v_mfma_f32_16x16x32_bf16 v[216:219],v[56:59],v[108:111],v[216:219]
v_add_f32_dpp v5,v5,v5 row_bcast:15 row_mask:0xa bank_mask:0xf
s_nop 0
v_mfma_f32_16x16x32_bf16 v[220:223],v[60:63],v[108:111],v[220:223]
ds_read_b128 v[100:103],v114 offset:2048
v_add_f32_dpp v3,v3,v3 row_bcast:31 row_mask:0xc bank_mask:0xf
v_mfma_f32_16x16x32_bf16 v[224:227],v[108:111],v[64:67],v[224:227]
v_add_f32_dpp v5,v5,v5 row_bcast:31 row_mask:0xc bank_mask:0xf
s_nop 0
v_mfma_f32_16x16x32_bf16 v[228:231],v[108:111],v[68:71],v[228:231]
v_readlane_b32 s46,v3,63
v_readlane_b32 s47,v5,63
v_mfma_f32_16x16x32_bf16 v[232:235],v[108:111],v[72:75],v[232:235]
s_nop 0
v_mul_f32 v7,s46,v14
v_mfma_f32_16x16x32_bf16 v[236:239],v[108:111],v[76:79],v[236:239]
v_mul_f32 v8,s47,v14
v_lshlrev_b32 v184,16,v168
v_mfma_f32_16x16x32_bf16 v[240:243],v[80:83],v[108:111],v[240:243]
buffer_load_dwordx4 v130,s[8:11],s24 offen offset:2048 lds
v_mfma_f32_16x16x32_bf16 v[244:247],v[84:87],v[108:111],v[244:247]
v_and_b32 v185,s44,v168
v_sub_f32 v184,v184,v7
v_mfma_f32_16x16x32_bf16 v[248:251],v[88:91],v[108:111],v[248:251]
v_sub_f32 v185,v185,v7
v_mul_f32 v3,v184,v184
v_mfma_f32_16x16x32_bf16 v[252:255],v[92:95],v[108:111],v[252:255]
v_mul_f32 v4,v185,v185
s_waitcnt lgkmcnt(1)
v_mfma_f32_16x16x32_bf16 a[0:3],v[16:19],v[96:99],a[0:3]
v_lshlrev_b32 v186,16,v176
v_and_b32 v187,s44,v176
v_mfma_f32_16x16x32_bf16 a[4:7],v[20:23],v[96:99],a[4:7]
ds_read_b128 v[104:107],v114 offset:4096
v_sub_f32 v186,v186,v8
v_mfma_f32_16x16x32_bf16 a[8:11],v[96:99],v[24:27],a[8:11]
v_sub_f32 v187,v187,v8
v_mul_f32 v5,v186,v186
v_mfma_f32_16x16x32_bf16 a[12:15],v[96:99],v[28:31],a[12:15]
ds_read_b64_tr_b16 v[56:57],v118
v_mul_f32 v6,v187,v187
v_mfma_f32_16x16x32_bf16 a[16:19],v[96:99],v[32:35],a[16:19]
buffer_load_dwordx4 v131,s[8:11],s24 offen offset:3072 lds
v_mfma_f32_16x16x32_bf16 a[20:23],v[96:99],v[36:39],a[20:23]
ds_read_b64_tr_b16 v[58:59],v118 offset:1024
v_lshlrev_b32 v184,16,v169
v_mfma_f32_16x16x32_bf16 a[24:27],v[40:43],v[96:99],a[24:27]
v_and_b32 v185,s44,v169
v_sub_f32 v184,v184,v7
v_mfma_f32_16x16x32_bf16 a[28:31],v[44:47],v[96:99],a[28:31]
ds_read_b64_tr_b16 v[60:61],v119
v_sub_f32 v185,v185,v7
v_mfma_f32_16x16x32_bf16 a[32:35],v[48:51],v[96:99],a[32:35]
s_add_u32 m0,s33,4096
v_fmac_f32 v3,v184,v184
v_mfma_f32_16x16x32_bf16 a[36:39],v[52:55],v[96:99],a[36:39]
ds_read_b64_tr_b16 v[62:63],v119 offset:1024
s_waitcnt lgkmcnt(5)
v_mfma_f32_16x16x32_bf16 a[40:43],v[16:19],v[100:103],a[40:43]
v_fmac_f32 v4,v185,v185
v_lshlrev_b32 v186,16,v177
v_mfma_f32_16x16x32_bf16 a[44:47],v[20:23],v[100:103],a[44:47]
ds_read_b128 v[108:111],v114 offset:6144
v_and_b32 v187,s44,v177
v_mfma_f32_16x16x32_bf16 a[48:51],v[100:103],v[24:27],a[48:51]
v_sub_f32 v186,v186,v8
v_sub_f32 v187,v187,v8
v_mfma_f32_16x16x32_bf16 a[52:55],v[100:103],v[28:31],a[52:55]
ds_read_b64_tr_b16 v[64:65],v124 offset:4096
v_fmac_f32 v5,v186,v186
v_mfma_f32_16x16x32_bf16 a[56:59],v[100:103],v[32:35],a[56:59]
buffer_load_dwordx4 v128,s[8:11],s32 offen lds
v_mfma_f32_16x16x32_bf16 a[60:63],v[100:103],v[36:39],a[60:63]
ds_read_b64_tr_b16 v[66:67],v124 offset:5120
v_fmac_f32 v6,v187,v187
v_mfma_f32_16x16x32_bf16 a[64:67],v[40:43],v[100:103],a[64:67]
v_lshlrev_b32 v184,16,v170
v_and_b32 v185,s44,v170
v_mfma_f32_16x16x32_bf16 a[68:71],v[44:47],v[100:103],a[68:71]
ds_read_b64_tr_b16 v[68:69],v125 offset:4096
v_sub_f32 v184,v184,v7
v_mfma_f32_16x16x32_bf16 a[72:75],v[48:51],v[100:103],a[72:75]
v_sub_f32 v185,v185,v7
v_fmac_f32 v3,v184,v184
v_mfma_f32_16x16x32_bf16 a[76:79],v[52:55],v[100:103],a[76:79]
ds_read_b64_tr_b16 v[70:71],v125 offset:5120
s_waitcnt lgkmcnt(9)
v_mfma_f32_16x16x32_bf16 a[80:83],v[16:19],v[104:107],a[80:83]
buffer_load_dwordx4 v129,s[8:11],s32 offen offset:1024 lds
v_mfma_f32_16x16x32_bf16 a[84:87],v[20:23],v[104:107],a[84:87]
ds_read_b128 v[96:99],v114 offset:8192
v_fmac_f32 v4,v185,v185
v_mfma_f32_16x16x32_bf16 a[88:91],v[104:107],v[24:27],a[88:91]
v_lshlrev_b32 v186,16,v178
v_and_b32 v187,s44,v178
v_mfma_f32_16x16x32_bf16 a[92:95],v[104:107],v[28:31],a[92:95]
ds_read_b64_tr_b16 v[72:73],v126 offset:4096
v_sub_f32 v186,v186,v8
v_mfma_f32_16x16x32_bf16 a[96:99],v[104:107],v[32:35],a[96:99]
v_sub_f32 v187,v187,v8
v_fmac_f32 v5,v186,v186
v_mfma_f32_16x16x32_bf16 a[100:103],v[104:107],v[36:39],a[100:103]
ds_read_b64_tr_b16 v[74:75],v126 offset:5120
v_fmac_f32 v6,v187,v187
v_mfma_f32_16x16x32_bf16 a[104:107],v[40:43],v[104:107],a[104:107]
v_lshlrev_b32 v184,16,v171
v_and_b32 v185,s44,v171
v_mfma_f32_16x16x32_bf16 a[108:111],v[44:47],v[104:107],a[108:111]
ds_read_b64_tr_b16 v[76:77],v127 offset:4096
v_sub_f32 v184,v184,v7
v_mfma_f32_16x16x32_bf16 a[112:115],v[48:51],v[104:107],a[112:115]
buffer_load_dwordx4 v130,s[8:11],s32 offen offset:2048 lds
v_mfma_f32_16x16x32_bf16 a[116:119],v[52:55],v[104:107],a[116:119]
ds_read_b64_tr_b16 v[78:79],v127 offset:5120
s_waitcnt lgkmcnt(9)
v_mfma_f32_16x16x32_bf16 a[120:123],v[16:19],v[108:111],a[120:123]
v_sub_f32 v185,v185,v7
v_fmac_f32 v3,v184,v184
v_mfma_f32_16x16x32_bf16 a[124:127],v[20:23],v[108:111],a[124:127]
ds_read_b128 v[100:103],v114 offset:10240
v_fmac_f32 v4,v185,v185
v_mfma_f32_16x16x32_bf16 a[128:131],v[108:111],v[24:27],a[128:131]
v_lshlrev_b32 v186,16,v179
v_and_b32 v187,s44,v179
v_mfma_f32_16x16x32_bf16 a[132:135],v[108:111],v[28:31],a[132:135]
ds_read_b64_tr_b16 v[80:81],v118 offset:12288
v_sub_f32 v186,v186,v8
v_mfma_f32_16x16x32_bf16 a[136:139],v[108:111],v[32:35],a[136:139]
buffer_load_dwordx4 v131,s[8:11],s32 offen offset:3072 lds
v_mfma_f32_16x16x32_bf16 a[140:143],v[108:111],v[36:39],a[140:143]
ds_read_b64_tr_b16 v[82:83],v118 offset:13312
v_sub_f32 v187,v187,v8
v_mfma_f32_16x16x32_bf16 a[144:147],v[40:43],v[108:111],a[144:147]
v_fmac_f32 v5,v186,v186
v_fmac_f32 v6,v187,v187
v_mfma_f32_16x16x32_bf16 a[148:151],v[44:47],v[108:111],a[148:151]
ds_read_b64_tr_b16 v[84:85],v119 offset:12288
v_lshlrev_b32 v184,16,v172
v_mfma_f32_16x16x32_bf16 a[152:155],v[48:51],v[108:111],a[152:155]
s_add_u32 s24,s24,128
v_and_b32 v185,s44,v172
v_mfma_f32_16x16x32_bf16 a[156:159],v[52:55],v[108:111],a[156:159]
ds_read_b64_tr_b16 v[86:87],v119 offset:13312
s_waitcnt lgkmcnt(9)
v_mfma_f32_16x16x32_bf16 a[160:163],v[16:19],v[96:99],a[160:163]
s_add_u32 s32,s32,128
v_sub_f32 v184,v184,v7
v_mfma_f32_16x16x32_bf16 a[164:167],v[20:23],v[96:99],a[164:167]
ds_read_b128 v[104:107],v114 offset:12288
v_sub_f32 v185,v185,v7
v_mfma_f32_16x16x32_bf16 a[168:171],v[96:99],v[24:27],a[168:171]
s_add_u32 m0,s29,106496
v_fmac_f32 v3,v184,v184
v_mfma_f32_16x16x32_bf16 a[172:175],v[96:99],v[28:31],a[172:175]
ds_read_b64_tr_b16 v[88:89],v118 offset:16384
v_fmac_f32 v4,v185,v185
v_mfma_f32_16x16x32_bf16 a[176:179],v[96:99],v[32:35],a[176:179]
buffer_load_dwordx4 v132,s[12:15],s25 offen lds
v_mfma_f32_16x16x32_bf16 a[180:183],v[96:99],v[36:39],a[180:183]
ds_read_b64_tr_b16 v[90:91],v118 offset:17408
v_lshlrev_b32 v186,16,v180
v_mfma_f32_16x16x32_bf16 a[184:187],v[40:43],v[96:99],a[184:187]
v_and_b32 v187,s44,v180
v_sub_f32 v186,v186,v8
v_mfma_f32_16x16x32_bf16 a[188:191],v[44:47],v[96:99],a[188:191]
ds_read_b64_tr_b16 v[92:93],v119 offset:16384
v_sub_f32 v187,v187,v8
v_mfma_f32_16x16x32_bf16 a[192:195],v[48:51],v[96:99],a[192:195]
v_fmac_f32 v5,v186,v186
v_fmac_f32 v6,v187,v187
v_mfma_f32_16x16x32_bf16 a[196:199],v[52:55],v[96:99],a[196:199]
ds_read_b64_tr_b16 v[94:95],v119 offset:17408
s_waitcnt lgkmcnt(9)
v_mfma_f32_16x16x32_bf16 a[200:203],v[16:19],v[100:103],a[200:203]
buffer_load_dwordx4 v133,s[12:15],s25 offen offset:1024 lds
v_mfma_f32_16x16x32_bf16 a[204:207],v[20:23],v[100:103],a[204:207]
ds_read_b128 v[108:111],v114 offset:14336
v_lshlrev_b32 v184,16,v173
v_mfma_f32_16x16x32_bf16 a[208:211],v[100:103],v[24:27],a[208:211]
s_cmp_lg_u32 s34,1
s_cbranch_scc1 .Lce30
s_cbranch_vccnz .Lcs30
v_smfmac_f32_16x16x64_bf16 v[144:147],v[164:167],v[16:23],v143
v_smfmac_f32_16x16x64_bf16 v[148:151],v[164:167],v[24:31],v143
v_smfmac_f32_16x16x64_bf16 v[152:155],v[164:167],v[32:39],v143
s_branch .Lce30
.Lcs30:
v_smfmac_f32_16x16x64_bf16 v[156:159],v[164:167],v[40:47],v143
v_smfmac_f32_16x16x64_bf16 v[160:163],v[164:167],v[48:55],v143
.Lce30:
v_mfma_f32_16x16x32_bf16 a[212:215],v[100:103],v[28:31],a[212:215]
v_and_b32 v185,s44,v173
v_sub_f32 v184,v184,v7
v_mfma_f32_16x16x32_bf16 a[216:219],v[100:103],v[32:35],a[216:219]
v_sub_f32 v185,v185,v7
v_fmac_f32 v3,v184,v184
v_mfma_f32_16x16x32_bf16 a[220:223],v[100:103],v[36:39],a[220:223]
v_fmac_f32 v4,v185,v185
v_lshlrev_b32 v186,16,v181
v_mfma_f32_16x16x32_bf16 a[224:227],v[40:43],v[100:103],a[224:227]
buffer_load_dwordx4 v134,s[12:15],s25 offen offset:2048 lds
v_mfma_f32_16x16x32_bf16 a[228:231],v[44:47],v[100:103],a[228:231]
v_and_b32 v187,s44,v181
v_sub_f32 v186,v186,v8
v_mfma_f32_16x16x32_bf16 a[232:235],v[48:51],v[100:103],a[232:235]
s_waitcnt vmcnt(16) lgkmcnt(0)
s_barrier
s_cmp_lg_u32 s50,s51
s_cbranch_scc1 L_evBu
v_mov_b32 v10,1
v_mov_b32 v11,0
s_and_b32 s48,s2,7
s_lshl_b32 s48,s48,2
s_mov_b64 exec,1
buffer_store_dword v10,v11,s[20:23],s56 offen sc1
buffer_atomic_add v10,v11,s[52:55],s48 offen sc1
s_mov_b64 exec,-1
L_evBu:
s_cmp_lg_u32 s50,s57
s_cbranch_scc1 L_ezBu
v_mov_b32 v10,1
v_mov_b32 v11,0
s_mov_b64 exec,1
buffer_store_dword v10,v11,s[20:23],s58 offen sc1
s_mov_b64 exec,-1
L_ezBu:
v_mfma_f32_16x16x32_bf16 a[236:239],v[52:55],v[100:103],a[236:239]
v_sub_f32 v187,v187,v8
v_mfma_f32_16x16x32_bf16 a[240:243],v[16:19],v[104:107],a[240:243]
v_fmac_f32 v5,v186,v186
v_fmac_f32 v6,v187,v187
v_mfma_f32_16x16x32_bf16 a[244:247],v[20:23],v[104:107],a[244:247]
ds_read_b128 v[96:99],v115
v_lshlrev_b32 v184,16,v174
v_mfma_f32_16x16x32_bf16 a[248:251],v[104:107],v[24:27],a[248:251]
v_and_b32 v185,s44,v174
v_sub_f32 v184,v184,v7
v_mfma_f32_16x16x32_bf16 a[252:255],v[104:107],v[28:31],a[252:255]
v_sub_f32 v185,v185,v7
v_fmac_f32 v3,v184,v184
v_mfma_f32_16x16x32_bf16 v[192:195],v[104:107],v[32:35],v[192:195]
buffer_load_dwordx4 v135,s[12:15],s25 offen offset:3072 lds
v_mfma_f32_16x16x32_bf16 v[196:199],v[104:107],v[36:39],v[196:199]
v_fmac_f32 v4,v185,v185
v_lshlrev_b32 v186,16,v182
v_mfma_f32_16x16x32_bf16 v[200:203],v[40:43],v[104:107],v[200:203]
s_add_u32 s25,s25,s27
v_and_b32 v187,s44,v182
v_mfma_f32_16x16x32_bf16 v[204:207],v[44:47],v[104:107],v[204:207]
v_sub_f32 v186,v186,v8
v_sub_f32 v187,v187,v8
v_mfma_f32_16x16x32_bf16 v[208:211],v[48:51],v[104:107],v[208:211]
s_add_u32 m0,s30,122880
v_fmac_f32 v5,v186,v186
v_mfma_f32_16x16x32_bf16 v[212:215],v[52:55],v[104:107],v[212:215]
v_fmac_f32 v6,v187,v187
v_mfma_f32_16x16x32_bf16 v[216:219],v[16:19],v[108:111],v[216:219]
v_lshlrev_b32 v184,16,v175
v_and_b32 v185,s44,v175
v_mfma_f32_16x16x32_bf16 v[220:223],v[20:23],v[108:111],v[220:223]
ds_read_b128 v[100:103],v115 offset:2048
v_sub_f32 v184,v184,v7
v_mfma_f32_16x16x32_bf16 v[224:227],v[108:111],v[24:27],v[224:227]
v_sub_f32 v185,v185,v7
v_fmac_f32 v3,v184,v184
v_mfma_f32_16x16x32_bf16 v[228:231],v[108:111],v[28:31],v[228:231]
v_fmac_f32 v4,v185,v185
v_lshlrev_b32 v186,16,v183
v_mfma_f32_16x16x32_bf16 v[232:235],v[108:111],v[32:35],v[232:235]
buffer_load_dwordx4 v136,s[16:19],s26 offen lds
v_mfma_f32_16x16x32_bf16 v[236:239],v[108:111],v[36:39],v[236:239]
v_and_b32 v187,s44,v183
v_sub_f32 v186,v186,v8
v_mfma_f32_16x16x32_bf16 v[240:243],v[40:43],v[108:111],v[240:243]
v_sub_f32 v187,v187,v8
v_fmac_f32 v5,v186,v186
v_mfma_f32_16x16x32_bf16 v[244:247],v[44:47],v[108:111],v[244:247]
v_fmac_f32 v6,v187,v187
v_add_f32 v3,v3,v4
v_mfma_f32_16x16x32_bf16 v[248:251],v[48:51],v[108:111],v[248:251]
s_add_u32 s26,s26,s28
v_add_f32 v5,v5,v6
v_mfma_f32_16x16x32_bf16 v[252:255],v[52:55],v[108:111],v[252:255]
s_mov_b32 s45,0x3727c5ac
s_waitcnt lgkmcnt(1)
v_mfma_f32_16x16x32_bf16 a[0:3],v[56:59],v[96:99],a[0:3]
s_nop 0
v_add_f32_dpp v3,v3,v3 row_shr:1 row_mask:0xf bank_mask:0xf bound_ctrl:1
v_mfma_f32_16x16x32_bf16 a[4:7],v[60:63],v[96:99],a[4:7]
ds_read_b128 v[104:107],v115 offset:4096
v_add_f32_dpp v5,v5,v5 row_shr:1 row_mask:0xf bank_mask:0xf bound_ctrl:1
v_mfma_f32_16x16x32_bf16 a[8:11],v[96:99],v[64:67],a[8:11]
s_nop 0
v_add_f32_dpp v3,v3,v3 row_shr:2 row_mask:0xf bank_mask:0xf bound_ctrl:1
v_mfma_f32_16x16x32_bf16 a[12:15],v[96:99],v[68:71],a[12:15]
ds_read_b64_tr_b16 v[16:17],v116
v_add_f32_dpp v5,v5,v5 row_shr:2 row_mask:0xf bank_mask:0xf bound_ctrl:1
v_mfma_f32_16x16x32_bf16 a[16:19],v[96:99],v[72:75],a[16:19]
s_add_u32 m0,s29,126976
s_nop 0
v_mfma_f32_16x16x32_bf16 a[20:23],v[96:99],v[76:79],a[20:23]
ds_read_b64_tr_b16 v[18:19],v116 offset:1024
v_add_f32_dpp v3,v3,v3 row_shr:4 row_mask:0xf bank_mask:0xf bound_ctrl:1
v_mfma_f32_16x16x32_bf16 a[24:27],v[80:83],v[96:99],a[24:27]
v_add_f32_dpp v5,v5,v5 row_shr:4 row_mask:0xf bank_mask:0xf bound_ctrl:1
s_nop 0
v_mfma_f32_16x16x32_bf16 a[28:31],v[84:87],v[96:99],a[28:31]
ds_read_b64_tr_b16 v[20:21],v117
v_add_f32_dpp v3,v3,v3 row_shr:8 row_mask:0xf bank_mask:0xf bound_ctrl:1
v_mfma_f32_16x16x32_bf16 a[32:35],v[88:91],v[96:99],a[32:35]
buffer_load_dwordx4 v132,s[12:15],s25 offen lds
v_mfma_f32_16x16x32_bf16 a[36:39],v[92:95],v[96:99],a[36:39]
ds_read_b64_tr_b16 v[22:23],v117 offset:1024
s_waitcnt lgkmcnt(5)
v_mfma_f32_16x16x32_bf16 a[40:43],v[56:59],v[100:103],a[40:43]
v_add_f32_dpp v5,v5,v5 row_shr:8 row_mask:0xf bank_mask:0xf bound_ctrl:1
s_nop 0
v_mfma_f32_16x16x32_bf16 a[44:47],v[60:63],v[100:103],a[44:47]
ds_read_b128 v[108:111],v115 offset:6144
v_add_f32_dpp v3,v3,v3 row_bcast:15 row_mask:0xa bank_mask:0xf
v_mfma_f32_16x16x32_bf16 a[48:51],v[100:103],v[64:67],a[48:51]
v_add_f32_dpp v5,v5,v5 row_bcast:15 row_mask:0xa bank_mask:0xf
s_nop 0
v_mfma_f32_16x16x32_bf16 a[52:55],v[100:103],v[68:71],a[52:55]
ds_read_b64_tr_b16 v[24:25],v120 offset:4096
v_add_f32_dpp v3,v3,v3 row_bcast:31 row_mask:0xc bank_mask:0xf
v_mfma_f32_16x16x32_bf16 a[56:59],v[100:103],v[72:75],a[56:59]
v_add_f32_dpp v5,v5,v5 row_bcast:31 row_mask:0xc bank_mask:0xf
s_nop 0
v_mfma_f32_16x16x32_bf16 a[60:63],v[100:103],v[76:79],a[60:63]
ds_read_b64_tr_b16 v[26:27],v120 offset:5120
v_readlane_b32 s46,v3,63
v_mfma_f32_16x16x32_bf16 a[64:67],v[80:83],v[100:103],a[64:67]
v_readlane_b32 s47,v5,63
s_nop 0
v_mfma_f32_16x16x32_bf16 a[68:71],v[84:87],v[100:103],a[68:71]
ds_read_b64_tr_b16 v[28:29],v121 offset:4096
v_mul_f32 v12,s46,v14
v_mfma_f32_16x16x32_bf16 a[72:75],v[88:91],v[100:103],a[72:75]
buffer_load_dwordx4 v133,s[12:15],s25 offen offset:1024 lds
v_mfma_f32_16x16x32_bf16 a[76:79],v[92:95],v[100:103],a[76:79]
ds_read_b64_tr_b16 v[30:31],v121 offset:5120
s_waitcnt lgkmcnt(9)
v_mfma_f32_16x16x32_bf16 a[80:83],v[56:59],v[104:107],a[80:83]
v_mul_f32 v13,s47,v14
v_cvt_pk_bf16_f32 v12,v12,v7
v_mfma_f32_16x16x32_bf16 a[84:87],v[60:63],v[104:107],a[84:87]
ds_read_b128 v[96:99],v115 offset:8192
v_cvt_pk_bf16_f32 v13,v13,v8
v_mfma_f32_16x16x32_bf16 a[88:91],v[104:107],v[64:67],a[88:91]
v_and_b32 v186,s44,v12
v_and_b32 v187,s44,v13
v_mfma_f32_16x16x32_bf16 a[92:95],v[104:107],v[68:71],a[92:95]
ds_read_b64_tr_b16 v[32:33],v122 offset:4096
v_lshlrev_b32 v12,16,v12
v_mfma_f32_16x16x32_bf16 a[96:99],v[104:107],v[72:75],a[96:99]
v_lshlrev_b32 v13,16,v13
v_add_f32 v12,s45,v12
v_mfma_f32_16x16x32_bf16 a[100:103],v[104:107],v[76:79],a[100:103]
ds_read_b64_tr_b16 v[34:35],v122 offset:5120
v_add_f32 v13,s45,v13
v_mfma_f32_16x16x32_bf16 a[104:107],v[80:83],v[104:107],a[104:107]
v_cvt_pk_bf16_f32 v12,v12,v12
v_cvt_pk_bf16_f32 v13,v13,v13
v_mfma_f32_16x16x32_bf16 a[108:111],v[84:87],v[104:107],a[108:111]
ds_read_b64_tr_b16 v[36:37],v123 offset:4096
v_lshlrev_b32 v12,16,v12
v_mfma_f32_16x16x32_bf16 a[112:115],v[88:91],v[104:107],a[112:115]
buffer_load_dwordx4 v134,s[12:15],s25 offen offset:2048 lds
v_mfma_f32_16x16x32_bf16 a[116:119],v[92:95],v[104:107],a[116:119]
ds_read_b64_tr_b16 v[38:39],v123 offset:5120
s_waitcnt lgkmcnt(9)
v_mfma_f32_16x16x32_bf16 a[120:123],v[56:59],v[108:111],a[120:123]
v_lshlrev_b32 v13,16,v13
v_sqrt_f32 v12,v12
v_mfma_f32_16x16x32_bf16 a[124:127],v[60:63],v[108:111],a[124:127]
ds_read_b128 v[100:103],v115 offset:10240
v_sqrt_f32 v13,v13
v_mfma_f32_16x16x32_bf16 a[128:131],v[108:111],v[64:67],a[128:131]
s_nop 0
v_cvt_pk_bf16_f32 v12,v12,v12
v_mfma_f32_16x16x32_bf16 a[132:135],v[108:111],v[68:71],a[132:135]
ds_read_b64_tr_b16 v[40:41],v116 offset:12288
v_cvt_pk_bf16_f32 v13,v13,v13
v_mfma_f32_16x16x32_bf16 a[136:139],v[108:111],v[72:75],a[136:139]
v_lshlrev_b32 v12,16,v12
v_lshlrev_b32 v13,16,v13
v_mfma_f32_16x16x32_bf16 a[140:143],v[108:111],v[76:79],a[140:143]
ds_read_b64_tr_b16 v[42:43],v116 offset:13312
v_rcp_f32 v184,v12
v_mfma_f32_16x16x32_bf16 a[144:147],v[80:83],v[108:111],a[144:147]
v_rcp_f32 v185,v13
v_mul_f32 v190,v12,v12
v_mfma_f32_16x16x32_bf16 a[148:151],v[84:87],v[108:111],a[148:151]
ds_read_b64_tr_b16 v[44:45],v117 offset:12288
v_mul_f32 v191,v13,v13
v_mfma_f32_16x16x32_bf16 a[152:155],v[88:91],v[108:111],a[152:155]
buffer_load_dwordx4 v135,s[12:15],s25 offen offset:3072 lds
v_mfma_f32_16x16x32_bf16 a[156:159],v[92:95],v[108:111],a[156:159]
ds_read_b64_tr_b16 v[46:47],v117 offset:13312
s_waitcnt lgkmcnt(9)
v_mfma_f32_16x16x32_bf16 a[160:163],v[56:59],v[96:99],a[160:163]
s_add_u32 s25,s25,s27
v_xor_b32 v186,0x80000000,v186
v_mfma_f32_16x16x32_bf16 a[164:167],v[60:63],v[96:99],a[164:167]
ds_read_b128 v[104:107],v115 offset:12288
v_xor_b32 v187,0x80000000,v187
v_mfma_f32_16x16x32_bf16 a[168:171],v[96:99],v[64:67],a[168:171]
v_mul_f32 v188,0xbfb8aa3b,v184
v_mul_f32 v189,0xbfb8aa3b,v185
v_mfma_f32_16x16x32_bf16 a[172:175],v[96:99],v[68:71],a[172:175]
ds_read_b64_tr_b16 v[48:49],v116 offset:16384
v_cmp_eq_u32 s[48:49],1,v2
v_mfma_f32_16x16x32_bf16 a[176:179],v[96:99],v[72:75],a[176:179]
s_add_u32 m0,s30,143360
s_nop 1
v_mfma_f32_16x16x32_bf16 a[180:183],v[96:99],v[76:79],a[180:183]
ds_read_b64_tr_b16 v[50:51],v116 offset:17408
v_cndmask_b32 v184,v184,v186,s[48:49]
v_mfma_f32_16x16x32_bf16 a[184:187],v[80:83],v[96:99],a[184:187]
v_cndmask_b32 v185,v185,v187,s[48:49]
v_cmp_eq_u32 s[48:49],2,v2
v_mfma_f32_16x16x32_bf16 a[188:191],v[84:87],v[96:99],a[188:191]
ds_read_b64_tr_b16 v[52:53],v117 offset:16384
s_nop 1
v_mfma_f32_16x16x32_bf16 a[192:195],v[88:91],v[96:99],a[192:195]
buffer_load_dwordx4 v136,s[16:19],s26 offen lds
v_mfma_f32_16x16x32_bf16 a[196:199],v[92:95],v[96:99],a[196:199]
ds_read_b64_tr_b16 v[54:55],v117 offset:17408
s_waitcnt lgkmcnt(9)
v_mfma_f32_16x16x32_bf16 a[200:203],v[56:59],v[100:103],a[200:203]
s_add_u32 s26,s26,s28
v_cndmask_b32 v184,v184,v188,s[48:49]
v_mfma_f32_16x16x32_bf16 a[204:207],v[60:63],v[100:103],a[204:207]
ds_read_b128 v[108:111],v115 offset:14336
v_cndmask_b32 v185,v185,v189,s[48:49]
v_mfma_f32_16x16x32_bf16 a[208:211],v[100:103],v[64:67],a[208:211]
s_cmp_lg_u32 s34,1
s_cbranch_scc1 .Lce31
s_cbranch_vccnz .Lcs31
v_smfmac_f32_16x16x64_bf16 v[144:147],v[164:167],v[56:63],v143
v_smfmac_f32_16x16x64_bf16 v[148:151],v[164:167],v[64:71],v143
v_smfmac_f32_16x16x64_bf16 v[152:155],v[164:167],v[72:79],v143
s_branch .Lce31
.Lcs31:
v_smfmac_f32_16x16x64_bf16 v[156:159],v[164:167],v[80:87],v143
v_smfmac_f32_16x16x64_bf16 v[160:163],v[164:167],v[88:95],v143
.Lce31:
v_mfma_f32_16x16x32_bf16 a[212:215],v[100:103],v[68:71],a[212:215]
v_cmp_eq_u32 s[48:49],3,v2
s_nop 1
v_mfma_f32_16x16x32_bf16 a[216:219],v[100:103],v[72:75],a[216:219]
v_cndmask_b32 v184,v184,v190,s[48:49]
v_cndmask_b32 v185,v185,v191,s[48:49]
v_mfma_f32_16x16x32_bf16 a[220:223],v[100:103],v[76:79],a[220:223]
v_lshlrev_b32 v12,13,v2
v_cmp_gt_u32 s[48:49],4,v2
v_mfma_f32_16x16x32_bf16 a[224:227],v[80:83],v[100:103],a[224:227]
v_mov_b32 v13,0x80000000
s_lshl_b32 s46,s34,10
v_mfma_f32_16x16x32_bf16 a[228:231],v[84:87],v[100:103],a[228:231]
s_lshl_b32 s47,s35,5
s_add_u32 s46,s46,s47
v_mfma_f32_16x16x32_bf16 a[232:235],v[88:91],v[100:103],a[232:235]
s_waitcnt vmcnt(10) lgkmcnt(0)
s_barrier
v_mfma_f32_16x16x32_bf16 a[236:239],v[92:95],v[100:103],a[236:239]
s_add_u32 m0,s33,32768
v_mfma_f32_16x16x32_bf16 a[240:243],v[56:59],v[104:107],a[240:243]
buffer_load_dwordx4 v128,s[8:11],s24 offen lds
v_mfma_f32_16x16x32_bf16 a[244:247],v[60:63],v[104:107],a[244:247]
ds_read_b128 v[96:99],v112
s_lshl_b32 s47,s31,3
v_mfma_f32_16x16x32_bf16 a[248:251],v[104:107],v[64:67],a[248:251]
s_add_u32 s46,s46,s47
s_add_u32 s46,s46,0x2710000
v_mfma_f32_16x16x32_bf16 a[252:255],v[104:107],v[68:71],a[252:255]
v_cndmask_b32 v12,v13,v12,s[48:49]
buffer_store_dwordx2 v[184:185],v12,s[20:23],s46 offen sc1
v_mfma_f32_16x16x32_bf16 v[192:195],v[104:107],v[72:75],v[192:195]
v_mfma_f32_16x16x32_bf16 v[196:199],v[104:107],v[76:79],v[196:199]
v_mfma_f32_16x16x32_bf16 v[200:203],v[80:83],v[104:107],v[200:203]
v_mfma_f32_16x16x32_bf16 v[204:207],v[84:87],v[104:107],v[204:207]
v_mfma_f32_16x16x32_bf16 v[208:211],v[88:91],v[104:107],v[208:211]
buffer_load_dwordx4 v129,s[8:11],s24 offen offset:1024 lds
v_mfma_f32_16x16x32_bf16 v[212:215],v[92:95],v[104:107],v[212:215]
v_mfma_f32_16x16x32_bf16 v[216:219],v[56:59],v[108:111],v[216:219]
v_mfma_f32_16x16x32_bf16 v[220:223],v[60:63],v[108:111],v[220:223]
ds_read_b128 v[100:103],v112 offset:2048
v_mfma_f32_16x16x32_bf16 v[224:227],v[108:111],v[64:67],v[224:227]
v_mfma_f32_16x16x32_bf16 v[228:231],v[108:111],v[68:71],v[228:231]
v_mfma_f32_16x16x32_bf16 v[232:235],v[108:111],v[72:75],v[232:235]
v_mfma_f32_16x16x32_bf16 v[236:239],v[108:111],v[76:79],v[236:239]
v_mfma_f32_16x16x32_bf16 v[240:243],v[80:83],v[108:111],v[240:243]
buffer_load_dwordx4 v130,s[8:11],s24 offen offset:2048 lds
v_mfma_f32_16x16x32_bf16 v[244:247],v[84:87],v[108:111],v[244:247]
v_mfma_f32_16x16x32_bf16 v[248:251],v[88:91],v[108:111],v[248:251]
v_mfma_f32_16x16x32_bf16 v[252:255],v[92:95],v[108:111],v[252:255]
s_min_u32 s59,s34,5
s_cmp_lt_u32 s34,2
s_cselect_b32 s59,5,s59
s_cbranch_scc1 L_pubB
s_mov_b32 s50,2
s_cmp_eq_u32 s34,2
s_cbranch_scc1 L_bxB
.p2align 6
L_loopB:
s_waitcnt lgkmcnt(1)
v_mfma_f32_16x16x32_bf16 a[0:3],v[16:19],v[96:99],a[0:3]
v_mfma_f32_16x16x32_bf16 a[4:7],v[20:23],v[96:99],a[4:7]
ds_read_b128 v[104:107],v112 offset:4096
v_mfma_f32_16x16x32_bf16 a[8:11],v[96:99],v[24:27],a[8:11]
v_mfma_f32_16x16x32_bf16 a[12:15],v[96:99],v[28:31],a[12:15]
ds_read_b64_tr_b16 v[56:57],v116 offset:20480
v_mfma_f32_16x16x32_bf16 a[16:19],v[96:99],v[32:35],a[16:19]
buffer_load_dwordx4 v131,s[8:11],s24 offen offset:3072 lds
v_mfma_f32_16x16x32_bf16 a[20:23],v[96:99],v[36:39],a[20:23]
ds_read_b64_tr_b16 v[58:59],v116 offset:21504
v_mfma_f32_16x16x32_bf16 a[24:27],v[40:43],v[96:99],a[24:27]
v_mfma_f32_16x16x32_bf16 a[28:31],v[44:47],v[96:99],a[28:31]
ds_read_b64_tr_b16 v[60:61],v117 offset:20480
v_mfma_f32_16x16x32_bf16 a[32:35],v[48:51],v[96:99],a[32:35]
s_add_u32 m0,s33,36864
v_mfma_f32_16x16x32_bf16 a[36:39],v[52:55],v[96:99],a[36:39]
ds_read_b64_tr_b16 v[62:63],v117 offset:21504
s_waitcnt lgkmcnt(5)
v_mfma_f32_16x16x32_bf16 a[40:43],v[16:19],v[100:103],a[40:43]
v_mfma_f32_16x16x32_bf16 a[44:47],v[20:23],v[100:103],a[44:47]
ds_read_b128 v[108:111],v112 offset:6144
v_mfma_f32_16x16x32_bf16 a[48:51],v[100:103],v[24:27],a[48:51]
v_mfma_f32_16x16x32_bf16 a[52:55],v[100:103],v[28:31],a[52:55]
ds_read_b64_tr_b16 v[64:65],v120 offset:24576
v_mfma_f32_16x16x32_bf16 a[56:59],v[100:103],v[32:35],a[56:59]
buffer_load_dwordx4 v128,s[8:11],s32 offen lds
v_mfma_f32_16x16x32_bf16 a[60:63],v[100:103],v[36:39],a[60:63]
ds_read_b64_tr_b16 v[66:67],v120 offset:25600
v_mfma_f32_16x16x32_bf16 a[64:67],v[40:43],v[100:103],a[64:67]
v_mfma_f32_16x16x32_bf16 a[68:71],v[44:47],v[100:103],a[68:71]
ds_read_b64_tr_b16 v[68:69],v121 offset:24576
v_mfma_f32_16x16x32_bf16 a[72:75],v[48:51],v[100:103],a[72:75]
v_mfma_f32_16x16x32_bf16 a[76:79],v[52:55],v[100:103],a[76:79]
ds_read_b64_tr_b16 v[70:71],v121 offset:25600
s_waitcnt lgkmcnt(9)
v_mfma_f32_16x16x32_bf16 a[80:83],v[16:19],v[104:107],a[80:83]
buffer_load_dwordx4 v129,s[8:11],s32 offen offset:1024 lds
v_mfma_f32_16x16x32_bf16 a[84:87],v[20:23],v[104:107],a[84:87]
ds_read_b128 v[96:99],v112 offset:8192
v_mfma_f32_16x16x32_bf16 a[88:91],v[104:107],v[24:27],a[88:91]
v_mfma_f32_16x16x32_bf16 a[92:95],v[104:107],v[28:31],a[92:95]
ds_read_b64_tr_b16 v[72:73],v122 offset:24576
v_mfma_f32_16x16x32_bf16 a[96:99],v[104:107],v[32:35],a[96:99]
v_mfma_f32_16x16x32_bf16 a[100:103],v[104:107],v[36:39],a[100:103]
ds_read_b64_tr_b16 v[74:75],v122 offset:25600
v_mfma_f32_16x16x32_bf16 a[104:107],v[40:43],v[104:107],a[104:107]
v_mfma_f32_16x16x32_bf16 a[108:111],v[44:47],v[104:107],a[108:111]
ds_read_b64_tr_b16 v[76:77],v123 offset:24576
v_mfma_f32_16x16x32_bf16 a[112:115],v[48:51],v[104:107],a[112:115]
buffer_load_dwordx4 v130,s[8:11],s32 offen offset:2048 lds
v_mfma_f32_16x16x32_bf16 a[116:119],v[52:55],v[104:107],a[116:119]
ds_read_b64_tr_b16 v[78:79],v123 offset:25600
s_waitcnt lgkmcnt(9)
v_mfma_f32_16x16x32_bf16 a[120:123],v[16:19],v[108:111],a[120:123]
v_mfma_f32_16x16x32_bf16 a[124:127],v[20:23],v[108:111],a[124:127]
ds_read_b128 v[100:103],v112 offset:10240
v_mfma_f32_16x16x32_bf16 a[128:131],v[108:111],v[24:27],a[128:131]
v_mfma_f32_16x16x32_bf16 a[132:135],v[108:111],v[28:31],a[132:135]
ds_read_b64_tr_b16 v[80:81],v116 offset:32768
v_mfma_f32_16x16x32_bf16 a[136:139],v[108:111],v[32:35],a[136:139]
buffer_load_dwordx4 v131,s[8:11],s32 offen offset:3072 lds
v_mfma_f32_16x16x32_bf16 a[140:143],v[108:111],v[36:39],a[140:143]
ds_read_b64_tr_b16 v[82:83],v116 offset:33792
v_mfma_f32_16x16x32_bf16 a[144:147],v[40:43],v[108:111],a[144:147]
v_mfma_f32_16x16x32_bf16 a[148:151],v[44:47],v[108:111],a[148:151]
ds_read_b64_tr_b16 v[84:85],v117 offset:32768
v_mfma_f32_16x16x32_bf16 a[152:155],v[48:51],v[108:111],a[152:155]
s_add_u32 s24,s24,128
v_mfma_f32_16x16x32_bf16 a[156:159],v[52:55],v[108:111],a[156:159]
ds_read_b64_tr_b16 v[86:87],v117 offset:33792
s_waitcnt lgkmcnt(9)
v_mfma_f32_16x16x32_bf16 a[160:163],v[16:19],v[96:99],a[160:163]
s_add_u32 s32,s32,128
v_mfma_f32_16x16x32_bf16 a[164:167],v[20:23],v[96:99],a[164:167]
ds_read_b128 v[104:107],v112 offset:12288
v_mfma_f32_16x16x32_bf16 a[168:171],v[96:99],v[24:27],a[168:171]
s_add_u32 m0,s29,65536
v_mfma_f32_16x16x32_bf16 a[172:175],v[96:99],v[28:31],a[172:175]
ds_read_b64_tr_b16 v[88:89],v116 offset:36864
v_mfma_f32_16x16x32_bf16 a[176:179],v[96:99],v[32:35],a[176:179]
buffer_load_dwordx4 v132,s[12:15],s25 offen lds
v_mfma_f32_16x16x32_bf16 a[180:183],v[96:99],v[36:39],a[180:183]
ds_read_b64_tr_b16 v[90:91],v116 offset:37888
v_mfma_f32_16x16x32_bf16 a[184:187],v[40:43],v[96:99],a[184:187]
v_mfma_f32_16x16x32_bf16 a[188:191],v[44:47],v[96:99],a[188:191]
ds_read_b64_tr_b16 v[92:93],v117 offset:36864
v_mfma_f32_16x16x32_bf16 a[192:195],v[48:51],v[96:99],a[192:195]
v_mfma_f32_16x16x32_bf16 a[196:199],v[52:55],v[96:99],a[196:199]
ds_read_b64_tr_b16 v[94:95],v117 offset:37888
s_waitcnt lgkmcnt(9)
v_mfma_f32_16x16x32_bf16 a[200:203],v[16:19],v[100:103],a[200:203]
buffer_load_dwordx4 v133,s[12:15],s25 offen offset:1024 lds
v_mfma_f32_16x16x32_bf16 a[204:207],v[20:23],v[100:103],a[204:207]
ds_read_b128 v[108:111],v112 offset:14336
v_mfma_f32_16x16x32_bf16 a[208:211],v[100:103],v[24:27],a[208:211]
v_mfma_f32_16x16x32_bf16 a[212:215],v[100:103],v[28:31],a[212:215]
v_mfma_f32_16x16x32_bf16 a[216:219],v[100:103],v[32:35],a[216:219]
v_mfma_f32_16x16x32_bf16 a[220:223],v[100:103],v[36:39],a[220:223]
v_mfma_f32_16x16x32_bf16 a[224:227],v[40:43],v[100:103],a[224:227]
buffer_load_dwordx4 v134,s[12:15],s25 offen offset:2048 lds
v_mfma_f32_16x16x32_bf16 a[228:231],v[44:47],v[100:103],a[228:231]
v_mfma_f32_16x16x32_bf16 a[232:235],v[48:51],v[100:103],a[232:235]
s_waitcnt vmcnt(16) lgkmcnt(0)
s_barrier
v_mfma_f32_16x16x32_bf16 a[236:239],v[52:55],v[100:103],a[236:239]
v_mfma_f32_16x16x32_bf16 a[240:243],v[16:19],v[104:107],a[240:243]
v_mfma_f32_16x16x32_bf16 a[244:247],v[20:23],v[104:107],a[244:247]
ds_read_b128 v[96:99],v113
v_mfma_f32_16x16x32_bf16 a[248:251],v[104:107],v[24:27],a[248:251]
v_mfma_f32_16x16x32_bf16 a[252:255],v[104:107],v[28:31],a[252:255]
v_mfma_f32_16x16x32_bf16 v[192:195],v[104:107],v[32:35],v[192:195]
buffer_load_dwordx4 v135,s[12:15],s25 offen offset:3072 lds
v_mfma_f32_16x16x32_bf16 v[196:199],v[104:107],v[36:39],v[196:199]
v_mfma_f32_16x16x32_bf16 v[200:203],v[40:43],v[104:107],v[200:203]
s_add_u32 s25,s25,s27
v_mfma_f32_16x16x32_bf16 v[204:207],v[44:47],v[104:107],v[204:207]
v_mfma_f32_16x16x32_bf16 v[208:211],v[48:51],v[104:107],v[208:211]
s_add_u32 m0,s30,81920
v_mfma_f32_16x16x32_bf16 v[212:215],v[52:55],v[104:107],v[212:215]
v_mfma_f32_16x16x32_bf16 v[216:219],v[16:19],v[108:111],v[216:219]
v_mfma_f32_16x16x32_bf16 v[220:223],v[20:23],v[108:111],v[220:223]
ds_read_b128 v[100:103],v113 offset:2048
v_mfma_f32_16x16x32_bf16 v[224:227],v[108:111],v[24:27],v[224:227]
v_mfma_f32_16x16x32_bf16 v[228:231],v[108:111],v[28:31],v[228:231]
v_mfma_f32_16x16x32_bf16 v[232:235],v[108:111],v[32:35],v[232:235]
buffer_load_dwordx4 v136,s[16:19],s26 offen lds
v_mfma_f32_16x16x32_bf16 v[236:239],v[108:111],v[36:39],v[236:239]
v_mfma_f32_16x16x32_bf16 v[240:243],v[40:43],v[108:111],v[240:243]
v_mfma_f32_16x16x32_bf16 v[244:247],v[44:47],v[108:111],v[244:247]
v_mfma_f32_16x16x32_bf16 v[248:251],v[48:51],v[108:111],v[248:251]
s_add_u32 s26,s26,s28
v_mfma_f32_16x16x32_bf16 v[252:255],v[52:55],v[108:111],v[252:255]
s_waitcnt lgkmcnt(1)
v_mfma_f32_16x16x32_bf16 a[0:3],v[56:59],v[96:99],a[0:3]
v_mfma_f32_16x16x32_bf16 a[4:7],v[60:63],v[96:99],a[4:7]
ds_read_b128 v[104:107],v113 offset:4096
v_mfma_f32_16x16x32_bf16 a[8:11],v[96:99],v[64:67],a[8:11]
v_mfma_f32_16x16x32_bf16 a[12:15],v[96:99],v[68:71],a[12:15]
ds_read_b64_tr_b16 v[16:17],v116 offset:40960
v_mfma_f32_16x16x32_bf16 a[16:19],v[96:99],v[72:75],a[16:19]
s_add_u32 m0,s29,86016
v_mfma_f32_16x16x32_bf16 a[20:23],v[96:99],v[76:79],a[20:23]
ds_read_b64_tr_b16 v[18:19],v116 offset:41984
v_mfma_f32_16x16x32_bf16 a[24:27],v[80:83],v[96:99],a[24:27]
v_mfma_f32_16x16x32_bf16 a[28:31],v[84:87],v[96:99],a[28:31]
ds_read_b64_tr_b16 v[20:21],v117 offset:40960
v_mfma_f32_16x16x32_bf16 a[32:35],v[88:91],v[96:99],a[32:35]
buffer_load_dwordx4 v132,s[12:15],s25 offen lds
v_mfma_f32_16x16x32_bf16 a[36:39],v[92:95],v[96:99],a[36:39]
ds_read_b64_tr_b16 v[22:23],v117 offset:41984
s_waitcnt lgkmcnt(5)
v_mfma_f32_16x16x32_bf16 a[40:43],v[56:59],v[100:103],a[40:43]
v_mfma_f32_16x16x32_bf16 a[44:47],v[60:63],v[100:103],a[44:47]
ds_read_b128 v[108:111],v113 offset:6144
v_mfma_f32_16x16x32_bf16 a[48:51],v[100:103],v[64:67],a[48:51]
v_mfma_f32_16x16x32_bf16 a[52:55],v[100:103],v[68:71],a[52:55]
ds_read_b64_tr_b16 v[24:25],v120 offset:45056
v_mfma_f32_16x16x32_bf16 a[56:59],v[100:103],v[72:75],a[56:59]
v_mfma_f32_16x16x32_bf16 a[60:63],v[100:103],v[76:79],a[60:63]
ds_read_b64_tr_b16 v[26:27],v120 offset:46080
v_mfma_f32_16x16x32_bf16 a[64:67],v[80:83],v[100:103],a[64:67]
v_mfma_f32_16x16x32_bf16 a[68:71],v[84:87],v[100:103],a[68:71]
ds_read_b64_tr_b16 v[28:29],v121 offset:45056
v_mfma_f32_16x16x32_bf16 a[72:75],v[88:91],v[100:103],a[72:75]
buffer_load_dwordx4 v133,s[12:15],s25 offen offset:1024 lds
v_mfma_f32_16x16x32_bf16 a[76:79],v[92:95],v[100:103],a[76:79]
ds_read_b64_tr_b16 v[30:31],v121 offset:46080
s_waitcnt lgkmcnt(9)
v_mfma_f32_16x16x32_bf16 a[80:83],v[56:59],v[104:107],a[80:83]
v_mfma_f32_16x16x32_bf16 a[84:87],v[60:63],v[104:107],a[84:87]
ds_read_b128 v[96:99],v113 offset:8192
v_mfma_f32_16x16x32_bf16 a[88:91],v[104:107],v[64:67],a[88:91]
v_mfma_f32_16x16x32_bf16 a[92:95],v[104:107],v[68:71],a[92:95]
ds_read_b64_tr_b16 v[32:33],v122 offset:45056
v_mfma_f32_16x16x32_bf16 a[96:99],v[104:107],v[72:75],a[96:99]
v_mfma_f32_16x16x32_bf16 a[100:103],v[104:107],v[76:79],a[100:103]
ds_read_b64_tr_b16 v[34:35],v122 offset:46080
v_mfma_f32_16x16x32_bf16 a[104:107],v[80:83],v[104:107],a[104:107]
v_mfma_f32_16x16x32_bf16 a[108:111],v[84:87],v[104:107],a[108:111]
ds_read_b64_tr_b16 v[36:37],v123 offset:45056
v_mfma_f32_16x16x32_bf16 a[112:115],v[88:91],v[104:107],a[112:115]
buffer_load_dwordx4 v134,s[12:15],s25 offen offset:2048 lds
v_mfma_f32_16x16x32_bf16 a[116:119],v[92:95],v[104:107],a[116:119]
ds_read_b64_tr_b16 v[38:39],v123 offset:46080
s_waitcnt lgkmcnt(9)
v_mfma_f32_16x16x32_bf16 a[120:123],v[56:59],v[108:111],a[120:123]
v_mfma_f32_16x16x32_bf16 a[124:127],v[60:63],v[108:111],a[124:127]
ds_read_b128 v[100:103],v113 offset:10240
v_mfma_f32_16x16x32_bf16 a[128:131],v[108:111],v[64:67],a[128:131]
v_mfma_f32_16x16x32_bf16 a[132:135],v[108:111],v[68:71],a[132:135]
ds_read_b64_tr_b16 v[40:41],v116 offset:53248
v_mfma_f32_16x16x32_bf16 a[136:139],v[108:111],v[72:75],a[136:139]
v_mfma_f32_16x16x32_bf16 a[140:143],v[108:111],v[76:79],a[140:143]
ds_read_b64_tr_b16 v[42:43],v116 offset:54272
v_mfma_f32_16x16x32_bf16 a[144:147],v[80:83],v[108:111],a[144:147]
v_mfma_f32_16x16x32_bf16 a[148:151],v[84:87],v[108:111],a[148:151]
ds_read_b64_tr_b16 v[44:45],v117 offset:53248
v_mfma_f32_16x16x32_bf16 a[152:155],v[88:91],v[108:111],a[152:155]
buffer_load_dwordx4 v135,s[12:15],s25 offen offset:3072 lds
v_mfma_f32_16x16x32_bf16 a[156:159],v[92:95],v[108:111],a[156:159]
ds_read_b64_tr_b16 v[46:47],v117 offset:54272
s_waitcnt lgkmcnt(9)
v_mfma_f32_16x16x32_bf16 a[160:163],v[56:59],v[96:99],a[160:163]
s_add_u32 s25,s25,s27
v_mfma_f32_16x16x32_bf16 a[164:167],v[60:63],v[96:99],a[164:167]
ds_read_b128 v[104:107],v113 offset:12288
v_mfma_f32_16x16x32_bf16 a[168:171],v[96:99],v[64:67],a[168:171]
v_mfma_f32_16x16x32_bf16 a[172:175],v[96:99],v[68:71],a[172:175]
ds_read_b64_tr_b16 v[48:49],v116 offset:57344
v_mfma_f32_16x16x32_bf16 a[176:179],v[96:99],v[72:75],a[176:179]
s_add_u32 m0,s30,102400
v_mfma_f32_16x16x32_bf16 a[180:183],v[96:99],v[76:79],a[180:183]
ds_read_b64_tr_b16 v[50:51],v116 offset:58368
v_mfma_f32_16x16x32_bf16 a[184:187],v[80:83],v[96:99],a[184:187]
v_mfma_f32_16x16x32_bf16 a[188:191],v[84:87],v[96:99],a[188:191]
ds_read_b64_tr_b16 v[52:53],v117 offset:57344
v_mfma_f32_16x16x32_bf16 a[192:195],v[88:91],v[96:99],a[192:195]
buffer_load_dwordx4 v136,s[16:19],s26 offen lds
v_mfma_f32_16x16x32_bf16 a[196:199],v[92:95],v[96:99],a[196:199]
ds_read_b64_tr_b16 v[54:55],v117 offset:58368
s_waitcnt lgkmcnt(9)
v_mfma_f32_16x16x32_bf16 a[200:203],v[56:59],v[100:103],a[200:203]
s_add_u32 s26,s26,s28
v_mfma_f32_16x16x32_bf16 a[204:207],v[60:63],v[100:103],a[204:207]
ds_read_b128 v[108:111],v113 offset:14336
v_mfma_f32_16x16x32_bf16 a[208:211],v[100:103],v[64:67],a[208:211]
v_mfma_f32_16x16x32_bf16 a[212:215],v[100:103],v[68:71],a[212:215]
v_mfma_f32_16x16x32_bf16 a[216:219],v[100:103],v[72:75],a[216:219]
v_mfma_f32_16x16x32_bf16 a[220:223],v[100:103],v[76:79],a[220:223]
v_mfma_f32_16x16x32_bf16 a[224:227],v[80:83],v[100:103],a[224:227]
v_mfma_f32_16x16x32_bf16 a[228:231],v[84:87],v[100:103],a[228:231]
v_mfma_f32_16x16x32_bf16 a[232:235],v[88:91],v[100:103],a[232:235]
s_waitcnt vmcnt(10) lgkmcnt(0)
s_barrier
v_mfma_f32_16x16x32_bf16 a[236:239],v[92:95],v[100:103],a[236:239]
s_add_u32 m0,s33,0
v_mfma_f32_16x16x32_bf16 a[240:243],v[56:59],v[104:107],a[240:243]
buffer_load_dwordx4 v128,s[8:11],s24 offen lds
v_mfma_f32_16x16x32_bf16 a[244:247],v[60:63],v[104:107],a[244:247]
ds_read_b128 v[96:99],v114
v_mfma_f32_16x16x32_bf16 a[248:251],v[104:107],v[64:67],a[248:251]
buffer_load_dword v139,v137,s[64:67],s72 offen
v_mfma_f32_16x16x32_bf16 a[252:255],v[104:107],v[68:71],a[252:255]
v_mfma_f32_16x16x32_bf16 v[192:195],v[104:107],v[72:75],v[192:195]
v_mfma_f32_16x16x32_bf16 v[196:199],v[104:107],v[76:79],v[196:199]
v_mfma_f32_16x16x32_bf16 v[200:203],v[80:83],v[104:107],v[200:203]
v_mfma_f32_16x16x32_bf16 v[204:207],v[84:87],v[104:107],v[204:207]
v_mfma_f32_16x16x32_bf16 v[208:211],v[88:91],v[104:107],v[208:211]
buffer_load_dwordx4 v129,s[8:11],s24 offen offset:1024 lds
v_mfma_f32_16x16x32_bf16 v[212:215],v[92:95],v[104:107],v[212:215]
v_mfma_f32_16x16x32_bf16 v[216:219],v[56:59],v[108:111],v[216:219]
v_mfma_f32_16x16x32_bf16 v[220:223],v[60:63],v[108:111],v[220:223]
ds_read_b128 v[100:103],v114 offset:2048
v_mfma_f32_16x16x32_bf16 v[224:227],v[108:111],v[64:67],v[224:227]
s_add_u32 s72,s72,1835008
v_mfma_f32_16x16x32_bf16 v[228:231],v[108:111],v[68:71],v[228:231]
v_mfma_f32_16x16x32_bf16 v[232:235],v[108:111],v[72:75],v[232:235]
v_mfma_f32_16x16x32_bf16 v[236:239],v[108:111],v[76:79],v[236:239]
v_mfma_f32_16x16x32_bf16 v[240:243],v[80:83],v[108:111],v[240:243]
buffer_load_dwordx4 v130,s[8:11],s24 offen offset:2048 lds
v_mfma_f32_16x16x32_bf16 v[244:247],v[84:87],v[108:111],v[244:247]
v_mfma_f32_16x16x32_bf16 v[248:251],v[88:91],v[108:111],v[248:251]
v_mfma_f32_16x16x32_bf16 v[252:255],v[92:95],v[108:111],v[252:255]
s_waitcnt lgkmcnt(1)
v_mfma_f32_16x16x32_bf16 a[0:3],v[16:19],v[96:99],a[0:3]
v_mfma_f32_16x16x32_bf16 a[4:7],v[20:23],v[96:99],a[4:7]
ds_read_b128 v[104:107],v114 offset:4096
v_mfma_f32_16x16x32_bf16 a[8:11],v[96:99],v[24:27],a[8:11]
v_mfma_f32_16x16x32_bf16 a[12:15],v[96:99],v[28:31],a[12:15]
ds_read_b64_tr_b16 v[56:57],v118
v_mfma_f32_16x16x32_bf16 a[16:19],v[96:99],v[32:35],a[16:19]
buffer_load_dwordx4 v131,s[8:11],s24 offen offset:3072 lds
v_mfma_f32_16x16x32_bf16 a[20:23],v[96:99],v[36:39],a[20:23]
ds_read_b64_tr_b16 v[58:59],v118 offset:1024
v_mfma_f32_16x16x32_bf16 a[24:27],v[40:43],v[96:99],a[24:27]
v_mfma_f32_16x16x32_bf16 a[28:31],v[44:47],v[96:99],a[28:31]
ds_read_b64_tr_b16 v[60:61],v119
v_mfma_f32_16x16x32_bf16 a[32:35],v[48:51],v[96:99],a[32:35]
s_add_u32 m0,s33,4096
v_mfma_f32_16x16x32_bf16 a[36:39],v[52:55],v[96:99],a[36:39]
ds_read_b64_tr_b16 v[62:63],v119 offset:1024
s_waitcnt lgkmcnt(5)
v_mfma_f32_16x16x32_bf16 a[40:43],v[16:19],v[100:103],a[40:43]
v_mfma_f32_16x16x32_bf16 a[44:47],v[20:23],v[100:103],a[44:47]
ds_read_b128 v[108:111],v114 offset:6144
v_mfma_f32_16x16x32_bf16 a[48:51],v[100:103],v[24:27],a[48:51]
v_mfma_f32_16x16x32_bf16 a[52:55],v[100:103],v[28:31],a[52:55]
ds_read_b64_tr_b16 v[64:65],v124 offset:4096
v_mfma_f32_16x16x32_bf16 a[56:59],v[100:103],v[32:35],a[56:59]
buffer_load_dwordx4 v128,s[8:11],s32 offen lds
v_mfma_f32_16x16x32_bf16 a[60:63],v[100:103],v[36:39],a[60:63]
ds_read_b64_tr_b16 v[66:67],v124 offset:5120
v_mfma_f32_16x16x32_bf16 a[64:67],v[40:43],v[100:103],a[64:67]
v_mfma_f32_16x16x32_bf16 a[68:71],v[44:47],v[100:103],a[68:71]
ds_read_b64_tr_b16 v[68:69],v125 offset:4096
v_mfma_f32_16x16x32_bf16 a[72:75],v[48:51],v[100:103],a[72:75]
v_mfma_f32_16x16x32_bf16 a[76:79],v[52:55],v[100:103],a[76:79]
ds_read_b64_tr_b16 v[70:71],v125 offset:5120
s_waitcnt lgkmcnt(9)
v_mfma_f32_16x16x32_bf16 a[80:83],v[16:19],v[104:107],a[80:83]
buffer_load_dwordx4 v129,s[8:11],s32 offen offset:1024 lds
v_mfma_f32_16x16x32_bf16 a[84:87],v[20:23],v[104:107],a[84:87]
ds_read_b128 v[96:99],v114 offset:8192
v_mfma_f32_16x16x32_bf16 a[88:91],v[104:107],v[24:27],a[88:91]
v_mfma_f32_16x16x32_bf16 a[92:95],v[104:107],v[28:31],a[92:95]
ds_read_b64_tr_b16 v[72:73],v126 offset:4096
v_mfma_f32_16x16x32_bf16 a[96:99],v[104:107],v[32:35],a[96:99]
v_mfma_f32_16x16x32_bf16 a[100:103],v[104:107],v[36:39],a[100:103]
ds_read_b64_tr_b16 v[74:75],v126 offset:5120
v_mfma_f32_16x16x32_bf16 a[104:107],v[40:43],v[104:107],a[104:107]
v_mfma_f32_16x16x32_bf16 a[108:111],v[44:47],v[104:107],a[108:111]
ds_read_b64_tr_b16 v[76:77],v127 offset:4096
v_mfma_f32_16x16x32_bf16 a[112:115],v[48:51],v[104:107],a[112:115]
buffer_load_dwordx4 v130,s[8:11],s32 offen offset:2048 lds
v_mfma_f32_16x16x32_bf16 a[116:119],v[52:55],v[104:107],a[116:119]
ds_read_b64_tr_b16 v[78:79],v127 offset:5120
s_waitcnt lgkmcnt(9)
v_mfma_f32_16x16x32_bf16 a[120:123],v[16:19],v[108:111],a[120:123]
v_mfma_f32_16x16x32_bf16 a[124:127],v[20:23],v[108:111],a[124:127]
ds_read_b128 v[100:103],v114 offset:10240
v_mfma_f32_16x16x32_bf16 a[128:131],v[108:111],v[24:27],a[128:131]
v_mfma_f32_16x16x32_bf16 a[132:135],v[108:111],v[28:31],a[132:135]
ds_read_b64_tr_b16 v[80:81],v118 offset:12288
v_mfma_f32_16x16x32_bf16 a[136:139],v[108:111],v[32:35],a[136:139]
buffer_load_dwordx4 v131,s[8:11],s32 offen offset:3072 lds
v_mfma_f32_16x16x32_bf16 a[140:143],v[108:111],v[36:39],a[140:143]
ds_read_b64_tr_b16 v[82:83],v118 offset:13312
v_mfma_f32_16x16x32_bf16 a[144:147],v[40:43],v[108:111],a[144:147]
v_mfma_f32_16x16x32_bf16 a[148:151],v[44:47],v[108:111],a[148:151]
ds_read_b64_tr_b16 v[84:85],v119 offset:12288
v_mfma_f32_16x16x32_bf16 a[152:155],v[48:51],v[108:111],a[152:155]
s_add_u32 s24,s24,128
v_mfma_f32_16x16x32_bf16 a[156:159],v[52:55],v[108:111],a[156:159]
ds_read_b64_tr_b16 v[86:87],v119 offset:13312
s_waitcnt lgkmcnt(9)
v_mfma_f32_16x16x32_bf16 a[160:163],v[16:19],v[96:99],a[160:163]
s_add_u32 s32,s32,128
v_mfma_f32_16x16x32_bf16 a[164:167],v[20:23],v[96:99],a[164:167]
ds_read_b128 v[104:107],v114 offset:12288
v_mfma_f32_16x16x32_bf16 a[168:171],v[96:99],v[24:27],a[168:171]
s_add_u32 m0,s29,106496
v_mfma_f32_16x16x32_bf16 a[172:175],v[96:99],v[28:31],a[172:175]
ds_read_b64_tr_b16 v[88:89],v118 offset:16384
v_mfma_f32_16x16x32_bf16 a[176:179],v[96:99],v[32:35],a[176:179]
buffer_load_dwordx4 v132,s[12:15],s25 offen lds
v_mfma_f32_16x16x32_bf16 a[180:183],v[96:99],v[36:39],a[180:183]
ds_read_b64_tr_b16 v[90:91],v118 offset:17408
v_mfma_f32_16x16x32_bf16 a[184:187],v[40:43],v[96:99],a[184:187]
v_mfma_f32_16x16x32_bf16 a[188:191],v[44:47],v[96:99],a[188:191]
ds_read_b64_tr_b16 v[92:93],v119 offset:16384
v_mfma_f32_16x16x32_bf16 a[192:195],v[48:51],v[96:99],a[192:195]
v_mfma_f32_16x16x32_bf16 a[196:199],v[52:55],v[96:99],a[196:199]
ds_read_b64_tr_b16 v[94:95],v119 offset:17408
s_waitcnt lgkmcnt(9)
v_mfma_f32_16x16x32_bf16 a[200:203],v[16:19],v[100:103],a[200:203]
buffer_load_dwordx4 v133,s[12:15],s25 offen offset:1024 lds
v_mfma_f32_16x16x32_bf16 a[204:207],v[20:23],v[100:103],a[204:207]
ds_read_b128 v[108:111],v114 offset:14336
v_mfma_f32_16x16x32_bf16 a[208:211],v[100:103],v[24:27],a[208:211]
v_mfma_f32_16x16x32_bf16 a[212:215],v[100:103],v[28:31],a[212:215]
v_mfma_f32_16x16x32_bf16 a[216:219],v[100:103],v[32:35],a[216:219]
v_mfma_f32_16x16x32_bf16 a[220:223],v[100:103],v[36:39],a[220:223]
v_mfma_f32_16x16x32_bf16 a[224:227],v[40:43],v[100:103],a[224:227]
buffer_load_dwordx4 v134,s[12:15],s25 offen offset:2048 lds
v_mfma_f32_16x16x32_bf16 a[228:231],v[44:47],v[100:103],a[228:231]
v_mfma_f32_16x16x32_bf16 a[232:235],v[48:51],v[100:103],a[232:235]
s_waitcnt vmcnt(16) lgkmcnt(0)
s_barrier
s_cmp_lg_u32 s50,s51
s_cbranch_scc1 L_evB0
v_mov_b32 v10,1
v_mov_b32 v11,0
s_and_b32 s48,s2,7
s_lshl_b32 s48,s48,2
s_mov_b64 exec,1
buffer_store_dword v10,v11,s[20:23],s56 offen sc1
buffer_atomic_add v10,v11,s[52:55],s48 offen sc1
s_mov_b64 exec,-1
L_evB0:
s_cmp_lg_u32 s50,s57
s_cbranch_scc1 L_ezB0
v_mov_b32 v10,1
v_mov_b32 v11,0
s_mov_b64 exec,1
buffer_store_dword v10,v11,s[20:23],s58 offen sc1
s_mov_b64 exec,-1
L_ezB0:
v_mfma_f32_16x16x32_bf16 a[236:239],v[52:55],v[100:103],a[236:239]
v_mfma_f32_16x16x32_bf16 a[240:243],v[16:19],v[104:107],a[240:243]
v_mfma_f32_16x16x32_bf16 a[244:247],v[20:23],v[104:107],a[244:247]
ds_read_b128 v[96:99],v115
v_mfma_f32_16x16x32_bf16 a[248:251],v[104:107],v[24:27],a[248:251]
v_mfma_f32_16x16x32_bf16 a[252:255],v[104:107],v[28:31],a[252:255]
v_mfma_f32_16x16x32_bf16 v[192:195],v[104:107],v[32:35],v[192:195]
buffer_load_dwordx4 v135,s[12:15],s25 offen offset:3072 lds
v_mfma_f32_16x16x32_bf16 v[196:199],v[104:107],v[36:39],v[196:199]
v_mfma_f32_16x16x32_bf16 v[200:203],v[40:43],v[104:107],v[200:203]
s_add_u32 s25,s25,s27
v_mfma_f32_16x16x32_bf16 v[204:207],v[44:47],v[104:107],v[204:207]
v_mfma_f32_16x16x32_bf16 v[208:211],v[48:51],v[104:107],v[208:211]
s_add_u32 m0,s30,122880
v_mfma_f32_16x16x32_bf16 v[212:215],v[52:55],v[104:107],v[212:215]
v_mfma_f32_16x16x32_bf16 v[216:219],v[16:19],v[108:111],v[216:219]
v_mfma_f32_16x16x32_bf16 v[220:223],v[20:23],v[108:111],v[220:223]
ds_read_b128 v[100:103],v115 offset:2048
v_mfma_f32_16x16x32_bf16 v[224:227],v[108:111],v[24:27],v[224:227]
v_mfma_f32_16x16x32_bf16 v[228:231],v[108:111],v[28:31],v[228:231]
v_mfma_f32_16x16x32_bf16 v[232:235],v[108:111],v[32:35],v[232:235]
buffer_load_dwordx4 v136,s[16:19],s26 offen lds
v_mfma_f32_16x16x32_bf16 v[236:239],v[108:111],v[36:39],v[236:239]
v_mfma_f32_16x16x32_bf16 v[240:243],v[40:43],v[108:111],v[240:243]
v_mfma_f32_16x16x32_bf16 v[244:247],v[44:47],v[108:111],v[244:247]
v_mfma_f32_16x16x32_bf16 v[248:251],v[48:51],v[108:111],v[248:251]
s_add_u32 s26,s26,s28
v_mfma_f32_16x16x32_bf16 v[252:255],v[52:55],v[108:111],v[252:255]
s_waitcnt lgkmcnt(1)
v_mfma_f32_16x16x32_bf16 a[0:3],v[56:59],v[96:99],a[0:3]
v_mfma_f32_16x16x32_bf16 a[4:7],v[60:63],v[96:99],a[4:7]
ds_read_b128 v[104:107],v115 offset:4096
v_mfma_f32_16x16x32_bf16 a[8:11],v[96:99],v[64:67],a[8:11]
v_mfma_f32_16x16x32_bf16 a[12:15],v[96:99],v[68:71],a[12:15]
ds_read_b64_tr_b16 v[16:17],v116
v_mfma_f32_16x16x32_bf16 a[16:19],v[96:99],v[72:75],a[16:19]
s_add_u32 m0,s29,126976
v_mfma_f32_16x16x32_bf16 a[20:23],v[96:99],v[76:79],a[20:23]
ds_read_b64_tr_b16 v[18:19],v116 offset:1024
v_mfma_f32_16x16x32_bf16 a[24:27],v[80:83],v[96:99],a[24:27]
v_mfma_f32_16x16x32_bf16 a[28:31],v[84:87],v[96:99],a[28:31]
ds_read_b64_tr_b16 v[20:21],v117
v_mfma_f32_16x16x32_bf16 a[32:35],v[88:91],v[96:99],a[32:35]
buffer_load_dwordx4 v132,s[12:15],s25 offen lds
v_mfma_f32_16x16x32_bf16 a[36:39],v[92:95],v[96:99],a[36:39]
ds_read_b64_tr_b16 v[22:23],v117 offset:1024
s_waitcnt lgkmcnt(5)
v_mfma_f32_16x16x32_bf16 a[40:43],v[56:59],v[100:103],a[40:43]
v_mfma_f32_16x16x32_bf16 a[44:47],v[60:63],v[100:103],a[44:47]
ds_read_b128 v[108:111],v115 offset:6144
v_mfma_f32_16x16x32_bf16 a[48:51],v[100:103],v[64:67],a[48:51]
v_mfma_f32_16x16x32_bf16 a[52:55],v[100:103],v[68:71],a[52:55]
ds_read_b64_tr_b16 v[24:25],v120 offset:4096
v_mfma_f32_16x16x32_bf16 a[56:59],v[100:103],v[72:75],a[56:59]
v_mfma_f32_16x16x32_bf16 a[60:63],v[100:103],v[76:79],a[60:63]
ds_read_b64_tr_b16 v[26:27],v120 offset:5120
v_mfma_f32_16x16x32_bf16 a[64:67],v[80:83],v[100:103],a[64:67]
v_mfma_f32_16x16x32_bf16 a[68:71],v[84:87],v[100:103],a[68:71]
ds_read_b64_tr_b16 v[28:29],v121 offset:4096
v_mfma_f32_16x16x32_bf16 a[72:75],v[88:91],v[100:103],a[72:75]
buffer_load_dwordx4 v133,s[12:15],s25 offen offset:1024 lds
v_mfma_f32_16x16x32_bf16 a[76:79],v[92:95],v[100:103],a[76:79]
ds_read_b64_tr_b16 v[30:31],v121 offset:5120
s_waitcnt lgkmcnt(9)
v_mfma_f32_16x16x32_bf16 a[80:83],v[56:59],v[104:107],a[80:83]
v_mfma_f32_16x16x32_bf16 a[84:87],v[60:63],v[104:107],a[84:87]
ds_read_b128 v[96:99],v115 offset:8192
v_mfma_f32_16x16x32_bf16 a[88:91],v[104:107],v[64:67],a[88:91]
v_mfma_f32_16x16x32_bf16 a[92:95],v[104:107],v[68:71],a[92:95]
ds_read_b64_tr_b16 v[32:33],v122 offset:4096
v_mfma_f32_16x16x32_bf16 a[96:99],v[104:107],v[72:75],a[96:99]
v_mfma_f32_16x16x32_bf16 a[100:103],v[104:107],v[76:79],a[100:103]
ds_read_b64_tr_b16 v[34:35],v122 offset:5120
v_mfma_f32_16x16x32_bf16 a[104:107],v[80:83],v[104:107],a[104:107]
v_mfma_f32_16x16x32_bf16 a[108:111],v[84:87],v[104:107],a[108:111]
ds_read_b64_tr_b16 v[36:37],v123 offset:4096
v_mfma_f32_16x16x32_bf16 a[112:115],v[88:91],v[104:107],a[112:115]
buffer_load_dwordx4 v134,s[12:15],s25 offen offset:2048 lds
v_mfma_f32_16x16x32_bf16 a[116:119],v[92:95],v[104:107],a[116:119]
ds_read_b64_tr_b16 v[38:39],v123 offset:5120
s_waitcnt lgkmcnt(9)
v_mfma_f32_16x16x32_bf16 a[120:123],v[56:59],v[108:111],a[120:123]
v_mfma_f32_16x16x32_bf16 a[124:127],v[60:63],v[108:111],a[124:127]
ds_read_b128 v[100:103],v115 offset:10240
v_mfma_f32_16x16x32_bf16 a[128:131],v[108:111],v[64:67],a[128:131]
v_mfma_f32_16x16x32_bf16 a[132:135],v[108:111],v[68:71],a[132:135]
ds_read_b64_tr_b16 v[40:41],v116 offset:12288
v_mfma_f32_16x16x32_bf16 a[136:139],v[108:111],v[72:75],a[136:139]
v_mfma_f32_16x16x32_bf16 a[140:143],v[108:111],v[76:79],a[140:143]
ds_read_b64_tr_b16 v[42:43],v116 offset:13312
v_mfma_f32_16x16x32_bf16 a[144:147],v[80:83],v[108:111],a[144:147]
v_mfma_f32_16x16x32_bf16 a[148:151],v[84:87],v[108:111],a[148:151]
ds_read_b64_tr_b16 v[44:45],v117 offset:12288
v_mfma_f32_16x16x32_bf16 a[152:155],v[88:91],v[108:111],a[152:155]
buffer_load_dwordx4 v135,s[12:15],s25 offen offset:3072 lds
v_mfma_f32_16x16x32_bf16 a[156:159],v[92:95],v[108:111],a[156:159]
ds_read_b64_tr_b16 v[46:47],v117 offset:13312
s_waitcnt lgkmcnt(9)
v_mfma_f32_16x16x32_bf16 a[160:163],v[56:59],v[96:99],a[160:163]
s_add_u32 s25,s25,s27
v_mfma_f32_16x16x32_bf16 a[164:167],v[60:63],v[96:99],a[164:167]
ds_read_b128 v[104:107],v115 offset:12288
v_mfma_f32_16x16x32_bf16 a[168:171],v[96:99],v[64:67],a[168:171]
v_mfma_f32_16x16x32_bf16 a[172:175],v[96:99],v[68:71],a[172:175]
ds_read_b64_tr_b16 v[48:49],v116 offset:16384
v_mfma_f32_16x16x32_bf16 a[176:179],v[96:99],v[72:75],a[176:179]
s_add_u32 m0,s30,143360
v_mfma_f32_16x16x32_bf16 a[180:183],v[96:99],v[76:79],a[180:183]
ds_read_b64_tr_b16 v[50:51],v116 offset:17408
v_mfma_f32_16x16x32_bf16 a[184:187],v[80:83],v[96:99],a[184:187]
v_mfma_f32_16x16x32_bf16 a[188:191],v[84:87],v[96:99],a[188:191]
ds_read_b64_tr_b16 v[52:53],v117 offset:16384
v_mfma_f32_16x16x32_bf16 a[192:195],v[88:91],v[96:99],a[192:195]
buffer_load_dwordx4 v136,s[16:19],s26 offen lds
v_mfma_f32_16x16x32_bf16 a[196:199],v[92:95],v[96:99],a[196:199]
ds_read_b64_tr_b16 v[54:55],v117 offset:17408
s_waitcnt lgkmcnt(9)
v_mfma_f32_16x16x32_bf16 a[200:203],v[56:59],v[100:103],a[200:203]
s_add_u32 s26,s26,s28
v_mfma_f32_16x16x32_bf16 a[204:207],v[60:63],v[100:103],a[204:207]
ds_read_b128 v[108:111],v115 offset:14336
v_mfma_f32_16x16x32_bf16 a[208:211],v[100:103],v[64:67],a[208:211]
v_mfma_f32_16x16x32_bf16 a[212:215],v[100:103],v[68:71],a[212:215]
v_mfma_f32_16x16x32_bf16 a[216:219],v[100:103],v[72:75],a[216:219]
v_mfma_f32_16x16x32_bf16 a[220:223],v[100:103],v[76:79],a[220:223]
v_mfma_f32_16x16x32_bf16 a[224:227],v[80:83],v[100:103],a[224:227]
v_mfma_f32_16x16x32_bf16 a[228:231],v[84:87],v[100:103],a[228:231]
v_mfma_f32_16x16x32_bf16 a[232:235],v[88:91],v[100:103],a[232:235]
s_waitcnt vmcnt(10) lgkmcnt(0)
s_barrier
v_mfma_f32_16x16x32_bf16 a[236:239],v[92:95],v[100:103],a[236:239]
s_add_u32 m0,s33,32768
v_mfma_f32_16x16x32_bf16 a[240:243],v[56:59],v[104:107],a[240:243]
buffer_load_dwordx4 v128,s[8:11],s24 offen lds
v_mfma_f32_16x16x32_bf16 a[244:247],v[60:63],v[104:107],a[244:247]
ds_read_b128 v[96:99],v112
v_mfma_f32_16x16x32_bf16 a[248:251],v[104:107],v[64:67],a[248:251]
v_mfma_f32_16x16x32_bf16 a[252:255],v[104:107],v[68:71],a[252:255]
v_mfma_f32_16x16x32_bf16 v[192:195],v[104:107],v[72:75],v[192:195]
v_mfma_f32_16x16x32_bf16 v[196:199],v[104:107],v[76:79],v[196:199]
v_mfma_f32_16x16x32_bf16 v[200:203],v[80:83],v[104:107],v[200:203]
v_mfma_f32_16x16x32_bf16 v[204:207],v[84:87],v[104:107],v[204:207]
v_mfma_f32_16x16x32_bf16 v[208:211],v[88:91],v[104:107],v[208:211]
buffer_load_dwordx4 v129,s[8:11],s24 offen offset:1024 lds
v_mfma_f32_16x16x32_bf16 v[212:215],v[92:95],v[104:107],v[212:215]
v_mfma_f32_16x16x32_bf16 v[216:219],v[56:59],v[108:111],v[216:219]
v_mfma_f32_16x16x32_bf16 v[220:223],v[60:63],v[108:111],v[220:223]
ds_read_b128 v[100:103],v112 offset:2048
v_mfma_f32_16x16x32_bf16 v[224:227],v[108:111],v[64:67],v[224:227]
v_mfma_f32_16x16x32_bf16 v[228:231],v[108:111],v[68:71],v[228:231]
v_mfma_f32_16x16x32_bf16 v[232:235],v[108:111],v[72:75],v[232:235]
v_mfma_f32_16x16x32_bf16 v[236:239],v[108:111],v[76:79],v[236:239]
v_mfma_f32_16x16x32_bf16 v[240:243],v[80:83],v[108:111],v[240:243]
buffer_load_dwordx4 v130,s[8:11],s24 offen offset:2048 lds
s_add_u32 s50,s50,1
v_mfma_f32_16x16x32_bf16 v[244:247],v[84:87],v[108:111],v[244:247]
s_cmp_lg_u32 s50,s59
v_mfma_f32_16x16x32_bf16 v[248:251],v[88:91],v[108:111],v[248:251]
v_mfma_f32_16x16x32_bf16 v[252:255],v[92:95],v[108:111],v[252:255]
s_cbranch_scc1 L_loopB
L_bxB:
s_waitcnt lgkmcnt(1)
v_mfma_f32_16x16x32_bf16 a[0:3],v[16:19],v[96:99],a[0:3]
v_mfma_f32_16x16x32_bf16 a[4:7],v[20:23],v[96:99],a[4:7]
ds_read_b128 v[104:107],v112 offset:4096
v_mfma_f32_16x16x32_bf16 a[8:11],v[96:99],v[24:27],a[8:11]
v_mfma_f32_16x16x32_bf16 a[12:15],v[96:99],v[28:31],a[12:15]
ds_read_b64_tr_b16 v[56:57],v116 offset:20480
v_mfma_f32_16x16x32_bf16 a[16:19],v[96:99],v[32:35],a[16:19]
buffer_load_dwordx4 v131,s[8:11],s24 offen offset:3072 lds
v_mfma_f32_16x16x32_bf16 a[20:23],v[96:99],v[36:39],a[20:23]
ds_read_b64_tr_b16 v[58:59],v116 offset:21504
v_mfma_f32_16x16x32_bf16 a[24:27],v[40:43],v[96:99],a[24:27]
v_mfma_f32_16x16x32_bf16 a[28:31],v[44:47],v[96:99],a[28:31]
ds_read_b64_tr_b16 v[60:61],v117 offset:20480
v_mfma_f32_16x16x32_bf16 a[32:35],v[48:51],v[96:99],a[32:35]
s_add_u32 m0,s33,36864
v_mfma_f32_16x16x32_bf16 a[36:39],v[52:55],v[96:99],a[36:39]
ds_read_b64_tr_b16 v[62:63],v117 offset:21504
s_waitcnt lgkmcnt(5)
v_mfma_f32_16x16x32_bf16 a[40:43],v[16:19],v[100:103],a[40:43]
v_mfma_f32_16x16x32_bf16 a[44:47],v[20:23],v[100:103],a[44:47]
ds_read_b128 v[108:111],v112 offset:6144
v_mfma_f32_16x16x32_bf16 a[48:51],v[100:103],v[24:27],a[48:51]
v_mfma_f32_16x16x32_bf16 a[52:55],v[100:103],v[28:31],a[52:55]
ds_read_b64_tr_b16 v[64:65],v120 offset:24576
v_mfma_f32_16x16x32_bf16 a[56:59],v[100:103],v[32:35],a[56:59]
buffer_load_dwordx4 v128,s[8:11],s32 offen lds
v_mfma_f32_16x16x32_bf16 a[60:63],v[100:103],v[36:39],a[60:63]
ds_read_b64_tr_b16 v[66:67],v120 offset:25600
v_mfma_f32_16x16x32_bf16 a[64:67],v[40:43],v[100:103],a[64:67]
v_mfma_f32_16x16x32_bf16 a[68:71],v[44:47],v[100:103],a[68:71]
ds_read_b64_tr_b16 v[68:69],v121 offset:24576
v_mfma_f32_16x16x32_bf16 a[72:75],v[48:51],v[100:103],a[72:75]
v_mfma_f32_16x16x32_bf16 a[76:79],v[52:55],v[100:103],a[76:79]
ds_read_b64_tr_b16 v[70:71],v121 offset:25600
s_waitcnt lgkmcnt(9)
v_mfma_f32_16x16x32_bf16 a[80:83],v[16:19],v[104:107],a[80:83]
buffer_load_dwordx4 v129,s[8:11],s32 offen offset:1024 lds
v_mfma_f32_16x16x32_bf16 a[84:87],v[20:23],v[104:107],a[84:87]
ds_read_b128 v[96:99],v112 offset:8192
v_mfma_f32_16x16x32_bf16 a[88:91],v[104:107],v[24:27],a[88:91]
v_mfma_f32_16x16x32_bf16 a[92:95],v[104:107],v[28:31],a[92:95]
ds_read_b64_tr_b16 v[72:73],v122 offset:24576
v_mfma_f32_16x16x32_bf16 a[96:99],v[104:107],v[32:35],a[96:99]
v_mfma_f32_16x16x32_bf16 a[100:103],v[104:107],v[36:39],a[100:103]
ds_read_b64_tr_b16 v[74:75],v122 offset:25600
v_mfma_f32_16x16x32_bf16 a[104:107],v[40:43],v[104:107],a[104:107]
v_mfma_f32_16x16x32_bf16 a[108:111],v[44:47],v[104:107],a[108:111]
ds_read_b64_tr_b16 v[76:77],v123 offset:24576
v_mfma_f32_16x16x32_bf16 a[112:115],v[48:51],v[104:107],a[112:115]
buffer_load_dwordx4 v130,s[8:11],s32 offen offset:2048 lds
v_mfma_f32_16x16x32_bf16 a[116:119],v[52:55],v[104:107],a[116:119]
ds_read_b64_tr_b16 v[78:79],v123 offset:25600
s_waitcnt lgkmcnt(9)
v_mfma_f32_16x16x32_bf16 a[120:123],v[16:19],v[108:111],a[120:123]
v_mfma_f32_16x16x32_bf16 a[124:127],v[20:23],v[108:111],a[124:127]
ds_read_b128 v[100:103],v112 offset:10240
v_mfma_f32_16x16x32_bf16 a[128:131],v[108:111],v[24:27],a[128:131]
v_mfma_f32_16x16x32_bf16 a[132:135],v[108:111],v[28:31],a[132:135]
ds_read_b64_tr_b16 v[80:81],v116 offset:32768
v_mfma_f32_16x16x32_bf16 a[136:139],v[108:111],v[32:35],a[136:139]
buffer_load_dwordx4 v131,s[8:11],s32 offen offset:3072 lds
v_mfma_f32_16x16x32_bf16 a[140:143],v[108:111],v[36:39],a[140:143]
ds_read_b64_tr_b16 v[82:83],v116 offset:33792
v_mfma_f32_16x16x32_bf16 a[144:147],v[40:43],v[108:111],a[144:147]
v_mfma_f32_16x16x32_bf16 a[148:151],v[44:47],v[108:111],a[148:151]
ds_read_b64_tr_b16 v[84:85],v117 offset:32768
v_mfma_f32_16x16x32_bf16 a[152:155],v[48:51],v[108:111],a[152:155]
s_add_u32 s24,s24,128
v_mfma_f32_16x16x32_bf16 a[156:159],v[52:55],v[108:111],a[156:159]
ds_read_b64_tr_b16 v[86:87],v117 offset:33792
s_waitcnt lgkmcnt(9)
v_mfma_f32_16x16x32_bf16 a[160:163],v[16:19],v[96:99],a[160:163]
s_add_u32 s32,s32,128
v_mfma_f32_16x16x32_bf16 a[164:167],v[20:23],v[96:99],a[164:167]
ds_read_b128 v[104:107],v112 offset:12288
v_mfma_f32_16x16x32_bf16 a[168:171],v[96:99],v[24:27],a[168:171]
s_add_u32 m0,s29,65536
v_mfma_f32_16x16x32_bf16 a[172:175],v[96:99],v[28:31],a[172:175]
ds_read_b64_tr_b16 v[88:89],v116 offset:36864
v_mfma_f32_16x16x32_bf16 a[176:179],v[96:99],v[32:35],a[176:179]
buffer_load_dwordx4 v132,s[12:15],s25 offen lds
v_mfma_f32_16x16x32_bf16 a[180:183],v[96:99],v[36:39],a[180:183]
ds_read_b64_tr_b16 v[90:91],v116 offset:37888
v_mfma_f32_16x16x32_bf16 a[184:187],v[40:43],v[96:99],a[184:187]
v_mfma_f32_16x16x32_bf16 a[188:191],v[44:47],v[96:99],a[188:191]
ds_read_b64_tr_b16 v[92:93],v117 offset:36864
v_mfma_f32_16x16x32_bf16 a[192:195],v[48:51],v[96:99],a[192:195]
v_mfma_f32_16x16x32_bf16 a[196:199],v[52:55],v[96:99],a[196:199]
ds_read_b64_tr_b16 v[94:95],v117 offset:37888
s_waitcnt lgkmcnt(9)
v_mfma_f32_16x16x32_bf16 a[200:203],v[16:19],v[100:103],a[200:203]
buffer_load_dwordx4 v133,s[12:15],s25 offen offset:1024 lds
v_mfma_f32_16x16x32_bf16 a[204:207],v[20:23],v[100:103],a[204:207]
ds_read_b128 v[108:111],v112 offset:14336
v_mfma_f32_16x16x32_bf16 a[208:211],v[100:103],v[24:27],a[208:211]
s_cbranch_vccnz .Lcs32
v_smfmac_f32_16x16x64_bf16 v[144:147],v[164:167],v[16:23],v143
v_smfmac_f32_16x16x64_bf16 v[148:151],v[164:167],v[24:31],v143
v_smfmac_f32_16x16x64_bf16 v[152:155],v[164:167],v[32:39],v143
s_branch .Lce32
.Lcs32:
v_smfmac_f32_16x16x64_bf16 v[156:159],v[164:167],v[40:47],v143
v_smfmac_f32_16x16x64_bf16 v[160:163],v[164:167],v[48:55],v143
.Lce32:
v_mfma_f32_16x16x32_bf16 a[212:215],v[100:103],v[28:31],a[212:215]
v_mfma_f32_16x16x32_bf16 a[216:219],v[100:103],v[32:35],a[216:219]
v_mfma_f32_16x16x32_bf16 a[220:223],v[100:103],v[36:39],a[220:223]
v_mfma_f32_16x16x32_bf16 a[224:227],v[40:43],v[100:103],a[224:227]
buffer_load_dwordx4 v134,s[12:15],s25 offen offset:2048 lds
v_mfma_f32_16x16x32_bf16 a[228:231],v[44:47],v[100:103],a[228:231]
v_mfma_f32_16x16x32_bf16 a[232:235],v[48:51],v[100:103],a[232:235]
s_waitcnt vmcnt(16) lgkmcnt(0)
s_barrier
v_mfma_f32_16x16x32_bf16 a[236:239],v[52:55],v[100:103],a[236:239]
v_mfma_f32_16x16x32_bf16 a[240:243],v[16:19],v[104:107],a[240:243]
v_mfma_f32_16x16x32_bf16 a[244:247],v[20:23],v[104:107],a[244:247]
ds_read_b128 v[96:99],v113
v_mfma_f32_16x16x32_bf16 a[248:251],v[104:107],v[24:27],a[248:251]
v_mfma_f32_16x16x32_bf16 a[252:255],v[104:107],v[28:31],a[252:255]
v_mfma_f32_16x16x32_bf16 v[192:195],v[104:107],v[32:35],v[192:195]
buffer_load_dwordx4 v135,s[12:15],s25 offen offset:3072 lds
v_mfma_f32_16x16x32_bf16 v[196:199],v[104:107],v[36:39],v[196:199]
v_mfma_f32_16x16x32_bf16 v[200:203],v[40:43],v[104:107],v[200:203]
s_add_u32 s25,s25,s27
v_mfma_f32_16x16x32_bf16 v[204:207],v[44:47],v[104:107],v[204:207]
v_mfma_f32_16x16x32_bf16 v[208:211],v[48:51],v[104:107],v[208:211]
s_add_u32 m0,s30,81920
v_mfma_f32_16x16x32_bf16 v[212:215],v[52:55],v[104:107],v[212:215]
v_mfma_f32_16x16x32_bf16 v[216:219],v[16:19],v[108:111],v[216:219]
v_mfma_f32_16x16x32_bf16 v[220:223],v[20:23],v[108:111],v[220:223]
ds_read_b128 v[100:103],v113 offset:2048
v_mfma_f32_16x16x32_bf16 v[224:227],v[108:111],v[24:27],v[224:227]
v_mfma_f32_16x16x32_bf16 v[228:231],v[108:111],v[28:31],v[228:231]
v_mfma_f32_16x16x32_bf16 v[232:235],v[108:111],v[32:35],v[232:235]
buffer_load_dwordx4 v136,s[16:19],s26 offen lds
v_mfma_f32_16x16x32_bf16 v[236:239],v[108:111],v[36:39],v[236:239]
v_mfma_f32_16x16x32_bf16 v[240:243],v[40:43],v[108:111],v[240:243]
v_mfma_f32_16x16x32_bf16 v[244:247],v[44:47],v[108:111],v[244:247]
v_mfma_f32_16x16x32_bf16 v[248:251],v[48:51],v[108:111],v[248:251]
s_add_u32 s26,s26,s28
v_mfma_f32_16x16x32_bf16 v[252:255],v[52:55],v[108:111],v[252:255]
s_waitcnt lgkmcnt(1)
v_mfma_f32_16x16x32_bf16 a[0:3],v[56:59],v[96:99],a[0:3]
v_mfma_f32_16x16x32_bf16 a[4:7],v[60:63],v[96:99],a[4:7]
ds_read_b128 v[104:107],v113 offset:4096
v_mfma_f32_16x16x32_bf16 a[8:11],v[96:99],v[64:67],a[8:11]
v_mfma_f32_16x16x32_bf16 a[12:15],v[96:99],v[68:71],a[12:15]
ds_read_b64_tr_b16 v[16:17],v116 offset:40960
v_mfma_f32_16x16x32_bf16 a[16:19],v[96:99],v[72:75],a[16:19]
s_add_u32 m0,s29,86016
v_mfma_f32_16x16x32_bf16 a[20:23],v[96:99],v[76:79],a[20:23]
ds_read_b64_tr_b16 v[18:19],v116 offset:41984
v_mfma_f32_16x16x32_bf16 a[24:27],v[80:83],v[96:99],a[24:27]
v_mfma_f32_16x16x32_bf16 a[28:31],v[84:87],v[96:99],a[28:31]
ds_read_b64_tr_b16 v[20:21],v117 offset:40960
v_mfma_f32_16x16x32_bf16 a[32:35],v[88:91],v[96:99],a[32:35]
buffer_load_dwordx4 v132,s[12:15],s25 offen lds
v_mfma_f32_16x16x32_bf16 a[36:39],v[92:95],v[96:99],a[36:39]
ds_read_b64_tr_b16 v[22:23],v117 offset:41984
s_waitcnt lgkmcnt(5)
v_mfma_f32_16x16x32_bf16 a[40:43],v[56:59],v[100:103],a[40:43]
v_mfma_f32_16x16x32_bf16 a[44:47],v[60:63],v[100:103],a[44:47]
ds_read_b128 v[108:111],v113 offset:6144
v_mfma_f32_16x16x32_bf16 a[48:51],v[100:103],v[64:67],a[48:51]
v_mfma_f32_16x16x32_bf16 a[52:55],v[100:103],v[68:71],a[52:55]
ds_read_b64_tr_b16 v[24:25],v120 offset:45056
v_mfma_f32_16x16x32_bf16 a[56:59],v[100:103],v[72:75],a[56:59]
v_mfma_f32_16x16x32_bf16 a[60:63],v[100:103],v[76:79],a[60:63]
ds_read_b64_tr_b16 v[26:27],v120 offset:46080
v_mfma_f32_16x16x32_bf16 a[64:67],v[80:83],v[100:103],a[64:67]
v_mfma_f32_16x16x32_bf16 a[68:71],v[84:87],v[100:103],a[68:71]
ds_read_b64_tr_b16 v[28:29],v121 offset:45056
v_mfma_f32_16x16x32_bf16 a[72:75],v[88:91],v[100:103],a[72:75]
buffer_load_dwordx4 v133,s[12:15],s25 offen offset:1024 lds
v_mfma_f32_16x16x32_bf16 a[76:79],v[92:95],v[100:103],a[76:79]
ds_read_b64_tr_b16 v[30:31],v121 offset:46080
s_waitcnt lgkmcnt(9)
v_mfma_f32_16x16x32_bf16 a[80:83],v[56:59],v[104:107],a[80:83]
v_mfma_f32_16x16x32_bf16 a[84:87],v[60:63],v[104:107],a[84:87]
ds_read_b128 v[96:99],v113 offset:8192
v_mfma_f32_16x16x32_bf16 a[88:91],v[104:107],v[64:67],a[88:91]
v_mfma_f32_16x16x32_bf16 a[92:95],v[104:107],v[68:71],a[92:95]
ds_read_b64_tr_b16 v[32:33],v122 offset:45056
v_mfma_f32_16x16x32_bf16 a[96:99],v[104:107],v[72:75],a[96:99]
v_mfma_f32_16x16x32_bf16 a[100:103],v[104:107],v[76:79],a[100:103]
ds_read_b64_tr_b16 v[34:35],v122 offset:46080
v_mfma_f32_16x16x32_bf16 a[104:107],v[80:83],v[104:107],a[104:107]
v_mfma_f32_16x16x32_bf16 a[108:111],v[84:87],v[104:107],a[108:111]
ds_read_b64_tr_b16 v[36:37],v123 offset:45056
v_mfma_f32_16x16x32_bf16 a[112:115],v[88:91],v[104:107],a[112:115]
buffer_load_dwordx4 v134,s[12:15],s25 offen offset:2048 lds
v_mfma_f32_16x16x32_bf16 a[116:119],v[92:95],v[104:107],a[116:119]
ds_read_b64_tr_b16 v[38:39],v123 offset:46080
s_waitcnt lgkmcnt(9)
v_mfma_f32_16x16x32_bf16 a[120:123],v[56:59],v[108:111],a[120:123]
v_mfma_f32_16x16x32_bf16 a[124:127],v[60:63],v[108:111],a[124:127]
ds_read_b128 v[100:103],v113 offset:10240
v_mfma_f32_16x16x32_bf16 a[128:131],v[108:111],v[64:67],a[128:131]
v_mfma_f32_16x16x32_bf16 a[132:135],v[108:111],v[68:71],a[132:135]
ds_read_b64_tr_b16 v[40:41],v116 offset:53248
v_mfma_f32_16x16x32_bf16 a[136:139],v[108:111],v[72:75],a[136:139]
v_mfma_f32_16x16x32_bf16 a[140:143],v[108:111],v[76:79],a[140:143]
ds_read_b64_tr_b16 v[42:43],v116 offset:54272
v_mfma_f32_16x16x32_bf16 a[144:147],v[80:83],v[108:111],a[144:147]
v_mfma_f32_16x16x32_bf16 a[148:151],v[84:87],v[108:111],a[148:151]
ds_read_b64_tr_b16 v[44:45],v117 offset:53248
v_mfma_f32_16x16x32_bf16 a[152:155],v[88:91],v[108:111],a[152:155]
buffer_load_dwordx4 v135,s[12:15],s25 offen offset:3072 lds
v_mfma_f32_16x16x32_bf16 a[156:159],v[92:95],v[108:111],a[156:159]
ds_read_b64_tr_b16 v[46:47],v117 offset:54272
s_waitcnt lgkmcnt(9)
v_mfma_f32_16x16x32_bf16 a[160:163],v[56:59],v[96:99],a[160:163]
s_add_u32 s25,s25,s27
v_mfma_f32_16x16x32_bf16 a[164:167],v[60:63],v[96:99],a[164:167]
ds_read_b128 v[104:107],v113 offset:12288
v_mfma_f32_16x16x32_bf16 a[168:171],v[96:99],v[64:67],a[168:171]
v_mfma_f32_16x16x32_bf16 a[172:175],v[96:99],v[68:71],a[172:175]
ds_read_b64_tr_b16 v[48:49],v116 offset:57344
v_mfma_f32_16x16x32_bf16 a[176:179],v[96:99],v[72:75],a[176:179]
s_add_u32 m0,s30,102400
v_mfma_f32_16x16x32_bf16 a[180:183],v[96:99],v[76:79],a[180:183]
ds_read_b64_tr_b16 v[50:51],v116 offset:58368
v_mfma_f32_16x16x32_bf16 a[184:187],v[80:83],v[96:99],a[184:187]
v_mfma_f32_16x16x32_bf16 a[188:191],v[84:87],v[96:99],a[188:191]
ds_read_b64_tr_b16 v[52:53],v117 offset:57344
v_mfma_f32_16x16x32_bf16 a[192:195],v[88:91],v[96:99],a[192:195]
buffer_load_dwordx4 v136,s[16:19],s26 offen lds
v_mfma_f32_16x16x32_bf16 a[196:199],v[92:95],v[96:99],a[196:199]
ds_read_b64_tr_b16 v[54:55],v117 offset:58368
s_waitcnt lgkmcnt(9)
v_mfma_f32_16x16x32_bf16 a[200:203],v[56:59],v[100:103],a[200:203]
s_add_u32 s26,s26,s28
v_mfma_f32_16x16x32_bf16 a[204:207],v[60:63],v[100:103],a[204:207]
ds_read_b128 v[108:111],v113 offset:14336
v_mfma_f32_16x16x32_bf16 a[208:211],v[100:103],v[64:67],a[208:211]
s_cbranch_vccnz .Lcs33
v_smfmac_f32_16x16x64_bf16 v[144:147],v[164:167],v[56:63],v143
v_smfmac_f32_16x16x64_bf16 v[148:151],v[164:167],v[64:71],v143
v_smfmac_f32_16x16x64_bf16 v[152:155],v[164:167],v[72:79],v143
s_branch .Lce33
.Lcs33:
v_smfmac_f32_16x16x64_bf16 v[156:159],v[164:167],v[80:87],v143
v_smfmac_f32_16x16x64_bf16 v[160:163],v[164:167],v[88:95],v143
.Lce33:
v_mfma_f32_16x16x32_bf16 a[212:215],v[100:103],v[68:71],a[212:215]
v_mfma_f32_16x16x32_bf16 a[216:219],v[100:103],v[72:75],a[216:219]
v_mfma_f32_16x16x32_bf16 a[220:223],v[100:103],v[76:79],a[220:223]
v_mfma_f32_16x16x32_bf16 a[224:227],v[80:83],v[100:103],a[224:227]
v_mfma_f32_16x16x32_bf16 a[228:231],v[84:87],v[100:103],a[228:231]
v_mfma_f32_16x16x32_bf16 a[232:235],v[88:91],v[100:103],a[232:235]
s_waitcnt vmcnt(10) lgkmcnt(0)
s_barrier
v_mfma_f32_16x16x32_bf16 a[236:239],v[92:95],v[100:103],a[236:239]
s_add_u32 m0,s33,0
v_mfma_f32_16x16x32_bf16 a[240:243],v[56:59],v[104:107],a[240:243]
buffer_load_dwordx4 v128,s[8:11],s24 offen lds
v_mfma_f32_16x16x32_bf16 a[244:247],v[60:63],v[104:107],a[244:247]
ds_read_b128 v[96:99],v114
v_mfma_f32_16x16x32_bf16 a[248:251],v[104:107],v[64:67],a[248:251]
buffer_load_dword v139,v137,s[64:67],s72 offen
v_mfma_f32_16x16x32_bf16 a[252:255],v[104:107],v[68:71],a[252:255]
v_mfma_f32_16x16x32_bf16 v[192:195],v[104:107],v[72:75],v[192:195]
v_mfma_f32_16x16x32_bf16 v[196:199],v[104:107],v[76:79],v[196:199]
v_mfma_f32_16x16x32_bf16 v[200:203],v[80:83],v[104:107],v[200:203]
v_mfma_f32_16x16x32_bf16 v[204:207],v[84:87],v[104:107],v[204:207]
v_mfma_f32_16x16x32_bf16 v[208:211],v[88:91],v[104:107],v[208:211]
buffer_load_dwordx4 v129,s[8:11],s24 offen offset:1024 lds
v_mfma_f32_16x16x32_bf16 v[212:215],v[92:95],v[104:107],v[212:215]
v_mfma_f32_16x16x32_bf16 v[216:219],v[56:59],v[108:111],v[216:219]
v_mfma_f32_16x16x32_bf16 v[220:223],v[60:63],v[108:111],v[220:223]
ds_read_b128 v[100:103],v114 offset:2048
v_mfma_f32_16x16x32_bf16 v[224:227],v[108:111],v[64:67],v[224:227]
s_add_u32 s72,s72,1835008
v_mfma_f32_16x16x32_bf16 v[228:231],v[108:111],v[68:71],v[228:231]
v_mfma_f32_16x16x32_bf16 v[232:235],v[108:111],v[72:75],v[232:235]
v_mfma_f32_16x16x32_bf16 v[236:239],v[108:111],v[76:79],v[236:239]
v_mfma_f32_16x16x32_bf16 v[240:243],v[80:83],v[108:111],v[240:243]
buffer_load_dwordx4 v130,s[8:11],s24 offen offset:2048 lds
v_mfma_f32_16x16x32_bf16 v[244:247],v[84:87],v[108:111],v[244:247]
v_mfma_f32_16x16x32_bf16 v[248:251],v[88:91],v[108:111],v[248:251]
v_mfma_f32_16x16x32_bf16 v[252:255],v[92:95],v[108:111],v[252:255]
s_waitcnt lgkmcnt(1)
v_mfma_f32_16x16x32_bf16 a[0:3],v[16:19],v[96:99],a[0:3]
v_mfma_f32_16x16x32_bf16 a[4:7],v[20:23],v[96:99],a[4:7]
ds_read_b128 v[104:107],v114 offset:4096
v_mfma_f32_16x16x32_bf16 a[8:11],v[96:99],v[24:27],a[8:11]
v_mfma_f32_16x16x32_bf16 a[12:15],v[96:99],v[28:31],a[12:15]
ds_read_b64_tr_b16 v[56:57],v118
v_mfma_f32_16x16x32_bf16 a[16:19],v[96:99],v[32:35],a[16:19]
buffer_load_dwordx4 v131,s[8:11],s24 offen offset:3072 lds
v_mfma_f32_16x16x32_bf16 a[20:23],v[96:99],v[36:39],a[20:23]
ds_read_b64_tr_b16 v[58:59],v118 offset:1024
v_mfma_f32_16x16x32_bf16 a[24:27],v[40:43],v[96:99],a[24:27]
v_mfma_f32_16x16x32_bf16 a[28:31],v[44:47],v[96:99],a[28:31]
ds_read_b64_tr_b16 v[60:61],v119
v_mfma_f32_16x16x32_bf16 a[32:35],v[48:51],v[96:99],a[32:35]
s_add_u32 m0,s33,4096
v_mfma_f32_16x16x32_bf16 a[36:39],v[52:55],v[96:99],a[36:39]
ds_read_b64_tr_b16 v[62:63],v119 offset:1024
s_waitcnt lgkmcnt(5)
v_mfma_f32_16x16x32_bf16 a[40:43],v[16:19],v[100:103],a[40:43]
v_mfma_f32_16x16x32_bf16 a[44:47],v[20:23],v[100:103],a[44:47]
ds_read_b128 v[108:111],v114 offset:6144
v_mfma_f32_16x16x32_bf16 a[48:51],v[100:103],v[24:27],a[48:51]
v_mfma_f32_16x16x32_bf16 a[52:55],v[100:103],v[28:31],a[52:55]
ds_read_b64_tr_b16 v[64:65],v124 offset:4096
v_mfma_f32_16x16x32_bf16 a[56:59],v[100:103],v[32:35],a[56:59]
buffer_load_dwordx4 v128,s[8:11],s32 offen lds
v_mfma_f32_16x16x32_bf16 a[60:63],v[100:103],v[36:39],a[60:63]
ds_read_b64_tr_b16 v[66:67],v124 offset:5120
v_mfma_f32_16x16x32_bf16 a[64:67],v[40:43],v[100:103],a[64:67]
v_mfma_f32_16x16x32_bf16 a[68:71],v[44:47],v[100:103],a[68:71]
ds_read_b64_tr_b16 v[68:69],v125 offset:4096
v_mfma_f32_16x16x32_bf16 a[72:75],v[48:51],v[100:103],a[72:75]
v_mfma_f32_16x16x32_bf16 a[76:79],v[52:55],v[100:103],a[76:79]
ds_read_b64_tr_b16 v[70:71],v125 offset:5120
s_waitcnt lgkmcnt(9)
v_mfma_f32_16x16x32_bf16 a[80:83],v[16:19],v[104:107],a[80:83]
buffer_load_dwordx4 v129,s[8:11],s32 offen offset:1024 lds
v_mfma_f32_16x16x32_bf16 a[84:87],v[20:23],v[104:107],a[84:87]
ds_read_b128 v[96:99],v114 offset:8192
v_mfma_f32_16x16x32_bf16 a[88:91],v[104:107],v[24:27],a[88:91]
v_mfma_f32_16x16x32_bf16 a[92:95],v[104:107],v[28:31],a[92:95]
ds_read_b64_tr_b16 v[72:73],v126 offset:4096
v_mfma_f32_16x16x32_bf16 a[96:99],v[104:107],v[32:35],a[96:99]
v_mfma_f32_16x16x32_bf16 a[100:103],v[104:107],v[36:39],a[100:103]
ds_read_b64_tr_b16 v[74:75],v126 offset:5120
v_mfma_f32_16x16x32_bf16 a[104:107],v[40:43],v[104:107],a[104:107]
v_mfma_f32_16x16x32_bf16 a[108:111],v[44:47],v[104:107],a[108:111]
ds_read_b64_tr_b16 v[76:77],v127 offset:4096
v_mfma_f32_16x16x32_bf16 a[112:115],v[48:51],v[104:107],a[112:115]
buffer_load_dwordx4 v130,s[8:11],s32 offen offset:2048 lds
v_mfma_f32_16x16x32_bf16 a[116:119],v[52:55],v[104:107],a[116:119]
ds_read_b64_tr_b16 v[78:79],v127 offset:5120
s_waitcnt lgkmcnt(9)
v_mfma_f32_16x16x32_bf16 a[120:123],v[16:19],v[108:111],a[120:123]
v_mfma_f32_16x16x32_bf16 a[124:127],v[20:23],v[108:111],a[124:127]
ds_read_b128 v[100:103],v114 offset:10240
v_mfma_f32_16x16x32_bf16 a[128:131],v[108:111],v[24:27],a[128:131]
v_mfma_f32_16x16x32_bf16 a[132:135],v[108:111],v[28:31],a[132:135]
ds_read_b64_tr_b16 v[80:81],v118 offset:12288
v_mfma_f32_16x16x32_bf16 a[136:139],v[108:111],v[32:35],a[136:139]
buffer_load_dwordx4 v131,s[8:11],s32 offen offset:3072 lds
v_mfma_f32_16x16x32_bf16 a[140:143],v[108:111],v[36:39],a[140:143]
ds_read_b64_tr_b16 v[82:83],v118 offset:13312
v_mfma_f32_16x16x32_bf16 a[144:147],v[40:43],v[108:111],a[144:147]
v_mfma_f32_16x16x32_bf16 a[148:151],v[44:47],v[108:111],a[148:151]
ds_read_b64_tr_b16 v[84:85],v119 offset:12288
v_mfma_f32_16x16x32_bf16 a[152:155],v[48:51],v[108:111],a[152:155]
s_add_u32 s24,s24,128
v_mfma_f32_16x16x32_bf16 a[156:159],v[52:55],v[108:111],a[156:159]
ds_read_b64_tr_b16 v[86:87],v119 offset:13312
s_waitcnt lgkmcnt(9)
v_mfma_f32_16x16x32_bf16 a[160:163],v[16:19],v[96:99],a[160:163]
s_add_u32 s32,s32,128
v_mfma_f32_16x16x32_bf16 a[164:167],v[20:23],v[96:99],a[164:167]
ds_read_b128 v[104:107],v114 offset:12288
v_mfma_f32_16x16x32_bf16 a[168:171],v[96:99],v[24:27],a[168:171]
s_add_u32 m0,s29,106496
v_mfma_f32_16x16x32_bf16 a[172:175],v[96:99],v[28:31],a[172:175]
ds_read_b64_tr_b16 v[88:89],v118 offset:16384
v_mfma_f32_16x16x32_bf16 a[176:179],v[96:99],v[32:35],a[176:179]
buffer_load_dwordx4 v132,s[12:15],s25 offen lds
v_mfma_f32_16x16x32_bf16 a[180:183],v[96:99],v[36:39],a[180:183]
ds_read_b64_tr_b16 v[90:91],v118 offset:17408
v_mfma_f32_16x16x32_bf16 a[184:187],v[40:43],v[96:99],a[184:187]
v_mfma_f32_16x16x32_bf16 a[188:191],v[44:47],v[96:99],a[188:191]
ds_read_b64_tr_b16 v[92:93],v119 offset:16384
v_mfma_f32_16x16x32_bf16 a[192:195],v[48:51],v[96:99],a[192:195]
v_mfma_f32_16x16x32_bf16 a[196:199],v[52:55],v[96:99],a[196:199]
ds_read_b64_tr_b16 v[94:95],v119 offset:17408
s_waitcnt lgkmcnt(9)
v_mfma_f32_16x16x32_bf16 a[200:203],v[16:19],v[100:103],a[200:203]
buffer_load_dwordx4 v133,s[12:15],s25 offen offset:1024 lds
v_mfma_f32_16x16x32_bf16 a[204:207],v[20:23],v[100:103],a[204:207]
ds_read_b128 v[108:111],v114 offset:14336
v_mfma_f32_16x16x32_bf16 a[208:211],v[100:103],v[24:27],a[208:211]
s_cbranch_vccnz .Lcs34
v_smfmac_f32_16x16x64_bf16 v[144:147],v[164:167],v[16:23],v143
v_smfmac_f32_16x16x64_bf16 v[148:151],v[164:167],v[24:31],v143
v_smfmac_f32_16x16x64_bf16 v[152:155],v[164:167],v[32:39],v143
s_branch .Lce34
.Lcs34:
v_smfmac_f32_16x16x64_bf16 v[156:159],v[164:167],v[40:47],v143
v_smfmac_f32_16x16x64_bf16 v[160:163],v[164:167],v[48:55],v143
.Lce34:
v_mfma_f32_16x16x32_bf16 a[212:215],v[100:103],v[28:31],a[212:215]
v_mfma_f32_16x16x32_bf16 a[216:219],v[100:103],v[32:35],a[216:219]
v_mfma_f32_16x16x32_bf16 a[220:223],v[100:103],v[36:39],a[220:223]
v_mfma_f32_16x16x32_bf16 a[224:227],v[40:43],v[100:103],a[224:227]
buffer_load_dwordx4 v134,s[12:15],s25 offen offset:2048 lds
v_mfma_f32_16x16x32_bf16 a[228:231],v[44:47],v[100:103],a[228:231]
v_mfma_f32_16x16x32_bf16 a[232:235],v[48:51],v[100:103],a[232:235]
s_waitcnt vmcnt(16) lgkmcnt(0)
s_barrier
s_cmp_lg_u32 s50,s51
s_cbranch_scc1 L_evB1
v_mov_b32 v10,1
v_mov_b32 v11,0
s_and_b32 s48,s2,7
s_lshl_b32 s48,s48,2
s_mov_b64 exec,1
buffer_store_dword v10,v11,s[20:23],s56 offen sc1
buffer_atomic_add v10,v11,s[52:55],s48 offen sc1
s_mov_b64 exec,-1
L_evB1:
s_cmp_lg_u32 s50,s57
s_cbranch_scc1 L_ezB1
v_mov_b32 v10,1
v_mov_b32 v11,0
s_mov_b64 exec,1
buffer_store_dword v10,v11,s[20:23],s58 offen sc1
s_mov_b64 exec,-1
L_ezB1:
v_mfma_f32_16x16x32_bf16 a[236:239],v[52:55],v[100:103],a[236:239]
v_mfma_f32_16x16x32_bf16 a[240:243],v[16:19],v[104:107],a[240:243]
v_mfma_f32_16x16x32_bf16 a[244:247],v[20:23],v[104:107],a[244:247]
ds_read_b128 v[96:99],v115
v_mfma_f32_16x16x32_bf16 a[248:251],v[104:107],v[24:27],a[248:251]
v_mfma_f32_16x16x32_bf16 a[252:255],v[104:107],v[28:31],a[252:255]
v_mfma_f32_16x16x32_bf16 v[192:195],v[104:107],v[32:35],v[192:195]
buffer_load_dwordx4 v135,s[12:15],s25 offen offset:3072 lds
v_mfma_f32_16x16x32_bf16 v[196:199],v[104:107],v[36:39],v[196:199]
v_mfma_f32_16x16x32_bf16 v[200:203],v[40:43],v[104:107],v[200:203]
s_add_u32 s25,s25,s27
v_mfma_f32_16x16x32_bf16 v[204:207],v[44:47],v[104:107],v[204:207]
v_mfma_f32_16x16x32_bf16 v[208:211],v[48:51],v[104:107],v[208:211]
s_add_u32 m0,s30,122880
v_mfma_f32_16x16x32_bf16 v[212:215],v[52:55],v[104:107],v[212:215]
v_mfma_f32_16x16x32_bf16 v[216:219],v[16:19],v[108:111],v[216:219]
v_mfma_f32_16x16x32_bf16 v[220:223],v[20:23],v[108:111],v[220:223]
ds_read_b128 v[100:103],v115 offset:2048
v_mfma_f32_16x16x32_bf16 v[224:227],v[108:111],v[24:27],v[224:227]
v_mfma_f32_16x16x32_bf16 v[228:231],v[108:111],v[28:31],v[228:231]
v_mfma_f32_16x16x32_bf16 v[232:235],v[108:111],v[32:35],v[232:235]
buffer_load_dwordx4 v136,s[16:19],s26 offen lds
v_mfma_f32_16x16x32_bf16 v[236:239],v[108:111],v[36:39],v[236:239]
v_mfma_f32_16x16x32_bf16 v[240:243],v[40:43],v[108:111],v[240:243]
v_mfma_f32_16x16x32_bf16 v[244:247],v[44:47],v[108:111],v[244:247]
v_mfma_f32_16x16x32_bf16 v[248:251],v[48:51],v[108:111],v[248:251]
s_add_u32 s26,s26,s28
v_mfma_f32_16x16x32_bf16 v[252:255],v[52:55],v[108:111],v[252:255]
s_waitcnt lgkmcnt(1)
v_mfma_f32_16x16x32_bf16 a[0:3],v[56:59],v[96:99],a[0:3]
v_mfma_f32_16x16x32_bf16 a[4:7],v[60:63],v[96:99],a[4:7]
ds_read_b128 v[104:107],v115 offset:4096
v_mfma_f32_16x16x32_bf16 a[8:11],v[96:99],v[64:67],a[8:11]
v_mfma_f32_16x16x32_bf16 a[12:15],v[96:99],v[68:71],a[12:15]
ds_read_b64_tr_b16 v[16:17],v116
v_mfma_f32_16x16x32_bf16 a[16:19],v[96:99],v[72:75],a[16:19]
s_add_u32 m0,s29,126976
v_mfma_f32_16x16x32_bf16 a[20:23],v[96:99],v[76:79],a[20:23]
ds_read_b64_tr_b16 v[18:19],v116 offset:1024
v_mfma_f32_16x16x32_bf16 a[24:27],v[80:83],v[96:99],a[24:27]
v_mfma_f32_16x16x32_bf16 a[28:31],v[84:87],v[96:99],a[28:31]
ds_read_b64_tr_b16 v[20:21],v117
v_mfma_f32_16x16x32_bf16 a[32:35],v[88:91],v[96:99],a[32:35]
buffer_load_dwordx4 v132,s[12:15],s25 offen lds
v_mfma_f32_16x16x32_bf16 a[36:39],v[92:95],v[96:99],a[36:39]
ds_read_b64_tr_b16 v[22:23],v117 offset:1024
s_waitcnt lgkmcnt(5)
v_mfma_f32_16x16x32_bf16 a[40:43],v[56:59],v[100:103],a[40:43]
v_mfma_f32_16x16x32_bf16 a[44:47],v[60:63],v[100:103],a[44:47]
ds_read_b128 v[108:111],v115 offset:6144
v_mfma_f32_16x16x32_bf16 a[48:51],v[100:103],v[64:67],a[48:51]
v_mfma_f32_16x16x32_bf16 a[52:55],v[100:103],v[68:71],a[52:55]
ds_read_b64_tr_b16 v[24:25],v120 offset:4096
v_mfma_f32_16x16x32_bf16 a[56:59],v[100:103],v[72:75],a[56:59]
v_mfma_f32_16x16x32_bf16 a[60:63],v[100:103],v[76:79],a[60:63]
ds_read_b64_tr_b16 v[26:27],v120 offset:5120
v_mfma_f32_16x16x32_bf16 a[64:67],v[80:83],v[100:103],a[64:67]
v_mfma_f32_16x16x32_bf16 a[68:71],v[84:87],v[100:103],a[68:71]
ds_read_b64_tr_b16 v[28:29],v121 offset:4096
v_mfma_f32_16x16x32_bf16 a[72:75],v[88:91],v[100:103],a[72:75]
buffer_load_dwordx4 v133,s[12:15],s25 offen offset:1024 lds
v_mfma_f32_16x16x32_bf16 a[76:79],v[92:95],v[100:103],a[76:79]
ds_read_b64_tr_b16 v[30:31],v121 offset:5120
s_waitcnt lgkmcnt(9)
v_mfma_f32_16x16x32_bf16 a[80:83],v[56:59],v[104:107],a[80:83]
v_mfma_f32_16x16x32_bf16 a[84:87],v[60:63],v[104:107],a[84:87]
ds_read_b128 v[96:99],v115 offset:8192
v_mfma_f32_16x16x32_bf16 a[88:91],v[104:107],v[64:67],a[88:91]
v_mfma_f32_16x16x32_bf16 a[92:95],v[104:107],v[68:71],a[92:95]
ds_read_b64_tr_b16 v[32:33],v122 offset:4096
v_mfma_f32_16x16x32_bf16 a[96:99],v[104:107],v[72:75],a[96:99]
v_mfma_f32_16x16x32_bf16 a[100:103],v[104:107],v[76:79],a[100:103]
ds_read_b64_tr_b16 v[34:35],v122 offset:5120
v_mfma_f32_16x16x32_bf16 a[104:107],v[80:83],v[104:107],a[104:107]
v_mfma_f32_16x16x32_bf16 a[108:111],v[84:87],v[104:107],a[108:111]
ds_read_b64_tr_b16 v[36:37],v123 offset:4096
v_mfma_f32_16x16x32_bf16 a[112:115],v[88:91],v[104:107],a[112:115]
buffer_load_dwordx4 v134,s[12:15],s25 offen offset:2048 lds
v_mfma_f32_16x16x32_bf16 a[116:119],v[92:95],v[104:107],a[116:119]
ds_read_b64_tr_b16 v[38:39],v123 offset:5120
s_waitcnt lgkmcnt(9)
v_mfma_f32_16x16x32_bf16 a[120:123],v[56:59],v[108:111],a[120:123]
v_mfma_f32_16x16x32_bf16 a[124:127],v[60:63],v[108:111],a[124:127]
ds_read_b128 v[100:103],v115 offset:10240
v_mfma_f32_16x16x32_bf16 a[128:131],v[108:111],v[64:67],a[128:131]
v_mfma_f32_16x16x32_bf16 a[132:135],v[108:111],v[68:71],a[132:135]
ds_read_b64_tr_b16 v[40:41],v116 offset:12288
v_mfma_f32_16x16x32_bf16 a[136:139],v[108:111],v[72:75],a[136:139]
v_mfma_f32_16x16x32_bf16 a[140:143],v[108:111],v[76:79],a[140:143]
ds_read_b64_tr_b16 v[42:43],v116 offset:13312
v_mfma_f32_16x16x32_bf16 a[144:147],v[80:83],v[108:111],a[144:147]
v_mfma_f32_16x16x32_bf16 a[148:151],v[84:87],v[108:111],a[148:151]
ds_read_b64_tr_b16 v[44:45],v117 offset:12288
v_mfma_f32_16x16x32_bf16 a[152:155],v[88:91],v[108:111],a[152:155]
buffer_load_dwordx4 v135,s[12:15],s25 offen offset:3072 lds
v_mfma_f32_16x16x32_bf16 a[156:159],v[92:95],v[108:111],a[156:159]
ds_read_b64_tr_b16 v[46:47],v117 offset:13312
s_waitcnt lgkmcnt(9)
v_mfma_f32_16x16x32_bf16 a[160:163],v[56:59],v[96:99],a[160:163]
s_add_u32 s25,s25,s27
v_mfma_f32_16x16x32_bf16 a[164:167],v[60:63],v[96:99],a[164:167]
ds_read_b128 v[104:107],v115 offset:12288
v_mfma_f32_16x16x32_bf16 a[168:171],v[96:99],v[64:67],a[168:171]
v_mfma_f32_16x16x32_bf16 a[172:175],v[96:99],v[68:71],a[172:175]
ds_read_b64_tr_b16 v[48:49],v116 offset:16384
v_mfma_f32_16x16x32_bf16 a[176:179],v[96:99],v[72:75],a[176:179]
s_add_u32 m0,s30,143360
v_mfma_f32_16x16x32_bf16 a[180:183],v[96:99],v[76:79],a[180:183]
ds_read_b64_tr_b16 v[50:51],v116 offset:17408
v_mfma_f32_16x16x32_bf16 a[184:187],v[80:83],v[96:99],a[184:187]
v_mfma_f32_16x16x32_bf16 a[188:191],v[84:87],v[96:99],a[188:191]
ds_read_b64_tr_b16 v[52:53],v117 offset:16384
v_mfma_f32_16x16x32_bf16 a[192:195],v[88:91],v[96:99],a[192:195]
buffer_load_dwordx4 v136,s[16:19],s26 offen lds
v_mfma_f32_16x16x32_bf16 a[196:199],v[92:95],v[96:99],a[196:199]
ds_read_b64_tr_b16 v[54:55],v117 offset:17408
s_waitcnt lgkmcnt(9)
v_mfma_f32_16x16x32_bf16 a[200:203],v[56:59],v[100:103],a[200:203]
s_add_u32 s26,s26,s28
v_mfma_f32_16x16x32_bf16 a[204:207],v[60:63],v[100:103],a[204:207]
ds_read_b128 v[108:111],v115 offset:14336
v_mfma_f32_16x16x32_bf16 a[208:211],v[100:103],v[64:67],a[208:211]
s_cbranch_vccnz .Lcs35
v_smfmac_f32_16x16x64_bf16 v[144:147],v[164:167],v[56:63],v143
v_smfmac_f32_16x16x64_bf16 v[148:151],v[164:167],v[64:71],v143
v_smfmac_f32_16x16x64_bf16 v[152:155],v[164:167],v[72:79],v143
s_branch .Lce35
.Lcs35:
v_smfmac_f32_16x16x64_bf16 v[156:159],v[164:167],v[80:87],v143
v_smfmac_f32_16x16x64_bf16 v[160:163],v[164:167],v[88:95],v143
.Lce35:
v_mfma_f32_16x16x32_bf16 a[212:215],v[100:103],v[68:71],a[212:215]
v_mfma_f32_16x16x32_bf16 a[216:219],v[100:103],v[72:75],a[216:219]
v_mfma_f32_16x16x32_bf16 a[220:223],v[100:103],v[76:79],a[220:223]
v_mfma_f32_16x16x32_bf16 a[224:227],v[80:83],v[100:103],a[224:227]
v_mfma_f32_16x16x32_bf16 a[228:231],v[84:87],v[100:103],a[228:231]
v_mfma_f32_16x16x32_bf16 a[232:235],v[88:91],v[100:103],a[232:235]
s_waitcnt vmcnt(10) lgkmcnt(0)
s_barrier
v_mfma_f32_16x16x32_bf16 a[236:239],v[92:95],v[100:103],a[236:239]
s_add_u32 m0,s33,32768
v_mfma_f32_16x16x32_bf16 a[240:243],v[56:59],v[104:107],a[240:243]
buffer_load_dwordx4 v128,s[8:11],s24 offen lds
v_mfma_f32_16x16x32_bf16 a[244:247],v[60:63],v[104:107],a[244:247]
ds_read_b128 v[96:99],v112
v_mfma_f32_16x16x32_bf16 a[248:251],v[104:107],v[64:67],a[248:251]
v_mfma_f32_16x16x32_bf16 a[252:255],v[104:107],v[68:71],a[252:255]
v_mfma_f32_16x16x32_bf16 v[192:195],v[104:107],v[72:75],v[192:195]
v_mfma_f32_16x16x32_bf16 v[196:199],v[104:107],v[76:79],v[196:199]
v_mfma_f32_16x16x32_bf16 v[200:203],v[80:83],v[104:107],v[200:203]
v_mfma_f32_16x16x32_bf16 v[204:207],v[84:87],v[104:107],v[204:207]
v_mfma_f32_16x16x32_bf16 v[208:211],v[88:91],v[104:107],v[208:211]
buffer_load_dwordx4 v129,s[8:11],s24 offen offset:1024 lds
v_mfma_f32_16x16x32_bf16 v[212:215],v[92:95],v[104:107],v[212:215]
v_mfma_f32_16x16x32_bf16 v[216:219],v[56:59],v[108:111],v[216:219]
v_mfma_f32_16x16x32_bf16 v[220:223],v[60:63],v[108:111],v[220:223]
ds_read_b128 v[100:103],v112 offset:2048
v_mfma_f32_16x16x32_bf16 v[224:227],v[108:111],v[64:67],v[224:227]
v_mfma_f32_16x16x32_bf16 v[228:231],v[108:111],v[68:71],v[228:231]
v_mfma_f32_16x16x32_bf16 v[232:235],v[108:111],v[72:75],v[232:235]
v_mfma_f32_16x16x32_bf16 v[236:239],v[108:111],v[76:79],v[236:239]
v_mfma_f32_16x16x32_bf16 v[240:243],v[80:83],v[108:111],v[240:243]
buffer_load_dwordx4 v130,s[8:11],s24 offen offset:2048 lds
v_mfma_f32_16x16x32_bf16 v[244:247],v[84:87],v[108:111],v[244:247]
v_mfma_f32_16x16x32_bf16 v[248:251],v[88:91],v[108:111],v[248:251]
v_mfma_f32_16x16x32_bf16 v[252:255],v[92:95],v[108:111],v[252:255]
s_cmp_eq_u32 s50,5
s_cbranch_scc1 L_lendB
L_pubB:
v_add_f32 v184,v144,v145
v_add_f32 v185,v146,v147
v_add_f32 v186,v148,v149
v_add_f32 v187,v150,v151
v_add_f32 v188,v152,v153
v_add_f32 v189,v154,v155
v_add_f32 v3,v156,v157
v_add_f32 v4,v158,v159
v_add_f32 v5,v160,v161
v_add_f32 v6,v162,v163
v_add_f32 v184,v184,v3
v_add_f32 v185,v185,v4
v_add_f32 v186,v186,v5
v_add_f32 v187,v187,v6
v_lshlrev_b32 v3,5,v2
s_mov_b64 exec,0xffff
buffer_store_dwordx4 v[184:187],v3,s[20:23],s43 offen sc1
buffer_store_dwordx2 v[188:189],v3,s[20:23],s43 offen offset:16 sc1
s_mov_b64 exec,-1
s_add_u32 s50,s50,1
s_mov_b32 s59,5
s_cmp_eq_u32 s50,5
s_cbranch_scc1 L_bxB
s_branch L_loopB
L_lendB:
s_waitcnt lgkmcnt(1)
v_mfma_f32_16x16x32_bf16 a[0:3],v[16:19],v[96:99],a[0:3]
v_min_u32 v169,7,v2
v_lshlrev_b32 v169,2,v169
v_mfma_f32_16x16x32_bf16 a[4:7],v[20:23],v[96:99],a[4:7]
ds_read_b128 v[104:107],v112 offset:4096
buffer_load_dword v168,v169,s[52:55],0 offen sc1
v_mfma_f32_16x16x32_bf16 a[8:11],v[96:99],v[24:27],a[8:11]
s_lshl_b32 s48,s34,7
s_add_u32 s48,s48,0x2701800
v_mfma_f32_16x16x32_bf16 a[12:15],v[96:99],v[28:31],a[12:15]
ds_read_b64_tr_b16 v[56:57],v116 offset:20480
v_lshl_add_u32 v171,v2,2,s48
v_mfma_f32_16x16x32_bf16 a[16:19],v[96:99],v[32:35],a[16:19]
buffer_load_dwordx4 v131,s[8:11],s24 offen offset:3072 lds
v_mfma_f32_16x16x32_bf16 a[20:23],v[96:99],v[36:39],a[20:23]
ds_read_b64_tr_b16 v[58:59],v116 offset:21504
s_lshl_b32 s48,s35,5
v_mfma_f32_16x16x32_bf16 a[24:27],v[40:43],v[96:99],a[24:27]
s_add_u32 s48,s48,0x2701b80
v_min_u32 v170,36,v2
v_mfma_f32_16x16x32_bf16 a[28:31],v[44:47],v[96:99],a[28:31]
ds_read_b64_tr_b16 v[60:61],v117 offset:20480
v_lshl_add_u32 v170,v170,2,s48
v_mfma_f32_16x16x32_bf16 a[32:35],v[48:51],v[96:99],a[32:35]
s_add_u32 m0,s33,36864
v_cmp_gt_u32 s[48:49],32,v2
v_mfma_f32_16x16x32_bf16 a[36:39],v[52:55],v[96:99],a[36:39]
ds_read_b64_tr_b16 v[62:63],v117 offset:21504
s_waitcnt lgkmcnt(5)
v_mfma_f32_16x16x32_bf16 a[40:43],v[16:19],v[100:103],a[40:43]
s_nop 1
v_cndmask_b32 v171,v170,v171,s[48:49]
v_mfma_f32_16x16x32_bf16 a[44:47],v[20:23],v[100:103],a[44:47]
ds_read_b128 v[108:111],v112 offset:6144
v_mfma_f32_16x16x32_bf16 a[48:51],v[100:103],v[24:27],a[48:51]
v_mfma_f32_16x16x32_bf16 a[52:55],v[100:103],v[28:31],a[52:55]
ds_read_b64_tr_b16 v[64:65],v120 offset:24576
v_mfma_f32_16x16x32_bf16 a[56:59],v[100:103],v[32:35],a[56:59]
buffer_load_dwordx4 v128,s[8:11],s32 offen lds
v_mfma_f32_16x16x32_bf16 a[60:63],v[100:103],v[36:39],a[60:63]
ds_read_b64_tr_b16 v[66:67],v120 offset:25600
v_mfma_f32_16x16x32_bf16 a[64:67],v[40:43],v[100:103],a[64:67]
v_mfma_f32_16x16x32_bf16 a[68:71],v[44:47],v[100:103],a[68:71]
ds_read_b64_tr_b16 v[68:69],v121 offset:24576
v_mfma_f32_16x16x32_bf16 a[72:75],v[48:51],v[100:103],a[72:75]
v_mfma_f32_16x16x32_bf16 a[76:79],v[52:55],v[100:103],a[76:79]
ds_read_b64_tr_b16 v[70:71],v121 offset:25600
s_waitcnt lgkmcnt(9)
v_mfma_f32_16x16x32_bf16 a[80:83],v[16:19],v[104:107],a[80:83]
buffer_load_dwordx4 v129,s[8:11],s32 offen offset:1024 lds
v_mfma_f32_16x16x32_bf16 a[84:87],v[20:23],v[104:107],a[84:87]
ds_read_b128 v[96:99],v112 offset:8192
v_mfma_f32_16x16x32_bf16 a[88:91],v[104:107],v[24:27],a[88:91]
buffer_load_dword v139,v138,s[68:71],s73 offen
v_mfma_f32_16x16x32_bf16 a[92:95],v[104:107],v[28:31],a[92:95]
ds_read_b64_tr_b16 v[72:73],v122 offset:24576
v_mfma_f32_16x16x32_bf16 a[96:99],v[104:107],v[32:35],a[96:99]
v_mfma_f32_16x16x32_bf16 a[100:103],v[104:107],v[36:39],a[100:103]
ds_read_b64_tr_b16 v[74:75],v122 offset:25600
v_mfma_f32_16x16x32_bf16 a[104:107],v[40:43],v[104:107],a[104:107]
v_mfma_f32_16x16x32_bf16 a[108:111],v[44:47],v[104:107],a[108:111]
ds_read_b64_tr_b16 v[76:77],v123 offset:24576
v_mfma_f32_16x16x32_bf16 a[112:115],v[48:51],v[104:107],a[112:115]
buffer_load_dwordx4 v130,s[8:11],s32 offen offset:2048 lds
v_mfma_f32_16x16x32_bf16 a[116:119],v[52:55],v[104:107],a[116:119]
ds_read_b64_tr_b16 v[78:79],v123 offset:25600
s_waitcnt lgkmcnt(9)
v_mfma_f32_16x16x32_bf16 a[120:123],v[16:19],v[108:111],a[120:123]
v_mfma_f32_16x16x32_bf16 a[124:127],v[20:23],v[108:111],a[124:127]
ds_read_b128 v[100:103],v112 offset:10240
v_mfma_f32_16x16x32_bf16 a[128:131],v[108:111],v[24:27],a[128:131]
v_mfma_f32_16x16x32_bf16 a[132:135],v[108:111],v[28:31],a[132:135]
ds_read_b64_tr_b16 v[80:81],v116 offset:32768
v_mfma_f32_16x16x32_bf16 a[136:139],v[108:111],v[32:35],a[136:139]
buffer_load_dwordx4 v131,s[8:11],s32 offen offset:3072 lds
v_mfma_f32_16x16x32_bf16 a[140:143],v[108:111],v[36:39],a[140:143]
ds_read_b64_tr_b16 v[82:83],v116 offset:33792
v_mfma_f32_16x16x32_bf16 a[144:147],v[40:43],v[108:111],a[144:147]
v_mfma_f32_16x16x32_bf16 a[148:151],v[44:47],v[108:111],a[148:151]
ds_read_b64_tr_b16 v[84:85],v117 offset:32768
v_mfma_f32_16x16x32_bf16 a[152:155],v[48:51],v[108:111],a[152:155]
s_add_u32 s24,s24,128
v_mfma_f32_16x16x32_bf16 a[156:159],v[52:55],v[108:111],a[156:159]
ds_read_b64_tr_b16 v[86:87],v117 offset:33792
s_waitcnt lgkmcnt(9)
v_mfma_f32_16x16x32_bf16 a[160:163],v[16:19],v[96:99],a[160:163]
s_add_u32 s32,s32,128
v_mfma_f32_16x16x32_bf16 a[164:167],v[20:23],v[96:99],a[164:167]
ds_read_b128 v[104:107],v112 offset:12288
v_mfma_f32_16x16x32_bf16 a[168:171],v[96:99],v[24:27],a[168:171]
s_add_u32 m0,s29,65536
v_mfma_f32_16x16x32_bf16 a[172:175],v[96:99],v[28:31],a[172:175]
ds_read_b64_tr_b16 v[88:89],v116 offset:36864
v_mfma_f32_16x16x32_bf16 a[176:179],v[96:99],v[32:35],a[176:179]
buffer_load_dwordx4 v132,s[12:15],s25 offen lds
v_mfma_f32_16x16x32_bf16 a[180:183],v[96:99],v[36:39],a[180:183]
ds_read_b64_tr_b16 v[90:91],v116 offset:37888
v_mfma_f32_16x16x32_bf16 a[184:187],v[40:43],v[96:99],a[184:187]
v_mfma_f32_16x16x32_bf16 a[188:191],v[44:47],v[96:99],a[188:191]
ds_read_b64_tr_b16 v[92:93],v117 offset:36864
v_mfma_f32_16x16x32_bf16 a[192:195],v[48:51],v[96:99],a[192:195]
v_mfma_f32_16x16x32_bf16 a[196:199],v[52:55],v[96:99],a[196:199]
ds_read_b64_tr_b16 v[94:95],v117 offset:37888
s_waitcnt lgkmcnt(9)
v_mfma_f32_16x16x32_bf16 a[200:203],v[16:19],v[100:103],a[200:203]
buffer_load_dwordx4 v133,s[12:15],s25 offen offset:1024 lds
v_mfma_f32_16x16x32_bf16 a[204:207],v[20:23],v[100:103],a[204:207]
ds_read_b128 v[108:111],v112 offset:14336
v_mfma_f32_16x16x32_bf16 a[208:211],v[100:103],v[24:27],a[208:211]
s_cbranch_vccnz .Lcs36
v_smfmac_f32_16x16x64_bf16 v[144:147],v[164:167],v[16:23],v143
v_smfmac_f32_16x16x64_bf16 v[148:151],v[164:167],v[24:31],v143
v_smfmac_f32_16x16x64_bf16 v[152:155],v[164:167],v[32:39],v143
s_branch .Lce36
.Lcs36:
v_smfmac_f32_16x16x64_bf16 v[156:159],v[164:167],v[40:47],v143
v_smfmac_f32_16x16x64_bf16 v[160:163],v[164:167],v[48:55],v143
.Lce36:
v_mfma_f32_16x16x32_bf16 a[212:215],v[100:103],v[28:31],a[212:215]
v_mfma_f32_16x16x32_bf16 a[216:219],v[100:103],v[32:35],a[216:219]
v_mfma_f32_16x16x32_bf16 a[220:223],v[100:103],v[36:39],a[220:223]
v_mfma_f32_16x16x32_bf16 a[224:227],v[40:43],v[100:103],a[224:227]
buffer_load_dwordx4 v134,s[12:15],s25 offen offset:2048 lds
v_mfma_f32_16x16x32_bf16 a[228:231],v[44:47],v[100:103],a[228:231]
v_mfma_f32_16x16x32_bf16 a[232:235],v[48:51],v[100:103],a[232:235]
s_waitcnt vmcnt(18) lgkmcnt(0)
s_barrier
v_mfma_f32_16x16x32_bf16 a[236:239],v[52:55],v[100:103],a[236:239]
v_mfma_f32_16x16x32_bf16 a[240:243],v[16:19],v[104:107],a[240:243]
v_mfma_f32_16x16x32_bf16 a[244:247],v[20:23],v[104:107],a[244:247]
ds_read_b128 v[96:99],v113
v_mfma_f32_16x16x32_bf16 a[248:251],v[104:107],v[24:27],a[248:251]
v_mfma_f32_16x16x32_bf16 a[252:255],v[104:107],v[28:31],a[252:255]
v_mfma_f32_16x16x32_bf16 v[192:195],v[104:107],v[32:35],v[192:195]
buffer_load_dwordx4 v135,s[12:15],s25 offen offset:3072 lds
v_mfma_f32_16x16x32_bf16 v[196:199],v[104:107],v[36:39],v[196:199]
v_mfma_f32_16x16x32_bf16 v[200:203],v[40:43],v[104:107],v[200:203]
s_add_u32 s25,s25,s27
v_mfma_f32_16x16x32_bf16 v[204:207],v[44:47],v[104:107],v[204:207]
v_mfma_f32_16x16x32_bf16 v[208:211],v[48:51],v[104:107],v[208:211]
s_add_u32 m0,s30,81920
v_mfma_f32_16x16x32_bf16 v[212:215],v[52:55],v[104:107],v[212:215]
v_mfma_f32_16x16x32_bf16 v[216:219],v[16:19],v[108:111],v[216:219]
v_mfma_f32_16x16x32_bf16 v[220:223],v[20:23],v[108:111],v[220:223]
ds_read_b128 v[100:103],v113 offset:2048
v_mfma_f32_16x16x32_bf16 v[224:227],v[108:111],v[24:27],v[224:227]
v_mfma_f32_16x16x32_bf16 v[228:231],v[108:111],v[28:31],v[228:231]
v_mfma_f32_16x16x32_bf16 v[232:235],v[108:111],v[32:35],v[232:235]
buffer_load_dwordx4 v136,s[16:19],s26 offen lds
v_mfma_f32_16x16x32_bf16 v[236:239],v[108:111],v[36:39],v[236:239]
v_mfma_f32_16x16x32_bf16 v[240:243],v[40:43],v[108:111],v[240:243]
v_mfma_f32_16x16x32_bf16 v[244:247],v[44:47],v[108:111],v[244:247]
v_mfma_f32_16x16x32_bf16 v[248:251],v[48:51],v[108:111],v[248:251]
s_add_u32 s26,s26,s28
v_mfma_f32_16x16x32_bf16 v[252:255],v[52:55],v[108:111],v[252:255]
s_waitcnt lgkmcnt(1)
v_mfma_f32_16x16x32_bf16 a[0:3],v[56:59],v[96:99],a[0:3]
v_mfma_f32_16x16x32_bf16 a[4:7],v[60:63],v[96:99],a[4:7]
ds_read_b128 v[104:107],v113 offset:4096
v_mfma_f32_16x16x32_bf16 a[8:11],v[96:99],v[64:67],a[8:11]
v_mfma_f32_16x16x32_bf16 a[12:15],v[96:99],v[68:71],a[12:15]
ds_read_b64_tr_b16 v[16:17],v116 offset:40960
v_mfma_f32_16x16x32_bf16 a[16:19],v[96:99],v[72:75],a[16:19]
s_add_u32 m0,s29,86016
v_mfma_f32_16x16x32_bf16 a[20:23],v[96:99],v[76:79],a[20:23]
ds_read_b64_tr_b16 v[18:19],v116 offset:41984
v_mfma_f32_16x16x32_bf16 a[24:27],v[80:83],v[96:99],a[24:27]
v_mfma_f32_16x16x32_bf16 a[28:31],v[84:87],v[96:99],a[28:31]
ds_read_b64_tr_b16 v[20:21],v117 offset:40960
v_mfma_f32_16x16x32_bf16 a[32:35],v[88:91],v[96:99],a[32:35]
buffer_load_dwordx4 v132,s[12:15],s25 offen lds
v_mfma_f32_16x16x32_bf16 a[36:39],v[92:95],v[96:99],a[36:39]
ds_read_b64_tr_b16 v[22:23],v117 offset:41984
s_waitcnt lgkmcnt(5)
v_mfma_f32_16x16x32_bf16 a[40:43],v[56:59],v[100:103],a[40:43]
v_mfma_f32_16x16x32_bf16 a[44:47],v[60:63],v[100:103],a[44:47]
ds_read_b128 v[108:111],v113 offset:6144
v_mfma_f32_16x16x32_bf16 a[48:51],v[100:103],v[64:67],a[48:51]
v_mfma_f32_16x16x32_bf16 a[52:55],v[100:103],v[68:71],a[52:55]
ds_read_b64_tr_b16 v[24:25],v120 offset:45056
v_mfma_f32_16x16x32_bf16 a[56:59],v[100:103],v[72:75],a[56:59]
v_mfma_f32_16x16x32_bf16 a[60:63],v[100:103],v[76:79],a[60:63]
ds_read_b64_tr_b16 v[26:27],v120 offset:46080
v_mfma_f32_16x16x32_bf16 a[64:67],v[80:83],v[100:103],a[64:67]
v_mfma_f32_16x16x32_bf16 a[68:71],v[84:87],v[100:103],a[68:71]
ds_read_b64_tr_b16 v[28:29],v121 offset:45056
v_mfma_f32_16x16x32_bf16 a[72:75],v[88:91],v[100:103],a[72:75]
buffer_load_dwordx4 v133,s[12:15],s25 offen offset:1024 lds
v_mfma_f32_16x16x32_bf16 a[76:79],v[92:95],v[100:103],a[76:79]
ds_read_b64_tr_b16 v[30:31],v121 offset:46080
s_waitcnt lgkmcnt(9)
v_mfma_f32_16x16x32_bf16 a[80:83],v[56:59],v[104:107],a[80:83]
v_mfma_f32_16x16x32_bf16 a[84:87],v[60:63],v[104:107],a[84:87]
ds_read_b128 v[96:99],v113 offset:8192
v_mfma_f32_16x16x32_bf16 a[88:91],v[104:107],v[64:67],a[88:91]
v_mfma_f32_16x16x32_bf16 a[92:95],v[104:107],v[68:71],a[92:95]
ds_read_b64_tr_b16 v[32:33],v122 offset:45056
v_mfma_f32_16x16x32_bf16 a[96:99],v[104:107],v[72:75],a[96:99]
v_mfma_f32_16x16x32_bf16 a[100:103],v[104:107],v[76:79],a[100:103]
ds_read_b64_tr_b16 v[34:35],v122 offset:46080
v_mfma_f32_16x16x32_bf16 a[104:107],v[80:83],v[104:107],a[104:107]
v_mfma_f32_16x16x32_bf16 a[108:111],v[84:87],v[104:107],a[108:111]
ds_read_b64_tr_b16 v[36:37],v123 offset:45056
v_mfma_f32_16x16x32_bf16 a[112:115],v[88:91],v[104:107],a[112:115]
buffer_load_dwordx4 v134,s[12:15],s25 offen offset:2048 lds
v_mfma_f32_16x16x32_bf16 a[116:119],v[92:95],v[104:107],a[116:119]
ds_read_b64_tr_b16 v[38:39],v123 offset:46080
s_waitcnt lgkmcnt(9)
v_mfma_f32_16x16x32_bf16 a[120:123],v[56:59],v[108:111],a[120:123]
s_waitcnt vmcnt(14)
s_mov_b32 s75,0x40000
L_zB_chk:
v_cmp_le_u32 s[48:49],32,v168
s_sub_u32 s75,s75,1
s_cbranch_scc1 L_zB_ok
s_nop 1
s_cmp_eq_u64 s[48:49],-1
s_cbranch_scc1 L_zB_ok
s_sleep 4
buffer_load_dword v168,v169,s[52:55],0 offen sc1
s_waitcnt vmcnt(0)
s_branch L_zB_chk
L_zB_ok:
buffer_load_dword v168,v171,s[20:23],0 offen sc1
v_mfma_f32_16x16x32_bf16 a[124:127],v[60:63],v[108:111],a[124:127]
ds_read_b128 v[100:103],v113 offset:10240
s_lshl_b32 s44,s31,13
v_mfma_f32_16x16x32_bf16 a[128:131],v[108:111],v[64:67],a[128:131]
s_lshl_b32 s45,s34,10
s_add_u32 s44,s44,s45
v_mfma_f32_16x16x32_bf16 a[132:135],v[108:111],v[68:71],a[132:135]
ds_read_b64_tr_b16 v[40:41],v116 offset:53248
s_add_u32 s44,s44,0x2710000
v_mfma_f32_16x16x32_bf16 a[136:139],v[108:111],v[72:75],a[136:139]
s_lshl_b32 s45,s34,11
s_sub_u32 s45,s43,s45
v_mfma_f32_16x16x32_bf16 a[140:143],v[108:111],v[76:79],a[140:143]
ds_read_b64_tr_b16 v[42:43],v116 offset:54272
v_and_b32 v172,15,v2
v_mfma_f32_16x16x32_bf16 a[144:147],v[80:83],v[108:111],a[144:147]
v_lshrrev_b32 v173,4,v2
v_lshlrev_b32 v174,5,v172
v_mfma_f32_16x16x32_bf16 a[148:151],v[84:87],v[108:111],a[148:151]
ds_read_b64_tr_b16 v[44:45],v117 offset:53248
v_lshl_add_u32 v174,v173,3,v174
v_mfma_f32_16x16x32_bf16 a[152:155],v[88:91],v[108:111],a[152:155]
buffer_load_dwordx4 v135,s[12:15],s25 offen offset:3072 lds
v_mfma_f32_16x16x32_bf16 a[156:159],v[92:95],v[108:111],a[156:159]
ds_read_b64_tr_b16 v[46:47],v117 offset:54272
s_waitcnt lgkmcnt(9)
v_mfma_f32_16x16x32_bf16 a[160:163],v[56:59],v[96:99],a[160:163]
s_add_u32 s25,s25,s27
s_mul_i32 s46,s31,768
v_mfma_f32_16x16x32_bf16 a[164:167],v[60:63],v[96:99],a[164:167]
ds_read_b128 v[104:107],v113 offset:12288
s_add_u32 s46,s46,150528
v_mfma_f32_16x16x32_bf16 a[168:171],v[96:99],v[64:67],a[168:171]
v_lshl_add_u32 v172,v172,2,s46
v_lshl_add_u32 v173,v173,7,v172
v_mfma_f32_16x16x32_bf16 a[172:175],v[96:99],v[68:71],a[172:175]
ds_read_b64_tr_b16 v[48:49],v116 offset:57344
v_mfma_f32_16x16x32_bf16 a[176:179],v[96:99],v[72:75],a[176:179]
s_add_u32 m0,s30,102400
v_mfma_f32_16x16x32_bf16 a[180:183],v[96:99],v[76:79],a[180:183]
ds_read_b64_tr_b16 v[50:51],v116 offset:58368
v_mfma_f32_16x16x32_bf16 a[184:187],v[80:83],v[96:99],a[184:187]
v_mfma_f32_16x16x32_bf16 a[188:191],v[84:87],v[96:99],a[188:191]
ds_read_b64_tr_b16 v[52:53],v117 offset:57344
v_mfma_f32_16x16x32_bf16 a[192:195],v[88:91],v[96:99],a[192:195]
buffer_load_dwordx4 v136,s[16:19],s26 offen lds
v_mfma_f32_16x16x32_bf16 a[196:199],v[92:95],v[96:99],a[196:199]
ds_read_b64_tr_b16 v[54:55],v117 offset:58368
s_waitcnt lgkmcnt(9)
v_mfma_f32_16x16x32_bf16 a[200:203],v[56:59],v[100:103],a[200:203]
s_add_u32 s26,s26,s28
v_mfma_f32_16x16x32_bf16 a[204:207],v[60:63],v[100:103],a[204:207]
ds_read_b128 v[108:111],v113 offset:14336
v_mfma_f32_16x16x32_bf16 a[208:211],v[100:103],v[64:67],a[208:211]
s_cbranch_vccnz .Lcs37
v_smfmac_f32_16x16x64_bf16 v[144:147],v[164:167],v[56:63],v143
v_smfmac_f32_16x16x64_bf16 v[148:151],v[164:167],v[64:71],v143
v_smfmac_f32_16x16x64_bf16 v[152:155],v[164:167],v[72:79],v143
s_branch .Lce37
.Lcs37:
v_smfmac_f32_16x16x64_bf16 v[156:159],v[164:167],v[80:87],v143
v_smfmac_f32_16x16x64_bf16 v[160:163],v[164:167],v[88:95],v143
.Lce37:
v_mfma_f32_16x16x32_bf16 a[212:215],v[100:103],v[68:71],a[212:215]
v_mfma_f32_16x16x32_bf16 a[216:219],v[100:103],v[72:75],a[216:219]
v_mfma_f32_16x16x32_bf16 a[220:223],v[100:103],v[76:79],a[220:223]
v_mfma_f32_16x16x32_bf16 a[224:227],v[80:83],v[100:103],a[224:227]
v_mfma_f32_16x16x32_bf16 a[228:231],v[84:87],v[100:103],a[228:231]
v_mfma_f32_16x16x32_bf16 a[232:235],v[88:91],v[100:103],a[232:235]
s_waitcnt vmcnt(11) lgkmcnt(0)
s_barrier
v_mfma_f32_16x16x32_bf16 a[236:239],v[92:95],v[100:103],a[236:239]
s_add_u32 m0,s33,0
v_mfma_f32_16x16x32_bf16 a[240:243],v[56:59],v[104:107],a[240:243]
buffer_load_dwordx4 v128,s[8:11],s24 offen lds
v_mfma_f32_16x16x32_bf16 a[244:247],v[60:63],v[104:107],a[244:247]
ds_read_b128 v[96:99],v114
v_mfma_f32_16x16x32_bf16 a[248:251],v[104:107],v[64:67],a[248:251]
v_mfma_f32_16x16x32_bf16 a[252:255],v[104:107],v[68:71],a[252:255]
v_mfma_f32_16x16x32_bf16 v[192:195],v[104:107],v[72:75],v[192:195]
v_mfma_f32_16x16x32_bf16 v[196:199],v[104:107],v[76:79],v[196:199]
v_mfma_f32_16x16x32_bf16 v[200:203],v[80:83],v[104:107],v[200:203]
v_mfma_f32_16x16x32_bf16 v[204:207],v[84:87],v[104:107],v[204:207]
v_mfma_f32_16x16x32_bf16 v[208:211],v[88:91],v[104:107],v[208:211]
buffer_load_dwordx4 v129,s[8:11],s24 offen offset:1024 lds
v_mfma_f32_16x16x32_bf16 v[212:215],v[92:95],v[104:107],v[212:215]
v_mfma_f32_16x16x32_bf16 v[216:219],v[56:59],v[108:111],v[216:219]
v_mfma_f32_16x16x32_bf16 v[220:223],v[60:63],v[108:111],v[220:223]
ds_read_b128 v[100:103],v114 offset:2048
v_mfma_f32_16x16x32_bf16 v[224:227],v[108:111],v[64:67],v[224:227]
v_mfma_f32_16x16x32_bf16 v[228:231],v[108:111],v[68:71],v[228:231]
v_mfma_f32_16x16x32_bf16 v[232:235],v[108:111],v[72:75],v[232:235]
v_mfma_f32_16x16x32_bf16 v[236:239],v[108:111],v[76:79],v[236:239]
v_mfma_f32_16x16x32_bf16 v[240:243],v[80:83],v[108:111],v[240:243]
buffer_load_dwordx4 v130,s[8:11],s24 offen offset:2048 lds
v_mfma_f32_16x16x32_bf16 v[244:247],v[84:87],v[108:111],v[244:247]
v_mfma_f32_16x16x32_bf16 v[248:251],v[88:91],v[108:111],v[248:251]
v_mfma_f32_16x16x32_bf16 v[252:255],v[92:95],v[108:111],v[252:255]
s_waitcnt lgkmcnt(1)
v_mfma_f32_16x16x32_bf16 a[0:3],v[16:19],v[96:99],a[0:3]
v_mfma_f32_16x16x32_bf16 a[4:7],v[20:23],v[96:99],a[4:7]
ds_read_b128 v[104:107],v114 offset:4096
v_mfma_f32_16x16x32_bf16 a[8:11],v[96:99],v[24:27],a[8:11]
s_getpc_b64 s[60:61]
.Lct4:
s_add_u32 s60,s60,L_epiB-.Lct4
s_addc_u32 s61,s61,0
v_mfma_f32_16x16x32_bf16 a[12:15],v[96:99],v[28:31],a[12:15]
ds_read_b64_tr_b16 v[56:57],v118
v_mfma_f32_16x16x32_bf16 a[16:19],v[96:99],v[32:35],a[16:19]
buffer_load_dwordx4 v131,s[8:11],s24 offen offset:3072 lds
v_mfma_f32_16x16x32_bf16 a[20:23],v[96:99],v[36:39],a[20:23]
ds_read_b64_tr_b16 v[58:59],v118 offset:1024
v_mfma_f32_16x16x32_bf16 a[24:27],v[40:43],v[96:99],a[24:27]
s_lshr_b32 s62,s2,3
v_mfma_f32_16x16x32_bf16 a[28:31],v[44:47],v[96:99],a[28:31]
ds_read_b64_tr_b16 v[60:61],v119
v_mfma_f32_16x16x32_bf16 a[32:35],v[48:51],v[96:99],a[32:35]
s_add_u32 m0,s33,4096
v_mfma_f32_16x16x32_bf16 a[36:39],v[52:55],v[96:99],a[36:39]
ds_read_b64_tr_b16 v[62:63],v119 offset:1024
s_waitcnt lgkmcnt(5)
v_mfma_f32_16x16x32_bf16 a[40:43],v[16:19],v[100:103],a[40:43]
v_mfma_f32_16x16x32_bf16 a[44:47],v[20:23],v[100:103],a[44:47]
ds_read_b128 v[108:111],v114 offset:6144
v_mfma_f32_16x16x32_bf16 a[48:51],v[100:103],v[24:27],a[48:51]
s_lshl_b32 s62,s62,2
v_mfma_f32_16x16x32_bf16 a[52:55],v[100:103],v[28:31],a[52:55]
ds_read_b64_tr_b16 v[64:65],v124 offset:4096
v_mfma_f32_16x16x32_bf16 a[56:59],v[100:103],v[32:35],a[56:59]
buffer_load_dwordx4 v128,s[8:11],s32 offen lds
v_mfma_f32_16x16x32_bf16 a[60:63],v[100:103],v[36:39],a[60:63]
ds_read_b64_tr_b16 v[66:67],v124 offset:5120
v_mfma_f32_16x16x32_bf16 a[64:67],v[40:43],v[100:103],a[64:67]
s_add_u32 s62,s62,s31
v_mfma_f32_16x16x32_bf16 a[68:71],v[44:47],v[100:103],a[68:71]
ds_read_b64_tr_b16 v[68:69],v125 offset:4096
v_mfma_f32_16x16x32_bf16 a[72:75],v[48:51],v[100:103],a[72:75]
v_mfma_f32_16x16x32_bf16 a[76:79],v[52:55],v[100:103],a[76:79]
ds_read_b64_tr_b16 v[70:71],v125 offset:5120
s_waitcnt lgkmcnt(9)
v_mfma_f32_16x16x32_bf16 a[80:83],v[16:19],v[104:107],a[80:83]
buffer_load_dwordx4 v129,s[8:11],s32 offen offset:1024 lds
v_mfma_f32_16x16x32_bf16 a[84:87],v[20:23],v[104:107],a[84:87]
ds_read_b128 v[96:99],v114 offset:8192
v_mfma_f32_16x16x32_bf16 a[88:91],v[104:107],v[24:27],a[88:91]
s_and_b32 s62,s62,15
v_mfma_f32_16x16x32_bf16 a[92:95],v[104:107],v[28:31],a[92:95]
ds_read_b64_tr_b16 v[72:73],v126 offset:4096
v_mfma_f32_16x16x32_bf16 a[96:99],v[104:107],v[32:35],a[96:99]
v_mfma_f32_16x16x32_bf16 a[100:103],v[104:107],v[36:39],a[100:103]
ds_read_b64_tr_b16 v[74:75],v126 offset:5120
v_mfma_f32_16x16x32_bf16 a[104:107],v[40:43],v[104:107],a[104:107]
s_lshl_b32 s62,s62,7
v_mfma_f32_16x16x32_bf16 a[108:111],v[44:47],v[104:107],a[108:111]
ds_read_b64_tr_b16 v[76:77],v127 offset:4096
v_mfma_f32_16x16x32_bf16 a[112:115],v[48:51],v[104:107],a[112:115]
buffer_load_dwordx4 v130,s[8:11],s32 offen offset:2048 lds
v_mfma_f32_16x16x32_bf16 a[116:119],v[52:55],v[104:107],a[116:119]
ds_read_b64_tr_b16 v[78:79],v127 offset:5120
s_waitcnt lgkmcnt(9)
v_mfma_f32_16x16x32_bf16 a[120:123],v[16:19],v[108:111],a[120:123]
v_mfma_f32_16x16x32_bf16 a[124:127],v[20:23],v[108:111],a[124:127]
ds_read_b128 v[100:103],v114 offset:10240
v_mfma_f32_16x16x32_bf16 a[128:131],v[108:111],v[24:27],a[128:131]
v_lshlrev_b32 v140,11,v2
v_mfma_f32_16x16x32_bf16 a[132:135],v[108:111],v[28:31],a[132:135]
ds_read_b64_tr_b16 v[80:81],v118 offset:12288
v_mfma_f32_16x16x32_bf16 a[136:139],v[108:111],v[32:35],a[136:139]
buffer_load_dwordx4 v131,s[8:11],s32 offen offset:3072 lds
v_mfma_f32_16x16x32_bf16 a[140:143],v[108:111],v[36:39],a[140:143]
ds_read_b64_tr_b16 v[82:83],v118 offset:13312
v_mfma_f32_16x16x32_bf16 a[144:147],v[40:43],v[108:111],a[144:147]
v_add_u32 v140,s62,v140
v_mfma_f32_16x16x32_bf16 a[148:151],v[44:47],v[108:111],a[148:151]
ds_read_b64_tr_b16 v[84:85],v119 offset:12288
v_mfma_f32_16x16x32_bf16 a[152:155],v[48:51],v[108:111],a[152:155]
s_add_u32 s24,s24,128
v_mfma_f32_16x16x32_bf16 a[156:159],v[52:55],v[108:111],a[156:159]
ds_read_b64_tr_b16 v[86:87],v119 offset:13312
s_waitcnt lgkmcnt(9)
v_mfma_f32_16x16x32_bf16 a[160:163],v[16:19],v[96:99],a[160:163]
s_add_u32 s32,s32,128
v_mfma_f32_16x16x32_bf16 a[164:167],v[20:23],v[96:99],a[164:167]
ds_read_b128 v[104:107],v114 offset:12288
v_mfma_f32_16x16x32_bf16 a[168:171],v[96:99],v[24:27],a[168:171]
s_add_u32 m0,s29,106496
v_mfma_f32_16x16x32_bf16 a[172:175],v[96:99],v[28:31],a[172:175]
ds_read_b64_tr_b16 v[88:89],v118 offset:16384
v_mfma_f32_16x16x32_bf16 a[176:179],v[96:99],v[32:35],a[176:179]
buffer_load_dwordx4 v132,s[12:15],s25 offen lds
v_mfma_f32_16x16x32_bf16 a[180:183],v[96:99],v[36:39],a[180:183]
ds_read_b64_tr_b16 v[90:91],v118 offset:17408
v_mfma_f32_16x16x32_bf16 a[184:187],v[40:43],v[96:99],a[184:187]
v_min_u32 v140,L_atfin-L_epiB-4,v140
v_mfma_f32_16x16x32_bf16 a[188:191],v[44:47],v[96:99],a[188:191]
ds_read_b64_tr_b16 v[92:93],v119 offset:16384
v_mfma_f32_16x16x32_bf16 a[192:195],v[48:51],v[96:99],a[192:195]
v_mfma_f32_16x16x32_bf16 a[196:199],v[52:55],v[96:99],a[196:199]
ds_read_b64_tr_b16 v[94:95],v119 offset:17408
s_waitcnt lgkmcnt(9)
v_mfma_f32_16x16x32_bf16 a[200:203],v[16:19],v[100:103],a[200:203]
buffer_load_dwordx4 v133,s[12:15],s25 offen offset:1024 lds
v_mfma_f32_16x16x32_bf16 a[204:207],v[20:23],v[100:103],a[204:207]
ds_read_b128 v[108:111],v114 offset:14336
v_mfma_f32_16x16x32_bf16 a[208:211],v[100:103],v[24:27],a[208:211]
s_cbranch_vccnz .Lcs38
v_smfmac_f32_16x16x64_bf16 v[144:147],v[164:167],v[16:23],v143
v_smfmac_f32_16x16x64_bf16 v[148:151],v[164:167],v[24:31],v143
v_smfmac_f32_16x16x64_bf16 v[152:155],v[164:167],v[32:39],v143
s_branch .Lce38
.Lcs38:
v_smfmac_f32_16x16x64_bf16 v[156:159],v[164:167],v[40:47],v143
v_smfmac_f32_16x16x64_bf16 v[160:163],v[164:167],v[48:55],v143
.Lce38:
v_mfma_f32_16x16x32_bf16 a[212:215],v[100:103],v[28:31],a[212:215]
v_mfma_f32_16x16x32_bf16 a[216:219],v[100:103],v[32:35],a[216:219]
v_mfma_f32_16x16x32_bf16 a[220:223],v[100:103],v[36:39],a[220:223]
v_mfma_f32_16x16x32_bf16 a[224:227],v[40:43],v[100:103],a[224:227]
buffer_load_dwordx4 v134,s[12:15],s25 offen offset:2048 lds
v_mfma_f32_16x16x32_bf16 a[228:231],v[44:47],v[100:103],a[228:231]
v_mfma_f32_16x16x32_bf16 a[232:235],v[48:51],v[100:103],a[232:235]
s_waitcnt vmcnt(17) lgkmcnt(0)
s_barrier
v_mfma_f32_16x16x32_bf16 a[236:239],v[52:55],v[100:103],a[236:239]
v_mfma_f32_16x16x32_bf16 a[240:243],v[16:19],v[104:107],a[240:243]
v_mfma_f32_16x16x32_bf16 a[244:247],v[20:23],v[104:107],a[244:247]
ds_read_b128 v[96:99],v115
v_mfma_f32_16x16x32_bf16 a[248:251],v[104:107],v[24:27],a[248:251]
global_load_dword v139,v140,s[60:61]
v_mfma_f32_16x16x32_bf16 a[252:255],v[104:107],v[28:31],a[252:255]
v_mfma_f32_16x16x32_bf16 v[192:195],v[104:107],v[32:35],v[192:195]
buffer_load_dwordx4 v135,s[12:15],s25 offen offset:3072 lds
v_mfma_f32_16x16x32_bf16 v[196:199],v[104:107],v[36:39],v[196:199]
v_mfma_f32_16x16x32_bf16 v[200:203],v[40:43],v[104:107],v[200:203]
s_add_u32 s25,s25,s27
v_mfma_f32_16x16x32_bf16 v[204:207],v[44:47],v[104:107],v[204:207]
v_mfma_f32_16x16x32_bf16 v[208:211],v[48:51],v[104:107],v[208:211]
s_add_u32 m0,s30,122880
v_mfma_f32_16x16x32_bf16 v[212:215],v[52:55],v[104:107],v[212:215]
v_mfma_f32_16x16x32_bf16 v[216:219],v[16:19],v[108:111],v[216:219]
v_mfma_f32_16x16x32_bf16 v[220:223],v[20:23],v[108:111],v[220:223]
ds_read_b128 v[100:103],v115 offset:2048
v_mfma_f32_16x16x32_bf16 v[224:227],v[108:111],v[24:27],v[224:227]
v_mfma_f32_16x16x32_bf16 v[228:231],v[108:111],v[28:31],v[228:231]
v_mfma_f32_16x16x32_bf16 v[232:235],v[108:111],v[32:35],v[232:235]
buffer_load_dwordx4 v136,s[16:19],s26 offen lds
v_mfma_f32_16x16x32_bf16 v[236:239],v[108:111],v[36:39],v[236:239]
v_mfma_f32_16x16x32_bf16 v[240:243],v[40:43],v[108:111],v[240:243]
v_mfma_f32_16x16x32_bf16 v[244:247],v[44:47],v[108:111],v[244:247]
v_mfma_f32_16x16x32_bf16 v[248:251],v[48:51],v[108:111],v[248:251]
s_add_u32 s26,s26,s28
v_mfma_f32_16x16x32_bf16 v[252:255],v[52:55],v[108:111],v[252:255]
s_waitcnt lgkmcnt(1)
v_mfma_f32_16x16x32_bf16 a[0:3],v[56:59],v[96:99],a[0:3]
v_mfma_f32_16x16x32_bf16 a[4:7],v[60:63],v[96:99],a[4:7]
ds_read_b128 v[104:107],v115 offset:4096
v_mfma_f32_16x16x32_bf16 a[8:11],v[96:99],v[64:67],a[8:11]
s_waitcnt vmcnt(16)
s_mov_b32 s75,0x40000
L_fB_chk:
v_cmp_eq_u32 s[48:49],1,v168
s_sub_u32 s75,s75,1
s_cbranch_scc1 L_fB_ok
s_nop 1
s_cmp_eq_u64 s[48:49],-1
s_cbranch_scc1 L_fB_ok
s_sleep 4
buffer_load_dword v168,v171,s[20:23],0 offen sc1
s_waitcnt vmcnt(0)
s_branch L_fB_chk
L_fB_ok:
s_add_u32 m0,s30,155648
s_nop 0
buffer_load_dwordx4 v9,s[20:23],s44 offen sc1 lds
v_mfma_f32_16x16x32_bf16 a[12:15],v[96:99],v[68:71],a[12:15]
ds_read_b64_tr_b16 v[16:17],v116
v_mfma_f32_16x16x32_bf16 a[16:19],v[96:99],v[72:75],a[16:19]
s_add_u32 m0,s29,126976
v_mfma_f32_16x16x32_bf16 a[20:23],v[96:99],v[76:79],a[20:23]
ds_read_b64_tr_b16 v[18:19],v116 offset:1024
v_mfma_f32_16x16x32_bf16 a[24:27],v[80:83],v[96:99],a[24:27]
v_mfma_f32_16x16x32_bf16 a[28:31],v[84:87],v[96:99],a[28:31]
ds_read_b64_tr_b16 v[20:21],v117
v_mfma_f32_16x16x32_bf16 a[32:35],v[88:91],v[96:99],a[32:35]
buffer_load_dwordx4 v132,s[12:15],s25 offen lds
v_mfma_f32_16x16x32_bf16 a[36:39],v[92:95],v[96:99],a[36:39]
ds_read_b64_tr_b16 v[22:23],v117 offset:1024
s_waitcnt lgkmcnt(5)
v_mfma_f32_16x16x32_bf16 a[40:43],v[56:59],v[100:103],a[40:43]
s_cmp_eq_u32 s34,0
s_cselect_b32 s46,0x80000000,s45
buffer_load_dwordx2 v[176:177],v174,s[20:23],s46 offen sc1
v_mfma_f32_16x16x32_bf16 a[44:47],v[60:63],v[100:103],a[44:47]
ds_read_b128 v[108:111],v115 offset:6144
s_add_u32 s45,s45,2048
v_mfma_f32_16x16x32_bf16 a[48:51],v[100:103],v[64:67],a[48:51]
s_cmp_eq_u32 s34,1
s_cselect_b32 s46,0x80000000,s45
buffer_load_dwordx2 v[178:179],v174,s[20:23],s46 offen sc1
v_mfma_f32_16x16x32_bf16 a[52:55],v[100:103],v[68:71],a[52:55]
ds_read_b64_tr_b16 v[24:25],v120 offset:4096
s_add_u32 s45,s45,2048
v_mfma_f32_16x16x32_bf16 a[56:59],v[100:103],v[72:75],a[56:59]
s_cmp_eq_u32 s34,2
s_cselect_b32 s46,0x80000000,s45
buffer_load_dwordx2 v[180:181],v174,s[20:23],s46 offen sc1
v_mfma_f32_16x16x32_bf16 a[60:63],v[100:103],v[76:79],a[60:63]
ds_read_b64_tr_b16 v[26:27],v120 offset:5120
s_add_u32 s45,s45,2048
v_mfma_f32_16x16x32_bf16 a[64:67],v[80:83],v[100:103],a[64:67]
s_cmp_eq_u32 s34,3
s_cselect_b32 s46,0x80000000,s45
buffer_load_dwordx2 v[182:183],v174,s[20:23],s46 offen sc1
v_mfma_f32_16x16x32_bf16 a[68:71],v[84:87],v[100:103],a[68:71]
ds_read_b64_tr_b16 v[28:29],v121 offset:4096
s_add_u32 s45,s45,2048
v_mfma_f32_16x16x32_bf16 a[72:75],v[88:91],v[100:103],a[72:75]
buffer_load_dwordx4 v133,s[12:15],s25 offen offset:1024 lds
v_mfma_f32_16x16x32_bf16 a[76:79],v[92:95],v[100:103],a[76:79]
ds_read_b64_tr_b16 v[30:31],v121 offset:5120
s_waitcnt lgkmcnt(9)
v_mfma_f32_16x16x32_bf16 a[80:83],v[56:59],v[104:107],a[80:83]
s_cmp_eq_u32 s34,4
s_cselect_b32 s46,0x80000000,s45
buffer_load_dwordx2 v[184:185],v174,s[20:23],s46 offen sc1
v_mfma_f32_16x16x32_bf16 a[84:87],v[60:63],v[104:107],a[84:87]
ds_read_b128 v[96:99],v115 offset:8192
s_add_u32 s45,s45,2048
v_mfma_f32_16x16x32_bf16 a[88:91],v[104:107],v[64:67],a[88:91]
v_mfma_f32_16x16x32_bf16 a[92:95],v[104:107],v[68:71],a[92:95]
ds_read_b64_tr_b16 v[32:33],v122 offset:4096
v_mfma_f32_16x16x32_bf16 a[96:99],v[104:107],v[72:75],a[96:99]
v_mfma_f32_16x16x32_bf16 a[100:103],v[104:107],v[76:79],a[100:103]
ds_read_b64_tr_b16 v[34:35],v122 offset:5120
v_mfma_f32_16x16x32_bf16 a[104:107],v[80:83],v[104:107],a[104:107]
v_mfma_f32_16x16x32_bf16 a[108:111],v[84:87],v[104:107],a[108:111]
ds_read_b64_tr_b16 v[36:37],v123 offset:4096
v_mfma_f32_16x16x32_bf16 a[112:115],v[88:91],v[104:107],a[112:115]
buffer_load_dwordx4 v134,s[12:15],s25 offen offset:2048 lds
v_mfma_f32_16x16x32_bf16 a[116:119],v[92:95],v[104:107],a[116:119]
ds_read_b64_tr_b16 v[38:39],v123 offset:5120
s_waitcnt lgkmcnt(9)
v_mfma_f32_16x16x32_bf16 a[120:123],v[56:59],v[108:111],a[120:123]
v_mfma_f32_16x16x32_bf16 a[124:127],v[60:63],v[108:111],a[124:127]
ds_read_b128 v[100:103],v115 offset:10240
v_mfma_f32_16x16x32_bf16 a[128:131],v[108:111],v[64:67],a[128:131]
v_mfma_f32_16x16x32_bf16 a[132:135],v[108:111],v[68:71],a[132:135]
ds_read_b64_tr_b16 v[40:41],v116 offset:12288
v_mfma_f32_16x16x32_bf16 a[136:139],v[108:111],v[72:75],a[136:139]
v_mfma_f32_16x16x32_bf16 a[140:143],v[108:111],v[76:79],a[140:143]
ds_read_b64_tr_b16 v[42:43],v116 offset:13312
v_mfma_f32_16x16x32_bf16 a[144:147],v[80:83],v[108:111],a[144:147]
v_mfma_f32_16x16x32_bf16 a[148:151],v[84:87],v[108:111],a[148:151]
ds_read_b64_tr_b16 v[44:45],v117 offset:12288
v_mfma_f32_16x16x32_bf16 a[152:155],v[88:91],v[108:111],a[152:155]
buffer_load_dwordx4 v135,s[12:15],s25 offen offset:3072 lds
v_mfma_f32_16x16x32_bf16 a[156:159],v[92:95],v[108:111],a[156:159]
ds_read_b64_tr_b16 v[46:47],v117 offset:13312
s_waitcnt lgkmcnt(9)
v_mfma_f32_16x16x32_bf16 a[160:163],v[56:59],v[96:99],a[160:163]
s_add_u32 s25,s25,s27
v_mfma_f32_16x16x32_bf16 a[164:167],v[60:63],v[96:99],a[164:167]
ds_read_b128 v[104:107],v115 offset:12288
v_mfma_f32_16x16x32_bf16 a[168:171],v[96:99],v[64:67],a[168:171]
v_mfma_f32_16x16x32_bf16 a[172:175],v[96:99],v[68:71],a[172:175]
ds_read_b64_tr_b16 v[48:49],v116 offset:16384
v_mfma_f32_16x16x32_bf16 a[176:179],v[96:99],v[72:75],a[176:179]
s_add_u32 m0,s30,143360
v_mfma_f32_16x16x32_bf16 a[180:183],v[96:99],v[76:79],a[180:183]
ds_read_b64_tr_b16 v[50:51],v116 offset:17408
v_mfma_f32_16x16x32_bf16 a[184:187],v[80:83],v[96:99],a[184:187]
v_mfma_f32_16x16x32_bf16 a[188:191],v[84:87],v[96:99],a[188:191]
ds_read_b64_tr_b16 v[52:53],v117 offset:16384
v_mfma_f32_16x16x32_bf16 a[192:195],v[88:91],v[96:99],a[192:195]
buffer_load_dwordx4 v136,s[16:19],s26 offen lds
v_mfma_f32_16x16x32_bf16 a[196:199],v[92:95],v[96:99],a[196:199]
ds_read_b64_tr_b16 v[54:55],v117 offset:17408
s_waitcnt lgkmcnt(9)
v_mfma_f32_16x16x32_bf16 a[200:203],v[56:59],v[100:103],a[200:203]
s_add_u32 s26,s26,s28
v_mfma_f32_16x16x32_bf16 a[204:207],v[60:63],v[100:103],a[204:207]
ds_read_b128 v[108:111],v115 offset:14336
v_mfma_f32_16x16x32_bf16 a[208:211],v[100:103],v[64:67],a[208:211]
s_cbranch_vccnz .Lcs39
v_smfmac_f32_16x16x64_bf16 v[144:147],v[164:167],v[56:63],v143
v_smfmac_f32_16x16x64_bf16 v[148:151],v[164:167],v[64:71],v143
v_smfmac_f32_16x16x64_bf16 v[152:155],v[164:167],v[72:79],v143
s_branch .Lce39
.Lcs39:
v_smfmac_f32_16x16x64_bf16 v[156:159],v[164:167],v[80:87],v143
v_smfmac_f32_16x16x64_bf16 v[160:163],v[164:167],v[88:95],v143
.Lce39:
v_mfma_f32_16x16x32_bf16 a[212:215],v[100:103],v[68:71],a[212:215]
v_mfma_f32_16x16x32_bf16 a[216:219],v[100:103],v[72:75],a[216:219]
v_mfma_f32_16x16x32_bf16 a[220:223],v[100:103],v[76:79],a[220:223]
v_mfma_f32_16x16x32_bf16 a[224:227],v[80:83],v[100:103],a[224:227]
v_mfma_f32_16x16x32_bf16 a[228:231],v[84:87],v[100:103],a[228:231]
v_mfma_f32_16x16x32_bf16 a[232:235],v[88:91],v[100:103],a[232:235]
s_waitcnt vmcnt(17) lgkmcnt(0)
s_barrier
v_mfma_f32_16x16x32_bf16 a[236:239],v[92:95],v[100:103],a[236:239]
s_add_u32 m0,s33,32768
v_mfma_f32_16x16x32_bf16 a[240:243],v[56:59],v[104:107],a[240:243]
buffer_load_dwordx4 v128,s[8:11],s24 offen lds
v_mfma_f32_16x16x32_bf16 a[244:247],v[60:63],v[104:107],a[244:247]
ds_read_b128 v[96:99],v112
v_mfma_f32_16x16x32_bf16 a[248:251],v[104:107],v[64:67],a[248:251]
v_mfma_f32_16x16x32_bf16 a[252:255],v[104:107],v[68:71],a[252:255]
v_mfma_f32_16x16x32_bf16 v[192:195],v[104:107],v[72:75],v[192:195]
v_mfma_f32_16x16x32_bf16 v[196:199],v[104:107],v[76:79],v[196:199]
v_mfma_f32_16x16x32_bf16 v[200:203],v[80:83],v[104:107],v[200:203]
v_mfma_f32_16x16x32_bf16 v[204:207],v[84:87],v[104:107],v[204:207]
v_mfma_f32_16x16x32_bf16 v[208:211],v[88:91],v[104:107],v[208:211]
buffer_load_dwordx4 v129,s[8:11],s24 offen offset:1024 lds
v_mfma_f32_16x16x32_bf16 v[212:215],v[92:95],v[104:107],v[212:215]
v_mfma_f32_16x16x32_bf16 v[216:219],v[56:59],v[108:111],v[216:219]
v_mfma_f32_16x16x32_bf16 v[220:223],v[60:63],v[108:111],v[220:223]
ds_read_b128 v[100:103],v112 offset:2048
v_mfma_f32_16x16x32_bf16 v[224:227],v[108:111],v[64:67],v[224:227]
v_mfma_f32_16x16x32_bf16 v[228:231],v[108:111],v[68:71],v[228:231]
v_mfma_f32_16x16x32_bf16 v[232:235],v[108:111],v[72:75],v[232:235]
v_mfma_f32_16x16x32_bf16 v[236:239],v[108:111],v[76:79],v[236:239]
v_mfma_f32_16x16x32_bf16 v[240:243],v[80:83],v[108:111],v[240:243]
buffer_load_dwordx4 v130,s[8:11],s24 offen offset:2048 lds
v_mfma_f32_16x16x32_bf16 v[244:247],v[84:87],v[108:111],v[244:247]
v_mfma_f32_16x16x32_bf16 v[248:251],v[88:91],v[108:111],v[248:251]
v_mfma_f32_16x16x32_bf16 v[252:255],v[92:95],v[108:111],v[252:255]
s_waitcnt lgkmcnt(1)
v_mfma_f32_16x16x32_bf16 a[0:3],v[16:19],v[96:99],a[0:3]
buffer_load_dwordx4 v131,s[8:11],s24 offen offset:3072 lds
v_mfma_f32_16x16x32_bf16 a[4:7],v[20:23],v[96:99],a[4:7]
ds_read_b128 v[104:107],v112 offset:4096
v_mfma_f32_16x16x32_bf16 a[8:11],v[96:99],v[24:27],a[8:11]
s_add_u32 m0,s33,36864
v_mfma_f32_16x16x32_bf16 a[12:15],v[96:99],v[28:31],a[12:15]
ds_read_b64_tr_b16 v[56:57],v116 offset:20480
v_mfma_f32_16x16x32_bf16 a[16:19],v[96:99],v[32:35],a[16:19]
v_mfma_f32_16x16x32_bf16 a[20:23],v[96:99],v[36:39],a[20:23]
ds_read_b64_tr_b16 v[58:59],v116 offset:21504
v_mfma_f32_16x16x32_bf16 a[24:27],v[40:43],v[96:99],a[24:27]
buffer_load_dwordx4 v128,s[8:11],s32 offen lds
v_mfma_f32_16x16x32_bf16 a[28:31],v[44:47],v[96:99],a[28:31]
ds_read_b64_tr_b16 v[60:61],v117 offset:20480
v_mfma_f32_16x16x32_bf16 a[32:35],v[48:51],v[96:99],a[32:35]
v_mfma_f32_16x16x32_bf16 a[36:39],v[52:55],v[96:99],a[36:39]
ds_read_b64_tr_b16 v[62:63],v117 offset:21504
s_waitcnt lgkmcnt(5)
v_mfma_f32_16x16x32_bf16 a[40:43],v[16:19],v[100:103],a[40:43]
buffer_load_dwordx4 v129,s[8:11],s32 offen offset:1024 lds
v_mfma_f32_16x16x32_bf16 a[44:47],v[20:23],v[100:103],a[44:47]
ds_read_b128 v[108:111],v112 offset:6144
v_mfma_f32_16x16x32_bf16 a[48:51],v[100:103],v[24:27],a[48:51]
s_waitcnt vmcnt(9)
v_add_f32 v176,v176,v178
v_mfma_f32_16x16x32_bf16 a[52:55],v[100:103],v[28:31],a[52:55]
ds_read_b64_tr_b16 v[64:65],v120 offset:24576
v_add_f32 v177,v177,v179
v_mfma_f32_16x16x32_bf16 a[56:59],v[100:103],v[32:35],a[56:59]
buffer_load_dwordx4 v130,s[8:11],s32 offen offset:2048 lds
v_mfma_f32_16x16x32_bf16 a[60:63],v[100:103],v[36:39],a[60:63]
ds_read_b64_tr_b16 v[66:67],v120 offset:25600
v_add_f32 v176,v176,v180
v_mfma_f32_16x16x32_bf16 a[64:67],v[40:43],v[100:103],a[64:67]
v_add_f32 v177,v177,v181
v_add_f32 v176,v176,v182
v_mfma_f32_16x16x32_bf16 a[68:71],v[44:47],v[100:103],a[68:71]
ds_read_b64_tr_b16 v[68:69],v121 offset:24576
v_add_f32 v177,v177,v183
v_mfma_f32_16x16x32_bf16 a[72:75],v[48:51],v[100:103],a[72:75]
buffer_load_dwordx4 v131,s[8:11],s32 offen offset:3072 lds
v_mfma_f32_16x16x32_bf16 a[76:79],v[52:55],v[100:103],a[76:79]
ds_read_b64_tr_b16 v[70:71],v121 offset:25600
s_waitcnt lgkmcnt(9)
v_mfma_f32_16x16x32_bf16 a[80:83],v[16:19],v[104:107],a[80:83]
s_add_u32 s24,s24,128
v_add_f32 v176,v176,v184
v_mfma_f32_16x16x32_bf16 a[84:87],v[20:23],v[104:107],a[84:87]
ds_read_b128 v[96:99],v112 offset:8192
v_add_f32 v177,v177,v185
v_mfma_f32_16x16x32_bf16 a[88:91],v[104:107],v[24:27],a[88:91]
ds_write_b32 v173,v176
ds_write_b32 v173,v177 offset:64
v_mfma_f32_16x16x32_bf16 a[92:95],v[104:107],v[28:31],a[92:95]
ds_read_b64_tr_b16 v[72:73],v122 offset:24576
ds_read2_b32 v[178:179],v172 offset0:0 offset1:16
v_mfma_f32_16x16x32_bf16 a[96:99],v[104:107],v[32:35],a[96:99]
s_add_u32 s32,s32,128
ds_read2_b32 v[180:181],v172 offset0:32 offset1:48
v_mfma_f32_16x16x32_bf16 a[100:103],v[104:107],v[36:39],a[100:103]
s_waitcnt lgkmcnt(11)
ds_read_b64_tr_b16 v[74:75],v122 offset:25600
ds_read2_b32 v[182:183],v172 offset0:64 offset1:80
v_mfma_f32_16x16x32_bf16 a[104:107],v[40:43],v[104:107],a[104:107]
v_mfma_f32_16x16x32_bf16 a[108:111],v[44:47],v[104:107],a[108:111]
ds_read_b64_tr_b16 v[76:77],v123 offset:24576
v_mfma_f32_16x16x32_bf16 a[112:115],v[48:51],v[104:107],a[112:115]
v_mfma_f32_16x16x32_bf16 a[116:119],v[52:55],v[104:107],a[116:119]
ds_read_b64_tr_b16 v[78:79],v123 offset:25600
s_waitcnt lgkmcnt(14)
v_mfma_f32_16x16x32_bf16 a[120:123],v[16:19],v[108:111],a[120:123]
v_mfma_f32_16x16x32_bf16 a[124:127],v[20:23],v[108:111],a[124:127]
ds_read_b128 v[100:103],v112 offset:10240
v_mfma_f32_16x16x32_bf16 a[128:131],v[108:111],v[24:27],a[128:131]
s_waitcnt lgkmcnt(3)
v_add_f32 v144,v144,v178
v_mfma_f32_16x16x32_bf16 a[132:135],v[108:111],v[28:31],a[132:135]
ds_read_b64_tr_b16 v[80:81],v116 offset:32768
v_add_f32 v146,v146,v179
v_mfma_f32_16x16x32_bf16 a[136:139],v[108:111],v[32:35],a[136:139]
v_add_f32 v148,v148,v180
v_add_f32 v150,v150,v181
v_mfma_f32_16x16x32_bf16 a[140:143],v[108:111],v[36:39],a[140:143]
ds_read_b64_tr_b16 v[82:83],v116 offset:33792
v_add_f32 v152,v152,v182
v_mfma_f32_16x16x32_bf16 a[144:147],v[40:43],v[108:111],a[144:147]
v_add_f32 v154,v154,v183
v_add_f32 v156,v156,v178
v_mfma_f32_16x16x32_bf16 a[148:151],v[44:47],v[108:111],a[148:151]
ds_read_b64_tr_b16 v[84:85],v117 offset:32768
v_add_f32 v158,v158,v179
v_mfma_f32_16x16x32_bf16 a[152:155],v[48:51],v[108:111],a[152:155]
v_add_f32 v160,v160,v180
v_add_f32 v162,v162,v181
v_mfma_f32_16x16x32_bf16 a[156:159],v[52:55],v[108:111],a[156:159]
ds_read_b64_tr_b16 v[86:87],v117 offset:33792
v_mfma_f32_16x16x32_bf16 a[160:163],v[16:19],v[96:99],a[160:163]
v_mfma_f32_16x16x32_bf16 a[164:167],v[20:23],v[96:99],a[164:167]
ds_read_b128 v[104:107],v112 offset:12288
v_mfma_f32_16x16x32_bf16 a[168:171],v[96:99],v[24:27],a[168:171]
v_mfma_f32_16x16x32_bf16 a[172:175],v[96:99],v[28:31],a[172:175]
ds_read_b64_tr_b16 v[88:89],v116 offset:36864
v_mfma_f32_16x16x32_bf16 a[176:179],v[96:99],v[32:35],a[176:179]
v_mfma_f32_16x16x32_bf16 a[180:183],v[96:99],v[36:39],a[180:183]
ds_read_b64_tr_b16 v[90:91],v116 offset:37888
v_mfma_f32_16x16x32_bf16 a[184:187],v[40:43],v[96:99],a[184:187]
v_mfma_f32_16x16x32_bf16 a[188:191],v[44:47],v[96:99],a[188:191]
ds_read_b64_tr_b16 v[92:93],v117 offset:36864
v_mfma_f32_16x16x32_bf16 a[192:195],v[48:51],v[96:99],a[192:195]
v_mfma_f32_16x16x32_bf16 a[196:199],v[52:55],v[96:99],a[196:199]
ds_read_b64_tr_b16 v[94:95],v117 offset:37888
s_waitcnt lgkmcnt(9)
v_mfma_f32_16x16x32_bf16 a[200:203],v[16:19],v[100:103],a[200:203]
v_mfma_f32_16x16x32_bf16 a[204:207],v[20:23],v[100:103],a[204:207]
ds_read_b128 v[108:111],v112 offset:14336
v_mfma_f32_16x16x32_bf16 a[208:211],v[100:103],v[24:27],a[208:211]
s_cbranch_vccnz .Lcs40
v_smfmac_f32_16x16x64_bf16 v[144:147],v[164:167],v[16:23],v143
v_smfmac_f32_16x16x64_bf16 v[148:151],v[164:167],v[24:31],v143
v_smfmac_f32_16x16x64_bf16 v[152:155],v[164:167],v[32:39],v143
s_branch .Lce40
.Lcs40:
v_smfmac_f32_16x16x64_bf16 v[156:159],v[164:167],v[40:47],v143
v_smfmac_f32_16x16x64_bf16 v[160:163],v[164:167],v[48:55],v143
.Lce40:
v_mfma_f32_16x16x32_bf16 a[212:215],v[100:103],v[28:31],a[212:215]
v_mfma_f32_16x16x32_bf16 a[216:219],v[100:103],v[32:35],a[216:219]
v_mfma_f32_16x16x32_bf16 a[220:223],v[100:103],v[36:39],a[220:223]
v_mfma_f32_16x16x32_bf16 a[224:227],v[40:43],v[100:103],a[224:227]
v_mfma_f32_16x16x32_bf16 a[228:231],v[44:47],v[100:103],a[228:231]
v_mfma_f32_16x16x32_bf16 a[232:235],v[48:51],v[100:103],a[232:235]
v_mfma_f32_16x16x32_bf16 a[236:239],v[52:55],v[100:103],a[236:239]
s_waitcnt lgkmcnt(5)
v_mfma_f32_16x16x32_bf16 a[240:243],v[16:19],v[104:107],a[240:243]
v_mfma_f32_16x16x32_bf16 a[244:247],v[20:23],v[104:107],a[244:247]
ds_read_b128 v[96:99],v113
v_mfma_f32_16x16x32_bf16 a[248:251],v[104:107],v[24:27],a[248:251]
v_mfma_f32_16x16x32_bf16 a[252:255],v[104:107],v[28:31],a[252:255]
v_mfma_f32_16x16x32_bf16 v[192:195],v[104:107],v[32:35],v[192:195]
v_mfma_f32_16x16x32_bf16 v[196:199],v[104:107],v[36:39],v[196:199]
v_mfma_f32_16x16x32_bf16 v[200:203],v[40:43],v[104:107],v[200:203]
v_mfma_f32_16x16x32_bf16 v[204:207],v[44:47],v[104:107],v[204:207]
v_mfma_f32_16x16x32_bf16 v[208:211],v[48:51],v[104:107],v[208:211]
v_mfma_f32_16x16x32_bf16 v[212:215],v[52:55],v[104:107],v[212:215]
s_waitcnt lgkmcnt(1)
v_mfma_f32_16x16x32_bf16 v[216:219],v[16:19],v[108:111],v[216:219]
v_mfma_f32_16x16x32_bf16 v[220:223],v[20:23],v[108:111],v[220:223]
ds_read_b128 v[100:103],v113 offset:2048
v_mfma_f32_16x16x32_bf16 v[224:227],v[108:111],v[24:27],v[224:227]
v_mfma_f32_16x16x32_bf16 v[228:231],v[108:111],v[28:31],v[228:231]
v_mfma_f32_16x16x32_bf16 v[232:235],v[108:111],v[32:35],v[232:235]
v_mfma_f32_16x16x32_bf16 v[236:239],v[108:111],v[36:39],v[236:239]
v_mfma_f32_16x16x32_bf16 v[240:243],v[40:43],v[108:111],v[240:243]
v_mfma_f32_16x16x32_bf16 v[244:247],v[44:47],v[108:111],v[244:247]
v_mfma_f32_16x16x32_bf16 v[248:251],v[48:51],v[108:111],v[248:251]
v_mfma_f32_16x16x32_bf16 v[252:255],v[52:55],v[108:111],v[252:255]
s_waitcnt vmcnt(0) lgkmcnt(0)
s_barrier
L_epiB:
v_mfma_f32_16x16x32_bf16 a[0:3],v[56:59],v[96:99],a[0:3]
ds_read_b128 v[104:107],v113 offset:4096
ds_read_b64_tr_b16 v[16:17],v116 offset:40960
v_mfma_f32_16x16x32_bf16 a[4:7],v[60:63],v[96:99],a[4:7]
ds_read_b64_tr_b16 v[18:19],v116 offset:41984
ds_read_b64_tr_b16 v[20:21],v117 offset:40960
v_mfma_f32_16x16x32_bf16 a[8:11],v[96:99],v[64:67],a[8:11]
ds_read_b64_tr_b16 v[22:23],v117 offset:41984
ds_read_b64_tr_b16 v[24:25],v120 offset:45056
v_mfma_f32_16x16x32_bf16 a[12:15],v[96:99],v[68:71],a[12:15]
ds_read_b64_tr_b16 v[26:27],v120 offset:46080
ds_read_b64_tr_b16 v[28:29],v121 offset:45056
v_mfma_f32_16x16x32_bf16 a[16:19],v[96:99],v[72:75],a[16:19]
ds_read_b64_tr_b16 v[30:31],v121 offset:46080
ds_read_b64_tr_b16 v[32:33],v122 offset:45056
v_mfma_f32_16x16x32_bf16 a[20:23],v[96:99],v[76:79],a[20:23]
ds_read_b64_tr_b16 v[34:35],v122 offset:46080
ds_read_b64_tr_b16 v[36:37],v123 offset:45056
v_mfma_f32_16x16x32_bf16 a[40:43],v[56:59],v[100:103],a[40:43]
ds_read_b128 v[108:111],v113 offset:6144
ds_read_b64_tr_b16 v[38:39],v123 offset:46080
v_mfma_f32_16x16x32_bf16 a[44:47],v[60:63],v[100:103],a[44:47]
ds_read_b64_tr_b16 v[40:41],v116 offset:53248
s_waitcnt lgkmcnt(11)
ds_read_b64_tr_b16 v[42:43],v116 offset:54272
v_mfma_f32_16x16x32_bf16 a[48:51],v[100:103],v[64:67],a[48:51]
ds_read_b64_tr_b16 v[44:45],v117 offset:53248
ds_read_b64_tr_b16 v[46:47],v117 offset:54272
v_mfma_f32_16x16x32_bf16 a[52:55],v[100:103],v[68:71],a[52:55]
ds_read_b64_tr_b16 v[48:49],v116 offset:57344
s_waitcnt lgkmcnt(11)
ds_read_b64_tr_b16 v[50:51],v116 offset:58368
v_mfma_f32_16x16x32_bf16 a[56:59],v[100:103],v[72:75],a[56:59]
ds_read_b64_tr_b16 v[52:53],v117 offset:57344
ds_read_b64_tr_b16 v[54:55],v117 offset:58368
v_mfma_f32_16x16x32_bf16 a[60:63],v[100:103],v[76:79],a[60:63]
v_mfma_f32_16x16x32_bf16 a[80:83],v[56:59],v[104:107],a[80:83]
ds_read_b128 v[96:99],v113 offset:8192
v_mfma_f32_16x16x32_bf16 a[84:87],v[60:63],v[104:107],a[84:87]
v_mfma_f32_16x16x32_bf16 a[88:91],v[104:107],v[64:67],a[88:91]
v_mfma_f32_16x16x32_bf16 a[92:95],v[104:107],v[68:71],a[92:95]
v_mfma_f32_16x16x32_bf16 a[96:99],v[104:107],v[72:75],a[96:99]
v_mfma_f32_16x16x32_bf16 a[100:103],v[104:107],v[76:79],a[100:103]
s_waitcnt lgkmcnt(10)
v_mfma_f32_16x16x32_bf16 a[120:123],v[56:59],v[108:111],a[120:123]
ds_read_b128 v[100:103],v113 offset:10240
v_mfma_f32_16x16x32_bf16 a[124:127],v[60:63],v[108:111],a[124:127]
v_mfma_f32_16x16x32_bf16 a[128:131],v[108:111],v[64:67],a[128:131]
v_mfma_f32_16x16x32_bf16 a[132:135],v[108:111],v[68:71],a[132:135]
v_mfma_f32_16x16x32_bf16 a[136:139],v[108:111],v[72:75],a[136:139]
v_mfma_f32_16x16x32_bf16 a[140:143],v[108:111],v[76:79],a[140:143]
s_waitcnt lgkmcnt(1)
v_mfma_f32_16x16x32_bf16 a[160:163],v[56:59],v[96:99],a[160:163]
ds_read_b128 v[104:107],v113 offset:12288
v_mfma_f32_16x16x32_bf16 a[164:167],v[60:63],v[96:99],a[164:167]
v_mfma_f32_16x16x32_bf16 a[168:171],v[96:99],v[64:67],a[168:171]
v_mfma_f32_16x16x32_bf16 a[172:175],v[96:99],v[68:71],a[172:175]
v_mfma_f32_16x16x32_bf16 a[176:179],v[96:99],v[72:75],a[176:179]
v_mfma_f32_16x16x32_bf16 a[180:183],v[96:99],v[76:79],a[180:183]
s_waitcnt lgkmcnt(1)
v_mfma_f32_16x16x32_bf16 a[200:203],v[56:59],v[100:103],a[200:203]
ds_read_b128 v[108:111],v113 offset:14336
v_mfma_f32_16x16x32_bf16 a[204:207],v[60:63],v[100:103],a[204:207]
v_mfma_f32_16x16x32_bf16 a[208:211],v[100:103],v[64:67],a[208:211]
v_mfma_f32_16x16x32_bf16 a[212:215],v[100:103],v[68:71],a[212:215]
v_mfma_f32_16x16x32_bf16 a[216:219],v[100:103],v[72:75],a[216:219]
v_mfma_f32_16x16x32_bf16 a[220:223],v[100:103],v[76:79],a[220:223]
s_waitcnt lgkmcnt(1)
v_mfma_f32_16x16x32_bf16 a[240:243],v[56:59],v[104:107],a[240:243]
ds_read_b128 v[96:99],v114
v_mfma_f32_16x16x32_bf16 a[244:247],v[60:63],v[104:107],a[244:247]
v_mfma_f32_16x16x32_bf16 a[248:251],v[104:107],v[64:67],a[248:251]
v_mfma_f32_16x16x32_bf16 a[252:255],v[104:107],v[68:71],a[252:255]
v_mfma_f32_16x16x32_bf16 v[192:195],v[104:107],v[72:75],v[192:195]
v_mfma_f32_16x16x32_bf16 v[196:199],v[104:107],v[76:79],v[196:199]
s_waitcnt lgkmcnt(1)
v_mfma_f32_16x16x32_bf16 v[216:219],v[56:59],v[108:111],v[216:219]
ds_read_b128 v[100:103],v114 offset:2048
v_mfma_f32_16x16x32_bf16 v[220:223],v[60:63],v[108:111],v[220:223]
v_mfma_f32_16x16x32_bf16 v[224:227],v[108:111],v[64:67],v[224:227]
v_mfma_f32_16x16x32_bf16 v[228:231],v[108:111],v[68:71],v[228:231]
v_mfma_f32_16x16x32_bf16 v[232:235],v[108:111],v[72:75],v[232:235]
v_mfma_f32_16x16x32_bf16 v[236:239],v[108:111],v[76:79],v[236:239]
s_cbranch_vccnz .Lce41
v_smfmac_f32_16x16x64_bf16 v[144:147],v[164:167],v[56:63],v143
v_smfmac_f32_16x16x64_bf16 v[148:151],v[164:167],v[64:71],v143
v_smfmac_f32_16x16x64_bf16 v[152:155],v[164:167],v[72:79],v143
.Lce41:
s_waitcnt lgkmcnt(1)
v_mfma_f32_16x16x32_bf16 a[0:3],v[16:19],v[96:99],a[0:3]
ds_read_b128 v[104:107],v114 offset:4096
ds_read_b64_tr_b16 v[56:57],v118
v_mfma_f32_16x16x32_bf16 a[4:7],v[20:23],v[96:99],a[4:7]
ds_read_b64_tr_b16 v[58:59],v118 offset:1024
ds_read_b64_tr_b16 v[60:61],v119
v_mfma_f32_16x16x32_bf16 a[8:11],v[96:99],v[24:27],a[8:11]
ds_read_b64_tr_b16 v[62:63],v119 offset:1024
ds_read_b64_tr_b16 v[64:65],v124 offset:4096
v_mfma_f32_16x16x32_bf16 a[12:15],v[96:99],v[28:31],a[12:15]
ds_read_b64_tr_b16 v[66:67],v124 offset:5120
ds_read_b64_tr_b16 v[68:69],v125 offset:4096
v_mfma_f32_16x16x32_bf16 a[16:19],v[96:99],v[32:35],a[16:19]
ds_read_b64_tr_b16 v[70:71],v125 offset:5120
ds_read_b64_tr_b16 v[72:73],v126 offset:4096
v_mfma_f32_16x16x32_bf16 a[20:23],v[96:99],v[36:39],a[20:23]
ds_read_b64_tr_b16 v[74:75],v126 offset:5120
ds_read_b64_tr_b16 v[76:77],v127 offset:4096
s_waitcnt lgkmcnt(12)
v_mfma_f32_16x16x32_bf16 a[40:43],v[16:19],v[100:103],a[40:43]
ds_read_b128 v[108:111],v114 offset:6144
ds_read_b64_tr_b16 v[78:79],v127 offset:5120
v_mfma_f32_16x16x32_bf16 a[44:47],v[20:23],v[100:103],a[44:47]
v_mfma_f32_16x16x32_bf16 a[48:51],v[100:103],v[24:27],a[48:51]
v_mfma_f32_16x16x32_bf16 a[52:55],v[100:103],v[28:31],a[52:55]
v_mfma_f32_16x16x32_bf16 a[56:59],v[100:103],v[32:35],a[56:59]
v_mfma_f32_16x16x32_bf16 a[60:63],v[100:103],v[36:39],a[60:63]
s_waitcnt lgkmcnt(13)
v_mfma_f32_16x16x32_bf16 a[80:83],v[16:19],v[104:107],a[80:83]
ds_read_b128 v[96:99],v114 offset:8192
v_mfma_f32_16x16x32_bf16 a[84:87],v[20:23],v[104:107],a[84:87]
v_mfma_f32_16x16x32_bf16 a[88:91],v[104:107],v[24:27],a[88:91]
v_mfma_f32_16x16x32_bf16 a[92:95],v[104:107],v[28:31],a[92:95]
v_mfma_f32_16x16x32_bf16 a[96:99],v[104:107],v[32:35],a[96:99]
v_mfma_f32_16x16x32_bf16 a[100:103],v[104:107],v[36:39],a[100:103]
s_waitcnt lgkmcnt(2)
v_mfma_f32_16x16x32_bf16 a[120:123],v[16:19],v[108:111],a[120:123]
ds_read_b128 v[100:103],v114 offset:10240
v_mfma_f32_16x16x32_bf16 a[124:127],v[20:23],v[108:111],a[124:127]
v_mfma_f32_16x16x32_bf16 a[128:131],v[108:111],v[24:27],a[128:131]
v_mfma_f32_16x16x32_bf16 a[132:135],v[108:111],v[28:31],a[132:135]
v_mfma_f32_16x16x32_bf16 a[136:139],v[108:111],v[32:35],a[136:139]
v_mfma_f32_16x16x32_bf16 a[140:143],v[108:111],v[36:39],a[140:143]
s_waitcnt lgkmcnt(1)
v_mfma_f32_16x16x32_bf16 a[160:163],v[16:19],v[96:99],a[160:163]
ds_read_b128 v[104:107],v114 offset:12288
v_mfma_f32_16x16x32_bf16 a[164:167],v[20:23],v[96:99],a[164:167]
v_mfma_f32_16x16x32_bf16 a[168:171],v[96:99],v[24:27],a[168:171]
v_mfma_f32_16x16x32_bf16 a[172:175],v[96:99],v[28:31],a[172:175]
v_mfma_f32_16x16x32_bf16 a[176:179],v[96:99],v[32:35],a[176:179]
v_mfma_f32_16x16x32_bf16 a[180:183],v[96:99],v[36:39],a[180:183]
s_waitcnt lgkmcnt(1)
v_mfma_f32_16x16x32_bf16 a[200:203],v[16:19],v[100:103],a[200:203]
ds_read_b128 v[108:111],v114 offset:14336
v_mfma_f32_16x16x32_bf16 a[204:207],v[20:23],v[100:103],a[204:207]
v_mfma_f32_16x16x32_bf16 a[208:211],v[100:103],v[24:27],a[208:211]
v_mfma_f32_16x16x32_bf16 a[212:215],v[100:103],v[28:31],a[212:215]
v_mfma_f32_16x16x32_bf16 a[216:219],v[100:103],v[32:35],a[216:219]
v_mfma_f32_16x16x32_bf16 a[220:223],v[100:103],v[36:39],a[220:223]
s_waitcnt lgkmcnt(1)
v_mfma_f32_16x16x32_bf16 a[240:243],v[16:19],v[104:107],a[240:243]
ds_read_b128 v[96:99],v115
v_mfma_f32_16x16x32_bf16 a[244:247],v[20:23],v[104:107],a[244:247]
v_mfma_f32_16x16x32_bf16 a[248:251],v[104:107],v[24:27],a[248:251]
v_mfma_f32_16x16x32_bf16 a[252:255],v[104:107],v[28:31],a[252:255]
v_mfma_f32_16x16x32_bf16 v[192:195],v[104:107],v[32:35],v[192:195]
v_mfma_f32_16x16x32_bf16 v[196:199],v[104:107],v[36:39],v[196:199]
s_waitcnt lgkmcnt(1)
v_mfma_f32_16x16x32_bf16 v[216:219],v[16:19],v[108:111],v[216:219]
ds_read_b128 v[100:103],v115 offset:2048
v_mfma_f32_16x16x32_bf16 v[220:223],v[20:23],v[108:111],v[220:223]
v_mfma_f32_16x16x32_bf16 v[224:227],v[108:111],v[24:27],v[224:227]
v_mfma_f32_16x16x32_bf16 v[228:231],v[108:111],v[28:31],v[228:231]
v_mfma_f32_16x16x32_bf16 v[232:235],v[108:111],v[32:35],v[232:235]
v_mfma_f32_16x16x32_bf16 v[236:239],v[108:111],v[36:39],v[236:239]
s_cbranch_vccnz .Lce42
v_smfmac_f32_16x16x64_bf16 v[144:147],v[164:167],v[16:23],v143
v_smfmac_f32_16x16x64_bf16 v[148:151],v[164:167],v[24:31],v143
v_smfmac_f32_16x16x64_bf16 v[152:155],v[164:167],v[32:39],v143
.Lce42:
s_waitcnt lgkmcnt(1)
v_mfma_f32_16x16x32_bf16 a[0:3],v[56:59],v[96:99],a[0:3]
ds_read_b128 v[104:107],v115 offset:4096
v_mfma_f32_16x16x32_bf16 a[4:7],v[60:63],v[96:99],a[4:7]
v_mfma_f32_16x16x32_bf16 a[8:11],v[96:99],v[64:67],a[8:11]
v_mfma_f32_16x16x32_bf16 a[12:15],v[96:99],v[68:71],a[12:15]
v_mfma_f32_16x16x32_bf16 a[16:19],v[96:99],v[72:75],a[16:19]
v_mfma_f32_16x16x32_bf16 a[20:23],v[96:99],v[76:79],a[20:23]
s_waitcnt lgkmcnt(1)
v_mfma_f32_16x16x32_bf16 a[40:43],v[56:59],v[100:103],a[40:43]
ds_read_b128 v[108:111],v115 offset:6144
v_mfma_f32_16x16x32_bf16 a[44:47],v[60:63],v[100:103],a[44:47]
v_mfma_f32_16x16x32_bf16 a[48:51],v[100:103],v[64:67],a[48:51]
v_mfma_f32_16x16x32_bf16 a[52:55],v[100:103],v[68:71],a[52:55]
v_mfma_f32_16x16x32_bf16 a[56:59],v[100:103],v[72:75],a[56:59]
v_mfma_f32_16x16x32_bf16 a[60:63],v[100:103],v[76:79],a[60:63]
s_waitcnt lgkmcnt(1)
v_mfma_f32_16x16x32_bf16 a[80:83],v[56:59],v[104:107],a[80:83]
ds_read_b128 v[96:99],v115 offset:8192
v_mfma_f32_16x16x32_bf16 a[84:87],v[60:63],v[104:107],a[84:87]
v_mfma_f32_16x16x32_bf16 a[88:91],v[104:107],v[64:67],a[88:91]
v_mfma_f32_16x16x32_bf16 a[92:95],v[104:107],v[68:71],a[92:95]
v_mfma_f32_16x16x32_bf16 a[96:99],v[104:107],v[72:75],a[96:99]
v_mfma_f32_16x16x32_bf16 a[100:103],v[104:107],v[76:79],a[100:103]
s_waitcnt lgkmcnt(1)
v_mfma_f32_16x16x32_bf16 a[120:123],v[56:59],v[108:111],a[120:123]
ds_read_b128 v[100:103],v115 offset:10240
v_mfma_f32_16x16x32_bf16 a[124:127],v[60:63],v[108:111],a[124:127]
v_mfma_f32_16x16x32_bf16 a[128:131],v[108:111],v[64:67],a[128:131]
v_mfma_f32_16x16x32_bf16 a[132:135],v[108:111],v[68:71],a[132:135]
v_mfma_f32_16x16x32_bf16 a[136:139],v[108:111],v[72:75],a[136:139]
v_mfma_f32_16x16x32_bf16 a[140:143],v[108:111],v[76:79],a[140:143]
s_waitcnt lgkmcnt(1)
v_mfma_f32_16x16x32_bf16 a[160:163],v[56:59],v[96:99],a[160:163]
ds_read_b128 v[104:107],v115 offset:12288
v_mfma_f32_16x16x32_bf16 a[164:167],v[60:63],v[96:99],a[164:167]
v_mfma_f32_16x16x32_bf16 a[168:171],v[96:99],v[64:67],a[168:171]
v_mfma_f32_16x16x32_bf16 a[172:175],v[96:99],v[68:71],a[172:175]
v_mfma_f32_16x16x32_bf16 a[176:179],v[96:99],v[72:75],a[176:179]
v_mfma_f32_16x16x32_bf16 a[180:183],v[96:99],v[76:79],a[180:183]
s_waitcnt lgkmcnt(1)
v_mfma_f32_16x16x32_bf16 a[200:203],v[56:59],v[100:103],a[200:203]
ds_read_b128 v[108:111],v115 offset:14336
v_mfma_f32_16x16x32_bf16 a[204:207],v[60:63],v[100:103],a[204:207]
v_mfma_f32_16x16x32_bf16 a[208:211],v[100:103],v[64:67],a[208:211]
v_mfma_f32_16x16x32_bf16 a[212:215],v[100:103],v[68:71],a[212:215]
v_mfma_f32_16x16x32_bf16 a[216:219],v[100:103],v[72:75],a[216:219]
v_mfma_f32_16x16x32_bf16 a[220:223],v[100:103],v[76:79],a[220:223]
s_waitcnt lgkmcnt(1)
v_mfma_f32_16x16x32_bf16 a[240:243],v[56:59],v[104:107],a[240:243]
ds_read_b128 v[96:99],v113
v_mfma_f32_16x16x32_bf16 a[244:247],v[60:63],v[104:107],a[244:247]
v_mfma_f32_16x16x32_bf16 a[248:251],v[104:107],v[64:67],a[248:251]
v_mfma_f32_16x16x32_bf16 a[252:255],v[104:107],v[68:71],a[252:255]
v_mfma_f32_16x16x32_bf16 v[192:195],v[104:107],v[72:75],v[192:195]
v_mfma_f32_16x16x32_bf16 v[196:199],v[104:107],v[76:79],v[196:199]
s_waitcnt lgkmcnt(1)
v_mfma_f32_16x16x32_bf16 v[216:219],v[56:59],v[108:111],v[216:219]
ds_read_b128 v[100:103],v113 offset:2048
v_mfma_f32_16x16x32_bf16 v[220:223],v[60:63],v[108:111],v[220:223]
v_mfma_f32_16x16x32_bf16 v[224:227],v[108:111],v[64:67],v[224:227]
v_mfma_f32_16x16x32_bf16 v[228:231],v[108:111],v[68:71],v[228:231]
v_mfma_f32_16x16x32_bf16 v[232:235],v[108:111],v[72:75],v[232:235]
v_mfma_f32_16x16x32_bf16 v[236:239],v[108:111],v[76:79],v[236:239]
s_cbranch_vccnz .Lce43
v_smfmac_f32_16x16x64_bf16 v[144:147],v[164:167],v[56:63],v143
v_smfmac_f32_16x16x64_bf16 v[148:151],v[164:167],v[64:71],v143
v_smfmac_f32_16x16x64_bf16 v[152:155],v[164:167],v[72:79],v143
.Lce43:
s_waitcnt lgkmcnt(1)
v_mfma_f32_16x16x32_bf16 a[24:27],v[80:83],v[96:99],a[24:27]
ds_read_b128 v[104:107],v113 offset:4096
v_lshrrev_b32 v3,5,v2
v_mfma_f32_16x16x32_bf16 a[28:31],v[84:87],v[96:99],a[28:31]
v_bfe_u32 v4,v2,4,1
v_lshlrev_b32 v3,10,v3
v_mfma_f32_16x16x32_bf16 a[32:35],v[88:91],v[96:99],a[32:35]
v_lshl_add_u32 v3,v4,9,v3
v_and_b32 v5,15,v2
v_mfma_f32_16x16x32_bf16 a[36:39],v[92:95],v[96:99],a[36:39]
v_lshl_add_u32 v8,v5,4,v3
v_bfe_u32 v6,v2,2,2
s_waitcnt lgkmcnt(1)
v_mfma_f32_16x16x32_bf16 a[64:67],v[80:83],v[100:103],a[64:67]
ds_read_b128 v[108:111],v113 offset:6144
v_and_b32 v7,3,v2
v_mfma_f32_16x16x32_bf16 a[68:71],v[84:87],v[100:103],a[68:71]
v_lshl_add_u32 v6,v6,3,v7
v_lshl_add_u32 v12,v6,4,v3
v_mfma_f32_16x16x32_bf16 a[72:75],v[88:91],v[100:103],a[72:75]
s_mul_i32 s48,s41,1280
s_add_u32 s48,s48,147456
v_mfma_f32_16x16x32_bf16 a[76:79],v[92:95],v[100:103],a[76:79]
v_lshl_add_u32 v7,v5,2,s48
s_mul_i32 s49,s40,640
s_waitcnt lgkmcnt(1)
v_mfma_f32_16x16x32_bf16 a[104:107],v[80:83],v[104:107],a[104:107]
ds_read_b128 v[96:99],v113 offset:8192
v_add_u32 v11,s49,v7
v_mfma_f32_16x16x32_bf16 a[108:111],v[84:87],v[104:107],a[108:111]
v_cmp_gt_u32 s[46:47],16,v2
v_mov_b32 v10,153600
v_mfma_f32_16x16x32_bf16 a[112:115],v[88:91],v[104:107],a[112:115]
v_lshrrev_b32 v6,4,v2
v_lshl_add_u32 v13,v6,4,s48
v_mfma_f32_16x16x32_bf16 a[116:119],v[92:95],v[104:107],a[116:119]
s_lshl_b32 s48,s40,9
s_add_u32 s48,s48,155648
s_waitcnt lgkmcnt(1)
v_mfma_f32_16x16x32_bf16 a[144:147],v[80:83],v[108:111],a[144:147]
ds_read_b128 v[100:103],v113 offset:10240
v_lshl_add_u32 v14,v5,2,s48
v_mfma_f32_16x16x32_bf16 a[148:151],v[84:87],v[108:111],a[148:151]
v_lshl_add_u32 v15,v6,4,s48
v_cndmask_b32 v11,v10,v11,s[46:47]
v_mfma_f32_16x16x32_bf16 a[152:155],v[88:91],v[108:111],a[152:155]
v_add_f32 v168,v144,v145
v_add_f32 v169,v146,v147
v_mfma_f32_16x16x32_bf16 a[156:159],v[92:95],v[108:111],a[156:159]
v_add_f32 v170,v148,v149
v_add_f32 v171,v150,v151
s_waitcnt lgkmcnt(1)
v_mfma_f32_16x16x32_bf16 a[184:187],v[80:83],v[96:99],a[184:187]
ds_read_b128 v[104:107],v113 offset:12288
v_add_f32 v172,v152,v153
v_mfma_f32_16x16x32_bf16 a[188:191],v[84:87],v[96:99],a[188:191]
v_add_f32 v173,v154,v155
ds_write_b32 v11,v168
v_mfma_f32_16x16x32_bf16 a[192:195],v[88:91],v[96:99],a[192:195]
ds_write_b32 v11,v169 offset:64
ds_write_b32 v11,v170 offset:128
v_mfma_f32_16x16x32_bf16 a[196:199],v[92:95],v[96:99],a[196:199]
ds_write_b32 v11,v171 offset:192
ds_write_b32 v11,v172 offset:256
s_waitcnt lgkmcnt(6)
v_mfma_f32_16x16x32_bf16 a[224:227],v[80:83],v[100:103],a[224:227]
ds_read_b128 v[108:111],v113 offset:14336
ds_write_b32 v11,v173 offset:320
v_mfma_f32_16x16x32_bf16 a[228:231],v[84:87],v[100:103],a[228:231]
s_lshl_b32 s51,s34,14
s_lshl_b32 s56,s40,13
v_mfma_f32_16x16x32_bf16 a[232:235],v[88:91],v[100:103],a[232:235]
s_add_u32 s51,s51,s56
s_and_b32 s56,s35,7
v_mfma_f32_16x16x32_bf16 a[236:239],v[92:95],v[100:103],a[236:239]
s_lshl_b32 s56,s56,1
s_bfe_u32 s59,s35,0x10003
s_waitcnt lgkmcnt(7)
v_mfma_f32_16x16x32_bf16 v[200:203],v[80:83],v[104:107],v[200:203]
ds_read_b128 v[96:99],v114
s_add_u32 s56,s56,s59
v_mfma_f32_16x16x32_bf16 v[204:207],v[84:87],v[104:107],v[204:207]
s_lshl_b32 s56,s56,1
s_add_u32 s59,s56,s41
v_mfma_f32_16x16x32_bf16 v[208:211],v[88:91],v[104:107],v[208:211]
s_cmp_lt_u32 s35,16
s_cselect_b32 s46,17,18
s_mov_b32 s44,126912
s_cselect_b32 s44,-6400,s44
s_mov_b32 s45,0x800000
s_cselect_b32 s45,0x401000,s45
s_cselect_b32 s56,256,64
s_mov_b32 s57,0xfc0
s_cselect_b32 s57,0x700,s57
s_cselect_b32 s58,0x3e8293ee,1.0
s_cselect_b64 s[48:49],-1,0
s_lshl_b32 s59,s59,s46
v_mfma_f32_16x16x32_bf16 v[212:215],v[92:95],v[104:107],v[212:215]
s_add_u32 s45,s45,s59
s_add_u32 s45,s45,s51
s_waitcnt lgkmcnt(2)
v_mfma_f32_16x16x32_bf16 v[240:243],v[80:83],v[108:111],v[240:243]
ds_read_b128 v[100:103],v114 offset:2048
v_cndmask_b32 v8,v12,v8,s[48:49]
v_mfma_f32_16x16x32_bf16 v[244:247],v[84:87],v[108:111],v[244:247]
s_waitcnt lgkmcnt(0)
s_barrier
ds_read_b128 v[16:19],v13
v_mfma_f32_16x16x32_bf16 v[248:251],v[88:91],v[108:111],v[248:251]
ds_read_b128 v[20:23],v13 offset:64
v_add_u32 v6,1024,v14
v_mfma_f32_16x16x32_bf16 v[252:255],v[92:95],v[108:111],v[252:255]
ds_read2_b32 v[56:57],v14 offset0:0 offset1:16
ds_read2_b32 v[58:59],v14 offset0:32 offset1:48
s_cbranch_vccz .Lce44
v_smfmac_f32_16x16x64_bf16 v[156:159],v[164:167],v[80:87],v143
v_smfmac_f32_16x16x64_bf16 v[160:163],v[164:167],v[88:95],v143
.Lce44:
v_mfma_f32_16x16x32_bf16 a[24:27],v[40:43],v[96:99],a[24:27]
ds_read_b128 v[104:107],v114 offset:4096
ds_read_b64_tr_b16 v[80:81],v118 offset:12288
v_mfma_f32_16x16x32_bf16 a[28:31],v[44:47],v[96:99],a[28:31]
ds_read_b64_tr_b16 v[82:83],v118 offset:13312
ds_read_b64_tr_b16 v[84:85],v119 offset:12288
v_mfma_f32_16x16x32_bf16 a[32:35],v[48:51],v[96:99],a[32:35]
ds_read_b64_tr_b16 v[86:87],v119 offset:13312
ds_read_b64_tr_b16 v[88:89],v118 offset:16384
v_mfma_f32_16x16x32_bf16 a[36:39],v[52:55],v[96:99],a[36:39]
ds_read_b64_tr_b16 v[90:91],v118 offset:17408
ds_read_b64_tr_b16 v[92:93],v119 offset:16384
v_mfma_f32_16x16x32_bf16 a[64:67],v[40:43],v[100:103],a[64:67]
ds_read_b128 v[108:111],v114 offset:6144
ds_read_b64_tr_b16 v[94:95],v119 offset:17408
v_mfma_f32_16x16x32_bf16 a[68:71],v[44:47],v[100:103],a[68:71]
ds_read2_b32 v[60:61],v14 offset0:64 offset1:80
s_waitcnt lgkmcnt(11)
ds_read2_b32 v[62:63],v14 offset0:96 offset1:112
v_mfma_f32_16x16x32_bf16 a[72:75],v[48:51],v[100:103],a[72:75]
ds_read2_b32 v[168:169],v6 offset0:0 offset1:16
ds_read2_b32 v[170:171],v6 offset0:32 offset1:48
v_mfma_f32_16x16x32_bf16 a[76:79],v[52:55],v[100:103],a[76:79]
ds_read2_b32 v[172:173],v6 offset0:64 offset1:80
s_waitcnt lgkmcnt(11)
ds_read2_b32 v[174:175],v6 offset0:96 offset1:112
v_mfma_f32_16x16x32_bf16 a[104:107],v[40:43],v[104:107],a[104:107]
ds_read_b128 v[96:99],v114 offset:8192
s_waitcnt lgkmcnt(5)
v_mfma_f32_16x16x32_bf16 a[108:111],v[44:47],v[104:107],a[108:111]
v_mul_f32 v56,s58,v56
v_mul_f32 v57,s58,v57
v_mfma_f32_16x16x32_bf16 a[112:115],v[48:51],v[104:107],a[112:115]
v_mul_f32 v58,s58,v58
v_mul_f32 v59,s58,v59
v_mfma_f32_16x16x32_bf16 a[116:119],v[52:55],v[104:107],a[116:119]
v_mul_f32 v60,s58,v60
v_mul_f32 v61,s58,v61
v_mfma_f32_16x16x32_bf16 a[144:147],v[40:43],v[108:111],a[144:147]
ds_read_b128 v[100:103],v114 offset:10240
v_mul_f32 v62,s58,v62
v_mfma_f32_16x16x32_bf16 a[148:151],v[44:47],v[108:111],a[148:151]
v_mul_f32 v63,s58,v63
s_waitcnt lgkmcnt(2)
v_mfma_f32_16x16x32_bf16 a[152:155],v[48:51],v[108:111],a[152:155]
v_accvgpr_read_b32 v176,a160
v_accvgpr_read_b32 v177,a161
v_mfma_f32_16x16x32_bf16 a[156:159],v[52:55],v[108:111],a[156:159]
v_accvgpr_read_b32 v178,a162
v_accvgpr_read_b32 v179,a163
s_waitcnt lgkmcnt(1)
v_mfma_f32_16x16x32_bf16 a[184:187],v[40:43],v[96:99],a[184:187]
ds_read_b128 v[104:107],v114 offset:12288
v_fma_f32 v176,v16,v172,v176
v_mfma_f32_16x16x32_bf16 a[188:191],v[44:47],v[96:99],a[188:191]
v_fma_f32 v177,v17,v172,v177
v_fma_f32 v178,v18,v172,v178
v_mfma_f32_16x16x32_bf16 a[192:195],v[48:51],v[96:99],a[192:195]
v_fma_f32 v179,v19,v172,v179
v_mul_f32 v176,v176,v60
v_mfma_f32_16x16x32_bf16 a[196:199],v[52:55],v[96:99],a[196:199]
v_mul_f32 v177,v177,v60
v_mul_f32 v178,v178,v60
s_waitcnt lgkmcnt(1)
v_mfma_f32_16x16x32_bf16 a[224:227],v[40:43],v[100:103],a[224:227]
ds_read_b128 v[108:111],v114 offset:14336
v_mul_f32 v179,v179,v60
v_mfma_f32_16x16x32_bf16 a[228:231],v[44:47],v[100:103],a[228:231]
v_accvgpr_read_b32 v180,a164
v_accvgpr_read_b32 v181,a165
v_mfma_f32_16x16x32_bf16 a[232:235],v[48:51],v[100:103],a[232:235]
v_accvgpr_read_b32 v182,a166
v_accvgpr_read_b32 v183,a167
v_mfma_f32_16x16x32_bf16 a[236:239],v[52:55],v[100:103],a[236:239]
v_fma_f32 v180,v20,v172,v180
v_fma_f32 v181,v21,v172,v181
s_waitcnt lgkmcnt(1)
v_mfma_f32_16x16x32_bf16 v[200:203],v[40:43],v[104:107],v[200:203]
ds_read_b128 v[96:99],v115
v_fma_f32 v182,v22,v172,v182
v_mfma_f32_16x16x32_bf16 v[204:207],v[44:47],v[104:107],v[204:207]
v_fma_f32 v183,v23,v172,v183
v_mul_f32 v180,v180,v60
v_mfma_f32_16x16x32_bf16 v[208:211],v[48:51],v[104:107],v[208:211]
v_mul_f32 v181,v181,v60
v_mul_f32 v182,v182,v60
v_mfma_f32_16x16x32_bf16 v[212:215],v[52:55],v[104:107],v[212:215]
v_mul_f32 v183,v183,v60
v_cvt_pk_bf16_f32 v184,v176,v177
s_waitcnt lgkmcnt(1)
v_mfma_f32_16x16x32_bf16 v[240:243],v[40:43],v[108:111],v[240:243]
ds_read_b128 v[100:103],v115 offset:2048
v_cvt_pk_bf16_f32 v185,v178,v179
v_mfma_f32_16x16x32_bf16 v[244:247],v[44:47],v[108:111],v[244:247]
v_cvt_pk_bf16_f32 v186,v180,v181
v_cvt_pk_bf16_f32 v187,v182,v183
v_mfma_f32_16x16x32_bf16 v[248:251],v[48:51],v[108:111],v[248:251]
buffer_store_dwordx4 v[184:187],v8,s[20:23],s45 offen sc1
s_add_u32 s45,s45,s56
v_mfma_f32_16x16x32_bf16 v[252:255],v[52:55],v[108:111],v[252:255]
v_accvgpr_read_b32 v176,a200
v_accvgpr_read_b32 v177,a201
s_cbranch_vccz .Lce45
v_smfmac_f32_16x16x64_bf16 v[156:159],v[164:167],v[40:47],v143
v_smfmac_f32_16x16x64_bf16 v[160:163],v[164:167],v[48:55],v143
.Lce45:
s_waitcnt lgkmcnt(1)
v_mfma_f32_16x16x32_bf16 a[24:27],v[80:83],v[96:99],a[24:27]
ds_read_b128 v[104:107],v115 offset:4096
v_accvgpr_read_b32 v178,a202
v_mfma_f32_16x16x32_bf16 a[28:31],v[84:87],v[96:99],a[28:31]
v_accvgpr_read_b32 v179,a203
v_fma_f32 v176,v16,v173,v176
v_mfma_f32_16x16x32_bf16 a[32:35],v[88:91],v[96:99],a[32:35]
v_fma_f32 v177,v17,v173,v177
v_fma_f32 v178,v18,v173,v178
v_mfma_f32_16x16x32_bf16 a[36:39],v[92:95],v[96:99],a[36:39]
v_fma_f32 v179,v19,v173,v179
v_mul_f32 v176,v176,v61
s_waitcnt lgkmcnt(1)
v_mfma_f32_16x16x32_bf16 a[64:67],v[80:83],v[100:103],a[64:67]
ds_read_b128 v[108:111],v115 offset:6144
v_mul_f32 v177,v177,v61
v_mfma_f32_16x16x32_bf16 a[68:71],v[84:87],v[100:103],a[68:71]
v_mul_f32 v178,v178,v61
v_mul_f32 v179,v179,v61
v_mfma_f32_16x16x32_bf16 a[72:75],v[88:91],v[100:103],a[72:75]
v_accvgpr_read_b32 v180,a204
v_accvgpr_read_b32 v181,a205
v_mfma_f32_16x16x32_bf16 a[76:79],v[92:95],v[100:103],a[76:79]
v_accvgpr_read_b32 v182,a206
v_accvgpr_read_b32 v183,a207
s_waitcnt lgkmcnt(1)
v_mfma_f32_16x16x32_bf16 a[104:107],v[80:83],v[104:107],a[104:107]
ds_read_b128 v[96:99],v115 offset:8192
v_fma_f32 v180,v20,v173,v180
v_mfma_f32_16x16x32_bf16 a[108:111],v[84:87],v[104:107],a[108:111]
v_fma_f32 v181,v21,v173,v181
v_fma_f32 v182,v22,v173,v182
v_mfma_f32_16x16x32_bf16 a[112:115],v[88:91],v[104:107],a[112:115]
v_fma_f32 v183,v23,v173,v183
v_mul_f32 v180,v180,v61
v_mfma_f32_16x16x32_bf16 a[116:119],v[92:95],v[104:107],a[116:119]
v_mul_f32 v181,v181,v61
v_mul_f32 v182,v182,v61
s_waitcnt lgkmcnt(1)
v_mfma_f32_16x16x32_bf16 a[144:147],v[80:83],v[108:111],a[144:147]
ds_read_b128 v[100:103],v115 offset:10240
v_mul_f32 v183,v183,v61
v_mfma_f32_16x16x32_bf16 a[148:151],v[84:87],v[108:111],a[148:151]
v_cvt_pk_bf16_f32 v188,v176,v177
v_cvt_pk_bf16_f32 v189,v178,v179
v_mfma_f32_16x16x32_bf16 a[152:155],v[88:91],v[108:111],a[152:155]
v_cvt_pk_bf16_f32 v190,v180,v181
v_cvt_pk_bf16_f32 v191,v182,v183
v_mfma_f32_16x16x32_bf16 a[156:159],v[92:95],v[108:111],a[156:159]
buffer_store_dwordx4 v[188:191],v8,s[20:23],s45 offen sc1
s_add_u32 s45,s45,s57
s_waitcnt lgkmcnt(1)
v_mfma_f32_16x16x32_bf16 a[184:187],v[80:83],v[96:99],a[184:187]
ds_read_b128 v[104:107],v115 offset:12288
v_accvgpr_read_b32 v176,a240
v_mfma_f32_16x16x32_bf16 a[188:191],v[84:87],v[96:99],a[188:191]
v_accvgpr_read_b32 v177,a241
v_accvgpr_read_b32 v178,a242
v_mfma_f32_16x16x32_bf16 a[192:195],v[88:91],v[96:99],a[192:195]
v_accvgpr_read_b32 v179,a243
v_fma_f32 v176,v16,v174,v176
v_mfma_f32_16x16x32_bf16 a[196:199],v[92:95],v[96:99],a[196:199]
v_fma_f32 v177,v17,v174,v177
v_fma_f32 v178,v18,v174,v178
s_waitcnt lgkmcnt(1)
v_mfma_f32_16x16x32_bf16 a[224:227],v[80:83],v[100:103],a[224:227]
ds_read_b128 v[108:111],v115 offset:14336
v_fma_f32 v179,v19,v174,v179
v_mfma_f32_16x16x32_bf16 a[228:231],v[84:87],v[100:103],a[228:231]
v_mul_f32 v176,v176,v62
v_mul_f32 v177,v177,v62
v_mfma_f32_16x16x32_bf16 a[232:235],v[88:91],v[100:103],a[232:235]
v_mul_f32 v178,v178,v62
v_mul_f32 v179,v179,v62
v_mfma_f32_16x16x32_bf16 a[236:239],v[92:95],v[100:103],a[236:239]
v_accvgpr_read_b32 v180,a244
v_accvgpr_read_b32 v181,a245
s_waitcnt lgkmcnt(1)
v_mfma_f32_16x16x32_bf16 v[200:203],v[80:83],v[104:107],v[200:203]
v_accvgpr_read_b32 v182,a246
v_accvgpr_read_b32 v183,a247
v_mfma_f32_16x16x32_bf16 v[204:207],v[84:87],v[104:107],v[204:207]
v_fma_f32 v180,v20,v174,v180
v_fma_f32 v181,v21,v174,v181
v_mfma_f32_16x16x32_bf16 v[208:211],v[88:91],v[104:107],v[208:211]
v_fma_f32 v182,v22,v174,v182
v_fma_f32 v183,v23,v174,v183
v_mfma_f32_16x16x32_bf16 v[212:215],v[92:95],v[104:107],v[212:215]
v_mul_f32 v180,v180,v62
v_mul_f32 v181,v181,v62
s_waitcnt lgkmcnt(0)
v_mfma_f32_16x16x32_bf16 v[240:243],v[80:83],v[108:111],v[240:243]
v_mul_f32 v182,v182,v62
v_mul_f32 v183,v183,v62
v_mfma_f32_16x16x32_bf16 v[244:247],v[84:87],v[108:111],v[244:247]
v_cvt_pk_bf16_f32 v184,v176,v177
v_cvt_pk_bf16_f32 v185,v178,v179
v_mfma_f32_16x16x32_bf16 v[248:251],v[88:91],v[108:111],v[248:251]
v_cvt_pk_bf16_f32 v186,v180,v181
v_cvt_pk_bf16_f32 v187,v182,v183
v_mfma_f32_16x16x32_bf16 v[252:255],v[92:95],v[108:111],v[252:255]
buffer_store_dwordx4 v[184:187],v8,s[20:23],s45 offen sc1
s_add_u32 s45,s45,s56
s_cbranch_vccz .Lce46
v_smfmac_f32_16x16x64_bf16 v[156:159],v[164:167],v[80:87],v143
v_smfmac_f32_16x16x64_bf16 v[160:163],v[164:167],v[88:95],v143
.Lce46:
v_fma_f32 v176,v16,v175,v216
v_fma_f32 v177,v17,v175,v217
v_fma_f32 v178,v18,v175,v218
v_fma_f32 v179,v19,v175,v219
v_mul_f32 v176,v176,v63
v_mul_f32 v177,v177,v63
v_mul_f32 v178,v178,v63
v_mul_f32 v179,v179,v63
v_fma_f32 v180,v20,v175,v220
v_fma_f32 v181,v21,v175,v221
v_fma_f32 v182,v22,v175,v222
v_fma_f32 v183,v23,v175,v223
v_mul_f32 v180,v180,v63
v_mul_f32 v181,v181,v63
v_mul_f32 v182,v182,v63
v_mul_f32 v183,v183,v63
v_cvt_pk_bf16_f32 v188,v176,v177
v_cvt_pk_bf16_f32 v189,v178,v179
v_cvt_pk_bf16_f32 v190,v180,v181
v_cvt_pk_bf16_f32 v191,v182,v183
buffer_store_dwordx4 v[188:191],v8,s[20:23],s45 offen sc1
s_add_u32 s45,s45,s44
ds_read2_b32 v[24:25],v7 offset0:32 offset1:48
ds_read2_b32 v[26:27],v7 offset0:64 offset1:80
ds_read_b128 v[64:67],v15 offset:256
ds_read_b128 v[72:75],v15 offset:1280
ds_read_b128 v[68:71],v15 offset:320
ds_read_b128 v[76:79],v15 offset:1344
ds_read_b128 v[28:31],v15 offset:384
ds_read_b128 v[56:59],v15 offset:1408
ds_read_b128 v[32:35],v15 offset:448
ds_read_b128 v[60:63],v15 offset:1472
v_and_b32 v6,7,v2
v_and_b32 v12,8,v2
v_lshl_add_u32 v6,v12,1,v6
v_lshl_add_u32 v12,v6,4,v3
s_sub_u32 s46,s35,24
s_lshl_b32 s46,s46,1
s_add_u32 s46,s46,s41
s_lshl_b32 s46,s46,19
s_add_u32 s46,s46,s51
s_add_u32 s46,s46,0x800800
s_add_u32 s47,s46,0x40000
s_waitcnt lgkmcnt(0)
v_accvgpr_read_b32 v176,a168
v_accvgpr_read_b32 v177,a169
v_accvgpr_read_b32 v178,a170
v_accvgpr_read_b32 v179,a171
v_pk_fma_f32 v[176:177],v[72:73],v[24:25],v[176:177] op_sel:[0,0,0] op_sel_hi:[1,0,1]
v_pk_fma_f32 v[178:179],v[74:75],v[24:25],v[178:179] op_sel:[0,0,0] op_sel_hi:[1,0,1]
v_pk_mul_f32 v[176:177],v[176:177],v[64:65]
v_pk_mul_f32 v[178:179],v[178:179],v[66:67]
v_accvgpr_read_b32 v180,a208
v_accvgpr_read_b32 v181,a209
v_accvgpr_read_b32 v182,a210
v_accvgpr_read_b32 v183,a211
v_pk_fma_f32 v[180:181],v[76:77],v[24:25],v[180:181] op_sel:[0,0,0] op_sel_hi:[1,0,1]
v_pk_fma_f32 v[182:183],v[78:79],v[24:25],v[182:183] op_sel:[0,0,0] op_sel_hi:[1,0,1]
v_pk_mul_f32 v[180:181],v[180:181],v[68:69]
v_pk_mul_f32 v[182:183],v[182:183],v[70:71]
v_cvt_pk_bf16_f32 v184,v176,v177
v_cvt_pk_bf16_f32 v185,v178,v179
v_cvt_pk_bf16_f32 v186,v180,v181
v_cvt_pk_bf16_f32 v187,v182,v183
buffer_store_dwordx4 v[184:187],v12,s[20:23],s46 offen sc1
v_accvgpr_read_b32 v176,a172
v_accvgpr_read_b32 v177,a173
v_accvgpr_read_b32 v178,a174
v_accvgpr_read_b32 v179,a175
v_pk_fma_f32 v[176:177],v[72:73],v[24:25],v[176:177] op_sel:[0,1,0] op_sel_hi:[1,1,1]
v_pk_fma_f32 v[178:179],v[74:75],v[24:25],v[178:179] op_sel:[0,1,0] op_sel_hi:[1,1,1]
v_pk_mul_f32 v[176:177],v[176:177],v[64:65]
v_pk_mul_f32 v[178:179],v[178:179],v[66:67]
v_accvgpr_read_b32 v180,a212
v_accvgpr_read_b32 v181,a213
v_accvgpr_read_b32 v182,a214
v_accvgpr_read_b32 v183,a215
v_pk_fma_f32 v[180:181],v[76:77],v[24:25],v[180:181] op_sel:[0,1,0] op_sel_hi:[1,1,1]
v_pk_fma_f32 v[182:183],v[78:79],v[24:25],v[182:183] op_sel:[0,1,0] op_sel_hi:[1,1,1]
v_pk_mul_f32 v[180:181],v[180:181],v[68:69]
v_pk_mul_f32 v[182:183],v[182:183],v[70:71]
v_cvt_pk_bf16_f32 v188,v176,v177
v_cvt_pk_bf16_f32 v189,v178,v179
v_cvt_pk_bf16_f32 v190,v180,v181
v_cvt_pk_bf16_f32 v191,v182,v183
buffer_store_dwordx4 v[188:191],v12,s[20:23],s46 offen offset:128 sc1
v_accvgpr_read_b32 v176,a176
v_accvgpr_read_b32 v177,a177
v_accvgpr_read_b32 v178,a178
v_accvgpr_read_b32 v179,a179
v_pk_fma_f32 v[176:177],v[72:73],v[26:27],v[176:177] op_sel:[0,0,0] op_sel_hi:[1,0,1]
v_pk_fma_f32 v[178:179],v[74:75],v[26:27],v[178:179] op_sel:[0,0,0] op_sel_hi:[1,0,1]
v_pk_mul_f32 v[176:177],v[176:177],v[64:65]
v_pk_mul_f32 v[178:179],v[178:179],v[66:67]
v_accvgpr_read_b32 v180,a216
v_accvgpr_read_b32 v181,a217
v_accvgpr_read_b32 v182,a218
v_accvgpr_read_b32 v183,a219
v_pk_fma_f32 v[180:181],v[76:77],v[26:27],v[180:181] op_sel:[0,0,0] op_sel_hi:[1,0,1]
v_pk_fma_f32 v[182:183],v[78:79],v[26:27],v[182:183] op_sel:[0,0,0] op_sel_hi:[1,0,1]
v_pk_mul_f32 v[180:181],v[180:181],v[68:69]
v_pk_mul_f32 v[182:183],v[182:183],v[70:71]
v_cvt_pk_bf16_f32 v184,v176,v177
v_cvt_pk_bf16_f32 v185,v178,v179
v_cvt_pk_bf16_f32 v186,v180,v181
v_cvt_pk_bf16_f32 v187,v182,v183
buffer_store_dwordx4 v[184:187],v12,s[20:23],s47 offen sc1
v_accvgpr_read_b32 v176,a180
v_accvgpr_read_b32 v177,a181
v_accvgpr_read_b32 v178,a182
v_accvgpr_read_b32 v179,a183
v_pk_fma_f32 v[176:177],v[72:73],v[26:27],v[176:177] op_sel:[0,1,0] op_sel_hi:[1,1,1]
v_pk_fma_f32 v[178:179],v[74:75],v[26:27],v[178:179] op_sel:[0,1,0] op_sel_hi:[1,1,1]
v_pk_mul_f32 v[176:177],v[176:177],v[64:65]
v_pk_mul_f32 v[178:179],v[178:179],v[66:67]
v_accvgpr_read_b32 v180,a220
v_accvgpr_read_b32 v181,a221
v_accvgpr_read_b32 v182,a222
v_accvgpr_read_b32 v183,a223
v_pk_fma_f32 v[180:181],v[76:77],v[26:27],v[180:181] op_sel:[0,1,0] op_sel_hi:[1,1,1]
v_pk_fma_f32 v[182:183],v[78:79],v[26:27],v[182:183] op_sel:[0,1,0] op_sel_hi:[1,1,1]
v_pk_mul_f32 v[180:181],v[180:181],v[68:69]
v_pk_mul_f32 v[182:183],v[182:183],v[70:71]
v_cvt_pk_bf16_f32 v188,v176,v177
v_cvt_pk_bf16_f32 v189,v178,v179
v_cvt_pk_bf16_f32 v190,v180,v181
v_cvt_pk_bf16_f32 v191,v182,v183
buffer_store_dwordx4 v[188:191],v12,s[20:23],s47 offen offset:128 sc1
s_add_u32 s46,s46,4096
s_add_u32 s47,s47,4096
v_accvgpr_read_b32 v176,a248
v_accvgpr_read_b32 v177,a249
v_accvgpr_read_b32 v178,a250
v_accvgpr_read_b32 v179,a251
v_pk_fma_f32 v[176:177],v[56:57],v[24:25],v[176:177] op_sel:[0,0,0] op_sel_hi:[1,0,1]
v_pk_fma_f32 v[178:179],v[58:59],v[24:25],v[178:179] op_sel:[0,0,0] op_sel_hi:[1,0,1]
v_pk_mul_f32 v[176:177],v[176:177],v[28:29]
v_pk_mul_f32 v[178:179],v[178:179],v[30:31]
v_pk_fma_f32 v[180:181],v[60:61],v[24:25],v[224:225] op_sel:[0,0,0] op_sel_hi:[1,0,1]
v_pk_fma_f32 v[182:183],v[62:63],v[24:25],v[226:227] op_sel:[0,0,0] op_sel_hi:[1,0,1]
v_pk_mul_f32 v[180:181],v[180:181],v[32:33]
v_pk_mul_f32 v[182:183],v[182:183],v[34:35]
v_cvt_pk_bf16_f32 v184,v176,v177
v_cvt_pk_bf16_f32 v185,v178,v179
v_cvt_pk_bf16_f32 v186,v180,v181
v_cvt_pk_bf16_f32 v187,v182,v183
buffer_store_dwordx4 v[184:187],v12,s[20:23],s46 offen sc1
v_accvgpr_read_b32 v176,a252
v_accvgpr_read_b32 v177,a253
v_accvgpr_read_b32 v178,a254
v_accvgpr_read_b32 v179,a255
v_pk_fma_f32 v[176:177],v[56:57],v[24:25],v[176:177] op_sel:[0,1,0] op_sel_hi:[1,1,1]
v_pk_fma_f32 v[178:179],v[58:59],v[24:25],v[178:179] op_sel:[0,1,0] op_sel_hi:[1,1,1]
v_pk_mul_f32 v[176:177],v[176:177],v[28:29]
v_pk_mul_f32 v[178:179],v[178:179],v[30:31]
v_pk_fma_f32 v[180:181],v[60:61],v[24:25],v[228:229] op_sel:[0,1,0] op_sel_hi:[1,1,1]
v_pk_fma_f32 v[182:183],v[62:63],v[24:25],v[230:231] op_sel:[0,1,0] op_sel_hi:[1,1,1]
v_pk_mul_f32 v[180:181],v[180:181],v[32:33]
v_pk_mul_f32 v[182:183],v[182:183],v[34:35]
v_cvt_pk_bf16_f32 v188,v176,v177
v_cvt_pk_bf16_f32 v189,v178,v179
v_cvt_pk_bf16_f32 v190,v180,v181
v_cvt_pk_bf16_f32 v191,v182,v183
buffer_store_dwordx4 v[188:191],v12,s[20:23],s46 offen offset:128 sc1
v_pk_fma_f32 v[176:177],v[56:57],v[26:27],v[192:193] op_sel:[0,0,0] op_sel_hi:[1,0,1]
v_pk_fma_f32 v[178:179],v[58:59],v[26:27],v[194:195] op_sel:[0,0,0] op_sel_hi:[1,0,1]
v_pk_mul_f32 v[176:177],v[176:177],v[28:29]
v_pk_mul_f32 v[178:179],v[178:179],v[30:31]
v_pk_fma_f32 v[180:181],v[60:61],v[26:27],v[232:233] op_sel:[0,0,0] op_sel_hi:[1,0,1]
v_pk_fma_f32 v[182:183],v[62:63],v[26:27],v[234:235] op_sel:[0,0,0] op_sel_hi:[1,0,1]
v_pk_mul_f32 v[180:181],v[180:181],v[32:33]
v_pk_mul_f32 v[182:183],v[182:183],v[34:35]
v_cvt_pk_bf16_f32 v184,v176,v177
v_cvt_pk_bf16_f32 v185,v178,v179
v_cvt_pk_bf16_f32 v186,v180,v181
v_cvt_pk_bf16_f32 v187,v182,v183
buffer_store_dwordx4 v[184:187],v12,s[20:23],s47 offen sc1
v_pk_fma_f32 v[176:177],v[56:57],v[26:27],v[196:197] op_sel:[0,1,0] op_sel_hi:[1,1,1]
v_pk_fma_f32 v[178:179],v[58:59],v[26:27],v[198:199] op_sel:[0,1,0] op_sel_hi:[1,1,1]
v_pk_mul_f32 v[176:177],v[176:177],v[28:29]
v_pk_mul_f32 v[178:179],v[178:179],v[30:31]
v_pk_fma_f32 v[180:181],v[60:61],v[26:27],v[236:237] op_sel:[0,1,0] op_sel_hi:[1,1,1]
v_pk_fma_f32 v[182:183],v[62:63],v[26:27],v[238:239] op_sel:[0,1,0] op_sel_hi:[1,1,1]
v_pk_mul_f32 v[180:181],v[180:181],v[32:33]
v_pk_mul_f32 v[182:183],v[182:183],v[34:35]
v_cvt_pk_bf16_f32 v188,v176,v177
v_cvt_pk_bf16_f32 v189,v178,v179
v_cvt_pk_bf16_f32 v190,v180,v181
v_cvt_pk_bf16_f32 v191,v182,v183
buffer_store_dwordx4 v[188:191],v12,s[20:23],s47 offen offset:128 sc1
s_add_u32 s46,s46,126976
s_add_u32 s47,s47,126976
s_nop 7
v_add_f32 v100,v156,v157
v_add_f32 v101,v158,v159
v_add_f32 v102,v160,v161
v_add_f32 v103,v162,v163
ds_write_b32 v11,v100 offset:384
ds_write_b32 v11,v101 offset:448
ds_write_b32 v11,v102 offset:512
ds_write_b32 v11,v103 offset:576
v_lshrrev_b32 v3,5,v2
v_lshlrev_b32 v3,12,v3
v_lshl_add_u32 v3,v4,9,v3
v_lshl_add_u32 v150,v5,4,v3
v_add_u32 v6,1024,v14
v_add_u32 v152,2048,v14
v_add_u32 v153,3072,v14
ds_read_b128 v[128:131],v13
ds_read_b128 v[132:135],v13 offset:64
ds_read2_b32 v[136:137],v14 offset0:0 offset1:16
ds_read2_b32 v[138:139],v14 offset0:32 offset1:48
ds_read2_b32 v[140:141],v6 offset0:0 offset1:16
ds_read2_b32 v[142:143],v6 offset0:32 offset1:48
ds_read2_b32 v[144:145],v7 offset0:32 offset1:48
ds_read2_b32 v[146:147],v7 offset0:64 offset1:80
ds_read_b128 v[154:157],v15
ds_read_b128 v[162:165],v15 offset:1024
ds_read_b128 v[158:161],v15 offset:64
s_waitcnt lgkmcnt(11)
ds_read_b128 v[166:169],v15 offset:1088
v_mov_b32 v148,v12
ds_read2_b32 v[16:17],v6 offset0:0 offset1:16
ds_read2_b32 v[18:19],v6 offset0:32 offset1:48
ds_read2_b32 v[20:21],v6 offset0:64 offset1:80
s_waitcnt lgkmcnt(11)
ds_read2_b32 v[22:23],v6 offset0:96 offset1:112
ds_read2_b32 v[24:25],v152 offset0:0 offset1:16
ds_read2_b32 v[26:27],v152 offset0:32 offset1:48
ds_read2_b32 v[28:29],v152 offset0:64 offset1:80
s_waitcnt lgkmcnt(11)
ds_read2_b32 v[30:31],v152 offset0:96 offset1:112
ds_read2_b32 v[32:33],v153 offset0:0 offset1:16
ds_read2_b32 v[34:35],v153 offset0:32 offset1:48
ds_read2_b32 v[36:37],v153 offset0:64 offset1:80
s_waitcnt lgkmcnt(11)
ds_read2_b32 v[38:39],v153 offset0:96 offset1:112
s_lshl_b32 s52,s34,1
s_add_u32 s52,s52,s40
s_mul_i32 s52,s52,1179648
s_lshl_b32 s53,s35,1
s_add_u32 s54,s41,48
s_add_u32 s53,s53,s54
s_lshl_b32 s53,s53,13
s_add_u32 s52,s52,s53
s_add_u32 s52,s52,0x1000000
s_mov_b32 s53,0x80000000
s_waitcnt lgkmcnt(0)
s_barrier
ds_read_b128 v[112:115],v13 offset:1024
ds_read_b128 v[116:119],v13 offset:1088
ds_read_b128 v[120:123],v13 offset:1152
ds_read_b128 v[124:127],v13 offset:1216
s_waitcnt lgkmcnt(2)
v_pk_fma_f32 v[48:49],v[112:113],v[22:23],v[240:241] op_sel:[0,1,0] op_sel_hi:[1,1,1]
v_pk_fma_f32 v[50:51],v[114:115],v[22:23],v[242:243] op_sel:[0,1,0] op_sel_hi:[1,1,1]
v_pk_fma_f32 v[52:53],v[116:117],v[22:23],v[244:245] op_sel:[0,1,0] op_sel_hi:[1,1,1]
v_pk_fma_f32 v[54:55],v[118:119],v[22:23],v[246:247] op_sel:[0,1,0] op_sel_hi:[1,1,1]
v_pk_mul_f32 v[64:65],v[48:49],v[30:31] op_sel:[0,1] op_sel_hi:[1,1]
v_pk_mul_f32 v[66:67],v[50:51],v[30:31] op_sel:[0,1] op_sel_hi:[1,1]
v_pk_mul_f32 v[68:69],v[52:53],v[30:31] op_sel:[0,1] op_sel_hi:[1,1]
v_pk_mul_f32 v[70:71],v[54:55],v[30:31] op_sel:[0,1] op_sel_hi:[1,1]
v_exp_f32 v64,v64
v_exp_f32 v65,v65
v_exp_f32 v66,v66
v_exp_f32 v67,v67
v_exp_f32 v68,v68
v_exp_f32 v69,v69
v_exp_f32 v70,v70
v_exp_f32 v71,v71
s_waitcnt lgkmcnt(0)
v_pk_fma_f32 v[56:57],v[120:121],v[22:23],v[248:249] op_sel:[0,1,0] op_sel_hi:[1,1,1]
v_pk_fma_f32 v[58:59],v[122:123],v[22:23],v[250:251] op_sel:[0,1,0] op_sel_hi:[1,1,1]
v_pk_fma_f32 v[60:61],v[124:125],v[22:23],v[252:253] op_sel:[0,1,0] op_sel_hi:[1,1,1]
v_pk_fma_f32 v[62:63],v[126:127],v[22:23],v[254:255] op_sel:[0,1,0] op_sel_hi:[1,1,1]
v_pk_fma_f32 v[64:65],v[64:65],v[38:39],v[38:39] op_sel:[0,1,1] op_sel_hi:[1,1,1]
v_pk_fma_f32 v[66:67],v[66:67],v[38:39],v[38:39] op_sel:[0,1,1] op_sel_hi:[1,1,1]
v_pk_fma_f32 v[68:69],v[68:69],v[38:39],v[38:39] op_sel:[0,1,1] op_sel_hi:[1,1,1]
v_pk_fma_f32 v[70:71],v[70:71],v[38:39],v[38:39] op_sel:[0,1,1] op_sel_hi:[1,1,1]
v_rcp_f32 v64,v64
v_rcp_f32 v65,v65
v_rcp_f32 v66,v66
v_rcp_f32 v67,v67
v_rcp_f32 v68,v68
v_rcp_f32 v69,v69
v_rcp_f32 v70,v70
v_rcp_f32 v71,v71
v_pk_mul_f32 v[48:49],v[48:49],v[56:57]
v_pk_mul_f32 v[50:51],v[50:51],v[58:59]
v_pk_mul_f32 v[52:53],v[52:53],v[60:61]
v_pk_mul_f32 v[54:55],v[54:55],v[62:63]
v_pk_mul_f32 v[48:49],v[48:49],v[64:65]
v_pk_mul_f32 v[50:51],v[50:51],v[66:67]
v_pk_mul_f32 v[52:53],v[52:53],v[68:69]
v_pk_mul_f32 v[54:55],v[54:55],v[70:71]
v_cvt_pk_bf16_f32 v176,v48,v49
v_cvt_pk_bf16_f32 v177,v50,v51
v_cvt_pk_bf16_f32 v178,v52,v53
v_cvt_pk_bf16_f32 v179,v54,v55
ds_read_b128 v[240:243],v15 offset:128
ds_read_b128 v[248:251],v15 offset:1152
ds_read_b128 v[244:247],v15 offset:192
ds_read_b128 v[252:255],v15 offset:1216
s_waitcnt vmcnt(0) lgkmcnt(0)
s_barrier
s_lshl_b32 s62,s35,7
s_lshl_b32 s63,s34,2
s_add_u32 s62,s62,s63
s_add_u32 s62,s62,0x2700000
s_cmp_lg_u32 s31,0
s_cbranch_scc1 L_fqB
v_mov_b32 v10,1
v_mov_b32 v11,0
s_mov_b64 exec,1
buffer_store_dword v10,v11,s[20:23],s62 offen sc1
s_mov_b64 exec,-1
L_fqB:
v_pk_fma_f32 v[80:81],v[112:113],v[22:23],v[200:201] op_sel:[0,0,0] op_sel_hi:[1,0,1]
v_pk_fma_f32 v[82:83],v[114:115],v[22:23],v[202:203] op_sel:[0,0,0] op_sel_hi:[1,0,1]
v_pk_fma_f32 v[84:85],v[116:117],v[22:23],v[204:205] op_sel:[0,0,0] op_sel_hi:[1,0,1]
v_pk_fma_f32 v[86:87],v[118:119],v[22:23],v[206:207] op_sel:[0,0,0] op_sel_hi:[1,0,1]
v_pk_mul_f32 v[96:97],v[80:81],v[30:31] op_sel:[0,0] op_sel_hi:[1,0]
v_pk_mul_f32 v[98:99],v[82:83],v[30:31] op_sel:[0,0] op_sel_hi:[1,0]
v_pk_mul_f32 v[100:101],v[84:85],v[30:31] op_sel:[0,0] op_sel_hi:[1,0]
v_pk_mul_f32 v[102:103],v[86:87],v[30:31] op_sel:[0,0] op_sel_hi:[1,0]
v_exp_f32 v96,v96
v_exp_f32 v97,v97
v_exp_f32 v98,v98
v_exp_f32 v99,v99
v_exp_f32 v100,v100
v_exp_f32 v101,v101
v_exp_f32 v102,v102
v_exp_f32 v103,v103
v_pk_fma_f32 v[88:89],v[120:121],v[22:23],v[208:209] op_sel:[0,0,0] op_sel_hi:[1,0,1]
v_pk_fma_f32 v[90:91],v[122:123],v[22:23],v[210:211] op_sel:[0,0,0] op_sel_hi:[1,0,1]
v_pk_fma_f32 v[92:93],v[124:125],v[22:23],v[212:213] op_sel:[0,0,0] op_sel_hi:[1,0,1]
v_pk_fma_f32 v[94:95],v[126:127],v[22:23],v[214:215] op_sel:[0,0,0] op_sel_hi:[1,0,1]
v_pk_fma_f32 v[96:97],v[96:97],v[38:39],v[38:39] op_sel:[0,0,0] op_sel_hi:[1,0,0]
v_pk_fma_f32 v[98:99],v[98:99],v[38:39],v[38:39] op_sel:[0,0,0] op_sel_hi:[1,0,0]
v_pk_fma_f32 v[100:101],v[100:101],v[38:39],v[38:39] op_sel:[0,0,0] op_sel_hi:[1,0,0]
v_pk_fma_f32 v[102:103],v[102:103],v[38:39],v[38:39] op_sel:[0,0,0] op_sel_hi:[1,0,0]
v_rcp_f32 v96,v96
v_rcp_f32 v97,v97
v_rcp_f32 v98,v98
v_rcp_f32 v99,v99
v_rcp_f32 v100,v100
v_rcp_f32 v101,v101
v_rcp_f32 v102,v102
v_rcp_f32 v103,v103
v_pk_mul_f32 v[80:81],v[80:81],v[88:89]
v_pk_mul_f32 v[82:83],v[82:83],v[90:91]
v_pk_mul_f32 v[84:85],v[84:85],v[92:93]
v_pk_mul_f32 v[86:87],v[86:87],v[94:95]
v_pk_mul_f32 v[80:81],v[80:81],v[96:97]
v_pk_mul_f32 v[82:83],v[82:83],v[98:99]
v_pk_mul_f32 v[84:85],v[84:85],v[100:101]
v_pk_mul_f32 v[86:87],v[86:87],v[102:103]
v_cvt_pk_bf16_f32 v184,v80,v81
v_cvt_pk_bf16_f32 v185,v82,v83
v_cvt_pk_bf16_f32 v186,v84,v85
v_cvt_pk_bf16_f32 v187,v86,v87
v_accvgpr_read_b32 v48,a24
v_accvgpr_read_b32 v49,a25
v_accvgpr_read_b32 v50,a26
v_accvgpr_read_b32 v51,a27
v_accvgpr_read_b32 v52,a28
v_accvgpr_read_b32 v53,a29
v_accvgpr_read_b32 v54,a30
v_accvgpr_read_b32 v55,a31
v_pk_fma_f32 v[48:49],v[112:113],v[16:17],v[48:49] op_sel:[0,0,0] op_sel_hi:[1,0,1]
v_pk_fma_f32 v[50:51],v[114:115],v[16:17],v[50:51] op_sel:[0,0,0] op_sel_hi:[1,0,1]
v_pk_fma_f32 v[52:53],v[116:117],v[16:17],v[52:53] op_sel:[0,0,0] op_sel_hi:[1,0,1]
v_pk_fma_f32 v[54:55],v[118:119],v[16:17],v[54:55] op_sel:[0,0,0] op_sel_hi:[1,0,1]
v_pk_mul_f32 v[64:65],v[48:49],v[24:25] op_sel:[0,0] op_sel_hi:[1,0]
v_pk_mul_f32 v[66:67],v[50:51],v[24:25] op_sel:[0,0] op_sel_hi:[1,0]
v_pk_mul_f32 v[68:69],v[52:53],v[24:25] op_sel:[0,0] op_sel_hi:[1,0]
v_pk_mul_f32 v[70:71],v[54:55],v[24:25] op_sel:[0,0] op_sel_hi:[1,0]
v_exp_f32 v64,v64
v_exp_f32 v65,v65
v_exp_f32 v66,v66
v_exp_f32 v67,v67
v_exp_f32 v68,v68
v_exp_f32 v69,v69
v_exp_f32 v70,v70
v_exp_f32 v71,v71
v_accvgpr_read_b32 v56,a32
v_accvgpr_read_b32 v57,a33
v_accvgpr_read_b32 v58,a34
v_accvgpr_read_b32 v59,a35
v_accvgpr_read_b32 v60,a36
v_accvgpr_read_b32 v61,a37
v_accvgpr_read_b32 v62,a38
v_accvgpr_read_b32 v63,a39
v_pk_fma_f32 v[56:57],v[120:121],v[16:17],v[56:57] op_sel:[0,0,0] op_sel_hi:[1,0,1]
v_pk_fma_f32 v[58:59],v[122:123],v[16:17],v[58:59] op_sel:[0,0,0] op_sel_hi:[1,0,1]
v_pk_fma_f32 v[60:61],v[124:125],v[16:17],v[60:61] op_sel:[0,0,0] op_sel_hi:[1,0,1]
v_pk_fma_f32 v[62:63],v[126:127],v[16:17],v[62:63] op_sel:[0,0,0] op_sel_hi:[1,0,1]
v_pk_fma_f32 v[64:65],v[64:65],v[32:33],v[32:33] op_sel:[0,0,0] op_sel_hi:[1,0,0]
v_pk_fma_f32 v[66:67],v[66:67],v[32:33],v[32:33] op_sel:[0,0,0] op_sel_hi:[1,0,0]
v_pk_fma_f32 v[68:69],v[68:69],v[32:33],v[32:33] op_sel:[0,0,0] op_sel_hi:[1,0,0]
v_pk_fma_f32 v[70:71],v[70:71],v[32:33],v[32:33] op_sel:[0,0,0] op_sel_hi:[1,0,0]
v_rcp_f32 v64,v64
v_rcp_f32 v65,v65
v_rcp_f32 v66,v66
v_rcp_f32 v67,v67
v_rcp_f32 v68,v68
v_rcp_f32 v69,v69
v_rcp_f32 v70,v70
v_rcp_f32 v71,v71
v_pk_mul_f32 v[48:49],v[48:49],v[56:57]
v_pk_mul_f32 v[50:51],v[50:51],v[58:59]
v_pk_mul_f32 v[52:53],v[52:53],v[60:61]
v_pk_mul_f32 v[54:55],v[54:55],v[62:63]
v_pk_mul_f32 v[48:49],v[48:49],v[64:65]
v_pk_mul_f32 v[50:51],v[50:51],v[66:67]
v_pk_mul_f32 v[52:53],v[52:53],v[68:69]
v_pk_mul_f32 v[54:55],v[54:55],v[70:71]
v_cvt_pk_bf16_f32 v192,v48,v49
v_cvt_pk_bf16_f32 v193,v50,v51
v_cvt_pk_bf16_f32 v194,v52,v53
v_cvt_pk_bf16_f32 v195,v54,v55
buffer_store_dwordx4 v[176:179],v150,s[20:23],s52 offen offset:3328 sc1
buffer_store_dwordx4 v[184:187],v150,s[20:23],s52 offen offset:3072 sc1
v_accvgpr_read_b32 v80,a64
v_accvgpr_read_b32 v81,a65
v_accvgpr_read_b32 v82,a66
v_accvgpr_read_b32 v83,a67
v_accvgpr_read_b32 v84,a68
v_accvgpr_read_b32 v85,a69
v_accvgpr_read_b32 v86,a70
v_accvgpr_read_b32 v87,a71
v_pk_fma_f32 v[80:81],v[112:113],v[16:17],v[80:81] op_sel:[0,1,0] op_sel_hi:[1,1,1]
v_pk_fma_f32 v[82:83],v[114:115],v[16:17],v[82:83] op_sel:[0,1,0] op_sel_hi:[1,1,1]
v_pk_fma_f32 v[84:85],v[116:117],v[16:17],v[84:85] op_sel:[0,1,0] op_sel_hi:[1,1,1]
v_pk_fma_f32 v[86:87],v[118:119],v[16:17],v[86:87] op_sel:[0,1,0] op_sel_hi:[1,1,1]
v_pk_mul_f32 v[96:97],v[80:81],v[24:25] op_sel:[0,1] op_sel_hi:[1,1]
v_pk_mul_f32 v[98:99],v[82:83],v[24:25] op_sel:[0,1] op_sel_hi:[1,1]
v_pk_mul_f32 v[100:101],v[84:85],v[24:25] op_sel:[0,1] op_sel_hi:[1,1]
v_pk_mul_f32 v[102:103],v[86:87],v[24:25] op_sel:[0,1] op_sel_hi:[1,1]
v_exp_f32 v96,v96
v_exp_f32 v97,v97
v_exp_f32 v98,v98
v_exp_f32 v99,v99
v_exp_f32 v100,v100
v_exp_f32 v101,v101
v_exp_f32 v102,v102
v_exp_f32 v103,v103
v_accvgpr_read_b32 v88,a72
v_accvgpr_read_b32 v89,a73
v_accvgpr_read_b32 v90,a74
v_accvgpr_read_b32 v91,a75
v_accvgpr_read_b32 v92,a76
v_accvgpr_read_b32 v93,a77
v_accvgpr_read_b32 v94,a78
v_accvgpr_read_b32 v95,a79
v_pk_fma_f32 v[88:89],v[120:121],v[16:17],v[88:89] op_sel:[0,1,0] op_sel_hi:[1,1,1]
v_pk_fma_f32 v[90:91],v[122:123],v[16:17],v[90:91] op_sel:[0,1,0] op_sel_hi:[1,1,1]
v_pk_fma_f32 v[92:93],v[124:125],v[16:17],v[92:93] op_sel:[0,1,0] op_sel_hi:[1,1,1]
v_pk_fma_f32 v[94:95],v[126:127],v[16:17],v[94:95] op_sel:[0,1,0] op_sel_hi:[1,1,1]
v_pk_fma_f32 v[96:97],v[96:97],v[32:33],v[32:33] op_sel:[0,1,1] op_sel_hi:[1,1,1]
v_pk_fma_f32 v[98:99],v[98:99],v[32:33],v[32:33] op_sel:[0,1,1] op_sel_hi:[1,1,1]
v_pk_fma_f32 v[100:101],v[100:101],v[32:33],v[32:33] op_sel:[0,1,1] op_sel_hi:[1,1,1]
v_pk_fma_f32 v[102:103],v[102:103],v[32:33],v[32:33] op_sel:[0,1,1] op_sel_hi:[1,1,1]
v_rcp_f32 v96,v96
v_rcp_f32 v97,v97
v_rcp_f32 v98,v98
v_rcp_f32 v99,v99
v_rcp_f32 v100,v100
v_rcp_f32 v101,v101
v_rcp_f32 v102,v102
v_rcp_f32 v103,v103
v_pk_mul_f32 v[80:81],v[80:81],v[88:89]
v_pk_mul_f32 v[82:83],v[82:83],v[90:91]
v_pk_mul_f32 v[84:85],v[84:85],v[92:93]
v_pk_mul_f32 v[86:87],v[86:87],v[94:95]
v_pk_mul_f32 v[80:81],v[80:81],v[96:97]
v_pk_mul_f32 v[82:83],v[82:83],v[98:99]
v_pk_mul_f32 v[84:85],v[84:85],v[100:101]
v_pk_mul_f32 v[86:87],v[86:87],v[102:103]
v_cvt_pk_bf16_f32 v200,v80,v81
v_cvt_pk_bf16_f32 v201,v82,v83
v_cvt_pk_bf16_f32 v202,v84,v85
v_cvt_pk_bf16_f32 v203,v86,v87
buffer_store_dwordx4 v[192:195],v150,s[20:23],s52 offen sc1
v_accvgpr_read_b32 v48,a104
v_accvgpr_read_b32 v49,a105
v_accvgpr_read_b32 v50,a106
v_accvgpr_read_b32 v51,a107
v_accvgpr_read_b32 v52,a108
v_accvgpr_read_b32 v53,a109
v_accvgpr_read_b32 v54,a110
v_accvgpr_read_b32 v55,a111
v_pk_fma_f32 v[48:49],v[112:113],v[18:19],v[48:49] op_sel:[0,0,0] op_sel_hi:[1,0,1]
v_pk_fma_f32 v[50:51],v[114:115],v[18:19],v[50:51] op_sel:[0,0,0] op_sel_hi:[1,0,1]
v_pk_fma_f32 v[52:53],v[116:117],v[18:19],v[52:53] op_sel:[0,0,0] op_sel_hi:[1,0,1]
v_pk_fma_f32 v[54:55],v[118:119],v[18:19],v[54:55] op_sel:[0,0,0] op_sel_hi:[1,0,1]
v_pk_mul_f32 v[64:65],v[48:49],v[26:27] op_sel:[0,0] op_sel_hi:[1,0]
v_pk_mul_f32 v[66:67],v[50:51],v[26:27] op_sel:[0,0] op_sel_hi:[1,0]
v_pk_mul_f32 v[68:69],v[52:53],v[26:27] op_sel:[0,0] op_sel_hi:[1,0]
v_pk_mul_f32 v[70:71],v[54:55],v[26:27] op_sel:[0,0] op_sel_hi:[1,0]
v_exp_f32 v64,v64
v_exp_f32 v65,v65
v_exp_f32 v66,v66
v_exp_f32 v67,v67
v_exp_f32 v68,v68
v_exp_f32 v69,v69
v_exp_f32 v70,v70
v_exp_f32 v71,v71
v_accvgpr_read_b32 v56,a112
v_accvgpr_read_b32 v57,a113
v_accvgpr_read_b32 v58,a114
v_accvgpr_read_b32 v59,a115
v_accvgpr_read_b32 v60,a116
v_accvgpr_read_b32 v61,a117
v_accvgpr_read_b32 v62,a118
v_accvgpr_read_b32 v63,a119
v_pk_fma_f32 v[56:57],v[120:121],v[18:19],v[56:57] op_sel:[0,0,0] op_sel_hi:[1,0,1]
v_pk_fma_f32 v[58:59],v[122:123],v[18:19],v[58:59] op_sel:[0,0,0] op_sel_hi:[1,0,1]
v_pk_fma_f32 v[60:61],v[124:125],v[18:19],v[60:61] op_sel:[0,0,0] op_sel_hi:[1,0,1]
v_pk_fma_f32 v[62:63],v[126:127],v[18:19],v[62:63] op_sel:[0,0,0] op_sel_hi:[1,0,1]
v_pk_fma_f32 v[64:65],v[64:65],v[34:35],v[34:35] op_sel:[0,0,0] op_sel_hi:[1,0,0]
v_pk_fma_f32 v[66:67],v[66:67],v[34:35],v[34:35] op_sel:[0,0,0] op_sel_hi:[1,0,0]
v_pk_fma_f32 v[68:69],v[68:69],v[34:35],v[34:35] op_sel:[0,0,0] op_sel_hi:[1,0,0]
v_pk_fma_f32 v[70:71],v[70:71],v[34:35],v[34:35] op_sel:[0,0,0] op_sel_hi:[1,0,0]
v_rcp_f32 v64,v64
v_rcp_f32 v65,v65
v_rcp_f32 v66,v66
v_rcp_f32 v67,v67
v_rcp_f32 v68,v68
v_rcp_f32 v69,v69
v_rcp_f32 v70,v70
v_rcp_f32 v71,v71
v_pk_mul_f32 v[48:49],v[48:49],v[56:57]
v_pk_mul_f32 v[50:51],v[50:51],v[58:59]
v_pk_mul_f32 v[52:53],v[52:53],v[60:61]
v_pk_mul_f32 v[54:55],v[54:55],v[62:63]
v_pk_mul_f32 v[48:49],v[48:49],v[64:65]
v_pk_mul_f32 v[50:51],v[50:51],v[66:67]
v_pk_mul_f32 v[52:53],v[52:53],v[68:69]
v_pk_mul_f32 v[54:55],v[54:55],v[70:71]
v_cvt_pk_bf16_f32 v208,v48,v49
v_cvt_pk_bf16_f32 v209,v50,v51
v_cvt_pk_bf16_f32 v210,v52,v53
v_cvt_pk_bf16_f32 v211,v54,v55
buffer_store_dwordx4 v[200:203],v150,s[20:23],s52 offen offset:256 sc1
s_and_b32 s62,s2,7
s_lshr_b32 s71,s2,6
s_lshl_b32 s70,s62,2
s_add_u32 s70,s70,s71
s_lshr_b32 s63,s71,1
s_lshl_b32 s63,s63,3
s_add_u32 s63,s63,s62
s_lshl_b32 s63,s63,7
s_bfe_u32 s71,s2,0x30003
s_lshl_b32 s72,s71,2
s_add_u32 s72,s72,s63
s_add_u32 s63,s63,2048
s_lshl_b32 s62,s62,7
s_add_u32 s62,s62,3072
v_and_b32 v13,7,v2
v_lshlrev_b32 v13,2,v13
v_add_u32 v14,s63,v13
v_add_u32 v13,s62,v13
v_mov_b32 v15,s72
v_cmp_gt_u32 vcc,16,v2
v_cmp_gt_u32 s[74:75],8,v2
s_nop 1
v_cndmask_b32 v13,v15,v13,vcc
v_cndmask_b32 v13,v13,v14,s[74:75]
v_add_u32 v13,0x2700000,v13
v_lshlrev_b32 v9,4,v2
buffer_load_dword v14,v13,s[20:23],0 offen sc1
v_accvgpr_read_b32 v80,a144
v_accvgpr_read_b32 v81,a145
v_accvgpr_read_b32 v82,a146
v_accvgpr_read_b32 v83,a147
v_accvgpr_read_b32 v84,a148
v_accvgpr_read_b32 v85,a149
v_accvgpr_read_b32 v86,a150
v_accvgpr_read_b32 v87,a151
v_pk_fma_f32 v[80:81],v[112:113],v[18:19],v[80:81] op_sel:[0,1,0] op_sel_hi:[1,1,1]
v_pk_fma_f32 v[82:83],v[114:115],v[18:19],v[82:83] op_sel:[0,1,0] op_sel_hi:[1,1,1]
v_pk_fma_f32 v[84:85],v[116:117],v[18:19],v[84:85] op_sel:[0,1,0] op_sel_hi:[1,1,1]
v_pk_fma_f32 v[86:87],v[118:119],v[18:19],v[86:87] op_sel:[0,1,0] op_sel_hi:[1,1,1]
v_pk_mul_f32 v[96:97],v[80:81],v[26:27] op_sel:[0,1] op_sel_hi:[1,1]
v_pk_mul_f32 v[98:99],v[82:83],v[26:27] op_sel:[0,1] op_sel_hi:[1,1]
v_pk_mul_f32 v[100:101],v[84:85],v[26:27] op_sel:[0,1] op_sel_hi:[1,1]
v_pk_mul_f32 v[102:103],v[86:87],v[26:27] op_sel:[0,1] op_sel_hi:[1,1]
v_exp_f32 v96,v96
v_exp_f32 v97,v97
v_exp_f32 v98,v98
v_exp_f32 v99,v99
v_exp_f32 v100,v100
v_exp_f32 v101,v101
v_exp_f32 v102,v102
v_exp_f32 v103,v103
v_accvgpr_read_b32 v88,a152
v_accvgpr_read_b32 v89,a153
v_accvgpr_read_b32 v90,a154
v_accvgpr_read_b32 v91,a155
v_accvgpr_read_b32 v92,a156
v_accvgpr_read_b32 v93,a157
v_accvgpr_read_b32 v94,a158
v_accvgpr_read_b32 v95,a159
v_pk_fma_f32 v[88:89],v[120:121],v[18:19],v[88:89] op_sel:[0,1,0] op_sel_hi:[1,1,1]
v_pk_fma_f32 v[90:91],v[122:123],v[18:19],v[90:91] op_sel:[0,1,0] op_sel_hi:[1,1,1]
v_pk_fma_f32 v[92:93],v[124:125],v[18:19],v[92:93] op_sel:[0,1,0] op_sel_hi:[1,1,1]
v_pk_fma_f32 v[94:95],v[126:127],v[18:19],v[94:95] op_sel:[0,1,0] op_sel_hi:[1,1,1]
v_pk_fma_f32 v[96:97],v[96:97],v[34:35],v[34:35] op_sel:[0,1,1] op_sel_hi:[1,1,1]
v_pk_fma_f32 v[98:99],v[98:99],v[34:35],v[34:35] op_sel:[0,1,1] op_sel_hi:[1,1,1]
v_pk_fma_f32 v[100:101],v[100:101],v[34:35],v[34:35] op_sel:[0,1,1] op_sel_hi:[1,1,1]
v_pk_fma_f32 v[102:103],v[102:103],v[34:35],v[34:35] op_sel:[0,1,1] op_sel_hi:[1,1,1]
v_rcp_f32 v96,v96
v_rcp_f32 v97,v97
v_rcp_f32 v98,v98
v_rcp_f32 v99,v99
v_rcp_f32 v100,v100
v_rcp_f32 v101,v101
v_rcp_f32 v102,v102
v_rcp_f32 v103,v103
v_pk_mul_f32 v[80:81],v[80:81],v[88:89]
v_pk_mul_f32 v[82:83],v[82:83],v[90:91]
v_pk_mul_f32 v[84:85],v[84:85],v[92:93]
v_pk_mul_f32 v[86:87],v[86:87],v[94:95]
v_pk_mul_f32 v[80:81],v[80:81],v[96:97]
v_pk_mul_f32 v[82:83],v[82:83],v[98:99]
v_pk_mul_f32 v[84:85],v[84:85],v[100:101]
v_pk_mul_f32 v[86:87],v[86:87],v[102:103]
v_cvt_pk_bf16_f32 v216,v80,v81
v_cvt_pk_bf16_f32 v217,v82,v83
v_cvt_pk_bf16_f32 v218,v84,v85
v_cvt_pk_bf16_f32 v219,v86,v87
buffer_store_dwordx4 v[208:211],v150,s[20:23],s52 offen offset:1024 sc1
v_accvgpr_read_b32 v48,a184
v_accvgpr_read_b32 v49,a185
v_accvgpr_read_b32 v50,a186
v_accvgpr_read_b32 v51,a187
v_accvgpr_read_b32 v52,a188
v_accvgpr_read_b32 v53,a189
v_accvgpr_read_b32 v54,a190
v_accvgpr_read_b32 v55,a191
v_pk_fma_f32 v[48:49],v[112:113],v[20:21],v[48:49] op_sel:[0,0,0] op_sel_hi:[1,0,1]
v_pk_fma_f32 v[50:51],v[114:115],v[20:21],v[50:51] op_sel:[0,0,0] op_sel_hi:[1,0,1]
v_pk_fma_f32 v[52:53],v[116:117],v[20:21],v[52:53] op_sel:[0,0,0] op_sel_hi:[1,0,1]
v_pk_fma_f32 v[54:55],v[118:119],v[20:21],v[54:55] op_sel:[0,0,0] op_sel_hi:[1,0,1]
v_pk_mul_f32 v[64:65],v[48:49],v[28:29] op_sel:[0,0] op_sel_hi:[1,0]
v_pk_mul_f32 v[66:67],v[50:51],v[28:29] op_sel:[0,0] op_sel_hi:[1,0]
v_pk_mul_f32 v[68:69],v[52:53],v[28:29] op_sel:[0,0] op_sel_hi:[1,0]
v_pk_mul_f32 v[70:71],v[54:55],v[28:29] op_sel:[0,0] op_sel_hi:[1,0]
v_exp_f32 v64,v64
v_exp_f32 v65,v65
v_exp_f32 v66,v66
v_exp_f32 v67,v67
v_exp_f32 v68,v68
v_exp_f32 v69,v69
v_exp_f32 v70,v70
v_exp_f32 v71,v71
v_accvgpr_read_b32 v56,a192
v_accvgpr_read_b32 v57,a193
v_accvgpr_read_b32 v58,a194
v_accvgpr_read_b32 v59,a195
v_accvgpr_read_b32 v60,a196
v_accvgpr_read_b32 v61,a197
v_accvgpr_read_b32 v62,a198
v_accvgpr_read_b32 v63,a199
v_pk_fma_f32 v[56:57],v[120:121],v[20:21],v[56:57] op_sel:[0,0,0] op_sel_hi:[1,0,1]
v_pk_fma_f32 v[58:59],v[122:123],v[20:21],v[58:59] op_sel:[0,0,0] op_sel_hi:[1,0,1]
v_pk_fma_f32 v[60:61],v[124:125],v[20:21],v[60:61] op_sel:[0,0,0] op_sel_hi:[1,0,1]
v_pk_fma_f32 v[62:63],v[126:127],v[20:21],v[62:63] op_sel:[0,0,0] op_sel_hi:[1,0,1]
v_pk_fma_f32 v[64:65],v[64:65],v[36:37],v[36:37] op_sel:[0,0,0] op_sel_hi:[1,0,0]
v_pk_fma_f32 v[66:67],v[66:67],v[36:37],v[36:37] op_sel:[0,0,0] op_sel_hi:[1,0,0]
v_pk_fma_f32 v[68:69],v[68:69],v[36:37],v[36:37] op_sel:[0,0,0] op_sel_hi:[1,0,0]
v_pk_fma_f32 v[70:71],v[70:71],v[36:37],v[36:37] op_sel:[0,0,0] op_sel_hi:[1,0,0]
v_rcp_f32 v64,v64
v_rcp_f32 v65,v65
v_rcp_f32 v66,v66
v_rcp_f32 v67,v67
v_rcp_f32 v68,v68
v_rcp_f32 v69,v69
v_rcp_f32 v70,v70
v_rcp_f32 v71,v71
v_pk_mul_f32 v[48:49],v[48:49],v[56:57]
v_pk_mul_f32 v[50:51],v[50:51],v[58:59]
v_pk_mul_f32 v[52:53],v[52:53],v[60:61]
v_pk_mul_f32 v[54:55],v[54:55],v[62:63]
v_pk_mul_f32 v[48:49],v[48:49],v[64:65]
v_pk_mul_f32 v[50:51],v[50:51],v[66:67]
v_pk_mul_f32 v[52:53],v[52:53],v[68:69]
v_pk_mul_f32 v[54:55],v[54:55],v[70:71]
v_cvt_pk_bf16_f32 v224,v48,v49
v_cvt_pk_bf16_f32 v225,v50,v51
v_cvt_pk_bf16_f32 v226,v52,v53
v_cvt_pk_bf16_f32 v227,v54,v55
buffer_store_dwordx4 v[216:219],v150,s[20:23],s52 offen offset:1280 sc1
s_waitcnt vmcnt(2)
s_mov_b32 s75,0x40000
kvpollB_chk:
v_cmp_eq_u32 vcc,1,v14
s_sub_u32 s75,s75,1
s_cbranch_scc1 kvpollB_ok
s_nop 1
s_cmp_eq_u64 vcc,-1
s_cbranch_scc1 kvpollB_ok
s_sleep 4
buffer_load_dword v14,v13,s[20:23],0 offen sc1
s_waitcnt vmcnt(0)
s_branch kvpollB_chk
kvpollB_ok:
s_add_u32 s64,s6,0x800000
s_addc_u32 s65,s7,0
s_and_b32 s65,s65,0xffff
s_mov_b32 s66,0x800000
s_mov_b32 s67,0x00020000
s_lshl_b32 s69,s31,11
s_lshl_b32 s68,s70,18
s_add_u32 s68,s68,s69
s_add_u32 m0,s69,131072
s_nop 0
buffer_load_dwordx4 v9,s[64:67],s68 offen sc1 lds
buffer_load_dwordx4 v9,s[64:67],s68 offen offset:1024 sc1 lds
s_add_u32 s68,s68,8192
s_lshl_b32 s62,s70,17
s_lshl_b32 s63,s71,14
s_add_u32 s62,s62,s63
s_lshl_b32 s63,s31,12
s_add_u32 s62,s62,s63
s_add_u32 s62,s62,0x400000
buffer_load_dwordx4 a[64:67],v9,s[20:23],s62 offen sc1
buffer_load_dwordx4 a[68:71],v9,s[20:23],s62 offen offset:1024 sc1
buffer_load_dwordx4 a[72:75],v9,s[20:23],s62 offen offset:2048 sc1
buffer_load_dwordx4 a[76:79],v9,s[20:23],s62 offen offset:3072 sc1
s_add_u32 m0,s69,139264
s_nop 0
buffer_load_dwordx4 v9,s[64:67],s68 offen sc1 lds
buffer_load_dwordx4 v9,s[64:67],s68 offen offset:1024 sc1 lds
s_add_u32 s68,s68,8192
s_add_u32 m0,s69,147456
s_nop 0
buffer_load_dwordx4 v9,s[64:67],s68 offen sc1 lds
buffer_load_dwordx4 v9,s[64:67],s68 offen offset:1024 sc1 lds
s_add_u32 s68,s68,8192
s_add_u32 m0,s69,155648
s_nop 0
buffer_load_dwordx4 v9,s[64:67],s68 offen sc1 lds
buffer_load_dwordx4 v9,s[64:67],s68 offen offset:1024 sc1 lds
s_add_u32 s68,s68,8192
s_lshl_b32 s62,s71,2
s_add_u32 s62,s62,s31
s_lshl_b32 s62,s62,12
s_lshl_b32 s63,s70,18
s_add_u32 s62,s62,s63
v_and_b32 v12,31,v2
v_lshlrev_b32 v12,7,v12
buffer_load_dword v15,v12,s[64:67],s62 offen sc1
v_accvgpr_read_b32 v80,a224
v_accvgpr_read_b32 v81,a225
v_accvgpr_read_b32 v82,a226
v_accvgpr_read_b32 v83,a227
v_accvgpr_read_b32 v84,a228
v_accvgpr_read_b32 v85,a229
v_accvgpr_read_b32 v86,a230
v_accvgpr_read_b32 v87,a231
v_pk_fma_f32 v[80:81],v[112:113],v[20:21],v[80:81] op_sel:[0,1,0] op_sel_hi:[1,1,1]
v_pk_fma_f32 v[82:83],v[114:115],v[20:21],v[82:83] op_sel:[0,1,0] op_sel_hi:[1,1,1]
v_pk_fma_f32 v[84:85],v[116:117],v[20:21],v[84:85] op_sel:[0,1,0] op_sel_hi:[1,1,1]
v_pk_fma_f32 v[86:87],v[118:119],v[20:21],v[86:87] op_sel:[0,1,0] op_sel_hi:[1,1,1]
v_pk_mul_f32 v[96:97],v[80:81],v[28:29] op_sel:[0,1] op_sel_hi:[1,1]
v_pk_mul_f32 v[98:99],v[82:83],v[28:29] op_sel:[0,1] op_sel_hi:[1,1]
v_pk_mul_f32 v[100:101],v[84:85],v[28:29] op_sel:[0,1] op_sel_hi:[1,1]
v_pk_mul_f32 v[102:103],v[86:87],v[28:29] op_sel:[0,1] op_sel_hi:[1,1]
v_exp_f32 v96,v96
v_exp_f32 v97,v97
v_exp_f32 v98,v98
v_exp_f32 v99,v99
v_exp_f32 v100,v100
v_exp_f32 v101,v101
v_exp_f32 v102,v102
v_exp_f32 v103,v103
v_accvgpr_read_b32 v88,a232
v_accvgpr_read_b32 v89,a233
v_accvgpr_read_b32 v90,a234
v_accvgpr_read_b32 v91,a235
v_accvgpr_read_b32 v92,a236
v_accvgpr_read_b32 v93,a237
v_accvgpr_read_b32 v94,a238
v_accvgpr_read_b32 v95,a239
v_pk_fma_f32 v[88:89],v[120:121],v[20:21],v[88:89] op_sel:[0,1,0] op_sel_hi:[1,1,1]
v_pk_fma_f32 v[90:91],v[122:123],v[20:21],v[90:91] op_sel:[0,1,0] op_sel_hi:[1,1,1]
v_pk_fma_f32 v[92:93],v[124:125],v[20:21],v[92:93] op_sel:[0,1,0] op_sel_hi:[1,1,1]
v_pk_fma_f32 v[94:95],v[126:127],v[20:21],v[94:95] op_sel:[0,1,0] op_sel_hi:[1,1,1]
v_pk_fma_f32 v[96:97],v[96:97],v[36:37],v[36:37] op_sel:[0,1,1] op_sel_hi:[1,1,1]
v_pk_fma_f32 v[98:99],v[98:99],v[36:37],v[36:37] op_sel:[0,1,1] op_sel_hi:[1,1,1]
v_pk_fma_f32 v[100:101],v[100:101],v[36:37],v[36:37] op_sel:[0,1,1] op_sel_hi:[1,1,1]
v_pk_fma_f32 v[102:103],v[102:103],v[36:37],v[36:37] op_sel:[0,1,1] op_sel_hi:[1,1,1]
v_rcp_f32 v96,v96
v_rcp_f32 v97,v97
v_rcp_f32 v98,v98
v_rcp_f32 v99,v99
v_rcp_f32 v100,v100
v_rcp_f32 v101,v101
v_rcp_f32 v102,v102
v_rcp_f32 v103,v103
v_pk_mul_f32 v[80:81],v[80:81],v[88:89]
v_pk_mul_f32 v[82:83],v[82:83],v[90:91]
v_pk_mul_f32 v[84:85],v[84:85],v[92:93]
v_pk_mul_f32 v[86:87],v[86:87],v[94:95]
v_pk_mul_f32 v[80:81],v[80:81],v[96:97]
v_pk_mul_f32 v[82:83],v[82:83],v[98:99]
v_pk_mul_f32 v[84:85],v[84:85],v[100:101]
v_pk_mul_f32 v[86:87],v[86:87],v[102:103]
v_cvt_pk_bf16_f32 v232,v80,v81
v_cvt_pk_bf16_f32 v233,v82,v83
v_cvt_pk_bf16_f32 v234,v84,v85
v_cvt_pk_bf16_f32 v235,v86,v87
buffer_store_dwordx4 v[224:227],v150,s[20:23],s52 offen offset:2048 sc1
s_nop 0
buffer_store_dwordx4 v[232:235],v150,s[20:23],s52 offen offset:2304 sc1
v_accvgpr_read_b32 v48,a0
v_accvgpr_read_b32 v49,a1
v_accvgpr_read_b32 v50,a2
v_accvgpr_read_b32 v51,a3
v_pk_fma_f32 v[48:49],v[128:129],v[140:141],v[48:49] op_sel:[0,0,0] op_sel_hi:[1,0,1]
v_pk_fma_f32 v[50:51],v[130:131],v[140:141],v[50:51] op_sel:[0,0,0] op_sel_hi:[1,0,1]
v_pk_mul_f32 v[48:49],v[48:49],v[136:137] op_sel:[0,0] op_sel_hi:[1,0]
v_pk_mul_f32 v[50:51],v[50:51],v[136:137] op_sel:[0,0] op_sel_hi:[1,0]
v_accvgpr_read_b32 v52,a4
v_accvgpr_read_b32 v53,a5
v_accvgpr_read_b32 v54,a6
v_accvgpr_read_b32 v55,a7
v_pk_fma_f32 v[52:53],v[132:133],v[140:141],v[52:53] op_sel:[0,0,0] op_sel_hi:[1,0,1]
v_pk_fma_f32 v[54:55],v[134:135],v[140:141],v[54:55] op_sel:[0,0,0] op_sel_hi:[1,0,1]
v_pk_mul_f32 v[52:53],v[52:53],v[136:137] op_sel:[0,0] op_sel_hi:[1,0]
v_pk_mul_f32 v[54:55],v[54:55],v[136:137] op_sel:[0,0] op_sel_hi:[1,0]
v_cvt_pk_bf16_f32 v56,v48,v49
v_cvt_pk_bf16_f32 v57,v50,v51
v_cvt_pk_bf16_f32 v58,v52,v53
v_cvt_pk_bf16_f32 v59,v54,v55
buffer_store_dwordx4 v[56:59],v8,s[20:23],s45 offen sc1
s_add_u32 s45,s45,s56
v_accvgpr_read_b32 v48,a40
v_accvgpr_read_b32 v49,a41
v_accvgpr_read_b32 v50,a42
v_accvgpr_read_b32 v51,a43
v_pk_fma_f32 v[48:49],v[128:129],v[140:141],v[48:49] op_sel:[0,1,0] op_sel_hi:[1,1,1]
v_pk_fma_f32 v[50:51],v[130:131],v[140:141],v[50:51] op_sel:[0,1,0] op_sel_hi:[1,1,1]
v_pk_mul_f32 v[48:49],v[48:49],v[136:137] op_sel:[0,1] op_sel_hi:[1,1]
v_pk_mul_f32 v[50:51],v[50:51],v[136:137] op_sel:[0,1] op_sel_hi:[1,1]
v_accvgpr_read_b32 v52,a44
v_accvgpr_read_b32 v53,a45
v_accvgpr_read_b32 v54,a46
v_accvgpr_read_b32 v55,a47
v_pk_fma_f32 v[52:53],v[132:133],v[140:141],v[52:53] op_sel:[0,1,0] op_sel_hi:[1,1,1]
v_pk_fma_f32 v[54:55],v[134:135],v[140:141],v[54:55] op_sel:[0,1,0] op_sel_hi:[1,1,1]
v_pk_mul_f32 v[52:53],v[52:53],v[136:137] op_sel:[0,1] op_sel_hi:[1,1]
v_pk_mul_f32 v[54:55],v[54:55],v[136:137] op_sel:[0,1] op_sel_hi:[1,1]
v_cvt_pk_bf16_f32 v60,v48,v49
v_cvt_pk_bf16_f32 v61,v50,v51
v_cvt_pk_bf16_f32 v62,v52,v53
v_cvt_pk_bf16_f32 v63,v54,v55
buffer_store_dwordx4 v[60:63],v8,s[20:23],s45 offen sc1
s_add_u32 s45,s45,s57
v_accvgpr_read_b32 v48,a80
v_accvgpr_read_b32 v49,a81
v_accvgpr_read_b32 v50,a82
v_accvgpr_read_b32 v51,a83
v_pk_fma_f32 v[48:49],v[128:129],v[142:143],v[48:49] op_sel:[0,0,0] op_sel_hi:[1,0,1]
v_pk_fma_f32 v[50:51],v[130:131],v[142:143],v[50:51] op_sel:[0,0,0] op_sel_hi:[1,0,1]
v_pk_mul_f32 v[48:49],v[48:49],v[138:139] op_sel:[0,0] op_sel_hi:[1,0]
v_pk_mul_f32 v[50:51],v[50:51],v[138:139] op_sel:[0,0] op_sel_hi:[1,0]
v_accvgpr_read_b32 v52,a84
v_accvgpr_read_b32 v53,a85
v_accvgpr_read_b32 v54,a86
v_accvgpr_read_b32 v55,a87
v_pk_fma_f32 v[52:53],v[132:133],v[142:143],v[52:53] op_sel:[0,0,0] op_sel_hi:[1,0,1]
v_pk_fma_f32 v[54:55],v[134:135],v[142:143],v[54:55] op_sel:[0,0,0] op_sel_hi:[1,0,1]
v_pk_mul_f32 v[52:53],v[52:53],v[138:139] op_sel:[0,0] op_sel_hi:[1,0]
v_pk_mul_f32 v[54:55],v[54:55],v[138:139] op_sel:[0,0] op_sel_hi:[1,0]
v_cvt_pk_bf16_f32 v56,v48,v49
v_cvt_pk_bf16_f32 v57,v50,v51
v_cvt_pk_bf16_f32 v58,v52,v53
v_cvt_pk_bf16_f32 v59,v54,v55
buffer_store_dwordx4 v[56:59],v8,s[20:23],s45 offen sc1
s_add_u32 s45,s45,s56
v_accvgpr_read_b32 v48,a120
v_accvgpr_read_b32 v49,a121
v_accvgpr_read_b32 v50,a122
v_accvgpr_read_b32 v51,a123
v_pk_fma_f32 v[48:49],v[128:129],v[142:143],v[48:49] op_sel:[0,1,0] op_sel_hi:[1,1,1]
v_pk_fma_f32 v[50:51],v[130:131],v[142:143],v[50:51] op_sel:[0,1,0] op_sel_hi:[1,1,1]
v_pk_mul_f32 v[48:49],v[48:49],v[138:139] op_sel:[0,1] op_sel_hi:[1,1]
v_pk_mul_f32 v[50:51],v[50:51],v[138:139] op_sel:[0,1] op_sel_hi:[1,1]
v_accvgpr_read_b32 v52,a124
v_accvgpr_read_b32 v53,a125
v_accvgpr_read_b32 v54,a126
v_accvgpr_read_b32 v55,a127
v_pk_fma_f32 v[52:53],v[132:133],v[142:143],v[52:53] op_sel:[0,1,0] op_sel_hi:[1,1,1]
v_pk_fma_f32 v[54:55],v[134:135],v[142:143],v[54:55] op_sel:[0,1,0] op_sel_hi:[1,1,1]
v_pk_mul_f32 v[52:53],v[52:53],v[138:139] op_sel:[0,1] op_sel_hi:[1,1]
v_pk_mul_f32 v[54:55],v[54:55],v[138:139] op_sel:[0,1] op_sel_hi:[1,1]
v_cvt_pk_bf16_f32 v60,v48,v49
v_cvt_pk_bf16_f32 v61,v50,v51
v_cvt_pk_bf16_f32 v62,v52,v53
v_cvt_pk_bf16_f32 v63,v54,v55
buffer_store_dwordx4 v[60:63],v8,s[20:23],s45 offen sc1
s_add_u32 s45,s45,s57
v_accvgpr_read_b32 v48,a8
v_accvgpr_read_b32 v49,a9
v_accvgpr_read_b32 v50,a10
v_accvgpr_read_b32 v51,a11
v_pk_fma_f32 v[48:49],v[162:163],v[144:145],v[48:49] op_sel:[0,0,0] op_sel_hi:[1,0,1]
v_pk_fma_f32 v[50:51],v[164:165],v[144:145],v[50:51] op_sel:[0,0,0] op_sel_hi:[1,0,1]
v_pk_mul_f32 v[48:49],v[48:49],v[154:155]
v_pk_mul_f32 v[50:51],v[50:51],v[156:157]
v_accvgpr_read_b32 v52,a48
v_accvgpr_read_b32 v53,a49
v_accvgpr_read_b32 v54,a50
v_accvgpr_read_b32 v55,a51
v_pk_fma_f32 v[52:53],v[166:167],v[144:145],v[52:53] op_sel:[0,0,0] op_sel_hi:[1,0,1]
v_pk_fma_f32 v[54:55],v[168:169],v[144:145],v[54:55] op_sel:[0,0,0] op_sel_hi:[1,0,1]
v_pk_mul_f32 v[52:53],v[52:53],v[158:159]
v_pk_mul_f32 v[54:55],v[54:55],v[160:161]
v_cvt_pk_bf16_f32 v56,v48,v49
v_cvt_pk_bf16_f32 v57,v50,v51
v_cvt_pk_bf16_f32 v58,v52,v53
v_cvt_pk_bf16_f32 v59,v54,v55
buffer_store_dwordx4 v[56:59],v148,s[20:23],s46 offen sc1
v_accvgpr_read_b32 v48,a12
v_accvgpr_read_b32 v49,a13
v_accvgpr_read_b32 v50,a14
v_accvgpr_read_b32 v51,a15
v_pk_fma_f32 v[48:49],v[162:163],v[144:145],v[48:49] op_sel:[0,1,0] op_sel_hi:[1,1,1]
v_pk_fma_f32 v[50:51],v[164:165],v[144:145],v[50:51] op_sel:[0,1,0] op_sel_hi:[1,1,1]
v_pk_mul_f32 v[48:49],v[48:49],v[154:155]
v_pk_mul_f32 v[50:51],v[50:51],v[156:157]
v_accvgpr_read_b32 v52,a52
v_accvgpr_read_b32 v53,a53
v_accvgpr_read_b32 v54,a54
v_accvgpr_read_b32 v55,a55
v_pk_fma_f32 v[52:53],v[166:167],v[144:145],v[52:53] op_sel:[0,1,0] op_sel_hi:[1,1,1]
v_pk_fma_f32 v[54:55],v[168:169],v[144:145],v[54:55] op_sel:[0,1,0] op_sel_hi:[1,1,1]
v_pk_mul_f32 v[52:53],v[52:53],v[158:159]
v_pk_mul_f32 v[54:55],v[54:55],v[160:161]
v_cvt_pk_bf16_f32 v60,v48,v49
v_cvt_pk_bf16_f32 v61,v50,v51
v_cvt_pk_bf16_f32 v62,v52,v53
v_cvt_pk_bf16_f32 v63,v54,v55
buffer_store_dwordx4 v[60:63],v148,s[20:23],s46 offen offset:128 sc1
v_accvgpr_read_b32 v48,a16
v_accvgpr_read_b32 v49,a17
v_accvgpr_read_b32 v50,a18
v_accvgpr_read_b32 v51,a19
v_pk_fma_f32 v[48:49],v[162:163],v[146:147],v[48:49] op_sel:[0,0,0] op_sel_hi:[1,0,1]
v_pk_fma_f32 v[50:51],v[164:165],v[146:147],v[50:51] op_sel:[0,0,0] op_sel_hi:[1,0,1]
v_pk_mul_f32 v[48:49],v[48:49],v[154:155]
v_pk_mul_f32 v[50:51],v[50:51],v[156:157]
v_accvgpr_read_b32 v52,a56
v_accvgpr_read_b32 v53,a57
v_accvgpr_read_b32 v54,a58
v_accvgpr_read_b32 v55,a59
v_pk_fma_f32 v[52:53],v[166:167],v[146:147],v[52:53] op_sel:[0,0,0] op_sel_hi:[1,0,1]
v_pk_fma_f32 v[54:55],v[168:169],v[146:147],v[54:55] op_sel:[0,0,0] op_sel_hi:[1,0,1]
v_pk_mul_f32 v[52:53],v[52:53],v[158:159]
v_pk_mul_f32 v[54:55],v[54:55],v[160:161]
v_cvt_pk_bf16_f32 v56,v48,v49
v_cvt_pk_bf16_f32 v57,v50,v51
v_cvt_pk_bf16_f32 v58,v52,v53
v_cvt_pk_bf16_f32 v59,v54,v55
buffer_store_dwordx4 v[56:59],v148,s[20:23],s47 offen sc1
v_accvgpr_read_b32 v48,a20
v_accvgpr_read_b32 v49,a21
v_accvgpr_read_b32 v50,a22
v_accvgpr_read_b32 v51,a23
v_pk_fma_f32 v[48:49],v[162:163],v[146:147],v[48:49] op_sel:[0,1,0] op_sel_hi:[1,1,1]
v_pk_fma_f32 v[50:51],v[164:165],v[146:147],v[50:51] op_sel:[0,1,0] op_sel_hi:[1,1,1]
v_pk_mul_f32 v[48:49],v[48:49],v[154:155]
v_pk_mul_f32 v[50:51],v[50:51],v[156:157]
v_accvgpr_read_b32 v52,a60
v_accvgpr_read_b32 v53,a61
v_accvgpr_read_b32 v54,a62
v_accvgpr_read_b32 v55,a63
v_pk_fma_f32 v[52:53],v[166:167],v[146:147],v[52:53] op_sel:[0,1,0] op_sel_hi:[1,1,1]
v_pk_fma_f32 v[54:55],v[168:169],v[146:147],v[54:55] op_sel:[0,1,0] op_sel_hi:[1,1,1]
v_pk_mul_f32 v[52:53],v[52:53],v[158:159]
v_pk_mul_f32 v[54:55],v[54:55],v[160:161]
v_cvt_pk_bf16_f32 v60,v48,v49
v_cvt_pk_bf16_f32 v61,v50,v51
v_cvt_pk_bf16_f32 v62,v52,v53
v_cvt_pk_bf16_f32 v63,v54,v55
buffer_store_dwordx4 v[60:63],v148,s[20:23],s47 offen offset:128 sc1
s_add_u32 s46,s46,4096
s_add_u32 s47,s47,4096
v_accvgpr_read_b32 v48,a88
v_accvgpr_read_b32 v49,a89
v_accvgpr_read_b32 v50,a90
v_accvgpr_read_b32 v51,a91
v_pk_fma_f32 v[48:49],v[248:249],v[144:145],v[48:49] op_sel:[0,0,0] op_sel_hi:[1,0,1]
v_pk_fma_f32 v[50:51],v[250:251],v[144:145],v[50:51] op_sel:[0,0,0] op_sel_hi:[1,0,1]
v_pk_mul_f32 v[48:49],v[48:49],v[240:241]
v_pk_mul_f32 v[50:51],v[50:51],v[242:243]
v_accvgpr_read_b32 v52,a128
v_accvgpr_read_b32 v53,a129
v_accvgpr_read_b32 v54,a130
v_accvgpr_read_b32 v55,a131
v_pk_fma_f32 v[52:53],v[252:253],v[144:145],v[52:53] op_sel:[0,0,0] op_sel_hi:[1,0,1]
v_pk_fma_f32 v[54:55],v[254:255],v[144:145],v[54:55] op_sel:[0,0,0] op_sel_hi:[1,0,1]
v_pk_mul_f32 v[52:53],v[52:53],v[244:245]
v_pk_mul_f32 v[54:55],v[54:55],v[246:247]
v_cvt_pk_bf16_f32 v56,v48,v49
v_cvt_pk_bf16_f32 v57,v50,v51
v_cvt_pk_bf16_f32 v58,v52,v53
v_cvt_pk_bf16_f32 v59,v54,v55
buffer_store_dwordx4 v[56:59],v148,s[20:23],s46 offen sc1
v_accvgpr_read_b32 v48,a92
v_accvgpr_read_b32 v49,a93
v_accvgpr_read_b32 v50,a94
v_accvgpr_read_b32 v51,a95
v_pk_fma_f32 v[48:49],v[248:249],v[144:145],v[48:49] op_sel:[0,1,0] op_sel_hi:[1,1,1]
v_pk_fma_f32 v[50:51],v[250:251],v[144:145],v[50:51] op_sel:[0,1,0] op_sel_hi:[1,1,1]
v_pk_mul_f32 v[48:49],v[48:49],v[240:241]
v_pk_mul_f32 v[50:51],v[50:51],v[242:243]
v_accvgpr_read_b32 v52,a132
v_accvgpr_read_b32 v53,a133
v_accvgpr_read_b32 v54,a134
v_accvgpr_read_b32 v55,a135
v_pk_fma_f32 v[52:53],v[252:253],v[144:145],v[52:53] op_sel:[0,1,0] op_sel_hi:[1,1,1]
v_pk_fma_f32 v[54:55],v[254:255],v[144:145],v[54:55] op_sel:[0,1,0] op_sel_hi:[1,1,1]
v_pk_mul_f32 v[52:53],v[52:53],v[244:245]
v_pk_mul_f32 v[54:55],v[54:55],v[246:247]
v_cvt_pk_bf16_f32 v60,v48,v49
v_cvt_pk_bf16_f32 v61,v50,v51
v_cvt_pk_bf16_f32 v62,v52,v53
v_cvt_pk_bf16_f32 v63,v54,v55
buffer_store_dwordx4 v[60:63],v148,s[20:23],s46 offen offset:128 sc1
v_accvgpr_read_b32 v48,a96
v_accvgpr_read_b32 v49,a97
v_accvgpr_read_b32 v50,a98
v_accvgpr_read_b32 v51,a99
v_pk_fma_f32 v[48:49],v[248:249],v[146:147],v[48:49] op_sel:[0,0,0] op_sel_hi:[1,0,1]
v_pk_fma_f32 v[50:51],v[250:251],v[146:147],v[50:51] op_sel:[0,0,0] op_sel_hi:[1,0,1]
v_pk_mul_f32 v[48:49],v[48:49],v[240:241]
v_pk_mul_f32 v[50:51],v[50:51],v[242:243]
v_accvgpr_read_b32 v52,a136
v_accvgpr_read_b32 v53,a137
v_accvgpr_read_b32 v54,a138
v_accvgpr_read_b32 v55,a139
v_pk_fma_f32 v[52:53],v[252:253],v[146:147],v[52:53] op_sel:[0,0,0] op_sel_hi:[1,0,1]
v_pk_fma_f32 v[54:55],v[254:255],v[146:147],v[54:55] op_sel:[0,0,0] op_sel_hi:[1,0,1]
v_pk_mul_f32 v[52:53],v[52:53],v[244:245]
v_pk_mul_f32 v[54:55],v[54:55],v[246:247]
v_cvt_pk_bf16_f32 v56,v48,v49
v_cvt_pk_bf16_f32 v57,v50,v51
v_cvt_pk_bf16_f32 v58,v52,v53
v_cvt_pk_bf16_f32 v59,v54,v55
buffer_store_dwordx4 v[56:59],v148,s[20:23],s47 offen sc1
v_accvgpr_read_b32 v48,a100
v_accvgpr_read_b32 v49,a101
v_accvgpr_read_b32 v50,a102
v_accvgpr_read_b32 v51,a103
v_pk_fma_f32 v[48:49],v[248:249],v[146:147],v[48:49] op_sel:[0,1,0] op_sel_hi:[1,1,1]
v_pk_fma_f32 v[50:51],v[250:251],v[146:147],v[50:51] op_sel:[0,1,0] op_sel_hi:[1,1,1]
v_pk_mul_f32 v[48:49],v[48:49],v[240:241]
v_pk_mul_f32 v[50:51],v[50:51],v[242:243]
v_accvgpr_read_b32 v52,a140
v_accvgpr_read_b32 v53,a141
v_accvgpr_read_b32 v54,a142
v_accvgpr_read_b32 v55,a143
v_pk_fma_f32 v[52:53],v[252:253],v[146:147],v[52:53] op_sel:[0,1,0] op_sel_hi:[1,1,1]
v_pk_fma_f32 v[54:55],v[254:255],v[146:147],v[54:55] op_sel:[0,1,0] op_sel_hi:[1,1,1]
v_pk_mul_f32 v[52:53],v[52:53],v[244:245]
v_pk_mul_f32 v[54:55],v[54:55],v[246:247]
v_cvt_pk_bf16_f32 v60,v48,v49
v_cvt_pk_bf16_f32 v61,v50,v51
v_cvt_pk_bf16_f32 v62,v52,v53
v_cvt_pk_bf16_f32 v63,v54,v55
buffer_store_dwordx4 v[60:63],v148,s[20:23],s47 offen offset:128 sc1
s_add_u32 s46,s46,4096
s_add_u32 s47,s47,4096
s_load_dwordx2 s[4:5],s[0:1],16
s_load_dwordx2 s[36:37],s[0:1],48
s_load_dwordx2 s[38:39],s[0:1],0
v_mov_b32 v76,0xdddd
v_and_b32 v3,3,v2
v_bfe_u32 v4,v2,2,1
v_cmp_eq_u32 vcc,0,v3
v_mov_b32 v5,0x3f803f80
s_nop 0
v_cndmask_b32 v5,0,v5,vcc
v_cmp_eq_u32 vcc,0,v4
s_nop 1
v_cndmask_b32 v72,0,v5,vcc
v_cndmask_b32 v73,0,v5,vcc
v_sub_u32 v74,v5,v72
v_sub_u32 v75,v5,v72
v_mov_b32 v32,0
v_mov_b32 v33,0
v_mov_b32 v34,0
v_mov_b32 v35,0
v_mov_b32 v36,0
v_mov_b32 v37,0
v_mov_b32 v38,0
v_mov_b32 v39,0
v_mov_b32 v40,0
v_mov_b32 v41,0
v_mov_b32 v42,0
v_mov_b32 v43,0
v_mov_b32 v44,0
v_mov_b32 v45,0
v_mov_b32 v46,0
v_mov_b32 v47,0
v_mov_b32 v48,0
v_mov_b32 v49,0
v_mov_b32 v50,0
v_mov_b32 v51,0
v_mov_b32 v52,0
v_mov_b32 v53,0
v_mov_b32 v54,0
v_mov_b32 v55,0
v_mov_b32 v56,0
v_mov_b32 v57,0
v_mov_b32 v58,0
v_mov_b32 v59,0
v_mov_b32 v60,0
v_mov_b32 v61,0
v_mov_b32 v62,0
v_mov_b32 v63,0
v_mov_b32 v64,0
v_mov_b32 v65,0
v_mov_b32 v66,0
v_mov_b32 v67,0
v_mov_b32 v68,0
v_mov_b32 v69,0
v_mov_b32 v70,0
v_mov_b32 v71,0
v_add_u32 v77,131072,v9
v_mov_b32 v78,v150
s_waitcnt lgkmcnt(0)
s_and_b32 s40,s2,1
s_mul_i32 s46,s40,5
s_xor_b32 s46,s46,s2
s_bfe_u32 s41,s46,0x10001
s_lshl_b32 s41,s41,3
s_bfe_u32 s42,s46,0x30003
s_add_u32 s41,s41,s42
s_bfe_u32 s42,s46,0x10002
s_lshl_b32 s42,s42,2
s_lshr_b32 s43,s46,6
s_add_u32 s42,s42,s43
s_and_b32 s44,s31,1
s_lshr_b32 s45,s31,1
s_lshl_b32 s29,s31,12
s_add_u32 s8,s6,0x1000000
s_addc_u32 s9,s7,0
s_and_b32 s9,s9,0xffff
s_mov_b32 s10,0x1200000
s_mov_b32 s11,0x00020000
s_mov_b32 s12,s36
s_and_b32 s13,s37,0xffff
s_mov_b32 s14,0x700000
s_mov_b32 s15,0x00020000
s_mov_b32 s16,s4
s_and_b32 s17,s5,0xffff
s_mov_b32 s18,0x200000
s_mov_b32 s19,0x00020000
s_mul_i32 s24,s41,1179648
s_lshl_b32 s46,s40,11
s_lshl_b32 s47,s45,13
s_add_u32 s46,s46,s47
s_add_u32 s25,s24,s46
s_add_u32 s25,s25,917504
s_add_u32 s24,s24,s29
s_mul_i32 s46,s40,901120
s_add_u32 s24,s24,s46
s_mul_i32 s32,s40,-32768
s_add_u32 s32,s32,16384
s_lshl_b32 s74,s32,3
s_mul_i32 s26,s40,7208960
s_lshl_b32 s46,s31,15
s_add_u32 s26,s26,s46
s_lshl_b32 s47,s42,8
s_add_u32 s26,s26,s47
s_lshl_b32 s46,s45,16
s_add_u32 s27,s46,s47
s_add_u32 s28,s27,0x8000
s_lshl_b32 s30,s45,13
s_lshl_b32 s33,s45,12
s_xor_b32 s43,s44,s40
s_add_u32 s4,s29,0x10000
s_add_u32 s5,s30,0x10000
s_add_u32 s36,s33,0x10000
v_lshrrev_b32 v3,4,v2
v_bfe_u32 v4,v2,1,3
v_and_b32 v5,1,v2
v_lshlrev_b32 v5,4,v5
v_lshl_add_u32 v5,v3,11,v5
v_xor_b32 v6,v4,v3
v_lshl_add_u32 v7,v6,5,v5
v_xor_b32 v6,4,v6
v_lshl_add_u32 v8,v6,5,v5
v_add_u32 v244,0,v7
v_add_u32 v245,7168,v8
v_add_u32 v246,14336,v7
v_add_u32 v247,21504,v8
v_add_u32 v28,2048,v9
v_lshrrev_b32 v3,5,v2
v_bfe_u32 v4,v2,4,1
v_and_b32 v5,15,v2
v_lshlrev_b32 v5,4,v5
v_lshl_add_u32 v5,v4,9,v5
v_lshl_add_u32 v4,v3,12,v5
s_lshl_b32 s46,s44,11
v_add_u32 v16,s46,v4
v_add_u32 v17,65536,v16
v_lshl_add_u32 v4,v3,11,v5
s_lshl_b32 s46,s43,10
v_add_u32 v26,s46,v4
v_add_u32 v27,65536,v26
v_lshrrev_b32 v3,2,v2
v_and_b32 v4,7,v3
v_and_b32 v5,3,v2
v_lshlrev_b32 v5,3,v5
v_lshl_add_u32 v6,v3,8,v5
s_lshl_b32 s46,s45,2
v_xor_b32 v4,s46,v4
v_xor_b32 v7,0,v4
v_lshl_add_u32 v18,v7,5,v6
v_add_u32 v19,65536,v18
v_xor_b32 v7,1,v4
v_lshl_add_u32 v20,v7,5,v6
v_add_u32 v21,65536,v20
v_xor_b32 v7,2,v4
v_lshl_add_u32 v22,v7,5,v6
v_add_u32 v23,65536,v22
v_xor_b32 v7,3,v4
v_lshl_add_u32 v24,v7,5,v6
v_add_u32 v25,65536,v24
s_lshr_b32 s46,s41,1
s_lshl_b32 s46,s46,7
s_add_u32 s46,s46,0x2701000
v_lshl_add_u32 v250,v2,2,s46
s_and_b32 s46,s2,7
s_lshl_b32 s46,s46,2
s_add_u32 s46,s46,0x2701060
v_and_b32 v3,7,v2
v_lshl_add_u32 v3,v3,7,s46
v_cmp_gt_u32 vcc,32,v2
s_nop 1
v_cndmask_b32 v250,v3,v250,vcc
s_waitcnt vmcnt(25)
s_barrier
ds_read_b128 v[80:83],v77
ds_read_b128 v[84:87],v77 offset:1024
ds_read_b128 v[96:99],v77 offset:2048
ds_read_b128 v[100:103],v77 offset:3072
s_waitcnt vmcnt(21)
s_branch L_attn
L_attn:
s_waitcnt lgkmcnt(0)
v_mfma_f32_32x32x16_bf16 v[112:127],v[80:83],a[64:67],0
v_mfma_f32_32x32x16_bf16 v[112:127],v[84:87],a[68:71],v[112:127]
s_nop 7
s_nop 3
ds_read_b128 v[88:91],v77 offset:4096
v_exp_f32 v112,v112
v_exp_f32 v113,v113
v_exp_f32 v114,v114
v_mfma_f32_32x32x16_bf16 v[128:143],v[80:83],a[72:75],0
ds_read_b128 v[92:95],v77 offset:5120
v_exp_f32 v115,v115
v_exp_f32 v116,v116
v_exp_f32 v117,v117
v_exp_f32 v118,v118
v_mfma_f32_32x32x16_bf16 v[128:143],v[84:87],a[76:79],v[128:143]
v_exp_f32 v119,v119
v_exp_f32 v120,v120
v_exp_f32 v121,v121
v_exp_f32 v122,v122
v_exp_f32 v123,v123
v_exp_f32 v124,v124
s_waitcnt lgkmcnt(0)
v_exp_f32 v125,v125
v_exp_f32 v126,v126
v_exp_f32 v127,v127
v_smfmac_f32_32x32x32_bf16 v[32:47],v[96:99],v[112:119],v76
ds_read_b128 v[104:107],v77 offset:6144
v_exp_f32 v128,v128
v_exp_f32 v129,v129
v_exp_f32 v130,v130
v_mfma_f32_32x32x16_bf16 v[144:159],v[88:91],a[64:67],0
ds_read_b128 v[108:111],v77 offset:7168
v_exp_f32 v131,v131
v_exp_f32 v132,v132
v_exp_f32 v133,v133
v_smfmac_f32_16x16x64_bf16 v[64:67],v[72:75],v[112:119],v76
v_exp_f32 v134,v134
v_mfma_f32_32x32x16_bf16 v[144:159],v[92:95],a[68:71],v[144:159]
v_exp_f32 v135,v135
v_exp_f32 v136,v136
v_exp_f32 v137,v137
v_smfmac_f32_32x32x32_bf16 v[32:47],v[100:103],v[120:127],v76
v_exp_f32 v138,v138
v_exp_f32 v139,v139
v_exp_f32 v140,v140
v_smfmac_f32_16x16x64_bf16 v[64:67],v[72:75],v[120:127],v76
v_exp_f32 v141,v141
v_exp_f32 v142,v142
v_exp_f32 v143,v143
v_smfmac_f32_32x32x32_bf16 v[48:63],v[96:99],v[128:135],v76
s_waitcnt vmcnt(4) lgkmcnt(0)
s_barrier
v_exp_f32 v144,v144
v_exp_f32 v145,v145
v_exp_f32 v146,v146
v_mfma_f32_32x32x16_bf16 v[160:175],v[88:91],a[72:75],0
ds_read_b128 v[80:83],v77 offset:8192
v_exp_f32 v147,v147
v_exp_f32 v148,v148
v_exp_f32 v149,v149
v_smfmac_f32_16x16x64_bf16 v[68:71],v[72:75],v[128:135],v76
ds_read_b128 v[84:87],v77 offset:9216
v_exp_f32 v150,v150
v_mfma_f32_32x32x16_bf16 v[160:175],v[92:95],a[76:79],v[160:175]
s_add_u32 m0,s69,131072
v_exp_f32 v151,v151
v_exp_f32 v152,v152
v_exp_f32 v153,v153
v_smfmac_f32_32x32x32_bf16 v[48:63],v[100:103],v[136:143],v76
buffer_load_dwordx4 v9,s[64:67],s68 offen sc1 lds
v_exp_f32 v154,v154
v_exp_f32 v155,v155
v_exp_f32 v156,v156
v_smfmac_f32_16x16x64_bf16 v[68:71],v[72:75],v[136:143],v76
s_waitcnt lgkmcnt(0)
v_exp_f32 v157,v157
v_exp_f32 v158,v158
v_exp_f32 v159,v159
v_smfmac_f32_32x32x32_bf16 v[32:47],v[104:107],v[144:151],v76
ds_read_b128 v[96:99],v77 offset:10240
v_exp_f32 v160,v160
v_exp_f32 v161,v161
v_exp_f32 v162,v162
v_mfma_f32_32x32x16_bf16 v[112:127],v[80:83],a[64:67],0
ds_read_b128 v[100:103],v77 offset:11264
v_exp_f32 v163,v163
v_exp_f32 v164,v164
v_exp_f32 v165,v165
v_smfmac_f32_16x16x64_bf16 v[64:67],v[72:75],v[144:151],v76
v_exp_f32 v166,v166
v_mfma_f32_32x32x16_bf16 v[112:127],v[84:87],a[68:71],v[112:127]
buffer_load_dwordx4 v9,s[64:67],s68 offen offset:1024 sc1 lds
v_exp_f32 v167,v167
v_exp_f32 v168,v168
v_exp_f32 v169,v169
v_smfmac_f32_32x32x32_bf16 v[32:47],v[108:111],v[152:159],v76
s_add_u32 s68,s68,8192
v_exp_f32 v170,v170
v_exp_f32 v171,v171
v_exp_f32 v172,v172
v_smfmac_f32_16x16x64_bf16 v[64:67],v[72:75],v[152:159],v76
v_exp_f32 v173,v173
v_exp_f32 v174,v174
v_exp_f32 v175,v175
v_smfmac_f32_32x32x32_bf16 v[48:63],v[104:107],v[160:167],v76
ds_read_b128 v[88:91],v77 offset:12288
v_exp_f32 v112,v112
v_exp_f32 v113,v113
v_exp_f32 v114,v114
v_mfma_f32_32x32x16_bf16 v[128:143],v[80:83],a[72:75],0
ds_read_b128 v[92:95],v77 offset:13312
v_exp_f32 v115,v115
v_exp_f32 v116,v116
v_exp_f32 v117,v117
v_smfmac_f32_16x16x64_bf16 v[68:71],v[72:75],v[160:167],v76
v_exp_f32 v118,v118
v_mfma_f32_32x32x16_bf16 v[128:143],v[84:87],a[76:79],v[128:143]
v_exp_f32 v119,v119
v_exp_f32 v120,v120
v_exp_f32 v121,v121
v_smfmac_f32_32x32x32_bf16 v[48:63],v[108:111],v[168:175],v76
v_exp_f32 v122,v122
v_exp_f32 v123,v123
v_exp_f32 v124,v124
v_smfmac_f32_16x16x64_bf16 v[68:71],v[72:75],v[168:175],v76
s_waitcnt lgkmcnt(0)
v_exp_f32 v125,v125
v_exp_f32 v126,v126
v_exp_f32 v127,v127
v_smfmac_f32_32x32x32_bf16 v[32:47],v[96:99],v[112:119],v76
ds_read_b128 v[104:107],v77 offset:14336
v_exp_f32 v128,v128
v_exp_f32 v129,v129
v_exp_f32 v130,v130
v_mfma_f32_32x32x16_bf16 v[144:159],v[88:91],a[64:67],0
ds_read_b128 v[108:111],v77 offset:15360
v_exp_f32 v131,v131
v_exp_f32 v132,v132
v_exp_f32 v133,v133
v_smfmac_f32_16x16x64_bf16 v[64:67],v[72:75],v[112:119],v76
v_exp_f32 v134,v134
v_mfma_f32_32x32x16_bf16 v[144:159],v[92:95],a[68:71],v[144:159]
v_exp_f32 v135,v135
v_exp_f32 v136,v136
v_exp_f32 v137,v137
v_smfmac_f32_32x32x32_bf16 v[32:47],v[100:103],v[120:127],v76
v_exp_f32 v138,v138
v_exp_f32 v139,v139
v_exp_f32 v140,v140
v_smfmac_f32_16x16x64_bf16 v[64:67],v[72:75],v[120:127],v76
v_exp_f32 v141,v141
v_exp_f32 v142,v142
v_exp_f32 v143,v143
v_smfmac_f32_32x32x32_bf16 v[48:63],v[96:99],v[128:135],v76
s_waitcnt vmcnt(4) lgkmcnt(0)
s_barrier
v_exp_f32 v144,v144
v_exp_f32 v145,v145
v_exp_f32 v146,v146
v_mfma_f32_32x32x16_bf16 v[160:175],v[88:91],a[72:75],0
ds_read_b128 v[80:83],v77 offset:16384
v_exp_f32 v147,v147
v_exp_f32 v148,v148
v_exp_f32 v149,v149
v_smfmac_f32_16x16x64_bf16 v[68:71],v[72:75],v[128:135],v76
ds_read_b128 v[84:87],v77 offset:17408
v_exp_f32 v150,v150
v_mfma_f32_32x32x16_bf16 v[160:175],v[92:95],a[76:79],v[160:175]
s_add_u32 m0,s69,139264
v_exp_f32 v151,v151
v_exp_f32 v152,v152
v_exp_f32 v153,v153
v_smfmac_f32_32x32x32_bf16 v[48:63],v[100:103],v[136:143],v76
buffer_load_dwordx4 v9,s[64:67],s68 offen sc1 lds
v_exp_f32 v154,v154
v_exp_f32 v155,v155
v_exp_f32 v156,v156
v_smfmac_f32_16x16x64_bf16 v[68:71],v[72:75],v[136:143],v76
s_waitcnt lgkmcnt(0)
v_exp_f32 v157,v157
v_exp_f32 v158,v158
v_exp_f32 v159,v159
v_smfmac_f32_32x32x32_bf16 v[32:47],v[104:107],v[144:151],v76
ds_read_b128 v[96:99],v77 offset:18432
v_exp_f32 v160,v160
v_exp_f32 v161,v161
v_exp_f32 v162,v162
v_mfma_f32_32x32x16_bf16 v[112:127],v[80:83],a[64:67],0
ds_read_b128 v[100:103],v77 offset:19456
v_exp_f32 v163,v163
v_exp_f32 v164,v164
v_exp_f32 v165,v165
v_smfmac_f32_16x16x64_bf16 v[64:67],v[72:75],v[144:151],v76
v_exp_f32 v166,v166
v_mfma_f32_32x32x16_bf16 v[112:127],v[84:87],a[68:71],v[112:127]
buffer_load_dwordx4 v9,s[64:67],s68 offen offset:1024 sc1 lds
v_exp_f32 v167,v167
v_exp_f32 v168,v168
v_exp_f32 v169,v169
v_smfmac_f32_32x32x32_bf16 v[32:47],v[108:111],v[152:159],v76
s_add_u32 s68,s68,8192
v_exp_f32 v170,v170
v_exp_f32 v171,v171
v_exp_f32 v172,v172
v_smfmac_f32_16x16x64_bf16 v[64:67],v[72:75],v[152:159],v76
v_exp_f32 v173,v173
v_exp_f32 v174,v174
v_exp_f32 v175,v175
v_smfmac_f32_32x32x32_bf16 v[48:63],v[104:107],v[160:167],v76
ds_read_b128 v[88:91],v77 offset:20480
v_exp_f32 v112,v112
v_exp_f32 v113,v113
v_exp_f32 v114,v114
v_mfma_f32_32x32x16_bf16 v[128:143],v[80:83],a[72:75],0
ds_read_b128 v[92:95],v77 offset:21504
v_exp_f32 v115,v115
v_exp_f32 v116,v116
v_exp_f32 v117,v117
v_smfmac_f32_16x16x64_bf16 v[68:71],v[72:75],v[160:167],v76
v_exp_f32 v118,v118
v_mfma_f32_32x32x16_bf16 v[128:143],v[84:87],a[76:79],v[128:143]
v_exp_f32 v119,v119
v_exp_f32 v120,v120
v_exp_f32 v121,v121
v_smfmac_f32_32x32x32_bf16 v[48:63],v[108:111],v[168:175],v76
v_exp_f32 v122,v122
v_exp_f32 v123,v123
v_exp_f32 v124,v124
v_smfmac_f32_16x16x64_bf16 v[68:71],v[72:75],v[168:175],v76
s_waitcnt lgkmcnt(0)
v_exp_f32 v125,v125
v_exp_f32 v126,v126
v_exp_f32 v127,v127
v_smfmac_f32_32x32x32_bf16 v[32:47],v[96:99],v[112:119],v76
ds_read_b128 v[104:107],v77 offset:22528
v_exp_f32 v128,v128
v_exp_f32 v129,v129
v_exp_f32 v130,v130
v_mfma_f32_32x32x16_bf16 v[144:159],v[88:91],a[64:67],0
ds_read_b128 v[108:111],v77 offset:23552
v_exp_f32 v131,v131
v_exp_f32 v132,v132
v_exp_f32 v133,v133
v_smfmac_f32_16x16x64_bf16 v[64:67],v[72:75],v[112:119],v76
v_exp_f32 v134,v134
v_mfma_f32_32x32x16_bf16 v[144:159],v[92:95],a[68:71],v[144:159]
v_exp_f32 v135,v135
v_exp_f32 v136,v136
v_exp_f32 v137,v137
v_smfmac_f32_32x32x32_bf16 v[32:47],v[100:103],v[120:127],v76
v_exp_f32 v138,v138
v_exp_f32 v139,v139
v_exp_f32 v140,v140
v_smfmac_f32_16x16x64_bf16 v[64:67],v[72:75],v[120:127],v76
v_exp_f32 v141,v141
v_exp_f32 v142,v142
v_exp_f32 v143,v143
v_smfmac_f32_32x32x32_bf16 v[48:63],v[96:99],v[128:135],v76
s_waitcnt vmcnt(4) lgkmcnt(0)
s_barrier
v_exp_f32 v144,v144
v_exp_f32 v145,v145
v_exp_f32 v146,v146
v_mfma_f32_32x32x16_bf16 v[160:175],v[88:91],a[72:75],0
ds_read_b128 v[80:83],v77 offset:24576
v_exp_f32 v147,v147
v_exp_f32 v148,v148
v_exp_f32 v149,v149
v_smfmac_f32_16x16x64_bf16 v[68:71],v[72:75],v[128:135],v76
ds_read_b128 v[84:87],v77 offset:25600
v_exp_f32 v150,v150
v_mfma_f32_32x32x16_bf16 v[160:175],v[92:95],a[76:79],v[160:175]
s_add_u32 m0,s69,147456
v_exp_f32 v151,v151
v_exp_f32 v152,v152
v_exp_f32 v153,v153
v_smfmac_f32_32x32x32_bf16 v[48:63],v[100:103],v[136:143],v76
buffer_load_dwordx4 v9,s[64:67],s68 offen sc1 lds
v_exp_f32 v154,v154
v_exp_f32 v155,v155
v_exp_f32 v156,v156
v_smfmac_f32_16x16x64_bf16 v[68:71],v[72:75],v[136:143],v76
s_waitcnt lgkmcnt(0)
v_exp_f32 v157,v157
v_exp_f32 v158,v158
v_exp_f32 v159,v159
v_smfmac_f32_32x32x32_bf16 v[32:47],v[104:107],v[144:151],v76
ds_read_b128 v[96:99],v77 offset:26624
v_exp_f32 v160,v160
v_exp_f32 v161,v161
v_exp_f32 v162,v162
v_mfma_f32_32x32x16_bf16 v[112:127],v[80:83],a[64:67],0
ds_read_b128 v[100:103],v77 offset:27648
v_exp_f32 v163,v163
v_exp_f32 v164,v164
v_exp_f32 v165,v165
v_smfmac_f32_16x16x64_bf16 v[64:67],v[72:75],v[144:151],v76
v_exp_f32 v166,v166
v_mfma_f32_32x32x16_bf16 v[112:127],v[84:87],a[68:71],v[112:127]
buffer_load_dwordx4 v9,s[64:67],s68 offen offset:1024 sc1 lds
v_exp_f32 v167,v167
v_exp_f32 v168,v168
v_exp_f32 v169,v169
v_smfmac_f32_32x32x32_bf16 v[32:47],v[108:111],v[152:159],v76
s_add_u32 s68,s68,8192
v_exp_f32 v170,v170
v_exp_f32 v171,v171
v_exp_f32 v172,v172
v_smfmac_f32_16x16x64_bf16 v[64:67],v[72:75],v[152:159],v76
v_exp_f32 v173,v173
v_exp_f32 v174,v174
v_exp_f32 v175,v175
v_smfmac_f32_32x32x32_bf16 v[48:63],v[104:107],v[160:167],v76
ds_read_b128 v[88:91],v77 offset:28672
v_exp_f32 v112,v112
v_exp_f32 v113,v113
v_exp_f32 v114,v114
v_mfma_f32_32x32x16_bf16 v[128:143],v[80:83],a[72:75],0
ds_read_b128 v[92:95],v77 offset:29696
v_exp_f32 v115,v115
v_exp_f32 v116,v116
v_exp_f32 v117,v117
v_smfmac_f32_16x16x64_bf16 v[68:71],v[72:75],v[160:167],v76
v_exp_f32 v118,v118
v_mfma_f32_32x32x16_bf16 v[128:143],v[84:87],a[76:79],v[128:143]
v_exp_f32 v119,v119
v_exp_f32 v120,v120
v_exp_f32 v121,v121
v_smfmac_f32_32x32x32_bf16 v[48:63],v[108:111],v[168:175],v76
v_exp_f32 v122,v122
v_exp_f32 v123,v123
v_exp_f32 v124,v124
v_smfmac_f32_16x16x64_bf16 v[68:71],v[72:75],v[168:175],v76
s_waitcnt lgkmcnt(0)
v_exp_f32 v125,v125
v_exp_f32 v126,v126
v_exp_f32 v127,v127
v_smfmac_f32_32x32x32_bf16 v[32:47],v[96:99],v[112:119],v76
ds_read_b128 v[104:107],v77 offset:30720
v_exp_f32 v128,v128
v_exp_f32 v129,v129
v_exp_f32 v130,v130
v_mfma_f32_32x32x16_bf16 v[144:159],v[88:91],a[64:67],0
ds_read_b128 v[108:111],v77 offset:31744
v_exp_f32 v131,v131
v_exp_f32 v132,v132
v_exp_f32 v133,v133
v_smfmac_f32_16x16x64_bf16 v[64:67],v[72:75],v[112:119],v76
v_exp_f32 v134,v134
v_mfma_f32_32x32x16_bf16 v[144:159],v[92:95],a[68:71],v[144:159]
v_exp_f32 v135,v135
v_exp_f32 v136,v136
v_exp_f32 v137,v137
v_smfmac_f32_32x32x32_bf16 v[32:47],v[100:103],v[120:127],v76
v_exp_f32 v138,v138
v_exp_f32 v139,v139
v_exp_f32 v140,v140
v_smfmac_f32_16x16x64_bf16 v[64:67],v[72:75],v[120:127],v76
v_exp_f32 v141,v141
v_exp_f32 v142,v142
v_exp_f32 v143,v143
v_smfmac_f32_32x32x32_bf16 v[48:63],v[96:99],v[128:135],v76
s_waitcnt vmcnt(4) lgkmcnt(0)
s_barrier
v_exp_f32 v144,v144
v_exp_f32 v145,v145
v_exp_f32 v146,v146
v_mfma_f32_32x32x16_bf16 v[160:175],v[88:91],a[72:75],0
ds_read_b128 v[80:83],v77
v_exp_f32 v147,v147
v_exp_f32 v148,v148
v_exp_f32 v149,v149
v_smfmac_f32_16x16x64_bf16 v[68:71],v[72:75],v[128:135],v76
ds_read_b128 v[84:87],v77 offset:1024
v_exp_f32 v150,v150
v_mfma_f32_32x32x16_bf16 v[160:175],v[92:95],a[76:79],v[160:175]
s_add_u32 m0,s69,155648
v_exp_f32 v151,v151
v_exp_f32 v152,v152
v_exp_f32 v153,v153
v_smfmac_f32_32x32x32_bf16 v[48:63],v[100:103],v[136:143],v76
buffer_load_dwordx4 v9,s[64:67],s68 offen sc1 lds
v_exp_f32 v154,v154
v_exp_f32 v155,v155
v_exp_f32 v156,v156
v_smfmac_f32_16x16x64_bf16 v[68:71],v[72:75],v[136:143],v76
s_waitcnt lgkmcnt(0)
v_exp_f32 v157,v157
v_exp_f32 v158,v158
v_exp_f32 v159,v159
v_smfmac_f32_32x32x32_bf16 v[32:47],v[104:107],v[144:151],v76
ds_read_b128 v[96:99],v77 offset:2048
v_exp_f32 v160,v160
v_exp_f32 v161,v161
v_exp_f32 v162,v162
v_mfma_f32_32x32x16_bf16 v[112:127],v[80:83],a[64:67],0
ds_read_b128 v[100:103],v77 offset:3072
v_exp_f32 v163,v163
v_exp_f32 v164,v164
v_exp_f32 v165,v165
v_smfmac_f32_16x16x64_bf16 v[64:67],v[72:75],v[144:151],v76
v_exp_f32 v166,v166
v_mfma_f32_32x32x16_bf16 v[112:127],v[84:87],a[68:71],v[112:127]
buffer_load_dwordx4 v9,s[64:67],s68 offen offset:1024 sc1 lds
v_exp_f32 v167,v167
v_exp_f32 v168,v168
v_exp_f32 v169,v169
v_smfmac_f32_32x32x32_bf16 v[32:47],v[108:111],v[152:159],v76
s_add_u32 s68,s68,8192
v_exp_f32 v170,v170
v_exp_f32 v171,v171
v_exp_f32 v172,v172
v_smfmac_f32_16x16x64_bf16 v[64:67],v[72:75],v[152:159],v76
s_lshl_b32 s62,s34,7
s_lshl_b32 s63,s35,2
s_add_u32 s62,s62,s63
s_add_u32 s62,s62,0x2701000
s_cmp_lg_u32 s31,0
s_cbranch_scc1 L_fh
v_mov_b32 v10,1
v_mov_b32 v11,0
s_mov_b64 exec,1
buffer_store_dword v10,v11,s[20:23],s62 offen sc1
s_mov_b64 exec,-1
L_fh:
v_exp_f32 v173,v173
v_exp_f32 v174,v174
v_exp_f32 v175,v175
v_smfmac_f32_32x32x32_bf16 v[48:63],v[104:107],v[160:167],v76
ds_read_b128 v[88:91],v77 offset:4096
v_exp_f32 v112,v112
v_exp_f32 v113,v113
v_exp_f32 v114,v114
v_mfma_f32_32x32x16_bf16 v[128:143],v[80:83],a[72:75],0
ds_read_b128 v[92:95],v77 offset:5120
v_exp_f32 v115,v115
v_exp_f32 v116,v116
v_exp_f32 v117,v117
v_smfmac_f32_16x16x64_bf16 v[68:71],v[72:75],v[160:167],v76
v_exp_f32 v118,v118
v_mfma_f32_32x32x16_bf16 v[128:143],v[84:87],a[76:79],v[128:143]
s_getpc_b64 s[56:57]
.Lct5:
s_add_u32 s56,s56,L_atfin-.Lct5
s_addc_u32 s57,s57,0
s_lshr_b32 s58,s2,3
v_exp_f32 v119,v119
v_exp_f32 v120,v120
v_exp_f32 v121,v121
v_smfmac_f32_32x32x32_bf16 v[48:63],v[108:111],v[168:175],v76
s_lshl_b32 s58,s58,2
s_add_u32 s58,s58,s31
v_exp_f32 v122,v122
v_exp_f32 v123,v123
v_exp_f32 v124,v124
v_smfmac_f32_16x16x64_bf16 v[68:71],v[72:75],v[168:175],v76
s_and_b32 s58,s58,15
s_lshl_b32 s58,s58,7
s_waitcnt lgkmcnt(0)
v_exp_f32 v125,v125
v_exp_f32 v126,v126
v_exp_f32 v127,v127
v_smfmac_f32_32x32x32_bf16 v[32:47],v[96:99],v[112:119],v76
ds_read_b128 v[104:107],v77 offset:6144
v_exp_f32 v128,v128
v_exp_f32 v129,v129
v_exp_f32 v130,v130
v_mfma_f32_32x32x16_bf16 v[144:159],v[88:91],a[64:67],0
ds_read_b128 v[108:111],v77 offset:7168
v_exp_f32 v131,v131
v_exp_f32 v132,v132
v_exp_f32 v133,v133
v_smfmac_f32_16x16x64_bf16 v[64:67],v[72:75],v[112:119],v76
v_exp_f32 v134,v134
v_mfma_f32_32x32x16_bf16 v[144:159],v[92:95],a[68:71],v[144:159]
v_lshlrev_b32 v242,11,v2
v_add_u32 v242,s58,v242
v_exp_f32 v135,v135
v_exp_f32 v136,v136
v_exp_f32 v137,v137
v_smfmac_f32_32x32x32_bf16 v[32:47],v[100:103],v[120:127],v76
v_min_u32 v242,L_fallback-L_atfin-4,v242
global_load_dword v243,v242,s[56:57]
v_exp_f32 v138,v138
v_exp_f32 v139,v139
v_exp_f32 v140,v140
v_smfmac_f32_16x16x64_bf16 v[64:67],v[72:75],v[120:127],v76
v_exp_f32 v141,v141
v_exp_f32 v142,v142
v_exp_f32 v143,v143
v_smfmac_f32_32x32x32_bf16 v[48:63],v[96:99],v[128:135],v76
s_waitcnt vmcnt(5) lgkmcnt(0)
s_barrier
v_exp_f32 v144,v144
v_exp_f32 v145,v145
v_exp_f32 v146,v146
v_mfma_f32_32x32x16_bf16 v[160:175],v[88:91],a[72:75],0
ds_read_b128 v[80:83],v77 offset:8192
v_exp_f32 v147,v147
v_exp_f32 v148,v148
v_exp_f32 v149,v149
v_smfmac_f32_16x16x64_bf16 v[68:71],v[72:75],v[128:135],v76
ds_read_b128 v[84:87],v77 offset:9216
v_exp_f32 v150,v150
v_mfma_f32_32x32x16_bf16 v[160:175],v[92:95],a[76:79],v[160:175]
s_add_u32 m0,s69,131072
v_exp_f32 v151,v151
v_exp_f32 v152,v152
v_exp_f32 v153,v153
v_smfmac_f32_32x32x32_bf16 v[48:63],v[100:103],v[136:143],v76
buffer_load_dwordx4 v9,s[64:67],s68 offen sc1 lds
v_exp_f32 v154,v154
v_exp_f32 v155,v155
v_exp_f32 v156,v156
v_smfmac_f32_16x16x64_bf16 v[68:71],v[72:75],v[136:143],v76
s_waitcnt lgkmcnt(0)
v_exp_f32 v157,v157
v_exp_f32 v158,v158
v_exp_f32 v159,v159
v_smfmac_f32_32x32x32_bf16 v[32:47],v[104:107],v[144:151],v76
ds_read_b128 v[96:99],v77 offset:10240
v_exp_f32 v160,v160
v_exp_f32 v161,v161
v_exp_f32 v162,v162
v_mfma_f32_32x32x16_bf16 v[112:127],v[80:83],a[64:67],0
ds_read_b128 v[100:103],v77 offset:11264
v_exp_f32 v163,v163
v_exp_f32 v164,v164
v_exp_f32 v165,v165
v_smfmac_f32_16x16x64_bf16 v[64:67],v[72:75],v[144:151],v76
v_exp_f32 v166,v166
v_mfma_f32_32x32x16_bf16 v[112:127],v[84:87],a[68:71],v[112:127]
buffer_load_dwordx4 v9,s[64:67],s68 offen offset:1024 sc1 lds
v_exp_f32 v167,v167
v_exp_f32 v168,v168
v_exp_f32 v169,v169
v_smfmac_f32_32x32x32_bf16 v[32:47],v[108:111],v[152:159],v76
s_add_u32 s68,s68,8192
v_exp_f32 v170,v170
v_exp_f32 v171,v171
v_exp_f32 v172,v172
v_smfmac_f32_16x16x64_bf16 v[64:67],v[72:75],v[152:159],v76
v_exp_f32 v173,v173
v_exp_f32 v174,v174
v_exp_f32 v175,v175
v_smfmac_f32_32x32x32_bf16 v[48:63],v[104:107],v[160:167],v76
ds_read_b128 v[88:91],v77 offset:12288
v_exp_f32 v112,v112
v_exp_f32 v113,v113
v_exp_f32 v114,v114
v_mfma_f32_32x32x16_bf16 v[128:143],v[80:83],a[72:75],0
ds_read_b128 v[92:95],v77 offset:13312
v_exp_f32 v115,v115
v_exp_f32 v116,v116
v_exp_f32 v117,v117
v_smfmac_f32_16x16x64_bf16 v[68:71],v[72:75],v[160:167],v76
v_exp_f32 v118,v118
v_mfma_f32_32x32x16_bf16 v[128:143],v[84:87],a[76:79],v[128:143]
v_exp_f32 v119,v119
v_exp_f32 v120,v120
v_exp_f32 v121,v121
v_smfmac_f32_32x32x32_bf16 v[48:63],v[108:111],v[168:175],v76
v_exp_f32 v122,v122
v_exp_f32 v123,v123
v_exp_f32 v124,v124
v_smfmac_f32_16x16x64_bf16 v[68:71],v[72:75],v[168:175],v76
s_waitcnt lgkmcnt(0)
v_exp_f32 v125,v125
v_exp_f32 v126,v126
v_exp_f32 v127,v127
v_smfmac_f32_32x32x32_bf16 v[32:47],v[96:99],v[112:119],v76
ds_read_b128 v[104:107],v77 offset:14336
v_exp_f32 v128,v128
v_exp_f32 v129,v129
v_exp_f32 v130,v130
v_mfma_f32_32x32x16_bf16 v[144:159],v[88:91],a[64:67],0
ds_read_b128 v[108:111],v77 offset:15360
v_exp_f32 v131,v131
v_exp_f32 v132,v132
v_exp_f32 v133,v133
v_smfmac_f32_16x16x64_bf16 v[64:67],v[72:75],v[112:119],v76
v_exp_f32 v134,v134
v_mfma_f32_32x32x16_bf16 v[144:159],v[92:95],a[68:71],v[144:159]
v_exp_f32 v135,v135
v_exp_f32 v136,v136
v_exp_f32 v137,v137
v_smfmac_f32_32x32x32_bf16 v[32:47],v[100:103],v[120:127],v76
v_exp_f32 v138,v138
v_exp_f32 v139,v139
v_exp_f32 v140,v140
v_smfmac_f32_16x16x64_bf16 v[64:67],v[72:75],v[120:127],v76
v_exp_f32 v141,v141
v_exp_f32 v142,v142
v_exp_f32 v143,v143
v_smfmac_f32_32x32x32_bf16 v[48:63],v[96:99],v[128:135],v76
s_waitcnt vmcnt(5) lgkmcnt(0)
s_barrier
v_exp_f32 v144,v144
v_exp_f32 v145,v145
v_exp_f32 v146,v146
v_mfma_f32_32x32x16_bf16 v[160:175],v[88:91],a[72:75],0
ds_read_b128 v[80:83],v77 offset:16384
v_exp_f32 v147,v147
v_exp_f32 v148,v148
v_exp_f32 v149,v149
v_smfmac_f32_16x16x64_bf16 v[68:71],v[72:75],v[128:135],v76
ds_read_b128 v[84:87],v77 offset:17408
v_exp_f32 v150,v150
v_mfma_f32_32x32x16_bf16 v[160:175],v[92:95],a[76:79],v[160:175]
s_add_u32 m0,s69,139264
v_exp_f32 v151,v151
v_exp_f32 v152,v152
v_exp_f32 v153,v153
v_smfmac_f32_32x32x32_bf16 v[48:63],v[100:103],v[136:143],v76
buffer_load_dwordx4 v9,s[64:67],s68 offen sc1 lds
v_exp_f32 v154,v154
v_exp_f32 v155,v155
v_exp_f32 v156,v156
v_smfmac_f32_16x16x64_bf16 v[68:71],v[72:75],v[136:143],v76
s_waitcnt lgkmcnt(0)
v_exp_f32 v157,v157
v_exp_f32 v158,v158
v_exp_f32 v159,v159
v_smfmac_f32_32x32x32_bf16 v[32:47],v[104:107],v[144:151],v76
ds_read_b128 v[96:99],v77 offset:18432
v_exp_f32 v160,v160
v_exp_f32 v161,v161
v_exp_f32 v162,v162
v_mfma_f32_32x32x16_bf16 v[112:127],v[80:83],a[64:67],0
ds_read_b128 v[100:103],v77 offset:19456
v_exp_f32 v163,v163
v_exp_f32 v164,v164
v_exp_f32 v165,v165
v_smfmac_f32_16x16x64_bf16 v[64:67],v[72:75],v[144:151],v76
v_exp_f32 v166,v166
v_mfma_f32_32x32x16_bf16 v[112:127],v[84:87],a[68:71],v[112:127]
buffer_load_dwordx4 v9,s[64:67],s68 offen offset:1024 sc1 lds
v_exp_f32 v167,v167
v_exp_f32 v168,v168
v_exp_f32 v169,v169
v_smfmac_f32_32x32x32_bf16 v[32:47],v[108:111],v[152:159],v76
s_add_u32 s68,s68,8192
v_exp_f32 v170,v170
v_exp_f32 v171,v171
v_exp_f32 v172,v172
v_smfmac_f32_16x16x64_bf16 v[64:67],v[72:75],v[152:159],v76
v_exp_f32 v173,v173
v_exp_f32 v174,v174
v_exp_f32 v175,v175
v_smfmac_f32_32x32x32_bf16 v[48:63],v[104:107],v[160:167],v76
ds_read_b128 v[88:91],v77 offset:20480
v_exp_f32 v112,v112
v_exp_f32 v113,v113
v_exp_f32 v114,v114
v_mfma_f32_32x32x16_bf16 v[128:143],v[80:83],a[72:75],0
ds_read_b128 v[92:95],v77 offset:21504
v_exp_f32 v115,v115
v_exp_f32 v116,v116
v_exp_f32 v117,v117
v_smfmac_f32_16x16x64_bf16 v[68:71],v[72:75],v[160:167],v76
v_exp_f32 v118,v118
v_mfma_f32_32x32x16_bf16 v[128:143],v[84:87],a[76:79],v[128:143]
v_exp_f32 v119,v119
v_exp_f32 v120,v120
v_exp_f32 v121,v121
v_smfmac_f32_32x32x32_bf16 v[48:63],v[108:111],v[168:175],v76
v_exp_f32 v122,v122
v_exp_f32 v123,v123
v_exp_f32 v124,v124
v_smfmac_f32_16x16x64_bf16 v[68:71],v[72:75],v[168:175],v76
s_waitcnt lgkmcnt(0)
v_exp_f32 v125,v125
v_exp_f32 v126,v126
v_exp_f32 v127,v127
v_smfmac_f32_32x32x32_bf16 v[32:47],v[96:99],v[112:119],v76
ds_read_b128 v[104:107],v77 offset:22528
v_exp_f32 v128,v128
v_exp_f32 v129,v129
v_exp_f32 v130,v130
v_mfma_f32_32x32x16_bf16 v[144:159],v[88:91],a[64:67],0
ds_read_b128 v[108:111],v77 offset:23552
v_exp_f32 v131,v131
v_exp_f32 v132,v132
v_exp_f32 v133,v133
v_smfmac_f32_16x16x64_bf16 v[64:67],v[72:75],v[112:119],v76
v_exp_f32 v134,v134
v_mfma_f32_32x32x16_bf16 v[144:159],v[92:95],a[68:71],v[144:159]
v_exp_f32 v135,v135
v_exp_f32 v136,v136
v_exp_f32 v137,v137
v_smfmac_f32_32x32x32_bf16 v[32:47],v[100:103],v[120:127],v76
v_exp_f32 v138,v138
v_exp_f32 v139,v139
v_exp_f32 v140,v140
v_smfmac_f32_16x16x64_bf16 v[64:67],v[72:75],v[120:127],v76
v_exp_f32 v141,v141
v_exp_f32 v142,v142
v_exp_f32 v143,v143
v_smfmac_f32_32x32x32_bf16 v[48:63],v[96:99],v[128:135],v76
s_waitcnt vmcnt(5) lgkmcnt(0)
s_barrier
v_exp_f32 v144,v144
v_exp_f32 v145,v145
v_exp_f32 v146,v146
v_mfma_f32_32x32x16_bf16 v[160:175],v[88:91],a[72:75],0
ds_read_b128 v[80:83],v77 offset:24576
v_exp_f32 v147,v147
v_exp_f32 v148,v148
v_exp_f32 v149,v149
v_smfmac_f32_16x16x64_bf16 v[68:71],v[72:75],v[128:135],v76
ds_read_b128 v[84:87],v77 offset:25600
v_exp_f32 v150,v150
v_mfma_f32_32x32x16_bf16 v[160:175],v[92:95],a[76:79],v[160:175]
s_add_u32 m0,s69,147456
v_exp_f32 v151,v151
v_exp_f32 v152,v152
v_exp_f32 v153,v153
v_smfmac_f32_32x32x32_bf16 v[48:63],v[100:103],v[136:143],v76
buffer_load_dwordx4 v9,s[64:67],s68 offen sc1 lds
v_exp_f32 v154,v154
v_exp_f32 v155,v155
v_exp_f32 v156,v156
v_smfmac_f32_16x16x64_bf16 v[68:71],v[72:75],v[136:143],v76
s_waitcnt lgkmcnt(0)
v_exp_f32 v157,v157
v_exp_f32 v158,v158
v_exp_f32 v159,v159
v_smfmac_f32_32x32x32_bf16 v[32:47],v[104:107],v[144:151],v76
ds_read_b128 v[96:99],v77 offset:26624
v_exp_f32 v160,v160
v_exp_f32 v161,v161
v_exp_f32 v162,v162
v_mfma_f32_32x32x16_bf16 v[112:127],v[80:83],a[64:67],0
ds_read_b128 v[100:103],v77 offset:27648
v_exp_f32 v163,v163
v_exp_f32 v164,v164
v_exp_f32 v165,v165
v_smfmac_f32_16x16x64_bf16 v[64:67],v[72:75],v[144:151],v76
v_exp_f32 v166,v166
v_mfma_f32_32x32x16_bf16 v[112:127],v[84:87],a[68:71],v[112:127]
buffer_load_dwordx4 v9,s[64:67],s68 offen offset:1024 sc1 lds
v_exp_f32 v167,v167
v_exp_f32 v168,v168
v_exp_f32 v169,v169
v_smfmac_f32_32x32x32_bf16 v[32:47],v[108:111],v[152:159],v76
s_add_u32 s68,s68,8192
v_exp_f32 v170,v170
v_exp_f32 v171,v171
v_exp_f32 v172,v172
v_smfmac_f32_16x16x64_bf16 v[64:67],v[72:75],v[152:159],v76
v_exp_f32 v173,v173
v_exp_f32 v174,v174
v_exp_f32 v175,v175
v_smfmac_f32_32x32x32_bf16 v[48:63],v[104:107],v[160:167],v76
ds_read_b128 v[88:91],v77 offset:28672
v_exp_f32 v112,v112
v_exp_f32 v113,v113
v_exp_f32 v114,v114
v_mfma_f32_32x32x16_bf16 v[128:143],v[80:83],a[72:75],0
ds_read_b128 v[92:95],v77 offset:29696
v_exp_f32 v115,v115
v_exp_f32 v116,v116
v_exp_f32 v117,v117
v_smfmac_f32_16x16x64_bf16 v[68:71],v[72:75],v[160:167],v76
v_exp_f32 v118,v118
v_mfma_f32_32x32x16_bf16 v[128:143],v[84:87],a[76:79],v[128:143]
v_exp_f32 v119,v119
v_exp_f32 v120,v120
v_exp_f32 v121,v121
v_smfmac_f32_32x32x32_bf16 v[48:63],v[108:111],v[168:175],v76
v_exp_f32 v122,v122
v_exp_f32 v123,v123
v_exp_f32 v124,v124
v_smfmac_f32_16x16x64_bf16 v[68:71],v[72:75],v[168:175],v76
s_waitcnt lgkmcnt(0)
v_exp_f32 v125,v125
v_exp_f32 v126,v126
v_exp_f32 v127,v127
v_smfmac_f32_32x32x32_bf16 v[32:47],v[96:99],v[112:119],v76
ds_read_b128 v[104:107],v77 offset:30720
v_exp_f32 v128,v128
v_exp_f32 v129,v129
v_exp_f32 v130,v130
v_mfma_f32_32x32x16_bf16 v[144:159],v[88:91],a[64:67],0
ds_read_b128 v[108:111],v77 offset:31744
v_exp_f32 v131,v131
v_exp_f32 v132,v132
v_exp_f32 v133,v133
v_smfmac_f32_16x16x64_bf16 v[64:67],v[72:75],v[112:119],v76
v_exp_f32 v134,v134
v_mfma_f32_32x32x16_bf16 v[144:159],v[92:95],a[68:71],v[144:159]
v_exp_f32 v135,v135
v_exp_f32 v136,v136
v_exp_f32 v137,v137
v_smfmac_f32_32x32x32_bf16 v[32:47],v[100:103],v[120:127],v76
v_exp_f32 v138,v138
v_exp_f32 v139,v139
v_exp_f32 v140,v140
v_smfmac_f32_16x16x64_bf16 v[64:67],v[72:75],v[120:127],v76
v_exp_f32 v141,v141
v_exp_f32 v142,v142
v_exp_f32 v143,v143
v_smfmac_f32_32x32x32_bf16 v[48:63],v[96:99],v[128:135],v76
s_waitcnt vmcnt(4) lgkmcnt(0)
s_barrier
v_exp_f32 v144,v144
v_exp_f32 v145,v145
v_exp_f32 v146,v146
v_mfma_f32_32x32x16_bf16 v[160:175],v[88:91],a[72:75],0
ds_read_b128 v[80:83],v77
v_exp_f32 v147,v147
v_exp_f32 v148,v148
v_exp_f32 v149,v149
v_smfmac_f32_16x16x64_bf16 v[68:71],v[72:75],v[128:135],v76
ds_read_b128 v[84:87],v77 offset:1024
v_exp_f32 v150,v150
v_mfma_f32_32x32x16_bf16 v[160:175],v[92:95],a[76:79],v[160:175]
s_add_u32 m0,s69,155648
v_exp_f32 v151,v151
v_exp_f32 v152,v152
v_exp_f32 v153,v153
v_smfmac_f32_32x32x32_bf16 v[48:63],v[100:103],v[136:143],v76
buffer_load_dwordx4 v9,s[64:67],s68 offen sc1 lds
v_exp_f32 v154,v154
v_exp_f32 v155,v155
v_exp_f32 v156,v156
v_smfmac_f32_16x16x64_bf16 v[68:71],v[72:75],v[136:143],v76
s_waitcnt lgkmcnt(0)
v_exp_f32 v157,v157
v_exp_f32 v158,v158
v_exp_f32 v159,v159
v_smfmac_f32_32x32x32_bf16 v[32:47],v[104:107],v[144:151],v76
ds_read_b128 v[96:99],v77 offset:2048
v_exp_f32 v160,v160
v_exp_f32 v161,v161
v_exp_f32 v162,v162
v_mfma_f32_32x32x16_bf16 v[112:127],v[80:83],a[64:67],0
ds_read_b128 v[100:103],v77 offset:3072
v_exp_f32 v163,v163
v_exp_f32 v164,v164
v_exp_f32 v165,v165
v_smfmac_f32_16x16x64_bf16 v[64:67],v[72:75],v[144:151],v76
v_exp_f32 v166,v166
v_mfma_f32_32x32x16_bf16 v[112:127],v[84:87],a[68:71],v[112:127]
buffer_load_dwordx4 v9,s[64:67],s68 offen offset:1024 sc1 lds
v_exp_f32 v167,v167
v_exp_f32 v168,v168
v_exp_f32 v169,v169
v_smfmac_f32_32x32x32_bf16 v[32:47],v[108:111],v[152:159],v76
s_add_u32 s68,s68,8192
v_exp_f32 v170,v170
v_exp_f32 v171,v171
v_exp_f32 v172,v172
v_smfmac_f32_16x16x64_bf16 v[64:67],v[72:75],v[152:159],v76
v_exp_f32 v173,v173
v_exp_f32 v174,v174
v_exp_f32 v175,v175
v_smfmac_f32_32x32x32_bf16 v[48:63],v[104:107],v[160:167],v76
ds_read_b128 v[88:91],v77 offset:4096
v_exp_f32 v112,v112
v_exp_f32 v113,v113
v_exp_f32 v114,v114
v_mfma_f32_32x32x16_bf16 v[128:143],v[80:83],a[72:75],0
ds_read_b128 v[92:95],v77 offset:5120
v_exp_f32 v115,v115
v_exp_f32 v116,v116
v_exp_f32 v117,v117
v_smfmac_f32_16x16x64_bf16 v[68:71],v[72:75],v[160:167],v76
v_exp_f32 v118,v118
v_mfma_f32_32x32x16_bf16 v[128:143],v[84:87],a[76:79],v[128:143]
v_exp_f32 v119,v119
v_exp_f32 v120,v120
v_exp_f32 v121,v121
v_smfmac_f32_32x32x32_bf16 v[48:63],v[108:111],v[168:175],v76
v_exp_f32 v122,v122
v_exp_f32 v123,v123
v_exp_f32 v124,v124
v_smfmac_f32_16x16x64_bf16 v[68:71],v[72:75],v[168:175],v76
s_waitcnt lgkmcnt(0)
v_exp_f32 v125,v125
v_exp_f32 v126,v126
v_exp_f32 v127,v127
v_smfmac_f32_32x32x32_bf16 v[32:47],v[96:99],v[112:119],v76
ds_read_b128 v[104:107],v77 offset:6144
v_exp_f32 v128,v128
v_exp_f32 v129,v129
v_exp_f32 v130,v130
v_mfma_f32_32x32x16_bf16 v[144:159],v[88:91],a[64:67],0
ds_read_b128 v[108:111],v77 offset:7168
v_exp_f32 v131,v131
v_exp_f32 v132,v132
v_exp_f32 v133,v133
v_smfmac_f32_16x16x64_bf16 v[64:67],v[72:75],v[112:119],v76
v_exp_f32 v134,v134
v_mfma_f32_32x32x16_bf16 v[144:159],v[92:95],a[68:71],v[144:159]
v_exp_f32 v135,v135
v_exp_f32 v136,v136
v_exp_f32 v137,v137
v_smfmac_f32_32x32x32_bf16 v[32:47],v[100:103],v[120:127],v76
v_exp_f32 v138,v138
v_exp_f32 v139,v139
v_exp_f32 v140,v140
v_smfmac_f32_16x16x64_bf16 v[64:67],v[72:75],v[120:127],v76
v_exp_f32 v141,v141
v_exp_f32 v142,v142
v_exp_f32 v143,v143
v_smfmac_f32_32x32x32_bf16 v[48:63],v[96:99],v[128:135],v76
s_waitcnt vmcnt(4) lgkmcnt(0)
s_barrier
v_exp_f32 v144,v144
v_exp_f32 v145,v145
v_exp_f32 v146,v146
v_mfma_f32_32x32x16_bf16 v[160:175],v[88:91],a[72:75],0
ds_read_b128 v[80:83],v77 offset:8192
v_exp_f32 v147,v147
v_exp_f32 v148,v148
v_exp_f32 v149,v149
v_smfmac_f32_16x16x64_bf16 v[68:71],v[72:75],v[128:135],v76
ds_read_b128 v[84:87],v77 offset:9216
v_exp_f32 v150,v150
v_mfma_f32_32x32x16_bf16 v[160:175],v[92:95],a[76:79],v[160:175]
s_add_u32 m0,s69,131072
v_exp_f32 v151,v151
v_exp_f32 v152,v152
v_exp_f32 v153,v153
v_smfmac_f32_32x32x32_bf16 v[48:63],v[100:103],v[136:143],v76
buffer_load_dwordx4 v9,s[64:67],s68 offen sc1 lds
v_exp_f32 v154,v154
v_exp_f32 v155,v155
v_exp_f32 v156,v156
v_smfmac_f32_16x16x64_bf16 v[68:71],v[72:75],v[136:143],v76
s_waitcnt lgkmcnt(0)
v_exp_f32 v157,v157
v_exp_f32 v158,v158
v_exp_f32 v159,v159
v_smfmac_f32_32x32x32_bf16 v[32:47],v[104:107],v[144:151],v76
ds_read_b128 v[96:99],v77 offset:10240
v_exp_f32 v160,v160
v_exp_f32 v161,v161
v_exp_f32 v162,v162
v_mfma_f32_32x32x16_bf16 v[112:127],v[80:83],a[64:67],0
ds_read_b128 v[100:103],v77 offset:11264
v_exp_f32 v163,v163
v_exp_f32 v164,v164
v_exp_f32 v165,v165
v_smfmac_f32_16x16x64_bf16 v[64:67],v[72:75],v[144:151],v76
v_exp_f32 v166,v166
v_mfma_f32_32x32x16_bf16 v[112:127],v[84:87],a[68:71],v[112:127]
buffer_load_dwordx4 v9,s[64:67],s68 offen offset:1024 sc1 lds
v_exp_f32 v167,v167
v_exp_f32 v168,v168
v_exp_f32 v169,v169
v_smfmac_f32_32x32x32_bf16 v[32:47],v[108:111],v[152:159],v76
s_add_u32 s68,s68,8192
v_exp_f32 v170,v170
v_exp_f32 v171,v171
v_exp_f32 v172,v172
v_smfmac_f32_16x16x64_bf16 v[64:67],v[72:75],v[152:159],v76
v_exp_f32 v173,v173
v_exp_f32 v174,v174
v_exp_f32 v175,v175
v_smfmac_f32_32x32x32_bf16 v[48:63],v[104:107],v[160:167],v76
ds_read_b128 v[88:91],v77 offset:12288
v_exp_f32 v112,v112
v_exp_f32 v113,v113
v_exp_f32 v114,v114
v_mfma_f32_32x32x16_bf16 v[128:143],v[80:83],a[72:75],0
ds_read_b128 v[92:95],v77 offset:13312
v_exp_f32 v115,v115
v_exp_f32 v116,v116
v_exp_f32 v117,v117
v_smfmac_f32_16x16x64_bf16 v[68:71],v[72:75],v[160:167],v76
v_exp_f32 v118,v118
v_mfma_f32_32x32x16_bf16 v[128:143],v[84:87],a[76:79],v[128:143]
v_exp_f32 v119,v119
v_exp_f32 v120,v120
v_exp_f32 v121,v121
v_smfmac_f32_32x32x32_bf16 v[48:63],v[108:111],v[168:175],v76
buffer_load_dword v240,v250,s[20:23],0 offen sc1
v_exp_f32 v122,v122
v_exp_f32 v123,v123
v_exp_f32 v124,v124
v_smfmac_f32_16x16x64_bf16 v[68:71],v[72:75],v[168:175],v76
s_waitcnt lgkmcnt(0)
v_exp_f32 v125,v125
v_exp_f32 v126,v126
v_exp_f32 v127,v127
v_smfmac_f32_32x32x32_bf16 v[32:47],v[96:99],v[112:119],v76
ds_read_b128 v[104:107],v77 offset:14336
v_exp_f32 v128,v128
v_exp_f32 v129,v129
v_exp_f32 v130,v130
v_mfma_f32_32x32x16_bf16 v[144:159],v[88:91],a[64:67],0
ds_read_b128 v[108:111],v77 offset:15360
v_exp_f32 v131,v131
v_exp_f32 v132,v132
v_exp_f32 v133,v133
v_smfmac_f32_16x16x64_bf16 v[64:67],v[72:75],v[112:119],v76
v_exp_f32 v134,v134
v_mfma_f32_32x32x16_bf16 v[144:159],v[92:95],a[68:71],v[144:159]
v_exp_f32 v135,v135
v_exp_f32 v136,v136
v_exp_f32 v137,v137
v_smfmac_f32_32x32x32_bf16 v[32:47],v[100:103],v[120:127],v76
v_exp_f32 v138,v138
v_exp_f32 v139,v139
v_exp_f32 v140,v140
v_smfmac_f32_16x16x64_bf16 v[64:67],v[72:75],v[120:127],v76
v_exp_f32 v141,v141
v_exp_f32 v142,v142
v_exp_f32 v143,v143
v_smfmac_f32_32x32x32_bf16 v[48:63],v[96:99],v[128:135],v76
s_waitcnt vmcnt(5) lgkmcnt(0)
s_barrier
v_exp_f32 v144,v144
v_exp_f32 v145,v145
v_exp_f32 v146,v146
v_mfma_f32_32x32x16_bf16 v[160:175],v[88:91],a[72:75],0
ds_read_b128 v[80:83],v77 offset:16384
v_exp_f32 v147,v147
v_exp_f32 v148,v148
v_exp_f32 v149,v149
v_smfmac_f32_16x16x64_bf16 v[68:71],v[72:75],v[128:135],v76
ds_read_b128 v[84:87],v77 offset:17408
v_exp_f32 v150,v150
v_mfma_f32_32x32x16_bf16 v[160:175],v[92:95],a[76:79],v[160:175]
s_add_u32 m0,s69,139264
v_exp_f32 v151,v151
v_exp_f32 v152,v152
v_exp_f32 v153,v153
v_smfmac_f32_32x32x32_bf16 v[48:63],v[100:103],v[136:143],v76
buffer_load_dwordx4 v9,s[64:67],s68 offen sc1 lds
v_exp_f32 v154,v154
v_exp_f32 v155,v155
v_exp_f32 v156,v156
v_smfmac_f32_16x16x64_bf16 v[68:71],v[72:75],v[136:143],v76
s_waitcnt lgkmcnt(0)
v_exp_f32 v157,v157
v_exp_f32 v158,v158
v_exp_f32 v159,v159
v_smfmac_f32_32x32x32_bf16 v[32:47],v[104:107],v[144:151],v76
ds_read_b128 v[96:99],v77 offset:18432
v_exp_f32 v160,v160
v_exp_f32 v161,v161
v_exp_f32 v162,v162
v_mfma_f32_32x32x16_bf16 v[112:127],v[80:83],a[64:67],0
ds_read_b128 v[100:103],v77 offset:19456
v_exp_f32 v163,v163
v_exp_f32 v164,v164
v_exp_f32 v165,v165
v_smfmac_f32_16x16x64_bf16 v[64:67],v[72:75],v[144:151],v76
v_exp_f32 v166,v166
v_mfma_f32_32x32x16_bf16 v[112:127],v[84:87],a[68:71],v[112:127]
buffer_load_dwordx4 v9,s[64:67],s68 offen offset:1024 sc1 lds
v_exp_f32 v167,v167
v_exp_f32 v168,v168
v_exp_f32 v169,v169
v_smfmac_f32_32x32x32_bf16 v[32:47],v[108:111],v[152:159],v76
s_add_u32 s68,s68,8192
v_exp_f32 v170,v170
v_exp_f32 v171,v171
v_exp_f32 v172,v172
v_smfmac_f32_16x16x64_bf16 v[64:67],v[72:75],v[152:159],v76
v_exp_f32 v173,v173
v_exp_f32 v174,v174
v_exp_f32 v175,v175
v_smfmac_f32_32x32x32_bf16 v[48:63],v[104:107],v[160:167],v76
ds_read_b128 v[88:91],v77 offset:20480
v_exp_f32 v112,v112
v_exp_f32 v113,v113
v_exp_f32 v114,v114
v_mfma_f32_32x32x16_bf16 v[128:143],v[80:83],a[72:75],0
ds_read_b128 v[92:95],v77 offset:21504
v_exp_f32 v115,v115
v_exp_f32 v116,v116
v_exp_f32 v117,v117
v_smfmac_f32_16x16x64_bf16 v[68:71],v[72:75],v[160:167],v76
v_exp_f32 v118,v118
v_mfma_f32_32x32x16_bf16 v[128:143],v[84:87],a[76:79],v[128:143]
v_exp_f32 v119,v119
v_exp_f32 v120,v120
v_exp_f32 v121,v121
v_smfmac_f32_32x32x32_bf16 v[48:63],v[108:111],v[168:175],v76
v_exp_f32 v122,v122
v_exp_f32 v123,v123
v_exp_f32 v124,v124
v_smfmac_f32_16x16x64_bf16 v[68:71],v[72:75],v[168:175],v76
s_waitcnt lgkmcnt(0)
v_exp_f32 v125,v125
v_exp_f32 v126,v126
v_exp_f32 v127,v127
v_smfmac_f32_32x32x32_bf16 v[32:47],v[96:99],v[112:119],v76
ds_read_b128 v[104:107],v77 offset:22528
v_exp_f32 v128,v128
v_exp_f32 v129,v129
v_exp_f32 v130,v130
v_mfma_f32_32x32x16_bf16 v[144:159],v[88:91],a[64:67],0
ds_read_b128 v[108:111],v77 offset:23552
v_exp_f32 v131,v131
v_exp_f32 v132,v132
v_exp_f32 v133,v133
v_smfmac_f32_16x16x64_bf16 v[64:67],v[72:75],v[112:119],v76
v_exp_f32 v134,v134
v_mfma_f32_32x32x16_bf16 v[144:159],v[92:95],a[68:71],v[144:159]
v_exp_f32 v135,v135
v_exp_f32 v136,v136
v_exp_f32 v137,v137
v_smfmac_f32_32x32x32_bf16 v[32:47],v[100:103],v[120:127],v76
v_exp_f32 v138,v138
v_exp_f32 v139,v139
v_exp_f32 v140,v140
v_smfmac_f32_16x16x64_bf16 v[64:67],v[72:75],v[120:127],v76
v_exp_f32 v141,v141
v_exp_f32 v142,v142
v_exp_f32 v143,v143
v_smfmac_f32_32x32x32_bf16 v[48:63],v[96:99],v[128:135],v76
s_waitcnt vmcnt(5) lgkmcnt(0)
s_barrier
v_exp_f32 v144,v144
v_exp_f32 v145,v145
v_exp_f32 v146,v146
v_mfma_f32_32x32x16_bf16 v[160:175],v[88:91],a[72:75],0
ds_read_b128 v[80:83],v77 offset:24576
v_exp_f32 v147,v147
v_exp_f32 v148,v148
v_exp_f32 v149,v149
v_smfmac_f32_16x16x64_bf16 v[68:71],v[72:75],v[128:135],v76
ds_read_b128 v[84:87],v77 offset:25600
v_exp_f32 v150,v150
v_mfma_f32_32x32x16_bf16 v[160:175],v[92:95],a[76:79],v[160:175]
s_add_u32 m0,s69,147456
v_exp_f32 v151,v151
v_exp_f32 v152,v152
v_exp_f32 v153,v153
v_smfmac_f32_32x32x32_bf16 v[48:63],v[100:103],v[136:143],v76
buffer_load_dwordx4 v9,s[64:67],s68 offen sc1 lds
v_exp_f32 v154,v154
v_exp_f32 v155,v155
v_exp_f32 v156,v156
v_smfmac_f32_16x16x64_bf16 v[68:71],v[72:75],v[136:143],v76
s_waitcnt lgkmcnt(0)
v_exp_f32 v157,v157
v_exp_f32 v158,v158
v_exp_f32 v159,v159
v_smfmac_f32_32x32x32_bf16 v[32:47],v[104:107],v[144:151],v76
ds_read_b128 v[96:99],v77 offset:26624
v_exp_f32 v160,v160
v_exp_f32 v161,v161
v_exp_f32 v162,v162
v_mfma_f32_32x32x16_bf16 v[112:127],v[80:83],a[64:67],0
ds_read_b128 v[100:103],v77 offset:27648
v_exp_f32 v163,v163
v_exp_f32 v164,v164
v_exp_f32 v165,v165
v_smfmac_f32_16x16x64_bf16 v[64:67],v[72:75],v[144:151],v76
v_exp_f32 v166,v166
v_mfma_f32_32x32x16_bf16 v[112:127],v[84:87],a[68:71],v[112:127]
buffer_load_dwordx4 v9,s[64:67],s68 offen offset:1024 sc1 lds
v_exp_f32 v167,v167
v_exp_f32 v168,v168
v_exp_f32 v169,v169
v_smfmac_f32_32x32x32_bf16 v[32:47],v[108:111],v[152:159],v76
s_add_u32 s68,s68,8192
v_exp_f32 v170,v170
v_exp_f32 v171,v171
v_exp_f32 v172,v172
v_smfmac_f32_16x16x64_bf16 v[64:67],v[72:75],v[152:159],v76
v_exp_f32 v173,v173
v_exp_f32 v174,v174
v_exp_f32 v175,v175
v_smfmac_f32_32x32x32_bf16 v[48:63],v[104:107],v[160:167],v76
ds_read_b128 v[88:91],v77 offset:28672
v_exp_f32 v112,v112
v_exp_f32 v113,v113
v_exp_f32 v114,v114
v_mfma_f32_32x32x16_bf16 v[128:143],v[80:83],a[72:75],0
ds_read_b128 v[92:95],v77 offset:29696
v_exp_f32 v115,v115
v_exp_f32 v116,v116
v_exp_f32 v117,v117
v_smfmac_f32_16x16x64_bf16 v[68:71],v[72:75],v[160:167],v76
v_exp_f32 v118,v118
v_mfma_f32_32x32x16_bf16 v[128:143],v[84:87],a[76:79],v[128:143]
v_exp_f32 v119,v119
v_exp_f32 v120,v120
v_exp_f32 v121,v121
v_smfmac_f32_32x32x32_bf16 v[48:63],v[108:111],v[168:175],v76
v_exp_f32 v122,v122
v_exp_f32 v123,v123
v_exp_f32 v124,v124
v_smfmac_f32_16x16x64_bf16 v[68:71],v[72:75],v[168:175],v76
s_waitcnt lgkmcnt(0)
v_exp_f32 v125,v125
v_exp_f32 v126,v126
v_exp_f32 v127,v127
v_smfmac_f32_32x32x32_bf16 v[32:47],v[96:99],v[112:119],v76
ds_read_b128 v[104:107],v77 offset:30720
v_exp_f32 v128,v128
v_exp_f32 v129,v129
v_exp_f32 v130,v130
v_mfma_f32_32x32x16_bf16 v[144:159],v[88:91],a[64:67],0
ds_read_b128 v[108:111],v77 offset:31744
v_exp_f32 v131,v131
v_exp_f32 v132,v132
v_exp_f32 v133,v133
v_smfmac_f32_16x16x64_bf16 v[64:67],v[72:75],v[112:119],v76
v_exp_f32 v134,v134
v_mfma_f32_32x32x16_bf16 v[144:159],v[92:95],a[68:71],v[144:159]
v_exp_f32 v135,v135
v_exp_f32 v136,v136
v_exp_f32 v137,v137
v_smfmac_f32_32x32x32_bf16 v[32:47],v[100:103],v[120:127],v76
v_exp_f32 v138,v138
v_exp_f32 v139,v139
v_exp_f32 v140,v140
v_smfmac_f32_16x16x64_bf16 v[64:67],v[72:75],v[120:127],v76
v_exp_f32 v141,v141
v_exp_f32 v142,v142
v_exp_f32 v143,v143
v_smfmac_f32_32x32x32_bf16 v[48:63],v[96:99],v[128:135],v76
s_waitcnt vmcnt(5) lgkmcnt(0)
s_barrier
v_exp_f32 v144,v144
v_exp_f32 v145,v145
v_exp_f32 v146,v146
v_mfma_f32_32x32x16_bf16 v[160:175],v[88:91],a[72:75],0
ds_read_b128 v[80:83],v77
v_exp_f32 v147,v147
v_exp_f32 v148,v148
v_exp_f32 v149,v149
v_smfmac_f32_16x16x64_bf16 v[68:71],v[72:75],v[128:135],v76
ds_read_b128 v[84:87],v77 offset:1024
v_exp_f32 v150,v150
v_mfma_f32_32x32x16_bf16 v[160:175],v[92:95],a[76:79],v[160:175]
s_add_u32 m0,s69,155648
v_exp_f32 v151,v151
v_exp_f32 v152,v152
v_exp_f32 v153,v153
v_smfmac_f32_32x32x32_bf16 v[48:63],v[100:103],v[136:143],v76
buffer_load_dwordx4 v9,s[64:67],s68 offen sc1 lds
v_exp_f32 v154,v154
v_exp_f32 v155,v155
v_exp_f32 v156,v156
v_smfmac_f32_16x16x64_bf16 v[68:71],v[72:75],v[136:143],v76
s_waitcnt lgkmcnt(0)
v_exp_f32 v157,v157
v_exp_f32 v158,v158
v_exp_f32 v159,v159
v_smfmac_f32_32x32x32_bf16 v[32:47],v[104:107],v[144:151],v76
ds_read_b128 v[96:99],v77 offset:2048
v_exp_f32 v160,v160
v_exp_f32 v161,v161
v_exp_f32 v162,v162
v_mfma_f32_32x32x16_bf16 v[112:127],v[80:83],a[64:67],0
ds_read_b128 v[100:103],v77 offset:3072
v_exp_f32 v163,v163
v_exp_f32 v164,v164
v_exp_f32 v165,v165
v_smfmac_f32_16x16x64_bf16 v[64:67],v[72:75],v[144:151],v76
v_exp_f32 v166,v166
v_mfma_f32_32x32x16_bf16 v[112:127],v[84:87],a[68:71],v[112:127]
buffer_load_dwordx4 v9,s[64:67],s68 offen offset:1024 sc1 lds
v_exp_f32 v167,v167
v_exp_f32 v168,v168
v_exp_f32 v169,v169
v_smfmac_f32_32x32x32_bf16 v[32:47],v[108:111],v[152:159],v76
s_add_u32 s68,s68,8192
v_exp_f32 v170,v170
v_exp_f32 v171,v171
v_exp_f32 v172,v172
v_smfmac_f32_16x16x64_bf16 v[64:67],v[72:75],v[152:159],v76
s_waitcnt vmcnt(6)
s_mov_b32 s75,0x40000
L_pv_chk:
v_cmp_eq_u32 vcc,1,v240
s_sub_u32 s75,s75,1
s_cbranch_scc1 L_pv_ok
s_nop 1
s_cmp_eq_u64 vcc,-1
s_cbranch_scc1 L_pv_ok
s_sleep 4
buffer_load_dword v240,v250,s[20:23],0 offen sc1
s_waitcnt vmcnt(0)
s_branch L_pv_chk
L_pv_ok:
v_exp_f32 v173,v173
v_exp_f32 v174,v174
v_exp_f32 v175,v175
v_smfmac_f32_32x32x32_bf16 v[48:63],v[104:107],v[160:167],v76
ds_read_b128 v[88:91],v77 offset:4096
v_exp_f32 v112,v112
v_exp_f32 v113,v113
v_exp_f32 v114,v114
v_mfma_f32_32x32x16_bf16 v[128:143],v[80:83],a[72:75],0
ds_read_b128 v[92:95],v77 offset:5120
v_exp_f32 v115,v115
v_exp_f32 v116,v116
v_exp_f32 v117,v117
v_smfmac_f32_16x16x64_bf16 v[68:71],v[72:75],v[160:167],v76
v_exp_f32 v118,v118
v_mfma_f32_32x32x16_bf16 v[128:143],v[84:87],a[76:79],v[128:143]
v_exp_f32 v119,v119
v_exp_f32 v120,v120
v_exp_f32 v121,v121
v_smfmac_f32_32x32x32_bf16 v[48:63],v[108:111],v[168:175],v76
v_exp_f32 v122,v122
v_exp_f32 v123,v123
v_exp_f32 v124,v124
v_smfmac_f32_16x16x64_bf16 v[68:71],v[72:75],v[168:175],v76
s_waitcnt lgkmcnt(0)
v_exp_f32 v125,v125
v_exp_f32 v126,v126
v_exp_f32 v127,v127
v_smfmac_f32_32x32x32_bf16 v[32:47],v[96:99],v[112:119],v76
ds_read_b128 v[104:107],v77 offset:6144
v_exp_f32 v128,v128
v_exp_f32 v129,v129
v_exp_f32 v130,v130
v_mfma_f32_32x32x16_bf16 v[144:159],v[88:91],a[64:67],0
ds_read_b128 v[108:111],v77 offset:7168
v_exp_f32 v131,v131
v_exp_f32 v132,v132
v_exp_f32 v133,v133
v_smfmac_f32_16x16x64_bf16 v[64:67],v[72:75],v[112:119],v76
v_exp_f32 v134,v134
v_mfma_f32_32x32x16_bf16 v[144:159],v[92:95],a[68:71],v[144:159]
v_exp_f32 v135,v135
v_exp_f32 v136,v136
v_exp_f32 v137,v137
v_smfmac_f32_32x32x32_bf16 v[32:47],v[100:103],v[120:127],v76
v_exp_f32 v138,v138
v_exp_f32 v139,v139
v_exp_f32 v140,v140
v_smfmac_f32_16x16x64_bf16 v[64:67],v[72:75],v[120:127],v76
v_exp_f32 v141,v141
v_exp_f32 v142,v142
v_exp_f32 v143,v143
v_smfmac_f32_32x32x32_bf16 v[48:63],v[96:99],v[128:135],v76
s_waitcnt vmcnt(4) lgkmcnt(0)
s_barrier
v_exp_f32 v144,v144
v_exp_f32 v145,v145
v_exp_f32 v146,v146
v_mfma_f32_32x32x16_bf16 v[160:175],v[88:91],a[72:75],0
ds_read_b128 v[80:83],v77 offset:8192
v_exp_f32 v147,v147
v_exp_f32 v148,v148
v_exp_f32 v149,v149
v_smfmac_f32_16x16x64_bf16 v[68:71],v[72:75],v[128:135],v76
ds_read_b128 v[84:87],v77 offset:9216
v_exp_f32 v150,v150
v_mfma_f32_32x32x16_bf16 v[160:175],v[92:95],a[76:79],v[160:175]
s_add_u32 m0,s69,131072
v_exp_f32 v151,v151
v_exp_f32 v152,v152
v_exp_f32 v153,v153
v_smfmac_f32_32x32x32_bf16 v[48:63],v[100:103],v[136:143],v76
buffer_load_dwordx4 v9,s[64:67],s68 offen sc1 lds
v_exp_f32 v154,v154
v_exp_f32 v155,v155
v_exp_f32 v156,v156
v_smfmac_f32_16x16x64_bf16 v[68:71],v[72:75],v[136:143],v76
s_waitcnt lgkmcnt(0)
v_exp_f32 v157,v157
v_exp_f32 v158,v158
v_exp_f32 v159,v159
v_smfmac_f32_32x32x32_bf16 v[32:47],v[104:107],v[144:151],v76
ds_read_b128 v[96:99],v77 offset:10240
v_exp_f32 v160,v160
v_exp_f32 v161,v161
v_exp_f32 v162,v162
v_mfma_f32_32x32x16_bf16 v[112:127],v[80:83],a[64:67],0
ds_read_b128 v[100:103],v77 offset:11264
v_exp_f32 v163,v163
v_exp_f32 v164,v164
v_exp_f32 v165,v165
v_smfmac_f32_16x16x64_bf16 v[64:67],v[72:75],v[144:151],v76
v_exp_f32 v166,v166
v_mfma_f32_32x32x16_bf16 v[112:127],v[84:87],a[68:71],v[112:127]
buffer_load_dwordx4 v9,s[64:67],s68 offen offset:1024 sc1 lds
v_exp_f32 v167,v167
v_exp_f32 v168,v168
v_exp_f32 v169,v169
v_smfmac_f32_32x32x32_bf16 v[32:47],v[108:111],v[152:159],v76
s_add_u32 s68,s68,8192
v_exp_f32 v170,v170
v_exp_f32 v171,v171
v_exp_f32 v172,v172
v_smfmac_f32_16x16x64_bf16 v[64:67],v[72:75],v[152:159],v76
v_exp_f32 v173,v173
v_exp_f32 v174,v174
v_exp_f32 v175,v175
v_smfmac_f32_32x32x32_bf16 v[48:63],v[104:107],v[160:167],v76
ds_read_b128 v[88:91],v77 offset:12288
v_exp_f32 v112,v112
v_exp_f32 v113,v113
v_exp_f32 v114,v114
v_mfma_f32_32x32x16_bf16 v[128:143],v[80:83],a[72:75],0
ds_read_b128 v[92:95],v77 offset:13312
v_exp_f32 v115,v115
v_exp_f32 v116,v116
v_exp_f32 v117,v117
v_smfmac_f32_16x16x64_bf16 v[68:71],v[72:75],v[160:167],v76
v_exp_f32 v118,v118
v_mfma_f32_32x32x16_bf16 v[128:143],v[84:87],a[76:79],v[128:143]
v_exp_f32 v119,v119
v_exp_f32 v120,v120
v_exp_f32 v121,v121
v_smfmac_f32_32x32x32_bf16 v[48:63],v[108:111],v[168:175],v76
v_exp_f32 v122,v122
v_exp_f32 v123,v123
v_exp_f32 v124,v124
v_smfmac_f32_16x16x64_bf16 v[68:71],v[72:75],v[168:175],v76
s_waitcnt lgkmcnt(0)
v_exp_f32 v125,v125
v_exp_f32 v126,v126
v_exp_f32 v127,v127
v_smfmac_f32_32x32x32_bf16 v[32:47],v[96:99],v[112:119],v76
ds_read_b128 v[104:107],v77 offset:14336
v_exp_f32 v128,v128
v_exp_f32 v129,v129
v_exp_f32 v130,v130
v_mfma_f32_32x32x16_bf16 v[144:159],v[88:91],a[64:67],0
ds_read_b128 v[108:111],v77 offset:15360
v_exp_f32 v131,v131
v_exp_f32 v132,v132
v_exp_f32 v133,v133
v_smfmac_f32_16x16x64_bf16 v[64:67],v[72:75],v[112:119],v76
v_exp_f32 v134,v134
v_mfma_f32_32x32x16_bf16 v[144:159],v[92:95],a[68:71],v[144:159]
v_exp_f32 v135,v135
v_exp_f32 v136,v136
v_exp_f32 v137,v137
v_smfmac_f32_32x32x32_bf16 v[32:47],v[100:103],v[120:127],v76
v_exp_f32 v138,v138
v_exp_f32 v139,v139
v_exp_f32 v140,v140
v_smfmac_f32_16x16x64_bf16 v[64:67],v[72:75],v[120:127],v76
v_exp_f32 v141,v141
v_exp_f32 v142,v142
v_exp_f32 v143,v143
v_smfmac_f32_32x32x32_bf16 v[48:63],v[96:99],v[128:135],v76
s_waitcnt vmcnt(4) lgkmcnt(0)
s_barrier
v_exp_f32 v144,v144
v_exp_f32 v145,v145
v_exp_f32 v146,v146
v_mfma_f32_32x32x16_bf16 v[160:175],v[88:91],a[72:75],0
ds_read_b128 v[80:83],v77 offset:16384
v_exp_f32 v147,v147
v_exp_f32 v148,v148
v_exp_f32 v149,v149
v_smfmac_f32_16x16x64_bf16 v[68:71],v[72:75],v[128:135],v76
ds_read_b128 v[84:87],v77 offset:17408
v_exp_f32 v150,v150
v_mfma_f32_32x32x16_bf16 v[160:175],v[92:95],a[76:79],v[160:175]
s_add_u32 m0,s69,139264
v_exp_f32 v151,v151
v_exp_f32 v152,v152
v_exp_f32 v153,v153
v_smfmac_f32_32x32x32_bf16 v[48:63],v[100:103],v[136:143],v76
buffer_load_dwordx4 v9,s[64:67],s68 offen sc1 lds
v_exp_f32 v154,v154
v_exp_f32 v155,v155
v_exp_f32 v156,v156
v_smfmac_f32_16x16x64_bf16 v[68:71],v[72:75],v[136:143],v76
s_waitcnt lgkmcnt(0)
v_exp_f32 v157,v157
v_exp_f32 v158,v158
v_exp_f32 v159,v159
v_smfmac_f32_32x32x32_bf16 v[32:47],v[104:107],v[144:151],v76
ds_read_b128 v[96:99],v77 offset:18432
v_exp_f32 v160,v160
v_exp_f32 v161,v161
v_exp_f32 v162,v162
v_mfma_f32_32x32x16_bf16 v[112:127],v[80:83],a[64:67],0
ds_read_b128 v[100:103],v77 offset:19456
v_exp_f32 v163,v163
v_exp_f32 v164,v164
v_exp_f32 v165,v165
v_smfmac_f32_16x16x64_bf16 v[64:67],v[72:75],v[144:151],v76
v_exp_f32 v166,v166
v_mfma_f32_32x32x16_bf16 v[112:127],v[84:87],a[68:71],v[112:127]
buffer_load_dwordx4 v9,s[64:67],s68 offen offset:1024 sc1 lds
v_exp_f32 v167,v167
v_exp_f32 v168,v168
v_exp_f32 v169,v169
v_smfmac_f32_32x32x32_bf16 v[32:47],v[108:111],v[152:159],v76
s_add_u32 s68,s68,8192
v_exp_f32 v170,v170
v_exp_f32 v171,v171
v_exp_f32 v172,v172
v_smfmac_f32_16x16x64_bf16 v[64:67],v[72:75],v[152:159],v76
v_exp_f32 v173,v173
v_exp_f32 v174,v174
v_exp_f32 v175,v175
L_at14:
v_smfmac_f32_32x32x32_bf16 v[48:63],v[104:107],v[160:167],v76
ds_read_b128 v[88:91],v77 offset:20480
v_exp_f32 v112,v112
v_exp_f32 v113,v113
v_exp_f32 v114,v114
v_mfma_f32_32x32x16_bf16 v[128:143],v[80:83],a[72:75],0
ds_read_b128 v[92:95],v77 offset:21504
v_exp_f32 v115,v115
v_exp_f32 v116,v116
v_exp_f32 v117,v117
v_smfmac_f32_16x16x64_bf16 v[68:71],v[72:75],v[160:167],v76
v_exp_f32 v118,v118
v_mfma_f32_32x32x16_bf16 v[128:143],v[84:87],a[76:79],v[128:143]
v_exp_f32 v119,v119
v_exp_f32 v120,v120
v_exp_f32 v121,v121
v_smfmac_f32_32x32x32_bf16 v[48:63],v[108:111],v[168:175],v76
v_exp_f32 v122,v122
v_exp_f32 v123,v123
v_exp_f32 v124,v124
v_smfmac_f32_16x16x64_bf16 v[68:71],v[72:75],v[168:175],v76
s_waitcnt lgkmcnt(0)
v_exp_f32 v125,v125
v_exp_f32 v126,v126
v_exp_f32 v127,v127
v_smfmac_f32_32x32x32_bf16 v[32:47],v[96:99],v[112:119],v76
ds_read_b128 v[104:107],v77 offset:22528
v_exp_f32 v128,v128
v_exp_f32 v129,v129
v_exp_f32 v130,v130
v_mfma_f32_32x32x16_bf16 v[144:159],v[88:91],a[64:67],0
ds_read_b128 v[108:111],v77 offset:23552
v_exp_f32 v131,v131
v_exp_f32 v132,v132
v_exp_f32 v133,v133
v_smfmac_f32_16x16x64_bf16 v[64:67],v[72:75],v[112:119],v76
v_exp_f32 v134,v134
v_mfma_f32_32x32x16_bf16 v[144:159],v[92:95],a[68:71],v[144:159]
v_exp_f32 v135,v135
v_exp_f32 v136,v136
v_exp_f32 v137,v137
v_smfmac_f32_32x32x32_bf16 v[32:47],v[100:103],v[120:127],v76
v_exp_f32 v138,v138
v_exp_f32 v139,v139
v_exp_f32 v140,v140
v_smfmac_f32_16x16x64_bf16 v[64:67],v[72:75],v[120:127],v76
v_exp_f32 v141,v141
v_exp_f32 v142,v142
v_exp_f32 v143,v143
v_smfmac_f32_32x32x32_bf16 v[48:63],v[96:99],v[128:135],v76
s_waitcnt vmcnt(4) lgkmcnt(0)
s_barrier
v_exp_f32 v144,v144
v_exp_f32 v145,v145
v_exp_f32 v146,v146
v_mfma_f32_32x32x16_bf16 v[160:175],v[88:91],a[72:75],0
ds_read_b128 v[80:83],v77 offset:24576
v_exp_f32 v147,v147
v_exp_f32 v148,v148
v_exp_f32 v149,v149
v_smfmac_f32_16x16x64_bf16 v[68:71],v[72:75],v[128:135],v76
ds_read_b128 v[84:87],v77 offset:25600
v_exp_f32 v150,v150
v_mfma_f32_32x32x16_bf16 v[160:175],v[92:95],a[76:79],v[160:175]
s_add_u32 m0,s69,147456
v_exp_f32 v151,v151
v_exp_f32 v152,v152
v_exp_f32 v153,v153
v_smfmac_f32_32x32x32_bf16 v[48:63],v[100:103],v[136:143],v76
buffer_load_dwordx4 v9,s[64:67],s68 offen sc1 lds
v_exp_f32 v154,v154
v_exp_f32 v155,v155
v_exp_f32 v156,v156
v_smfmac_f32_16x16x64_bf16 v[68:71],v[72:75],v[136:143],v76
s_waitcnt lgkmcnt(0)
v_exp_f32 v157,v157
v_exp_f32 v158,v158
v_exp_f32 v159,v159
v_smfmac_f32_32x32x32_bf16 v[32:47],v[104:107],v[144:151],v76
ds_read_b128 v[96:99],v77 offset:26624
v_exp_f32 v160,v160
v_exp_f32 v161,v161
v_exp_f32 v162,v162
v_mfma_f32_32x32x16_bf16 v[112:127],v[80:83],a[64:67],0
ds_read_b128 v[100:103],v77 offset:27648
v_exp_f32 v163,v163
v_exp_f32 v164,v164
v_exp_f32 v165,v165
v_smfmac_f32_16x16x64_bf16 v[64:67],v[72:75],v[144:151],v76
v_exp_f32 v166,v166
v_mfma_f32_32x32x16_bf16 v[112:127],v[84:87],a[68:71],v[112:127]
buffer_load_dwordx4 v9,s[64:67],s68 offen offset:1024 sc1 lds
v_exp_f32 v167,v167
v_exp_f32 v168,v168
v_exp_f32 v169,v169
v_smfmac_f32_32x32x32_bf16 v[32:47],v[108:111],v[152:159],v76
s_add_u32 s68,s68,8192
v_exp_f32 v170,v170
v_exp_f32 v171,v171
v_exp_f32 v172,v172
v_smfmac_f32_16x16x64_bf16 v[64:67],v[72:75],v[152:159],v76
v_exp_f32 v173,v173
v_exp_f32 v174,v174
v_exp_f32 v175,v175
v_smfmac_f32_32x32x32_bf16 v[48:63],v[104:107],v[160:167],v76
ds_read_b128 v[88:91],v77 offset:28672
v_exp_f32 v112,v112
v_exp_f32 v113,v113
v_exp_f32 v114,v114
v_mfma_f32_32x32x16_bf16 v[128:143],v[80:83],a[72:75],0
ds_read_b128 v[92:95],v77 offset:29696
v_exp_f32 v115,v115
v_exp_f32 v116,v116
v_exp_f32 v117,v117
v_smfmac_f32_16x16x64_bf16 v[68:71],v[72:75],v[160:167],v76
v_exp_f32 v118,v118
v_mfma_f32_32x32x16_bf16 v[128:143],v[84:87],a[76:79],v[128:143]
s_add_u32 m0,s29,0
s_nop 0
buffer_load_dwordx4 v9,s[8:11],s24 offen sc1 lds
v_exp_f32 v119,v119
v_exp_f32 v120,v120
v_exp_f32 v121,v121
v_smfmac_f32_32x32x32_bf16 v[48:63],v[108:111],v[168:175],v76
buffer_load_dwordx4 v9,s[8:11],s24 offen offset:1024 sc1 lds
buffer_load_dwordx4 v9,s[8:11],s24 offen offset:2048 sc1 lds
v_exp_f32 v122,v122
v_exp_f32 v123,v123
v_exp_f32 v124,v124
v_smfmac_f32_16x16x64_bf16 v[68:71],v[72:75],v[168:175],v76
buffer_load_dwordx4 v9,s[8:11],s24 offen offset:3072 sc1 lds
s_add_u32 s24,s24,s32
s_waitcnt lgkmcnt(0)
v_exp_f32 v125,v125
v_exp_f32 v126,v126
v_exp_f32 v127,v127
v_smfmac_f32_32x32x32_bf16 v[32:47],v[96:99],v[112:119],v76
ds_read_b128 v[104:107],v77 offset:30720
v_exp_f32 v128,v128
v_exp_f32 v129,v129
v_exp_f32 v130,v130
v_mfma_f32_32x32x16_bf16 v[144:159],v[88:91],a[64:67],0
ds_read_b128 v[108:111],v77 offset:31744
v_exp_f32 v131,v131
v_exp_f32 v132,v132
v_exp_f32 v133,v133
v_smfmac_f32_16x16x64_bf16 v[64:67],v[72:75],v[112:119],v76
v_exp_f32 v134,v134
v_mfma_f32_32x32x16_bf16 v[144:159],v[92:95],a[68:71],v[144:159]
s_add_u32 m0,s29,16384
s_nop 0
buffer_load_dwordx4 v244,s[12:15],s26 offen lds
v_exp_f32 v135,v135
v_exp_f32 v136,v136
v_exp_f32 v137,v137
v_smfmac_f32_32x32x32_bf16 v[32:47],v[100:103],v[120:127],v76
buffer_load_dwordx4 v245,s[12:15],s26 offen offset:1024 lds
buffer_load_dwordx4 v246,s[12:15],s26 offen offset:2048 lds
v_exp_f32 v138,v138
v_exp_f32 v139,v139
v_exp_f32 v140,v140
v_smfmac_f32_16x16x64_bf16 v[64:67],v[72:75],v[120:127],v76
buffer_load_dwordx4 v247,s[12:15],s26 offen offset:3072 lds
s_add_u32 s26,s26,s74
v_exp_f32 v141,v141
v_exp_f32 v142,v142
v_exp_f32 v143,v143
v_smfmac_f32_32x32x32_bf16 v[48:63],v[96:99],v[128:135],v76
s_waitcnt vmcnt(12) lgkmcnt(0)
s_barrier
v_exp_f32 v144,v144
v_exp_f32 v145,v145
v_exp_f32 v146,v146
v_mfma_f32_32x32x16_bf16 v[160:175],v[88:91],a[72:75],0
ds_read_b128 v[80:83],v77
v_exp_f32 v147,v147
v_exp_f32 v148,v148
v_exp_f32 v149,v149
v_smfmac_f32_16x16x64_bf16 v[68:71],v[72:75],v[128:135],v76
ds_read_b128 v[84:87],v77 offset:1024
v_exp_f32 v150,v150
v_mfma_f32_32x32x16_bf16 v[160:175],v[92:95],a[76:79],v[160:175]
s_add_u32 m0,s69,155648
v_exp_f32 v151,v151
v_exp_f32 v152,v152
v_exp_f32 v153,v153
v_smfmac_f32_32x32x32_bf16 v[48:63],v[100:103],v[136:143],v76
buffer_load_dwordx4 v9,s[64:67],s68 offen sc1 lds
v_exp_f32 v154,v154
v_exp_f32 v155,v155
v_exp_f32 v156,v156
v_smfmac_f32_16x16x64_bf16 v[68:71],v[72:75],v[136:143],v76
s_waitcnt lgkmcnt(0)
v_exp_f32 v157,v157
v_exp_f32 v158,v158
v_exp_f32 v159,v159
v_smfmac_f32_32x32x32_bf16 v[32:47],v[104:107],v[144:151],v76
ds_read_b128 v[96:99],v77 offset:2048
v_exp_f32 v160,v160
v_exp_f32 v161,v161
v_exp_f32 v162,v162
v_mfma_f32_32x32x16_bf16 v[112:127],v[80:83],a[64:67],0
ds_read_b128 v[100:103],v77 offset:3072
v_exp_f32 v163,v163
v_exp_f32 v164,v164
v_exp_f32 v165,v165
v_smfmac_f32_16x16x64_bf16 v[64:67],v[72:75],v[144:151],v76
v_exp_f32 v166,v166
v_mfma_f32_32x32x16_bf16 v[112:127],v[84:87],a[68:71],v[112:127]
buffer_load_dwordx4 v9,s[64:67],s68 offen offset:1024 sc1 lds
v_exp_f32 v167,v167
v_exp_f32 v168,v168
v_exp_f32 v169,v169
v_smfmac_f32_32x32x32_bf16 v[32:47],v[108:111],v[152:159],v76
s_add_u32 s68,s68,8192
v_exp_f32 v170,v170
v_exp_f32 v171,v171
v_exp_f32 v172,v172
v_smfmac_f32_16x16x64_bf16 v[64:67],v[72:75],v[152:159],v76
v_exp_f32 v173,v173
v_exp_f32 v174,v174
v_exp_f32 v175,v175
v_smfmac_f32_32x32x32_bf16 v[48:63],v[104:107],v[160:167],v76
ds_read_b128 v[88:91],v77 offset:4096
v_exp_f32 v112,v112
v_exp_f32 v113,v113
v_exp_f32 v114,v114
v_mfma_f32_32x32x16_bf16 v[128:143],v[80:83],a[72:75],0
ds_read_b128 v[92:95],v77 offset:5120
v_exp_f32 v115,v115
v_exp_f32 v116,v116
v_exp_f32 v117,v117
v_smfmac_f32_16x16x64_bf16 v[68:71],v[72:75],v[160:167],v76
v_exp_f32 v118,v118
v_mfma_f32_32x32x16_bf16 v[128:143],v[84:87],a[76:79],v[128:143]
s_add_u32 m0,s29,32768
s_nop 0
buffer_load_dwordx4 v9,s[8:11],s24 offen sc1 lds
v_exp_f32 v119,v119
v_exp_f32 v120,v120
v_exp_f32 v121,v121
v_smfmac_f32_32x32x32_bf16 v[48:63],v[108:111],v[168:175],v76
buffer_load_dwordx4 v9,s[8:11],s24 offen offset:1024 sc1 lds
buffer_load_dwordx4 v9,s[8:11],s24 offen offset:2048 sc1 lds
v_exp_f32 v122,v122
v_exp_f32 v123,v123
v_exp_f32 v124,v124
v_smfmac_f32_16x16x64_bf16 v[68:71],v[72:75],v[168:175],v76
buffer_load_dwordx4 v9,s[8:11],s24 offen offset:3072 sc1 lds
s_add_u32 s24,s24,s32
s_waitcnt lgkmcnt(0)
v_exp_f32 v125,v125
v_exp_f32 v126,v126
v_exp_f32 v127,v127
v_smfmac_f32_32x32x32_bf16 v[32:47],v[96:99],v[112:119],v76
ds_read_b128 v[104:107],v77 offset:6144
v_exp_f32 v128,v128
v_exp_f32 v129,v129
v_exp_f32 v130,v130
v_mfma_f32_32x32x16_bf16 v[144:159],v[88:91],a[64:67],0
ds_read_b128 v[108:111],v77 offset:7168
v_exp_f32 v131,v131
v_exp_f32 v132,v132
v_exp_f32 v133,v133
v_smfmac_f32_16x16x64_bf16 v[64:67],v[72:75],v[112:119],v76
v_exp_f32 v134,v134
v_mfma_f32_32x32x16_bf16 v[144:159],v[92:95],a[68:71],v[144:159]
s_add_u32 m0,s29,49152
s_nop 0
buffer_load_dwordx4 v244,s[12:15],s26 offen lds
v_exp_f32 v135,v135
v_exp_f32 v136,v136
v_exp_f32 v137,v137
v_smfmac_f32_32x32x32_bf16 v[32:47],v[100:103],v[120:127],v76
buffer_load_dwordx4 v245,s[12:15],s26 offen offset:1024 lds
buffer_load_dwordx4 v246,s[12:15],s26 offen offset:2048 lds
v_exp_f32 v138,v138
v_exp_f32 v139,v139
v_exp_f32 v140,v140
v_smfmac_f32_16x16x64_bf16 v[64:67],v[72:75],v[120:127],v76
buffer_load_dwordx4 v247,s[12:15],s26 offen offset:3072 lds
s_add_u32 s26,s26,s74
v_exp_f32 v141,v141
v_exp_f32 v142,v142
v_exp_f32 v143,v143
v_smfmac_f32_32x32x32_bf16 v[48:63],v[96:99],v[128:135],v76
s_waitcnt vmcnt(20) lgkmcnt(0)
s_barrier
v_exp_f32 v144,v144
v_exp_f32 v145,v145
v_exp_f32 v146,v146
v_mfma_f32_32x32x16_bf16 v[160:175],v[88:91],a[72:75],0
ds_read_b128 v[80:83],v77 offset:8192
v_exp_f32 v147,v147
v_exp_f32 v148,v148
v_exp_f32 v149,v149
v_smfmac_f32_16x16x64_bf16 v[68:71],v[72:75],v[128:135],v76
ds_read_b128 v[84:87],v77 offset:9216
v_exp_f32 v150,v150
v_mfma_f32_32x32x16_bf16 v[160:175],v[92:95],a[76:79],v[160:175]
s_add_u32 m0,s69,131072
v_exp_f32 v151,v151
v_exp_f32 v152,v152
v_exp_f32 v153,v153
v_smfmac_f32_32x32x32_bf16 v[48:63],v[100:103],v[136:143],v76
buffer_load_dwordx4 v9,s[64:67],s68 offen sc1 lds
v_exp_f32 v154,v154
v_exp_f32 v155,v155
v_exp_f32 v156,v156
v_smfmac_f32_16x16x64_bf16 v[68:71],v[72:75],v[136:143],v76
s_waitcnt lgkmcnt(0)
v_exp_f32 v157,v157
v_exp_f32 v158,v158
v_exp_f32 v159,v159
v_smfmac_f32_32x32x32_bf16 v[32:47],v[104:107],v[144:151],v76
ds_read_b128 v[96:99],v77 offset:10240
v_exp_f32 v160,v160
v_exp_f32 v161,v161
v_exp_f32 v162,v162
v_mfma_f32_32x32x16_bf16 v[112:127],v[80:83],a[64:67],0
ds_read_b128 v[100:103],v77 offset:11264
v_exp_f32 v163,v163
v_exp_f32 v164,v164
v_exp_f32 v165,v165
v_smfmac_f32_16x16x64_bf16 v[64:67],v[72:75],v[144:151],v76
v_exp_f32 v166,v166
v_mfma_f32_32x32x16_bf16 v[112:127],v[84:87],a[68:71],v[112:127]
buffer_load_dwordx4 v9,s[64:67],s68 offen offset:1024 sc1 lds
v_exp_f32 v167,v167
v_exp_f32 v168,v168
v_exp_f32 v169,v169
v_smfmac_f32_32x32x32_bf16 v[32:47],v[108:111],v[152:159],v76
s_add_u32 s68,s68,8192
v_exp_f32 v170,v170
v_exp_f32 v171,v171
v_exp_f32 v172,v172
v_smfmac_f32_16x16x64_bf16 v[64:67],v[72:75],v[152:159],v76
v_exp_f32 v173,v173
v_exp_f32 v174,v174
v_exp_f32 v175,v175
v_smfmac_f32_32x32x32_bf16 v[48:63],v[104:107],v[160:167],v76
ds_read_b128 v[88:91],v77 offset:12288
v_exp_f32 v112,v112
v_exp_f32 v113,v113
v_exp_f32 v114,v114
v_mfma_f32_32x32x16_bf16 v[128:143],v[80:83],a[72:75],0
ds_read_b128 v[92:95],v77 offset:13312
v_exp_f32 v115,v115
v_exp_f32 v116,v116
v_exp_f32 v117,v117
v_smfmac_f32_16x16x64_bf16 v[68:71],v[72:75],v[160:167],v76
v_exp_f32 v118,v118
v_mfma_f32_32x32x16_bf16 v[128:143],v[84:87],a[76:79],v[128:143]
s_add_u32 m0,s4,0
s_nop 0
buffer_load_dwordx4 v9,s[8:11],s24 offen sc1 lds
v_exp_f32 v119,v119
v_exp_f32 v120,v120
v_exp_f32 v121,v121
v_smfmac_f32_32x32x32_bf16 v[48:63],v[108:111],v[168:175],v76
buffer_load_dwordx4 v9,s[8:11],s24 offen offset:1024 sc1 lds
buffer_load_dwordx4 v9,s[8:11],s24 offen offset:2048 sc1 lds
v_exp_f32 v122,v122
v_exp_f32 v123,v123
v_exp_f32 v124,v124
v_smfmac_f32_16x16x64_bf16 v[68:71],v[72:75],v[168:175],v76
buffer_load_dwordx4 v9,s[8:11],s24 offen offset:3072 sc1 lds
s_add_u32 s24,s24,s32
s_waitcnt lgkmcnt(0)
v_exp_f32 v125,v125
v_exp_f32 v126,v126
v_exp_f32 v127,v127
v_smfmac_f32_32x32x32_bf16 v[32:47],v[96:99],v[112:119],v76
ds_read_b128 v[104:107],v77 offset:14336
v_exp_f32 v128,v128
v_exp_f32 v129,v129
v_exp_f32 v130,v130
v_mfma_f32_32x32x16_bf16 v[144:159],v[88:91],a[64:67],0
ds_read_b128 v[108:111],v77 offset:15360
v_exp_f32 v131,v131
v_exp_f32 v132,v132
v_exp_f32 v133,v133
v_smfmac_f32_16x16x64_bf16 v[64:67],v[72:75],v[112:119],v76
v_exp_f32 v134,v134
v_mfma_f32_32x32x16_bf16 v[144:159],v[92:95],a[68:71],v[144:159]
s_add_u32 m0,s4,16384
s_nop 0
buffer_load_dwordx4 v244,s[12:15],s26 offen lds
v_exp_f32 v135,v135
v_exp_f32 v136,v136
v_exp_f32 v137,v137
v_smfmac_f32_32x32x32_bf16 v[32:47],v[100:103],v[120:127],v76
buffer_load_dwordx4 v245,s[12:15],s26 offen offset:1024 lds
buffer_load_dwordx4 v246,s[12:15],s26 offen offset:2048 lds
v_exp_f32 v138,v138
v_exp_f32 v139,v139
v_exp_f32 v140,v140
v_smfmac_f32_16x16x64_bf16 v[64:67],v[72:75],v[120:127],v76
buffer_load_dwordx4 v247,s[12:15],s26 offen offset:3072 lds
s_add_u32 s26,s26,s74
v_exp_f32 v141,v141
v_exp_f32 v142,v142
v_exp_f32 v143,v143
v_smfmac_f32_32x32x32_bf16 v[48:63],v[96:99],v[128:135],v76
s_waitcnt vmcnt(28) lgkmcnt(0)
s_barrier
v_exp_f32 v144,v144
v_exp_f32 v145,v145
v_exp_f32 v146,v146
v_mfma_f32_32x32x16_bf16 v[160:175],v[88:91],a[72:75],0
ds_read_b128 v[80:83],v77 offset:16384
v_exp_f32 v147,v147
v_exp_f32 v148,v148
v_exp_f32 v149,v149
v_smfmac_f32_16x16x64_bf16 v[68:71],v[72:75],v[128:135],v76
ds_read_b128 v[84:87],v77 offset:17408
v_exp_f32 v150,v150
v_mfma_f32_32x32x16_bf16 v[160:175],v[92:95],a[76:79],v[160:175]
s_add_u32 m0,s69,139264
v_exp_f32 v151,v151
v_exp_f32 v152,v152
v_exp_f32 v153,v153
v_smfmac_f32_32x32x32_bf16 v[48:63],v[100:103],v[136:143],v76
buffer_load_dwordx4 v9,s[64:67],s68 offen sc1 lds
v_exp_f32 v154,v154
v_exp_f32 v155,v155
v_exp_f32 v156,v156
v_smfmac_f32_16x16x64_bf16 v[68:71],v[72:75],v[136:143],v76
s_waitcnt lgkmcnt(0)
v_exp_f32 v157,v157
v_exp_f32 v158,v158
v_exp_f32 v159,v159
v_smfmac_f32_32x32x32_bf16 v[32:47],v[104:107],v[144:151],v76
ds_read_b128 v[96:99],v77 offset:18432
v_exp_f32 v160,v160
v_exp_f32 v161,v161
v_exp_f32 v162,v162
v_mfma_f32_32x32x16_bf16 v[112:127],v[80:83],a[64:67],0
ds_read_b128 v[100:103],v77 offset:19456
v_exp_f32 v163,v163
v_exp_f32 v164,v164
v_exp_f32 v165,v165
v_smfmac_f32_16x16x64_bf16 v[64:67],v[72:75],v[144:151],v76
v_exp_f32 v166,v166
v_mfma_f32_32x32x16_bf16 v[112:127],v[84:87],a[68:71],v[112:127]
buffer_load_dwordx4 v9,s[64:67],s68 offen offset:1024 sc1 lds
v_exp_f32 v167,v167
v_exp_f32 v168,v168
v_exp_f32 v169,v169
v_smfmac_f32_32x32x32_bf16 v[32:47],v[108:111],v[152:159],v76
s_add_u32 s68,s68,8192
v_exp_f32 v170,v170
v_exp_f32 v171,v171
v_exp_f32 v172,v172
v_smfmac_f32_16x16x64_bf16 v[64:67],v[72:75],v[152:159],v76
v_exp_f32 v173,v173
v_exp_f32 v174,v174
v_exp_f32 v175,v175
v_smfmac_f32_32x32x32_bf16 v[48:63],v[104:107],v[160:167],v76
ds_read_b128 v[88:91],v77 offset:20480
v_exp_f32 v112,v112
v_exp_f32 v113,v113
v_exp_f32 v114,v114
v_mfma_f32_32x32x16_bf16 v[128:143],v[80:83],a[72:75],0
ds_read_b128 v[92:95],v77 offset:21504
v_exp_f32 v115,v115
v_exp_f32 v116,v116
v_exp_f32 v117,v117
v_smfmac_f32_16x16x64_bf16 v[68:71],v[72:75],v[160:167],v76
v_exp_f32 v118,v118
v_mfma_f32_32x32x16_bf16 v[128:143],v[84:87],a[76:79],v[128:143]
s_add_u32 m0,s4,32768
s_nop 0
buffer_load_dwordx4 v9,s[8:11],s24 offen sc1 lds
v_exp_f32 v119,v119
v_exp_f32 v120,v120
v_exp_f32 v121,v121
v_smfmac_f32_32x32x32_bf16 v[48:63],v[108:111],v[168:175],v76
buffer_load_dwordx4 v9,s[8:11],s24 offen offset:1024 sc1 lds
buffer_load_dwordx4 v9,s[8:11],s24 offen offset:2048 sc1 lds
v_exp_f32 v122,v122
v_exp_f32 v123,v123
v_exp_f32 v124,v124
v_smfmac_f32_16x16x64_bf16 v[68:71],v[72:75],v[168:175],v76
buffer_load_dwordx4 v9,s[8:11],s24 offen offset:3072 sc1 lds
s_add_u32 s24,s24,s32
s_waitcnt lgkmcnt(0)
v_exp_f32 v125,v125
v_exp_f32 v126,v126
v_exp_f32 v127,v127
v_smfmac_f32_32x32x32_bf16 v[32:47],v[96:99],v[112:119],v76
ds_read_b128 v[104:107],v77 offset:22528
v_exp_f32 v128,v128
v_exp_f32 v129,v129
v_exp_f32 v130,v130
v_mfma_f32_32x32x16_bf16 v[144:159],v[88:91],a[64:67],0
ds_read_b128 v[108:111],v77 offset:23552
v_exp_f32 v131,v131
v_exp_f32 v132,v132
v_exp_f32 v133,v133
v_smfmac_f32_16x16x64_bf16 v[64:67],v[72:75],v[112:119],v76
v_exp_f32 v134,v134
v_mfma_f32_32x32x16_bf16 v[144:159],v[92:95],a[68:71],v[144:159]
s_add_u32 m0,s4,49152
s_nop 0
buffer_load_dwordx4 v244,s[12:15],s26 offen lds
v_exp_f32 v135,v135
v_exp_f32 v136,v136
v_exp_f32 v137,v137
v_smfmac_f32_32x32x32_bf16 v[32:47],v[100:103],v[120:127],v76
buffer_load_dwordx4 v245,s[12:15],s26 offen offset:1024 lds
buffer_load_dwordx4 v246,s[12:15],s26 offen offset:2048 lds
v_exp_f32 v138,v138
v_exp_f32 v139,v139
v_exp_f32 v140,v140
v_smfmac_f32_16x16x64_bf16 v[64:67],v[72:75],v[120:127],v76
buffer_load_dwordx4 v247,s[12:15],s26 offen offset:3072 lds
s_add_u32 s26,s26,s74
v_exp_f32 v141,v141
v_exp_f32 v142,v142
v_exp_f32 v143,v143
v_smfmac_f32_32x32x32_bf16 v[48:63],v[96:99],v[128:135],v76
s_waitcnt vmcnt(28) lgkmcnt(0)
s_barrier
v_exp_f32 v144,v144
v_exp_f32 v145,v145
v_exp_f32 v146,v146
v_mfma_f32_32x32x16_bf16 v[160:175],v[88:91],a[72:75],0
ds_read_b128 v[80:83],v77 offset:24576
v_exp_f32 v147,v147
v_exp_f32 v148,v148
v_exp_f32 v149,v149
v_smfmac_f32_16x16x64_bf16 v[68:71],v[72:75],v[128:135],v76
ds_read_b128 v[84:87],v77 offset:25600
v_exp_f32 v150,v150
v_mfma_f32_32x32x16_bf16 v[160:175],v[92:95],a[76:79],v[160:175]
s_add_u32 m0,s69,147456
v_exp_f32 v151,v151
v_exp_f32 v152,v152
v_exp_f32 v153,v153
v_smfmac_f32_32x32x32_bf16 v[48:63],v[100:103],v[136:143],v76
buffer_load_dwordx4 v9,s[64:67],s68 offen sc1 lds
v_exp_f32 v154,v154
v_exp_f32 v155,v155
v_exp_f32 v156,v156
v_smfmac_f32_16x16x64_bf16 v[68:71],v[72:75],v[136:143],v76
s_waitcnt lgkmcnt(0)
v_exp_f32 v157,v157
v_exp_f32 v158,v158
v_exp_f32 v159,v159
v_smfmac_f32_32x32x32_bf16 v[32:47],v[104:107],v[144:151],v76
ds_read_b128 v[96:99],v77 offset:26624
v_exp_f32 v160,v160
v_exp_f32 v161,v161
v_exp_f32 v162,v162
v_mfma_f32_32x32x16_bf16 v[112:127],v[80:83],a[64:67],0
ds_read_b128 v[100:103],v77 offset:27648
v_exp_f32 v163,v163
v_exp_f32 v164,v164
v_exp_f32 v165,v165
v_smfmac_f32_16x16x64_bf16 v[64:67],v[72:75],v[144:151],v76
v_exp_f32 v166,v166
v_mfma_f32_32x32x16_bf16 v[112:127],v[84:87],a[68:71],v[112:127]
buffer_load_dwordx4 v9,s[64:67],s68 offen offset:1024 sc1 lds
v_exp_f32 v167,v167
v_exp_f32 v168,v168
v_exp_f32 v169,v169
v_smfmac_f32_32x32x32_bf16 v[32:47],v[108:111],v[152:159],v76
s_add_u32 s68,s68,8192
v_exp_f32 v170,v170
v_exp_f32 v171,v171
v_exp_f32 v172,v172
v_smfmac_f32_16x16x64_bf16 v[64:67],v[72:75],v[152:159],v76
v_exp_f32 v173,v173
v_exp_f32 v174,v174
v_exp_f32 v175,v175
v_smfmac_f32_32x32x32_bf16 v[48:63],v[104:107],v[160:167],v76
ds_read_b128 v[88:91],v77 offset:28672
v_exp_f32 v112,v112
v_exp_f32 v113,v113
v_exp_f32 v114,v114
v_mfma_f32_32x32x16_bf16 v[128:143],v[80:83],a[72:75],0
ds_read_b128 v[92:95],v77 offset:29696
v_exp_f32 v115,v115
v_exp_f32 v116,v116
v_exp_f32 v117,v117
v_smfmac_f32_16x16x64_bf16 v[68:71],v[72:75],v[160:167],v76
v_exp_f32 v118,v118
v_mfma_f32_32x32x16_bf16 v[128:143],v[84:87],a[76:79],v[128:143]
v_exp_f32 v119,v119
v_exp_f32 v120,v120
v_exp_f32 v121,v121
v_smfmac_f32_32x32x32_bf16 v[48:63],v[108:111],v[168:175],v76
v_exp_f32 v122,v122
v_exp_f32 v123,v123
v_exp_f32 v124,v124
v_smfmac_f32_16x16x64_bf16 v[68:71],v[72:75],v[168:175],v76
s_waitcnt lgkmcnt(0)
v_exp_f32 v125,v125
v_exp_f32 v126,v126
v_exp_f32 v127,v127
v_smfmac_f32_32x32x32_bf16 v[32:47],v[96:99],v[112:119],v76
ds_read_b128 v[104:107],v77 offset:30720
v_exp_f32 v128,v128
v_exp_f32 v129,v129
v_exp_f32 v130,v130
v_mfma_f32_32x32x16_bf16 v[144:159],v[88:91],a[64:67],0
ds_read_b128 v[108:111],v77 offset:31744
v_exp_f32 v131,v131
v_exp_f32 v132,v132
v_exp_f32 v133,v133
v_smfmac_f32_16x16x64_bf16 v[64:67],v[72:75],v[112:119],v76
v_exp_f32 v134,v134
v_mfma_f32_32x32x16_bf16 v[144:159],v[92:95],a[68:71],v[144:159]
v_exp_f32 v135,v135
v_exp_f32 v136,v136
v_exp_f32 v137,v137
v_smfmac_f32_32x32x32_bf16 v[32:47],v[100:103],v[120:127],v76
v_exp_f32 v138,v138
v_exp_f32 v139,v139
v_exp_f32 v140,v140
v_smfmac_f32_16x16x64_bf16 v[64:67],v[72:75],v[120:127],v76
v_exp_f32 v141,v141
v_exp_f32 v142,v142
v_exp_f32 v143,v143
v_smfmac_f32_32x32x32_bf16 v[48:63],v[96:99],v[128:135],v76
s_waitcnt vmcnt(20) lgkmcnt(0)
s_barrier
v_exp_f32 v144,v144
v_exp_f32 v145,v145
v_exp_f32 v146,v146
v_mfma_f32_32x32x16_bf16 v[160:175],v[88:91],a[72:75],0
ds_read_b128 v[80:83],v77
v_exp_f32 v147,v147
v_exp_f32 v148,v148
v_exp_f32 v149,v149
v_smfmac_f32_16x16x64_bf16 v[68:71],v[72:75],v[128:135],v76
ds_read_b128 v[84:87],v77 offset:1024
v_exp_f32 v150,v150
v_mfma_f32_32x32x16_bf16 v[160:175],v[92:95],a[76:79],v[160:175]
ds_read_b64_tr_b16 v[176:177],v18 offset:16384
ds_read_b64_tr_b16 v[178:179],v18 offset:20480
ds_read_b128 v[208:211],v16
ds_read_b64_tr_b16 v[180:181],v20 offset:16384
ds_read_b64_tr_b16 v[182:183],v20 offset:20480
ds_read_b128 v[212:215],v16 offset:256
ds_read_b64_tr_b16 v[184:185],v22 offset:16384
ds_read_b64_tr_b16 v[186:187],v22 offset:20480
ds_read_b128 v[216:219],v16 offset:1024
ds_read_b64_tr_b16 v[188:189],v24 offset:16384
ds_read_b64_tr_b16 v[190:191],v24 offset:20480
ds_read_b128 v[220:223],v16 offset:1280
v_exp_f32 v151,v151
v_exp_f32 v152,v152
v_exp_f32 v153,v153
v_smfmac_f32_32x32x32_bf16 v[48:63],v[100:103],v[136:143],v76
v_exp_f32 v154,v154
v_exp_f32 v155,v155
v_exp_f32 v156,v156
v_smfmac_f32_16x16x64_bf16 v[68:71],v[72:75],v[136:143],v76
s_waitcnt lgkmcnt(12)
v_exp_f32 v157,v157
v_exp_f32 v158,v158
v_exp_f32 v159,v159
v_smfmac_f32_32x32x32_bf16 v[32:47],v[104:107],v[144:151],v76
ds_read_b128 v[96:99],v77 offset:2048
v_exp_f32 v160,v160
v_exp_f32 v161,v161
v_exp_f32 v162,v162
v_mfma_f32_32x32x16_bf16 v[112:127],v[80:83],a[64:67],0
ds_read_b128 v[100:103],v77 offset:3072
v_exp_f32 v163,v163
v_exp_f32 v164,v164
v_exp_f32 v165,v165
v_smfmac_f32_16x16x64_bf16 v[64:67],v[72:75],v[144:151],v76
v_exp_f32 v166,v166
v_mfma_f32_32x32x16_bf16 v[112:127],v[84:87],a[68:71],v[112:127]
v_exp_f32 v167,v167
v_exp_f32 v168,v168
v_exp_f32 v169,v169
v_smfmac_f32_32x32x32_bf16 v[32:47],v[108:111],v[152:159],v76
v_exp_f32 v170,v170
v_exp_f32 v171,v171
v_exp_f32 v172,v172
v_smfmac_f32_16x16x64_bf16 v[64:67],v[72:75],v[152:159],v76
v_exp_f32 v173,v173
v_exp_f32 v174,v174
v_exp_f32 v175,v175
s_waitcnt lgkmcnt(8)
v_mfma_f32_16x16x32_bf16 a[0:3],v[176:179],v[208:211],0
ds_read_b64_tr_b16 v[192:193],v18 offset:24576
ds_read_b64_tr_b16 v[194:195],v18 offset:28672
v_mfma_f32_16x16x32_bf16 a[4:7],v[180:183],v[208:211],0
s_add_u32 m0,s69,155648
v_mfma_f32_16x16x32_bf16 a[16:19],v[176:179],v[212:215],0
ds_read_b128 v[224:227],v16 offset:8192
ds_read_b64_tr_b16 v[196:197],v20 offset:24576
buffer_load_dwordx4 v9,s[64:67],s68 offen sc1 lds
v_mfma_f32_16x16x32_bf16 a[20:23],v[180:183],v[212:215],0
buffer_load_dwordx4 v9,s[64:67],s68 offen offset:1024 sc1 lds
s_waitcnt lgkmcnt(6)
v_mfma_f32_16x16x32_bf16 a[8:11],v[184:187],v[208:211],0
ds_read_b64_tr_b16 v[198:199],v20 offset:28672
ds_read_b128 v[228:231],v16 offset:8448
s_add_u32 s68,s68,8192
v_mfma_f32_16x16x32_bf16 a[24:27],v[184:187],v[212:215],0
v_mfma_f32_16x16x32_bf16 a[32:35],v[176:179],v[216:219],0
ds_read_b64_tr_b16 v[200:201],v22 offset:24576
ds_read_b64_tr_b16 v[202:203],v22 offset:28672
s_xor_b32 s62,s2,5
v_mfma_f32_16x16x32_bf16 a[36:39],v[180:183],v[216:219],0
s_lshl_b32 s62,s62,7
v_mfma_f32_16x16x32_bf16 a[40:43],v[184:187],v[216:219],0
ds_read_b128 v[232:235],v16 offset:9216
ds_read_b64_tr_b16 v[204:205],v24 offset:24576
s_add_u32 s62,s62,0x2702040
v_mfma_f32_16x16x32_bf16 a[12:15],v[188:191],v[208:211],0
v_mov_b32 v242,s62
v_mfma_f32_16x16x32_bf16 a[28:31],v[188:191],v[212:215],0
ds_read_b64_tr_b16 v[206:207],v24 offset:28672
ds_read_b128 v[236:239],v16 offset:9472
v_mfma_f32_16x16x32_bf16 a[44:47],v[188:191],v[216:219],0
s_lshl_b32 s62,s2,7
v_mfma_f32_16x16x32_bf16 a[48:51],v[176:179],v[220:223],0
s_add_u32 s62,s62,0x2702040
v_mfma_f32_16x16x32_bf16 a[52:55],v[180:183],v[220:223],0
v_mov_b32 v243,s62
v_mfma_f32_16x16x32_bf16 a[56:59],v[184:187],v[220:223],0
s_cmp_lg_u32 s31,0
s_cbranch_scc1 L_pg0
v_mov_b32 v10,1
s_mov_b64 exec,1
buffer_store_dword v10,v242,s[20:23],0 offen sc1
s_mov_b64 exec,-1
L_pg0:
v_mfma_f32_16x16x32_bf16 a[60:63],v[188:191],v[220:223],0
s_waitcnt lgkmcnt(6)
v_mfma_f32_16x16x32_bf16 a[0:3],v[192:195],v[224:227],a[0:3]
s_waitcnt lgkmcnt(0)
s_barrier
v_mfma_f32_16x16x32_bf16 a[4:7],v[196:199],v[224:227],a[4:7]
ds_read_b64_tr_b16 v[176:177],v18 offset:49152
ds_read_b64_tr_b16 v[178:179],v18 offset:53248
v_mfma_f32_16x16x32_bf16 a[16:19],v[192:195],v[228:231],a[16:19]
s_add_u32 m0,s29,0
v_mfma_f32_16x16x32_bf16 a[20:23],v[196:199],v[228:231],a[20:23]
ds_read_b128 v[208:211],v16 offset:32768
ds_read_b64_tr_b16 v[180:181],v20 offset:49152
v_mfma_f32_16x16x32_bf16 a[8:11],v[200:203],v[224:227],a[8:11]
buffer_load_dwordx4 v9,s[8:11],s24 offen sc1 lds
v_mfma_f32_16x16x32_bf16 a[24:27],v[200:203],v[228:231],a[24:27]
ds_read_b64_tr_b16 v[182:183],v20 offset:53248
ds_read_b128 v[212:215],v16 offset:33024
v_mfma_f32_16x16x32_bf16 a[32:35],v[192:195],v[232:235],a[32:35]
buffer_load_dwordx4 v9,s[8:11],s24 offen offset:1024 sc1 lds
v_mfma_f32_16x16x32_bf16 a[36:39],v[196:199],v[232:235],a[36:39]
ds_read_b64_tr_b16 v[184:185],v22 offset:49152
ds_read_b64_tr_b16 v[186:187],v22 offset:53248
v_mfma_f32_16x16x32_bf16 a[40:43],v[200:203],v[232:235],a[40:43]
buffer_load_dwordx4 v9,s[8:11],s24 offen offset:2048 sc1 lds
v_mfma_f32_16x16x32_bf16 a[12:15],v[204:207],v[224:227],a[12:15]
ds_read_b128 v[216:219],v16 offset:33792
ds_read_b64_tr_b16 v[188:189],v24 offset:49152
v_mfma_f32_16x16x32_bf16 a[28:31],v[204:207],v[228:231],a[28:31]
buffer_load_dwordx4 v9,s[8:11],s24 offen offset:3072 sc1 lds
v_mfma_f32_16x16x32_bf16 a[44:47],v[204:207],v[232:235],a[44:47]
ds_read_b64_tr_b16 v[190:191],v24 offset:53248
ds_read_b128 v[220:223],v16 offset:34048
v_mfma_f32_16x16x32_bf16 a[48:51],v[192:195],v[236:239],a[48:51]
s_add_u32 s24,s24,s32
v_mfma_f32_16x16x32_bf16 a[52:55],v[196:199],v[236:239],a[52:55]
v_mfma_f32_16x16x32_bf16 a[56:59],v[200:203],v[236:239],a[56:59]
v_mfma_f32_16x16x32_bf16 a[60:63],v[204:207],v[236:239],a[60:63]
v_smfmac_f32_32x32x32_bf16 v[48:63],v[104:107],v[160:167],v76
ds_read_b128 v[88:91],v77 offset:4096
v_exp_f32 v112,v112
v_exp_f32 v113,v113
v_exp_f32 v114,v114
v_mfma_f32_32x32x16_bf16 v[128:143],v[80:83],a[72:75],0
ds_read_b128 v[92:95],v77 offset:5120
v_exp_f32 v115,v115
v_exp_f32 v116,v116
v_exp_f32 v117,v117
v_smfmac_f32_16x16x64_bf16 v[68:71],v[72:75],v[160:167],v76
v_exp_f32 v118,v118
v_mfma_f32_32x32x16_bf16 v[128:143],v[84:87],a[76:79],v[128:143]
v_exp_f32 v119,v119
v_exp_f32 v120,v120
v_exp_f32 v121,v121
v_smfmac_f32_32x32x32_bf16 v[48:63],v[108:111],v[168:175],v76
v_exp_f32 v122,v122
v_exp_f32 v123,v123
v_exp_f32 v124,v124
v_smfmac_f32_16x16x64_bf16 v[68:71],v[72:75],v[168:175],v76
s_waitcnt lgkmcnt(0)
v_exp_f32 v125,v125
v_exp_f32 v126,v126
v_exp_f32 v127,v127
v_smfmac_f32_32x32x32_bf16 v[32:47],v[96:99],v[112:119],v76
ds_read_b128 v[104:107],v77 offset:6144
v_exp_f32 v128,v128
v_exp_f32 v129,v129
v_exp_f32 v130,v130
v_mfma_f32_32x32x16_bf16 v[144:159],v[88:91],a[64:67],0
ds_read_b128 v[108:111],v77 offset:7168
v_exp_f32 v131,v131
v_exp_f32 v132,v132
v_exp_f32 v133,v133
v_smfmac_f32_16x16x64_bf16 v[64:67],v[72:75],v[112:119],v76
v_exp_f32 v134,v134
v_mfma_f32_32x32x16_bf16 v[144:159],v[92:95],a[68:71],v[144:159]
v_exp_f32 v135,v135
v_exp_f32 v136,v136
v_exp_f32 v137,v137
v_smfmac_f32_32x32x32_bf16 v[32:47],v[100:103],v[120:127],v76
v_exp_f32 v138,v138
v_exp_f32 v139,v139
v_exp_f32 v140,v140
v_smfmac_f32_16x16x64_bf16 v[64:67],v[72:75],v[120:127],v76
v_exp_f32 v141,v141
v_exp_f32 v142,v142
v_exp_f32 v143,v143
v_smfmac_f32_32x32x32_bf16 v[48:63],v[96:99],v[128:135],v76
s_waitcnt vmcnt(16) lgkmcnt(0)
s_barrier
v_exp_f32 v144,v144
v_exp_f32 v145,v145
v_exp_f32 v146,v146
v_mfma_f32_32x32x16_bf16 v[160:175],v[88:91],a[72:75],0
ds_read_b128 v[80:83],v77 offset:8192
v_exp_f32 v147,v147
v_exp_f32 v148,v148
v_exp_f32 v149,v149
v_smfmac_f32_16x16x64_bf16 v[68:71],v[72:75],v[128:135],v76
ds_read_b128 v[84:87],v77 offset:9216
v_exp_f32 v150,v150
v_mfma_f32_32x32x16_bf16 v[160:175],v[92:95],a[76:79],v[160:175]
v_exp_f32 v151,v151
v_exp_f32 v152,v152
v_exp_f32 v153,v153
v_smfmac_f32_32x32x32_bf16 v[48:63],v[100:103],v[136:143],v76
v_exp_f32 v154,v154
v_exp_f32 v155,v155
v_exp_f32 v156,v156
v_smfmac_f32_16x16x64_bf16 v[68:71],v[72:75],v[136:143],v76
s_waitcnt lgkmcnt(0)
v_exp_f32 v157,v157
v_exp_f32 v158,v158
v_exp_f32 v159,v159
v_smfmac_f32_32x32x32_bf16 v[32:47],v[104:107],v[144:151],v76
ds_read_b128 v[96:99],v77 offset:10240
v_exp_f32 v160,v160
v_exp_f32 v161,v161
v_exp_f32 v162,v162
v_mfma_f32_32x32x16_bf16 v[112:127],v[80:83],a[64:67],0
ds_read_b128 v[100:103],v77 offset:11264
v_exp_f32 v163,v163
v_exp_f32 v164,v164
v_exp_f32 v165,v165
v_smfmac_f32_16x16x64_bf16 v[64:67],v[72:75],v[144:151],v76
v_exp_f32 v166,v166
v_mfma_f32_32x32x16_bf16 v[112:127],v[84:87],a[68:71],v[112:127]
v_exp_f32 v167,v167
v_exp_f32 v168,v168
v_exp_f32 v169,v169
v_smfmac_f32_32x32x32_bf16 v[32:47],v[108:111],v[152:159],v76
v_exp_f32 v170,v170
v_exp_f32 v171,v171
v_exp_f32 v172,v172
v_smfmac_f32_16x16x64_bf16 v[64:67],v[72:75],v[152:159],v76
v_exp_f32 v173,v173
v_exp_f32 v174,v174
v_exp_f32 v175,v175
v_mfma_f32_16x16x32_bf16 a[0:3],v[176:179],v[208:211],a[0:3]
ds_read_b64_tr_b16 v[192:193],v18 offset:57344
ds_read_b64_tr_b16 v[194:195],v18 offset:61440
v_mfma_f32_16x16x32_bf16 a[4:7],v[180:183],v[208:211],a[4:7]
s_add_u32 m0,s29,16384
v_mfma_f32_16x16x32_bf16 a[16:19],v[176:179],v[212:215],a[16:19]
ds_read_b128 v[224:227],v16 offset:40960
ds_read_b64_tr_b16 v[196:197],v20 offset:57344
buffer_load_dwordx4 v244,s[12:15],s26 offen lds
v_mfma_f32_16x16x32_bf16 a[20:23],v[180:183],v[212:215],a[20:23]
buffer_load_dwordx4 v245,s[12:15],s26 offen offset:1024 lds
v_mfma_f32_16x16x32_bf16 a[8:11],v[184:187],v[208:211],a[8:11]
ds_read_b64_tr_b16 v[198:199],v20 offset:61440
ds_read_b128 v[228:231],v16 offset:41216
v_mfma_f32_16x16x32_bf16 a[24:27],v[184:187],v[212:215],a[24:27]
buffer_load_dwordx4 v246,s[12:15],s26 offen offset:2048 lds
v_mfma_f32_16x16x32_bf16 a[32:35],v[176:179],v[216:219],a[32:35]
ds_read_b64_tr_b16 v[200:201],v22 offset:57344
ds_read_b64_tr_b16 v[202:203],v22 offset:61440
buffer_load_dwordx4 v247,s[12:15],s26 offen offset:3072 lds
v_mfma_f32_16x16x32_bf16 a[36:39],v[180:183],v[216:219],a[36:39]
s_add_u32 s26,s26,s74
v_mfma_f32_16x16x32_bf16 a[40:43],v[184:187],v[216:219],a[40:43]
ds_read_b128 v[232:235],v16 offset:41984
ds_read_b64_tr_b16 v[204:205],v24 offset:57344
v_mfma_f32_16x16x32_bf16 a[12:15],v[188:191],v[208:211],a[12:15]
s_add_u32 m0,s69,131072
v_mfma_f32_16x16x32_bf16 a[28:31],v[188:191],v[212:215],a[28:31]
ds_read_b64_tr_b16 v[206:207],v24 offset:61440
ds_read_b128 v[236:239],v16 offset:42240
buffer_load_dwordx4 v9,s[64:67],s68 offen sc1 lds
v_mfma_f32_16x16x32_bf16 a[44:47],v[188:191],v[216:219],a[44:47]
buffer_load_dwordx4 v9,s[64:67],s68 offen offset:1024 sc1 lds
v_mfma_f32_16x16x32_bf16 a[48:51],v[176:179],v[220:223],a[48:51]
v_mfma_f32_16x16x32_bf16 a[52:55],v[180:183],v[220:223],a[52:55]
s_add_u32 s68,s68,8192
v_mfma_f32_16x16x32_bf16 a[56:59],v[184:187],v[220:223],a[56:59]
s_cmp_lg_u32 s31,0
s_cbranch_scc1 L_pg1
v_mov_b32 v10,2
s_mov_b64 exec,1
buffer_store_dword v10,v242,s[20:23],0 offen sc1
s_mov_b64 exec,-1
L_pg1:
v_mfma_f32_16x16x32_bf16 a[60:63],v[188:191],v[220:223],a[60:63]
s_waitcnt lgkmcnt(6)
v_mfma_f32_16x16x32_bf16 a[0:3],v[192:195],v[224:227],a[0:3]
s_waitcnt lgkmcnt(0)
s_barrier
v_mfma_f32_16x16x32_bf16 a[4:7],v[196:199],v[224:227],a[4:7]
ds_read_b64_tr_b16 v[176:177],v19 offset:16384
ds_read_b64_tr_b16 v[178:179],v19 offset:20480
v_mfma_f32_16x16x32_bf16 a[16:19],v[192:195],v[228:231],a[16:19]
s_add_u32 m0,s29,32768
v_mfma_f32_16x16x32_bf16 a[20:23],v[196:199],v[228:231],a[20:23]
ds_read_b128 v[208:211],v17
ds_read_b64_tr_b16 v[180:181],v21 offset:16384
v_mfma_f32_16x16x32_bf16 a[8:11],v[200:203],v[224:227],a[8:11]
buffer_load_dwordx4 v9,s[8:11],s24 offen sc1 lds
v_mfma_f32_16x16x32_bf16 a[24:27],v[200:203],v[228:231],a[24:27]
ds_read_b64_tr_b16 v[182:183],v21 offset:20480
ds_read_b128 v[212:215],v17 offset:256
v_mfma_f32_16x16x32_bf16 a[32:35],v[192:195],v[232:235],a[32:35]
buffer_load_dwordx4 v9,s[8:11],s24 offen offset:1024 sc1 lds
v_mfma_f32_16x16x32_bf16 a[36:39],v[196:199],v[232:235],a[36:39]
ds_read_b64_tr_b16 v[184:185],v23 offset:16384
ds_read_b64_tr_b16 v[186:187],v23 offset:20480
v_mfma_f32_16x16x32_bf16 a[40:43],v[200:203],v[232:235],a[40:43]
buffer_load_dwordx4 v9,s[8:11],s24 offen offset:2048 sc1 lds
v_mfma_f32_16x16x32_bf16 a[12:15],v[204:207],v[224:227],a[12:15]
ds_read_b128 v[216:219],v17 offset:1024
ds_read_b64_tr_b16 v[188:189],v25 offset:16384
v_mfma_f32_16x16x32_bf16 a[28:31],v[204:207],v[228:231],a[28:31]
buffer_load_dwordx4 v9,s[8:11],s24 offen offset:3072 sc1 lds
v_mfma_f32_16x16x32_bf16 a[44:47],v[204:207],v[232:235],a[44:47]
ds_read_b64_tr_b16 v[190:191],v25 offset:20480
ds_read_b128 v[220:223],v17 offset:1280
v_mfma_f32_16x16x32_bf16 a[48:51],v[192:195],v[236:239],a[48:51]
s_add_u32 s24,s24,s32
v_mfma_f32_16x16x32_bf16 a[52:55],v[196:199],v[236:239],a[52:55]
v_mfma_f32_16x16x32_bf16 a[56:59],v[200:203],v[236:239],a[56:59]
v_mfma_f32_16x16x32_bf16 a[60:63],v[204:207],v[236:239],a[60:63]
v_smfmac_f32_32x32x32_bf16 v[48:63],v[104:107],v[160:167],v76
ds_read_b128 v[88:91],v77 offset:12288
v_exp_f32 v112,v112
v_exp_f32 v113,v113
v_exp_f32 v114,v114
v_mfma_f32_32x32x16_bf16 v[128:143],v[80:83],a[72:75],0
ds_read_b128 v[92:95],v77 offset:13312
v_exp_f32 v115,v115
v_exp_f32 v116,v116
v_exp_f32 v117,v117
v_smfmac_f32_16x16x64_bf16 v[68:71],v[72:75],v[160:167],v76
v_exp_f32 v118,v118
v_mfma_f32_32x32x16_bf16 v[128:143],v[84:87],a[76:79],v[128:143]
v_exp_f32 v119,v119
v_exp_f32 v120,v120
v_exp_f32 v121,v121
v_smfmac_f32_32x32x32_bf16 v[48:63],v[108:111],v[168:175],v76
v_exp_f32 v122,v122
v_exp_f32 v123,v123
v_exp_f32 v124,v124
v_smfmac_f32_16x16x64_bf16 v[68:71],v[72:75],v[168:175],v76
s_waitcnt lgkmcnt(0)
v_exp_f32 v125,v125
v_exp_f32 v126,v126
v_exp_f32 v127,v127
v_smfmac_f32_32x32x32_bf16 v[32:47],v[96:99],v[112:119],v76
ds_read_b128 v[104:107],v77 offset:14336
v_exp_f32 v128,v128
v_exp_f32 v129,v129
v_exp_f32 v130,v130
v_mfma_f32_32x32x16_bf16 v[144:159],v[88:91],a[64:67],0
ds_read_b128 v[108:111],v77 offset:15360
v_exp_f32 v131,v131
v_exp_f32 v132,v132
v_exp_f32 v133,v133
v_smfmac_f32_16x16x64_bf16 v[64:67],v[72:75],v[112:119],v76
v_exp_f32 v134,v134
v_mfma_f32_32x32x16_bf16 v[144:159],v[92:95],a[68:71],v[144:159]
v_exp_f32 v135,v135
v_exp_f32 v136,v136
v_exp_f32 v137,v137
v_smfmac_f32_32x32x32_bf16 v[32:47],v[100:103],v[120:127],v76
v_exp_f32 v138,v138
v_exp_f32 v139,v139
v_exp_f32 v140,v140
v_smfmac_f32_16x16x64_bf16 v[64:67],v[72:75],v[120:127],v76
v_exp_f32 v141,v141
v_exp_f32 v142,v142
v_exp_f32 v143,v143
v_smfmac_f32_32x32x32_bf16 v[48:63],v[96:99],v[128:135],v76
s_waitcnt vmcnt(16) lgkmcnt(0)
s_barrier
v_exp_f32 v144,v144
v_exp_f32 v145,v145
v_exp_f32 v146,v146
v_mfma_f32_32x32x16_bf16 v[160:175],v[88:91],a[72:75],0
ds_read_b128 v[80:83],v77 offset:16384
v_exp_f32 v147,v147
v_exp_f32 v148,v148
v_exp_f32 v149,v149
v_smfmac_f32_16x16x64_bf16 v[68:71],v[72:75],v[128:135],v76
ds_read_b128 v[84:87],v77 offset:17408
v_exp_f32 v150,v150
v_mfma_f32_32x32x16_bf16 v[160:175],v[92:95],a[76:79],v[160:175]
v_exp_f32 v151,v151
v_exp_f32 v152,v152
v_exp_f32 v153,v153
v_smfmac_f32_32x32x32_bf16 v[48:63],v[100:103],v[136:143],v76
v_exp_f32 v154,v154
v_exp_f32 v155,v155
v_exp_f32 v156,v156
v_smfmac_f32_16x16x64_bf16 v[68:71],v[72:75],v[136:143],v76
s_waitcnt lgkmcnt(0)
v_exp_f32 v157,v157
v_exp_f32 v158,v158
v_exp_f32 v159,v159
v_smfmac_f32_32x32x32_bf16 v[32:47],v[104:107],v[144:151],v76
ds_read_b128 v[96:99],v77 offset:18432
v_exp_f32 v160,v160
v_exp_f32 v161,v161
v_exp_f32 v162,v162
v_mfma_f32_32x32x16_bf16 v[112:127],v[80:83],a[64:67],0
ds_read_b128 v[100:103],v77 offset:19456
v_exp_f32 v163,v163
v_exp_f32 v164,v164
v_exp_f32 v165,v165
v_smfmac_f32_16x16x64_bf16 v[64:67],v[72:75],v[144:151],v76
v_exp_f32 v166,v166
v_mfma_f32_32x32x16_bf16 v[112:127],v[84:87],a[68:71],v[112:127]
v_exp_f32 v167,v167
v_exp_f32 v168,v168
v_exp_f32 v169,v169
v_smfmac_f32_32x32x32_bf16 v[32:47],v[108:111],v[152:159],v76
v_exp_f32 v170,v170
v_exp_f32 v171,v171
v_exp_f32 v172,v172
v_smfmac_f32_16x16x64_bf16 v[64:67],v[72:75],v[152:159],v76
v_exp_f32 v173,v173
v_exp_f32 v174,v174
v_exp_f32 v175,v175
v_mfma_f32_16x16x32_bf16 a[0:3],v[176:179],v[208:211],a[0:3]
ds_read_b64_tr_b16 v[192:193],v19 offset:24576
ds_read_b64_tr_b16 v[194:195],v19 offset:28672
v_mfma_f32_16x16x32_bf16 a[4:7],v[180:183],v[208:211],a[4:7]
s_add_u32 m0,s29,49152
v_mfma_f32_16x16x32_bf16 a[16:19],v[176:179],v[212:215],a[16:19]
ds_read_b128 v[224:227],v17 offset:8192
ds_read_b64_tr_b16 v[196:197],v21 offset:24576
buffer_load_dwordx4 v244,s[12:15],s26 offen lds
v_mfma_f32_16x16x32_bf16 a[20:23],v[180:183],v[212:215],a[20:23]
buffer_load_dwordx4 v245,s[12:15],s26 offen offset:1024 lds
v_mfma_f32_16x16x32_bf16 a[8:11],v[184:187],v[208:211],a[8:11]
ds_read_b64_tr_b16 v[198:199],v21 offset:28672
ds_read_b128 v[228:231],v17 offset:8448
v_mfma_f32_16x16x32_bf16 a[24:27],v[184:187],v[212:215],a[24:27]
buffer_load_dwordx4 v246,s[12:15],s26 offen offset:2048 lds
v_mfma_f32_16x16x32_bf16 a[32:35],v[176:179],v[216:219],a[32:35]
ds_read_b64_tr_b16 v[200:201],v23 offset:24576
ds_read_b64_tr_b16 v[202:203],v23 offset:28672
buffer_load_dwordx4 v247,s[12:15],s26 offen offset:3072 lds
v_mfma_f32_16x16x32_bf16 a[36:39],v[180:183],v[216:219],a[36:39]
s_add_u32 s26,s26,s74
v_mfma_f32_16x16x32_bf16 a[40:43],v[184:187],v[216:219],a[40:43]
ds_read_b128 v[232:235],v17 offset:9216
ds_read_b64_tr_b16 v[204:205],v25 offset:24576
v_mfma_f32_16x16x32_bf16 a[12:15],v[188:191],v[208:211],a[12:15]
s_add_u32 m0,s69,139264
v_mfma_f32_16x16x32_bf16 a[28:31],v[188:191],v[212:215],a[28:31]
ds_read_b64_tr_b16 v[206:207],v25 offset:28672
ds_read_b128 v[236:239],v17 offset:9472
buffer_load_dwordx4 v9,s[64:67],s68 offen sc1 lds
v_mfma_f32_16x16x32_bf16 a[44:47],v[188:191],v[216:219],a[44:47]
buffer_load_dwordx4 v9,s[64:67],s68 offen offset:1024 sc1 lds
v_mfma_f32_16x16x32_bf16 a[48:51],v[176:179],v[220:223],a[48:51]
v_mfma_f32_16x16x32_bf16 a[52:55],v[180:183],v[220:223],a[52:55]
s_add_u32 s68,s68,8192
v_mfma_f32_16x16x32_bf16 a[56:59],v[184:187],v[220:223],a[56:59]
s_cmp_lg_u32 s31,0
s_cbranch_scc1 L_pg2
v_mov_b32 v10,3
s_mov_b64 exec,1
buffer_store_dword v10,v242,s[20:23],0 offen sc1
s_mov_b64 exec,-1
L_pg2:
v_mfma_f32_16x16x32_bf16 a[60:63],v[188:191],v[220:223],a[60:63]
s_waitcnt lgkmcnt(6)
v_mfma_f32_16x16x32_bf16 a[0:3],v[192:195],v[224:227],a[0:3]
s_waitcnt lgkmcnt(0)
s_barrier
v_mfma_f32_16x16x32_bf16 a[4:7],v[196:199],v[224:227],a[4:7]
ds_read_b64_tr_b16 v[176:177],v19 offset:49152
ds_read_b64_tr_b16 v[178:179],v19 offset:53248
v_mfma_f32_16x16x32_bf16 a[16:19],v[192:195],v[228:231],a[16:19]
s_add_u32 m0,s4,0
v_mfma_f32_16x16x32_bf16 a[20:23],v[196:199],v[228:231],a[20:23]
ds_read_b128 v[208:211],v17 offset:32768
ds_read_b64_tr_b16 v[180:181],v21 offset:49152
v_mfma_f32_16x16x32_bf16 a[8:11],v[200:203],v[224:227],a[8:11]
buffer_load_dwordx4 v9,s[8:11],s24 offen sc1 lds
v_mfma_f32_16x16x32_bf16 a[24:27],v[200:203],v[228:231],a[24:27]
ds_read_b64_tr_b16 v[182:183],v21 offset:53248
ds_read_b128 v[212:215],v17 offset:33024
v_mfma_f32_16x16x32_bf16 a[32:35],v[192:195],v[232:235],a[32:35]
buffer_load_dwordx4 v9,s[8:11],s24 offen offset:1024 sc1 lds
v_mfma_f32_16x16x32_bf16 a[36:39],v[196:199],v[232:235],a[36:39]
ds_read_b64_tr_b16 v[184:185],v23 offset:49152
ds_read_b64_tr_b16 v[186:187],v23 offset:53248
v_mfma_f32_16x16x32_bf16 a[40:43],v[200:203],v[232:235],a[40:43]
buffer_load_dwordx4 v9,s[8:11],s24 offen offset:2048 sc1 lds
v_mfma_f32_16x16x32_bf16 a[12:15],v[204:207],v[224:227],a[12:15]
ds_read_b128 v[216:219],v17 offset:33792
ds_read_b64_tr_b16 v[188:189],v25 offset:49152
v_mfma_f32_16x16x32_bf16 a[28:31],v[204:207],v[228:231],a[28:31]
buffer_load_dwordx4 v9,s[8:11],s24 offen offset:3072 sc1 lds
v_mfma_f32_16x16x32_bf16 a[44:47],v[204:207],v[232:235],a[44:47]
ds_read_b64_tr_b16 v[190:191],v25 offset:53248
ds_read_b128 v[220:223],v17 offset:34048
v_mfma_f32_16x16x32_bf16 a[48:51],v[192:195],v[236:239],a[48:51]
s_add_u32 s24,s24,s32
v_mfma_f32_16x16x32_bf16 a[52:55],v[196:199],v[236:239],a[52:55]
v_mfma_f32_16x16x32_bf16 a[56:59],v[200:203],v[236:239],a[56:59]
v_mfma_f32_16x16x32_bf16 a[60:63],v[204:207],v[236:239],a[60:63]
v_smfmac_f32_32x32x32_bf16 v[48:63],v[104:107],v[160:167],v76
ds_read_b128 v[88:91],v77 offset:20480
v_exp_f32 v112,v112
v_exp_f32 v113,v113
v_exp_f32 v114,v114
v_mfma_f32_32x32x16_bf16 v[128:143],v[80:83],a[72:75],0
ds_read_b128 v[92:95],v77 offset:21504
v_exp_f32 v115,v115
v_exp_f32 v116,v116
v_exp_f32 v117,v117
v_smfmac_f32_16x16x64_bf16 v[68:71],v[72:75],v[160:167],v76
v_exp_f32 v118,v118
v_mfma_f32_32x32x16_bf16 v[128:143],v[84:87],a[76:79],v[128:143]
v_exp_f32 v119,v119
v_exp_f32 v120,v120
v_exp_f32 v121,v121
v_smfmac_f32_32x32x32_bf16 v[48:63],v[108:111],v[168:175],v76
v_exp_f32 v122,v122
v_exp_f32 v123,v123
v_exp_f32 v124,v124
v_smfmac_f32_16x16x64_bf16 v[68:71],v[72:75],v[168:175],v76
s_waitcnt lgkmcnt(0)
v_exp_f32 v125,v125
v_exp_f32 v126,v126
v_exp_f32 v127,v127
v_smfmac_f32_32x32x32_bf16 v[32:47],v[96:99],v[112:119],v76
ds_read_b128 v[104:107],v77 offset:22528
v_exp_f32 v128,v128
v_exp_f32 v129,v129
v_exp_f32 v130,v130
v_mfma_f32_32x32x16_bf16 v[144:159],v[88:91],a[64:67],0
ds_read_b128 v[108:111],v77 offset:23552
v_exp_f32 v131,v131
v_exp_f32 v132,v132
v_exp_f32 v133,v133
v_smfmac_f32_16x16x64_bf16 v[64:67],v[72:75],v[112:119],v76
v_exp_f32 v134,v134
v_mfma_f32_32x32x16_bf16 v[144:159],v[92:95],a[68:71],v[144:159]
v_exp_f32 v135,v135
v_exp_f32 v136,v136
v_exp_f32 v137,v137
v_smfmac_f32_32x32x32_bf16 v[32:47],v[100:103],v[120:127],v76
v_exp_f32 v138,v138
v_exp_f32 v139,v139
v_exp_f32 v140,v140
v_smfmac_f32_16x16x64_bf16 v[64:67],v[72:75],v[120:127],v76
v_exp_f32 v141,v141
v_exp_f32 v142,v142
v_exp_f32 v143,v143
v_smfmac_f32_32x32x32_bf16 v[48:63],v[96:99],v[128:135],v76
s_waitcnt vmcnt(24) lgkmcnt(0)
s_barrier
v_exp_f32 v144,v144
v_exp_f32 v145,v145
v_exp_f32 v146,v146
v_mfma_f32_32x32x16_bf16 v[160:175],v[88:91],a[72:75],0
ds_read_b128 v[80:83],v77 offset:24576
v_exp_f32 v147,v147
v_exp_f32 v148,v148
v_exp_f32 v149,v149
v_smfmac_f32_16x16x64_bf16 v[68:71],v[72:75],v[128:135],v76
ds_read_b128 v[84:87],v77 offset:25600
v_exp_f32 v150,v150
v_mfma_f32_32x32x16_bf16 v[160:175],v[92:95],a[76:79],v[160:175]
v_exp_f32 v151,v151
v_exp_f32 v152,v152
v_exp_f32 v153,v153
v_smfmac_f32_32x32x32_bf16 v[48:63],v[100:103],v[136:143],v76
v_exp_f32 v154,v154
v_exp_f32 v155,v155
v_exp_f32 v156,v156
v_smfmac_f32_16x16x64_bf16 v[68:71],v[72:75],v[136:143],v76
s_waitcnt lgkmcnt(0)
v_exp_f32 v157,v157
v_exp_f32 v158,v158
v_exp_f32 v159,v159
v_smfmac_f32_32x32x32_bf16 v[32:47],v[104:107],v[144:151],v76
ds_read_b128 v[96:99],v77 offset:26624
v_exp_f32 v160,v160
v_exp_f32 v161,v161
v_exp_f32 v162,v162
v_mfma_f32_32x32x16_bf16 v[112:127],v[80:83],a[64:67],0
ds_read_b128 v[100:103],v77 offset:27648
v_exp_f32 v163,v163
v_exp_f32 v164,v164
v_exp_f32 v165,v165
v_smfmac_f32_16x16x64_bf16 v[64:67],v[72:75],v[144:151],v76
v_exp_f32 v166,v166
v_mfma_f32_32x32x16_bf16 v[112:127],v[84:87],a[68:71],v[112:127]
v_exp_f32 v167,v167
v_exp_f32 v168,v168
v_exp_f32 v169,v169
v_smfmac_f32_32x32x32_bf16 v[32:47],v[108:111],v[152:159],v76
v_exp_f32 v170,v170
v_exp_f32 v171,v171
v_exp_f32 v172,v172
v_smfmac_f32_16x16x64_bf16 v[64:67],v[72:75],v[152:159],v76
v_exp_f32 v173,v173
v_exp_f32 v174,v174
v_exp_f32 v175,v175
v_mfma_f32_16x16x32_bf16 a[0:3],v[176:179],v[208:211],a[0:3]
ds_read_b64_tr_b16 v[192:193],v19 offset:57344
ds_read_b64_tr_b16 v[194:195],v19 offset:61440
v_mfma_f32_16x16x32_bf16 a[4:7],v[180:183],v[208:211],a[4:7]
s_add_u32 m0,s4,16384
v_mfma_f32_16x16x32_bf16 a[16:19],v[176:179],v[212:215],a[16:19]
ds_read_b128 v[224:227],v17 offset:40960
ds_read_b64_tr_b16 v[196:197],v21 offset:57344
buffer_load_dwordx4 v244,s[12:15],s26 offen lds
v_mfma_f32_16x16x32_bf16 a[20:23],v[180:183],v[212:215],a[20:23]
buffer_load_dwordx4 v245,s[12:15],s26 offen offset:1024 lds
v_mfma_f32_16x16x32_bf16 a[8:11],v[184:187],v[208:211],a[8:11]
ds_read_b64_tr_b16 v[198:199],v21 offset:61440
ds_read_b128 v[228:231],v17 offset:41216
v_mfma_f32_16x16x32_bf16 a[24:27],v[184:187],v[212:215],a[24:27]
buffer_load_dwordx4 v246,s[12:15],s26 offen offset:2048 lds
v_mfma_f32_16x16x32_bf16 a[32:35],v[176:179],v[216:219],a[32:35]
ds_read_b64_tr_b16 v[200:201],v23 offset:57344
ds_read_b64_tr_b16 v[202:203],v23 offset:61440
buffer_load_dwordx4 v247,s[12:15],s26 offen offset:3072 lds
v_mfma_f32_16x16x32_bf16 a[36:39],v[180:183],v[216:219],a[36:39]
s_add_u32 s26,s26,s74
v_mfma_f32_16x16x32_bf16 a[40:43],v[184:187],v[216:219],a[40:43]
ds_read_b128 v[232:235],v17 offset:41984
ds_read_b64_tr_b16 v[204:205],v25 offset:57344
v_mfma_f32_16x16x32_bf16 a[12:15],v[188:191],v[208:211],a[12:15]
s_add_u32 m0,s69,147456
v_mfma_f32_16x16x32_bf16 a[28:31],v[188:191],v[212:215],a[28:31]
ds_read_b64_tr_b16 v[206:207],v25 offset:61440
ds_read_b128 v[236:239],v17 offset:42240
buffer_load_dwordx4 v9,s[64:67],s68 offen sc1 lds
v_mfma_f32_16x16x32_bf16 a[44:47],v[188:191],v[216:219],a[44:47]
buffer_load_dwordx4 v9,s[64:67],s68 offen offset:1024 sc1 lds
v_mfma_f32_16x16x32_bf16 a[48:51],v[176:179],v[220:223],a[48:51]
v_mfma_f32_16x16x32_bf16 a[52:55],v[180:183],v[220:223],a[52:55]
s_add_u32 s68,s68,8192
v_mfma_f32_16x16x32_bf16 a[56:59],v[184:187],v[220:223],a[56:59]
s_cmp_lg_u32 s31,0
s_cbranch_scc1 L_pg3
v_mov_b32 v10,4
s_mov_b64 exec,1
buffer_store_dword v10,v242,s[20:23],0 offen sc1
s_mov_b64 exec,-1
L_pg3:
v_mfma_f32_16x16x32_bf16 a[60:63],v[188:191],v[220:223],a[60:63]
s_waitcnt lgkmcnt(6)
v_mfma_f32_16x16x32_bf16 a[0:3],v[192:195],v[224:227],a[0:3]
s_waitcnt vmcnt(22) lgkmcnt(0)
s_barrier
v_mfma_f32_16x16x32_bf16 a[4:7],v[196:199],v[224:227],a[4:7]
ds_read_b64_tr_b16 v[176:177],v18 offset:16384
ds_read_b64_tr_b16 v[178:179],v18 offset:20480
s_add_u32 m0,s4,32768
s_nop 0
buffer_load_dwordx4 v9,s[8:11],s24 offen sc1 lds
v_mfma_f32_16x16x32_bf16 a[16:19],v[192:195],v[228:231],a[16:19]
buffer_load_dwordx4 v9,s[8:11],s24 offen offset:1024 sc1 lds
v_mfma_f32_16x16x32_bf16 a[20:23],v[196:199],v[228:231],a[20:23]
ds_read_b128 v[208:211],v16
ds_read_b64_tr_b16 v[180:181],v20 offset:16384
buffer_load_dwordx4 v9,s[8:11],s24 offen offset:2048 sc1 lds
v_mfma_f32_16x16x32_bf16 a[8:11],v[200:203],v[224:227],a[8:11]
buffer_load_dwordx4 v9,s[8:11],s24 offen offset:3072 sc1 lds
v_mfma_f32_16x16x32_bf16 a[24:27],v[200:203],v[228:231],a[24:27]
ds_read_b64_tr_b16 v[182:183],v20 offset:20480
ds_read_b128 v[212:215],v16 offset:256
s_add_u32 s24,s24,s32
v_mfma_f32_16x16x32_bf16 a[32:35],v[192:195],v[232:235],a[32:35]
s_mov_b32 s52,s38
s_and_b32 s53,s39,0xffff
v_mfma_f32_16x16x32_bf16 a[36:39],v[196:199],v[232:235],a[36:39]
ds_read_b64_tr_b16 v[184:185],v22 offset:16384
ds_read_b64_tr_b16 v[186:187],v22 offset:20480
s_mov_b32 s54,0x400000
v_mfma_f32_16x16x32_bf16 a[40:43],v[200:203],v[232:235],a[40:43]
s_mov_b32 s55,0x00020000
v_mfma_f32_16x16x32_bf16 a[12:15],v[204:207],v[224:227],a[12:15]
ds_read_b128 v[216:219],v16 offset:1024
ds_read_b64_tr_b16 v[188:189],v24 offset:16384
v_and_b32 v79,15,v2
v_mfma_f32_16x16x32_bf16 a[28:31],v[204:207],v[228:231],a[28:31]
v_lshrrev_b32 v4,4,v2
v_mfma_f32_16x16x32_bf16 a[44:47],v[204:207],v[232:235],a[44:47]
ds_read_b64_tr_b16 v[190:191],v24 offset:20480
ds_read_b128 v[220:223],v16 offset:1280
v_lshlrev_b32 v79,11,v79
v_lshl_add_u32 v3,v4,3,v79
v_mfma_f32_16x16x32_bf16 a[48:51],v[192:195],v[236:239],a[48:51]
v_bfe_u32 v4,v2,4,1
v_mfma_f32_16x16x32_bf16 a[52:55],v[196:199],v[236:239],a[52:55]
v_lshrrev_b32 v5,5,v2
v_mfma_f32_16x16x32_bf16 a[56:59],v[200:203],v[236:239],a[56:59]
v_lshl_add_u32 v79,v4,5,v79
v_mfma_f32_16x16x32_bf16 a[60:63],v[204:207],v[236:239],a[60:63]
v_lshl_add_u32 v79,v5,4,v79
v_smfmac_f32_32x32x32_bf16 v[48:63],v[104:107],v[160:167],v76
ds_read_b128 v[88:91],v77 offset:28672
v_exp_f32 v112,v112
v_exp_f32 v113,v113
v_exp_f32 v114,v114
v_mfma_f32_32x32x16_bf16 v[128:143],v[80:83],a[72:75],0
ds_read_b128 v[92:95],v77 offset:29696
v_exp_f32 v115,v115
v_exp_f32 v116,v116
v_exp_f32 v117,v117
v_smfmac_f32_16x16x64_bf16 v[68:71],v[72:75],v[160:167],v76
v_exp_f32 v118,v118
v_mfma_f32_32x32x16_bf16 v[128:143],v[84:87],a[76:79],v[128:143]
v_exp_f32 v119,v119
v_exp_f32 v120,v120
v_exp_f32 v121,v121
v_smfmac_f32_32x32x32_bf16 v[48:63],v[108:111],v[168:175],v76
v_exp_f32 v122,v122
v_exp_f32 v123,v123
v_exp_f32 v124,v124
v_smfmac_f32_16x16x64_bf16 v[68:71],v[72:75],v[168:175],v76
s_waitcnt lgkmcnt(0)
v_exp_f32 v125,v125
v_exp_f32 v126,v126
v_exp_f32 v127,v127
v_smfmac_f32_32x32x32_bf16 v[32:47],v[96:99],v[112:119],v76
ds_read_b128 v[104:107],v77 offset:30720
v_exp_f32 v128,v128
v_exp_f32 v129,v129
v_exp_f32 v130,v130
v_mfma_f32_32x32x16_bf16 v[144:159],v[88:91],a[64:67],0
ds_read_b128 v[108:111],v77 offset:31744
v_exp_f32 v131,v131
v_exp_f32 v132,v132
v_exp_f32 v133,v133
v_smfmac_f32_16x16x64_bf16 v[64:67],v[72:75],v[112:119],v76
v_exp_f32 v134,v134
v_mfma_f32_32x32x16_bf16 v[144:159],v[92:95],a[68:71],v[144:159]
v_exp_f32 v135,v135
v_exp_f32 v136,v136
v_exp_f32 v137,v137
v_smfmac_f32_32x32x32_bf16 v[32:47],v[100:103],v[120:127],v76
v_exp_f32 v138,v138
v_exp_f32 v139,v139
v_exp_f32 v140,v140
v_smfmac_f32_16x16x64_bf16 v[64:67],v[72:75],v[120:127],v76
v_exp_f32 v141,v141
v_exp_f32 v142,v142
v_exp_f32 v143,v143
v_smfmac_f32_32x32x32_bf16 v[48:63],v[96:99],v[128:135],v76
s_waitcnt vmcnt(24) lgkmcnt(0)
s_barrier
v_exp_f32 v144,v144
v_exp_f32 v145,v145
v_exp_f32 v146,v146
v_mfma_f32_32x32x16_bf16 v[160:175],v[88:91],a[72:75],0
ds_read_b128 v[80:83],v77
v_exp_f32 v147,v147
v_exp_f32 v148,v148
v_exp_f32 v149,v149
v_smfmac_f32_16x16x64_bf16 v[68:71],v[72:75],v[128:135],v76
ds_read_b128 v[84:87],v77 offset:1024
v_exp_f32 v150,v150
v_mfma_f32_32x32x16_bf16 v[160:175],v[92:95],a[76:79],v[160:175]
v_exp_f32 v151,v151
v_exp_f32 v152,v152
v_exp_f32 v153,v153
v_smfmac_f32_32x32x32_bf16 v[48:63],v[100:103],v[136:143],v76
v_exp_f32 v154,v154
v_exp_f32 v155,v155
v_exp_f32 v156,v156
v_smfmac_f32_16x16x64_bf16 v[68:71],v[72:75],v[136:143],v76
s_waitcnt lgkmcnt(0)
v_exp_f32 v157,v157
v_exp_f32 v158,v158
v_exp_f32 v159,v159
v_smfmac_f32_32x32x32_bf16 v[32:47],v[104:107],v[144:151],v76
ds_read_b128 v[96:99],v77 offset:2048
v_exp_f32 v160,v160
v_exp_f32 v161,v161
v_exp_f32 v162,v162
v_mfma_f32_32x32x16_bf16 v[112:127],v[80:83],a[64:67],0
ds_read_b128 v[100:103],v77 offset:3072
v_exp_f32 v163,v163
v_exp_f32 v164,v164
v_exp_f32 v165,v165
v_smfmac_f32_16x16x64_bf16 v[64:67],v[72:75],v[144:151],v76
v_exp_f32 v166,v166
v_mfma_f32_32x32x16_bf16 v[112:127],v[84:87],a[68:71],v[112:127]
v_exp_f32 v167,v167
v_exp_f32 v168,v168
v_exp_f32 v169,v169
v_smfmac_f32_32x32x32_bf16 v[32:47],v[108:111],v[152:159],v76
v_exp_f32 v170,v170
v_exp_f32 v171,v171
v_exp_f32 v172,v172
v_smfmac_f32_16x16x64_bf16 v[64:67],v[72:75],v[152:159],v76
v_exp_f32 v173,v173
v_exp_f32 v174,v174
v_exp_f32 v175,v175
v_mfma_f32_16x16x32_bf16 a[0:3],v[176:179],v[208:211],a[0:3]
ds_read_b64_tr_b16 v[192:193],v18 offset:24576
ds_read_b64_tr_b16 v[194:195],v18 offset:28672
v_mfma_f32_16x16x32_bf16 a[4:7],v[180:183],v[208:211],a[4:7]
s_add_u32 m0,s4,49152
v_mfma_f32_16x16x32_bf16 a[16:19],v[176:179],v[212:215],a[16:19]
ds_read_b128 v[224:227],v16 offset:8192
ds_read_b64_tr_b16 v[196:197],v20 offset:24576
buffer_load_dwordx4 v244,s[12:15],s26 offen lds
v_mfma_f32_16x16x32_bf16 a[20:23],v[180:183],v[212:215],a[20:23]
buffer_load_dwordx4 v245,s[12:15],s26 offen offset:1024 lds
v_mfma_f32_16x16x32_bf16 a[8:11],v[184:187],v[208:211],a[8:11]
ds_read_b64_tr_b16 v[198:199],v20 offset:28672
ds_read_b128 v[228:231],v16 offset:8448
buffer_load_dwordx4 v246,s[12:15],s26 offen offset:2048 lds
v_mfma_f32_16x16x32_bf16 a[24:27],v[184:187],v[212:215],a[24:27]
v_mfma_f32_16x16x32_bf16 a[32:35],v[176:179],v[216:219],a[32:35]
ds_read_b64_tr_b16 v[200:201],v22 offset:24576
ds_read_b64_tr_b16 v[202:203],v22 offset:28672
buffer_load_dwordx4 v247,s[12:15],s26 offen offset:3072 lds
v_mfma_f32_16x16x32_bf16 a[36:39],v[180:183],v[216:219],a[36:39]
s_add_u32 s26,s26,s74
v_mfma_f32_16x16x32_bf16 a[40:43],v[184:187],v[216:219],a[40:43]
ds_read_b128 v[232:235],v16 offset:9216
ds_read_b64_tr_b16 v[204:205],v24 offset:24576
s_add_u32 m0,s69,155648
v_mfma_f32_16x16x32_bf16 a[12:15],v[188:191],v[208:211],a[12:15]
buffer_load_dwordx4 v9,s[64:67],s68 offen sc1 lds
v_mfma_f32_16x16x32_bf16 a[28:31],v[188:191],v[212:215],a[28:31]
ds_read_b64_tr_b16 v[206:207],v24 offset:28672
ds_read_b128 v[236:239],v16 offset:9472
v_mfma_f32_16x16x32_bf16 a[44:47],v[188:191],v[216:219],a[44:47]
buffer_load_dwordx4 v9,s[64:67],s68 offen offset:1024 sc1 lds
v_mfma_f32_16x16x32_bf16 a[48:51],v[176:179],v[220:223],a[48:51]
s_add_u32 s68,s68,8192
v_mfma_f32_16x16x32_bf16 a[52:55],v[180:183],v[220:223],a[52:55]
s_cmp_lg_u32 s31,0
s_cbranch_scc1 L_pg4
v_mov_b32 v10,5
s_mov_b64 exec,1
buffer_store_dword v10,v242,s[20:23],0 offen sc1
s_mov_b64 exec,-1
L_pg4:
v_mfma_f32_16x16x32_bf16 a[56:59],v[184:187],v[220:223],a[56:59]
buffer_load_dword v240,v243,s[20:23],0 offen sc1
v_mfma_f32_16x16x32_bf16 a[60:63],v[188:191],v[220:223],a[60:63]
s_waitcnt lgkmcnt(6)
v_mfma_f32_16x16x32_bf16 a[0:3],v[192:195],v[224:227],a[0:3]
s_waitcnt vmcnt(23) lgkmcnt(0)
s_barrier
v_mfma_f32_16x16x32_bf16 a[4:7],v[196:199],v[224:227],a[4:7]
ds_read_b64_tr_b16 v[176:177],v18 offset:49152
ds_read_b64_tr_b16 v[178:179],v18 offset:53248
s_add_u32 m0,s29,0
s_nop 0
buffer_load_dwordx4 v9,s[8:11],s24 offen sc1 lds
v_mfma_f32_16x16x32_bf16 a[16:19],v[192:195],v[228:231],a[16:19]
buffer_load_dwordx4 v9,s[8:11],s24 offen offset:1024 sc1 lds
v_mfma_f32_16x16x32_bf16 a[20:23],v[196:199],v[228:231],a[20:23]
ds_read_b128 v[208:211],v16 offset:32768
ds_read_b64_tr_b16 v[180:181],v20 offset:49152
buffer_load_dwordx4 v9,s[8:11],s24 offen offset:2048 sc1 lds
v_mfma_f32_16x16x32_bf16 a[8:11],v[200:203],v[224:227],a[8:11]
buffer_load_dwordx4 v9,s[8:11],s24 offen offset:3072 sc1 lds
v_mfma_f32_16x16x32_bf16 a[24:27],v[200:203],v[228:231],a[24:27]
ds_read_b64_tr_b16 v[182:183],v20 offset:53248
ds_read_b128 v[212:215],v16 offset:33024
s_add_u32 s24,s24,s32
v_mfma_f32_16x16x32_bf16 a[32:35],v[192:195],v[232:235],a[32:35]
s_lshl_b32 s48,s41,7
v_mfma_f32_16x16x32_bf16 a[36:39],v[196:199],v[232:235],a[36:39]
ds_read_b64_tr_b16 v[184:185],v22 offset:49152
ds_read_b64_tr_b16 v[186:187],v22 offset:53248
s_lshl_b32 s49,s40,6
v_mfma_f32_16x16x32_bf16 a[40:43],v[200:203],v[232:235],a[40:43]
s_add_u32 s48,s48,s49
s_lshl_b32 s49,s43,5
v_mfma_f32_16x16x32_bf16 a[12:15],v[204:207],v[224:227],a[12:15]
ds_read_b128 v[216:219],v16 offset:33792
ds_read_b64_tr_b16 v[188:189],v24 offset:49152
s_add_u32 s48,s48,s49
v_mfma_f32_16x16x32_bf16 a[28:31],v[204:207],v[228:231],a[28:31]
s_lshl_b32 s48,s48,11
v_mfma_f32_16x16x32_bf16 a[44:47],v[204:207],v[232:235],a[44:47]
ds_read_b64_tr_b16 v[190:191],v24 offset:53248
ds_read_b128 v[220:223],v16 offset:34048
s_lshl_b32 s49,s42,8
v_mfma_f32_16x16x32_bf16 a[48:51],v[192:195],v[236:239],a[48:51]
s_add_u32 s48,s48,s49
v_mfma_f32_16x16x32_bf16 a[52:55],v[196:199],v[236:239],a[52:55]
s_lshl_b32 s49,s45,7
v_mfma_f32_16x16x32_bf16 a[56:59],v[200:203],v[236:239],a[56:59]
s_add_u32 s48,s48,s49
v_mfma_f32_16x16x32_bf16 a[60:63],v[204:207],v[236:239],a[60:63]
s_add_u32 s49,s48,0x8000
v_smfmac_f32_32x32x32_bf16 v[48:63],v[104:107],v[160:167],v76
ds_read_b128 v[88:91],v77 offset:4096
v_exp_f32 v112,v112
v_exp_f32 v113,v113
v_exp_f32 v114,v114
v_mfma_f32_32x32x16_bf16 v[128:143],v[80:83],a[72:75],0
ds_read_b128 v[92:95],v77 offset:5120
v_exp_f32 v115,v115
v_exp_f32 v116,v116
v_exp_f32 v117,v117
v_smfmac_f32_16x16x64_bf16 v[68:71],v[72:75],v[160:167],v76
v_exp_f32 v118,v118
v_mfma_f32_32x32x16_bf16 v[128:143],v[84:87],a[76:79],v[128:143]
v_exp_f32 v119,v119
v_exp_f32 v120,v120
v_exp_f32 v121,v121
v_smfmac_f32_32x32x32_bf16 v[48:63],v[108:111],v[168:175],v76
v_exp_f32 v122,v122
v_exp_f32 v123,v123
v_exp_f32 v124,v124
v_smfmac_f32_16x16x64_bf16 v[68:71],v[72:75],v[168:175],v76
s_waitcnt lgkmcnt(0)
v_exp_f32 v125,v125
v_exp_f32 v126,v126
v_exp_f32 v127,v127
v_smfmac_f32_32x32x32_bf16 v[32:47],v[96:99],v[112:119],v76
ds_read_b128 v[104:107],v77 offset:6144
v_exp_f32 v128,v128
v_exp_f32 v129,v129
v_exp_f32 v130,v130
v_mfma_f32_32x32x16_bf16 v[144:159],v[88:91],a[64:67],0
ds_read_b128 v[108:111],v77 offset:7168
v_exp_f32 v131,v131
v_exp_f32 v132,v132
v_exp_f32 v133,v133
v_smfmac_f32_16x16x64_bf16 v[64:67],v[72:75],v[112:119],v76
v_exp_f32 v134,v134
v_mfma_f32_32x32x16_bf16 v[144:159],v[92:95],a[68:71],v[144:159]
v_exp_f32 v135,v135
v_exp_f32 v136,v136
v_exp_f32 v137,v137
v_smfmac_f32_32x32x32_bf16 v[32:47],v[100:103],v[120:127],v76
v_exp_f32 v138,v138
v_exp_f32 v139,v139
v_exp_f32 v140,v140
v_smfmac_f32_16x16x64_bf16 v[64:67],v[72:75],v[120:127],v76
v_exp_f32 v141,v141
v_exp_f32 v142,v142
v_exp_f32 v143,v143
v_smfmac_f32_32x32x32_bf16 v[48:63],v[96:99],v[128:135],v76
s_waitcnt vmcnt(25) lgkmcnt(0)
s_barrier
v_exp_f32 v144,v144
v_exp_f32 v145,v145
v_exp_f32 v146,v146
v_mfma_f32_32x32x16_bf16 v[160:175],v[88:91],a[72:75],0
ds_read_b128 v[80:83],v77 offset:8192
v_exp_f32 v147,v147
v_exp_f32 v148,v148
v_exp_f32 v149,v149
v_smfmac_f32_16x16x64_bf16 v[68:71],v[72:75],v[128:135],v76
ds_read_b128 v[84:87],v77 offset:9216
v_exp_f32 v150,v150
v_mfma_f32_32x32x16_bf16 v[160:175],v[92:95],a[76:79],v[160:175]
v_exp_f32 v151,v151
v_exp_f32 v152,v152
v_exp_f32 v153,v153
v_smfmac_f32_32x32x32_bf16 v[48:63],v[100:103],v[136:143],v76
v_exp_f32 v154,v154
v_exp_f32 v155,v155
v_exp_f32 v156,v156
v_smfmac_f32_16x16x64_bf16 v[68:71],v[72:75],v[136:143],v76
s_waitcnt lgkmcnt(0)
v_exp_f32 v157,v157
v_exp_f32 v158,v158
v_exp_f32 v159,v159
v_smfmac_f32_32x32x32_bf16 v[32:47],v[104:107],v[144:151],v76
ds_read_b128 v[96:99],v77 offset:10240
v_exp_f32 v160,v160
v_exp_f32 v161,v161
v_exp_f32 v162,v162
v_mfma_f32_32x32x16_bf16 v[112:127],v[80:83],a[64:67],0
ds_read_b128 v[100:103],v77 offset:11264
v_exp_f32 v163,v163
v_exp_f32 v164,v164
v_exp_f32 v165,v165
v_smfmac_f32_16x16x64_bf16 v[64:67],v[72:75],v[144:151],v76
v_exp_f32 v166,v166
v_mfma_f32_32x32x16_bf16 v[112:127],v[84:87],a[68:71],v[112:127]
v_exp_f32 v167,v167
v_exp_f32 v168,v168
v_exp_f32 v169,v169
v_smfmac_f32_32x32x32_bf16 v[32:47],v[108:111],v[152:159],v76
v_exp_f32 v170,v170
v_exp_f32 v171,v171
v_exp_f32 v172,v172
v_smfmac_f32_16x16x64_bf16 v[64:67],v[72:75],v[152:159],v76
v_exp_f32 v173,v173
v_exp_f32 v174,v174
v_exp_f32 v175,v175
v_mfma_f32_16x16x32_bf16 a[0:3],v[176:179],v[208:211],a[0:3]
ds_read_b64_tr_b16 v[192:193],v18 offset:57344
ds_read_b64_tr_b16 v[194:195],v18 offset:61440
v_mfma_f32_16x16x32_bf16 a[4:7],v[180:183],v[208:211],a[4:7]
s_add_u32 m0,s29,16384
v_mfma_f32_16x16x32_bf16 a[16:19],v[176:179],v[212:215],a[16:19]
ds_read_b128 v[224:227],v16 offset:40960
ds_read_b64_tr_b16 v[196:197],v20 offset:57344
buffer_load_dwordx4 v244,s[12:15],s26 offen lds
v_mfma_f32_16x16x32_bf16 a[20:23],v[180:183],v[212:215],a[20:23]
buffer_load_dwordx4 v245,s[12:15],s26 offen offset:1024 lds
v_mfma_f32_16x16x32_bf16 a[8:11],v[184:187],v[208:211],a[8:11]
ds_read_b64_tr_b16 v[198:199],v20 offset:61440
ds_read_b128 v[228:231],v16 offset:41216
v_mfma_f32_16x16x32_bf16 a[24:27],v[184:187],v[212:215],a[24:27]
buffer_load_dwordx4 v246,s[12:15],s26 offen offset:2048 lds
v_mfma_f32_16x16x32_bf16 a[32:35],v[176:179],v[216:219],a[32:35]
ds_read_b64_tr_b16 v[200:201],v22 offset:57344
ds_read_b64_tr_b16 v[202:203],v22 offset:61440
buffer_load_dwordx4 v247,s[12:15],s26 offen offset:3072 lds
v_mfma_f32_16x16x32_bf16 a[36:39],v[180:183],v[216:219],a[36:39]
s_add_u32 s26,s26,s74
v_mfma_f32_16x16x32_bf16 a[40:43],v[184:187],v[216:219],a[40:43]
ds_read_b128 v[232:235],v16 offset:41984
ds_read_b64_tr_b16 v[204:205],v24 offset:57344
v_mfma_f32_16x16x32_bf16 a[12:15],v[188:191],v[208:211],a[12:15]
s_add_u32 m0,s69,131072
v_mfma_f32_16x16x32_bf16 a[28:31],v[188:191],v[212:215],a[28:31]
ds_read_b64_tr_b16 v[206:207],v24 offset:61440
ds_read_b128 v[236:239],v16 offset:42240
buffer_load_dwordx4 v9,s[64:67],s68 offen sc1 lds
v_mfma_f32_16x16x32_bf16 a[44:47],v[188:191],v[216:219],a[44:47]
buffer_load_dwordx4 v9,s[64:67],s68 offen offset:1024 sc1 lds
v_mfma_f32_16x16x32_bf16 a[48:51],v[176:179],v[220:223],a[48:51]
v_mfma_f32_16x16x32_bf16 a[52:55],v[180:183],v[220:223],a[52:55]
s_add_u32 s68,s68,8192
v_mfma_f32_16x16x32_bf16 a[56:59],v[184:187],v[220:223],a[56:59]
s_cmp_lg_u32 s31,0
s_cbranch_scc1 L_pg5
v_mov_b32 v10,6
s_mov_b64 exec,1
buffer_store_dword v10,v242,s[20:23],0 offen sc1
s_mov_b64 exec,-1
L_pg5:
v_mfma_f32_16x16x32_bf16 a[60:63],v[188:191],v[220:223],a[60:63]
s_waitcnt lgkmcnt(6)
v_mfma_f32_16x16x32_bf16 a[0:3],v[192:195],v[224:227],a[0:3]
s_waitcnt vmcnt(23) lgkmcnt(0)
s_barrier
v_mfma_f32_16x16x32_bf16 a[4:7],v[196:199],v[224:227],a[4:7]
ds_read_b64_tr_b16 v[176:177],v19 offset:16384
ds_read_b64_tr_b16 v[178:179],v19 offset:20480
s_add_u32 m0,s29,32768
v_mfma_f32_16x16x32_bf16 a[16:19],v[192:195],v[228:231],a[16:19]
buffer_load_dwordx4 v9,s[8:11],s24 offen sc1 lds
v_mfma_f32_16x16x32_bf16 a[20:23],v[196:199],v[228:231],a[20:23]
ds_read_b128 v[208:211],v17
ds_read_b64_tr_b16 v[180:181],v21 offset:16384
v_mfma_f32_16x16x32_bf16 a[8:11],v[200:203],v[224:227],a[8:11]
buffer_load_dwordx4 v9,s[8:11],s24 offen offset:1024 sc1 lds
v_mfma_f32_16x16x32_bf16 a[24:27],v[200:203],v[228:231],a[24:27]
ds_read_b64_tr_b16 v[182:183],v21 offset:20480
ds_read_b128 v[212:215],v17 offset:256
buffer_load_dwordx4 v9,s[8:11],s24 offen offset:2048 sc1 lds
v_mfma_f32_16x16x32_bf16 a[32:35],v[192:195],v[232:235],a[32:35]
v_mfma_f32_16x16x32_bf16 a[36:39],v[196:199],v[232:235],a[36:39]
ds_read_b64_tr_b16 v[184:185],v23 offset:16384
ds_read_b64_tr_b16 v[186:187],v23 offset:20480
buffer_load_dwordx4 v9,s[8:11],s24 offen offset:3072 sc1 lds
v_mfma_f32_16x16x32_bf16 a[40:43],v[200:203],v[232:235],a[40:43]
s_add_u32 s24,s24,s32
v_mfma_f32_16x16x32_bf16 a[12:15],v[204:207],v[224:227],a[12:15]
ds_read_b128 v[216:219],v17 offset:1024
ds_read_b64_tr_b16 v[188:189],v25 offset:16384
v_mfma_f32_16x16x32_bf16 a[28:31],v[204:207],v[228:231],a[28:31]
buffer_load_dwordx2 a[80:81],v3,s[52:55],s48 offen
v_mfma_f32_16x16x32_bf16 a[44:47],v[204:207],v[232:235],a[44:47]
ds_read_b64_tr_b16 v[190:191],v25 offset:20480
ds_read_b128 v[220:223],v17 offset:1280
buffer_load_dwordx2 a[82:83],v3,s[52:55],s48 offen offset:32
v_mfma_f32_16x16x32_bf16 a[48:51],v[192:195],v[236:239],a[48:51]
v_mfma_f32_16x16x32_bf16 a[52:55],v[196:199],v[236:239],a[52:55]
buffer_load_dwordx2 a[84:85],v3,s[52:55],s48 offen offset:64
v_mfma_f32_16x16x32_bf16 a[56:59],v[200:203],v[236:239],a[56:59]
buffer_load_dwordx2 a[86:87],v3,s[52:55],s48 offen offset:96
v_mfma_f32_16x16x32_bf16 a[60:63],v[204:207],v[236:239],a[60:63]
v_smfmac_f32_32x32x32_bf16 v[48:63],v[104:107],v[160:167],v76
ds_read_b128 v[88:91],v77 offset:12288
v_exp_f32 v112,v112
v_exp_f32 v113,v113
v_exp_f32 v114,v114
v_mfma_f32_32x32x16_bf16 v[128:143],v[80:83],a[72:75],0
ds_read_b128 v[92:95],v77 offset:13312
v_exp_f32 v115,v115
v_exp_f32 v116,v116
v_exp_f32 v117,v117
v_smfmac_f32_16x16x64_bf16 v[68:71],v[72:75],v[160:167],v76
v_exp_f32 v118,v118
v_mfma_f32_32x32x16_bf16 v[128:143],v[84:87],a[76:79],v[128:143]
v_exp_f32 v119,v119
v_exp_f32 v120,v120
v_exp_f32 v121,v121
v_smfmac_f32_32x32x32_bf16 v[48:63],v[108:111],v[168:175],v76
v_exp_f32 v122,v122
v_exp_f32 v123,v123
v_exp_f32 v124,v124
v_smfmac_f32_16x16x64_bf16 v[68:71],v[72:75],v[168:175],v76
s_waitcnt lgkmcnt(0)
v_exp_f32 v125,v125
v_exp_f32 v126,v126
v_exp_f32 v127,v127
v_smfmac_f32_32x32x32_bf16 v[32:47],v[96:99],v[112:119],v76
ds_read_b128 v[104:107],v77 offset:14336
v_exp_f32 v128,v128
v_exp_f32 v129,v129
v_exp_f32 v130,v130
v_mfma_f32_32x32x16_bf16 v[144:159],v[88:91],a[64:67],0
ds_read_b128 v[108:111],v77 offset:15360
v_exp_f32 v131,v131
v_exp_f32 v132,v132
v_exp_f32 v133,v133
v_smfmac_f32_16x16x64_bf16 v[64:67],v[72:75],v[112:119],v76
v_exp_f32 v134,v134
v_mfma_f32_32x32x16_bf16 v[144:159],v[92:95],a[68:71],v[144:159]
v_exp_f32 v135,v135
v_exp_f32 v136,v136
v_exp_f32 v137,v137
v_smfmac_f32_32x32x32_bf16 v[32:47],v[100:103],v[120:127],v76
v_exp_f32 v138,v138
v_exp_f32 v139,v139
v_exp_f32 v140,v140
v_smfmac_f32_16x16x64_bf16 v[64:67],v[72:75],v[120:127],v76
v_exp_f32 v141,v141
v_exp_f32 v142,v142
v_exp_f32 v143,v143
v_smfmac_f32_32x32x32_bf16 v[48:63],v[96:99],v[128:135],v76
s_waitcnt vmcnt(29) lgkmcnt(0)
s_barrier
v_exp_f32 v144,v144
v_exp_f32 v145,v145
v_exp_f32 v146,v146
v_mfma_f32_32x32x16_bf16 v[160:175],v[88:91],a[72:75],0
ds_read_b128 v[80:83],v77 offset:16384
v_exp_f32 v147,v147
v_exp_f32 v148,v148
v_exp_f32 v149,v149
v_smfmac_f32_16x16x64_bf16 v[68:71],v[72:75],v[128:135],v76
ds_read_b128 v[84:87],v77 offset:17408
v_exp_f32 v150,v150
v_mfma_f32_32x32x16_bf16 v[160:175],v[92:95],a[76:79],v[160:175]
v_exp_f32 v151,v151
v_exp_f32 v152,v152
v_exp_f32 v153,v153
v_smfmac_f32_32x32x32_bf16 v[48:63],v[100:103],v[136:143],v76
v_exp_f32 v154,v154
v_exp_f32 v155,v155
v_exp_f32 v156,v156
v_smfmac_f32_16x16x64_bf16 v[68:71],v[72:75],v[136:143],v76
s_waitcnt lgkmcnt(0)
v_exp_f32 v157,v157
v_exp_f32 v158,v158
v_exp_f32 v159,v159
v_smfmac_f32_32x32x32_bf16 v[32:47],v[104:107],v[144:151],v76
ds_read_b128 v[96:99],v77 offset:18432
v_exp_f32 v160,v160
v_exp_f32 v161,v161
v_exp_f32 v162,v162
v_mfma_f32_32x32x16_bf16 v[112:127],v[80:83],a[64:67],0
ds_read_b128 v[100:103],v77 offset:19456
v_exp_f32 v163,v163
v_exp_f32 v164,v164
v_exp_f32 v165,v165
v_smfmac_f32_16x16x64_bf16 v[64:67],v[72:75],v[144:151],v76
v_exp_f32 v166,v166
v_mfma_f32_32x32x16_bf16 v[112:127],v[84:87],a[68:71],v[112:127]
v_exp_f32 v167,v167
v_exp_f32 v168,v168
v_exp_f32 v169,v169
v_smfmac_f32_32x32x32_bf16 v[32:47],v[108:111],v[152:159],v76
v_exp_f32 v170,v170
v_exp_f32 v171,v171
v_exp_f32 v172,v172
v_smfmac_f32_16x16x64_bf16 v[64:67],v[72:75],v[152:159],v76
v_exp_f32 v173,v173
v_exp_f32 v174,v174
v_exp_f32 v175,v175
v_mfma_f32_16x16x32_bf16 a[0:3],v[176:179],v[208:211],a[0:3]
ds_read_b64_tr_b16 v[192:193],v19 offset:24576
ds_read_b64_tr_b16 v[194:195],v19 offset:28672
v_mfma_f32_16x16x32_bf16 a[4:7],v[180:183],v[208:211],a[4:7]
s_add_u32 m0,s29,49152
s_nop 0
buffer_load_dwordx4 v244,s[12:15],s26 offen lds
v_mfma_f32_16x16x32_bf16 a[16:19],v[176:179],v[212:215],a[16:19]
ds_read_b128 v[224:227],v17 offset:8192
ds_read_b64_tr_b16 v[196:197],v21 offset:24576
buffer_load_dwordx4 v245,s[12:15],s26 offen offset:1024 lds
buffer_load_dwordx4 v246,s[12:15],s26 offen offset:2048 lds
v_mfma_f32_16x16x32_bf16 a[20:23],v[180:183],v[212:215],a[20:23]
buffer_load_dwordx4 v247,s[12:15],s26 offen offset:3072 lds
v_mfma_f32_16x16x32_bf16 a[8:11],v[184:187],v[208:211],a[8:11]
ds_read_b64_tr_b16 v[198:199],v21 offset:28672
ds_read_b128 v[228:231],v17 offset:8448
s_add_u32 s26,s26,s74
s_add_u32 m0,s69,139264
v_mfma_f32_16x16x32_bf16 a[24:27],v[184:187],v[212:215],a[24:27]
buffer_load_dwordx4 v9,s[64:67],s68 offen sc1 lds
v_mfma_f32_16x16x32_bf16 a[32:35],v[176:179],v[216:219],a[32:35]
ds_read_b64_tr_b16 v[200:201],v23 offset:24576
ds_read_b64_tr_b16 v[202:203],v23 offset:28672
buffer_load_dwordx4 v9,s[64:67],s68 offen offset:1024 sc1 lds
s_add_u32 s68,s68,8192
v_mfma_f32_16x16x32_bf16 a[36:39],v[180:183],v[216:219],a[36:39]
s_cmp_lg_u32 s31,0
s_cbranch_scc1 L_pg6
v_mov_b32 v10,7
s_mov_b64 exec,1
buffer_store_dword v10,v242,s[20:23],0 offen sc1
s_mov_b64 exec,-1
L_pg6:
v_mfma_f32_16x16x32_bf16 a[40:43],v[184:187],v[216:219],a[40:43]
ds_read_b128 v[232:235],v17 offset:9216
ds_read_b64_tr_b16 v[204:205],v25 offset:24576
s_waitcnt vmcnt(24)
v_readfirstlane_b32 s62,v240
v_mfma_f32_16x16x32_bf16 a[12:15],v[188:191],v[208:211],a[12:15]
v_add_u32 v11,4,v243
v_mfma_f32_16x16x32_bf16 a[28:31],v[188:191],v[212:215],a[28:31]
ds_read_b64_tr_b16 v[206:207],v25 offset:28672
ds_read_b128 v[236:239],v17 offset:9472
v_add_u32 v12,4,v242
s_lshl_b32 s63,s31,1
v_mfma_f32_16x16x32_bf16 a[44:47],v[188:191],v[216:219],a[44:47]
s_xor_b32 s63,s63,s40
v_mfma_f32_16x16x32_bf16 a[48:51],v[176:179],v[220:223],a[48:51]
s_cmp_gt_u32 s62,4
s_subb_u32 s62,s62,0
s_max_i32 s62,s62,0
v_mfma_f32_16x16x32_bf16 a[52:55],v[180:183],v[220:223],a[52:55]
s_min_i32 s62,s62,8
v_mfma_f32_16x16x32_bf16 a[56:59],v[184:187],v[220:223],a[56:59]
s_add_u32 s62,s62,1
s_sub_u32 s75,10,s62
v_mfma_f32_16x16x32_bf16 a[60:63],v[188:191],v[220:223],a[60:63]
s_cmp_lg_u32 s63,1
s_cbranch_scc1 L_dec
v_mov_b32 v10,s75
v_mov_b32 v13,s62
s_mov_b64 exec,1
buffer_store_dword v10,v11,s[20:23],0 offen sc1
buffer_store_dword v13,v12,s[20:23],0 offen sc1
s_mov_b64 exec,-1
L_dec:
s_waitcnt lgkmcnt(6)
v_mfma_f32_16x16x32_bf16 a[0:3],v[192:195],v[224:227],a[0:3]
s_waitcnt lgkmcnt(0)
s_barrier
v_mfma_f32_16x16x32_bf16 a[4:7],v[196:199],v[224:227],a[4:7]
ds_read_b64_tr_b16 v[176:177],v19 offset:49152
ds_read_b64_tr_b16 v[178:179],v19 offset:53248
s_add_u32 m0,s4,0
v_mfma_f32_16x16x32_bf16 a[16:19],v[192:195],v[228:231],a[16:19]
buffer_load_dwordx4 v9,s[8:11],s24 offen sc1 lds
v_mfma_f32_16x16x32_bf16 a[20:23],v[196:199],v[228:231],a[20:23]
ds_read_b128 v[208:211],v17 offset:32768
ds_read_b64_tr_b16 v[180:181],v21 offset:49152
v_mfma_f32_16x16x32_bf16 a[8:11],v[200:203],v[224:227],a[8:11]
buffer_load_dwordx4 v9,s[8:11],s24 offen offset:1024 sc1 lds
v_mfma_f32_16x16x32_bf16 a[24:27],v[200:203],v[228:231],a[24:27]
ds_read_b64_tr_b16 v[182:183],v21 offset:53248
ds_read_b128 v[212:215],v17 offset:33024
buffer_load_dwordx4 v9,s[8:11],s24 offen offset:2048 sc1 lds
v_mfma_f32_16x16x32_bf16 a[32:35],v[192:195],v[232:235],a[32:35]
v_mfma_f32_16x16x32_bf16 a[36:39],v[196:199],v[232:235],a[36:39]
ds_read_b64_tr_b16 v[184:185],v23 offset:49152
ds_read_b64_tr_b16 v[186:187],v23 offset:53248
buffer_load_dwordx4 v9,s[8:11],s24 offen offset:3072 sc1 lds
v_mfma_f32_16x16x32_bf16 a[40:43],v[200:203],v[232:235],a[40:43]
s_add_u32 s24,s24,s32
v_mfma_f32_16x16x32_bf16 a[12:15],v[204:207],v[224:227],a[12:15]
ds_read_b128 v[216:219],v17 offset:33792
ds_read_b64_tr_b16 v[188:189],v25 offset:49152
v_mfma_f32_16x16x32_bf16 a[28:31],v[204:207],v[228:231],a[28:31]
buffer_load_dwordx2 a[88:89],v3,s[52:55],s49 offen
v_mfma_f32_16x16x32_bf16 a[44:47],v[204:207],v[232:235],a[44:47]
ds_read_b64_tr_b16 v[190:191],v25 offset:53248
ds_read_b128 v[220:223],v17 offset:34048
buffer_load_dwordx2 a[90:91],v3,s[52:55],s49 offen offset:32
v_mfma_f32_16x16x32_bf16 a[48:51],v[192:195],v[236:239],a[48:51]
v_mfma_f32_16x16x32_bf16 a[52:55],v[196:199],v[236:239],a[52:55]
buffer_load_dwordx2 a[92:93],v3,s[52:55],s49 offen offset:64
v_mfma_f32_16x16x32_bf16 a[56:59],v[200:203],v[236:239],a[56:59]
buffer_load_dwordx2 a[94:95],v3,s[52:55],s49 offen offset:96
v_mfma_f32_16x16x32_bf16 a[60:63],v[204:207],v[236:239],a[60:63]
v_smfmac_f32_32x32x32_bf16 v[48:63],v[104:107],v[160:167],v76
ds_read_b128 v[88:91],v77 offset:20480
v_exp_f32 v112,v112
v_exp_f32 v113,v113
v_exp_f32 v114,v114
v_mfma_f32_32x32x16_bf16 v[128:143],v[80:83],a[72:75],0
ds_read_b128 v[92:95],v77 offset:21504
v_exp_f32 v115,v115
v_exp_f32 v116,v116
v_exp_f32 v117,v117
v_smfmac_f32_16x16x64_bf16 v[68:71],v[72:75],v[160:167],v76
v_exp_f32 v118,v118
v_mfma_f32_32x32x16_bf16 v[128:143],v[84:87],a[76:79],v[128:143]
v_exp_f32 v119,v119
v_exp_f32 v120,v120
v_exp_f32 v121,v121
v_smfmac_f32_32x32x32_bf16 v[48:63],v[108:111],v[168:175],v76
v_exp_f32 v122,v122
v_exp_f32 v123,v123
v_exp_f32 v124,v124
v_smfmac_f32_16x16x64_bf16 v[68:71],v[72:75],v[168:175],v76
s_waitcnt lgkmcnt(0)
v_exp_f32 v125,v125
v_exp_f32 v126,v126
v_exp_f32 v127,v127
v_smfmac_f32_32x32x32_bf16 v[32:47],v[96:99],v[112:119],v76
ds_read_b128 v[104:107],v77 offset:22528
v_exp_f32 v128,v128
v_exp_f32 v129,v129
v_exp_f32 v130,v130
v_mfma_f32_32x32x16_bf16 v[144:159],v[88:91],a[64:67],0
ds_read_b128 v[108:111],v77 offset:23552
v_exp_f32 v131,v131
v_exp_f32 v132,v132
v_exp_f32 v133,v133
v_smfmac_f32_16x16x64_bf16 v[64:67],v[72:75],v[112:119],v76
v_exp_f32 v134,v134
v_mfma_f32_32x32x16_bf16 v[144:159],v[92:95],a[68:71],v[144:159]
v_exp_f32 v135,v135
v_exp_f32 v136,v136
v_exp_f32 v137,v137
v_smfmac_f32_32x32x32_bf16 v[32:47],v[100:103],v[120:127],v76
v_exp_f32 v138,v138
v_exp_f32 v139,v139
v_exp_f32 v140,v140
v_smfmac_f32_16x16x64_bf16 v[64:67],v[72:75],v[120:127],v76
v_exp_f32 v141,v141
v_exp_f32 v142,v142
v_exp_f32 v143,v143
v_smfmac_f32_32x32x32_bf16 v[48:63],v[96:99],v[128:135],v76
s_waitcnt lgkmcnt(0)
s_barrier
v_exp_f32 v144,v144
v_exp_f32 v145,v145
v_exp_f32 v146,v146
v_mfma_f32_32x32x16_bf16 v[160:175],v[88:91],a[72:75],0
ds_read_b128 v[80:83],v77 offset:24576
v_exp_f32 v147,v147
v_exp_f32 v148,v148
v_exp_f32 v149,v149
v_smfmac_f32_16x16x64_bf16 v[68:71],v[72:75],v[128:135],v76
ds_read_b128 v[84:87],v77 offset:25600
v_exp_f32 v150,v150
v_mfma_f32_32x32x16_bf16 v[160:175],v[92:95],a[76:79],v[160:175]
v_exp_f32 v151,v151
v_exp_f32 v152,v152
v_exp_f32 v153,v153
v_smfmac_f32_32x32x32_bf16 v[48:63],v[100:103],v[136:143],v76
v_exp_f32 v154,v154
v_exp_f32 v155,v155
v_exp_f32 v156,v156
v_smfmac_f32_16x16x64_bf16 v[68:71],v[72:75],v[136:143],v76
s_waitcnt lgkmcnt(0)
v_exp_f32 v157,v157
v_exp_f32 v158,v158
v_exp_f32 v159,v159
v_smfmac_f32_32x32x32_bf16 v[32:47],v[104:107],v[144:151],v76
ds_read_b128 v[96:99],v77 offset:26624
v_exp_f32 v160,v160
v_exp_f32 v161,v161
v_exp_f32 v162,v162
v_mfma_f32_32x32x16_bf16 v[112:127],v[80:83],a[64:67],0
ds_read_b128 v[100:103],v77 offset:27648
v_exp_f32 v163,v163
v_exp_f32 v164,v164
v_exp_f32 v165,v165
v_smfmac_f32_16x16x64_bf16 v[64:67],v[72:75],v[144:151],v76
v_exp_f32 v166,v166
v_mfma_f32_32x32x16_bf16 v[112:127],v[84:87],a[68:71],v[112:127]
v_exp_f32 v167,v167
v_exp_f32 v168,v168
v_exp_f32 v169,v169
v_smfmac_f32_32x32x32_bf16 v[32:47],v[108:111],v[152:159],v76
v_exp_f32 v170,v170
v_exp_f32 v171,v171
v_exp_f32 v172,v172
v_smfmac_f32_16x16x64_bf16 v[64:67],v[72:75],v[152:159],v76
v_exp_f32 v173,v173
v_exp_f32 v174,v174
v_exp_f32 v175,v175
v_mfma_f32_16x16x32_bf16 a[0:3],v[176:179],v[208:211],a[0:3]
ds_read_b64_tr_b16 v[192:193],v19 offset:57344
ds_read_b64_tr_b16 v[194:195],v19 offset:61440
v_mfma_f32_16x16x32_bf16 a[4:7],v[180:183],v[208:211],a[4:7]
s_add_u32 m0,s4,16384
v_mfma_f32_16x16x32_bf16 a[16:19],v[176:179],v[212:215],a[16:19]
ds_read_b128 v[224:227],v17 offset:40960
ds_read_b64_tr_b16 v[196:197],v21 offset:57344
buffer_load_dwordx4 v244,s[12:15],s26 offen lds
v_mfma_f32_16x16x32_bf16 a[20:23],v[180:183],v[212:215],a[20:23]
buffer_load_dwordx4 v245,s[12:15],s26 offen offset:1024 lds
v_mfma_f32_16x16x32_bf16 a[8:11],v[184:187],v[208:211],a[8:11]
ds_read_b64_tr_b16 v[198:199],v21 offset:61440
ds_read_b128 v[228:231],v17 offset:41216
v_mfma_f32_16x16x32_bf16 a[24:27],v[184:187],v[212:215],a[24:27]
buffer_load_dwordx4 v246,s[12:15],s26 offen offset:2048 lds
v_mfma_f32_16x16x32_bf16 a[32:35],v[176:179],v[216:219],a[32:35]
ds_read_b64_tr_b16 v[200:201],v23 offset:57344
ds_read_b64_tr_b16 v[202:203],v23 offset:61440
buffer_load_dwordx4 v247,s[12:15],s26 offen offset:3072 lds
v_mfma_f32_16x16x32_bf16 a[36:39],v[180:183],v[216:219],a[36:39]
s_add_u32 s26,s26,s74
v_mfma_f32_16x16x32_bf16 a[40:43],v[184:187],v[216:219],a[40:43]
ds_read_b128 v[232:235],v17 offset:41984
ds_read_b64_tr_b16 v[204:205],v25 offset:57344
v_mfma_f32_16x16x32_bf16 a[12:15],v[188:191],v[208:211],a[12:15]
s_add_u32 m0,s69,147456
v_mfma_f32_16x16x32_bf16 a[28:31],v[188:191],v[212:215],a[28:31]
ds_read_b64_tr_b16 v[206:207],v25 offset:61440
ds_read_b128 v[236:239],v17 offset:42240
buffer_load_dwordx4 v9,s[64:67],s68 offen sc1 lds
v_mfma_f32_16x16x32_bf16 a[44:47],v[188:191],v[216:219],a[44:47]
buffer_load_dwordx4 v9,s[64:67],s68 offen offset:1024 sc1 lds
v_mfma_f32_16x16x32_bf16 a[48:51],v[176:179],v[220:223],a[48:51]
v_mfma_f32_16x16x32_bf16 a[52:55],v[180:183],v[220:223],a[52:55]
s_add_u32 s68,s68,8192
v_mfma_f32_16x16x32_bf16 a[56:59],v[184:187],v[220:223],a[56:59]
s_cmp_lg_u32 s31,0
s_cbranch_scc1 L_pg7
v_mov_b32 v10,8
s_mov_b64 exec,1
buffer_store_dword v10,v242,s[20:23],0 offen sc1
s_mov_b64 exec,-1
L_pg7:
v_mfma_f32_16x16x32_bf16 a[60:63],v[188:191],v[220:223],a[60:63]
s_waitcnt lgkmcnt(6)
v_mfma_f32_16x16x32_bf16 a[0:3],v[192:195],v[224:227],a[0:3]
s_waitcnt vmcnt(30) lgkmcnt(0)
s_barrier
v_mfma_f32_16x16x32_bf16 a[4:7],v[196:199],v[224:227],a[4:7]
ds_read_b64_tr_b16 v[176:177],v18 offset:16384
ds_read_b64_tr_b16 v[178:179],v18 offset:20480
v_mfma_f32_16x16x32_bf16 a[16:19],v[192:195],v[228:231],a[16:19]
s_add_u32 m0,s4,32768
v_mfma_f32_16x16x32_bf16 a[20:23],v[196:199],v[228:231],a[20:23]
ds_read_b128 v[208:211],v16
ds_read_b64_tr_b16 v[180:181],v20 offset:16384
v_mfma_f32_16x16x32_bf16 a[8:11],v[200:203],v[224:227],a[8:11]
buffer_load_dwordx4 v9,s[8:11],s24 offen sc1 lds
v_mfma_f32_16x16x32_bf16 a[24:27],v[200:203],v[228:231],a[24:27]
ds_read_b64_tr_b16 v[182:183],v20 offset:20480
ds_read_b128 v[212:215],v16 offset:256
v_mfma_f32_16x16x32_bf16 a[32:35],v[192:195],v[232:235],a[32:35]
buffer_load_dwordx4 v9,s[8:11],s24 offen offset:1024 sc1 lds
v_mfma_f32_16x16x32_bf16 a[36:39],v[196:199],v[232:235],a[36:39]
ds_read_b64_tr_b16 v[184:185],v22 offset:16384
ds_read_b64_tr_b16 v[186:187],v22 offset:20480
v_mfma_f32_16x16x32_bf16 a[40:43],v[200:203],v[232:235],a[40:43]
buffer_load_dwordx4 v9,s[8:11],s24 offen offset:2048 sc1 lds
v_mfma_f32_16x16x32_bf16 a[12:15],v[204:207],v[224:227],a[12:15]
ds_read_b128 v[216:219],v16 offset:1024
ds_read_b64_tr_b16 v[188:189],v24 offset:16384
v_mfma_f32_16x16x32_bf16 a[28:31],v[204:207],v[228:231],a[28:31]
buffer_load_dwordx4 v9,s[8:11],s24 offen offset:3072 sc1 lds
v_mfma_f32_16x16x32_bf16 a[44:47],v[204:207],v[232:235],a[44:47]
ds_read_b64_tr_b16 v[190:191],v24 offset:20480
ds_read_b128 v[220:223],v16 offset:1280
v_mfma_f32_16x16x32_bf16 a[48:51],v[192:195],v[236:239],a[48:51]
s_add_u32 s24,s24,s32
v_mfma_f32_16x16x32_bf16 a[52:55],v[196:199],v[236:239],a[52:55]
v_mfma_f32_16x16x32_bf16 a[56:59],v[200:203],v[236:239],a[56:59]
v_mfma_f32_16x16x32_bf16 a[60:63],v[204:207],v[236:239],a[60:63]
v_smfmac_f32_32x32x32_bf16 v[48:63],v[104:107],v[160:167],v76
ds_read_b128 v[88:91],v77 offset:28672
v_exp_f32 v112,v112
v_exp_f32 v113,v113
v_exp_f32 v114,v114
v_mfma_f32_32x32x16_bf16 v[128:143],v[80:83],a[72:75],0
ds_read_b128 v[92:95],v77 offset:29696
v_exp_f32 v115,v115
v_exp_f32 v116,v116
v_exp_f32 v117,v117
v_smfmac_f32_16x16x64_bf16 v[68:71],v[72:75],v[160:167],v76
v_exp_f32 v118,v118
v_mfma_f32_32x32x16_bf16 v[128:143],v[84:87],a[76:79],v[128:143]
v_exp_f32 v119,v119
v_exp_f32 v120,v120
v_exp_f32 v121,v121
v_smfmac_f32_32x32x32_bf16 v[48:63],v[108:111],v[168:175],v76
v_exp_f32 v122,v122
v_exp_f32 v123,v123
v_exp_f32 v124,v124
v_smfmac_f32_16x16x64_bf16 v[68:71],v[72:75],v[168:175],v76
s_waitcnt lgkmcnt(0)
v_exp_f32 v125,v125
v_exp_f32 v126,v126
v_exp_f32 v127,v127
v_smfmac_f32_32x32x32_bf16 v[32:47],v[96:99],v[112:119],v76
ds_read_b128 v[104:107],v77 offset:30720
v_exp_f32 v128,v128
v_exp_f32 v129,v129
v_exp_f32 v130,v130
v_mfma_f32_32x32x16_bf16 v[144:159],v[88:91],a[64:67],0
ds_read_b128 v[108:111],v77 offset:31744
v_exp_f32 v131,v131
v_exp_f32 v132,v132
v_exp_f32 v133,v133
v_smfmac_f32_16x16x64_bf16 v[64:67],v[72:75],v[112:119],v76
v_exp_f32 v134,v134
v_mfma_f32_32x32x16_bf16 v[144:159],v[92:95],a[68:71],v[144:159]
v_exp_f32 v135,v135
v_exp_f32 v136,v136
v_exp_f32 v137,v137
v_smfmac_f32_32x32x32_bf16 v[32:47],v[100:103],v[120:127],v76
v_exp_f32 v138,v138
v_exp_f32 v139,v139
v_exp_f32 v140,v140
v_smfmac_f32_16x16x64_bf16 v[64:67],v[72:75],v[120:127],v76
v_exp_f32 v141,v141
v_exp_f32 v142,v142
v_exp_f32 v143,v143
v_smfmac_f32_32x32x32_bf16 v[48:63],v[96:99],v[128:135],v76
s_waitcnt vmcnt(32) lgkmcnt(0)
s_barrier
v_exp_f32 v144,v144
v_exp_f32 v145,v145
v_exp_f32 v146,v146
v_mfma_f32_32x32x16_bf16 v[160:175],v[88:91],a[72:75],0
ds_read_b128 v[80:83],v77
v_exp_f32 v147,v147
v_exp_f32 v148,v148
v_exp_f32 v149,v149
v_smfmac_f32_16x16x64_bf16 v[68:71],v[72:75],v[128:135],v76
ds_read_b128 v[84:87],v77 offset:1024
v_exp_f32 v150,v150
v_mfma_f32_32x32x16_bf16 v[160:175],v[92:95],a[76:79],v[160:175]
v_exp_f32 v151,v151
v_exp_f32 v152,v152
v_exp_f32 v153,v153
v_smfmac_f32_32x32x32_bf16 v[48:63],v[100:103],v[136:143],v76
v_exp_f32 v154,v154
v_exp_f32 v155,v155
v_exp_f32 v156,v156
v_smfmac_f32_16x16x64_bf16 v[68:71],v[72:75],v[136:143],v76
s_waitcnt lgkmcnt(0)
v_exp_f32 v157,v157
v_exp_f32 v158,v158
v_exp_f32 v159,v159
v_smfmac_f32_32x32x32_bf16 v[32:47],v[104:107],v[144:151],v76
ds_read_b128 v[96:99],v77 offset:2048
v_exp_f32 v160,v160
v_exp_f32 v161,v161
v_exp_f32 v162,v162
v_mfma_f32_32x32x16_bf16 v[112:127],v[80:83],a[64:67],0
ds_read_b128 v[100:103],v77 offset:3072
v_exp_f32 v163,v163
v_exp_f32 v164,v164
v_exp_f32 v165,v165
v_smfmac_f32_16x16x64_bf16 v[64:67],v[72:75],v[144:151],v76
v_exp_f32 v166,v166
v_mfma_f32_32x32x16_bf16 v[112:127],v[84:87],a[68:71],v[112:127]
v_exp_f32 v167,v167
v_exp_f32 v168,v168
v_exp_f32 v169,v169
v_smfmac_f32_32x32x32_bf16 v[32:47],v[108:111],v[152:159],v76
v_exp_f32 v170,v170
v_exp_f32 v171,v171
v_exp_f32 v172,v172
v_smfmac_f32_16x16x64_bf16 v[64:67],v[72:75],v[152:159],v76
v_exp_f32 v173,v173
v_exp_f32 v174,v174
v_exp_f32 v175,v175
v_mfma_f32_16x16x32_bf16 a[0:3],v[176:179],v[208:211],a[0:3]
ds_read_b64_tr_b16 v[192:193],v18 offset:24576
ds_read_b64_tr_b16 v[194:195],v18 offset:28672
v_mfma_f32_16x16x32_bf16 a[4:7],v[180:183],v[208:211],a[4:7]
s_add_u32 m0,s4,49152
v_mfma_f32_16x16x32_bf16 a[16:19],v[176:179],v[212:215],a[16:19]
ds_read_b128 v[224:227],v16 offset:8192
ds_read_b64_tr_b16 v[196:197],v20 offset:24576
buffer_load_dwordx4 v244,s[12:15],s26 offen lds
v_mfma_f32_16x16x32_bf16 a[20:23],v[180:183],v[212:215],a[20:23]
buffer_load_dwordx4 v245,s[12:15],s26 offen offset:1024 lds
v_mfma_f32_16x16x32_bf16 a[8:11],v[184:187],v[208:211],a[8:11]
ds_read_b64_tr_b16 v[198:199],v20 offset:28672
ds_read_b128 v[228:231],v16 offset:8448
v_mfma_f32_16x16x32_bf16 a[24:27],v[184:187],v[212:215],a[24:27]
buffer_load_dwordx4 v246,s[12:15],s26 offen offset:2048 lds
v_mfma_f32_16x16x32_bf16 a[32:35],v[176:179],v[216:219],a[32:35]
ds_read_b64_tr_b16 v[200:201],v22 offset:24576
ds_read_b64_tr_b16 v[202:203],v22 offset:28672
buffer_load_dwordx4 v247,s[12:15],s26 offen offset:3072 lds
v_mfma_f32_16x16x32_bf16 a[36:39],v[180:183],v[216:219],a[36:39]
s_add_u32 s26,s26,s74
v_mfma_f32_16x16x32_bf16 a[40:43],v[184:187],v[216:219],a[40:43]
ds_read_b128 v[232:235],v16 offset:9216
ds_read_b64_tr_b16 v[204:205],v24 offset:24576
v_mfma_f32_16x16x32_bf16 a[12:15],v[188:191],v[208:211],a[12:15]
s_add_u32 m0,s69,155648
v_mfma_f32_16x16x32_bf16 a[28:31],v[188:191],v[212:215],a[28:31]
ds_read_b64_tr_b16 v[206:207],v24 offset:28672
ds_read_b128 v[236:239],v16 offset:9472
buffer_load_dwordx4 v9,s[64:67],s68 offen sc1 lds
v_mfma_f32_16x16x32_bf16 a[44:47],v[188:191],v[216:219],a[44:47]
buffer_load_dwordx4 v9,s[64:67],s68 offen offset:1024 sc1 lds
v_mfma_f32_16x16x32_bf16 a[48:51],v[176:179],v[220:223],a[48:51]
v_mfma_f32_16x16x32_bf16 a[52:55],v[180:183],v[220:223],a[52:55]
s_add_u32 s68,s68,8192
v_mfma_f32_16x16x32_bf16 a[56:59],v[184:187],v[220:223],a[56:59]
s_cmp_lg_u32 s31,0
s_cbranch_scc1 L_pg8
v_mov_b32 v10,9
s_mov_b64 exec,1
buffer_store_dword v10,v242,s[20:23],0 offen sc1
s_mov_b64 exec,-1
L_pg8:
v_mfma_f32_16x16x32_bf16 a[60:63],v[188:191],v[220:223],a[60:63]
s_waitcnt lgkmcnt(6)
v_mfma_f32_16x16x32_bf16 a[0:3],v[192:195],v[224:227],a[0:3]
s_waitcnt vmcnt(26) lgkmcnt(0)
s_barrier
v_mfma_f32_16x16x32_bf16 a[4:7],v[196:199],v[224:227],a[4:7]
ds_read_b64_tr_b16 v[176:177],v18 offset:49152
ds_read_b64_tr_b16 v[178:179],v18 offset:53248
v_mfma_f32_16x16x32_bf16 a[16:19],v[192:195],v[228:231],a[16:19]
s_add_u32 m0,s29,0
v_mfma_f32_16x16x32_bf16 a[20:23],v[196:199],v[228:231],a[20:23]
ds_read_b128 v[208:211],v16 offset:32768
ds_read_b64_tr_b16 v[180:181],v20 offset:49152
v_mfma_f32_16x16x32_bf16 a[8:11],v[200:203],v[224:227],a[8:11]
buffer_load_dwordx4 v9,s[8:11],s24 offen sc1 lds
v_mfma_f32_16x16x32_bf16 a[24:27],v[200:203],v[228:231],a[24:27]
ds_read_b64_tr_b16 v[182:183],v20 offset:53248
ds_read_b128 v[212:215],v16 offset:33024
v_mfma_f32_16x16x32_bf16 a[32:35],v[192:195],v[232:235],a[32:35]
buffer_load_dwordx4 v9,s[8:11],s24 offen offset:1024 sc1 lds
v_mfma_f32_16x16x32_bf16 a[36:39],v[196:199],v[232:235],a[36:39]
ds_read_b64_tr_b16 v[184:185],v22 offset:49152
ds_read_b64_tr_b16 v[186:187],v22 offset:53248
v_mfma_f32_16x16x32_bf16 a[40:43],v[200:203],v[232:235],a[40:43]
buffer_load_dwordx4 v9,s[8:11],s24 offen offset:2048 sc1 lds
v_mfma_f32_16x16x32_bf16 a[12:15],v[204:207],v[224:227],a[12:15]
ds_read_b128 v[216:219],v16 offset:33792
ds_read_b64_tr_b16 v[188:189],v24 offset:49152
v_mfma_f32_16x16x32_bf16 a[28:31],v[204:207],v[228:231],a[28:31]
buffer_load_dwordx4 v9,s[8:11],s24 offen offset:3072 sc1 lds
v_mfma_f32_16x16x32_bf16 a[44:47],v[204:207],v[232:235],a[44:47]
ds_read_b64_tr_b16 v[190:191],v24 offset:53248
ds_read_b128 v[220:223],v16 offset:34048
v_mfma_f32_16x16x32_bf16 a[48:51],v[192:195],v[236:239],a[48:51]
s_add_u32 s24,s24,s32
v_mfma_f32_16x16x32_bf16 a[52:55],v[196:199],v[236:239],a[52:55]
v_mfma_f32_16x16x32_bf16 a[56:59],v[200:203],v[236:239],a[56:59]
v_mfma_f32_16x16x32_bf16 a[60:63],v[204:207],v[236:239],a[60:63]
v_smfmac_f32_32x32x32_bf16 v[48:63],v[104:107],v[160:167],v76
ds_read_b128 v[88:91],v77 offset:4096
v_exp_f32 v112,v112
v_exp_f32 v113,v113
v_exp_f32 v114,v114
v_mfma_f32_32x32x16_bf16 v[128:143],v[80:83],a[72:75],0
ds_read_b128 v[92:95],v77 offset:5120
v_exp_f32 v115,v115
v_exp_f32 v116,v116
v_exp_f32 v117,v117
v_smfmac_f32_16x16x64_bf16 v[68:71],v[72:75],v[160:167],v76
v_exp_f32 v118,v118
v_mfma_f32_32x32x16_bf16 v[128:143],v[84:87],a[76:79],v[128:143]
v_exp_f32 v119,v119
v_exp_f32 v120,v120
v_exp_f32 v121,v121
v_smfmac_f32_32x32x32_bf16 v[48:63],v[108:111],v[168:175],v76
v_exp_f32 v122,v122
v_exp_f32 v123,v123
v_exp_f32 v124,v124
v_smfmac_f32_16x16x64_bf16 v[68:71],v[72:75],v[168:175],v76
s_waitcnt lgkmcnt(0)
v_exp_f32 v125,v125
v_exp_f32 v126,v126
v_exp_f32 v127,v127
v_smfmac_f32_32x32x32_bf16 v[32:47],v[96:99],v[112:119],v76
ds_read_b128 v[104:107],v77 offset:6144
v_exp_f32 v128,v128
v_exp_f32 v129,v129
v_exp_f32 v130,v130
v_mfma_f32_32x32x16_bf16 v[144:159],v[88:91],a[64:67],0
ds_read_b128 v[108:111],v77 offset:7168
v_exp_f32 v131,v131
v_exp_f32 v132,v132
v_exp_f32 v133,v133
v_smfmac_f32_16x16x64_bf16 v[64:67],v[72:75],v[112:119],v76
v_exp_f32 v134,v134
v_mfma_f32_32x32x16_bf16 v[144:159],v[92:95],a[68:71],v[144:159]
v_exp_f32 v135,v135
v_exp_f32 v136,v136
v_exp_f32 v137,v137
v_smfmac_f32_32x32x32_bf16 v[32:47],v[100:103],v[120:127],v76
v_exp_f32 v138,v138
v_exp_f32 v139,v139
v_exp_f32 v140,v140
v_smfmac_f32_16x16x64_bf16 v[64:67],v[72:75],v[120:127],v76
v_exp_f32 v141,v141
v_exp_f32 v142,v142
v_exp_f32 v143,v143
v_smfmac_f32_32x32x32_bf16 v[48:63],v[96:99],v[128:135],v76
s_waitcnt vmcnt(28) lgkmcnt(0)
s_barrier
v_exp_f32 v144,v144
v_exp_f32 v145,v145
v_exp_f32 v146,v146
v_mfma_f32_32x32x16_bf16 v[160:175],v[88:91],a[72:75],0
ds_read_b128 v[80:83],v77 offset:8192
v_exp_f32 v147,v147
v_exp_f32 v148,v148
v_exp_f32 v149,v149
v_smfmac_f32_16x16x64_bf16 v[68:71],v[72:75],v[128:135],v76
ds_read_b128 v[84:87],v77 offset:9216
v_exp_f32 v150,v150
v_mfma_f32_32x32x16_bf16 v[160:175],v[92:95],a[76:79],v[160:175]
v_exp_f32 v151,v151
v_exp_f32 v152,v152
v_exp_f32 v153,v153
v_smfmac_f32_32x32x32_bf16 v[48:63],v[100:103],v[136:143],v76
v_exp_f32 v154,v154
v_exp_f32 v155,v155
v_exp_f32 v156,v156
v_smfmac_f32_16x16x64_bf16 v[68:71],v[72:75],v[136:143],v76
s_waitcnt lgkmcnt(0)
v_exp_f32 v157,v157
v_exp_f32 v158,v158
v_exp_f32 v159,v159
v_smfmac_f32_32x32x32_bf16 v[32:47],v[104:107],v[144:151],v76
ds_read_b128 v[96:99],v77 offset:10240
v_exp_f32 v160,v160
v_exp_f32 v161,v161
v_exp_f32 v162,v162
v_mfma_f32_32x32x16_bf16 v[112:127],v[80:83],a[64:67],0
ds_read_b128 v[100:103],v77 offset:11264
v_exp_f32 v163,v163
v_exp_f32 v164,v164
v_exp_f32 v165,v165
v_smfmac_f32_16x16x64_bf16 v[64:67],v[72:75],v[144:151],v76
v_exp_f32 v166,v166
v_mfma_f32_32x32x16_bf16 v[112:127],v[84:87],a[68:71],v[112:127]
v_exp_f32 v167,v167
v_exp_f32 v168,v168
v_exp_f32 v169,v169
v_smfmac_f32_32x32x32_bf16 v[32:47],v[108:111],v[152:159],v76
v_exp_f32 v170,v170
v_exp_f32 v171,v171
v_exp_f32 v172,v172
v_smfmac_f32_16x16x64_bf16 v[64:67],v[72:75],v[152:159],v76
v_exp_f32 v173,v173
v_exp_f32 v174,v174
v_exp_f32 v175,v175
v_mfma_f32_16x16x32_bf16 a[0:3],v[176:179],v[208:211],a[0:3]
ds_read_b64_tr_b16 v[192:193],v18 offset:57344
ds_read_b64_tr_b16 v[194:195],v18 offset:61440
v_mfma_f32_16x16x32_bf16 a[4:7],v[180:183],v[208:211],a[4:7]
s_add_u32 m0,s29,16384
v_mfma_f32_16x16x32_bf16 a[16:19],v[176:179],v[212:215],a[16:19]
ds_read_b128 v[224:227],v16 offset:40960
ds_read_b64_tr_b16 v[196:197],v20 offset:57344
v_mfma_f32_16x16x32_bf16 a[20:23],v[180:183],v[212:215],a[20:23]
buffer_load_dwordx4 v244,s[12:15],s26 offen lds
v_mfma_f32_16x16x32_bf16 a[8:11],v[184:187],v[208:211],a[8:11]
ds_read_b64_tr_b16 v[198:199],v20 offset:61440
ds_read_b128 v[228:231],v16 offset:41216
v_mfma_f32_16x16x32_bf16 a[24:27],v[184:187],v[212:215],a[24:27]
buffer_load_dwordx4 v245,s[12:15],s26 offen offset:1024 lds
v_mfma_f32_16x16x32_bf16 a[32:35],v[176:179],v[216:219],a[32:35]
ds_read_b64_tr_b16 v[200:201],v22 offset:57344
ds_read_b64_tr_b16 v[202:203],v22 offset:61440
v_mfma_f32_16x16x32_bf16 a[36:39],v[180:183],v[216:219],a[36:39]
buffer_load_dwordx4 v246,s[12:15],s26 offen offset:2048 lds
v_mfma_f32_16x16x32_bf16 a[40:43],v[184:187],v[216:219],a[40:43]
ds_read_b128 v[232:235],v16 offset:41984
ds_read_b64_tr_b16 v[204:205],v24 offset:57344
v_mfma_f32_16x16x32_bf16 a[12:15],v[188:191],v[208:211],a[12:15]
buffer_load_dwordx4 v247,s[12:15],s26 offen offset:3072 lds
v_mfma_f32_16x16x32_bf16 a[28:31],v[188:191],v[212:215],a[28:31]
ds_read_b64_tr_b16 v[206:207],v24 offset:61440
ds_read_b128 v[236:239],v16 offset:42240
v_mfma_f32_16x16x32_bf16 a[44:47],v[188:191],v[216:219],a[44:47]
s_add_u32 s26,s26,s74
v_mfma_f32_16x16x32_bf16 a[48:51],v[176:179],v[220:223],a[48:51]
v_mfma_f32_16x16x32_bf16 a[52:55],v[180:183],v[220:223],a[52:55]
v_add_u32 v241,4,v243
buffer_load_dword v240,v241,s[20:23],0 offen sc1
v_mfma_f32_16x16x32_bf16 a[56:59],v[184:187],v[220:223],a[56:59]
v_mfma_f32_16x16x32_bf16 a[60:63],v[188:191],v[220:223],a[60:63]
s_waitcnt lgkmcnt(6)
v_mfma_f32_16x16x32_bf16 a[0:3],v[192:195],v[224:227],a[0:3]
s_waitcnt vmcnt(21) lgkmcnt(0)
s_barrier
v_mfma_f32_16x16x32_bf16 a[4:7],v[196:199],v[224:227],a[4:7]
ds_read_b64_tr_b16 v[176:177],v19 offset:16384
ds_read_b64_tr_b16 v[178:179],v19 offset:20480
v_mfma_f32_16x16x32_bf16 a[16:19],v[192:195],v[228:231],a[16:19]
s_add_u32 m0,s29,32768
v_mfma_f32_16x16x32_bf16 a[20:23],v[196:199],v[228:231],a[20:23]
ds_read_b128 v[208:211],v17
ds_read_b64_tr_b16 v[180:181],v21 offset:16384
v_mfma_f32_16x16x32_bf16 a[8:11],v[200:203],v[224:227],a[8:11]
buffer_load_dwordx4 v9,s[8:11],s24 offen sc1 lds
v_mfma_f32_16x16x32_bf16 a[24:27],v[200:203],v[228:231],a[24:27]
ds_read_b64_tr_b16 v[182:183],v21 offset:20480
ds_read_b128 v[212:215],v17 offset:256
v_mfma_f32_16x16x32_bf16 a[32:35],v[192:195],v[232:235],a[32:35]
buffer_load_dwordx4 v9,s[8:11],s24 offen offset:1024 sc1 lds
v_mfma_f32_16x16x32_bf16 a[36:39],v[196:199],v[232:235],a[36:39]
ds_read_b64_tr_b16 v[184:185],v23 offset:16384
ds_read_b64_tr_b16 v[186:187],v23 offset:20480
v_mfma_f32_16x16x32_bf16 a[40:43],v[200:203],v[232:235],a[40:43]
buffer_load_dwordx4 v9,s[8:11],s24 offen offset:2048 sc1 lds
v_mfma_f32_16x16x32_bf16 a[12:15],v[204:207],v[224:227],a[12:15]
ds_read_b128 v[216:219],v17 offset:1024
ds_read_b64_tr_b16 v[188:189],v25 offset:16384
v_mfma_f32_16x16x32_bf16 a[28:31],v[204:207],v[228:231],a[28:31]
buffer_load_dwordx4 v9,s[8:11],s24 offen offset:3072 sc1 lds
v_mfma_f32_16x16x32_bf16 a[44:47],v[204:207],v[232:235],a[44:47]
ds_read_b64_tr_b16 v[190:191],v25 offset:20480
ds_read_b128 v[220:223],v17 offset:1280
v_mfma_f32_16x16x32_bf16 a[48:51],v[192:195],v[236:239],a[48:51]
s_add_u32 s24,s24,s32
v_mfma_f32_16x16x32_bf16 a[52:55],v[196:199],v[236:239],a[52:55]
v_mfma_f32_16x16x32_bf16 a[56:59],v[200:203],v[236:239],a[56:59]
v_mfma_f32_16x16x32_bf16 a[60:63],v[204:207],v[236:239],a[60:63]
v_smfmac_f32_32x32x32_bf16 v[48:63],v[104:107],v[160:167],v76
ds_read_b128 v[88:91],v77 offset:12288
v_exp_f32 v112,v112
v_exp_f32 v113,v113
v_exp_f32 v114,v114
v_mfma_f32_32x32x16_bf16 v[128:143],v[80:83],a[72:75],0
ds_read_b128 v[92:95],v77 offset:13312
v_exp_f32 v115,v115
v_exp_f32 v116,v116
v_exp_f32 v117,v117
v_smfmac_f32_16x16x64_bf16 v[68:71],v[72:75],v[160:167],v76
v_exp_f32 v118,v118
v_mfma_f32_32x32x16_bf16 v[128:143],v[84:87],a[76:79],v[128:143]
v_exp_f32 v119,v119
v_exp_f32 v120,v120
v_exp_f32 v121,v121
v_smfmac_f32_32x32x32_bf16 v[48:63],v[108:111],v[168:175],v76
v_exp_f32 v122,v122
v_exp_f32 v123,v123
v_exp_f32 v124,v124
v_smfmac_f32_16x16x64_bf16 v[68:71],v[72:75],v[168:175],v76
s_waitcnt lgkmcnt(0)
v_exp_f32 v125,v125
v_exp_f32 v126,v126
v_exp_f32 v127,v127
v_smfmac_f32_32x32x32_bf16 v[32:47],v[96:99],v[112:119],v76
ds_read_b128 v[104:107],v77 offset:14336
v_exp_f32 v128,v128
v_exp_f32 v129,v129
v_exp_f32 v130,v130
v_mfma_f32_32x32x16_bf16 v[144:159],v[88:91],a[64:67],0
ds_read_b128 v[108:111],v77 offset:15360
v_exp_f32 v131,v131
v_exp_f32 v132,v132
v_exp_f32 v133,v133
v_smfmac_f32_16x16x64_bf16 v[64:67],v[72:75],v[112:119],v76
v_exp_f32 v134,v134
v_mfma_f32_32x32x16_bf16 v[144:159],v[92:95],a[68:71],v[144:159]
v_exp_f32 v135,v135
v_exp_f32 v136,v136
v_exp_f32 v137,v137
v_smfmac_f32_32x32x32_bf16 v[32:47],v[100:103],v[120:127],v76
v_exp_f32 v138,v138
v_exp_f32 v139,v139
v_exp_f32 v140,v140
v_smfmac_f32_16x16x64_bf16 v[64:67],v[72:75],v[120:127],v76
v_exp_f32 v141,v141
v_exp_f32 v142,v142
v_exp_f32 v143,v143
v_smfmac_f32_32x32x32_bf16 v[48:63],v[96:99],v[128:135],v76
s_waitcnt vmcnt(23) lgkmcnt(0)
s_barrier
v_exp_f32 v144,v144
v_exp_f32 v145,v145
v_exp_f32 v146,v146
v_mfma_f32_32x32x16_bf16 v[160:175],v[88:91],a[72:75],0
ds_read_b128 v[80:83],v77 offset:16384
v_exp_f32 v147,v147
v_exp_f32 v148,v148
v_exp_f32 v149,v149
v_smfmac_f32_16x16x64_bf16 v[68:71],v[72:75],v[128:135],v76
ds_read_b128 v[84:87],v77 offset:17408
v_exp_f32 v150,v150
v_mfma_f32_32x32x16_bf16 v[160:175],v[92:95],a[76:79],v[160:175]
v_exp_f32 v151,v151
v_exp_f32 v152,v152
v_exp_f32 v153,v153
v_smfmac_f32_32x32x32_bf16 v[48:63],v[100:103],v[136:143],v76
v_exp_f32 v154,v154
v_exp_f32 v155,v155
v_exp_f32 v156,v156
v_smfmac_f32_16x16x64_bf16 v[68:71],v[72:75],v[136:143],v76
s_waitcnt lgkmcnt(0)
v_exp_f32 v157,v157
v_exp_f32 v158,v158
v_exp_f32 v159,v159
v_smfmac_f32_32x32x32_bf16 v[32:47],v[104:107],v[144:151],v76
ds_read_b128 v[96:99],v77 offset:18432
v_exp_f32 v160,v160
v_exp_f32 v161,v161
v_exp_f32 v162,v162
v_mfma_f32_32x32x16_bf16 v[112:127],v[80:83],a[64:67],0
ds_read_b128 v[100:103],v77 offset:19456
v_exp_f32 v163,v163
v_exp_f32 v164,v164
v_exp_f32 v165,v165
v_smfmac_f32_16x16x64_bf16 v[64:67],v[72:75],v[144:151],v76
v_exp_f32 v166,v166
v_mfma_f32_32x32x16_bf16 v[112:127],v[84:87],a[68:71],v[112:127]
v_exp_f32 v167,v167
v_exp_f32 v168,v168
v_exp_f32 v169,v169
v_smfmac_f32_32x32x32_bf16 v[32:47],v[108:111],v[152:159],v76
v_exp_f32 v170,v170
v_exp_f32 v171,v171
v_exp_f32 v172,v172
v_smfmac_f32_16x16x64_bf16 v[64:67],v[72:75],v[152:159],v76
v_exp_f32 v173,v173
v_exp_f32 v174,v174
v_exp_f32 v175,v175
v_mfma_f32_16x16x32_bf16 a[0:3],v[176:179],v[208:211],a[0:3]
ds_read_b64_tr_b16 v[192:193],v19 offset:24576
ds_read_b64_tr_b16 v[194:195],v19 offset:28672
v_mfma_f32_16x16x32_bf16 a[4:7],v[180:183],v[208:211],a[4:7]
s_add_u32 m0,s29,49152
v_mfma_f32_16x16x32_bf16 a[16:19],v[176:179],v[212:215],a[16:19]
ds_read_b128 v[224:227],v17 offset:8192
ds_read_b64_tr_b16 v[196:197],v21 offset:24576
v_mfma_f32_16x16x32_bf16 a[20:23],v[180:183],v[212:215],a[20:23]
buffer_load_dwordx4 v244,s[12:15],s26 offen lds
v_mfma_f32_16x16x32_bf16 a[8:11],v[184:187],v[208:211],a[8:11]
ds_read_b64_tr_b16 v[198:199],v21 offset:28672
ds_read_b128 v[228:231],v17 offset:8448
v_mfma_f32_16x16x32_bf16 a[24:27],v[184:187],v[212:215],a[24:27]
buffer_load_dwordx4 v245,s[12:15],s26 offen offset:1024 lds
v_mfma_f32_16x16x32_bf16 a[32:35],v[176:179],v[216:219],a[32:35]
ds_read_b64_tr_b16 v[200:201],v23 offset:24576
ds_read_b64_tr_b16 v[202:203],v23 offset:28672
v_mfma_f32_16x16x32_bf16 a[36:39],v[180:183],v[216:219],a[36:39]
buffer_load_dwordx4 v246,s[12:15],s26 offen offset:2048 lds
v_mfma_f32_16x16x32_bf16 a[40:43],v[184:187],v[216:219],a[40:43]
ds_read_b128 v[232:235],v17 offset:9216
ds_read_b64_tr_b16 v[204:205],v25 offset:24576
v_mfma_f32_16x16x32_bf16 a[12:15],v[188:191],v[208:211],a[12:15]
buffer_load_dwordx4 v247,s[12:15],s26 offen offset:3072 lds
v_mfma_f32_16x16x32_bf16 a[28:31],v[188:191],v[212:215],a[28:31]
ds_read_b64_tr_b16 v[206:207],v25 offset:28672
ds_read_b128 v[236:239],v17 offset:9472
v_mfma_f32_16x16x32_bf16 a[44:47],v[188:191],v[216:219],a[44:47]
s_add_u32 s26,s26,s74
v_mfma_f32_16x16x32_bf16 a[48:51],v[176:179],v[220:223],a[48:51]
v_mfma_f32_16x16x32_bf16 a[52:55],v[180:183],v[220:223],a[52:55]
v_mfma_f32_16x16x32_bf16 a[56:59],v[184:187],v[220:223],a[56:59]
v_mfma_f32_16x16x32_bf16 a[60:63],v[188:191],v[220:223],a[60:63]
s_waitcnt lgkmcnt(6)
v_mfma_f32_16x16x32_bf16 a[0:3],v[192:195],v[224:227],a[0:3]
s_waitcnt vmcnt(19) lgkmcnt(0)
s_barrier
v_mfma_f32_16x16x32_bf16 a[4:7],v[196:199],v[224:227],a[4:7]
ds_read_b64_tr_b16 v[176:177],v19 offset:49152
ds_read_b64_tr_b16 v[178:179],v19 offset:53248
v_mfma_f32_16x16x32_bf16 a[16:19],v[192:195],v[228:231],a[16:19]
s_add_u32 m0,s4,0
v_mfma_f32_16x16x32_bf16 a[20:23],v[196:199],v[228:231],a[20:23]
ds_read_b128 v[208:211],v17 offset:32768
ds_read_b64_tr_b16 v[180:181],v21 offset:49152
v_mfma_f32_16x16x32_bf16 a[8:11],v[200:203],v[224:227],a[8:11]
buffer_load_dwordx4 v9,s[8:11],s24 offen sc1 lds
v_mfma_f32_16x16x32_bf16 a[24:27],v[200:203],v[228:231],a[24:27]
ds_read_b64_tr_b16 v[182:183],v21 offset:53248
ds_read_b128 v[212:215],v17 offset:33024
v_mfma_f32_16x16x32_bf16 a[32:35],v[192:195],v[232:235],a[32:35]
buffer_load_dwordx4 v9,s[8:11],s24 offen offset:1024 sc1 lds
v_mfma_f32_16x16x32_bf16 a[36:39],v[196:199],v[232:235],a[36:39]
ds_read_b64_tr_b16 v[184:185],v23 offset:49152
ds_read_b64_tr_b16 v[186:187],v23 offset:53248
v_mfma_f32_16x16x32_bf16 a[40:43],v[200:203],v[232:235],a[40:43]
buffer_load_dwordx4 v9,s[8:11],s24 offen offset:2048 sc1 lds
v_mfma_f32_16x16x32_bf16 a[12:15],v[204:207],v[224:227],a[12:15]
ds_read_b128 v[216:219],v17 offset:33792
ds_read_b64_tr_b16 v[188:189],v25 offset:49152
v_mfma_f32_16x16x32_bf16 a[28:31],v[204:207],v[228:231],a[28:31]
buffer_load_dwordx4 v9,s[8:11],s24 offen offset:3072 sc1 lds
v_mfma_f32_16x16x32_bf16 a[44:47],v[204:207],v[232:235],a[44:47]
ds_read_b64_tr_b16 v[190:191],v25 offset:53248
ds_read_b128 v[220:223],v17 offset:34048
v_mfma_f32_16x16x32_bf16 a[48:51],v[192:195],v[236:239],a[48:51]
s_add_u32 s24,s24,s32
v_mfma_f32_16x16x32_bf16 a[52:55],v[196:199],v[236:239],a[52:55]
v_mfma_f32_16x16x32_bf16 a[56:59],v[200:203],v[236:239],a[56:59]
v_mfma_f32_16x16x32_bf16 a[60:63],v[204:207],v[236:239],a[60:63]
v_smfmac_f32_32x32x32_bf16 v[48:63],v[104:107],v[160:167],v76
ds_read_b128 v[88:91],v77 offset:20480
v_exp_f32 v112,v112
v_exp_f32 v113,v113
v_exp_f32 v114,v114
v_mfma_f32_32x32x16_bf16 v[128:143],v[80:83],a[72:75],0
ds_read_b128 v[92:95],v77 offset:21504
v_exp_f32 v115,v115
v_exp_f32 v116,v116
v_exp_f32 v117,v117
v_smfmac_f32_16x16x64_bf16 v[68:71],v[72:75],v[160:167],v76
v_exp_f32 v118,v118
v_mfma_f32_32x32x16_bf16 v[128:143],v[84:87],a[76:79],v[128:143]
v_exp_f32 v119,v119
v_exp_f32 v120,v120
v_exp_f32 v121,v121
v_smfmac_f32_32x32x32_bf16 v[48:63],v[108:111],v[168:175],v76
v_exp_f32 v122,v122
v_exp_f32 v123,v123
v_exp_f32 v124,v124
v_smfmac_f32_16x16x64_bf16 v[68:71],v[72:75],v[168:175],v76
s_waitcnt lgkmcnt(0)
v_exp_f32 v125,v125
v_exp_f32 v126,v126
v_exp_f32 v127,v127
v_smfmac_f32_32x32x32_bf16 v[32:47],v[96:99],v[112:119],v76
ds_read_b128 v[104:107],v77 offset:22528
v_exp_f32 v128,v128
v_exp_f32 v129,v129
v_exp_f32 v130,v130
v_mfma_f32_32x32x16_bf16 v[144:159],v[88:91],a[64:67],0
ds_read_b128 v[108:111],v77 offset:23552
v_exp_f32 v131,v131
v_exp_f32 v132,v132
v_exp_f32 v133,v133
v_smfmac_f32_16x16x64_bf16 v[64:67],v[72:75],v[112:119],v76
v_exp_f32 v134,v134
v_mfma_f32_32x32x16_bf16 v[144:159],v[92:95],a[68:71],v[144:159]
v_exp_f32 v135,v135
v_exp_f32 v136,v136
v_exp_f32 v137,v137
v_smfmac_f32_32x32x32_bf16 v[32:47],v[100:103],v[120:127],v76
v_exp_f32 v138,v138
v_exp_f32 v139,v139
v_exp_f32 v140,v140
v_smfmac_f32_16x16x64_bf16 v[64:67],v[72:75],v[120:127],v76
v_exp_f32 v141,v141
v_exp_f32 v142,v142
v_exp_f32 v143,v143
v_smfmac_f32_32x32x32_bf16 v[48:63],v[96:99],v[128:135],v76
s_waitcnt vmcnt(21) lgkmcnt(0)
s_barrier
v_exp_f32 v144,v144
v_exp_f32 v145,v145
v_exp_f32 v146,v146
v_mfma_f32_32x32x16_bf16 v[160:175],v[88:91],a[72:75],0
ds_read_b128 v[80:83],v77 offset:24576
v_exp_f32 v147,v147
v_exp_f32 v148,v148
v_exp_f32 v149,v149
v_smfmac_f32_16x16x64_bf16 v[68:71],v[72:75],v[128:135],v76
ds_read_b128 v[84:87],v77 offset:25600
v_exp_f32 v150,v150
v_mfma_f32_32x32x16_bf16 v[160:175],v[92:95],a[76:79],v[160:175]
v_exp_f32 v151,v151
v_exp_f32 v152,v152
v_exp_f32 v153,v153
v_smfmac_f32_32x32x32_bf16 v[48:63],v[100:103],v[136:143],v76
v_exp_f32 v154,v154
v_exp_f32 v155,v155
v_exp_f32 v156,v156
v_smfmac_f32_16x16x64_bf16 v[68:71],v[72:75],v[136:143],v76
s_waitcnt lgkmcnt(0)
v_exp_f32 v157,v157
v_exp_f32 v158,v158
v_exp_f32 v159,v159
v_smfmac_f32_32x32x32_bf16 v[32:47],v[104:107],v[144:151],v76
ds_read_b128 v[96:99],v77 offset:26624
v_exp_f32 v160,v160
v_exp_f32 v161,v161
v_exp_f32 v162,v162
v_mfma_f32_32x32x16_bf16 v[112:127],v[80:83],a[64:67],0
ds_read_b128 v[100:103],v77 offset:27648
v_exp_f32 v163,v163
v_exp_f32 v164,v164
v_exp_f32 v165,v165
v_smfmac_f32_16x16x64_bf16 v[64:67],v[72:75],v[144:151],v76
v_exp_f32 v166,v166
v_mfma_f32_32x32x16_bf16 v[112:127],v[84:87],a[68:71],v[112:127]
v_exp_f32 v167,v167
v_exp_f32 v168,v168
v_exp_f32 v169,v169
v_smfmac_f32_32x32x32_bf16 v[32:47],v[108:111],v[152:159],v76
v_exp_f32 v170,v170
v_exp_f32 v171,v171
v_exp_f32 v172,v172
v_smfmac_f32_16x16x64_bf16 v[64:67],v[72:75],v[152:159],v76
v_exp_f32 v173,v173
v_exp_f32 v174,v174
v_exp_f32 v175,v175
v_mfma_f32_16x16x32_bf16 a[0:3],v[176:179],v[208:211],a[0:3]
ds_read_b64_tr_b16 v[192:193],v19 offset:57344
ds_read_b64_tr_b16 v[194:195],v19 offset:61440
v_mfma_f32_16x16x32_bf16 a[4:7],v[180:183],v[208:211],a[4:7]
s_add_u32 m0,s4,16384
v_mfma_f32_16x16x32_bf16 a[16:19],v[176:179],v[212:215],a[16:19]
ds_read_b128 v[224:227],v17 offset:40960
ds_read_b64_tr_b16 v[196:197],v21 offset:57344
v_mfma_f32_16x16x32_bf16 a[20:23],v[180:183],v[212:215],a[20:23]
buffer_load_dwordx4 v244,s[12:15],s26 offen lds
v_mfma_f32_16x16x32_bf16 a[8:11],v[184:187],v[208:211],a[8:11]
ds_read_b64_tr_b16 v[198:199],v21 offset:61440
ds_read_b128 v[228:231],v17 offset:41216
v_mfma_f32_16x16x32_bf16 a[24:27],v[184:187],v[212:215],a[24:27]
buffer_load_dwordx4 v245,s[12:15],s26 offen offset:1024 lds
v_mfma_f32_16x16x32_bf16 a[32:35],v[176:179],v[216:219],a[32:35]
ds_read_b64_tr_b16 v[200:201],v23 offset:57344
ds_read_b64_tr_b16 v[202:203],v23 offset:61440
v_mfma_f32_16x16x32_bf16 a[36:39],v[180:183],v[216:219],a[36:39]
buffer_load_dwordx4 v246,s[12:15],s26 offen offset:2048 lds
v_mfma_f32_16x16x32_bf16 a[40:43],v[184:187],v[216:219],a[40:43]
ds_read_b128 v[232:235],v17 offset:41984
ds_read_b64_tr_b16 v[204:205],v25 offset:57344
v_mfma_f32_16x16x32_bf16 a[12:15],v[188:191],v[208:211],a[12:15]
buffer_load_dwordx4 v247,s[12:15],s26 offen offset:3072 lds
v_mfma_f32_16x16x32_bf16 a[28:31],v[188:191],v[212:215],a[28:31]
ds_read_b64_tr_b16 v[206:207],v25 offset:61440
ds_read_b128 v[236:239],v17 offset:42240
v_mfma_f32_16x16x32_bf16 a[44:47],v[188:191],v[216:219],a[44:47]
s_add_u32 s26,s26,s74
v_mfma_f32_16x16x32_bf16 a[48:51],v[176:179],v[220:223],a[48:51]
v_mfma_f32_16x16x32_bf16 a[52:55],v[180:183],v[220:223],a[52:55]
s_waitcnt vmcnt(16)
s_mov_b32 s75,0x40000
L_pt_chk:
v_cmp_ne_u32 vcc,0,v240
s_sub_u32 s75,s75,1
s_cbranch_scc1 L_pt_ok
s_nop 1
s_cmp_eq_u64 vcc,-1
s_cbranch_scc1 L_pt_ok
s_sleep 4
buffer_load_dword v240,v241,s[20:23],0 offen sc1
s_waitcnt vmcnt(0)
s_branch L_pt_chk
L_pt_ok:
s_nop 0
v_readfirstlane_b32 s3,v240
s_nop 3
s_sub_u32 s3,s3,1
s_min_u32 s3,s3,8
v_mfma_f32_16x16x32_bf16 a[56:59],v[184:187],v[220:223],a[56:59]
v_mfma_f32_16x16x32_bf16 a[60:63],v[188:191],v[220:223],a[60:63]
s_waitcnt lgkmcnt(6)
v_mfma_f32_16x16x32_bf16 a[0:3],v[192:195],v[224:227],a[0:3]
s_waitcnt lgkmcnt(0)
s_barrier
v_mfma_f32_16x16x32_bf16 a[4:7],v[196:199],v[224:227],a[4:7]
ds_read_b64_tr_b16 v[176:177],v18 offset:16384
ds_read_b64_tr_b16 v[178:179],v18 offset:20480
v_mfma_f32_16x16x32_bf16 a[16:19],v[192:195],v[228:231],a[16:19]
s_add_u32 m0,s4,32768
v_mfma_f32_16x16x32_bf16 a[20:23],v[196:199],v[228:231],a[20:23]
ds_read_b128 v[208:211],v16
ds_read_b64_tr_b16 v[180:181],v20 offset:16384
v_mfma_f32_16x16x32_bf16 a[8:11],v[200:203],v[224:227],a[8:11]
buffer_load_dwordx4 v9,s[8:11],s24 offen sc1 lds
v_mfma_f32_16x16x32_bf16 a[24:27],v[200:203],v[228:231],a[24:27]
ds_read_b64_tr_b16 v[182:183],v20 offset:20480
ds_read_b128 v[212:215],v16 offset:256
v_mfma_f32_16x16x32_bf16 a[32:35],v[192:195],v[232:235],a[32:35]
buffer_load_dwordx4 v9,s[8:11],s24 offen offset:1024 sc1 lds
v_mfma_f32_16x16x32_bf16 a[36:39],v[196:199],v[232:235],a[36:39]
ds_read_b64_tr_b16 v[184:185],v22 offset:16384
ds_read_b64_tr_b16 v[186:187],v22 offset:20480
v_mfma_f32_16x16x32_bf16 a[40:43],v[200:203],v[232:235],a[40:43]
buffer_load_dwordx4 v9,s[8:11],s24 offen offset:2048 sc1 lds
v_mfma_f32_16x16x32_bf16 a[12:15],v[204:207],v[224:227],a[12:15]
ds_read_b128 v[216:219],v16 offset:1024
ds_read_b64_tr_b16 v[188:189],v24 offset:16384
v_mfma_f32_16x16x32_bf16 a[28:31],v[204:207],v[228:231],a[28:31]
buffer_load_dwordx4 v9,s[8:11],s24 offen offset:3072 sc1 lds
v_mfma_f32_16x16x32_bf16 a[44:47],v[204:207],v[232:235],a[44:47]
ds_read_b64_tr_b16 v[190:191],v24 offset:20480
ds_read_b128 v[220:223],v16 offset:1280
v_mfma_f32_16x16x32_bf16 a[48:51],v[192:195],v[236:239],a[48:51]
s_add_u32 s24,s24,s32
v_mfma_f32_16x16x32_bf16 a[52:55],v[196:199],v[236:239],a[52:55]
v_mfma_f32_16x16x32_bf16 a[56:59],v[200:203],v[236:239],a[56:59]
v_mfma_f32_16x16x32_bf16 a[60:63],v[204:207],v[236:239],a[60:63]
v_smfmac_f32_32x32x32_bf16 v[48:63],v[104:107],v[160:167],v76
ds_read_b128 v[88:91],v77 offset:28672
v_exp_f32 v112,v112
v_exp_f32 v113,v113
v_exp_f32 v114,v114
v_mfma_f32_32x32x16_bf16 v[128:143],v[80:83],a[72:75],0
ds_read_b128 v[92:95],v77 offset:29696
v_exp_f32 v115,v115
v_exp_f32 v116,v116
v_exp_f32 v117,v117
v_smfmac_f32_16x16x64_bf16 v[68:71],v[72:75],v[160:167],v76
v_exp_f32 v118,v118
v_mfma_f32_32x32x16_bf16 v[128:143],v[84:87],a[76:79],v[128:143]
v_exp_f32 v119,v119
v_exp_f32 v120,v120
v_exp_f32 v121,v121
v_smfmac_f32_32x32x32_bf16 v[48:63],v[108:111],v[168:175],v76
v_exp_f32 v122,v122
v_exp_f32 v123,v123
v_exp_f32 v124,v124
v_smfmac_f32_16x16x64_bf16 v[68:71],v[72:75],v[168:175],v76
s_waitcnt lgkmcnt(0)
v_exp_f32 v125,v125
v_exp_f32 v126,v126
v_exp_f32 v127,v127
v_smfmac_f32_32x32x32_bf16 v[32:47],v[96:99],v[112:119],v76
ds_read_b128 v[104:107],v77 offset:30720
v_exp_f32 v128,v128
v_exp_f32 v129,v129
v_exp_f32 v130,v130
v_mfma_f32_32x32x16_bf16 v[144:159],v[88:91],a[64:67],0
ds_read_b128 v[108:111],v77 offset:31744
v_exp_f32 v131,v131
v_exp_f32 v132,v132
v_exp_f32 v133,v133
v_smfmac_f32_16x16x64_bf16 v[64:67],v[72:75],v[112:119],v76
v_exp_f32 v134,v134
v_mfma_f32_32x32x16_bf16 v[144:159],v[92:95],a[68:71],v[144:159]
v_exp_f32 v135,v135
v_exp_f32 v136,v136
v_exp_f32 v137,v137
v_smfmac_f32_32x32x32_bf16 v[32:47],v[100:103],v[120:127],v76
v_exp_f32 v138,v138
v_exp_f32 v139,v139
v_exp_f32 v140,v140
v_smfmac_f32_16x16x64_bf16 v[64:67],v[72:75],v[120:127],v76
v_exp_f32 v141,v141
v_exp_f32 v142,v142
v_exp_f32 v143,v143
v_smfmac_f32_32x32x32_bf16 v[48:63],v[96:99],v[128:135],v76
v_exp_f32 v144,v144
v_exp_f32 v145,v145
v_exp_f32 v146,v146
v_mfma_f32_32x32x16_bf16 v[160:175],v[88:91],a[72:75],0
v_exp_f32 v147,v147
v_exp_f32 v148,v148
v_exp_f32 v149,v149
v_smfmac_f32_16x16x64_bf16 v[68:71],v[72:75],v[128:135],v76
v_exp_f32 v150,v150
v_mfma_f32_32x32x16_bf16 v[160:175],v[92:95],a[76:79],v[160:175]
v_exp_f32 v151,v151
v_exp_f32 v152,v152
v_exp_f32 v153,v153
v_smfmac_f32_32x32x32_bf16 v[48:63],v[100:103],v[136:143],v76
v_exp_f32 v154,v154
v_exp_f32 v155,v155
v_exp_f32 v156,v156
v_smfmac_f32_16x16x64_bf16 v[68:71],v[72:75],v[136:143],v76
v_exp_f32 v157,v157
v_exp_f32 v158,v158
v_exp_f32 v159,v159
s_waitcnt lgkmcnt(0)
v_smfmac_f32_32x32x32_bf16 v[32:47],v[104:107],v[144:151],v76
v_exp_f32 v160,v160
v_exp_f32 v161,v161
v_exp_f32 v162,v162
v_exp_f32 v163,v163
v_exp_f32 v164,v164
v_exp_f32 v165,v165
v_smfmac_f32_16x16x64_bf16 v[64:67],v[72:75],v[144:151],v76
v_exp_f32 v166,v166
v_exp_f32 v167,v167
v_exp_f32 v168,v168
v_exp_f32 v169,v169
v_smfmac_f32_32x32x32_bf16 v[32:47],v[108:111],v[152:159],v76
v_exp_f32 v170,v170
v_exp_f32 v171,v171
v_exp_f32 v172,v172
v_smfmac_f32_16x16x64_bf16 v[64:67],v[72:75],v[152:159],v76
v_exp_f32 v173,v173
v_exp_f32 v174,v174
v_exp_f32 v175,v175
L_atfin:
v_smfmac_f32_32x32x32_bf16 v[48:63],v[104:107],v[160:167],v76
v_smfmac_f32_16x16x64_bf16 v[68:71],v[72:75],v[160:167],v76
v_smfmac_f32_32x32x32_bf16 v[48:63],v[108:111],v[168:175],v76
v_smfmac_f32_16x16x64_bf16 v[68:71],v[72:75],v[168:175],v76
s_load_dwordx2 s[72:73],s[0:1],56
s_nop 7
s_nop 3
v_pk_mul_f32 v[4:5],v[32:33],v[32:33]
v_pk_mul_f32 v[6:7],v[48:49],v[48:49]
v_pk_fma_f32 v[4:5],v[34:35],v[34:35],v[4:5]
v_pk_fma_f32 v[6:7],v[50:51],v[50:51],v[6:7]
v_pk_fma_f32 v[4:5],v[36:37],v[36:37],v[4:5]
v_pk_fma_f32 v[6:7],v[52:53],v[52:53],v[6:7]
v_pk_fma_f32 v[4:5],v[38:39],v[38:39],v[4:5]
v_pk_fma_f32 v[6:7],v[54:55],v[54:55],v[6:7]
v_pk_fma_f32 v[4:5],v[40:41],v[40:41],v[4:5]
v_pk_fma_f32 v[6:7],v[56:57],v[56:57],v[6:7]
v_pk_fma_f32 v[4:5],v[42:43],v[42:43],v[4:5]
v_pk_fma_f32 v[6:7],v[58:59],v[58:59],v[6:7]
v_pk_fma_f32 v[4:5],v[44:45],v[44:45],v[4:5]
v_pk_fma_f32 v[6:7],v[60:61],v[60:61],v[6:7]
v_pk_fma_f32 v[4:5],v[46:47],v[46:47],v[4:5]
v_pk_fma_f32 v[6:7],v[62:63],v[62:63],v[6:7]
v_add_f32 v4,v4,v5
v_add_f32 v5,v6,v7
s_mov_b32 s46,0x17800000
s_mov_b32 s47,0x71800000
s_mov_b32 s48,0x7f000000
v_cmp_le_f32 s[52:53],s46,v64
v_cmp_ge_f32 s[54:55],s47,v64
v_cmp_le_f32 s[56:57],s46,v68
v_cmp_ge_f32 s[58:59],s47,v68
v_cmp_ge_f32 s[60:61],s48,v4
v_cmp_ge_f32 s[62:63],s48,v5
s_lshr_b32 s46,s31,1
s_lshl_b32 s47,s71,1
s_add_u32 s46,s46,s47
s_mul_i32 s46,s46,1179648
s_and_b64 s[52:53],s[52:53],s[54:55]
s_and_b64 s[56:57],s[56:57],s[58:59]
s_and_b64 s[60:61],s[60:61],s[62:63]
s_and_b64 s[52:53],s[52:53],s[56:57]
s_and_b64 s[52:53],s[52:53],s[60:61]
s_cmp_eq_u64 s[52:53],-1
s_cbranch_scc0 L_fallback
L_ostore:
v_rcp_f32 v4,v64
v_rcp_f32 v6,v68
s_lshl_b32 s47,s70,13
s_add_u32 s46,s46,s47
s_and_b32 s47,s31,1
s_lshl_b32 s47,s47,11
s_add_u32 s46,s46,s47
s_add_u32 s46,s46,0x10e0000
s_add_u32 s47,s46,4096
v_pk_mul_f32 v[32:33],v[32:33],v[4:5] op_sel_hi:[1,0]
v_pk_mul_f32 v[34:35],v[34:35],v[4:5] op_sel_hi:[1,0]
v_pk_mul_f32 v[36:37],v[36:37],v[4:5] op_sel_hi:[1,0]
v_pk_mul_f32 v[38:39],v[38:39],v[4:5] op_sel_hi:[1,0]
v_pk_mul_f32 v[40:41],v[40:41],v[4:5] op_sel_hi:[1,0]
v_pk_mul_f32 v[42:43],v[42:43],v[4:5] op_sel_hi:[1,0]
v_pk_mul_f32 v[44:45],v[44:45],v[4:5] op_sel_hi:[1,0]
v_pk_mul_f32 v[46:47],v[46:47],v[4:5] op_sel_hi:[1,0]
v_cvt_pk_bf16_f32 v112,v32,v33
v_cvt_pk_bf16_f32 v113,v34,v35
v_cvt_pk_bf16_f32 v114,v36,v37
v_cvt_pk_bf16_f32 v115,v38,v39
v_cvt_pk_bf16_f32 v116,v40,v41
v_cvt_pk_bf16_f32 v117,v42,v43
v_cvt_pk_bf16_f32 v118,v44,v45
v_cvt_pk_bf16_f32 v119,v46,v47
buffer_store_dwordx4 v[112:115],v9,s[20:23],s46 offen sc1
buffer_store_dwordx4 v[116:119],v9,s[20:23],s47 offen sc1
v_pk_mul_f32 v[48:49],v[48:49],v[6:7] op_sel_hi:[1,0]
v_pk_mul_f32 v[50:51],v[50:51],v[6:7] op_sel_hi:[1,0]
v_pk_mul_f32 v[52:53],v[52:53],v[6:7] op_sel_hi:[1,0]
v_pk_mul_f32 v[54:55],v[54:55],v[6:7] op_sel_hi:[1,0]
v_pk_mul_f32 v[56:57],v[56:57],v[6:7] op_sel_hi:[1,0]
v_pk_mul_f32 v[58:59],v[58:59],v[6:7] op_sel_hi:[1,0]
v_pk_mul_f32 v[60:61],v[60:61],v[6:7] op_sel_hi:[1,0]
v_pk_mul_f32 v[62:63],v[62:63],v[6:7] op_sel_hi:[1,0]
v_cvt_pk_bf16_f32 v120,v48,v49
v_cvt_pk_bf16_f32 v121,v50,v51
v_cvt_pk_bf16_f32 v122,v52,v53
v_cvt_pk_bf16_f32 v123,v54,v55
v_cvt_pk_bf16_f32 v124,v56,v57
v_cvt_pk_bf16_f32 v125,v58,v59
v_cvt_pk_bf16_f32 v126,v60,v61
v_cvt_pk_bf16_f32 v127,v62,v63
buffer_store_dwordx4 v[120:123],v9,s[20:23],s46 offen offset:1024 sc1
buffer_store_dwordx4 v[124:127],v9,s[20:23],s47 offen offset:1024 sc1
s_waitcnt lgkmcnt(0)
s_mov_b32 s56,s72
s_and_b32 s57,s73,0xffff
s_mov_b32 s58,0x400000
s_mov_b32 s59,0x00020000
s_lshl_b32 s48,s41,7
s_lshl_b32 s49,s40,6
s_add_u32 s48,s48,s49
s_lshl_b32 s48,s48,11
s_lshl_b32 s49,s42,8
s_add_u32 s48,s48,s49
s_lshl_b32 s49,s45,7
s_add_u32 s48,s48,s49
s_add_u32 s49,s48,0x8000
v_mfma_f32_16x16x32_bf16 a[0:3],v[176:179],v[208:211],a[0:3]
ds_read_b64_tr_b16 v[192:193],v18 offset:24576
ds_read_b64_tr_b16 v[194:195],v18 offset:28672
v_mfma_f32_16x16x32_bf16 a[4:7],v[180:183],v[208:211],a[4:7]
s_add_u32 m0,s4,49152
s_nop 0
buffer_load_dwordx4 v244,s[12:15],s26 offen lds
v_mfma_f32_16x16x32_bf16 a[16:19],v[176:179],v[212:215],a[16:19]
ds_read_b128 v[224:227],v16 offset:8192
ds_read_b64_tr_b16 v[196:197],v20 offset:24576
buffer_load_dwordx4 v245,s[12:15],s26 offen offset:1024 lds
v_mfma_f32_16x16x32_bf16 a[20:23],v[180:183],v[212:215],a[20:23]
buffer_load_dwordx4 v246,s[12:15],s26 offen offset:2048 lds
v_mfma_f32_16x16x32_bf16 a[8:11],v[184:187],v[208:211],a[8:11]
ds_read_b64_tr_b16 v[198:199],v20 offset:28672
ds_read_b128 v[228:231],v16 offset:8448
buffer_load_dwordx4 v247,s[12:15],s26 offen offset:3072 lds
v_mfma_f32_16x16x32_bf16 a[24:27],v[184:187],v[212:215],a[24:27]
s_add_u32 s26,s26,s74
v_mfma_f32_16x16x32_bf16 a[32:35],v[176:179],v[216:219],a[32:35]
ds_read_b64_tr_b16 v[200:201],v22 offset:24576
ds_read_b64_tr_b16 v[202:203],v22 offset:28672
s_mov_b32 s51,0xffff0000
v_accvgpr_read_b32 v48,a80
v_mfma_f32_16x16x32_bf16 a[36:39],v[180:183],v[216:219],a[36:39]
v_lshlrev_b32 v80,16,v48
v_mfma_f32_16x16x32_bf16 a[40:43],v[184:187],v[216:219],a[40:43]
ds_read_b128 v[232:235],v16 offset:9216
ds_read_b64_tr_b16 v[204:205],v24 offset:24576
v_and_b32 v81,s51,v48
v_mfma_f32_16x16x32_bf16 a[12:15],v[188:191],v[208:211],a[12:15]
v_accvgpr_read_b32 v49,a81
v_mfma_f32_16x16x32_bf16 a[28:31],v[188:191],v[212:215],a[28:31]
ds_read_b64_tr_b16 v[206:207],v24 offset:28672
ds_read_b128 v[236:239],v16 offset:9472
v_lshlrev_b32 v82,16,v49
v_mfma_f32_16x16x32_bf16 a[44:47],v[188:191],v[216:219],a[44:47]
v_and_b32 v83,s51,v49
v_accvgpr_read_b32 v48,a82
v_mfma_f32_16x16x32_bf16 a[48:51],v[176:179],v[220:223],a[48:51]
v_lshlrev_b32 v84,16,v48
v_mfma_f32_16x16x32_bf16 a[52:55],v[180:183],v[220:223],a[52:55]
v_and_b32 v85,s51,v48
v_mfma_f32_16x16x32_bf16 a[56:59],v[184:187],v[220:223],a[56:59]
v_accvgpr_read_b32 v49,a83
v_mfma_f32_16x16x32_bf16 a[60:63],v[188:191],v[220:223],a[60:63]
v_lshlrev_b32 v86,16,v49
s_waitcnt lgkmcnt(6)
v_mfma_f32_16x16x32_bf16 a[0:3],v[192:195],v[224:227],a[0:3]
s_waitcnt vmcnt(20) lgkmcnt(0)
s_barrier
v_mfma_f32_16x16x32_bf16 a[4:7],v[196:199],v[224:227],a[4:7]
ds_read_b64_tr_b16 v[176:177],v18 offset:49152
ds_read_b64_tr_b16 v[178:179],v18 offset:53248
s_add_u32 m0,s29,0
s_nop 0
buffer_load_dwordx4 v9,s[8:11],s24 offen sc1 lds
v_mfma_f32_16x16x32_bf16 a[16:19],v[192:195],v[228:231],a[16:19]
buffer_load_dwordx4 v9,s[8:11],s24 offen offset:1024 sc1 lds
v_mfma_f32_16x16x32_bf16 a[20:23],v[196:199],v[228:231],a[20:23]
ds_read_b128 v[208:211],v16 offset:32768
ds_read_b64_tr_b16 v[180:181],v20 offset:49152
buffer_load_dwordx4 v9,s[8:11],s24 offen offset:2048 sc1 lds
v_mfma_f32_16x16x32_bf16 a[8:11],v[200:203],v[224:227],a[8:11]
buffer_load_dwordx4 v9,s[8:11],s24 offen offset:3072 sc1 lds
s_add_u32 s24,s24,s32
v_mfma_f32_16x16x32_bf16 a[24:27],v[200:203],v[228:231],a[24:27]
ds_read_b64_tr_b16 v[182:183],v20 offset:53248
ds_read_b128 v[212:215],v16 offset:33024
v_and_b32 v87,s51,v49
v_mfma_f32_16x16x32_bf16 a[32:35],v[192:195],v[232:235],a[32:35]
v_accvgpr_read_b32 v48,a84
v_mfma_f32_16x16x32_bf16 a[36:39],v[196:199],v[232:235],a[36:39]
ds_read_b64_tr_b16 v[184:185],v22 offset:49152
ds_read_b64_tr_b16 v[186:187],v22 offset:53248
v_lshlrev_b32 v88,16,v48
v_mfma_f32_16x16x32_bf16 a[40:43],v[200:203],v[232:235],a[40:43]
v_and_b32 v89,s51,v48
v_accvgpr_read_b32 v49,a85
v_mfma_f32_16x16x32_bf16 a[12:15],v[204:207],v[224:227],a[12:15]
ds_read_b128 v[216:219],v16 offset:33792
ds_read_b64_tr_b16 v[188:189],v24 offset:49152
v_lshlrev_b32 v90,16,v49
v_mfma_f32_16x16x32_bf16 a[28:31],v[204:207],v[228:231],a[28:31]
v_and_b32 v91,s51,v49
v_mfma_f32_16x16x32_bf16 a[44:47],v[204:207],v[232:235],a[44:47]
ds_read_b64_tr_b16 v[190:191],v24 offset:53248
ds_read_b128 v[220:223],v16 offset:34048
v_accvgpr_read_b32 v48,a86
v_mfma_f32_16x16x32_bf16 a[48:51],v[192:195],v[236:239],a[48:51]
v_lshlrev_b32 v92,16,v48
v_and_b32 v93,s51,v48
v_mfma_f32_16x16x32_bf16 a[52:55],v[196:199],v[236:239],a[52:55]
v_accvgpr_read_b32 v49,a87
v_mfma_f32_16x16x32_bf16 a[56:59],v[200:203],v[236:239],a[56:59]
v_lshlrev_b32 v94,16,v49
v_mfma_f32_16x16x32_bf16 a[60:63],v[204:207],v[236:239],a[60:63]
v_and_b32 v95,s51,v49
s_waitcnt lgkmcnt(6)
v_mfma_f32_16x16x32_bf16 a[0:3],v[176:179],v[208:211],a[0:3]
ds_read_b64_tr_b16 v[192:193],v18 offset:57344
ds_read_b64_tr_b16 v[194:195],v18 offset:61440
v_mfma_f32_16x16x32_bf16 a[4:7],v[180:183],v[208:211],a[4:7]
s_add_u32 m0,s29,16384
s_nop 0
buffer_load_dwordx4 v244,s[12:15],s26 offen lds
v_mfma_f32_16x16x32_bf16 a[16:19],v[176:179],v[212:215],a[16:19]
ds_read_b128 v[224:227],v16 offset:40960
ds_read_b64_tr_b16 v[196:197],v20 offset:57344
buffer_load_dwordx4 v245,s[12:15],s26 offen offset:1024 lds
v_mfma_f32_16x16x32_bf16 a[20:23],v[180:183],v[212:215],a[20:23]
buffer_load_dwordx4 v246,s[12:15],s26 offen offset:2048 lds
s_waitcnt lgkmcnt(4)
v_mfma_f32_16x16x32_bf16 a[8:11],v[184:187],v[208:211],a[8:11]
ds_read_b64_tr_b16 v[198:199],v20 offset:61440
ds_read_b128 v[228:231],v16 offset:41216
buffer_load_dwordx4 v247,s[12:15],s26 offen offset:3072 lds
v_mfma_f32_16x16x32_bf16 a[24:27],v[184:187],v[212:215],a[24:27]
s_add_u32 s26,s26,s74
v_mfma_f32_16x16x32_bf16 a[32:35],v[176:179],v[216:219],a[32:35]
ds_read_b64_tr_b16 v[200:201],v22 offset:57344
ds_read_b64_tr_b16 v[202:203],v22 offset:61440
v_accvgpr_read_b32 v48,a88
v_lshlrev_b32 v96,16,v48
v_mfma_f32_16x16x32_bf16 a[36:39],v[180:183],v[216:219],a[36:39]
v_and_b32 v97,s51,v48
v_mfma_f32_16x16x32_bf16 a[40:43],v[184:187],v[216:219],a[40:43]
ds_read_b128 v[232:235],v16 offset:41984
ds_read_b64_tr_b16 v[204:205],v24 offset:57344
v_accvgpr_read_b32 v49,a89
v_mfma_f32_16x16x32_bf16 a[12:15],v[188:191],v[208:211],a[12:15]
v_lshlrev_b32 v98,16,v49
v_mfma_f32_16x16x32_bf16 a[28:31],v[188:191],v[212:215],a[28:31]
ds_read_b64_tr_b16 v[206:207],v24 offset:61440
ds_read_b128 v[236:239],v16 offset:42240
v_and_b32 v99,s51,v49
v_mfma_f32_16x16x32_bf16 a[44:47],v[188:191],v[216:219],a[44:47]
v_accvgpr_read_b32 v48,a90
v_lshlrev_b32 v100,16,v48
v_mfma_f32_16x16x32_bf16 a[48:51],v[176:179],v[220:223],a[48:51]
v_and_b32 v101,s51,v48
v_mfma_f32_16x16x32_bf16 a[52:55],v[180:183],v[220:223],a[52:55]
v_accvgpr_read_b32 v49,a91
v_mfma_f32_16x16x32_bf16 a[56:59],v[184:187],v[220:223],a[56:59]
v_lshlrev_b32 v102,16,v49
v_mfma_f32_16x16x32_bf16 a[60:63],v[188:191],v[220:223],a[60:63]
v_and_b32 v103,s51,v49
s_waitcnt lgkmcnt(6)
v_mfma_f32_16x16x32_bf16 a[0:3],v[192:195],v[224:227],a[0:3]
s_waitcnt vmcnt(20) lgkmcnt(0)
s_barrier
v_mfma_f32_16x16x32_bf16 a[4:7],v[196:199],v[224:227],a[4:7]
ds_read_b64_tr_b16 v[176:177],v19 offset:16384
ds_read_b64_tr_b16 v[178:179],v19 offset:20480
s_add_u32 m0,s29,32768
s_nop 0
buffer_load_dwordx4 v9,s[8:11],s24 offen sc1 lds
v_mfma_f32_16x16x32_bf16 a[16:19],v[192:195],v[228:231],a[16:19]
buffer_load_dwordx4 v9,s[8:11],s24 offen offset:1024 sc1 lds
v_mfma_f32_16x16x32_bf16 a[20:23],v[196:199],v[228:231],a[20:23]
ds_read_b128 v[208:211],v17
ds_read_b64_tr_b16 v[180:181],v21 offset:16384
buffer_load_dwordx4 v9,s[8:11],s24 offen offset:2048 sc1 lds
v_mfma_f32_16x16x32_bf16 a[8:11],v[200:203],v[224:227],a[8:11]
buffer_load_dwordx4 v9,s[8:11],s24 offen offset:3072 sc1 lds
v_mfma_f32_16x16x32_bf16 a[24:27],v[200:203],v[228:231],a[24:27]
ds_read_b64_tr_b16 v[182:183],v21 offset:20480
ds_read_b128 v[212:215],v17 offset:256
s_add_u32 s24,s24,s32
v_mfma_f32_16x16x32_bf16 a[32:35],v[192:195],v[232:235],a[32:35]
v_accvgpr_read_b32 v48,a92
v_lshlrev_b32 v104,16,v48
v_mfma_f32_16x16x32_bf16 a[36:39],v[196:199],v[232:235],a[36:39]
ds_read_b64_tr_b16 v[184:185],v23 offset:16384
ds_read_b64_tr_b16 v[186:187],v23 offset:20480
v_and_b32 v105,s51,v48
v_mfma_f32_16x16x32_bf16 a[40:43],v[200:203],v[232:235],a[40:43]
v_accvgpr_read_b32 v49,a93
v_mfma_f32_16x16x32_bf16 a[12:15],v[204:207],v[224:227],a[12:15]
ds_read_b128 v[216:219],v17 offset:1024
ds_read_b64_tr_b16 v[188:189],v25 offset:16384
v_lshlrev_b32 v106,16,v49
v_mfma_f32_16x16x32_bf16 a[28:31],v[204:207],v[228:231],a[28:31]
v_and_b32 v107,s51,v49
v_mfma_f32_16x16x32_bf16 a[44:47],v[204:207],v[232:235],a[44:47]
ds_read_b64_tr_b16 v[190:191],v25 offset:20480
ds_read_b128 v[220:223],v17 offset:1280
v_accvgpr_read_b32 v48,a94
v_lshlrev_b32 v108,16,v48
v_mfma_f32_16x16x32_bf16 a[48:51],v[192:195],v[236:239],a[48:51]
v_and_b32 v109,s51,v48
v_mfma_f32_16x16x32_bf16 a[52:55],v[196:199],v[236:239],a[52:55]
v_accvgpr_read_b32 v49,a95
v_mfma_f32_16x16x32_bf16 a[56:59],v[200:203],v[236:239],a[56:59]
v_lshlrev_b32 v110,16,v49
v_mfma_f32_16x16x32_bf16 a[60:63],v[204:207],v[236:239],a[60:63]
v_and_b32 v111,s51,v49
s_waitcnt lgkmcnt(6)
v_mfma_f32_16x16x32_bf16 a[0:3],v[176:179],v[208:211],a[0:3]
ds_read_b64_tr_b16 v[192:193],v19 offset:24576
ds_read_b64_tr_b16 v[194:195],v19 offset:28672
v_mfma_f32_16x16x32_bf16 a[4:7],v[180:183],v[208:211],a[4:7]
s_add_u32 m0,s29,49152
v_mfma_f32_16x16x32_bf16 a[16:19],v[176:179],v[212:215],a[16:19]
ds_read_b128 v[224:227],v17 offset:8192
ds_read_b64_tr_b16 v[196:197],v21 offset:24576
v_mfma_f32_16x16x32_bf16 a[20:23],v[180:183],v[212:215],a[20:23]
buffer_load_dwordx4 v244,s[12:15],s26 offen lds
s_waitcnt lgkmcnt(4)
v_mfma_f32_16x16x32_bf16 a[8:11],v[184:187],v[208:211],a[8:11]
ds_read_b64_tr_b16 v[198:199],v21 offset:28672
ds_read_b128 v[228:231],v17 offset:8448
v_mfma_f32_16x16x32_bf16 a[24:27],v[184:187],v[212:215],a[24:27]
buffer_load_dwordx4 v245,s[12:15],s26 offen offset:1024 lds
v_mfma_f32_16x16x32_bf16 a[32:35],v[176:179],v[216:219],a[32:35]
ds_read_b64_tr_b16 v[200:201],v23 offset:24576
ds_read_b64_tr_b16 v[202:203],v23 offset:28672
v_mfma_f32_16x16x32_bf16 a[36:39],v[180:183],v[216:219],a[36:39]
buffer_load_dwordx4 v246,s[12:15],s26 offen offset:2048 lds
v_mfma_f32_16x16x32_bf16 a[40:43],v[184:187],v[216:219],a[40:43]
ds_read_b128 v[232:235],v17 offset:9216
ds_read_b64_tr_b16 v[204:205],v25 offset:24576
v_mfma_f32_16x16x32_bf16 a[12:15],v[188:191],v[208:211],a[12:15]
buffer_load_dwordx4 v247,s[12:15],s26 offen offset:3072 lds
v_mfma_f32_16x16x32_bf16 a[28:31],v[188:191],v[212:215],a[28:31]
ds_read_b64_tr_b16 v[206:207],v25 offset:28672
ds_read_b128 v[236:239],v17 offset:9472
v_mfma_f32_16x16x32_bf16 a[44:47],v[188:191],v[216:219],a[44:47]
s_add_u32 s26,s26,s74
v_mfma_f32_16x16x32_bf16 a[48:51],v[176:179],v[220:223],a[48:51]
v_mfma_f32_16x16x32_bf16 a[52:55],v[180:183],v[220:223],a[52:55]
v_mfma_f32_16x16x32_bf16 a[56:59],v[184:187],v[220:223],a[56:59]
v_mfma_f32_16x16x32_bf16 a[60:63],v[188:191],v[220:223],a[60:63]
s_waitcnt lgkmcnt(6)
v_mfma_f32_16x16x32_bf16 a[0:3],v[192:195],v[224:227],a[0:3]
s_waitcnt vmcnt(16) lgkmcnt(0)
s_barrier
s_lshl_b32 s62,s71,7
s_lshl_b32 s63,s70,2
s_add_u32 s62,s62,s63
s_add_u32 s62,s62,0x2701400
s_cmp_lg_u32 s31,0
s_cbranch_scc1 L_fo
v_mov_b32 v10,1
v_mov_b32 v11,0
s_mov_b64 exec,1
buffer_store_dword v10,v11,s[20:23],s62 offen sc1
s_mov_b64 exec,-1
L_fo:
v_mfma_f32_16x16x32_bf16 a[4:7],v[196:199],v[224:227],a[4:7]
ds_read_b64_tr_b16 v[176:177],v19 offset:49152
ds_read_b64_tr_b16 v[178:179],v19 offset:53248
v_mfma_f32_16x16x32_bf16 a[16:19],v[192:195],v[228:231],a[16:19]
s_add_u32 m0,s4,0
v_mfma_f32_16x16x32_bf16 a[20:23],v[196:199],v[228:231],a[20:23]
ds_read_b128 v[208:211],v17 offset:32768
ds_read_b64_tr_b16 v[180:181],v21 offset:49152
v_mfma_f32_16x16x32_bf16 a[8:11],v[200:203],v[224:227],a[8:11]
buffer_load_dwordx4 v9,s[8:11],s24 offen sc1 lds
v_mfma_f32_16x16x32_bf16 a[24:27],v[200:203],v[228:231],a[24:27]
ds_read_b64_tr_b16 v[182:183],v21 offset:53248
ds_read_b128 v[212:215],v17 offset:33024
v_mfma_f32_16x16x32_bf16 a[32:35],v[192:195],v[232:235],a[32:35]
buffer_load_dwordx4 v9,s[8:11],s24 offen offset:1024 sc1 lds
v_mfma_f32_16x16x32_bf16 a[36:39],v[196:199],v[232:235],a[36:39]
ds_read_b64_tr_b16 v[184:185],v23 offset:49152
ds_read_b64_tr_b16 v[186:187],v23 offset:53248
v_mfma_f32_16x16x32_bf16 a[40:43],v[200:203],v[232:235],a[40:43]
buffer_load_dwordx4 v9,s[8:11],s24 offen offset:2048 sc1 lds
v_mfma_f32_16x16x32_bf16 a[12:15],v[204:207],v[224:227],a[12:15]
ds_read_b128 v[216:219],v17 offset:33792
ds_read_b64_tr_b16 v[188:189],v25 offset:49152
v_mfma_f32_16x16x32_bf16 a[28:31],v[204:207],v[228:231],a[28:31]
buffer_load_dwordx4 v9,s[8:11],s24 offen offset:3072 sc1 lds
v_mfma_f32_16x16x32_bf16 a[44:47],v[204:207],v[232:235],a[44:47]
ds_read_b64_tr_b16 v[190:191],v25 offset:53248
ds_read_b128 v[220:223],v17 offset:34048
v_mfma_f32_16x16x32_bf16 a[48:51],v[192:195],v[236:239],a[48:51]
s_add_u32 s24,s24,s32
v_mfma_f32_16x16x32_bf16 a[52:55],v[196:199],v[236:239],a[52:55]
v_mfma_f32_16x16x32_bf16 a[56:59],v[200:203],v[236:239],a[56:59]
v_mfma_f32_16x16x32_bf16 a[60:63],v[204:207],v[236:239],a[60:63]
s_cmp_lg_u32 s3,0
s_cbranch_scc1 L_dnbody
s_xor_b32 s29,s29,0x10000
s_xor_b32 s4,s4,0x10000
s_xor_b32 s30,s30,0x10000
s_xor_b32 s5,s5,0x10000
s_xor_b32 s33,s33,0x10000
s_xor_b32 s36,s36,0x10000
v_swap_b32 v16,v17
v_swap_b32 v18,v19
v_swap_b32 v20,v21
v_swap_b32 v22,v23
v_swap_b32 v24,v25
v_swap_b32 v26,v27
s_branch L_skip
.p2align 6
L_dnloop:
s_xor_b32 s29,s29,0x10000
s_xor_b32 s4,s4,0x10000
s_xor_b32 s30,s30,0x10000
s_xor_b32 s5,s5,0x10000
s_xor_b32 s33,s33,0x10000
s_xor_b32 s36,s36,0x10000
v_swap_b32 v16,v17
v_swap_b32 v18,v19
v_swap_b32 v20,v21
v_swap_b32 v22,v23
v_swap_b32 v24,v25
v_swap_b32 v26,v27
L_dnbody:
s_waitcnt lgkmcnt(6)
v_mfma_f32_16x16x32_bf16 a[0:3],v[176:179],v[208:211],a[0:3]
ds_read_b64_tr_b16 v[192:193],v19 offset:57344
ds_read_b64_tr_b16 v[194:195],v19 offset:61440
v_mfma_f32_16x16x32_bf16 a[4:7],v[180:183],v[208:211],a[4:7]
s_add_u32 m0,s4,16384
v_mfma_f32_16x16x32_bf16 a[16:19],v[176:179],v[212:215],a[16:19]
ds_read_b128 v[224:227],v17 offset:40960
ds_read_b64_tr_b16 v[196:197],v21 offset:57344
v_mfma_f32_16x16x32_bf16 a[20:23],v[180:183],v[212:215],a[20:23]
buffer_load_dwordx4 v244,s[12:15],s26 offen lds
s_waitcnt lgkmcnt(4)
v_mfma_f32_16x16x32_bf16 a[8:11],v[184:187],v[208:211],a[8:11]
ds_read_b64_tr_b16 v[198:199],v21 offset:61440
ds_read_b128 v[228:231],v17 offset:41216
v_mfma_f32_16x16x32_bf16 a[24:27],v[184:187],v[212:215],a[24:27]
buffer_load_dwordx4 v245,s[12:15],s26 offen offset:1024 lds
v_mfma_f32_16x16x32_bf16 a[32:35],v[176:179],v[216:219],a[32:35]
ds_read_b64_tr_b16 v[200:201],v23 offset:57344
ds_read_b64_tr_b16 v[202:203],v23 offset:61440
v_mfma_f32_16x16x32_bf16 a[36:39],v[180:183],v[216:219],a[36:39]
buffer_load_dwordx4 v246,s[12:15],s26 offen offset:2048 lds
v_mfma_f32_16x16x32_bf16 a[40:43],v[184:187],v[216:219],a[40:43]
ds_read_b128 v[232:235],v17 offset:41984
ds_read_b64_tr_b16 v[204:205],v25 offset:57344
v_mfma_f32_16x16x32_bf16 a[12:15],v[188:191],v[208:211],a[12:15]
buffer_load_dwordx4 v247,s[12:15],s26 offen offset:3072 lds
v_mfma_f32_16x16x32_bf16 a[28:31],v[188:191],v[212:215],a[28:31]
ds_read_b64_tr_b16 v[206:207],v25 offset:61440
ds_read_b128 v[236:239],v17 offset:42240
v_mfma_f32_16x16x32_bf16 a[44:47],v[188:191],v[216:219],a[44:47]
s_add_u32 s26,s26,s74
v_mfma_f32_16x16x32_bf16 a[48:51],v[176:179],v[220:223],a[48:51]
v_mfma_f32_16x16x32_bf16 a[52:55],v[180:183],v[220:223],a[52:55]
v_mfma_f32_16x16x32_bf16 a[56:59],v[184:187],v[220:223],a[56:59]
v_mfma_f32_16x16x32_bf16 a[60:63],v[188:191],v[220:223],a[60:63]
s_waitcnt lgkmcnt(6)
v_mfma_f32_16x16x32_bf16 a[0:3],v[192:195],v[224:227],a[0:3]
s_waitcnt vmcnt(16) lgkmcnt(0)
s_barrier
v_mfma_f32_16x16x32_bf16 a[4:7],v[196:199],v[224:227],a[4:7]
ds_read_b64_tr_b16 v[176:177],v18 offset:16384
ds_read_b64_tr_b16 v[178:179],v18 offset:20480
v_mfma_f32_16x16x32_bf16 a[16:19],v[192:195],v[228:231],a[16:19]
s_add_u32 m0,s4,32768
v_mfma_f32_16x16x32_bf16 a[20:23],v[196:199],v[228:231],a[20:23]
ds_read_b128 v[208:211],v16
ds_read_b64_tr_b16 v[180:181],v20 offset:16384
v_mfma_f32_16x16x32_bf16 a[8:11],v[200:203],v[224:227],a[8:11]
buffer_load_dwordx4 v9,s[8:11],s24 offen sc1 lds
v_mfma_f32_16x16x32_bf16 a[24:27],v[200:203],v[228:231],a[24:27]
ds_read_b64_tr_b16 v[182:183],v20 offset:20480
ds_read_b128 v[212:215],v16 offset:256
v_mfma_f32_16x16x32_bf16 a[32:35],v[192:195],v[232:235],a[32:35]
buffer_load_dwordx4 v9,s[8:11],s24 offen offset:1024 sc1 lds
v_mfma_f32_16x16x32_bf16 a[36:39],v[196:199],v[232:235],a[36:39]
ds_read_b64_tr_b16 v[184:185],v22 offset:16384
ds_read_b64_tr_b16 v[186:187],v22 offset:20480
v_mfma_f32_16x16x32_bf16 a[40:43],v[200:203],v[232:235],a[40:43]
buffer_load_dwordx4 v9,s[8:11],s24 offen offset:2048 sc1 lds
v_mfma_f32_16x16x32_bf16 a[12:15],v[204:207],v[224:227],a[12:15]
ds_read_b128 v[216:219],v16 offset:1024
ds_read_b64_tr_b16 v[188:189],v24 offset:16384
v_mfma_f32_16x16x32_bf16 a[28:31],v[204:207],v[228:231],a[28:31]
buffer_load_dwordx4 v9,s[8:11],s24 offen offset:3072 sc1 lds
v_mfma_f32_16x16x32_bf16 a[44:47],v[204:207],v[232:235],a[44:47]
ds_read_b64_tr_b16 v[190:191],v24 offset:20480
ds_read_b128 v[220:223],v16 offset:1280
v_mfma_f32_16x16x32_bf16 a[48:51],v[192:195],v[236:239],a[48:51]
s_add_u32 s24,s24,s32
v_mfma_f32_16x16x32_bf16 a[52:55],v[196:199],v[236:239],a[52:55]
v_mfma_f32_16x16x32_bf16 a[56:59],v[200:203],v[236:239],a[56:59]
v_mfma_f32_16x16x32_bf16 a[60:63],v[204:207],v[236:239],a[60:63]
s_waitcnt lgkmcnt(6)
v_mfma_f32_16x16x32_bf16 a[0:3],v[176:179],v[208:211],a[0:3]
ds_read_b64_tr_b16 v[192:193],v18 offset:24576
ds_read_b64_tr_b16 v[194:195],v18 offset:28672
v_mfma_f32_16x16x32_bf16 a[4:7],v[180:183],v[208:211],a[4:7]
s_add_u32 m0,s4,49152
v_mfma_f32_16x16x32_bf16 a[16:19],v[176:179],v[212:215],a[16:19]
ds_read_b128 v[224:227],v16 offset:8192
ds_read_b64_tr_b16 v[196:197],v20 offset:24576
v_mfma_f32_16x16x32_bf16 a[20:23],v[180:183],v[212:215],a[20:23]
buffer_load_dwordx4 v244,s[12:15],s26 offen lds
s_waitcnt lgkmcnt(4)
v_mfma_f32_16x16x32_bf16 a[8:11],v[184:187],v[208:211],a[8:11]
ds_read_b64_tr_b16 v[198:199],v20 offset:28672
ds_read_b128 v[228:231],v16 offset:8448
v_mfma_f32_16x16x32_bf16 a[24:27],v[184:187],v[212:215],a[24:27]
buffer_load_dwordx4 v245,s[12:15],s26 offen offset:1024 lds
v_mfma_f32_16x16x32_bf16 a[32:35],v[176:179],v[216:219],a[32:35]
ds_read_b64_tr_b16 v[200:201],v22 offset:24576
ds_read_b64_tr_b16 v[202:203],v22 offset:28672
v_mfma_f32_16x16x32_bf16 a[36:39],v[180:183],v[216:219],a[36:39]
buffer_load_dwordx4 v246,s[12:15],s26 offen offset:2048 lds
v_mfma_f32_16x16x32_bf16 a[40:43],v[184:187],v[216:219],a[40:43]
ds_read_b128 v[232:235],v16 offset:9216
ds_read_b64_tr_b16 v[204:205],v24 offset:24576
v_mfma_f32_16x16x32_bf16 a[12:15],v[188:191],v[208:211],a[12:15]
buffer_load_dwordx4 v247,s[12:15],s26 offen offset:3072 lds
v_mfma_f32_16x16x32_bf16 a[28:31],v[188:191],v[212:215],a[28:31]
ds_read_b64_tr_b16 v[206:207],v24 offset:28672
ds_read_b128 v[236:239],v16 offset:9472
v_mfma_f32_16x16x32_bf16 a[44:47],v[188:191],v[216:219],a[44:47]
s_add_u32 s26,s26,s74
v_mfma_f32_16x16x32_bf16 a[48:51],v[176:179],v[220:223],a[48:51]
v_mfma_f32_16x16x32_bf16 a[52:55],v[180:183],v[220:223],a[52:55]
v_mfma_f32_16x16x32_bf16 a[56:59],v[184:187],v[220:223],a[56:59]
v_mfma_f32_16x16x32_bf16 a[60:63],v[188:191],v[220:223],a[60:63]
s_waitcnt lgkmcnt(6)
v_mfma_f32_16x16x32_bf16 a[0:3],v[192:195],v[224:227],a[0:3]
s_waitcnt vmcnt(16) lgkmcnt(0)
s_barrier
v_mfma_f32_16x16x32_bf16 a[4:7],v[196:199],v[224:227],a[4:7]
ds_read_b64_tr_b16 v[176:177],v18 offset:49152
ds_read_b64_tr_b16 v[178:179],v18 offset:53248
v_mfma_f32_16x16x32_bf16 a[16:19],v[192:195],v[228:231],a[16:19]
s_add_u32 m0,s29,0
v_mfma_f32_16x16x32_bf16 a[20:23],v[196:199],v[228:231],a[20:23]
ds_read_b128 v[208:211],v16 offset:32768
ds_read_b64_tr_b16 v[180:181],v20 offset:49152
v_mfma_f32_16x16x32_bf16 a[8:11],v[200:203],v[224:227],a[8:11]
buffer_load_dwordx4 v9,s[8:11],s24 offen sc1 lds
v_mfma_f32_16x16x32_bf16 a[24:27],v[200:203],v[228:231],a[24:27]
ds_read_b64_tr_b16 v[182:183],v20 offset:53248
ds_read_b128 v[212:215],v16 offset:33024
v_mfma_f32_16x16x32_bf16 a[32:35],v[192:195],v[232:235],a[32:35]
buffer_load_dwordx4 v9,s[8:11],s24 offen offset:1024 sc1 lds
v_mfma_f32_16x16x32_bf16 a[36:39],v[196:199],v[232:235],a[36:39]
ds_read_b64_tr_b16 v[184:185],v22 offset:49152
ds_read_b64_tr_b16 v[186:187],v22 offset:53248
v_mfma_f32_16x16x32_bf16 a[40:43],v[200:203],v[232:235],a[40:43]
buffer_load_dwordx4 v9,s[8:11],s24 offen offset:2048 sc1 lds
v_mfma_f32_16x16x32_bf16 a[12:15],v[204:207],v[224:227],a[12:15]
ds_read_b128 v[216:219],v16 offset:33792
ds_read_b64_tr_b16 v[188:189],v24 offset:49152
v_mfma_f32_16x16x32_bf16 a[28:31],v[204:207],v[228:231],a[28:31]
buffer_load_dwordx4 v9,s[8:11],s24 offen offset:3072 sc1 lds
v_mfma_f32_16x16x32_bf16 a[44:47],v[204:207],v[232:235],a[44:47]
ds_read_b64_tr_b16 v[190:191],v24 offset:53248
ds_read_b128 v[220:223],v16 offset:34048
v_mfma_f32_16x16x32_bf16 a[48:51],v[192:195],v[236:239],a[48:51]
s_add_u32 s24,s24,s32
v_mfma_f32_16x16x32_bf16 a[52:55],v[196:199],v[236:239],a[52:55]
v_mfma_f32_16x16x32_bf16 a[56:59],v[200:203],v[236:239],a[56:59]
v_mfma_f32_16x16x32_bf16 a[60:63],v[204:207],v[236:239],a[60:63]
s_sub_u32 s3,s3,1
s_cmp_lg_u32 s3,0
s_cbranch_scc1 L_dnloop
L_skip:
s_waitcnt lgkmcnt(6)
v_mfma_f32_16x16x32_bf16 a[0:3],v[176:179],v[208:211],a[0:3]
ds_read_b64_tr_b16 v[192:193],v18 offset:57344
ds_read_b64_tr_b16 v[194:195],v18 offset:61440
v_mfma_f32_16x16x32_bf16 a[4:7],v[180:183],v[208:211],a[4:7]
s_add_u32 m0,s29,16384
v_mfma_f32_16x16x32_bf16 a[16:19],v[176:179],v[212:215],a[16:19]
ds_read_b128 v[224:227],v16 offset:40960
ds_read_b64_tr_b16 v[196:197],v20 offset:57344
v_mfma_f32_16x16x32_bf16 a[20:23],v[180:183],v[212:215],a[20:23]
buffer_load_dwordx4 v244,s[12:15],s26 offen lds
s_waitcnt lgkmcnt(4)
v_mfma_f32_16x16x32_bf16 a[8:11],v[184:187],v[208:211],a[8:11]
ds_read_b64_tr_b16 v[198:199],v20 offset:61440
ds_read_b128 v[228:231],v16 offset:41216
v_mfma_f32_16x16x32_bf16 a[24:27],v[184:187],v[212:215],a[24:27]
buffer_load_dwordx4 v245,s[12:15],s26 offen offset:1024 lds
v_mfma_f32_16x16x32_bf16 a[32:35],v[176:179],v[216:219],a[32:35]
ds_read_b64_tr_b16 v[200:201],v22 offset:57344
ds_read_b64_tr_b16 v[202:203],v22 offset:61440
v_mfma_f32_16x16x32_bf16 a[36:39],v[180:183],v[216:219],a[36:39]
buffer_load_dwordx4 v246,s[12:15],s26 offen offset:2048 lds
v_mfma_f32_16x16x32_bf16 a[40:43],v[184:187],v[216:219],a[40:43]
ds_read_b128 v[232:235],v16 offset:41984
ds_read_b64_tr_b16 v[204:205],v24 offset:57344
v_mfma_f32_16x16x32_bf16 a[12:15],v[188:191],v[208:211],a[12:15]
buffer_load_dwordx4 v247,s[12:15],s26 offen offset:3072 lds
v_mfma_f32_16x16x32_bf16 a[28:31],v[188:191],v[212:215],a[28:31]
ds_read_b64_tr_b16 v[206:207],v24 offset:61440
ds_read_b128 v[236:239],v16 offset:42240
v_mfma_f32_16x16x32_bf16 a[44:47],v[188:191],v[216:219],a[44:47]
s_add_u32 s26,s26,s74
v_mfma_f32_16x16x32_bf16 a[48:51],v[176:179],v[220:223],a[48:51]
v_mfma_f32_16x16x32_bf16 a[52:55],v[180:183],v[220:223],a[52:55]
s_lshr_b32 s62,s41,1
s_lshl_b32 s62,s62,7
s_add_u32 s62,s62,0x2701400
v_and_b32 v241,31,v2
v_lshl_add_u32 v241,v241,2,s62
buffer_load_dword v240,v241,s[20:23],0 offen sc1
v_mfma_f32_16x16x32_bf16 a[56:59],v[184:187],v[220:223],a[56:59]
v_mfma_f32_16x16x32_bf16 a[60:63],v[188:191],v[220:223],a[60:63]
s_waitcnt lgkmcnt(6)
v_mfma_f32_16x16x32_bf16 a[0:3],v[192:195],v[224:227],a[0:3]
s_waitcnt vmcnt(17) lgkmcnt(0)
s_barrier
v_mfma_f32_16x16x32_bf16 a[4:7],v[196:199],v[224:227],a[4:7]
ds_read_b64_tr_b16 v[176:177],v19 offset:16384
ds_read_b64_tr_b16 v[178:179],v19 offset:20480
v_mfma_f32_16x16x32_bf16 a[16:19],v[192:195],v[228:231],a[16:19]
s_add_u32 m0,s29,32768
v_mfma_f32_16x16x32_bf16 a[20:23],v[196:199],v[228:231],a[20:23]
ds_read_b128 v[208:211],v17
ds_read_b64_tr_b16 v[180:181],v21 offset:16384
v_mfma_f32_16x16x32_bf16 a[8:11],v[200:203],v[224:227],a[8:11]
buffer_load_dwordx4 v9,s[8:11],s24 offen sc1 lds
v_mfma_f32_16x16x32_bf16 a[24:27],v[200:203],v[228:231],a[24:27]
ds_read_b64_tr_b16 v[182:183],v21 offset:20480
ds_read_b128 v[212:215],v17 offset:256
v_mfma_f32_16x16x32_bf16 a[32:35],v[192:195],v[232:235],a[32:35]
buffer_load_dwordx4 v9,s[8:11],s24 offen offset:1024 sc1 lds
v_mfma_f32_16x16x32_bf16 a[36:39],v[196:199],v[232:235],a[36:39]
ds_read_b64_tr_b16 v[184:185],v23 offset:16384
ds_read_b64_tr_b16 v[186:187],v23 offset:20480
v_mfma_f32_16x16x32_bf16 a[40:43],v[200:203],v[232:235],a[40:43]
buffer_load_dwordx4 v9,s[8:11],s24 offen offset:2048 sc1 lds
v_mfma_f32_16x16x32_bf16 a[12:15],v[204:207],v[224:227],a[12:15]
ds_read_b128 v[216:219],v17 offset:1024
ds_read_b64_tr_b16 v[188:189],v25 offset:16384
v_mfma_f32_16x16x32_bf16 a[28:31],v[204:207],v[228:231],a[28:31]
buffer_load_dwordx4 v9,s[8:11],s24 offen offset:3072 sc1 lds
v_mfma_f32_16x16x32_bf16 a[44:47],v[204:207],v[232:235],a[44:47]
ds_read_b64_tr_b16 v[190:191],v25 offset:20480
ds_read_b128 v[220:223],v17 offset:1280
v_mfma_f32_16x16x32_bf16 a[48:51],v[192:195],v[236:239],a[48:51]
s_add_u32 s24,s24,s32
v_mfma_f32_16x16x32_bf16 a[52:55],v[196:199],v[236:239],a[52:55]
v_mfma_f32_16x16x32_bf16 a[56:59],v[200:203],v[236:239],a[56:59]
v_mfma_f32_16x16x32_bf16 a[60:63],v[204:207],v[236:239],a[60:63]
s_cmp_lg_u32 s43,0
s_cbranch_scc1 L_r1
L_r0:
s_waitcnt lgkmcnt(6)
v_mfma_f32_16x16x32_bf16 a[0:3],v[176:179],v[208:211],a[0:3]
ds_read_b64_tr_b16 v[192:193],v19 offset:24576
ds_read_b64_tr_b16 v[194:195],v19 offset:28672
v_mfma_f32_16x16x32_bf16 a[4:7],v[180:183],v[208:211],a[4:7]
s_add_u32 m0,s29,49152
v_mfma_f32_16x16x32_bf16 a[16:19],v[176:179],v[212:215],a[16:19]
ds_read_b128 v[224:227],v17 offset:8192
ds_read_b64_tr_b16 v[196:197],v21 offset:24576
v_mfma_f32_16x16x32_bf16 a[20:23],v[180:183],v[212:215],a[20:23]
buffer_load_dwordx4 v244,s[12:15],s26 offen lds
s_waitcnt lgkmcnt(4)
v_mfma_f32_16x16x32_bf16 a[8:11],v[184:187],v[208:211],a[8:11]
ds_read_b64_tr_b16 v[198:199],v21 offset:28672
ds_read_b128 v[228:231],v17 offset:8448
v_mfma_f32_16x16x32_bf16 a[24:27],v[184:187],v[212:215],a[24:27]
buffer_load_dwordx4 v245,s[12:15],s26 offen offset:1024 lds
v_mfma_f32_16x16x32_bf16 a[32:35],v[176:179],v[216:219],a[32:35]
ds_read_b64_tr_b16 v[200:201],v23 offset:24576
ds_read_b64_tr_b16 v[202:203],v23 offset:28672
v_mfma_f32_16x16x32_bf16 a[36:39],v[180:183],v[216:219],a[36:39]
buffer_load_dwordx4 v246,s[12:15],s26 offen offset:2048 lds
v_mfma_f32_16x16x32_bf16 a[40:43],v[184:187],v[216:219],a[40:43]
ds_read_b128 v[232:235],v17 offset:9216
ds_read_b64_tr_b16 v[204:205],v25 offset:24576
v_mfma_f32_16x16x32_bf16 a[12:15],v[188:191],v[208:211],a[12:15]
buffer_load_dwordx4 v247,s[12:15],s26 offen offset:3072 lds
v_mfma_f32_16x16x32_bf16 a[28:31],v[188:191],v[212:215],a[28:31]
ds_read_b64_tr_b16 v[206:207],v25 offset:28672
ds_read_b128 v[236:239],v17 offset:9472
v_mfma_f32_16x16x32_bf16 a[44:47],v[188:191],v[216:219],a[44:47]
s_add_u32 s26,s26,s74
v_mfma_f32_16x16x32_bf16 a[48:51],v[176:179],v[220:223],a[48:51]
v_mfma_f32_16x16x32_bf16 a[52:55],v[180:183],v[220:223],a[52:55]
v_mfma_f32_16x16x32_bf16 a[56:59],v[184:187],v[220:223],a[56:59]
v_mfma_f32_16x16x32_bf16 a[60:63],v[188:191],v[220:223],a[60:63]
s_waitcnt lgkmcnt(6)
v_mfma_f32_16x16x32_bf16 a[0:3],v[192:195],v[224:227],a[0:3]
s_waitcnt vmcnt(17) lgkmcnt(0)
s_barrier
v_mfma_f32_16x16x32_bf16 a[4:7],v[196:199],v[224:227],a[4:7]
ds_read_b64_tr_b16 v[176:177],v19 offset:49152
ds_read_b64_tr_b16 v[178:179],v19 offset:53248
v_mfma_f32_16x16x32_bf16 a[16:19],v[192:195],v[228:231],a[16:19]
s_add_u32 m0,s5,16384
v_mfma_f32_16x16x32_bf16 a[20:23],v[196:199],v[228:231],a[20:23]
ds_read_b128 v[208:211],v17 offset:32768
ds_read_b64_tr_b16 v[180:181],v21 offset:49152
v_mfma_f32_16x16x32_bf16 a[8:11],v[200:203],v[224:227],a[8:11]
buffer_load_dwordx4 v244,s[16:19],s27 offen lds
v_mfma_f32_16x16x32_bf16 a[24:27],v[200:203],v[228:231],a[24:27]
ds_read_b64_tr_b16 v[182:183],v21 offset:53248
ds_read_b128 v[212:215],v17 offset:33024
v_mfma_f32_16x16x32_bf16 a[32:35],v[192:195],v[232:235],a[32:35]
buffer_load_dwordx4 v245,s[16:19],s27 offen offset:1024 lds
v_mfma_f32_16x16x32_bf16 a[36:39],v[196:199],v[232:235],a[36:39]
ds_read_b64_tr_b16 v[184:185],v23 offset:49152
ds_read_b64_tr_b16 v[186:187],v23 offset:53248
v_mfma_f32_16x16x32_bf16 a[40:43],v[200:203],v[232:235],a[40:43]
buffer_load_dwordx4 v246,s[16:19],s27 offen offset:2048 lds
v_mfma_f32_16x16x32_bf16 a[12:15],v[204:207],v[224:227],a[12:15]
ds_read_b128 v[216:219],v17 offset:33792
ds_read_b64_tr_b16 v[188:189],v25 offset:49152
v_mfma_f32_16x16x32_bf16 a[28:31],v[204:207],v[228:231],a[28:31]
buffer_load_dwordx4 v247,s[16:19],s27 offen offset:3072 lds
v_mfma_f32_16x16x32_bf16 a[44:47],v[204:207],v[232:235],a[44:47]
ds_read_b64_tr_b16 v[190:191],v25 offset:53248
ds_read_b128 v[220:223],v17 offset:34048
v_mfma_f32_16x16x32_bf16 a[48:51],v[192:195],v[236:239],a[48:51]
s_add_u32 s27,s27,0x20000
v_mfma_f32_16x16x32_bf16 a[52:55],v[196:199],v[236:239],a[52:55]
v_mfma_f32_16x16x32_bf16 a[56:59],v[200:203],v[236:239],a[56:59]
v_mfma_f32_16x16x32_bf16 a[60:63],v[204:207],v[236:239],a[60:63]
s_waitcnt lgkmcnt(6)
v_mfma_f32_16x16x32_bf16 a[0:3],v[176:179],v[208:211],a[0:3]
ds_read_b64_tr_b16 v[192:193],v19 offset:57344
ds_read_b64_tr_b16 v[194:195],v19 offset:61440
v_mfma_f32_16x16x32_bf16 a[4:7],v[180:183],v[208:211],a[4:7]
s_add_u32 m0,s5,20480
v_mfma_f32_16x16x32_bf16 a[16:19],v[176:179],v[212:215],a[16:19]
ds_read_b128 v[224:227],v17 offset:40960
ds_read_b64_tr_b16 v[196:197],v21 offset:57344
v_mfma_f32_16x16x32_bf16 a[20:23],v[180:183],v[212:215],a[20:23]
buffer_load_dwordx4 v244,s[16:19],s28 offen lds
s_waitcnt lgkmcnt(4)
v_mfma_f32_16x16x32_bf16 a[8:11],v[184:187],v[208:211],a[8:11]
ds_read_b64_tr_b16 v[198:199],v21 offset:61440
ds_read_b128 v[228:231],v17 offset:41216
v_mfma_f32_16x16x32_bf16 a[24:27],v[184:187],v[212:215],a[24:27]
buffer_load_dwordx4 v245,s[16:19],s28 offen offset:1024 lds
v_mfma_f32_16x16x32_bf16 a[32:35],v[176:179],v[216:219],a[32:35]
ds_read_b64_tr_b16 v[200:201],v23 offset:57344
ds_read_b64_tr_b16 v[202:203],v23 offset:61440
v_mfma_f32_16x16x32_bf16 a[36:39],v[180:183],v[216:219],a[36:39]
buffer_load_dwordx4 v246,s[16:19],s28 offen offset:2048 lds
v_mfma_f32_16x16x32_bf16 a[40:43],v[184:187],v[216:219],a[40:43]
ds_read_b128 v[232:235],v17 offset:41984
ds_read_b64_tr_b16 v[204:205],v25 offset:57344
v_mfma_f32_16x16x32_bf16 a[12:15],v[188:191],v[208:211],a[12:15]
buffer_load_dwordx4 v247,s[16:19],s28 offen offset:3072 lds
v_mfma_f32_16x16x32_bf16 a[28:31],v[188:191],v[212:215],a[28:31]
ds_read_b64_tr_b16 v[206:207],v25 offset:61440
ds_read_b128 v[236:239],v17 offset:42240
v_mfma_f32_16x16x32_bf16 a[44:47],v[188:191],v[216:219],a[44:47]
s_add_u32 s28,s28,0x20000
v_mfma_f32_16x16x32_bf16 a[48:51],v[176:179],v[220:223],a[48:51]
v_mfma_f32_16x16x32_bf16 a[52:55],v[180:183],v[220:223],a[52:55]
v_mfma_f32_16x16x32_bf16 a[56:59],v[184:187],v[220:223],a[56:59]
v_mfma_f32_16x16x32_bf16 a[60:63],v[188:191],v[220:223],a[60:63]
s_waitcnt lgkmcnt(6)
v_mfma_f32_16x16x32_bf16 a[0:3],v[192:195],v[224:227],a[0:3]
s_waitcnt vmcnt(17) lgkmcnt(0)
s_barrier
v_mfma_f32_16x16x32_bf16 a[4:7],v[196:199],v[224:227],a[4:7]
ds_read_b64_tr_b16 v[176:177],v18 offset:16384
ds_read_b64_tr_b16 v[178:179],v18 offset:20480
v_mfma_f32_16x16x32_bf16 a[16:19],v[192:195],v[228:231],a[16:19]
s_add_u32 m0,s5,49152
v_mfma_f32_16x16x32_bf16 a[20:23],v[196:199],v[228:231],a[20:23]
ds_read_b128 v[208:211],v16
ds_read_b64_tr_b16 v[180:181],v20 offset:16384
v_mfma_f32_16x16x32_bf16 a[8:11],v[200:203],v[224:227],a[8:11]
buffer_load_dwordx4 v244,s[16:19],s27 offen lds
v_mfma_f32_16x16x32_bf16 a[24:27],v[200:203],v[228:231],a[24:27]
ds_read_b64_tr_b16 v[182:183],v20 offset:20480
ds_read_b128 v[212:215],v16 offset:256
v_mfma_f32_16x16x32_bf16 a[32:35],v[192:195],v[232:235],a[32:35]
buffer_load_dwordx4 v245,s[16:19],s27 offen offset:1024 lds
v_mfma_f32_16x16x32_bf16 a[36:39],v[196:199],v[232:235],a[36:39]
ds_read_b64_tr_b16 v[184:185],v22 offset:16384
ds_read_b64_tr_b16 v[186:187],v22 offset:20480
v_mfma_f32_16x16x32_bf16 a[40:43],v[200:203],v[232:235],a[40:43]
buffer_load_dwordx4 v246,s[16:19],s27 offen offset:2048 lds
v_mfma_f32_16x16x32_bf16 a[12:15],v[204:207],v[224:227],a[12:15]
ds_read_b128 v[216:219],v16 offset:1024
ds_read_b64_tr_b16 v[188:189],v24 offset:16384
v_mfma_f32_16x16x32_bf16 a[28:31],v[204:207],v[228:231],a[28:31]
buffer_load_dwordx4 v247,s[16:19],s27 offen offset:3072 lds
v_mfma_f32_16x16x32_bf16 a[44:47],v[204:207],v[232:235],a[44:47]
ds_read_b64_tr_b16 v[190:191],v24 offset:20480
ds_read_b128 v[220:223],v16 offset:1280
v_mfma_f32_16x16x32_bf16 a[48:51],v[192:195],v[236:239],a[48:51]
s_add_u32 s27,s27,0x20000
v_mfma_f32_16x16x32_bf16 a[52:55],v[196:199],v[236:239],a[52:55]
v_mfma_f32_16x16x32_bf16 a[56:59],v[200:203],v[236:239],a[56:59]
v_mfma_f32_16x16x32_bf16 a[60:63],v[204:207],v[236:239],a[60:63]
s_waitcnt lgkmcnt(6)
v_mfma_f32_16x16x32_bf16 a[0:3],v[176:179],v[208:211],a[0:3]
ds_read_b64_tr_b16 v[192:193],v18 offset:24576
ds_read_b64_tr_b16 v[194:195],v18 offset:28672
v_mfma_f32_16x16x32_bf16 a[4:7],v[180:183],v[208:211],a[4:7]
s_add_u32 m0,s5,53248
v_mfma_f32_16x16x32_bf16 a[16:19],v[176:179],v[212:215],a[16:19]
ds_read_b128 v[224:227],v16 offset:8192
ds_read_b64_tr_b16 v[196:197],v20 offset:24576
v_mfma_f32_16x16x32_bf16 a[20:23],v[180:183],v[212:215],a[20:23]
buffer_load_dwordx4 v244,s[16:19],s28 offen lds
s_waitcnt lgkmcnt(4)
v_mfma_f32_16x16x32_bf16 a[8:11],v[184:187],v[208:211],a[8:11]
ds_read_b64_tr_b16 v[198:199],v20 offset:28672
ds_read_b128 v[228:231],v16 offset:8448
v_mfma_f32_16x16x32_bf16 a[24:27],v[184:187],v[212:215],a[24:27]
buffer_load_dwordx4 v245,s[16:19],s28 offen offset:1024 lds
v_mfma_f32_16x16x32_bf16 a[32:35],v[176:179],v[216:219],a[32:35]
ds_read_b64_tr_b16 v[200:201],v22 offset:24576
ds_read_b64_tr_b16 v[202:203],v22 offset:28672
v_mfma_f32_16x16x32_bf16 a[36:39],v[180:183],v[216:219],a[36:39]
buffer_load_dwordx4 v246,s[16:19],s28 offen offset:2048 lds
v_mfma_f32_16x16x32_bf16 a[40:43],v[184:187],v[216:219],a[40:43]
ds_read_b128 v[232:235],v16 offset:9216
ds_read_b64_tr_b16 v[204:205],v24 offset:24576
v_mfma_f32_16x16x32_bf16 a[12:15],v[188:191],v[208:211],a[12:15]
buffer_load_dwordx4 v247,s[16:19],s28 offen offset:3072 lds
v_mfma_f32_16x16x32_bf16 a[28:31],v[188:191],v[212:215],a[28:31]
ds_read_b64_tr_b16 v[206:207],v24 offset:28672
ds_read_b128 v[236:239],v16 offset:9472
v_mfma_f32_16x16x32_bf16 a[44:47],v[188:191],v[216:219],a[44:47]
s_add_u32 s28,s28,0x20000
v_mfma_f32_16x16x32_bf16 a[48:51],v[176:179],v[220:223],a[48:51]
v_mfma_f32_16x16x32_bf16 a[52:55],v[180:183],v[220:223],a[52:55]
v_mfma_f32_16x16x32_bf16 a[56:59],v[184:187],v[220:223],a[56:59]
v_mfma_f32_16x16x32_bf16 a[60:63],v[188:191],v[220:223],a[60:63]
s_waitcnt lgkmcnt(6)
v_mfma_f32_16x16x32_bf16 a[0:3],v[192:195],v[224:227],a[0:3]
s_waitcnt vmcnt(16) lgkmcnt(0)
s_barrier
v_mfma_f32_16x16x32_bf16 a[4:7],v[196:199],v[224:227],a[4:7]
ds_read_b64_tr_b16 v[176:177],v18 offset:49152
ds_read_b64_tr_b16 v[178:179],v18 offset:53248
v_mfma_f32_16x16x32_bf16 a[16:19],v[192:195],v[228:231],a[16:19]
s_add_u32 m0,s30,16384
v_mfma_f32_16x16x32_bf16 a[20:23],v[196:199],v[228:231],a[20:23]
ds_read_b128 v[208:211],v16 offset:32768
ds_read_b64_tr_b16 v[180:181],v20 offset:49152
v_mfma_f32_16x16x32_bf16 a[8:11],v[200:203],v[224:227],a[8:11]
buffer_load_dwordx4 v244,s[16:19],s27 offen lds
v_mfma_f32_16x16x32_bf16 a[24:27],v[200:203],v[228:231],a[24:27]
ds_read_b64_tr_b16 v[182:183],v20 offset:53248
ds_read_b128 v[212:215],v16 offset:33024
v_mfma_f32_16x16x32_bf16 a[32:35],v[192:195],v[232:235],a[32:35]
buffer_load_dwordx4 v245,s[16:19],s27 offen offset:1024 lds
v_mfma_f32_16x16x32_bf16 a[36:39],v[196:199],v[232:235],a[36:39]
ds_read_b64_tr_b16 v[184:185],v22 offset:49152
ds_read_b64_tr_b16 v[186:187],v22 offset:53248
v_mfma_f32_16x16x32_bf16 a[40:43],v[200:203],v[232:235],a[40:43]
buffer_load_dwordx4 v246,s[16:19],s27 offen offset:2048 lds
v_mfma_f32_16x16x32_bf16 a[12:15],v[204:207],v[224:227],a[12:15]
ds_read_b128 v[216:219],v16 offset:33792
ds_read_b64_tr_b16 v[188:189],v24 offset:49152
v_mfma_f32_16x16x32_bf16 a[28:31],v[204:207],v[228:231],a[28:31]
buffer_load_dwordx4 v247,s[16:19],s27 offen offset:3072 lds
v_mfma_f32_16x16x32_bf16 a[44:47],v[204:207],v[232:235],a[44:47]
ds_read_b64_tr_b16 v[190:191],v24 offset:53248
ds_read_b128 v[220:223],v16 offset:34048
v_mfma_f32_16x16x32_bf16 a[48:51],v[192:195],v[236:239],a[48:51]
s_add_u32 s27,s27,0x20000
v_mfma_f32_16x16x32_bf16 a[52:55],v[196:199],v[236:239],a[52:55]
v_mfma_f32_16x16x32_bf16 a[56:59],v[200:203],v[236:239],a[56:59]
v_mfma_f32_16x16x32_bf16 a[60:63],v[204:207],v[236:239],a[60:63]
s_waitcnt lgkmcnt(6)
v_mfma_f32_16x16x32_bf16 a[0:3],v[176:179],v[208:211],a[0:3]
ds_read_b64_tr_b16 v[192:193],v18 offset:57344
ds_read_b64_tr_b16 v[194:195],v18 offset:61440
v_mfma_f32_16x16x32_bf16 a[4:7],v[180:183],v[208:211],a[4:7]
s_add_u32 m0,s30,20480
v_mfma_f32_16x16x32_bf16 a[16:19],v[176:179],v[212:215],a[16:19]
ds_read_b128 v[224:227],v16 offset:40960
ds_read_b64_tr_b16 v[196:197],v20 offset:57344
v_mfma_f32_16x16x32_bf16 a[20:23],v[180:183],v[212:215],a[20:23]
buffer_load_dwordx4 v244,s[16:19],s28 offen lds
s_waitcnt lgkmcnt(4)
v_mfma_f32_16x16x32_bf16 a[8:11],v[184:187],v[208:211],a[8:11]
ds_read_b64_tr_b16 v[198:199],v20 offset:61440
ds_read_b128 v[228:231],v16 offset:41216
v_mfma_f32_16x16x32_bf16 a[24:27],v[184:187],v[212:215],a[24:27]
buffer_load_dwordx4 v245,s[16:19],s28 offen offset:1024 lds
v_mfma_f32_16x16x32_bf16 a[32:35],v[176:179],v[216:219],a[32:35]
ds_read_b64_tr_b16 v[200:201],v22 offset:57344
ds_read_b64_tr_b16 v[202:203],v22 offset:61440
v_mfma_f32_16x16x32_bf16 a[36:39],v[180:183],v[216:219],a[36:39]
buffer_load_dwordx4 v246,s[16:19],s28 offen offset:2048 lds
v_mfma_f32_16x16x32_bf16 a[40:43],v[184:187],v[216:219],a[40:43]
ds_read_b128 v[232:235],v16 offset:41984
ds_read_b64_tr_b16 v[204:205],v24 offset:57344
v_mfma_f32_16x16x32_bf16 a[12:15],v[188:191],v[208:211],a[12:15]
buffer_load_dwordx4 v247,s[16:19],s28 offen offset:3072 lds
v_mfma_f32_16x16x32_bf16 a[28:31],v[188:191],v[212:215],a[28:31]
ds_read_b64_tr_b16 v[206:207],v24 offset:61440
ds_read_b128 v[236:239],v16 offset:42240
v_mfma_f32_16x16x32_bf16 a[44:47],v[188:191],v[216:219],a[44:47]
s_add_u32 s28,s28,0x20000
v_mfma_f32_16x16x32_bf16 a[48:51],v[176:179],v[220:223],a[48:51]
v_mfma_f32_16x16x32_bf16 a[52:55],v[180:183],v[220:223],a[52:55]
v_mfma_f32_16x16x32_bf16 a[56:59],v[184:187],v[220:223],a[56:59]
v_mfma_f32_16x16x32_bf16 a[60:63],v[188:191],v[220:223],a[60:63]
s_waitcnt lgkmcnt(6)
v_mfma_f32_16x16x32_bf16 a[0:3],v[192:195],v[224:227],a[0:3]
s_waitcnt vmcnt(16) lgkmcnt(0)
s_barrier
v_mfma_f32_16x16x32_bf16 a[4:7],v[196:199],v[224:227],a[4:7]
ds_read_b64_tr_b16 v[176:177],v19 offset:16384
ds_read_b64_tr_b16 v[178:179],v19 offset:20480
v_mfma_f32_16x16x32_bf16 a[16:19],v[192:195],v[228:231],a[16:19]
s_add_u32 m0,s30,49152
v_mfma_f32_16x16x32_bf16 a[20:23],v[196:199],v[228:231],a[20:23]
ds_read_b128 v[208:211],v27
ds_read_b128 v[212:215],v27 offset:256
v_mfma_f32_16x16x32_bf16 a[8:11],v[200:203],v[224:227],a[8:11]
buffer_load_dwordx4 v244,s[16:19],s27 offen lds
v_mfma_f32_16x16x32_bf16 a[24:27],v[200:203],v[228:231],a[24:27]
ds_read_b64_tr_b16 v[180:181],v21 offset:16384
ds_read_b64_tr_b16 v[182:183],v21 offset:20480
v_mfma_f32_16x16x32_bf16 a[32:35],v[192:195],v[232:235],a[32:35]
buffer_load_dwordx4 v245,s[16:19],s27 offen offset:1024 lds
v_mfma_f32_16x16x32_bf16 a[36:39],v[196:199],v[232:235],a[36:39]
ds_read_b64_tr_b16 v[184:185],v23 offset:16384
ds_read_b64_tr_b16 v[186:187],v23 offset:20480
v_mfma_f32_16x16x32_bf16 a[40:43],v[200:203],v[232:235],a[40:43]
buffer_load_dwordx4 v246,s[16:19],s27 offen offset:2048 lds
v_mfma_f32_16x16x32_bf16 a[12:15],v[204:207],v[224:227],a[12:15]
ds_read_b64_tr_b16 v[188:189],v25 offset:16384
ds_read_b64_tr_b16 v[190:191],v25 offset:20480
v_mfma_f32_16x16x32_bf16 a[28:31],v[204:207],v[228:231],a[28:31]
buffer_load_dwordx4 v247,s[16:19],s27 offen offset:3072 lds
v_mfma_f32_16x16x32_bf16 a[44:47],v[204:207],v[232:235],a[44:47]
v_mfma_f32_16x16x32_bf16 a[48:51],v[192:195],v[236:239],a[48:51]
s_add_u32 s27,s27,0x20000
v_mfma_f32_16x16x32_bf16 a[52:55],v[196:199],v[236:239],a[52:55]
v_mfma_f32_16x16x32_bf16 a[56:59],v[200:203],v[236:239],a[56:59]
v_mfma_f32_16x16x32_bf16 a[60:63],v[204:207],v[236:239],a[60:63]
s_waitcnt lgkmcnt(4)
v_mfma_f32_16x16x32_bf16 v[80:83],v[176:179],v[208:211],v[80:83]
ds_read_b64_tr_b16 v[192:193],v19 offset:24576
ds_read_b64_tr_b16 v[194:195],v19 offset:28672
s_add_u32 m0,s30,53248
s_nop 0
buffer_load_dwordx4 v244,s[16:19],s28 offen lds
v_mfma_f32_16x16x32_bf16 v[96:99],v[176:179],v[212:215],v[96:99]
ds_read_b128 v[224:227],v27 offset:4096
ds_read_b128 v[228:231],v27 offset:4352
buffer_load_dwordx4 v245,s[16:19],s28 offen offset:1024 lds
v_mfma_f32_16x16x32_bf16 v[84:87],v[180:183],v[208:211],v[84:87]
ds_read_b64_tr_b16 v[196:197],v21 offset:24576
ds_read_b64_tr_b16 v[198:199],v21 offset:28672
buffer_load_dwordx4 v246,s[16:19],s28 offen offset:2048 lds
v_mfma_f32_16x16x32_bf16 v[100:103],v[180:183],v[212:215],v[100:103]
ds_read_b64_tr_b16 v[200:201],v23 offset:24576
ds_read_b64_tr_b16 v[202:203],v23 offset:28672
buffer_load_dwordx4 v247,s[16:19],s28 offen offset:3072 lds
s_waitcnt lgkmcnt(8)
v_mfma_f32_16x16x32_bf16 v[88:91],v[184:187],v[208:211],v[88:91]
ds_read_b64_tr_b16 v[204:205],v25 offset:24576
ds_read_b64_tr_b16 v[206:207],v25 offset:28672
s_add_u32 s28,s28,0x20000
v_mfma_f32_16x16x32_bf16 v[104:107],v[184:187],v[212:215],v[104:107]
s_lshl_b32 s46,s45,13
v_mfma_f32_16x16x32_bf16 v[92:95],v[188:191],v[208:211],v[92:95]
s_add_u32 s46,s46,131072
v_mfma_f32_16x16x32_bf16 v[108:111],v[188:191],v[212:215],v[108:111]
v_add_u32 v10,s46,v9
s_waitcnt lgkmcnt(4)
v_mfma_f32_16x16x32_bf16 v[80:83],v[192:195],v[224:227],v[80:83]
s_waitcnt vmcnt(16) lgkmcnt(0)
s_barrier
s_add_u32 m0,s5,16384
v_mfma_f32_16x16x32_bf16 v[96:99],v[192:195],v[228:231],v[96:99]
ds_read_b64_tr_b16 v[176:177],v19 offset:49152
ds_read_b64_tr_b16 v[178:179],v19 offset:53248
buffer_load_dwordx4 v244,s[16:19],s27 offen lds
v_mfma_f32_16x16x32_bf16 v[84:87],v[196:199],v[224:227],v[84:87]
ds_read_b128 v[208:211],v27 offset:8192
ds_read_b128 v[212:215],v27 offset:8448
buffer_load_dwordx4 v245,s[16:19],s27 offen offset:1024 lds
v_mfma_f32_16x16x32_bf16 v[100:103],v[196:199],v[228:231],v[100:103]
ds_read_b64_tr_b16 v[180:181],v21 offset:49152
ds_read_b64_tr_b16 v[182:183],v21 offset:53248
buffer_load_dwordx4 v246,s[16:19],s27 offen offset:2048 lds
v_mfma_f32_16x16x32_bf16 v[88:91],v[200:203],v[224:227],v[88:91]
ds_read_b64_tr_b16 v[184:185],v23 offset:49152
ds_read_b64_tr_b16 v[186:187],v23 offset:53248
buffer_load_dwordx4 v247,s[16:19],s27 offen offset:3072 lds
v_mfma_f32_16x16x32_bf16 v[104:107],v[200:203],v[228:231],v[104:107]
ds_read_b64_tr_b16 v[188:189],v25 offset:49152
ds_read_b64_tr_b16 v[190:191],v25 offset:53248
s_add_u32 s27,s27,0x20000
v_mfma_f32_16x16x32_bf16 v[92:95],v[204:207],v[224:227],v[92:95]
ds_write_b128 v10,a[32:35]
v_mfma_f32_16x16x32_bf16 v[108:111],v[204:207],v[228:231],v[108:111]
ds_write_b128 v10,a[36:39] offset:1024
s_waitcnt lgkmcnt(6)
v_mfma_f32_16x16x32_bf16 v[80:83],v[176:179],v[208:211],v[80:83]
ds_read_b64_tr_b16 v[192:193],v19 offset:57344
ds_read_b64_tr_b16 v[194:195],v19 offset:61440
s_add_u32 m0,s5,20480
s_nop 0
buffer_load_dwordx4 v244,s[16:19],s28 offen lds
v_mfma_f32_16x16x32_bf16 v[96:99],v[176:179],v[212:215],v[96:99]
ds_read_b128 v[224:227],v27 offset:12288
ds_read_b128 v[228:231],v27 offset:12544
buffer_load_dwordx4 v245,s[16:19],s28 offen offset:1024 lds
v_mfma_f32_16x16x32_bf16 v[84:87],v[180:183],v[208:211],v[84:87]
ds_read_b64_tr_b16 v[196:197],v21 offset:57344
ds_read_b64_tr_b16 v[198:199],v21 offset:61440
buffer_load_dwordx4 v246,s[16:19],s28 offen offset:2048 lds
v_mfma_f32_16x16x32_bf16 v[100:103],v[180:183],v[212:215],v[100:103]
ds_read_b64_tr_b16 v[200:201],v23 offset:57344
ds_read_b64_tr_b16 v[202:203],v23 offset:61440
buffer_load_dwordx4 v247,s[16:19],s28 offen offset:3072 lds
s_waitcnt lgkmcnt(10)
v_mfma_f32_16x16x32_bf16 v[88:91],v[184:187],v[208:211],v[88:91]
ds_read_b64_tr_b16 v[204:205],v25 offset:57344
ds_read_b64_tr_b16 v[206:207],v25 offset:61440
s_add_u32 s28,s28,0x20000
v_mfma_f32_16x16x32_bf16 v[104:107],v[184:187],v[212:215],v[104:107]
ds_write_b128 v10,a[40:43] offset:2048
v_mfma_f32_16x16x32_bf16 v[92:95],v[188:191],v[208:211],v[92:95]
ds_write_b128 v10,a[44:47] offset:3072
v_mfma_f32_16x16x32_bf16 v[108:111],v[188:191],v[212:215],v[108:111]
ds_write_b128 v10,a[48:51] offset:4096
s_waitcnt lgkmcnt(7)
v_mfma_f32_16x16x32_bf16 v[80:83],v[192:195],v[224:227],v[80:83]
s_waitcnt vmcnt(16) lgkmcnt(0)
s_barrier
s_add_u32 m0,s5,49152
s_nop 0
buffer_load_dwordx4 v244,s[16:19],s27 offen lds
v_mfma_f32_16x16x32_bf16 v[96:99],v[192:195],v[228:231],v[96:99]
ds_read_b64_tr_b16 v[176:177],v18 offset:16384
ds_read_b64_tr_b16 v[178:179],v18 offset:20480
buffer_load_dwordx4 v245,s[16:19],s27 offen offset:1024 lds
v_mfma_f32_16x16x32_bf16 v[84:87],v[196:199],v[224:227],v[84:87]
ds_read_b128 v[208:211],v27 offset:32768
ds_read_b128 v[212:215],v27 offset:33024
buffer_load_dwordx4 v246,s[16:19],s27 offen offset:2048 lds
v_mfma_f32_16x16x32_bf16 v[100:103],v[196:199],v[228:231],v[100:103]
ds_read_b64_tr_b16 v[180:181],v20 offset:16384
ds_read_b64_tr_b16 v[182:183],v20 offset:20480
buffer_load_dwordx4 v247,s[16:19],s27 offen offset:3072 lds
v_mfma_f32_16x16x32_bf16 v[88:91],v[200:203],v[224:227],v[88:91]
ds_read_b64_tr_b16 v[184:185],v22 offset:16384
ds_read_b64_tr_b16 v[186:187],v22 offset:20480
s_add_u32 s27,s27,0x20000
v_mfma_f32_16x16x32_bf16 v[104:107],v[200:203],v[228:231],v[104:107]
ds_read_b64_tr_b16 v[188:189],v24 offset:16384
ds_read_b64_tr_b16 v[190:191],v24 offset:20480
ds_write_b128 v10,a[52:55] offset:5120
v_mfma_f32_16x16x32_bf16 v[92:95],v[204:207],v[224:227],v[92:95]
ds_write_b128 v10,a[56:59] offset:6144
v_mfma_f32_16x16x32_bf16 v[108:111],v[204:207],v[228:231],v[108:111]
ds_write_b128 v10,a[60:63] offset:7168
s_waitcnt lgkmcnt(7)
v_mfma_f32_16x16x32_bf16 v[80:83],v[176:179],v[208:211],v[80:83]
ds_read_b64_tr_b16 v[192:193],v18 offset:24576
ds_read_b64_tr_b16 v[194:195],v18 offset:28672
s_add_u32 m0,s5,53248
v_mfma_f32_16x16x32_bf16 v[96:99],v[176:179],v[212:215],v[96:99]
ds_read_b128 v[224:227],v27 offset:36864
ds_read_b128 v[228:231],v27 offset:37120
buffer_load_dwordx4 v244,s[16:19],s28 offen lds
v_mfma_f32_16x16x32_bf16 v[84:87],v[180:183],v[208:211],v[84:87]
ds_read_b64_tr_b16 v[196:197],v20 offset:24576
ds_read_b64_tr_b16 v[198:199],v20 offset:28672
v_mfma_f32_16x16x32_bf16 v[100:103],v[180:183],v[212:215],v[100:103]
ds_read_b64_tr_b16 v[200:201],v22 offset:24576
ds_read_b64_tr_b16 v[202:203],v22 offset:28672
buffer_load_dwordx4 v245,s[16:19],s28 offen offset:1024 lds
s_waitcnt lgkmcnt(11)
v_mfma_f32_16x16x32_bf16 v[88:91],v[184:187],v[208:211],v[88:91]
ds_read_b64_tr_b16 v[204:205],v24 offset:24576
ds_read_b64_tr_b16 v[206:207],v24 offset:28672
v_mfma_f32_16x16x32_bf16 v[104:107],v[184:187],v[212:215],v[104:107]
buffer_load_dwordx4 v246,s[16:19],s28 offen offset:2048 lds
v_mfma_f32_16x16x32_bf16 v[92:95],v[188:191],v[208:211],v[92:95]
v_mfma_f32_16x16x32_bf16 v[108:111],v[188:191],v[212:215],v[108:111]
buffer_load_dwordx4 v247,s[16:19],s28 offen offset:3072 lds
s_add_u32 s28,s28,0x20000
s_waitcnt lgkmcnt(4)
v_mfma_f32_16x16x32_bf16 v[80:83],v[192:195],v[224:227],v[80:83]
s_waitcnt vmcnt(16) lgkmcnt(0)
s_barrier
v_mfma_f32_16x16x32_bf16 v[96:99],v[192:195],v[228:231],v[96:99]
ds_read_b64_tr_b16 v[176:177],v18 offset:49152
ds_read_b64_tr_b16 v[178:179],v18 offset:53248
s_add_u32 m0,s30,16384
v_mfma_f32_16x16x32_bf16 v[84:87],v[196:199],v[224:227],v[84:87]
ds_read_b128 v[208:211],v27 offset:40960
ds_read_b128 v[212:215],v27 offset:41216
buffer_load_dwordx4 v244,s[16:19],s27 offen lds
v_mfma_f32_16x16x32_bf16 v[100:103],v[196:199],v[228:231],v[100:103]
ds_read_b64_tr_b16 v[180:181],v20 offset:49152
ds_read_b64_tr_b16 v[182:183],v20 offset:53248
v_mfma_f32_16x16x32_bf16 v[88:91],v[200:203],v[224:227],v[88:91]
ds_read_b64_tr_b16 v[184:185],v22 offset:49152
ds_read_b64_tr_b16 v[186:187],v22 offset:53248
buffer_load_dwordx4 v245,s[16:19],s27 offen offset:1024 lds
v_mfma_f32_16x16x32_bf16 v[104:107],v[200:203],v[228:231],v[104:107]
ds_read_b64_tr_b16 v[188:189],v24 offset:49152
ds_read_b64_tr_b16 v[190:191],v24 offset:53248
v_mfma_f32_16x16x32_bf16 v[92:95],v[204:207],v[224:227],v[92:95]
buffer_load_dwordx4 v246,s[16:19],s27 offen offset:2048 lds
v_mfma_f32_16x16x32_bf16 v[108:111],v[204:207],v[228:231],v[108:111]
buffer_load_dwordx4 v247,s[16:19],s27 offen offset:3072 lds
s_add_u32 s27,s27,0x20000
s_waitcnt lgkmcnt(4)
v_mfma_f32_16x16x32_bf16 v[80:83],v[176:179],v[208:211],v[80:83]
ds_read_b64_tr_b16 v[192:193],v18 offset:57344
ds_read_b64_tr_b16 v[194:195],v18 offset:61440
s_add_u32 m0,s30,20480
v_mfma_f32_16x16x32_bf16 v[96:99],v[176:179],v[212:215],v[96:99]
ds_read_b128 v[224:227],v27 offset:45056
ds_read_b128 v[228:231],v27 offset:45312
buffer_load_dwordx4 v244,s[16:19],s28 offen lds
v_mfma_f32_16x16x32_bf16 v[84:87],v[180:183],v[208:211],v[84:87]
ds_read_b64_tr_b16 v[196:197],v20 offset:57344
ds_read_b64_tr_b16 v[198:199],v20 offset:61440
v_mfma_f32_16x16x32_bf16 v[100:103],v[180:183],v[212:215],v[100:103]
ds_read_b64_tr_b16 v[200:201],v22 offset:57344
ds_read_b64_tr_b16 v[202:203],v22 offset:61440
buffer_load_dwordx4 v245,s[16:19],s28 offen offset:1024 lds
s_waitcnt lgkmcnt(8)
v_mfma_f32_16x16x32_bf16 v[88:91],v[184:187],v[208:211],v[88:91]
ds_read_b64_tr_b16 v[204:205],v24 offset:57344
ds_read_b64_tr_b16 v[206:207],v24 offset:61440
v_mfma_f32_16x16x32_bf16 v[104:107],v[184:187],v[212:215],v[104:107]
buffer_load_dwordx4 v246,s[16:19],s28 offen offset:2048 lds
v_mfma_f32_16x16x32_bf16 v[92:95],v[188:191],v[208:211],v[92:95]
v_mfma_f32_16x16x32_bf16 v[108:111],v[188:191],v[212:215],v[108:111]
buffer_load_dwordx4 v247,s[16:19],s28 offen offset:3072 lds
s_add_u32 s28,s28,0x20000
s_waitcnt lgkmcnt(4)
v_mfma_f32_16x16x32_bf16 v[80:83],v[192:195],v[224:227],v[80:83]
s_waitcnt vmcnt(16) lgkmcnt(0)
s_barrier
v_mfma_f32_16x16x32_bf16 v[96:99],v[192:195],v[228:231],v[96:99]
ds_read_b64_tr_b16 v[176:177],v19 offset:16384
ds_read_b64_tr_b16 v[178:179],v19 offset:20480
s_add_u32 m0,s30,49152
v_mfma_f32_16x16x32_bf16 v[84:87],v[196:199],v[224:227],v[84:87]
ds_read_b128 v[208:211],v26
ds_read_b128 v[212:215],v26 offset:256
buffer_load_dwordx4 v244,s[16:19],s27 offen lds
v_mfma_f32_16x16x32_bf16 v[100:103],v[196:199],v[228:231],v[100:103]
ds_read_b64_tr_b16 v[180:181],v21 offset:16384
ds_read_b64_tr_b16 v[182:183],v21 offset:20480
v_mfma_f32_16x16x32_bf16 v[88:91],v[200:203],v[224:227],v[88:91]
ds_read_b64_tr_b16 v[184:185],v23 offset:16384
ds_read_b64_tr_b16 v[186:187],v23 offset:20480
buffer_load_dwordx4 v245,s[16:19],s27 offen offset:1024 lds
v_mfma_f32_16x16x32_bf16 v[104:107],v[200:203],v[228:231],v[104:107]
ds_read_b64_tr_b16 v[188:189],v25 offset:16384
ds_read_b64_tr_b16 v[190:191],v25 offset:20480
v_mfma_f32_16x16x32_bf16 v[92:95],v[204:207],v[224:227],v[92:95]
buffer_load_dwordx4 v246,s[16:19],s27 offen offset:2048 lds
v_mfma_f32_16x16x32_bf16 v[108:111],v[204:207],v[228:231],v[108:111]
buffer_load_dwordx4 v247,s[16:19],s27 offen offset:3072 lds
s_add_u32 s27,s27,0x20000
s_waitcnt lgkmcnt(4)
v_mfma_f32_16x16x32_bf16 v[80:83],v[176:179],v[208:211],v[80:83]
ds_read_b64_tr_b16 v[192:193],v19 offset:24576
ds_read_b64_tr_b16 v[194:195],v19 offset:28672
s_add_u32 m0,s30,53248
v_mfma_f32_16x16x32_bf16 v[96:99],v[176:179],v[212:215],v[96:99]
ds_read_b128 v[224:227],v26 offset:4096
ds_read_b128 v[228:231],v26 offset:4352
buffer_load_dwordx4 v244,s[16:19],s28 offen lds
v_mfma_f32_16x16x32_bf16 v[84:87],v[180:183],v[208:211],v[84:87]
ds_read_b64_tr_b16 v[196:197],v21 offset:24576
ds_read_b64_tr_b16 v[198:199],v21 offset:28672
v_mfma_f32_16x16x32_bf16 v[100:103],v[180:183],v[212:215],v[100:103]
ds_read_b64_tr_b16 v[200:201],v23 offset:24576
ds_read_b64_tr_b16 v[202:203],v23 offset:28672
buffer_load_dwordx4 v245,s[16:19],s28 offen offset:1024 lds
s_waitcnt lgkmcnt(8)
v_mfma_f32_16x16x32_bf16 v[88:91],v[184:187],v[208:211],v[88:91]
ds_read_b64_tr_b16 v[204:205],v25 offset:24576
ds_read_b64_tr_b16 v[206:207],v25 offset:28672
v_mfma_f32_16x16x32_bf16 v[104:107],v[184:187],v[212:215],v[104:107]
buffer_load_dwordx4 v246,s[16:19],s28 offen offset:2048 lds
v_mfma_f32_16x16x32_bf16 v[92:95],v[188:191],v[208:211],v[92:95]
v_mfma_f32_16x16x32_bf16 v[108:111],v[188:191],v[212:215],v[108:111]
buffer_load_dwordx4 v247,s[16:19],s28 offen offset:3072 lds
s_add_u32 s28,s28,0x20000
s_waitcnt lgkmcnt(4)
v_mfma_f32_16x16x32_bf16 v[80:83],v[192:195],v[224:227],v[80:83]
s_waitcnt vmcnt(16) lgkmcnt(0)
s_barrier
v_mfma_f32_16x16x32_bf16 v[96:99],v[192:195],v[228:231],v[96:99]
ds_read_b64_tr_b16 v[176:177],v19 offset:49152
ds_read_b64_tr_b16 v[178:179],v19 offset:53248
s_add_u32 m0,s5,16384
v_mfma_f32_16x16x32_bf16 v[84:87],v[196:199],v[224:227],v[84:87]
ds_read_b128 v[208:211],v26 offset:8192
ds_read_b128 v[212:215],v26 offset:8448
buffer_load_dwordx4 v244,s[16:19],s27 offen lds
v_mfma_f32_16x16x32_bf16 v[100:103],v[196:199],v[228:231],v[100:103]
ds_read_b64_tr_b16 v[180:181],v21 offset:49152
ds_read_b64_tr_b16 v[182:183],v21 offset:53248
v_mfma_f32_16x16x32_bf16 v[88:91],v[200:203],v[224:227],v[88:91]
ds_read_b64_tr_b16 v[184:185],v23 offset:49152
ds_read_b64_tr_b16 v[186:187],v23 offset:53248
buffer_load_dwordx4 v245,s[16:19],s27 offen offset:1024 lds
v_mfma_f32_16x16x32_bf16 v[104:107],v[200:203],v[228:231],v[104:107]
ds_read_b64_tr_b16 v[188:189],v25 offset:49152
ds_read_b64_tr_b16 v[190:191],v25 offset:53248
v_mfma_f32_16x16x32_bf16 v[92:95],v[204:207],v[224:227],v[92:95]
buffer_load_dwordx4 v246,s[16:19],s27 offen offset:2048 lds
v_mfma_f32_16x16x32_bf16 v[108:111],v[204:207],v[228:231],v[108:111]
buffer_load_dwordx4 v247,s[16:19],s27 offen offset:3072 lds
s_add_u32 s27,s27,0x20000
s_waitcnt lgkmcnt(4)
v_mfma_f32_16x16x32_bf16 v[80:83],v[176:179],v[208:211],v[80:83]
ds_read_b64_tr_b16 v[192:193],v19 offset:57344
ds_read_b64_tr_b16 v[194:195],v19 offset:61440
s_add_u32 m0,s5,20480
s_nop 0
buffer_load_dwordx4 v244,s[16:19],s28 offen lds
buffer_load_dwordx4 v245,s[16:19],s28 offen offset:1024 lds
v_mfma_f32_16x16x32_bf16 v[96:99],v[176:179],v[212:215],v[96:99]
ds_read_b128 v[224:227],v26 offset:12288
ds_read_b128 v[228:231],v26 offset:12544
buffer_load_dwordx4 v246,s[16:19],s28 offen offset:2048 lds
buffer_load_dwordx4 v247,s[16:19],s28 offen offset:3072 lds
v_mfma_f32_16x16x32_bf16 v[84:87],v[180:183],v[208:211],v[84:87]
ds_read_b64_tr_b16 v[196:197],v21 offset:57344
ds_read_b64_tr_b16 v[198:199],v21 offset:61440
s_add_u32 s28,s28,0x20000
v_accvgpr_read_b32 v144,a0
v_accvgpr_read_b32 v145,a1
v_mfma_f32_16x16x32_bf16 v[100:103],v[180:183],v[212:215],v[100:103]
ds_read_b64_tr_b16 v[200:201],v23 offset:57344
ds_read_b64_tr_b16 v[202:203],v23 offset:61440
v_accvgpr_read_b32 v146,a2
v_accvgpr_read_b32 v147,a3
s_waitcnt lgkmcnt(8)
v_mfma_f32_16x16x32_bf16 v[88:91],v[184:187],v[208:211],v[88:91]
ds_read_b64_tr_b16 v[204:205],v25 offset:57344
ds_read_b64_tr_b16 v[206:207],v25 offset:61440
v_accvgpr_read_b32 v148,a4
v_accvgpr_read_b32 v149,a5
v_accvgpr_read_b32 v150,a6
v_mfma_f32_16x16x32_bf16 v[104:107],v[184:187],v[212:215],v[104:107]
v_accvgpr_read_b32 v151,a7
v_accvgpr_read_b32 v152,a8
v_mfma_f32_16x16x32_bf16 v[92:95],v[188:191],v[208:211],v[92:95]
v_accvgpr_read_b32 v153,a9
v_accvgpr_read_b32 v154,a10
v_accvgpr_read_b32 v155,a11
v_mfma_f32_16x16x32_bf16 v[108:111],v[188:191],v[212:215],v[108:111]
v_accvgpr_read_b32 v156,a12
v_accvgpr_read_b32 v157,a13
s_waitcnt lgkmcnt(4)
v_mfma_f32_16x16x32_bf16 v[80:83],v[192:195],v[224:227],v[80:83]
s_waitcnt vmcnt(16) lgkmcnt(0)
s_barrier
s_add_u32 m0,s5,49152
s_nop 0
buffer_load_dwordx4 v244,s[16:19],s27 offen lds
buffer_load_dwordx4 v245,s[16:19],s27 offen offset:1024 lds
v_mfma_f32_16x16x32_bf16 v[96:99],v[192:195],v[228:231],v[96:99]
ds_read_b64_tr_b16 v[176:177],v18 offset:16384
ds_read_b64_tr_b16 v[178:179],v18 offset:20480
buffer_load_dwordx4 v246,s[16:19],s27 offen offset:2048 lds
buffer_load_dwordx4 v247,s[16:19],s27 offen offset:3072 lds
v_mfma_f32_16x16x32_bf16 v[84:87],v[196:199],v[224:227],v[84:87]
ds_read_b128 v[208:211],v26 offset:32768
ds_read_b128 v[212:215],v26 offset:33024
s_add_u32 s27,s27,0x20000
v_accvgpr_read_b32 v158,a14
v_accvgpr_read_b32 v159,a15
v_mfma_f32_16x16x32_bf16 v[100:103],v[196:199],v[228:231],v[100:103]
ds_read_b64_tr_b16 v[180:181],v20 offset:16384
ds_read_b64_tr_b16 v[182:183],v20 offset:20480
v_accvgpr_read_b32 v160,a16
v_accvgpr_read_b32 v161,a17
v_mfma_f32_16x16x32_bf16 v[88:91],v[200:203],v[224:227],v[88:91]
ds_read_b64_tr_b16 v[184:185],v22 offset:16384
ds_read_b64_tr_b16 v[186:187],v22 offset:20480
v_accvgpr_read_b32 v162,a18
v_accvgpr_read_b32 v163,a19
v_accvgpr_read_b32 v164,a20
v_mfma_f32_16x16x32_bf16 v[104:107],v[200:203],v[228:231],v[104:107]
ds_read_b64_tr_b16 v[188:189],v24 offset:16384
ds_read_b64_tr_b16 v[190:191],v24 offset:20480
v_accvgpr_read_b32 v165,a21
v_accvgpr_read_b32 v166,a22
v_mfma_f32_16x16x32_bf16 v[92:95],v[204:207],v[224:227],v[92:95]
v_accvgpr_read_b32 v167,a23
v_accvgpr_read_b32 v168,a24
v_accvgpr_read_b32 v169,a25
v_mfma_f32_16x16x32_bf16 v[108:111],v[204:207],v[228:231],v[108:111]
v_accvgpr_read_b32 v170,a26
v_accvgpr_read_b32 v171,a27
s_waitcnt lgkmcnt(4)
v_mfma_f32_16x16x32_bf16 v[80:83],v[176:179],v[208:211],v[80:83]
ds_read_b64_tr_b16 v[192:193],v18 offset:24576
ds_read_b64_tr_b16 v[194:195],v18 offset:28672
s_add_u32 m0,s5,53248
s_nop 0
buffer_load_dwordx4 v244,s[16:19],s28 offen lds
v_mfma_f32_16x16x32_bf16 v[96:99],v[176:179],v[212:215],v[96:99]
ds_read_b128 v[224:227],v26 offset:36864
ds_read_b128 v[228:231],v26 offset:37120
buffer_load_dwordx4 v245,s[16:19],s28 offen offset:1024 lds
v_mfma_f32_16x16x32_bf16 v[84:87],v[180:183],v[208:211],v[84:87]
ds_read_b64_tr_b16 v[196:197],v20 offset:24576
ds_read_b64_tr_b16 v[198:199],v20 offset:28672
buffer_load_dwordx4 v246,s[16:19],s28 offen offset:2048 lds
v_mfma_f32_16x16x32_bf16 v[100:103],v[180:183],v[212:215],v[100:103]
ds_read_b64_tr_b16 v[200:201],v22 offset:24576
ds_read_b64_tr_b16 v[202:203],v22 offset:28672
buffer_load_dwordx4 v247,s[16:19],s28 offen offset:3072 lds
s_waitcnt lgkmcnt(8)
v_mfma_f32_16x16x32_bf16 v[88:91],v[184:187],v[208:211],v[88:91]
ds_read_b64_tr_b16 v[204:205],v24 offset:24576
ds_read_b64_tr_b16 v[206:207],v24 offset:28672
s_add_u32 s28,s28,0x20000
v_accvgpr_read_b32 v172,a28
v_mfma_f32_16x16x32_bf16 v[104:107],v[184:187],v[212:215],v[104:107]
v_accvgpr_read_b32 v173,a29
v_mfma_f32_16x16x32_bf16 v[92:95],v[188:191],v[208:211],v[92:95]
v_accvgpr_read_b32 v174,a30
v_mfma_f32_16x16x32_bf16 v[108:111],v[188:191],v[212:215],v[108:111]
v_accvgpr_read_b32 v175,a31
s_waitcnt lgkmcnt(4)
v_mfma_f32_16x16x32_bf16 v[80:83],v[192:195],v[224:227],v[80:83]
s_waitcnt vmcnt(16) lgkmcnt(0)
s_barrier
s_xor_b32 s62,s2,5
s_lshl_b32 s62,s62,7
s_add_u32 s62,s62,0x2702000
s_cmp_lg_u32 s31,0
s_cbranch_scc1 L_r0_fp
v_mov_b32 v10,1
v_mov_b32 v11,0
s_mov_b64 exec,1
buffer_store_dword v10,v11,s[20:23],s62 offen sc1
s_mov_b64 exec,-1
L_r0_fp:
v_mfma_f32_16x16x32_bf16 v[96:99],v[192:195],v[228:231],v[96:99]
ds_read_b64_tr_b16 v[176:177],v18 offset:49152
ds_read_b64_tr_b16 v[178:179],v18 offset:53248
s_add_u32 m0,s30,16384
v_mfma_f32_16x16x32_bf16 v[84:87],v[196:199],v[224:227],v[84:87]
ds_read_b128 v[208:211],v26 offset:40960
ds_read_b128 v[212:215],v26 offset:41216
buffer_load_dwordx4 v244,s[16:19],s27 offen lds
v_mfma_f32_16x16x32_bf16 v[100:103],v[196:199],v[228:231],v[100:103]
ds_read_b64_tr_b16 v[180:181],v20 offset:49152
ds_read_b64_tr_b16 v[182:183],v20 offset:53248
v_mfma_f32_16x16x32_bf16 v[88:91],v[200:203],v[224:227],v[88:91]
ds_read_b64_tr_b16 v[184:185],v22 offset:49152
ds_read_b64_tr_b16 v[186:187],v22 offset:53248
buffer_load_dwordx4 v245,s[16:19],s27 offen offset:1024 lds
v_mfma_f32_16x16x32_bf16 v[104:107],v[200:203],v[228:231],v[104:107]
ds_read_b64_tr_b16 v[188:189],v24 offset:49152
ds_read_b64_tr_b16 v[190:191],v24 offset:53248
v_mfma_f32_16x16x32_bf16 v[92:95],v[204:207],v[224:227],v[92:95]
buffer_load_dwordx4 v246,s[16:19],s27 offen offset:2048 lds
v_mfma_f32_16x16x32_bf16 v[108:111],v[204:207],v[228:231],v[108:111]
buffer_load_dwordx4 v247,s[16:19],s27 offen offset:3072 lds
s_add_u32 s27,s27,0x20000
s_waitcnt lgkmcnt(4)
v_mfma_f32_16x16x32_bf16 v[80:83],v[176:179],v[208:211],v[80:83]
ds_read_b64_tr_b16 v[192:193],v18 offset:57344
ds_read_b64_tr_b16 v[194:195],v18 offset:61440
s_add_u32 m0,s30,20480
v_mfma_f32_16x16x32_bf16 v[96:99],v[176:179],v[212:215],v[96:99]
ds_read_b128 v[224:227],v26 offset:45056
ds_read_b128 v[228:231],v26 offset:45312
buffer_load_dwordx4 v244,s[16:19],s28 offen lds
v_mfma_f32_16x16x32_bf16 v[84:87],v[180:183],v[208:211],v[84:87]
ds_read_b64_tr_b16 v[196:197],v20 offset:57344
ds_read_b64_tr_b16 v[198:199],v20 offset:61440
v_mfma_f32_16x16x32_bf16 v[100:103],v[180:183],v[212:215],v[100:103]
ds_read_b64_tr_b16 v[200:201],v22 offset:57344
ds_read_b64_tr_b16 v[202:203],v22 offset:61440
buffer_load_dwordx4 v245,s[16:19],s28 offen offset:1024 lds
s_waitcnt lgkmcnt(8)
v_mfma_f32_16x16x32_bf16 v[88:91],v[184:187],v[208:211],v[88:91]
ds_read_b64_tr_b16 v[204:205],v24 offset:57344
ds_read_b64_tr_b16 v[206:207],v24 offset:61440
v_mfma_f32_16x16x32_bf16 v[104:107],v[184:187],v[212:215],v[104:107]
buffer_load_dwordx4 v246,s[16:19],s28 offen offset:2048 lds
v_mfma_f32_16x16x32_bf16 v[92:95],v[188:191],v[208:211],v[92:95]
v_mfma_f32_16x16x32_bf16 v[108:111],v[188:191],v[212:215],v[108:111]
buffer_load_dwordx4 v247,s[16:19],s28 offen offset:3072 lds
s_add_u32 s28,s28,0x20000
s_waitcnt lgkmcnt(4)
v_mfma_f32_16x16x32_bf16 v[80:83],v[192:195],v[224:227],v[80:83]
s_waitcnt vmcnt(16) lgkmcnt(0)
s_barrier
v_mfma_f32_16x16x32_bf16 v[96:99],v[192:195],v[228:231],v[96:99]
ds_read_b64_tr_b16 v[176:177],v19 offset:16384
ds_read_b64_tr_b16 v[178:179],v19 offset:20480
s_add_u32 m0,s30,49152
v_mfma_f32_16x16x32_bf16 v[84:87],v[196:199],v[224:227],v[84:87]
ds_read_b128 v[208:211],v27
ds_read_b128 v[212:215],v27 offset:256
buffer_load_dwordx4 v244,s[16:19],s27 offen lds
v_mfma_f32_16x16x32_bf16 v[100:103],v[196:199],v[228:231],v[100:103]
ds_read_b64_tr_b16 v[180:181],v21 offset:16384
ds_read_b64_tr_b16 v[182:183],v21 offset:20480
v_mfma_f32_16x16x32_bf16 v[88:91],v[200:203],v[224:227],v[88:91]
ds_read_b64_tr_b16 v[184:185],v23 offset:16384
ds_read_b64_tr_b16 v[186:187],v23 offset:20480
buffer_load_dwordx4 v245,s[16:19],s27 offen offset:1024 lds
v_mfma_f32_16x16x32_bf16 v[104:107],v[200:203],v[228:231],v[104:107]
ds_read_b64_tr_b16 v[188:189],v25 offset:16384
ds_read_b64_tr_b16 v[190:191],v25 offset:20480
v_mfma_f32_16x16x32_bf16 v[92:95],v[204:207],v[224:227],v[92:95]
buffer_load_dwordx4 v246,s[16:19],s27 offen offset:2048 lds
v_mfma_f32_16x16x32_bf16 v[108:111],v[204:207],v[228:231],v[108:111]
buffer_load_dwordx4 v247,s[16:19],s27 offen offset:3072 lds
s_add_u32 s27,s27,0x20000
s_waitcnt lgkmcnt(4)
v_mfma_f32_16x16x32_bf16 v[80:83],v[176:179],v[208:211],v[80:83]
ds_read_b64_tr_b16 v[192:193],v19 offset:24576
ds_read_b64_tr_b16 v[194:195],v19 offset:28672
s_add_u32 m0,s30,53248
v_mfma_f32_16x16x32_bf16 v[96:99],v[176:179],v[212:215],v[96:99]
ds_read_b128 v[224:227],v27 offset:4096
ds_read_b128 v[228:231],v27 offset:4352
buffer_load_dwordx4 v244,s[16:19],s28 offen lds
v_mfma_f32_16x16x32_bf16 v[84:87],v[180:183],v[208:211],v[84:87]
ds_read_b64_tr_b16 v[196:197],v21 offset:24576
ds_read_b64_tr_b16 v[198:199],v21 offset:28672
v_mfma_f32_16x16x32_bf16 v[100:103],v[180:183],v[212:215],v[100:103]
ds_read_b64_tr_b16 v[200:201],v23 offset:24576
ds_read_b64_tr_b16 v[202:203],v23 offset:28672
buffer_load_dwordx4 v245,s[16:19],s28 offen offset:1024 lds
s_waitcnt lgkmcnt(8)
v_mfma_f32_16x16x32_bf16 v[88:91],v[184:187],v[208:211],v[88:91]
ds_read_b64_tr_b16 v[204:205],v25 offset:24576
ds_read_b64_tr_b16 v[206:207],v25 offset:28672
v_mfma_f32_16x16x32_bf16 v[104:107],v[184:187],v[212:215],v[104:107]
buffer_load_dwordx4 v246,s[16:19],s28 offen offset:2048 lds
v_mfma_f32_16x16x32_bf16 v[92:95],v[188:191],v[208:211],v[92:95]
v_mfma_f32_16x16x32_bf16 v[108:111],v[188:191],v[212:215],v[108:111]
buffer_load_dwordx4 v247,s[16:19],s28 offen offset:3072 lds
s_add_u32 s28,s28,0x20000
s_waitcnt lgkmcnt(4)
v_mfma_f32_16x16x32_bf16 v[80:83],v[192:195],v[224:227],v[80:83]
s_waitcnt vmcnt(16) lgkmcnt(0)
s_barrier
v_mfma_f32_16x16x32_bf16 v[96:99],v[192:195],v[228:231],v[96:99]
ds_read_b64_tr_b16 v[176:177],v19 offset:49152
ds_read_b64_tr_b16 v[178:179],v19 offset:53248
s_add_u32 m0,s5,16384
v_mfma_f32_16x16x32_bf16 v[84:87],v[196:199],v[224:227],v[84:87]
ds_read_b128 v[208:211],v27 offset:8192
ds_read_b128 v[212:215],v27 offset:8448
buffer_load_dwordx4 v244,s[16:19],s27 offen lds
v_mfma_f32_16x16x32_bf16 v[100:103],v[196:199],v[228:231],v[100:103]
ds_read_b64_tr_b16 v[180:181],v21 offset:49152
ds_read_b64_tr_b16 v[182:183],v21 offset:53248
v_mfma_f32_16x16x32_bf16 v[88:91],v[200:203],v[224:227],v[88:91]
ds_read_b64_tr_b16 v[184:185],v23 offset:49152
ds_read_b64_tr_b16 v[186:187],v23 offset:53248
buffer_load_dwordx4 v245,s[16:19],s27 offen offset:1024 lds
v_mfma_f32_16x16x32_bf16 v[104:107],v[200:203],v[228:231],v[104:107]
ds_read_b64_tr_b16 v[188:189],v25 offset:49152
ds_read_b64_tr_b16 v[190:191],v25 offset:53248
v_mfma_f32_16x16x32_bf16 v[92:95],v[204:207],v[224:227],v[92:95]
buffer_load_dwordx4 v246,s[16:19],s27 offen offset:2048 lds
v_mfma_f32_16x16x32_bf16 v[108:111],v[204:207],v[228:231],v[108:111]
buffer_load_dwordx4 v247,s[16:19],s27 offen offset:3072 lds
s_add_u32 s27,s27,0x20000
s_waitcnt lgkmcnt(4)
v_mfma_f32_16x16x32_bf16 v[80:83],v[176:179],v[208:211],v[80:83]
ds_read_b64_tr_b16 v[192:193],v19 offset:57344
ds_read_b64_tr_b16 v[194:195],v19 offset:61440
s_add_u32 m0,s5,20480
v_mfma_f32_16x16x32_bf16 v[96:99],v[176:179],v[212:215],v[96:99]
ds_read_b128 v[224:227],v27 offset:12288
ds_read_b128 v[228:231],v27 offset:12544
v_mfma_f32_16x16x32_bf16 v[84:87],v[180:183],v[208:211],v[84:87]
ds_read_b64_tr_b16 v[196:197],v21 offset:57344
ds_read_b64_tr_b16 v[198:199],v21 offset:61440
buffer_load_dwordx4 v244,s[16:19],s28 offen lds
v_mfma_f32_16x16x32_bf16 v[100:103],v[180:183],v[212:215],v[100:103]
ds_read_b64_tr_b16 v[200:201],v23 offset:57344
ds_read_b64_tr_b16 v[202:203],v23 offset:61440
buffer_load_dwordx4 v245,s[16:19],s28 offen offset:1024 lds
s_waitcnt lgkmcnt(8)
v_mfma_f32_16x16x32_bf16 v[88:91],v[184:187],v[208:211],v[88:91]
ds_read_b64_tr_b16 v[204:205],v25 offset:57344
ds_read_b64_tr_b16 v[206:207],v25 offset:61440
buffer_load_dwordx4 v246,s[16:19],s28 offen offset:2048 lds
v_mfma_f32_16x16x32_bf16 v[104:107],v[184:187],v[212:215],v[104:107]
buffer_load_dwordx4 v247,s[16:19],s28 offen offset:3072 lds
v_mfma_f32_16x16x32_bf16 v[92:95],v[188:191],v[208:211],v[92:95]
s_add_u32 s28,s28,0x20000
v_mfma_f32_16x16x32_bf16 v[108:111],v[188:191],v[212:215],v[108:111]
s_lshl_b32 s62,s2,7
s_add_u32 s62,s62,0x2702000
v_mov_b32 v241,s62
buffer_load_dword v240,v241,s[20:23],0 offen sc1
s_waitcnt lgkmcnt(4)
v_mfma_f32_16x16x32_bf16 v[80:83],v[192:195],v[224:227],v[80:83]
s_waitcnt vmcnt(17) lgkmcnt(0)
s_barrier
v_mfma_f32_16x16x32_bf16 v[96:99],v[192:195],v[228:231],v[96:99]
ds_read_b64_tr_b16 v[176:177],v18 offset:16384
ds_read_b64_tr_b16 v[178:179],v18 offset:20480
s_add_u32 m0,s5,49152
v_mfma_f32_16x16x32_bf16 v[84:87],v[196:199],v[224:227],v[84:87]
ds_read_b128 v[208:211],v27 offset:32768
ds_read_b128 v[212:215],v27 offset:33024
buffer_load_dwordx4 v244,s[16:19],s27 offen lds
v_mfma_f32_16x16x32_bf16 v[100:103],v[196:199],v[228:231],v[100:103]
ds_read_b64_tr_b16 v[180:181],v20 offset:16384
ds_read_b64_tr_b16 v[182:183],v20 offset:20480
v_mfma_f32_16x16x32_bf16 v[88:91],v[200:203],v[224:227],v[88:91]
ds_read_b64_tr_b16 v[184:185],v22 offset:16384
ds_read_b64_tr_b16 v[186:187],v22 offset:20480
buffer_load_dwordx4 v245,s[16:19],s27 offen offset:1024 lds
v_mfma_f32_16x16x32_bf16 v[104:107],v[200:203],v[228:231],v[104:107]
ds_read_b64_tr_b16 v[188:189],v24 offset:16384
ds_read_b64_tr_b16 v[190:191],v24 offset:20480
v_mfma_f32_16x16x32_bf16 v[92:95],v[204:207],v[224:227],v[92:95]
buffer_load_dwordx4 v246,s[16:19],s27 offen offset:2048 lds
v_mfma_f32_16x16x32_bf16 v[108:111],v[204:207],v[228:231],v[108:111]
buffer_load_dwordx4 v247,s[16:19],s27 offen offset:3072 lds
s_add_u32 s27,s27,0x20000
s_waitcnt lgkmcnt(4)
v_mfma_f32_16x16x32_bf16 v[80:83],v[176:179],v[208:211],v[80:83]
ds_read_b64_tr_b16 v[192:193],v18 offset:24576
ds_read_b64_tr_b16 v[194:195],v18 offset:28672
s_add_u32 m0,s5,53248
v_mfma_f32_16x16x32_bf16 v[96:99],v[176:179],v[212:215],v[96:99]
ds_read_b128 v[224:227],v27 offset:36864
ds_read_b128 v[228:231],v27 offset:37120
buffer_load_dwordx4 v244,s[16:19],s28 offen lds
v_mfma_f32_16x16x32_bf16 v[84:87],v[180:183],v[208:211],v[84:87]
ds_read_b64_tr_b16 v[196:197],v20 offset:24576
ds_read_b64_tr_b16 v[198:199],v20 offset:28672
v_mfma_f32_16x16x32_bf16 v[100:103],v[180:183],v[212:215],v[100:103]
ds_read_b64_tr_b16 v[200:201],v22 offset:24576
ds_read_b64_tr_b16 v[202:203],v22 offset:28672
buffer_load_dwordx4 v245,s[16:19],s28 offen offset:1024 lds
s_waitcnt lgkmcnt(8)
v_mfma_f32_16x16x32_bf16 v[88:91],v[184:187],v[208:211],v[88:91]
ds_read_b64_tr_b16 v[204:205],v24 offset:24576
ds_read_b64_tr_b16 v[206:207],v24 offset:28672
v_mfma_f32_16x16x32_bf16 v[104:107],v[184:187],v[212:215],v[104:107]
buffer_load_dwordx4 v246,s[16:19],s28 offen offset:2048 lds
v_mfma_f32_16x16x32_bf16 v[92:95],v[188:191],v[208:211],v[92:95]
v_mfma_f32_16x16x32_bf16 v[108:111],v[188:191],v[212:215],v[108:111]
buffer_load_dwordx4 v247,s[16:19],s28 offen offset:3072 lds
s_add_u32 s28,s28,0x20000
s_waitcnt lgkmcnt(4)
v_mfma_f32_16x16x32_bf16 v[80:83],v[192:195],v[224:227],v[80:83]
s_waitcnt vmcnt(17) lgkmcnt(0)
s_barrier
v_mfma_f32_16x16x32_bf16 v[96:99],v[192:195],v[228:231],v[96:99]
ds_read_b64_tr_b16 v[176:177],v18 offset:49152
ds_read_b64_tr_b16 v[178:179],v18 offset:53248
s_add_u32 m0,s30,16384
v_mfma_f32_16x16x32_bf16 v[84:87],v[196:199],v[224:227],v[84:87]
ds_read_b128 v[208:211],v27 offset:40960
ds_read_b128 v[212:215],v27 offset:41216
buffer_load_dwordx4 v244,s[16:19],s27 offen lds
v_mfma_f32_16x16x32_bf16 v[100:103],v[196:199],v[228:231],v[100:103]
ds_read_b64_tr_b16 v[180:181],v20 offset:49152
ds_read_b64_tr_b16 v[182:183],v20 offset:53248
v_mfma_f32_16x16x32_bf16 v[88:91],v[200:203],v[224:227],v[88:91]
ds_read_b64_tr_b16 v[184:185],v22 offset:49152
ds_read_b64_tr_b16 v[186:187],v22 offset:53248
buffer_load_dwordx4 v245,s[16:19],s27 offen offset:1024 lds
v_mfma_f32_16x16x32_bf16 v[104:107],v[200:203],v[228:231],v[104:107]
ds_read_b64_tr_b16 v[188:189],v24 offset:49152
ds_read_b64_tr_b16 v[190:191],v24 offset:53248
v_mfma_f32_16x16x32_bf16 v[92:95],v[204:207],v[224:227],v[92:95]
buffer_load_dwordx4 v246,s[16:19],s27 offen offset:2048 lds
v_mfma_f32_16x16x32_bf16 v[108:111],v[204:207],v[228:231],v[108:111]
buffer_load_dwordx4 v247,s[16:19],s27 offen offset:3072 lds
s_add_u32 s27,s27,0x20000
s_waitcnt lgkmcnt(4)
v_mfma_f32_16x16x32_bf16 v[80:83],v[176:179],v[208:211],v[80:83]
ds_read_b64_tr_b16 v[192:193],v18 offset:57344
ds_read_b64_tr_b16 v[194:195],v18 offset:61440
s_add_u32 m0,s30,20480
v_mfma_f32_16x16x32_bf16 v[96:99],v[176:179],v[212:215],v[96:99]
ds_read_b128 v[224:227],v27 offset:45056
ds_read_b128 v[228:231],v27 offset:45312
v_mfma_f32_16x16x32_bf16 v[84:87],v[180:183],v[208:211],v[84:87]
ds_read_b64_tr_b16 v[196:197],v20 offset:57344
ds_read_b64_tr_b16 v[198:199],v20 offset:61440
buffer_load_dwordx4 v244,s[16:19],s28 offen lds
v_mfma_f32_16x16x32_bf16 v[100:103],v[180:183],v[212:215],v[100:103]
ds_read_b64_tr_b16 v[200:201],v22 offset:57344
ds_read_b64_tr_b16 v[202:203],v22 offset:61440
buffer_load_dwordx4 v245,s[16:19],s28 offen offset:1024 lds
s_waitcnt lgkmcnt(8)
v_mfma_f32_16x16x32_bf16 v[88:91],v[184:187],v[208:211],v[88:91]
ds_read_b64_tr_b16 v[204:205],v24 offset:57344
ds_read_b64_tr_b16 v[206:207],v24 offset:61440
buffer_load_dwordx4 v246,s[16:19],s28 offen offset:2048 lds
v_mfma_f32_16x16x32_bf16 v[104:107],v[184:187],v[212:215],v[104:107]
buffer_load_dwordx4 v247,s[16:19],s28 offen offset:3072 lds
v_mfma_f32_16x16x32_bf16 v[92:95],v[188:191],v[208:211],v[92:95]
s_add_u32 s28,s28,0x20000
v_mfma_f32_16x16x32_bf16 v[108:111],v[188:191],v[212:215],v[108:111]
s_waitcnt vmcnt(16)
s_mov_b32 s75,0x40000
L_r0_pp_chk:
v_cmp_eq_u32 vcc,1,v240
s_sub_u32 s75,s75,1
s_cbranch_scc1 L_r0_pp_ok
s_nop 1
s_cmp_eq_u64 vcc,-1
s_cbranch_scc1 L_r0_pp_ok
s_sleep 4
buffer_load_dword v240,v241,s[20:23],0 offen sc1
s_waitcnt vmcnt(0)
s_branch L_r0_pp_chk
L_r0_pp_ok:
s_lshl_b32 s62,s2,14
s_lshl_b32 s63,s45,13
s_add_u32 s62,s62,s63
s_add_u32 s62,s62,0x2a00000
buffer_load_dwordx4 v[32:35],v9,s[20:23],s62 offen sc1
buffer_load_dwordx4 v[36:39],v9,s[20:23],s62 offen offset:1024 sc1
buffer_load_dwordx4 v[40:43],v9,s[20:23],s62 offen offset:2048 sc1
buffer_load_dwordx4 v[44:47],v9,s[20:23],s62 offen offset:3072 sc1
s_waitcnt lgkmcnt(4)
v_mfma_f32_16x16x32_bf16 v[80:83],v[192:195],v[224:227],v[80:83]
s_waitcnt lgkmcnt(0)
s_barrier
v_mfma_f32_16x16x32_bf16 v[96:99],v[192:195],v[228:231],v[96:99]
ds_read_b64_tr_b16 v[176:177],v19 offset:16384
ds_read_b64_tr_b16 v[178:179],v19 offset:20480
s_add_u32 m0,s30,49152
v_mfma_f32_16x16x32_bf16 v[84:87],v[196:199],v[224:227],v[84:87]
ds_read_b128 v[208:211],v26
ds_read_b128 v[212:215],v26 offset:256
buffer_load_dwordx4 v244,s[16:19],s27 offen lds
v_mfma_f32_16x16x32_bf16 v[100:103],v[196:199],v[228:231],v[100:103]
ds_read_b64_tr_b16 v[180:181],v21 offset:16384
ds_read_b64_tr_b16 v[182:183],v21 offset:20480
v_mfma_f32_16x16x32_bf16 v[88:91],v[200:203],v[224:227],v[88:91]
ds_read_b64_tr_b16 v[184:185],v23 offset:16384
ds_read_b64_tr_b16 v[186:187],v23 offset:20480
buffer_load_dwordx4 v245,s[16:19],s27 offen offset:1024 lds
v_mfma_f32_16x16x32_bf16 v[104:107],v[200:203],v[228:231],v[104:107]
ds_read_b64_tr_b16 v[188:189],v25 offset:16384
ds_read_b64_tr_b16 v[190:191],v25 offset:20480
v_mfma_f32_16x16x32_bf16 v[92:95],v[204:207],v[224:227],v[92:95]
buffer_load_dwordx4 v246,s[16:19],s27 offen offset:2048 lds
v_mfma_f32_16x16x32_bf16 v[108:111],v[204:207],v[228:231],v[108:111]
buffer_load_dwordx4 v247,s[16:19],s27 offen offset:3072 lds
s_add_u32 s27,s27,0x20000
s_waitcnt lgkmcnt(4)
v_mfma_f32_16x16x32_bf16 v[80:83],v[176:179],v[208:211],v[80:83]
ds_read_b64_tr_b16 v[192:193],v19 offset:24576
ds_read_b64_tr_b16 v[194:195],v19 offset:28672
s_add_u32 m0,s30,53248
s_nop 0
buffer_load_dwordx4 v244,s[16:19],s28 offen lds
buffer_load_dwordx4 v245,s[16:19],s28 offen offset:1024 lds
v_mfma_f32_16x16x32_bf16 v[96:99],v[176:179],v[212:215],v[96:99]
ds_read_b128 v[224:227],v26 offset:4096
ds_read_b128 v[228:231],v26 offset:4352
buffer_load_dwordx4 v246,s[16:19],s28 offen offset:2048 lds
buffer_load_dwordx4 v247,s[16:19],s28 offen offset:3072 lds
v_mfma_f32_16x16x32_bf16 v[84:87],v[180:183],v[208:211],v[84:87]
ds_read_b64_tr_b16 v[196:197],v21 offset:24576
ds_read_b64_tr_b16 v[198:199],v21 offset:28672
s_add_u32 s28,s28,0x20000
s_waitcnt vmcnt(8)
v_lshlrev_b32 v48,16,v32
v_mfma_f32_16x16x32_bf16 v[100:103],v[180:183],v[212:215],v[100:103]
ds_read_b64_tr_b16 v[200:201],v23 offset:24576
ds_read_b64_tr_b16 v[202:203],v23 offset:28672
v_and_b32 v49,s51,v32
v_add_f32 v112,v144,v48
s_waitcnt lgkmcnt(8)
v_mfma_f32_16x16x32_bf16 v[88:91],v[184:187],v[208:211],v[88:91]
ds_read_b64_tr_b16 v[204:205],v25 offset:24576
ds_read_b64_tr_b16 v[206:207],v25 offset:28672
v_add_f32 v113,v145,v49
v_lshlrev_b32 v48,16,v33
v_and_b32 v49,s51,v33
v_mfma_f32_16x16x32_bf16 v[104:107],v[184:187],v[212:215],v[104:107]
v_add_f32 v114,v146,v48
v_add_f32 v115,v147,v49
v_mfma_f32_16x16x32_bf16 v[92:95],v[188:191],v[208:211],v[92:95]
v_lshlrev_b32 v48,16,v34
v_and_b32 v49,s51,v34
v_add_f32 v116,v148,v48
v_mfma_f32_16x16x32_bf16 v[108:111],v[188:191],v[212:215],v[108:111]
v_add_f32 v117,v149,v49
v_lshlrev_b32 v48,16,v35
s_waitcnt lgkmcnt(4)
v_mfma_f32_16x16x32_bf16 v[80:83],v[192:195],v[224:227],v[80:83]
s_waitcnt lgkmcnt(0)
s_barrier
v_and_b32 v49,s51,v35
v_add_f32 v118,v150,v48
v_add_f32 v119,v151,v49
v_mfma_f32_16x16x32_bf16 v[96:99],v[192:195],v[228:231],v[96:99]
ds_read_b64_tr_b16 v[176:177],v19 offset:49152
ds_read_b64_tr_b16 v[178:179],v19 offset:53248
v_lshlrev_b32 v48,16,v36
v_and_b32 v49,s51,v36
v_mfma_f32_16x16x32_bf16 v[84:87],v[196:199],v[224:227],v[84:87]
ds_read_b128 v[208:211],v26 offset:8192
ds_read_b128 v[212:215],v26 offset:8448
v_add_f32 v120,v152,v48
v_add_f32 v121,v153,v49
v_mfma_f32_16x16x32_bf16 v[100:103],v[196:199],v[228:231],v[100:103]
ds_read_b64_tr_b16 v[180:181],v21 offset:49152
ds_read_b64_tr_b16 v[182:183],v21 offset:53248
v_lshlrev_b32 v48,16,v37
v_and_b32 v49,s51,v37
v_mfma_f32_16x16x32_bf16 v[88:91],v[200:203],v[224:227],v[88:91]
ds_read_b64_tr_b16 v[184:185],v23 offset:49152
ds_read_b64_tr_b16 v[186:187],v23 offset:53248
v_add_f32 v122,v154,v48
v_add_f32 v123,v155,v49
v_lshlrev_b32 v48,16,v38
v_mfma_f32_16x16x32_bf16 v[104:107],v[200:203],v[228:231],v[104:107]
ds_read_b64_tr_b16 v[188:189],v25 offset:49152
ds_read_b64_tr_b16 v[190:191],v25 offset:53248
v_and_b32 v49,s51,v38
v_add_f32 v124,v156,v48
v_mfma_f32_16x16x32_bf16 v[92:95],v[204:207],v[224:227],v[92:95]
v_add_f32 v125,v157,v49
v_lshlrev_b32 v48,16,v39
v_mfma_f32_16x16x32_bf16 v[108:111],v[204:207],v[228:231],v[108:111]
v_and_b32 v49,s51,v39
v_add_f32 v126,v158,v48
s_waitcnt lgkmcnt(4)
v_mfma_f32_16x16x32_bf16 v[80:83],v[176:179],v[208:211],v[80:83]
ds_read_b64_tr_b16 v[192:193],v19 offset:57344
ds_read_b64_tr_b16 v[194:195],v19 offset:61440
v_add_f32 v127,v159,v49
v_lshlrev_b32 v48,16,v40
v_mfma_f32_16x16x32_bf16 v[96:99],v[176:179],v[212:215],v[96:99]
ds_read_b128 v[224:227],v26 offset:12288
ds_read_b128 v[228:231],v26 offset:12544
v_and_b32 v49,s51,v40
v_add_f32 v128,v160,v48
v_mfma_f32_16x16x32_bf16 v[84:87],v[180:183],v[208:211],v[84:87]
ds_read_b64_tr_b16 v[196:197],v21 offset:57344
ds_read_b64_tr_b16 v[198:199],v21 offset:61440
v_add_f32 v129,v161,v49
v_lshlrev_b32 v48,16,v41
v_mfma_f32_16x16x32_bf16 v[100:103],v[180:183],v[212:215],v[100:103]
ds_read_b64_tr_b16 v[200:201],v23 offset:57344
ds_read_b64_tr_b16 v[202:203],v23 offset:61440
v_and_b32 v49,s51,v41
s_waitcnt lgkmcnt(8)
v_mfma_f32_16x16x32_bf16 v[88:91],v[184:187],v[208:211],v[88:91]
ds_read_b64_tr_b16 v[204:205],v25 offset:57344
ds_read_b64_tr_b16 v[206:207],v25 offset:61440
v_add_f32 v130,v162,v48
v_add_f32 v131,v163,v49
v_mfma_f32_16x16x32_bf16 v[104:107],v[184:187],v[212:215],v[104:107]
v_lshlrev_b32 v48,16,v42
v_and_b32 v49,s51,v42
v_mfma_f32_16x16x32_bf16 v[92:95],v[188:191],v[208:211],v[92:95]
v_add_f32 v132,v164,v48
v_add_f32 v133,v165,v49
v_mfma_f32_16x16x32_bf16 v[108:111],v[188:191],v[212:215],v[108:111]
v_lshlrev_b32 v48,16,v43
s_waitcnt lgkmcnt(4)
v_mfma_f32_16x16x32_bf16 v[80:83],v[192:195],v[224:227],v[80:83]
s_waitcnt lgkmcnt(0)
s_barrier
v_and_b32 v49,s51,v43
v_add_f32 v134,v166,v48
v_add_f32 v135,v167,v49
v_mfma_f32_16x16x32_bf16 v[96:99],v[192:195],v[228:231],v[96:99]
ds_read_b64_tr_b16 v[176:177],v18 offset:16384
ds_read_b64_tr_b16 v[178:179],v18 offset:20480
v_lshlrev_b32 v48,16,v44
v_and_b32 v49,s51,v44
v_mfma_f32_16x16x32_bf16 v[84:87],v[196:199],v[224:227],v[84:87]
ds_read_b128 v[208:211],v26 offset:32768
ds_read_b128 v[212:215],v26 offset:33024
v_add_f32 v136,v168,v48
v_add_f32 v137,v169,v49
v_mfma_f32_16x16x32_bf16 v[100:103],v[196:199],v[228:231],v[100:103]
ds_read_b64_tr_b16 v[180:181],v20 offset:16384
ds_read_b64_tr_b16 v[182:183],v20 offset:20480
v_lshlrev_b32 v48,16,v45
v_and_b32 v49,s51,v45
v_mfma_f32_16x16x32_bf16 v[88:91],v[200:203],v[224:227],v[88:91]
ds_read_b64_tr_b16 v[184:185],v22 offset:16384
ds_read_b64_tr_b16 v[186:187],v22 offset:20480
v_add_f32 v138,v170,v48
v_add_f32 v139,v171,v49
v_lshlrev_b32 v48,16,v46
v_mfma_f32_16x16x32_bf16 v[104:107],v[200:203],v[228:231],v[104:107]
ds_read_b64_tr_b16 v[188:189],v24 offset:16384
ds_read_b64_tr_b16 v[190:191],v24 offset:20480
v_and_b32 v49,s51,v46
v_add_f32 v140,v172,v48
v_mfma_f32_16x16x32_bf16 v[92:95],v[204:207],v[224:227],v[92:95]
v_add_f32 v141,v173,v49
v_lshlrev_b32 v48,16,v47
v_mfma_f32_16x16x32_bf16 v[108:111],v[204:207],v[228:231],v[108:111]
v_and_b32 v49,s51,v47
v_add_f32 v142,v174,v48
s_waitcnt lgkmcnt(4)
v_mfma_f32_16x16x32_bf16 v[80:83],v[176:179],v[208:211],v[80:83]
ds_read_b64_tr_b16 v[192:193],v18 offset:24576
ds_read_b64_tr_b16 v[194:195],v18 offset:28672
v_add_f32 v143,v175,v49
v_mfma_f32_16x16x32_bf16 v[96:99],v[176:179],v[212:215],v[96:99]
ds_read_b128 v[224:227],v26 offset:36864
ds_read_b128 v[228:231],v26 offset:37120
v_mfma_f32_16x16x32_bf16 v[84:87],v[180:183],v[208:211],v[84:87]
ds_read_b64_tr_b16 v[196:197],v20 offset:24576
ds_read_b64_tr_b16 v[198:199],v20 offset:28672
v_mfma_f32_16x16x32_bf16 v[100:103],v[180:183],v[212:215],v[100:103]
ds_read_b64_tr_b16 v[200:201],v22 offset:24576
ds_read_b64_tr_b16 v[202:203],v22 offset:28672
s_waitcnt lgkmcnt(8)
v_mfma_f32_16x16x32_bf16 v[88:91],v[184:187],v[208:211],v[88:91]
ds_read_b64_tr_b16 v[204:205],v24 offset:24576
ds_read_b64_tr_b16 v[206:207],v24 offset:28672
v_mfma_f32_16x16x32_bf16 v[104:107],v[184:187],v[212:215],v[104:107]
v_mfma_f32_16x16x32_bf16 v[92:95],v[188:191],v[208:211],v[92:95]
v_mfma_f32_16x16x32_bf16 v[108:111],v[188:191],v[212:215],v[108:111]
s_waitcnt lgkmcnt(4)
v_mfma_f32_16x16x32_bf16 v[80:83],v[192:195],v[224:227],v[80:83]
s_waitcnt vmcnt(0) lgkmcnt(0)
s_barrier
v_mfma_f32_16x16x32_bf16 v[96:99],v[192:195],v[228:231],v[96:99]
ds_read_b64_tr_b16 v[176:177],v18 offset:49152
ds_read_b64_tr_b16 v[178:179],v18 offset:53248
v_mfma_f32_16x16x32_bf16 v[84:87],v[196:199],v[224:227],v[84:87]
ds_read_b128 v[208:211],v26 offset:40960
ds_read_b128 v[212:215],v26 offset:41216
v_mfma_f32_16x16x32_bf16 v[100:103],v[196:199],v[228:231],v[100:103]
ds_read_b64_tr_b16 v[180:181],v20 offset:49152
ds_read_b64_tr_b16 v[182:183],v20 offset:53248
v_mfma_f32_16x16x32_bf16 v[88:91],v[200:203],v[224:227],v[88:91]
ds_read_b64_tr_b16 v[184:185],v22 offset:49152
ds_read_b64_tr_b16 v[186:187],v22 offset:53248
v_mfma_f32_16x16x32_bf16 v[104:107],v[200:203],v[228:231],v[104:107]
ds_read_b64_tr_b16 v[188:189],v24 offset:49152
ds_read_b64_tr_b16 v[190:191],v24 offset:53248
v_mfma_f32_16x16x32_bf16 v[92:95],v[204:207],v[224:227],v[92:95]
v_mfma_f32_16x16x32_bf16 v[108:111],v[204:207],v[228:231],v[108:111]
s_waitcnt lgkmcnt(4)
v_mfma_f32_16x16x32_bf16 v[80:83],v[176:179],v[208:211],v[80:83]
ds_read_b64_tr_b16 v[192:193],v18 offset:57344
ds_read_b64_tr_b16 v[194:195],v18 offset:61440
v_mfma_f32_16x16x32_bf16 v[96:99],v[176:179],v[212:215],v[96:99]
ds_read_b128 v[224:227],v26 offset:45056
ds_read_b128 v[228:231],v26 offset:45312
v_mfma_f32_16x16x32_bf16 v[84:87],v[180:183],v[208:211],v[84:87]
ds_read_b64_tr_b16 v[196:197],v20 offset:57344
ds_read_b64_tr_b16 v[198:199],v20 offset:61440
v_mfma_f32_16x16x32_bf16 v[100:103],v[180:183],v[212:215],v[100:103]
ds_read_b64_tr_b16 v[200:201],v22 offset:57344
ds_read_b64_tr_b16 v[202:203],v22 offset:61440
s_waitcnt lgkmcnt(8)
v_mfma_f32_16x16x32_bf16 v[88:91],v[184:187],v[208:211],v[88:91]
ds_read_b64_tr_b16 v[204:205],v24 offset:57344
ds_read_b64_tr_b16 v[206:207],v24 offset:61440
v_mfma_f32_16x16x32_bf16 v[104:107],v[184:187],v[212:215],v[104:107]
v_mfma_f32_16x16x32_bf16 v[92:95],v[188:191],v[208:211],v[92:95]
v_mfma_f32_16x16x32_bf16 v[108:111],v[188:191],v[212:215],v[108:111]
s_waitcnt lgkmcnt(4)
v_mfma_f32_16x16x32_bf16 v[80:83],v[192:195],v[224:227],v[80:83]
v_mfma_f32_16x16x32_bf16 v[96:99],v[192:195],v[228:231],v[96:99]
v_mfma_f32_16x16x32_bf16 v[84:87],v[196:199],v[224:227],v[84:87]
v_mfma_f32_16x16x32_bf16 v[100:103],v[196:199],v[228:231],v[100:103]
s_waitcnt lgkmcnt(0)
v_mfma_f32_16x16x32_bf16 v[88:91],v[200:203],v[224:227],v[88:91]
v_mfma_f32_16x16x32_bf16 v[104:107],v[200:203],v[228:231],v[104:107]
v_mfma_f32_16x16x32_bf16 v[92:95],v[204:207],v[224:227],v[92:95]
v_mfma_f32_16x16x32_bf16 v[108:111],v[204:207],v[228:231],v[108:111]
s_nop 3
v_pk_add_f32 v[80:81],v[80:81],v[112:113]
v_pk_add_f32 v[82:83],v[82:83],v[114:115]
v_pk_add_f32 v[84:85],v[84:85],v[116:117]
v_pk_add_f32 v[86:87],v[86:87],v[118:119]
v_cvt_pk_bf16_f32 v48,v80,v81
v_cvt_pk_bf16_f32 v49,v82,v83
v_cvt_pk_bf16_f32 v50,v84,v85
v_cvt_pk_bf16_f32 v51,v86,v87
v_pk_add_f32 v[88:89],v[88:89],v[120:121]
v_pk_add_f32 v[90:91],v[90:91],v[122:123]
v_pk_add_f32 v[92:93],v[92:93],v[124:125]
v_pk_add_f32 v[94:95],v[94:95],v[126:127]
v_cvt_pk_bf16_f32 v52,v88,v89
v_cvt_pk_bf16_f32 v53,v90,v91
v_cvt_pk_bf16_f32 v54,v92,v93
v_cvt_pk_bf16_f32 v55,v94,v95
v_permlane16_swap_b32 v48,v50
v_permlane16_swap_b32 v49,v51
buffer_store_dwordx4 v[48:51],v79,s[56:59],s48 offen
v_pk_add_f32 v[96:97],v[96:97],v[128:129]
v_pk_add_f32 v[98:99],v[98:99],v[130:131]
v_pk_add_f32 v[100:101],v[100:101],v[132:133]
v_pk_add_f32 v[102:103],v[102:103],v[134:135]
v_cvt_pk_bf16_f32 v56,v96,v97
v_cvt_pk_bf16_f32 v57,v98,v99
v_cvt_pk_bf16_f32 v58,v100,v101
v_cvt_pk_bf16_f32 v59,v102,v103
v_permlane16_swap_b32 v52,v54
v_permlane16_swap_b32 v53,v55
buffer_store_dwordx4 v[52:55],v79,s[56:59],s48 offen offset:64
v_pk_add_f32 v[104:105],v[104:105],v[136:137]
v_pk_add_f32 v[106:107],v[106:107],v[138:139]
v_pk_add_f32 v[108:109],v[108:109],v[140:141]
v_pk_add_f32 v[110:111],v[110:111],v[142:143]
v_cvt_pk_bf16_f32 v60,v104,v105
v_cvt_pk_bf16_f32 v61,v106,v107
v_cvt_pk_bf16_f32 v62,v108,v109
v_cvt_pk_bf16_f32 v63,v110,v111
v_permlane16_swap_b32 v56,v58
v_permlane16_swap_b32 v57,v59
buffer_store_dwordx4 v[56:59],v79,s[56:59],s49 offen
s_nop 1
v_permlane16_swap_b32 v60,v62
v_permlane16_swap_b32 v61,v63
buffer_store_dwordx4 v[60:63],v79,s[56:59],s49 offen offset:64
s_endpgm
L_r1:
s_waitcnt lgkmcnt(6)
v_mfma_f32_16x16x32_bf16 a[0:3],v[176:179],v[208:211],a[0:3]
ds_read_b64_tr_b16 v[192:193],v19 offset:24576
ds_read_b64_tr_b16 v[194:195],v19 offset:28672
v_mfma_f32_16x16x32_bf16 a[4:7],v[180:183],v[208:211],a[4:7]
s_add_u32 m0,s29,49152
v_mfma_f32_16x16x32_bf16 a[16:19],v[176:179],v[212:215],a[16:19]
ds_read_b128 v[224:227],v17 offset:8192
ds_read_b64_tr_b16 v[196:197],v21 offset:24576
v_mfma_f32_16x16x32_bf16 a[20:23],v[180:183],v[212:215],a[20:23]
buffer_load_dwordx4 v244,s[12:15],s26 offen lds
s_waitcnt lgkmcnt(4)
v_mfma_f32_16x16x32_bf16 a[8:11],v[184:187],v[208:211],a[8:11]
ds_read_b64_tr_b16 v[198:199],v21 offset:28672
ds_read_b128 v[228:231],v17 offset:8448
v_mfma_f32_16x16x32_bf16 a[24:27],v[184:187],v[212:215],a[24:27]
buffer_load_dwordx4 v245,s[12:15],s26 offen offset:1024 lds
v_mfma_f32_16x16x32_bf16 a[32:35],v[176:179],v[216:219],a[32:35]
ds_read_b64_tr_b16 v[200:201],v23 offset:24576
ds_read_b64_tr_b16 v[202:203],v23 offset:28672
v_mfma_f32_16x16x32_bf16 a[36:39],v[180:183],v[216:219],a[36:39]
buffer_load_dwordx4 v246,s[12:15],s26 offen offset:2048 lds
v_mfma_f32_16x16x32_bf16 a[40:43],v[184:187],v[216:219],a[40:43]
ds_read_b128 v[232:235],v17 offset:9216
ds_read_b64_tr_b16 v[204:205],v25 offset:24576
v_mfma_f32_16x16x32_bf16 a[12:15],v[188:191],v[208:211],a[12:15]
buffer_load_dwordx4 v247,s[12:15],s26 offen offset:3072 lds
v_mfma_f32_16x16x32_bf16 a[28:31],v[188:191],v[212:215],a[28:31]
ds_read_b64_tr_b16 v[206:207],v25 offset:28672
ds_read_b128 v[236:239],v17 offset:9472
v_mfma_f32_16x16x32_bf16 a[44:47],v[188:191],v[216:219],a[44:47]
s_add_u32 s26,s26,s74
v_mfma_f32_16x16x32_bf16 a[48:51],v[176:179],v[220:223],a[48:51]
v_mfma_f32_16x16x32_bf16 a[52:55],v[180:183],v[220:223],a[52:55]
s_waitcnt vmcnt(8)
s_mov_b32 s75,0x40000
L_po_chk:
v_cmp_eq_u32 vcc,1,v240
s_sub_u32 s75,s75,1
s_cbranch_scc1 L_po_ok
s_nop 1
s_cmp_eq_u64 vcc,-1
s_cbranch_scc1 L_po_ok
s_sleep 4
buffer_load_dword v240,v241,s[20:23],0 offen sc1
s_waitcnt vmcnt(0)
s_branch L_po_chk
L_po_ok:
v_mfma_f32_16x16x32_bf16 a[56:59],v[184:187],v[220:223],a[56:59]
v_mfma_f32_16x16x32_bf16 a[60:63],v[188:191],v[220:223],a[60:63]
s_waitcnt lgkmcnt(6)
v_mfma_f32_16x16x32_bf16 a[0:3],v[192:195],v[224:227],a[0:3]
s_waitcnt lgkmcnt(0)
s_barrier
v_mfma_f32_16x16x32_bf16 a[4:7],v[196:199],v[224:227],a[4:7]
ds_read_b64_tr_b16 v[176:177],v19 offset:49152
ds_read_b64_tr_b16 v[178:179],v19 offset:53248
v_mfma_f32_16x16x32_bf16 a[16:19],v[192:195],v[228:231],a[16:19]
s_add_u32 m0,s36,0
v_mfma_f32_16x16x32_bf16 a[20:23],v[196:199],v[228:231],a[20:23]
ds_read_b128 v[208:211],v17 offset:32768
ds_read_b64_tr_b16 v[180:181],v21 offset:49152
v_mfma_f32_16x16x32_bf16 a[8:11],v[200:203],v[224:227],a[8:11]
buffer_load_dwordx4 v9,s[8:11],s25 offen sc1 lds
v_mfma_f32_16x16x32_bf16 a[24:27],v[200:203],v[228:231],a[24:27]
ds_read_b64_tr_b16 v[182:183],v21 offset:53248
ds_read_b128 v[212:215],v17 offset:33024
v_mfma_f32_16x16x32_bf16 a[32:35],v[192:195],v[232:235],a[32:35]
buffer_load_dwordx4 v9,s[8:11],s25 offen offset:1024 sc1 lds
v_mfma_f32_16x16x32_bf16 a[36:39],v[196:199],v[232:235],a[36:39]
ds_read_b64_tr_b16 v[184:185],v23 offset:49152
ds_read_b64_tr_b16 v[186:187],v23 offset:53248
v_mfma_f32_16x16x32_bf16 a[40:43],v[200:203],v[232:235],a[40:43]
buffer_load_dwordx4 v28,s[8:11],s25 offen offset:2048 sc1 lds
v_mfma_f32_16x16x32_bf16 a[12:15],v[204:207],v[224:227],a[12:15]
ds_read_b128 v[216:219],v17 offset:33792
ds_read_b64_tr_b16 v[188:189],v25 offset:49152
v_mfma_f32_16x16x32_bf16 a[28:31],v[204:207],v[228:231],a[28:31]
buffer_load_dwordx4 v28,s[8:11],s25 offen offset:3072 sc1 lds
v_mfma_f32_16x16x32_bf16 a[44:47],v[204:207],v[232:235],a[44:47]
ds_read_b64_tr_b16 v[190:191],v25 offset:53248
ds_read_b128 v[220:223],v17 offset:34048
v_mfma_f32_16x16x32_bf16 a[48:51],v[192:195],v[236:239],a[48:51]
s_add_u32 s25,s25,16384
v_mfma_f32_16x16x32_bf16 a[52:55],v[196:199],v[236:239],a[52:55]
v_mfma_f32_16x16x32_bf16 a[56:59],v[200:203],v[236:239],a[56:59]
v_mfma_f32_16x16x32_bf16 a[60:63],v[204:207],v[236:239],a[60:63]
s_waitcnt lgkmcnt(6)
v_mfma_f32_16x16x32_bf16 a[0:3],v[176:179],v[208:211],a[0:3]
ds_read_b64_tr_b16 v[192:193],v19 offset:57344
ds_read_b64_tr_b16 v[194:195],v19 offset:61440
v_mfma_f32_16x16x32_bf16 a[4:7],v[180:183],v[208:211],a[4:7]
s_add_u32 m0,s36,8192
v_mfma_f32_16x16x32_bf16 a[16:19],v[176:179],v[212:215],a[16:19]
ds_read_b128 v[224:227],v17 offset:40960
ds_read_b64_tr_b16 v[196:197],v21 offset:57344
v_mfma_f32_16x16x32_bf16 a[20:23],v[180:183],v[212:215],a[20:23]
buffer_load_dwordx4 v9,s[8:11],s25 offen sc1 lds
s_waitcnt lgkmcnt(4)
v_mfma_f32_16x16x32_bf16 a[8:11],v[184:187],v[208:211],a[8:11]
ds_read_b64_tr_b16 v[198:199],v21 offset:61440
ds_read_b128 v[228:231],v17 offset:41216
v_mfma_f32_16x16x32_bf16 a[24:27],v[184:187],v[212:215],a[24:27]
buffer_load_dwordx4 v9,s[8:11],s25 offen offset:1024 sc1 lds
v_mfma_f32_16x16x32_bf16 a[32:35],v[176:179],v[216:219],a[32:35]
ds_read_b64_tr_b16 v[200:201],v23 offset:57344
ds_read_b64_tr_b16 v[202:203],v23 offset:61440
v_mfma_f32_16x16x32_bf16 a[36:39],v[180:183],v[216:219],a[36:39]
buffer_load_dwordx4 v28,s[8:11],s25 offen offset:2048 sc1 lds
v_mfma_f32_16x16x32_bf16 a[40:43],v[184:187],v[216:219],a[40:43]
ds_read_b128 v[232:235],v17 offset:41984
ds_read_b64_tr_b16 v[204:205],v25 offset:57344
v_mfma_f32_16x16x32_bf16 a[12:15],v[188:191],v[208:211],a[12:15]
buffer_load_dwordx4 v28,s[8:11],s25 offen offset:3072 sc1 lds
v_mfma_f32_16x16x32_bf16 a[28:31],v[188:191],v[212:215],a[28:31]
ds_read_b64_tr_b16 v[206:207],v25 offset:61440
ds_read_b128 v[236:239],v17 offset:42240
v_mfma_f32_16x16x32_bf16 a[44:47],v[188:191],v[216:219],a[44:47]
s_add_u32 s25,s25,16384
v_mfma_f32_16x16x32_bf16 a[48:51],v[176:179],v[220:223],a[48:51]
v_mfma_f32_16x16x32_bf16 a[52:55],v[180:183],v[220:223],a[52:55]
v_mfma_f32_16x16x32_bf16 a[56:59],v[184:187],v[220:223],a[56:59]
v_mfma_f32_16x16x32_bf16 a[60:63],v[188:191],v[220:223],a[60:63]
s_waitcnt lgkmcnt(6)
v_mfma_f32_16x16x32_bf16 a[0:3],v[192:195],v[224:227],a[0:3]
s_waitcnt lgkmcnt(0)
s_barrier
v_mfma_f32_16x16x32_bf16 a[4:7],v[196:199],v[224:227],a[4:7]
ds_read_b64_tr_b16 v[176:177],v18 offset:16384
ds_read_b64_tr_b16 v[178:179],v18 offset:20480
v_mfma_f32_16x16x32_bf16 a[16:19],v[192:195],v[228:231],a[16:19]
s_add_u32 m0,s36,32768
v_mfma_f32_16x16x32_bf16 a[20:23],v[196:199],v[228:231],a[20:23]
ds_read_b128 v[208:211],v16
ds_read_b64_tr_b16 v[180:181],v20 offset:16384
v_mfma_f32_16x16x32_bf16 a[8:11],v[200:203],v[224:227],a[8:11]
buffer_load_dwordx4 v9,s[8:11],s25 offen sc1 lds
v_mfma_f32_16x16x32_bf16 a[24:27],v[200:203],v[228:231],a[24:27]
ds_read_b64_tr_b16 v[182:183],v20 offset:20480
ds_read_b128 v[212:215],v16 offset:256
v_mfma_f32_16x16x32_bf16 a[32:35],v[192:195],v[232:235],a[32:35]
buffer_load_dwordx4 v9,s[8:11],s25 offen offset:1024 sc1 lds
v_mfma_f32_16x16x32_bf16 a[36:39],v[196:199],v[232:235],a[36:39]
ds_read_b64_tr_b16 v[184:185],v22 offset:16384
ds_read_b64_tr_b16 v[186:187],v22 offset:20480
v_mfma_f32_16x16x32_bf16 a[40:43],v[200:203],v[232:235],a[40:43]
buffer_load_dwordx4 v28,s[8:11],s25 offen offset:2048 sc1 lds
v_mfma_f32_16x16x32_bf16 a[12:15],v[204:207],v[224:227],a[12:15]
ds_read_b128 v[216:219],v16 offset:1024
ds_read_b64_tr_b16 v[188:189],v24 offset:16384
v_mfma_f32_16x16x32_bf16 a[28:31],v[204:207],v[228:231],a[28:31]
buffer_load_dwordx4 v28,s[8:11],s25 offen offset:3072 sc1 lds
v_mfma_f32_16x16x32_bf16 a[44:47],v[204:207],v[232:235],a[44:47]
ds_read_b64_tr_b16 v[190:191],v24 offset:20480
ds_read_b128 v[220:223],v16 offset:1280
v_mfma_f32_16x16x32_bf16 a[48:51],v[192:195],v[236:239],a[48:51]
s_add_u32 s25,s25,16384
v_mfma_f32_16x16x32_bf16 a[52:55],v[196:199],v[236:239],a[52:55]
v_mfma_f32_16x16x32_bf16 a[56:59],v[200:203],v[236:239],a[56:59]
v_mfma_f32_16x16x32_bf16 a[60:63],v[204:207],v[236:239],a[60:63]
s_waitcnt lgkmcnt(6)
v_mfma_f32_16x16x32_bf16 a[0:3],v[176:179],v[208:211],a[0:3]
ds_read_b64_tr_b16 v[192:193],v18 offset:24576
ds_read_b64_tr_b16 v[194:195],v18 offset:28672
v_mfma_f32_16x16x32_bf16 a[4:7],v[180:183],v[208:211],a[4:7]
s_add_u32 m0,s36,40960
v_mfma_f32_16x16x32_bf16 a[16:19],v[176:179],v[212:215],a[16:19]
ds_read_b128 v[224:227],v16 offset:8192
ds_read_b64_tr_b16 v[196:197],v20 offset:24576
v_mfma_f32_16x16x32_bf16 a[20:23],v[180:183],v[212:215],a[20:23]
buffer_load_dwordx4 v9,s[8:11],s25 offen sc1 lds
s_waitcnt lgkmcnt(4)
v_mfma_f32_16x16x32_bf16 a[8:11],v[184:187],v[208:211],a[8:11]
ds_read_b64_tr_b16 v[198:199],v20 offset:28672
ds_read_b128 v[228:231],v16 offset:8448
v_mfma_f32_16x16x32_bf16 a[24:27],v[184:187],v[212:215],a[24:27]
buffer_load_dwordx4 v9,s[8:11],s25 offen offset:1024 sc1 lds
v_mfma_f32_16x16x32_bf16 a[32:35],v[176:179],v[216:219],a[32:35]
ds_read_b64_tr_b16 v[200:201],v22 offset:24576
ds_read_b64_tr_b16 v[202:203],v22 offset:28672
v_mfma_f32_16x16x32_bf16 a[36:39],v[180:183],v[216:219],a[36:39]
buffer_load_dwordx4 v28,s[8:11],s25 offen offset:2048 sc1 lds
v_mfma_f32_16x16x32_bf16 a[40:43],v[184:187],v[216:219],a[40:43]
ds_read_b128 v[232:235],v16 offset:9216
ds_read_b64_tr_b16 v[204:205],v24 offset:24576
v_mfma_f32_16x16x32_bf16 a[12:15],v[188:191],v[208:211],a[12:15]
buffer_load_dwordx4 v28,s[8:11],s25 offen offset:3072 sc1 lds
v_mfma_f32_16x16x32_bf16 a[28:31],v[188:191],v[212:215],a[28:31]
ds_read_b64_tr_b16 v[206:207],v24 offset:28672
ds_read_b128 v[236:239],v16 offset:9472
v_mfma_f32_16x16x32_bf16 a[44:47],v[188:191],v[216:219],a[44:47]
s_add_u32 s25,s25,16384
v_mfma_f32_16x16x32_bf16 a[48:51],v[176:179],v[220:223],a[48:51]
v_mfma_f32_16x16x32_bf16 a[52:55],v[180:183],v[220:223],a[52:55]
v_mfma_f32_16x16x32_bf16 a[56:59],v[184:187],v[220:223],a[56:59]
v_mfma_f32_16x16x32_bf16 a[60:63],v[188:191],v[220:223],a[60:63]
s_waitcnt lgkmcnt(6)
v_mfma_f32_16x16x32_bf16 a[0:3],v[192:195],v[224:227],a[0:3]
s_waitcnt vmcnt(16) lgkmcnt(0)
s_barrier
v_mfma_f32_16x16x32_bf16 a[4:7],v[196:199],v[224:227],a[4:7]
ds_read_b64_tr_b16 v[176:177],v18 offset:49152
ds_read_b64_tr_b16 v[178:179],v18 offset:53248
v_mfma_f32_16x16x32_bf16 a[16:19],v[192:195],v[228:231],a[16:19]
s_add_u32 m0,s33,0
v_mfma_f32_16x16x32_bf16 a[20:23],v[196:199],v[228:231],a[20:23]
ds_read_b128 v[208:211],v16 offset:32768
ds_read_b64_tr_b16 v[180:181],v20 offset:49152
v_mfma_f32_16x16x32_bf16 a[8:11],v[200:203],v[224:227],a[8:11]
buffer_load_dwordx4 v9,s[8:11],s25 offen sc1 lds
v_mfma_f32_16x16x32_bf16 a[24:27],v[200:203],v[228:231],a[24:27]
ds_read_b64_tr_b16 v[182:183],v20 offset:53248
ds_read_b128 v[212:215],v16 offset:33024
v_mfma_f32_16x16x32_bf16 a[32:35],v[192:195],v[232:235],a[32:35]
buffer_load_dwordx4 v9,s[8:11],s25 offen offset:1024 sc1 lds
v_mfma_f32_16x16x32_bf16 a[36:39],v[196:199],v[232:235],a[36:39]
ds_read_b64_tr_b16 v[184:185],v22 offset:49152
ds_read_b64_tr_b16 v[186:187],v22 offset:53248
v_mfma_f32_16x16x32_bf16 a[40:43],v[200:203],v[232:235],a[40:43]
buffer_load_dwordx4 v28,s[8:11],s25 offen offset:2048 sc1 lds
v_mfma_f32_16x16x32_bf16 a[12:15],v[204:207],v[224:227],a[12:15]
ds_read_b128 v[216:219],v16 offset:33792
ds_read_b64_tr_b16 v[188:189],v24 offset:49152
v_mfma_f32_16x16x32_bf16 a[28:31],v[204:207],v[228:231],a[28:31]
buffer_load_dwordx4 v28,s[8:11],s25 offen offset:3072 sc1 lds
v_mfma_f32_16x16x32_bf16 a[44:47],v[204:207],v[232:235],a[44:47]
ds_read_b64_tr_b16 v[190:191],v24 offset:53248
ds_read_b128 v[220:223],v16 offset:34048
v_mfma_f32_16x16x32_bf16 a[48:51],v[192:195],v[236:239],a[48:51]
s_add_u32 s25,s25,16384
v_mfma_f32_16x16x32_bf16 a[52:55],v[196:199],v[236:239],a[52:55]
v_mfma_f32_16x16x32_bf16 a[56:59],v[200:203],v[236:239],a[56:59]
v_mfma_f32_16x16x32_bf16 a[60:63],v[204:207],v[236:239],a[60:63]
s_waitcnt lgkmcnt(6)
v_mfma_f32_16x16x32_bf16 a[0:3],v[176:179],v[208:211],a[0:3]
ds_read_b64_tr_b16 v[192:193],v18 offset:57344
ds_read_b64_tr_b16 v[194:195],v18 offset:61440
v_mfma_f32_16x16x32_bf16 a[4:7],v[180:183],v[208:211],a[4:7]
s_add_u32 m0,s33,8192
v_mfma_f32_16x16x32_bf16 a[16:19],v[176:179],v[212:215],a[16:19]
ds_read_b128 v[224:227],v16 offset:40960
ds_read_b64_tr_b16 v[196:197],v20 offset:57344
v_mfma_f32_16x16x32_bf16 a[20:23],v[180:183],v[212:215],a[20:23]
buffer_load_dwordx4 v9,s[8:11],s25 offen sc1 lds
s_waitcnt lgkmcnt(4)
v_mfma_f32_16x16x32_bf16 a[8:11],v[184:187],v[208:211],a[8:11]
ds_read_b64_tr_b16 v[198:199],v20 offset:61440
ds_read_b128 v[228:231],v16 offset:41216
v_mfma_f32_16x16x32_bf16 a[24:27],v[184:187],v[212:215],a[24:27]
buffer_load_dwordx4 v9,s[8:11],s25 offen offset:1024 sc1 lds
v_mfma_f32_16x16x32_bf16 a[32:35],v[176:179],v[216:219],a[32:35]
ds_read_b64_tr_b16 v[200:201],v22 offset:57344
ds_read_b64_tr_b16 v[202:203],v22 offset:61440
v_mfma_f32_16x16x32_bf16 a[36:39],v[180:183],v[216:219],a[36:39]
buffer_load_dwordx4 v28,s[8:11],s25 offen offset:2048 sc1 lds
v_mfma_f32_16x16x32_bf16 a[40:43],v[184:187],v[216:219],a[40:43]
ds_read_b128 v[232:235],v16 offset:41984
ds_read_b64_tr_b16 v[204:205],v24 offset:57344
v_mfma_f32_16x16x32_bf16 a[12:15],v[188:191],v[208:211],a[12:15]
buffer_load_dwordx4 v28,s[8:11],s25 offen offset:3072 sc1 lds
v_mfma_f32_16x16x32_bf16 a[28:31],v[188:191],v[212:215],a[28:31]
ds_read_b64_tr_b16 v[206:207],v24 offset:61440
ds_read_b128 v[236:239],v16 offset:42240
v_mfma_f32_16x16x32_bf16 a[44:47],v[188:191],v[216:219],a[44:47]
s_add_u32 s25,s25,16384
v_mfma_f32_16x16x32_bf16 a[48:51],v[176:179],v[220:223],a[48:51]
v_mfma_f32_16x16x32_bf16 a[52:55],v[180:183],v[220:223],a[52:55]
v_mfma_f32_16x16x32_bf16 a[56:59],v[184:187],v[220:223],a[56:59]
v_mfma_f32_16x16x32_bf16 a[60:63],v[188:191],v[220:223],a[60:63]
s_waitcnt lgkmcnt(6)
v_mfma_f32_16x16x32_bf16 a[0:3],v[192:195],v[224:227],a[0:3]
s_waitcnt vmcnt(20) lgkmcnt(0)
s_barrier
v_mfma_f32_16x16x32_bf16 a[4:7],v[196:199],v[224:227],a[4:7]
ds_read_b64_tr_b16 v[176:177],v19 offset:16384
ds_read_b64_tr_b16 v[178:179],v19 offset:20480
v_mfma_f32_16x16x32_bf16 a[16:19],v[192:195],v[228:231],a[16:19]
s_add_u32 m0,s33,32768
v_mfma_f32_16x16x32_bf16 a[20:23],v[196:199],v[228:231],a[20:23]
ds_read_b128 v[208:211],v27
ds_read_b128 v[212:215],v27 offset:256
v_mfma_f32_16x16x32_bf16 a[8:11],v[200:203],v[224:227],a[8:11]
buffer_load_dwordx4 v9,s[8:11],s25 offen sc1 lds
v_mfma_f32_16x16x32_bf16 a[24:27],v[200:203],v[228:231],a[24:27]
ds_read_b64_tr_b16 v[180:181],v21 offset:16384
ds_read_b64_tr_b16 v[182:183],v21 offset:20480
v_mfma_f32_16x16x32_bf16 a[32:35],v[192:195],v[232:235],a[32:35]
buffer_load_dwordx4 v9,s[8:11],s25 offen offset:1024 sc1 lds
v_mfma_f32_16x16x32_bf16 a[36:39],v[196:199],v[232:235],a[36:39]
ds_read_b64_tr_b16 v[184:185],v23 offset:16384
ds_read_b64_tr_b16 v[186:187],v23 offset:20480
v_mfma_f32_16x16x32_bf16 a[40:43],v[200:203],v[232:235],a[40:43]
buffer_load_dwordx4 v28,s[8:11],s25 offen offset:2048 sc1 lds
v_mfma_f32_16x16x32_bf16 a[12:15],v[204:207],v[224:227],a[12:15]
ds_read_b64_tr_b16 v[188:189],v25 offset:16384
ds_read_b64_tr_b16 v[190:191],v25 offset:20480
v_mfma_f32_16x16x32_bf16 a[28:31],v[204:207],v[228:231],a[28:31]
buffer_load_dwordx4 v28,s[8:11],s25 offen offset:3072 sc1 lds
v_mfma_f32_16x16x32_bf16 a[44:47],v[204:207],v[232:235],a[44:47]
v_mfma_f32_16x16x32_bf16 a[48:51],v[192:195],v[236:239],a[48:51]
s_add_u32 s25,s25,16384
v_mfma_f32_16x16x32_bf16 a[52:55],v[196:199],v[236:239],a[52:55]
v_mfma_f32_16x16x32_bf16 a[56:59],v[200:203],v[236:239],a[56:59]
v_mfma_f32_16x16x32_bf16 a[60:63],v[204:207],v[236:239],a[60:63]
s_waitcnt lgkmcnt(4)
v_mfma_f32_16x16x32_bf16 v[80:83],v[176:179],v[208:211],v[80:83]
ds_read_b64_tr_b16 v[192:193],v19 offset:24576
ds_read_b64_tr_b16 v[194:195],v19 offset:28672
s_add_u32 m0,s33,40960
s_nop 0
buffer_load_dwordx4 v9,s[8:11],s25 offen sc1 lds
buffer_load_dwordx4 v9,s[8:11],s25 offen offset:1024 sc1 lds
v_mfma_f32_16x16x32_bf16 v[96:99],v[176:179],v[212:215],v[96:99]
ds_read_b128 v[224:227],v27 offset:4096
ds_read_b128 v[228:231],v27 offset:4352
buffer_load_dwordx4 v28,s[8:11],s25 offen offset:2048 sc1 lds
buffer_load_dwordx4 v28,s[8:11],s25 offen offset:3072 sc1 lds
s_add_u32 s25,s25,16384
v_mfma_f32_16x16x32_bf16 v[84:87],v[180:183],v[208:211],v[84:87]
ds_read_b64_tr_b16 v[196:197],v21 offset:24576
ds_read_b64_tr_b16 v[198:199],v21 offset:28672
s_xor_b32 s46,s2,5
s_lshl_b32 s46,s46,14
s_lshl_b32 s47,s45,13
v_mfma_f32_16x16x32_bf16 v[100:103],v[180:183],v[212:215],v[100:103]
ds_read_b64_tr_b16 v[200:201],v23 offset:24576
ds_read_b64_tr_b16 v[202:203],v23 offset:28672
s_add_u32 s46,s46,s47
s_add_u32 s46,s46,0x2a00000
v_accvgpr_read_b32 v144,a0
s_waitcnt lgkmcnt(8)
v_mfma_f32_16x16x32_bf16 v[88:91],v[184:187],v[208:211],v[88:91]
ds_read_b64_tr_b16 v[204:205],v25 offset:24576
ds_read_b64_tr_b16 v[206:207],v25 offset:28672
v_accvgpr_read_b32 v145,a1
v_accvgpr_read_b32 v146,a2
v_accvgpr_read_b32 v147,a3
v_mfma_f32_16x16x32_bf16 v[104:107],v[184:187],v[212:215],v[104:107]
v_accvgpr_read_b32 v148,a4
v_accvgpr_read_b32 v149,a5
v_accvgpr_read_b32 v150,a6
v_mfma_f32_16x16x32_bf16 v[92:95],v[188:191],v[208:211],v[92:95]
v_accvgpr_read_b32 v151,a7
v_cvt_pk_bf16_f32 v160,v144,v145
v_cvt_pk_bf16_f32 v161,v146,v147
v_mfma_f32_16x16x32_bf16 v[108:111],v[188:191],v[212:215],v[108:111]
v_cvt_pk_bf16_f32 v162,v148,v149
v_cvt_pk_bf16_f32 v163,v150,v151
buffer_store_dwordx4 v[160:163],v9,s[20:23],s46 offen sc1
s_waitcnt lgkmcnt(4)
v_mfma_f32_16x16x32_bf16 v[80:83],v[192:195],v[224:227],v[80:83]
s_waitcnt vmcnt(25) lgkmcnt(0)
s_barrier
s_add_u32 m0,s36,0
s_nop 0
buffer_load_dwordx4 v9,s[8:11],s25 offen sc1 lds
buffer_load_dwordx4 v9,s[8:11],s25 offen offset:1024 sc1 lds
v_mfma_f32_16x16x32_bf16 v[96:99],v[192:195],v[228:231],v[96:99]
ds_read_b64_tr_b16 v[176:177],v19 offset:49152
ds_read_b64_tr_b16 v[178:179],v19 offset:53248
buffer_load_dwordx4 v28,s[8:11],s25 offen offset:2048 sc1 lds
buffer_load_dwordx4 v28,s[8:11],s25 offen offset:3072 sc1 lds
v_mfma_f32_16x16x32_bf16 v[84:87],v[196:199],v[224:227],v[84:87]
ds_read_b128 v[208:211],v27 offset:8192
ds_read_b128 v[212:215],v27 offset:8448
s_add_u32 s25,s25,16384
v_accvgpr_read_b32 v152,a8
v_accvgpr_read_b32 v153,a9
v_mfma_f32_16x16x32_bf16 v[100:103],v[196:199],v[228:231],v[100:103]
ds_read_b64_tr_b16 v[180:181],v21 offset:49152
ds_read_b64_tr_b16 v[182:183],v21 offset:53248
v_accvgpr_read_b32 v154,a10
v_accvgpr_read_b32 v155,a11
v_mfma_f32_16x16x32_bf16 v[88:91],v[200:203],v[224:227],v[88:91]
ds_read_b64_tr_b16 v[184:185],v23 offset:49152
ds_read_b64_tr_b16 v[186:187],v23 offset:53248
v_accvgpr_read_b32 v156,a12
v_accvgpr_read_b32 v157,a13
v_mfma_f32_16x16x32_bf16 v[104:107],v[200:203],v[228:231],v[104:107]
ds_read_b64_tr_b16 v[188:189],v25 offset:49152
ds_read_b64_tr_b16 v[190:191],v25 offset:53248
v_accvgpr_read_b32 v158,a14
v_accvgpr_read_b32 v159,a15
v_cvt_pk_bf16_f32 v164,v152,v153
v_mfma_f32_16x16x32_bf16 v[92:95],v[204:207],v[224:227],v[92:95]
v_cvt_pk_bf16_f32 v165,v154,v155
v_cvt_pk_bf16_f32 v166,v156,v157
v_mfma_f32_16x16x32_bf16 v[108:111],v[204:207],v[228:231],v[108:111]
v_cvt_pk_bf16_f32 v167,v158,v159
buffer_store_dwordx4 v[164:167],v9,s[20:23],s46 offen offset:1024 sc1
s_waitcnt lgkmcnt(4)
v_mfma_f32_16x16x32_bf16 v[80:83],v[176:179],v[208:211],v[80:83]
ds_read_b64_tr_b16 v[192:193],v19 offset:57344
ds_read_b64_tr_b16 v[194:195],v19 offset:61440
v_accvgpr_read_b32 v144,a16
v_accvgpr_read_b32 v145,a17
v_mfma_f32_16x16x32_bf16 v[96:99],v[176:179],v[212:215],v[96:99]
ds_read_b128 v[224:227],v27 offset:12288
ds_read_b128 v[228:231],v27 offset:12544
v_accvgpr_read_b32 v146,a18
v_accvgpr_read_b32 v147,a19
v_mfma_f32_16x16x32_bf16 v[84:87],v[180:183],v[208:211],v[84:87]
ds_read_b64_tr_b16 v[196:197],v21 offset:57344
ds_read_b64_tr_b16 v[198:199],v21 offset:61440
v_accvgpr_read_b32 v148,a20
v_mfma_f32_16x16x32_bf16 v[100:103],v[180:183],v[212:215],v[100:103]
ds_read_b64_tr_b16 v[200:201],v23 offset:57344
ds_read_b64_tr_b16 v[202:203],v23 offset:61440
v_accvgpr_read_b32 v149,a21
v_accvgpr_read_b32 v150,a22
s_waitcnt lgkmcnt(8)
v_mfma_f32_16x16x32_bf16 v[88:91],v[184:187],v[208:211],v[88:91]
ds_read_b64_tr_b16 v[204:205],v25 offset:57344
ds_read_b64_tr_b16 v[206:207],v25 offset:61440
v_accvgpr_read_b32 v151,a23
v_cvt_pk_bf16_f32 v160,v144,v145
v_mfma_f32_16x16x32_bf16 v[104:107],v[184:187],v[212:215],v[104:107]
v_cvt_pk_bf16_f32 v161,v146,v147
v_mfma_f32_16x16x32_bf16 v[92:95],v[188:191],v[208:211],v[92:95]
v_cvt_pk_bf16_f32 v162,v148,v149
v_cvt_pk_bf16_f32 v163,v150,v151
v_mfma_f32_16x16x32_bf16 v[108:111],v[188:191],v[212:215],v[108:111]
buffer_store_dwordx4 v[160:163],v9,s[20:23],s46 offen offset:2048 sc1
s_waitcnt lgkmcnt(4)
v_mfma_f32_16x16x32_bf16 v[80:83],v[192:195],v[224:227],v[80:83]
s_waitcnt vmcnt(27) lgkmcnt(0)
s_barrier
s_add_u32 m0,s36,8192
s_nop 0
buffer_load_dwordx4 v9,s[8:11],s25 offen sc1 lds
buffer_load_dwordx4 v9,s[8:11],s25 offen offset:1024 sc1 lds
v_mfma_f32_16x16x32_bf16 v[96:99],v[192:195],v[228:231],v[96:99]
ds_read_b64_tr_b16 v[176:177],v18 offset:16384
ds_read_b64_tr_b16 v[178:179],v18 offset:20480
buffer_load_dwordx4 v28,s[8:11],s25 offen offset:2048 sc1 lds
buffer_load_dwordx4 v28,s[8:11],s25 offen offset:3072 sc1 lds
v_mfma_f32_16x16x32_bf16 v[84:87],v[196:199],v[224:227],v[84:87]
ds_read_b128 v[208:211],v27 offset:32768
ds_read_b128 v[212:215],v27 offset:33024
s_add_u32 s25,s25,16384
v_accvgpr_read_b32 v152,a24
v_accvgpr_read_b32 v153,a25
v_mfma_f32_16x16x32_bf16 v[100:103],v[196:199],v[228:231],v[100:103]
ds_read_b64_tr_b16 v[180:181],v20 offset:16384
ds_read_b64_tr_b16 v[182:183],v20 offset:20480
v_accvgpr_read_b32 v154,a26
v_accvgpr_read_b32 v155,a27
v_mfma_f32_16x16x32_bf16 v[88:91],v[200:203],v[224:227],v[88:91]
ds_read_b64_tr_b16 v[184:185],v22 offset:16384
ds_read_b64_tr_b16 v[186:187],v22 offset:20480
v_accvgpr_read_b32 v156,a28
v_accvgpr_read_b32 v157,a29
v_accvgpr_read_b32 v158,a30
v_mfma_f32_16x16x32_bf16 v[104:107],v[200:203],v[228:231],v[104:107]
ds_read_b64_tr_b16 v[188:189],v24 offset:16384
ds_read_b64_tr_b16 v[190:191],v24 offset:20480
v_accvgpr_read_b32 v159,a31
v_cvt_pk_bf16_f32 v164,v152,v153
v_mfma_f32_16x16x32_bf16 v[92:95],v[204:207],v[224:227],v[92:95]
v_cvt_pk_bf16_f32 v165,v154,v155
v_cvt_pk_bf16_f32 v166,v156,v157
v_cvt_pk_bf16_f32 v167,v158,v159
v_mfma_f32_16x16x32_bf16 v[108:111],v[204:207],v[228:231],v[108:111]
buffer_store_dwordx4 v[164:167],v9,s[20:23],s46 offen offset:3072 sc1
s_add_u32 s46,s46,4096
s_waitcnt lgkmcnt(4)
v_mfma_f32_16x16x32_bf16 v[80:83],v[176:179],v[208:211],v[80:83]
ds_read_b64_tr_b16 v[192:193],v18 offset:24576
ds_read_b64_tr_b16 v[194:195],v18 offset:28672
v_accvgpr_read_b32 v144,a32
v_accvgpr_read_b32 v145,a33
v_mfma_f32_16x16x32_bf16 v[96:99],v[176:179],v[212:215],v[96:99]
ds_read_b128 v[224:227],v27 offset:36864
ds_read_b128 v[228:231],v27 offset:37120
v_accvgpr_read_b32 v146,a34
v_accvgpr_read_b32 v147,a35
v_mfma_f32_16x16x32_bf16 v[84:87],v[180:183],v[208:211],v[84:87]
ds_read_b64_tr_b16 v[196:197],v20 offset:24576
ds_read_b64_tr_b16 v[198:199],v20 offset:28672
v_accvgpr_read_b32 v148,a36
v_mfma_f32_16x16x32_bf16 v[100:103],v[180:183],v[212:215],v[100:103]
ds_read_b64_tr_b16 v[200:201],v22 offset:24576
ds_read_b64_tr_b16 v[202:203],v22 offset:28672
v_accvgpr_read_b32 v149,a37
v_accvgpr_read_b32 v150,a38
s_waitcnt lgkmcnt(8)
v_mfma_f32_16x16x32_bf16 v[88:91],v[184:187],v[208:211],v[88:91]
ds_read_b64_tr_b16 v[204:205],v24 offset:24576
ds_read_b64_tr_b16 v[206:207],v24 offset:28672
v_accvgpr_read_b32 v151,a39
v_cvt_pk_bf16_f32 v160,v144,v145
v_mfma_f32_16x16x32_bf16 v[104:107],v[184:187],v[212:215],v[104:107]
v_cvt_pk_bf16_f32 v161,v146,v147
v_mfma_f32_16x16x32_bf16 v[92:95],v[188:191],v[208:211],v[92:95]
v_cvt_pk_bf16_f32 v162,v148,v149
v_cvt_pk_bf16_f32 v163,v150,v151
v_mfma_f32_16x16x32_bf16 v[108:111],v[188:191],v[212:215],v[108:111]
buffer_store_dwordx4 v[160:163],v9,s[20:23],s46 offen sc1
s_waitcnt lgkmcnt(4)
v_mfma_f32_16x16x32_bf16 v[80:83],v[192:195],v[224:227],v[80:83]
s_waitcnt vmcnt(29) lgkmcnt(0)
s_barrier
s_add_u32 m0,s36,32768
s_nop 0
buffer_load_dwordx4 v9,s[8:11],s25 offen sc1 lds
buffer_load_dwordx4 v9,s[8:11],s25 offen offset:1024 sc1 lds
v_mfma_f32_16x16x32_bf16 v[96:99],v[192:195],v[228:231],v[96:99]
ds_read_b64_tr_b16 v[176:177],v18 offset:49152
ds_read_b64_tr_b16 v[178:179],v18 offset:53248
buffer_load_dwordx4 v28,s[8:11],s25 offen offset:2048 sc1 lds
buffer_load_dwordx4 v28,s[8:11],s25 offen offset:3072 sc1 lds
v_mfma_f32_16x16x32_bf16 v[84:87],v[196:199],v[224:227],v[84:87]
ds_read_b128 v[208:211],v27 offset:40960
ds_read_b128 v[212:215],v27 offset:41216
s_add_u32 s25,s25,16384
v_accvgpr_read_b32 v152,a40
v_accvgpr_read_b32 v153,a41
v_mfma_f32_16x16x32_bf16 v[100:103],v[196:199],v[228:231],v[100:103]
ds_read_b64_tr_b16 v[180:181],v20 offset:49152
ds_read_b64_tr_b16 v[182:183],v20 offset:53248
v_accvgpr_read_b32 v154,a42
v_accvgpr_read_b32 v155,a43
v_mfma_f32_16x16x32_bf16 v[88:91],v[200:203],v[224:227],v[88:91]
ds_read_b64_tr_b16 v[184:185],v22 offset:49152
ds_read_b64_tr_b16 v[186:187],v22 offset:53248
v_accvgpr_read_b32 v156,a44
v_accvgpr_read_b32 v157,a45
v_mfma_f32_16x16x32_bf16 v[104:107],v[200:203],v[228:231],v[104:107]
ds_read_b64_tr_b16 v[188:189],v24 offset:49152
ds_read_b64_tr_b16 v[190:191],v24 offset:53248
v_accvgpr_read_b32 v158,a46
v_accvgpr_read_b32 v159,a47
v_cvt_pk_bf16_f32 v164,v152,v153
v_mfma_f32_16x16x32_bf16 v[92:95],v[204:207],v[224:227],v[92:95]
v_cvt_pk_bf16_f32 v165,v154,v155
v_cvt_pk_bf16_f32 v166,v156,v157
v_mfma_f32_16x16x32_bf16 v[108:111],v[204:207],v[228:231],v[108:111]
v_cvt_pk_bf16_f32 v167,v158,v159
buffer_store_dwordx4 v[164:167],v9,s[20:23],s46 offen offset:1024 sc1
s_waitcnt lgkmcnt(4)
v_mfma_f32_16x16x32_bf16 v[80:83],v[176:179],v[208:211],v[80:83]
ds_read_b64_tr_b16 v[192:193],v18 offset:57344
ds_read_b64_tr_b16 v[194:195],v18 offset:61440
v_accvgpr_read_b32 v144,a48
v_accvgpr_read_b32 v145,a49
v_mfma_f32_16x16x32_bf16 v[96:99],v[176:179],v[212:215],v[96:99]
ds_read_b128 v[224:227],v27 offset:45056
ds_read_b128 v[228:231],v27 offset:45312
v_accvgpr_read_b32 v146,a50
v_accvgpr_read_b32 v147,a51
v_mfma_f32_16x16x32_bf16 v[84:87],v[180:183],v[208:211],v[84:87]
ds_read_b64_tr_b16 v[196:197],v20 offset:57344
ds_read_b64_tr_b16 v[198:199],v20 offset:61440
v_accvgpr_read_b32 v148,a52
v_mfma_f32_16x16x32_bf16 v[100:103],v[180:183],v[212:215],v[100:103]
ds_read_b64_tr_b16 v[200:201],v22 offset:57344
ds_read_b64_tr_b16 v[202:203],v22 offset:61440
v_accvgpr_read_b32 v149,a53
v_accvgpr_read_b32 v150,a54
s_waitcnt lgkmcnt(8)
v_mfma_f32_16x16x32_bf16 v[88:91],v[184:187],v[208:211],v[88:91]
ds_read_b64_tr_b16 v[204:205],v24 offset:57344
ds_read_b64_tr_b16 v[206:207],v24 offset:61440
v_accvgpr_read_b32 v151,a55
v_cvt_pk_bf16_f32 v160,v144,v145
v_mfma_f32_16x16x32_bf16 v[104:107],v[184:187],v[212:215],v[104:107]
v_cvt_pk_bf16_f32 v161,v146,v147
v_mfma_f32_16x16x32_bf16 v[92:95],v[188:191],v[208:211],v[92:95]
v_cvt_pk_bf16_f32 v162,v148,v149
v_cvt_pk_bf16_f32 v163,v150,v151
v_mfma_f32_16x16x32_bf16 v[108:111],v[188:191],v[212:215],v[108:111]
buffer_store_dwordx4 v[160:163],v9,s[20:23],s46 offen offset:2048 sc1
s_waitcnt lgkmcnt(4)
v_mfma_f32_16x16x32_bf16 v[80:83],v[192:195],v[224:227],v[80:83]
s_waitcnt vmcnt(31) lgkmcnt(0)
s_barrier
s_add_u32 m0,s36,40960
s_nop 0
buffer_load_dwordx4 v9,s[8:11],s25 offen sc1 lds
buffer_load_dwordx4 v9,s[8:11],s25 offen offset:1024 sc1 lds
v_mfma_f32_16x16x32_bf16 v[96:99],v[192:195],v[228:231],v[96:99]
ds_read_b64_tr_b16 v[176:177],v19 offset:16384
ds_read_b64_tr_b16 v[178:179],v19 offset:20480
buffer_load_dwordx4 v28,s[8:11],s25 offen offset:2048 sc1 lds
buffer_load_dwordx4 v28,s[8:11],s25 offen offset:3072 sc1 lds
v_mfma_f32_16x16x32_bf16 v[84:87],v[196:199],v[224:227],v[84:87]
ds_read_b128 v[208:211],v26
ds_read_b128 v[212:215],v26 offset:256
s_add_u32 s25,s25,16384
v_accvgpr_read_b32 v152,a56
v_accvgpr_read_b32 v153,a57
v_mfma_f32_16x16x32_bf16 v[100:103],v[196:199],v[228:231],v[100:103]
ds_read_b64_tr_b16 v[180:181],v21 offset:16384
ds_read_b64_tr_b16 v[182:183],v21 offset:20480
v_accvgpr_read_b32 v154,a58
v_accvgpr_read_b32 v155,a59
v_mfma_f32_16x16x32_bf16 v[88:91],v[200:203],v[224:227],v[88:91]
ds_read_b64_tr_b16 v[184:185],v23 offset:16384
ds_read_b64_tr_b16 v[186:187],v23 offset:20480
v_accvgpr_read_b32 v156,a60
v_accvgpr_read_b32 v157,a61
v_mfma_f32_16x16x32_bf16 v[104:107],v[200:203],v[228:231],v[104:107]
ds_read_b64_tr_b16 v[188:189],v25 offset:16384
ds_read_b64_tr_b16 v[190:191],v25 offset:20480
v_accvgpr_read_b32 v158,a62
v_accvgpr_read_b32 v159,a63
v_cvt_pk_bf16_f32 v164,v152,v153
v_mfma_f32_16x16x32_bf16 v[92:95],v[204:207],v[224:227],v[92:95]
v_cvt_pk_bf16_f32 v165,v154,v155
v_cvt_pk_bf16_f32 v166,v156,v157
v_mfma_f32_16x16x32_bf16 v[108:111],v[204:207],v[228:231],v[108:111]
v_cvt_pk_bf16_f32 v167,v158,v159
buffer_store_dwordx4 v[164:167],v9,s[20:23],s46 offen offset:3072 sc1
s_waitcnt lgkmcnt(4)
v_mfma_f32_16x16x32_bf16 v[80:83],v[176:179],v[208:211],v[80:83]
ds_read_b64_tr_b16 v[192:193],v19 offset:24576
ds_read_b64_tr_b16 v[194:195],v19 offset:28672
v_mfma_f32_16x16x32_bf16 v[96:99],v[176:179],v[212:215],v[96:99]
ds_read_b128 v[224:227],v26 offset:4096
ds_read_b128 v[228:231],v26 offset:4352
v_mfma_f32_16x16x32_bf16 v[84:87],v[180:183],v[208:211],v[84:87]
ds_read_b64_tr_b16 v[196:197],v21 offset:24576
ds_read_b64_tr_b16 v[198:199],v21 offset:28672
v_mfma_f32_16x16x32_bf16 v[100:103],v[180:183],v[212:215],v[100:103]
ds_read_b64_tr_b16 v[200:201],v23 offset:24576
ds_read_b64_tr_b16 v[202:203],v23 offset:28672
s_waitcnt lgkmcnt(8)
v_mfma_f32_16x16x32_bf16 v[88:91],v[184:187],v[208:211],v[88:91]
ds_read_b64_tr_b16 v[204:205],v25 offset:24576
ds_read_b64_tr_b16 v[206:207],v25 offset:28672
v_mfma_f32_16x16x32_bf16 v[104:107],v[184:187],v[212:215],v[104:107]
v_mfma_f32_16x16x32_bf16 v[92:95],v[188:191],v[208:211],v[92:95]
v_mfma_f32_16x16x32_bf16 v[108:111],v[188:191],v[212:215],v[108:111]
s_waitcnt lgkmcnt(4)
v_mfma_f32_16x16x32_bf16 v[80:83],v[192:195],v[224:227],v[80:83]
s_waitcnt vmcnt(32) lgkmcnt(0)
s_barrier
v_mfma_f32_16x16x32_bf16 v[96:99],v[192:195],v[228:231],v[96:99]
ds_read_b64_tr_b16 v[176:177],v19 offset:49152
ds_read_b64_tr_b16 v[178:179],v19 offset:53248
s_add_u32 m0,s33,0
v_mfma_f32_16x16x32_bf16 v[84:87],v[196:199],v[224:227],v[84:87]
ds_read_b128 v[208:211],v26 offset:8192
ds_read_b128 v[212:215],v26 offset:8448
buffer_load_dwordx4 v9,s[8:11],s25 offen sc1 lds
v_mfma_f32_16x16x32_bf16 v[100:103],v[196:199],v[228:231],v[100:103]
ds_read_b64_tr_b16 v[180:181],v21 offset:49152
ds_read_b64_tr_b16 v[182:183],v21 offset:53248
v_mfma_f32_16x16x32_bf16 v[88:91],v[200:203],v[224:227],v[88:91]
ds_read_b64_tr_b16 v[184:185],v23 offset:49152
ds_read_b64_tr_b16 v[186:187],v23 offset:53248
buffer_load_dwordx4 v9,s[8:11],s25 offen offset:1024 sc1 lds
v_mfma_f32_16x16x32_bf16 v[104:107],v[200:203],v[228:231],v[104:107]
ds_read_b64_tr_b16 v[188:189],v25 offset:49152
ds_read_b64_tr_b16 v[190:191],v25 offset:53248
v_mfma_f32_16x16x32_bf16 v[92:95],v[204:207],v[224:227],v[92:95]
buffer_load_dwordx4 v28,s[8:11],s25 offen offset:2048 sc1 lds
v_mfma_f32_16x16x32_bf16 v[108:111],v[204:207],v[228:231],v[108:111]
buffer_load_dwordx4 v28,s[8:11],s25 offen offset:3072 sc1 lds
s_add_u32 s25,s25,16384
s_waitcnt lgkmcnt(4)
v_mfma_f32_16x16x32_bf16 v[80:83],v[176:179],v[208:211],v[80:83]
ds_read_b64_tr_b16 v[192:193],v19 offset:57344
ds_read_b64_tr_b16 v[194:195],v19 offset:61440
s_lshl_b32 s63,s45,13
s_add_u32 s63,s63,131072
v_mfma_f32_16x16x32_bf16 v[96:99],v[176:179],v[212:215],v[96:99]
ds_read_b128 v[224:227],v26 offset:12288
ds_read_b128 v[228:231],v26 offset:12544
v_add_u32 v10,s63,v9
s_add_u32 s48,s48,0x10000
v_mfma_f32_16x16x32_bf16 v[84:87],v[180:183],v[208:211],v[84:87]
ds_read_b64_tr_b16 v[196:197],v21 offset:57344
ds_read_b64_tr_b16 v[198:199],v21 offset:61440
s_add_u32 s49,s49,0x10000
ds_read_b128 v[144:147],v10
v_mfma_f32_16x16x32_bf16 v[100:103],v[180:183],v[212:215],v[100:103]
ds_read_b64_tr_b16 v[200:201],v23 offset:57344
ds_read_b64_tr_b16 v[202:203],v23 offset:61440
ds_read_b128 v[148:151],v10 offset:1024
s_waitcnt lgkmcnt(10)
v_mfma_f32_16x16x32_bf16 v[88:91],v[184:187],v[208:211],v[88:91]
ds_read_b64_tr_b16 v[204:205],v25 offset:57344
ds_read_b64_tr_b16 v[206:207],v25 offset:61440
ds_read_b128 v[152:155],v10 offset:2048
ds_read_b128 v[156:159],v10 offset:3072
v_mfma_f32_16x16x32_bf16 v[104:107],v[184:187],v[212:215],v[104:107]
ds_read_b128 v[160:163],v10 offset:4096
s_waitcnt lgkmcnt(11)
ds_read_b128 v[164:167],v10 offset:5120
v_mfma_f32_16x16x32_bf16 v[92:95],v[188:191],v[208:211],v[92:95]
ds_read_b128 v[168:171],v10 offset:6144
ds_read_b128 v[172:175],v10 offset:7168
v_mfma_f32_16x16x32_bf16 v[108:111],v[188:191],v[212:215],v[108:111]
s_waitcnt lgkmcnt(0)
v_mfma_f32_16x16x32_bf16 v[80:83],v[192:195],v[224:227],v[80:83]
s_waitcnt vmcnt(32)
s_barrier
v_mfma_f32_16x16x32_bf16 v[96:99],v[192:195],v[228:231],v[96:99]
ds_read_b64_tr_b16 v[176:177],v18 offset:16384
ds_read_b64_tr_b16 v[178:179],v18 offset:20480
s_add_u32 m0,s33,8192
v_mfma_f32_16x16x32_bf16 v[84:87],v[196:199],v[224:227],v[84:87]
ds_read_b128 v[208:211],v26 offset:32768
ds_read_b128 v[212:215],v26 offset:33024
buffer_load_dwordx4 v9,s[8:11],s25 offen sc1 lds
v_mfma_f32_16x16x32_bf16 v[100:103],v[196:199],v[228:231],v[100:103]
ds_read_b64_tr_b16 v[180:181],v20 offset:16384
ds_read_b64_tr_b16 v[182:183],v20 offset:20480
v_mfma_f32_16x16x32_bf16 v[88:91],v[200:203],v[224:227],v[88:91]
ds_read_b64_tr_b16 v[184:185],v22 offset:16384
ds_read_b64_tr_b16 v[186:187],v22 offset:20480
buffer_load_dwordx4 v9,s[8:11],s25 offen offset:1024 sc1 lds
v_mfma_f32_16x16x32_bf16 v[104:107],v[200:203],v[228:231],v[104:107]
ds_read_b64_tr_b16 v[188:189],v24 offset:16384
ds_read_b64_tr_b16 v[190:191],v24 offset:20480
v_mfma_f32_16x16x32_bf16 v[92:95],v[204:207],v[224:227],v[92:95]
buffer_load_dwordx4 v28,s[8:11],s25 offen offset:2048 sc1 lds
v_mfma_f32_16x16x32_bf16 v[108:111],v[204:207],v[228:231],v[108:111]
buffer_load_dwordx4 v28,s[8:11],s25 offen offset:3072 sc1 lds
s_add_u32 s25,s25,16384
s_waitcnt lgkmcnt(4)
v_mfma_f32_16x16x32_bf16 v[80:83],v[176:179],v[208:211],v[80:83]
ds_read_b64_tr_b16 v[192:193],v18 offset:24576
ds_read_b64_tr_b16 v[194:195],v18 offset:28672
v_mfma_f32_16x16x32_bf16 v[96:99],v[176:179],v[212:215],v[96:99]
ds_read_b128 v[224:227],v26 offset:36864
ds_read_b128 v[228:231],v26 offset:37120
v_mfma_f32_16x16x32_bf16 v[84:87],v[180:183],v[208:211],v[84:87]
ds_read_b64_tr_b16 v[196:197],v20 offset:24576
ds_read_b64_tr_b16 v[198:199],v20 offset:28672
v_mfma_f32_16x16x32_bf16 v[100:103],v[180:183],v[212:215],v[100:103]
ds_read_b64_tr_b16 v[200:201],v22 offset:24576
ds_read_b64_tr_b16 v[202:203],v22 offset:28672
s_waitcnt lgkmcnt(8)
v_mfma_f32_16x16x32_bf16 v[88:91],v[184:187],v[208:211],v[88:91]
ds_read_b64_tr_b16 v[204:205],v24 offset:24576
ds_read_b64_tr_b16 v[206:207],v24 offset:28672
v_mfma_f32_16x16x32_bf16 v[104:107],v[184:187],v[212:215],v[104:107]
v_mfma_f32_16x16x32_bf16 v[92:95],v[188:191],v[208:211],v[92:95]
v_mfma_f32_16x16x32_bf16 v[108:111],v[188:191],v[212:215],v[108:111]
s_waitcnt lgkmcnt(4)
v_mfma_f32_16x16x32_bf16 v[80:83],v[192:195],v[224:227],v[80:83]
s_waitcnt vmcnt(32)
s_waitcnt vmcnt(8) lgkmcnt(0)
s_barrier
s_xor_b32 s62,s2,5
s_lshl_b32 s62,s62,7
s_add_u32 s62,s62,0x2702000
s_cmp_lg_u32 s31,0
s_cbranch_scc1 L_r1_fp
v_mov_b32 v10,1
v_mov_b32 v11,0
s_mov_b64 exec,1
buffer_store_dword v10,v11,s[20:23],s62 offen sc1
s_mov_b64 exec,-1
L_r1_fp:
v_mfma_f32_16x16x32_bf16 v[96:99],v[192:195],v[228:231],v[96:99]
ds_read_b64_tr_b16 v[176:177],v18 offset:49152
ds_read_b64_tr_b16 v[178:179],v18 offset:53248
s_add_u32 m0,s33,32768
v_mfma_f32_16x16x32_bf16 v[84:87],v[196:199],v[224:227],v[84:87]
ds_read_b128 v[208:211],v26 offset:40960
ds_read_b128 v[212:215],v26 offset:41216
buffer_load_dwordx4 v9,s[8:11],s25 offen sc1 lds
v_mfma_f32_16x16x32_bf16 v[100:103],v[196:199],v[228:231],v[100:103]
ds_read_b64_tr_b16 v[180:181],v20 offset:49152
ds_read_b64_tr_b16 v[182:183],v20 offset:53248
v_mfma_f32_16x16x32_bf16 v[88:91],v[200:203],v[224:227],v[88:91]
ds_read_b64_tr_b16 v[184:185],v22 offset:49152
ds_read_b64_tr_b16 v[186:187],v22 offset:53248
buffer_load_dwordx4 v9,s[8:11],s25 offen offset:1024 sc1 lds
v_mfma_f32_16x16x32_bf16 v[104:107],v[200:203],v[228:231],v[104:107]
ds_read_b64_tr_b16 v[188:189],v24 offset:49152
ds_read_b64_tr_b16 v[190:191],v24 offset:53248
v_mfma_f32_16x16x32_bf16 v[92:95],v[204:207],v[224:227],v[92:95]
buffer_load_dwordx4 v28,s[8:11],s25 offen offset:2048 sc1 lds
v_mfma_f32_16x16x32_bf16 v[108:111],v[204:207],v[228:231],v[108:111]
buffer_load_dwordx4 v28,s[8:11],s25 offen offset:3072 sc1 lds
s_add_u32 s25,s25,16384
s_waitcnt lgkmcnt(4)
v_mfma_f32_16x16x32_bf16 v[80:83],v[176:179],v[208:211],v[80:83]
ds_read_b64_tr_b16 v[192:193],v18 offset:57344
ds_read_b64_tr_b16 v[194:195],v18 offset:61440
v_mfma_f32_16x16x32_bf16 v[96:99],v[176:179],v[212:215],v[96:99]
ds_read_b128 v[224:227],v26 offset:45056
ds_read_b128 v[228:231],v26 offset:45312
v_mfma_f32_16x16x32_bf16 v[84:87],v[180:183],v[208:211],v[84:87]
ds_read_b64_tr_b16 v[196:197],v20 offset:57344
ds_read_b64_tr_b16 v[198:199],v20 offset:61440
v_mfma_f32_16x16x32_bf16 v[100:103],v[180:183],v[212:215],v[100:103]
ds_read_b64_tr_b16 v[200:201],v22 offset:57344
ds_read_b64_tr_b16 v[202:203],v22 offset:61440
s_waitcnt lgkmcnt(8)
v_mfma_f32_16x16x32_bf16 v[88:91],v[184:187],v[208:211],v[88:91]
ds_read_b64_tr_b16 v[204:205],v24 offset:57344
ds_read_b64_tr_b16 v[206:207],v24 offset:61440
v_mfma_f32_16x16x32_bf16 v[104:107],v[184:187],v[212:215],v[104:107]
v_mfma_f32_16x16x32_bf16 v[92:95],v[188:191],v[208:211],v[92:95]
v_mfma_f32_16x16x32_bf16 v[108:111],v[188:191],v[212:215],v[108:111]
s_waitcnt lgkmcnt(4)
v_mfma_f32_16x16x32_bf16 v[80:83],v[192:195],v[224:227],v[80:83]
s_waitcnt lgkmcnt(0)
s_barrier
v_mfma_f32_16x16x32_bf16 v[96:99],v[192:195],v[228:231],v[96:99]
ds_read_b64_tr_b16 v[176:177],v19 offset:16384
ds_read_b64_tr_b16 v[178:179],v19 offset:20480
s_add_u32 m0,s33,40960
v_mfma_f32_16x16x32_bf16 v[84:87],v[196:199],v[224:227],v[84:87]
ds_read_b128 v[208:211],v27
ds_read_b128 v[212:215],v27 offset:256
buffer_load_dwordx4 v9,s[8:11],s25 offen sc1 lds
v_mfma_f32_16x16x32_bf16 v[100:103],v[196:199],v[228:231],v[100:103]
ds_read_b64_tr_b16 v[180:181],v21 offset:16384
ds_read_b64_tr_b16 v[182:183],v21 offset:20480
v_mfma_f32_16x16x32_bf16 v[88:91],v[200:203],v[224:227],v[88:91]
ds_read_b64_tr_b16 v[184:185],v23 offset:16384
ds_read_b64_tr_b16 v[186:187],v23 offset:20480
buffer_load_dwordx4 v9,s[8:11],s25 offen offset:1024 sc1 lds
v_mfma_f32_16x16x32_bf16 v[104:107],v[200:203],v[228:231],v[104:107]
ds_read_b64_tr_b16 v[188:189],v25 offset:16384
ds_read_b64_tr_b16 v[190:191],v25 offset:20480
v_mfma_f32_16x16x32_bf16 v[92:95],v[204:207],v[224:227],v[92:95]
buffer_load_dwordx4 v28,s[8:11],s25 offen offset:2048 sc1 lds
v_mfma_f32_16x16x32_bf16 v[108:111],v[204:207],v[228:231],v[108:111]
buffer_load_dwordx4 v28,s[8:11],s25 offen offset:3072 sc1 lds
s_add_u32 s25,s25,16384
s_waitcnt lgkmcnt(4)
v_mfma_f32_16x16x32_bf16 v[80:83],v[176:179],v[208:211],v[80:83]
ds_read_b64_tr_b16 v[192:193],v19 offset:24576
ds_read_b64_tr_b16 v[194:195],v19 offset:28672
v_mfma_f32_16x16x32_bf16 v[96:99],v[176:179],v[212:215],v[96:99]
ds_read_b128 v[224:227],v27 offset:4096
ds_read_b128 v[228:231],v27 offset:4352
v_mfma_f32_16x16x32_bf16 v[84:87],v[180:183],v[208:211],v[84:87]
ds_read_b64_tr_b16 v[196:197],v21 offset:24576
ds_read_b64_tr_b16 v[198:199],v21 offset:28672
v_mfma_f32_16x16x32_bf16 v[100:103],v[180:183],v[212:215],v[100:103]
ds_read_b64_tr_b16 v[200:201],v23 offset:24576
ds_read_b64_tr_b16 v[202:203],v23 offset:28672
s_waitcnt lgkmcnt(8)
v_mfma_f32_16x16x32_bf16 v[88:91],v[184:187],v[208:211],v[88:91]
ds_read_b64_tr_b16 v[204:205],v25 offset:24576
ds_read_b64_tr_b16 v[206:207],v25 offset:28672
v_mfma_f32_16x16x32_bf16 v[104:107],v[184:187],v[212:215],v[104:107]
v_mfma_f32_16x16x32_bf16 v[92:95],v[188:191],v[208:211],v[92:95]
v_mfma_f32_16x16x32_bf16 v[108:111],v[188:191],v[212:215],v[108:111]
s_waitcnt lgkmcnt(4)
v_mfma_f32_16x16x32_bf16 v[80:83],v[192:195],v[224:227],v[80:83]
s_waitcnt lgkmcnt(0)
s_barrier
v_mfma_f32_16x16x32_bf16 v[96:99],v[192:195],v[228:231],v[96:99]
ds_read_b64_tr_b16 v[176:177],v19 offset:49152
ds_read_b64_tr_b16 v[178:179],v19 offset:53248
v_mfma_f32_16x16x32_bf16 v[84:87],v[196:199],v[224:227],v[84:87]
ds_read_b128 v[208:211],v27 offset:8192
ds_read_b128 v[212:215],v27 offset:8448
v_mfma_f32_16x16x32_bf16 v[100:103],v[196:199],v[228:231],v[100:103]
ds_read_b64_tr_b16 v[180:181],v21 offset:49152
ds_read_b64_tr_b16 v[182:183],v21 offset:53248
v_mfma_f32_16x16x32_bf16 v[88:91],v[200:203],v[224:227],v[88:91]
ds_read_b64_tr_b16 v[184:185],v23 offset:49152
ds_read_b64_tr_b16 v[186:187],v23 offset:53248
v_mfma_f32_16x16x32_bf16 v[104:107],v[200:203],v[228:231],v[104:107]
ds_read_b64_tr_b16 v[188:189],v25 offset:49152
ds_read_b64_tr_b16 v[190:191],v25 offset:53248
v_mfma_f32_16x16x32_bf16 v[92:95],v[204:207],v[224:227],v[92:95]
v_mfma_f32_16x16x32_bf16 v[108:111],v[204:207],v[228:231],v[108:111]
s_waitcnt lgkmcnt(4)
v_mfma_f32_16x16x32_bf16 v[80:83],v[176:179],v[208:211],v[80:83]
ds_read_b64_tr_b16 v[192:193],v19 offset:57344
ds_read_b64_tr_b16 v[194:195],v19 offset:61440
s_lshl_b32 s62,s2,7
s_add_u32 s62,s62,0x2702000
v_mov_b32 v241,s62
buffer_load_dword v240,v241,s[20:23],0 offen sc1
v_mfma_f32_16x16x32_bf16 v[96:99],v[176:179],v[212:215],v[96:99]
ds_read_b128 v[224:227],v27 offset:12288
ds_read_b128 v[228:231],v27 offset:12544
v_mfma_f32_16x16x32_bf16 v[84:87],v[180:183],v[208:211],v[84:87]
ds_read_b64_tr_b16 v[196:197],v21 offset:57344
ds_read_b64_tr_b16 v[198:199],v21 offset:61440
v_mfma_f32_16x16x32_bf16 v[100:103],v[180:183],v[212:215],v[100:103]
ds_read_b64_tr_b16 v[200:201],v23 offset:57344
ds_read_b64_tr_b16 v[202:203],v23 offset:61440
s_waitcnt lgkmcnt(8)
v_mfma_f32_16x16x32_bf16 v[88:91],v[184:187],v[208:211],v[88:91]
ds_read_b64_tr_b16 v[204:205],v25 offset:57344
ds_read_b64_tr_b16 v[206:207],v25 offset:61440
v_mfma_f32_16x16x32_bf16 v[104:107],v[184:187],v[212:215],v[104:107]
v_mfma_f32_16x16x32_bf16 v[92:95],v[188:191],v[208:211],v[92:95]
v_mfma_f32_16x16x32_bf16 v[108:111],v[188:191],v[212:215],v[108:111]
s_waitcnt lgkmcnt(4)
v_mfma_f32_16x16x32_bf16 v[80:83],v[192:195],v[224:227],v[80:83]
s_waitcnt lgkmcnt(0)
s_barrier
v_mfma_f32_16x16x32_bf16 v[96:99],v[192:195],v[228:231],v[96:99]
ds_read_b64_tr_b16 v[176:177],v18 offset:16384
ds_read_b64_tr_b16 v[178:179],v18 offset:20480
v_mfma_f32_16x16x32_bf16 v[84:87],v[196:199],v[224:227],v[84:87]
ds_read_b128 v[208:211],v27 offset:32768
ds_read_b128 v[212:215],v27 offset:33024
v_mfma_f32_16x16x32_bf16 v[100:103],v[196:199],v[228:231],v[100:103]
ds_read_b64_tr_b16 v[180:181],v20 offset:16384
ds_read_b64_tr_b16 v[182:183],v20 offset:20480
v_mfma_f32_16x16x32_bf16 v[88:91],v[200:203],v[224:227],v[88:91]
ds_read_b64_tr_b16 v[184:185],v22 offset:16384
ds_read_b64_tr_b16 v[186:187],v22 offset:20480
v_mfma_f32_16x16x32_bf16 v[104:107],v[200:203],v[228:231],v[104:107]
ds_read_b64_tr_b16 v[188:189],v24 offset:16384
ds_read_b64_tr_b16 v[190:191],v24 offset:20480
v_mfma_f32_16x16x32_bf16 v[92:95],v[204:207],v[224:227],v[92:95]
v_mfma_f32_16x16x32_bf16 v[108:111],v[204:207],v[228:231],v[108:111]
s_waitcnt lgkmcnt(4)
v_mfma_f32_16x16x32_bf16 v[80:83],v[176:179],v[208:211],v[80:83]
ds_read_b64_tr_b16 v[192:193],v18 offset:24576
ds_read_b64_tr_b16 v[194:195],v18 offset:28672
v_mfma_f32_16x16x32_bf16 v[96:99],v[176:179],v[212:215],v[96:99]
ds_read_b128 v[224:227],v27 offset:36864
ds_read_b128 v[228:231],v27 offset:37120
v_mfma_f32_16x16x32_bf16 v[84:87],v[180:183],v[208:211],v[84:87]
ds_read_b64_tr_b16 v[196:197],v20 offset:24576
ds_read_b64_tr_b16 v[198:199],v20 offset:28672
v_mfma_f32_16x16x32_bf16 v[100:103],v[180:183],v[212:215],v[100:103]
ds_read_b64_tr_b16 v[200:201],v22 offset:24576
ds_read_b64_tr_b16 v[202:203],v22 offset:28672
s_waitcnt lgkmcnt(8)
v_mfma_f32_16x16x32_bf16 v[88:91],v[184:187],v[208:211],v[88:91]
ds_read_b64_tr_b16 v[204:205],v24 offset:24576
ds_read_b64_tr_b16 v[206:207],v24 offset:28672
v_mfma_f32_16x16x32_bf16 v[104:107],v[184:187],v[212:215],v[104:107]
v_mfma_f32_16x16x32_bf16 v[92:95],v[188:191],v[208:211],v[92:95]
v_mfma_f32_16x16x32_bf16 v[108:111],v[188:191],v[212:215],v[108:111]
s_waitcnt lgkmcnt(4)
v_mfma_f32_16x16x32_bf16 v[80:83],v[192:195],v[224:227],v[80:83]
s_waitcnt lgkmcnt(0)
s_barrier
v_mfma_f32_16x16x32_bf16 v[96:99],v[192:195],v[228:231],v[96:99]
ds_read_b64_tr_b16 v[176:177],v18 offset:49152
ds_read_b64_tr_b16 v[178:179],v18 offset:53248
v_mfma_f32_16x16x32_bf16 v[84:87],v[196:199],v[224:227],v[84:87]
ds_read_b128 v[208:211],v27 offset:40960
ds_read_b128 v[212:215],v27 offset:41216
v_mfma_f32_16x16x32_bf16 v[100:103],v[196:199],v[228:231],v[100:103]
ds_read_b64_tr_b16 v[180:181],v20 offset:49152
ds_read_b64_tr_b16 v[182:183],v20 offset:53248
v_mfma_f32_16x16x32_bf16 v[88:91],v[200:203],v[224:227],v[88:91]
ds_read_b64_tr_b16 v[184:185],v22 offset:49152
ds_read_b64_tr_b16 v[186:187],v22 offset:53248
v_mfma_f32_16x16x32_bf16 v[104:107],v[200:203],v[228:231],v[104:107]
ds_read_b64_tr_b16 v[188:189],v24 offset:49152
ds_read_b64_tr_b16 v[190:191],v24 offset:53248
v_mfma_f32_16x16x32_bf16 v[92:95],v[204:207],v[224:227],v[92:95]
v_mfma_f32_16x16x32_bf16 v[108:111],v[204:207],v[228:231],v[108:111]
s_waitcnt lgkmcnt(4)
v_mfma_f32_16x16x32_bf16 v[80:83],v[176:179],v[208:211],v[80:83]
ds_read_b64_tr_b16 v[192:193],v18 offset:57344
ds_read_b64_tr_b16 v[194:195],v18 offset:61440
s_waitcnt vmcnt(0)
s_mov_b32 s75,0x40000
L_r1_pp_chk:
v_cmp_eq_u32 vcc,1,v240
s_sub_u32 s75,s75,1
s_cbranch_scc1 L_r1_pp_ok
s_nop 1
s_cmp_eq_u64 vcc,-1
s_cbranch_scc1 L_r1_pp_ok
s_sleep 4
buffer_load_dword v240,v241,s[20:23],0 offen sc1
s_waitcnt vmcnt(0)
s_branch L_r1_pp_chk
L_r1_pp_ok:
s_lshl_b32 s62,s2,14
s_lshl_b32 s63,s45,13
s_add_u32 s62,s62,s63
s_add_u32 s62,s62,0x2a01000
buffer_load_dwordx4 v[32:35],v9,s[20:23],s62 offen sc1
buffer_load_dwordx4 v[36:39],v9,s[20:23],s62 offen offset:1024 sc1
buffer_load_dwordx4 v[40:43],v9,s[20:23],s62 offen offset:2048 sc1
buffer_load_dwordx4 v[44:47],v9,s[20:23],s62 offen offset:3072 sc1
v_mfma_f32_16x16x32_bf16 v[96:99],v[176:179],v[212:215],v[96:99]
ds_read_b128 v[224:227],v27 offset:45056
ds_read_b128 v[228:231],v27 offset:45312
v_mfma_f32_16x16x32_bf16 v[84:87],v[180:183],v[208:211],v[84:87]
ds_read_b64_tr_b16 v[196:197],v20 offset:57344
ds_read_b64_tr_b16 v[198:199],v20 offset:61440
v_mfma_f32_16x16x32_bf16 v[100:103],v[180:183],v[212:215],v[100:103]
ds_read_b64_tr_b16 v[200:201],v22 offset:57344
ds_read_b64_tr_b16 v[202:203],v22 offset:61440
s_waitcnt lgkmcnt(8)
v_mfma_f32_16x16x32_bf16 v[88:91],v[184:187],v[208:211],v[88:91]
ds_read_b64_tr_b16 v[204:205],v24 offset:57344
ds_read_b64_tr_b16 v[206:207],v24 offset:61440
v_mfma_f32_16x16x32_bf16 v[104:107],v[184:187],v[212:215],v[104:107]
v_mfma_f32_16x16x32_bf16 v[92:95],v[188:191],v[208:211],v[92:95]
v_mfma_f32_16x16x32_bf16 v[108:111],v[188:191],v[212:215],v[108:111]
s_waitcnt lgkmcnt(4)
v_mfma_f32_16x16x32_bf16 v[80:83],v[192:195],v[224:227],v[80:83]
s_waitcnt lgkmcnt(0)
s_barrier
v_mfma_f32_16x16x32_bf16 v[96:99],v[192:195],v[228:231],v[96:99]
ds_read_b64_tr_b16 v[176:177],v19 offset:16384
ds_read_b64_tr_b16 v[178:179],v19 offset:20480
v_mfma_f32_16x16x32_bf16 v[84:87],v[196:199],v[224:227],v[84:87]
ds_read_b128 v[208:211],v26
ds_read_b128 v[212:215],v26 offset:256
v_mfma_f32_16x16x32_bf16 v[100:103],v[196:199],v[228:231],v[100:103]
ds_read_b64_tr_b16 v[180:181],v21 offset:16384
ds_read_b64_tr_b16 v[182:183],v21 offset:20480
v_mfma_f32_16x16x32_bf16 v[88:91],v[200:203],v[224:227],v[88:91]
ds_read_b64_tr_b16 v[184:185],v23 offset:16384
ds_read_b64_tr_b16 v[186:187],v23 offset:20480
v_mfma_f32_16x16x32_bf16 v[104:107],v[200:203],v[228:231],v[104:107]
ds_read_b64_tr_b16 v[188:189],v25 offset:16384
ds_read_b64_tr_b16 v[190:191],v25 offset:20480
v_mfma_f32_16x16x32_bf16 v[92:95],v[204:207],v[224:227],v[92:95]
v_mfma_f32_16x16x32_bf16 v[108:111],v[204:207],v[228:231],v[108:111]
s_waitcnt lgkmcnt(4)
v_mfma_f32_16x16x32_bf16 v[80:83],v[176:179],v[208:211],v[80:83]
ds_read_b64_tr_b16 v[192:193],v19 offset:24576
ds_read_b64_tr_b16 v[194:195],v19 offset:28672
s_waitcnt vmcnt(0)
v_lshlrev_b32 v48,16,v32
v_mfma_f32_16x16x32_bf16 v[96:99],v[176:179],v[212:215],v[96:99]
ds_read_b128 v[224:227],v26 offset:4096
ds_read_b128 v[228:231],v26 offset:4352
v_and_b32 v49,s51,v32
v_add_f32 v112,v144,v48
v_mfma_f32_16x16x32_bf16 v[84:87],v[180:183],v[208:211],v[84:87]
ds_read_b64_tr_b16 v[196:197],v21 offset:24576
ds_read_b64_tr_b16 v[198:199],v21 offset:28672
v_add_f32 v113,v145,v49
v_lshlrev_b32 v48,16,v33
v_mfma_f32_16x16x32_bf16 v[100:103],v[180:183],v[212:215],v[100:103]
ds_read_b64_tr_b16 v[200:201],v23 offset:24576
ds_read_b64_tr_b16 v[202:203],v23 offset:28672
v_and_b32 v49,s51,v33
s_waitcnt lgkmcnt(8)
v_mfma_f32_16x16x32_bf16 v[88:91],v[184:187],v[208:211],v[88:91]
ds_read_b64_tr_b16 v[204:205],v25 offset:24576
ds_read_b64_tr_b16 v[206:207],v25 offset:28672
v_add_f32 v114,v146,v48
v_add_f32 v115,v147,v49
v_mfma_f32_16x16x32_bf16 v[104:107],v[184:187],v[212:215],v[104:107]
v_lshlrev_b32 v48,16,v34
v_and_b32 v49,s51,v34
v_mfma_f32_16x16x32_bf16 v[92:95],v[188:191],v[208:211],v[92:95]
v_add_f32 v116,v148,v48
v_add_f32 v117,v149,v49
v_mfma_f32_16x16x32_bf16 v[108:111],v[188:191],v[212:215],v[108:111]
v_lshlrev_b32 v48,16,v35
s_waitcnt lgkmcnt(4)
v_mfma_f32_16x16x32_bf16 v[80:83],v[192:195],v[224:227],v[80:83]
s_waitcnt lgkmcnt(0)
s_barrier
v_and_b32 v49,s51,v35
v_add_f32 v118,v150,v48
v_add_f32 v119,v151,v49
v_mfma_f32_16x16x32_bf16 v[96:99],v[192:195],v[228:231],v[96:99]
ds_read_b64_tr_b16 v[176:177],v19 offset:49152
ds_read_b64_tr_b16 v[178:179],v19 offset:53248
v_lshlrev_b32 v48,16,v36
v_and_b32 v49,s51,v36
v_mfma_f32_16x16x32_bf16 v[84:87],v[196:199],v[224:227],v[84:87]
ds_read_b128 v[208:211],v26 offset:8192
ds_read_b128 v[212:215],v26 offset:8448
v_add_f32 v120,v152,v48
v_add_f32 v121,v153,v49
v_mfma_f32_16x16x32_bf16 v[100:103],v[196:199],v[228:231],v[100:103]
ds_read_b64_tr_b16 v[180:181],v21 offset:49152
ds_read_b64_tr_b16 v[182:183],v21 offset:53248
v_lshlrev_b32 v48,16,v37
v_and_b32 v49,s51,v37
v_mfma_f32_16x16x32_bf16 v[88:91],v[200:203],v[224:227],v[88:91]
ds_read_b64_tr_b16 v[184:185],v23 offset:49152
ds_read_b64_tr_b16 v[186:187],v23 offset:53248
v_add_f32 v122,v154,v48
v_add_f32 v123,v155,v49
v_lshlrev_b32 v48,16,v38
v_mfma_f32_16x16x32_bf16 v[104:107],v[200:203],v[228:231],v[104:107]
ds_read_b64_tr_b16 v[188:189],v25 offset:49152
ds_read_b64_tr_b16 v[190:191],v25 offset:53248
v_and_b32 v49,s51,v38
v_add_f32 v124,v156,v48
v_mfma_f32_16x16x32_bf16 v[92:95],v[204:207],v[224:227],v[92:95]
v_add_f32 v125,v157,v49
v_lshlrev_b32 v48,16,v39
v_mfma_f32_16x16x32_bf16 v[108:111],v[204:207],v[228:231],v[108:111]
v_and_b32 v49,s51,v39
v_add_f32 v126,v158,v48
s_waitcnt lgkmcnt(4)
v_mfma_f32_16x16x32_bf16 v[80:83],v[176:179],v[208:211],v[80:83]
ds_read_b64_tr_b16 v[192:193],v19 offset:57344
ds_read_b64_tr_b16 v[194:195],v19 offset:61440
v_add_f32 v127,v159,v49
v_lshlrev_b32 v48,16,v40
v_mfma_f32_16x16x32_bf16 v[96:99],v[176:179],v[212:215],v[96:99]
ds_read_b128 v[224:227],v26 offset:12288
ds_read_b128 v[228:231],v26 offset:12544
v_and_b32 v49,s51,v40
v_add_f32 v128,v160,v48
v_mfma_f32_16x16x32_bf16 v[84:87],v[180:183],v[208:211],v[84:87]
ds_read_b64_tr_b16 v[196:197],v21 offset:57344
ds_read_b64_tr_b16 v[198:199],v21 offset:61440
v_add_f32 v129,v161,v49
v_lshlrev_b32 v48,16,v41
v_mfma_f32_16x16x32_bf16 v[100:103],v[180:183],v[212:215],v[100:103]
ds_read_b64_tr_b16 v[200:201],v23 offset:57344
ds_read_b64_tr_b16 v[202:203],v23 offset:61440
v_and_b32 v49,s51,v41
s_waitcnt lgkmcnt(8)
v_mfma_f32_16x16x32_bf16 v[88:91],v[184:187],v[208:211],v[88:91]
ds_read_b64_tr_b16 v[204:205],v25 offset:57344
ds_read_b64_tr_b16 v[206:207],v25 offset:61440
v_add_f32 v130,v162,v48
v_add_f32 v131,v163,v49
v_mfma_f32_16x16x32_bf16 v[104:107],v[184:187],v[212:215],v[104:107]
v_lshlrev_b32 v48,16,v42
v_and_b32 v49,s51,v42
v_mfma_f32_16x16x32_bf16 v[92:95],v[188:191],v[208:211],v[92:95]
v_add_f32 v132,v164,v48
v_add_f32 v133,v165,v49
v_mfma_f32_16x16x32_bf16 v[108:111],v[188:191],v[212:215],v[108:111]
v_lshlrev_b32 v48,16,v43
s_waitcnt lgkmcnt(4)
v_mfma_f32_16x16x32_bf16 v[80:83],v[192:195],v[224:227],v[80:83]
s_waitcnt lgkmcnt(0)
s_barrier
v_and_b32 v49,s51,v43
v_add_f32 v134,v166,v48
v_add_f32 v135,v167,v49
v_mfma_f32_16x16x32_bf16 v[96:99],v[192:195],v[228:231],v[96:99]
ds_read_b64_tr_b16 v[176:177],v18 offset:16384
ds_read_b64_tr_b16 v[178:179],v18 offset:20480
v_lshlrev_b32 v48,16,v44
v_and_b32 v49,s51,v44
v_mfma_f32_16x16x32_bf16 v[84:87],v[196:199],v[224:227],v[84:87]
ds_read_b128 v[208:211],v26 offset:32768
ds_read_b128 v[212:215],v26 offset:33024
v_add_f32 v136,v168,v48
v_add_f32 v137,v169,v49
v_mfma_f32_16x16x32_bf16 v[100:103],v[196:199],v[228:231],v[100:103]
ds_read_b64_tr_b16 v[180:181],v20 offset:16384
ds_read_b64_tr_b16 v[182:183],v20 offset:20480
v_lshlrev_b32 v48,16,v45
v_and_b32 v49,s51,v45
v_mfma_f32_16x16x32_bf16 v[88:91],v[200:203],v[224:227],v[88:91]
ds_read_b64_tr_b16 v[184:185],v22 offset:16384
ds_read_b64_tr_b16 v[186:187],v22 offset:20480
v_add_f32 v138,v170,v48
v_add_f32 v139,v171,v49
v_lshlrev_b32 v48,16,v46
v_mfma_f32_16x16x32_bf16 v[104:107],v[200:203],v[228:231],v[104:107]
ds_read_b64_tr_b16 v[188:189],v24 offset:16384
ds_read_b64_tr_b16 v[190:191],v24 offset:20480
v_and_b32 v49,s51,v46
v_add_f32 v140,v172,v48
v_mfma_f32_16x16x32_bf16 v[92:95],v[204:207],v[224:227],v[92:95]
v_add_f32 v141,v173,v49
v_lshlrev_b32 v48,16,v47
v_mfma_f32_16x16x32_bf16 v[108:111],v[204:207],v[228:231],v[108:111]
v_and_b32 v49,s51,v47
v_add_f32 v142,v174,v48
s_waitcnt lgkmcnt(4)
v_mfma_f32_16x16x32_bf16 v[80:83],v[176:179],v[208:211],v[80:83]
ds_read_b64_tr_b16 v[192:193],v18 offset:24576
ds_read_b64_tr_b16 v[194:195],v18 offset:28672
v_add_f32 v143,v175,v49
v_mfma_f32_16x16x32_bf16 v[96:99],v[176:179],v[212:215],v[96:99]
ds_read_b128 v[224:227],v26 offset:36864
ds_read_b128 v[228:231],v26 offset:37120
v_mfma_f32_16x16x32_bf16 v[84:87],v[180:183],v[208:211],v[84:87]
ds_read_b64_tr_b16 v[196:197],v20 offset:24576
ds_read_b64_tr_b16 v[198:199],v20 offset:28672
v_mfma_f32_16x16x32_bf16 v[100:103],v[180:183],v[212:215],v[100:103]
ds_read_b64_tr_b16 v[200:201],v22 offset:24576
ds_read_b64_tr_b16 v[202:203],v22 offset:28672
s_waitcnt lgkmcnt(8)
v_mfma_f32_16x16x32_bf16 v[88:91],v[184:187],v[208:211],v[88:91]
ds_read_b64_tr_b16 v[204:205],v24 offset:24576
ds_read_b64_tr_b16 v[206:207],v24 offset:28672
v_mfma_f32_16x16x32_bf16 v[104:107],v[184:187],v[212:215],v[104:107]
v_mfma_f32_16x16x32_bf16 v[92:95],v[188:191],v[208:211],v[92:95]
v_mfma_f32_16x16x32_bf16 v[108:111],v[188:191],v[212:215],v[108:111]
s_waitcnt lgkmcnt(4)
v_mfma_f32_16x16x32_bf16 v[80:83],v[192:195],v[224:227],v[80:83]
s_waitcnt lgkmcnt(0)
s_barrier
v_mfma_f32_16x16x32_bf16 v[96:99],v[192:195],v[228:231],v[96:99]
ds_read_b64_tr_b16 v[176:177],v18 offset:49152
ds_read_b64_tr_b16 v[178:179],v18 offset:53248
v_mfma_f32_16x16x32_bf16 v[84:87],v[196:199],v[224:227],v[84:87]
ds_read_b128 v[208:211],v26 offset:40960
ds_read_b128 v[212:215],v26 offset:41216
v_mfma_f32_16x16x32_bf16 v[100:103],v[196:199],v[228:231],v[100:103]
ds_read_b64_tr_b16 v[180:181],v20 offset:49152
ds_read_b64_tr_b16 v[182:183],v20 offset:53248
v_mfma_f32_16x16x32_bf16 v[88:91],v[200:203],v[224:227],v[88:91]
ds_read_b64_tr_b16 v[184:185],v22 offset:49152
ds_read_b64_tr_b16 v[186:187],v22 offset:53248
v_mfma_f32_16x16x32_bf16 v[104:107],v[200:203],v[228:231],v[104:107]
ds_read_b64_tr_b16 v[188:189],v24 offset:49152
ds_read_b64_tr_b16 v[190:191],v24 offset:53248
v_mfma_f32_16x16x32_bf16 v[92:95],v[204:207],v[224:227],v[92:95]
v_mfma_f32_16x16x32_bf16 v[108:111],v[204:207],v[228:231],v[108:111]
s_waitcnt lgkmcnt(4)
v_mfma_f32_16x16x32_bf16 v[80:83],v[176:179],v[208:211],v[80:83]
ds_read_b64_tr_b16 v[192:193],v18 offset:57344
ds_read_b64_tr_b16 v[194:195],v18 offset:61440
v_mfma_f32_16x16x32_bf16 v[96:99],v[176:179],v[212:215],v[96:99]
ds_read_b128 v[224:227],v26 offset:45056
ds_read_b128 v[228:231],v26 offset:45312
v_mfma_f32_16x16x32_bf16 v[84:87],v[180:183],v[208:211],v[84:87]
ds_read_b64_tr_b16 v[196:197],v20 offset:57344
ds_read_b64_tr_b16 v[198:199],v20 offset:61440
v_mfma_f32_16x16x32_bf16 v[100:103],v[180:183],v[212:215],v[100:103]
ds_read_b64_tr_b16 v[200:201],v22 offset:57344
ds_read_b64_tr_b16 v[202:203],v22 offset:61440
s_waitcnt lgkmcnt(8)
v_mfma_f32_16x16x32_bf16 v[88:91],v[184:187],v[208:211],v[88:91]
ds_read_b64_tr_b16 v[204:205],v24 offset:57344
ds_read_b64_tr_b16 v[206:207],v24 offset:61440
v_mfma_f32_16x16x32_bf16 v[104:107],v[184:187],v[212:215],v[104:107]
v_mfma_f32_16x16x32_bf16 v[92:95],v[188:191],v[208:211],v[92:95]
v_mfma_f32_16x16x32_bf16 v[108:111],v[188:191],v[212:215],v[108:111]
s_waitcnt lgkmcnt(4)
v_mfma_f32_16x16x32_bf16 v[80:83],v[192:195],v[224:227],v[80:83]
v_mfma_f32_16x16x32_bf16 v[96:99],v[192:195],v[228:231],v[96:99]
v_mfma_f32_16x16x32_bf16 v[84:87],v[196:199],v[224:227],v[84:87]
v_mfma_f32_16x16x32_bf16 v[100:103],v[196:199],v[228:231],v[100:103]
s_waitcnt lgkmcnt(0)
v_mfma_f32_16x16x32_bf16 v[88:91],v[200:203],v[224:227],v[88:91]
v_mfma_f32_16x16x32_bf16 v[104:107],v[200:203],v[228:231],v[104:107]
v_mfma_f32_16x16x32_bf16 v[92:95],v[204:207],v[224:227],v[92:95]
v_mfma_f32_16x16x32_bf16 v[108:111],v[204:207],v[228:231],v[108:111]
s_nop 3
v_pk_add_f32 v[80:81],v[80:81],v[112:113]
v_pk_add_f32 v[82:83],v[82:83],v[114:115]
v_pk_add_f32 v[84:85],v[84:85],v[116:117]
v_pk_add_f32 v[86:87],v[86:87],v[118:119]
v_cvt_pk_bf16_f32 v48,v80,v81
v_cvt_pk_bf16_f32 v49,v82,v83
v_cvt_pk_bf16_f32 v50,v84,v85
v_cvt_pk_bf16_f32 v51,v86,v87
v_pk_add_f32 v[88:89],v[88:89],v[120:121]
v_pk_add_f32 v[90:91],v[90:91],v[122:123]
v_pk_add_f32 v[92:93],v[92:93],v[124:125]
v_pk_add_f32 v[94:95],v[94:95],v[126:127]
v_cvt_pk_bf16_f32 v52,v88,v89
v_cvt_pk_bf16_f32 v53,v90,v91
v_cvt_pk_bf16_f32 v54,v92,v93
v_cvt_pk_bf16_f32 v55,v94,v95
v_permlane16_swap_b32 v48,v50
v_permlane16_swap_b32 v49,v51
buffer_store_dwordx4 v[48:51],v79,s[56:59],s48 offen
v_pk_add_f32 v[96:97],v[96:97],v[128:129]
v_pk_add_f32 v[98:99],v[98:99],v[130:131]
v_pk_add_f32 v[100:101],v[100:101],v[132:133]
v_pk_add_f32 v[102:103],v[102:103],v[134:135]
v_cvt_pk_bf16_f32 v56,v96,v97
v_cvt_pk_bf16_f32 v57,v98,v99
v_cvt_pk_bf16_f32 v58,v100,v101
v_cvt_pk_bf16_f32 v59,v102,v103
v_permlane16_swap_b32 v52,v54
v_permlane16_swap_b32 v53,v55
buffer_store_dwordx4 v[52:55],v79,s[56:59],s48 offen offset:64
v_pk_add_f32 v[104:105],v[104:105],v[136:137]
v_pk_add_f32 v[106:107],v[106:107],v[138:139]
v_pk_add_f32 v[108:109],v[108:109],v[140:141]
v_pk_add_f32 v[110:111],v[110:111],v[142:143]
v_cvt_pk_bf16_f32 v60,v104,v105
v_cvt_pk_bf16_f32 v61,v106,v107
v_cvt_pk_bf16_f32 v62,v108,v109
v_cvt_pk_bf16_f32 v63,v110,v111
v_permlane16_swap_b32 v56,v58
v_permlane16_swap_b32 v57,v59
buffer_store_dwordx4 v[56:59],v79,s[56:59],s49 offen
s_nop 1
v_permlane16_swap_b32 v60,v62
v_permlane16_swap_b32 v61,v63
buffer_store_dwordx4 v[60:63],v79,s[56:59],s49 offen offset:64
s_endpgm
L_fallback:
v_mov_b32 v12,0xff800000
v_mov_b32 v13,0xff800000
s_lshl_b32 s47,s70,18
s_mov_b32 s50,64
L_fb0:
buffer_load_dwordx4 v[80:83],v9,s[64:67],s47 offen sc1
buffer_load_dwordx4 v[84:87],v9,s[64:67],s47 offen offset:1024 sc1
buffer_load_dwordx4 v[96:99],v9,s[64:67],s47 offen offset:2048 sc1
buffer_load_dwordx4 v[100:103],v9,s[64:67],s47 offen offset:3072 sc1
s_add_u32 s47,s47,4096
s_waitcnt vmcnt(0)
v_mfma_f32_32x32x16_bf16 v[112:127],v[80:83],a[64:67],0
v_mfma_f32_32x32x16_bf16 v[112:127],v[84:87],a[68:71],v[112:127]
v_mfma_f32_32x32x16_bf16 v[128:143],v[80:83],a[72:75],0
v_mfma_f32_32x32x16_bf16 v[128:143],v[84:87],a[76:79],v[128:143]
s_nop 15
s_nop 3
v_max3_f32 v12,v112,v113,v12
v_max3_f32 v12,v114,v115,v12
v_max3_f32 v12,v116,v117,v12
v_max3_f32 v12,v118,v119,v12
v_max3_f32 v12,v120,v121,v12
v_max3_f32 v12,v122,v123,v12
v_max3_f32 v12,v124,v125,v12
v_max3_f32 v12,v126,v127,v12
v_max3_f32 v13,v128,v129,v13
v_max3_f32 v13,v130,v131,v13
v_max3_f32 v13,v132,v133,v13
v_max3_f32 v13,v134,v135,v13
v_max3_f32 v13,v136,v137,v13
v_max3_f32 v13,v138,v139,v13
v_max3_f32 v13,v140,v141,v13
v_max3_f32 v13,v142,v143,v13
s_sub_u32 s50,s50,1
s_cmp_lg_u32 s50,0
s_cbranch_scc1 L_fb0
v_mov_b32 v10,v12
v_mov_b32 v11,v12
s_nop 1
v_permlane32_swap_b32 v10,v11
s_nop 1
v_max_f32 v12,v10,v11
v_mov_b32 v10,v13
v_mov_b32 v11,v13
s_nop 1
v_permlane32_swap_b32 v10,v11
s_nop 1
v_max_f32 v13,v10,v11
s_lshl_b32 s47,s70,18
s_mov_b32 s50,64
v_mov_b32 v32,0
v_mov_b32 v33,0
v_mov_b32 v34,0
v_mov_b32 v35,0
v_mov_b32 v36,0
v_mov_b32 v37,0
v_mov_b32 v38,0
v_mov_b32 v39,0
v_mov_b32 v40,0
v_mov_b32 v41,0
v_mov_b32 v42,0
v_mov_b32 v43,0
v_mov_b32 v44,0
v_mov_b32 v45,0
v_mov_b32 v46,0
v_mov_b32 v47,0
v_mov_b32 v48,0
v_mov_b32 v49,0
v_mov_b32 v50,0
v_mov_b32 v51,0
v_mov_b32 v52,0
v_mov_b32 v53,0
v_mov_b32 v54,0
v_mov_b32 v55,0
v_mov_b32 v56,0
v_mov_b32 v57,0
v_mov_b32 v58,0
v_mov_b32 v59,0
v_mov_b32 v60,0
v_mov_b32 v61,0
v_mov_b32 v62,0
v_mov_b32 v63,0
v_mov_b32 v64,0
v_mov_b32 v65,0
v_mov_b32 v66,0
v_mov_b32 v67,0
v_mov_b32 v68,0
v_mov_b32 v69,0
v_mov_b32 v70,0
v_mov_b32 v71,0
L_fb1:
buffer_load_dwordx4 v[80:83],v9,s[64:67],s47 offen sc1
buffer_load_dwordx4 v[84:87],v9,s[64:67],s47 offen offset:1024 sc1
buffer_load_dwordx4 v[96:99],v9,s[64:67],s47 offen offset:2048 sc1
buffer_load_dwordx4 v[100:103],v9,s[64:67],s47 offen offset:3072 sc1
s_add_u32 s47,s47,4096
s_waitcnt vmcnt(0)
v_mfma_f32_32x32x16_bf16 v[112:127],v[80:83],a[64:67],0
v_mfma_f32_32x32x16_bf16 v[112:127],v[84:87],a[68:71],v[112:127]
v_mfma_f32_32x32x16_bf16 v[128:143],v[80:83],a[72:75],0
v_mfma_f32_32x32x16_bf16 v[128:143],v[84:87],a[76:79],v[128:143]
s_nop 15
s_nop 3
v_sub_f32 v112,v112,v12
v_sub_f32 v113,v113,v12
v_sub_f32 v114,v114,v12
v_sub_f32 v115,v115,v12
v_sub_f32 v116,v116,v12
v_sub_f32 v117,v117,v12
v_sub_f32 v118,v118,v12
v_sub_f32 v119,v119,v12
v_sub_f32 v120,v120,v12
v_sub_f32 v121,v121,v12
v_sub_f32 v122,v122,v12
v_sub_f32 v123,v123,v12
v_sub_f32 v124,v124,v12
v_sub_f32 v125,v125,v12
v_sub_f32 v126,v126,v12
v_sub_f32 v127,v127,v12
v_exp_f32 v112,v112
v_exp_f32 v113,v113
v_exp_f32 v114,v114
v_exp_f32 v115,v115
v_exp_f32 v116,v116
v_exp_f32 v117,v117
v_exp_f32 v118,v118
v_exp_f32 v119,v119
v_exp_f32 v120,v120
v_exp_f32 v121,v121
v_exp_f32 v122,v122
v_exp_f32 v123,v123
v_exp_f32 v124,v124
v_exp_f32 v125,v125
v_exp_f32 v126,v126
v_exp_f32 v127,v127
v_sub_f32 v128,v128,v13
v_sub_f32 v129,v129,v13
v_sub_f32 v130,v130,v13
v_sub_f32 v131,v131,v13
v_sub_f32 v132,v132,v13
v_sub_f32 v133,v133,v13
v_sub_f32 v134,v134,v13
v_sub_f32 v135,v135,v13
v_sub_f32 v136,v136,v13
v_sub_f32 v137,v137,v13
v_sub_f32 v138,v138,v13
v_sub_f32 v139,v139,v13
v_sub_f32 v140,v140,v13
v_sub_f32 v141,v141,v13
v_sub_f32 v142,v142,v13
v_sub_f32 v143,v143,v13
v_exp_f32 v128,v128
v_exp_f32 v129,v129
v_exp_f32 v130,v130
v_exp_f32 v131,v131
v_exp_f32 v132,v132
v_exp_f32 v133,v133
v_exp_f32 v134,v134
v_exp_f32 v135,v135
v_exp_f32 v136,v136
v_exp_f32 v137,v137
v_exp_f32 v138,v138
v_exp_f32 v139,v139
v_exp_f32 v140,v140
v_exp_f32 v141,v141
v_exp_f32 v142,v142
v_exp_f32 v143,v143
s_nop 2
v_smfmac_f32_32x32x32_bf16 v[32:47],v[96:99],v[112:119],v76
v_smfmac_f32_16x16x64_bf16 v[64:67],v[72:75],v[112:119],v76
v_smfmac_f32_32x32x32_bf16 v[32:47],v[100:103],v[120:127],v76
v_smfmac_f32_16x16x64_bf16 v[64:67],v[72:75],v[120:127],v76
v_smfmac_f32_32x32x32_bf16 v[48:63],v[96:99],v[128:135],v76
v_smfmac_f32_16x16x64_bf16 v[68:71],v[72:75],v[128:135],v76
v_smfmac_f32_32x32x32_bf16 v[48:63],v[100:103],v[136:143],v76
v_smfmac_f32_16x16x64_bf16 v[68:71],v[72:75],v[136:143],v76
s_nop 7
s_sub_u32 s50,s50,1
s_cmp_lg_u32 s50,0
s_cbranch_scc1 L_fb1
s_nop 7
s_nop 7
s_branch L_ostore
.section .rodata,"a"
.p2align 6
.amdhsa_kernel parallel_sum__softmax_full_mha__swiglu_ffn__prompt_kernel
  .amdhsa_next_free_vgpr 512
  .amdhsa_next_free_sgpr 102
  .amdhsa_accum_offset 256
  .amdhsa_group_segment_fixed_size 0
  .amdhsa_kernarg_size 80
  .amdhsa_user_sgpr_count 2
  .amdhsa_user_sgpr_kernarg_segment_ptr 1
  .amdhsa_system_sgpr_workgroup_id_x 1
.end_amdhsa_kernel
```
